```python
import torch

def _softmax(x, axis=-1):
    return torch.softmax(x, dim=axis)
def _gelu(x):
    return torch.nn.functional.gelu(x, approximate="tanh")
def _silu(x):
    return torch.nn.functional.silu(x)
def _sigmoid(x):
    return torch.sigmoid(x)
def _layernorm(x, axis=-1, eps=1e-5):
    m = x.mean(dim=axis, keepdim=True)
    v = x.var(dim=axis, keepdim=True, unbiased=False)
    return (x - m) / torch.sqrt(v + eps)
def _scatter_add(tgt, idx, src, axis=0):
    return tgt.clone().index_add_(axis, idx, src)
def _segment_sum(src, seg, n):
    out = torch.zeros((n,) + src.shape[1:], dtype=src.dtype)
    return out.index_add_(0, seg, src)
def _pad(x, pw):
    flat = tuple(v for pair in reversed(pw) for v in pair)
    return torch.nn.functional.pad(x, flat)

kernel_name = 'gated_mix__compressed_kv_cla__mixer_s_mlp__prompt'

def setup_inputs():

    _w = (lambda a: (lambda t: t.to(torch.bfloat16) if t.is_floating_point() else t)(torch.as_tensor(a)))
    def _A_setup():
        B, H, Sq, Sk, D, M = 1, 16, 2048, 2048, 256, 448
        Dc = 4 * D
        return {
            "x": _w((lambda *s: torch.randn(*s, dtype=torch.bfloat16) * 0.05)(B, Sq, M)),
            "c_kv": _w((lambda *s: torch.randn(*s, dtype=torch.bfloat16) * 1.6)(B, Sk, Dc)),
            "w_q": _w((lambda *s: torch.randn(*s, dtype=torch.bfloat16) * 6.4)(M, H, D) * (M ** -0.5)),
            "w_uk": _w((lambda *s: torch.randn(*s, dtype=torch.bfloat16) * 6.4)(Dc, H, D) * (Dc ** -0.5)),
            "w_uv": _w((lambda *s: torch.randn(*s, dtype=torch.bfloat16) * 1.6)(Dc, H, D) * (Dc ** -0.5)),
            "w_o": _w((lambda *s: torch.randn(*s, dtype=torch.bfloat16) * 1.6)(H, D, M) * ((H * D) ** -0.5)),
        }
    _A_in = _A_setup()

    def _B_setup():
        B, S, D, F = 1, 2048, 448, 1792
        return {
            "x":  _w((lambda *s: torch.randn(*s, dtype=torch.bfloat16) * 0.05)(B, S, D)),
            "w1": _w((lambda *s: torch.randn(*s, dtype=torch.bfloat16) * 3.2)(D, D) * (D ** -0.5)),
            "w2": _w((lambda *s: torch.randn(*s, dtype=torch.bfloat16) * 3.2)(D, D) * (D ** -0.5)),
            "w3": _w((lambda *s: torch.randn(*s, dtype=torch.bfloat16) * 3.2)(D, F) * (D ** -0.5)),
            "w4": _w((lambda *s: torch.randn(*s, dtype=torch.bfloat16) * 1.6)(F, D) * (F ** -0.5)),
        }
    _B_in = _B_setup()

    return {
        "A_x": _A_in["x"],
        "A_c_kv": _A_in["c_kv"],
        "A_w_q": _A_in["w_q"],
        "A_w_uk": _A_in["w_uk"],
        "A_w_uv": _A_in["w_uv"],
        "A_w_o": _A_in["w_o"],
        "B_x": _B_in["x"],
        "B_w1": _B_in["w1"],
        "B_w2": _B_in["w2"],
        "B_w3": _B_in["w3"],
        "B_w4": _B_in["w4"],
        "gate_w": _w((lambda *s: torch.randn(*s, dtype=torch.bfloat16) * 0.05)(448) * 16.0),
    }

def reference(A_x, A_c_kv, A_w_q, A_w_uk, A_w_uv, A_w_o, B_x, B_w1, B_w2, B_w3, B_w4, gate_w):
    def _A_ref(x, c_kv, w_q, w_uk, w_uv, w_o):
        B, Sq, M = x.shape[0], x.shape[1], x.shape[2]
        Sk = c_kv.shape[1]
        H, D = w_q.shape[1], w_q.shape[2]
        q = torch.einsum("bqm,mhd->bhqd", x, w_q)
        k = torch.einsum("bkc,chd->bhkd", c_kv, w_uk)
        v = torch.einsum("bkc,chd->bhkd", c_kv, w_uv)
        scores = torch.einsum("bhqd,bhkd->bhqk", q, k) * (D ** -0.5)
        off = Sk - Sq
        qi = torch.arange(Sq)[:, None]
        kj = torch.arange(Sk)[None, :]
        cmask = kj <= (qi + off)
        scores = torch.where(cmask[None, None], scores, -1e9)
        p = _softmax(scores, axis=-1)
        ctx = torch.einsum("bhqk,bhkd->bhqd", p, v)
        return torch.einsum("bhqd,hdm->bqm", ctx, w_o)

    def _B_ref(x, w1, w2, w3, w4):
        B, S, D = x.shape
        h = _gelu(_layernorm(x, axis=-1) @ w1)
        c = D // 4
        g0 = _pad(h[:, :, 0*c:1*c], ((0, 0), (1, 0), (0, 0)))[:, :S, :]
        g1 = _pad(h[:, :, 1*c:2*c], ((0, 0), (0, 1), (0, 0)))[:, 1:, :]
        g2 = _pad(h[:, :, 2*c:3*c], ((0, 0), (2, 0), (0, 0)))[:, :S, :]
        g3 = _pad(h[:, :, 3*c:   ], ((0, 0), (0, 2), (0, 0)))[:, 2:, :]
        hs = torch.concatenate([g0, g1, g2, g3], axis=-1) @ w2
        x1 = x + hs
        h2 = _gelu(_layernorm(x1, axis=-1) @ w3) @ w4
        return x1 + h2

    x = A_x
    g = _sigmoid((x * gate_w).sum(-1, keepdims=True))
    a = _A_ref(x, A_c_kv, A_w_q, A_w_uk, A_w_uv, A_w_o)
    b = _B_ref(x, B_w1, B_w2, B_w3, B_w4)
    return g * a + (1 - g) * b
```

```asm
; @launch grid=(256,1,1) block=(256,1,1) lds=163840
.amdgcn_target "amdgcn-amd-amdhsa--gfx950"
.text
.globl gated_mix__compressed_kv_cla__mixer_s_mlp__prompt_kernel
.p2align 8
.type gated_mix__compressed_kv_cla__mixer_s_mlp__prompt_kernel,@function
gated_mix__compressed_kv_cla__mixer_s_mlp__prompt_kernel:
  s_cmp_ge_u32 s2, 256
  s_cbranch_scc1 Lk_end
  s_load_dwordx8 s[4:11], s[0:1], 0
  s_load_dwordx4 s[12:15], s[0:1], 32
  s_load_dwordx8 s[64:71], s[0:1], 56
  s_load_dwordx2 s[72:73], s[0:1], 88
  s_load_dwordx2 s[74:75], s[0:1], 112
  s_load_dwordx2 s[50:51], s[0:1], 104
  s_and_b32 s32, s2, 7
  s_lshr_b32 s33, s2, 3
  s_and_b32 s16, s33, 7
  s_and_b32 s44, s33, 15
  s_lshr_b32 s17, s33, 4
  s_lshl_b32 s32, s32, 1
  s_add_u32 s17, s17, s32
  s_bfe_u32 s18, s33, 0x10003
  v_and_b32 v1, 63, v0
  v_lshrrev_b32 v2, 6, v0
  s_nop 0
  v_readfirstlane_b32 s19, v2
  s_getpc_b64 s[40:41]
Lk_pc:
  s_lshl_b32 s42, s33, 2
  v_add_u32 v3, s42, v2
  v_lshl_add_u32 v3, v1, 7, v3
  v_lshlrev_b32 v3, 7, v3
  v_min_u32 v3, Lk_end-Lk_pc, v3
  s_mov_b64 exec, 0xff
  global_load_dword v254, v3, s[40:41]
  s_mov_b64 exec, -1
  v_lshrrev_b32 v2, 3, v1
  v_lshlrev_b32 v2, 11, v2
  s_lshl_b32 s32, s16, 19
  s_lshr_b32 s33, s19, 1
  s_lshl_b32 s33, s33, 18
  s_add_u32 s32, s32, s33
  s_and_b32 s33, s19, 1
  s_lshl_b32 s33, s33, 16
  s_add_u32 s32, s32, s33
  v_add_u32 v2, s32, v2
  v_lshrrev_b32 v3, 4, v1
  v_and_b32 v4, 7, v1
  v_xor_b32 v3, v3, v4
  v_lshl_add_u32 v6, v3, 4, v2
  v_xor_b32 v7, 64, v6
  v_add_u32 v7, 0x3c00, v7
  v_add_u32 v8, 0x7800, v6
  v_add_u32 v9, 0x7800, v7
  v_lshrrev_b32 v2, 5, v1
  v_bfe_u32 v3, v1, 1, 4
  v_xor_b32 v3, v3, v2
  s_and_b32 s32, s19, 1
  s_lshl_b32 s32, s32, 2
  v_xor_b32 v3, s32, v3
  v_lshlrev_b32 v2, 13, v2
  s_lshl_b32 s32, s17, 9
  s_lshl_b32 s33, s19, 16
  s_add_u32 s32, s32, s33
  v_add_u32 v2, s32, v2
  v_and_b32 v4, 1, v1
  v_lshl_add_u32 v2, v4, 4, v2
  v_lshl_add_u32 v10, v3, 5, v2
  v_xor_b32 v3, 2, v3
  v_lshl_add_u32 v11, v3, 5, v2
  v_add_u32 v11, 0x3c00, v11
  v_add_u32 v12, 0x7800, v10
  v_add_u32 v13, 0x7800, v11
  s_lshl_b32 s34, s19, 12
  s_mov_b32 s36, 0
  s_mov_b32 s37, 0
  s_waitcnt lgkmcnt(0)
  s_mov_b32 s20, s6
  s_and_b32 s21, s7, 0xffff
  s_mov_b32 s22, 0x400000
  s_mov_b32 s23, 0x20000
  s_cmp_eq_u32 s18, 0
  s_cselect_b32 s24, s10, s12
  s_cselect_b32 s25, s11, s13
  s_and_b32 s25, s25, 0xffff
  s_mov_b32 s26, 0x800000
  s_mov_b32 s27, 0x20000
  s_add_u32 m0, s34, 0x1c000
  s_nop 0
  buffer_load_dwordx4 v10, s[24:27], s37 offen offset:0 lds
  buffer_load_dwordx4 v11, s[24:27], s37 offen offset:1024 lds
  buffer_load_dwordx4 v12, s[24:27], s37 offen offset:2048 lds
  buffer_load_dwordx4 v13, s[24:27], s37 offen offset:3072 lds
  s_add_u32 s37, s37, 0x40000
  s_add_u32 m0, s34, 0x0
  s_nop 0
  buffer_load_dwordx4 v6, s[20:23], s36 offen offset:0 lds
  buffer_load_dwordx4 v7, s[20:23], s36 offen offset:1024 lds
  buffer_load_dwordx4 v8, s[20:23], s36 offen offset:2048 lds
  buffer_load_dwordx4 v9, s[20:23], s36 offen offset:3072 lds
  s_add_u32 s36, s36, 131072
  s_add_u32 m0, s34, 0x10000
  s_nop 0
  buffer_load_dwordx4 v10, s[24:27], s37 offen offset:0 lds
  buffer_load_dwordx4 v11, s[24:27], s37 offen offset:1024 lds
  buffer_load_dwordx4 v12, s[24:27], s37 offen offset:2048 lds
  buffer_load_dwordx4 v13, s[24:27], s37 offen offset:3072 lds
  s_add_u32 s37, s37, 0x40000
  s_add_u32 m0, s34, 0x4000
  s_nop 0
  buffer_load_dwordx4 v6, s[20:23], s36 offen offset:0 lds
  buffer_load_dwordx4 v7, s[20:23], s36 offen offset:1024 lds
  buffer_load_dwordx4 v8, s[20:23], s36 offen offset:2048 lds
  buffer_load_dwordx4 v9, s[20:23], s36 offen offset:3072 lds
  s_sub_u32 s36, s36, 130944
  s_add_u32 m0, s34, 0x14000
  s_nop 0
  buffer_load_dwordx4 v10, s[24:27], s37 offen offset:0 lds
  buffer_load_dwordx4 v11, s[24:27], s37 offen offset:1024 lds
  buffer_load_dwordx4 v12, s[24:27], s37 offen offset:2048 lds
  buffer_load_dwordx4 v13, s[24:27], s37 offen offset:3072 lds
  s_add_u32 s37, s37, 0x40000
  s_mov_b32 s79, 0x20000
  s_mov_b32 s39, 0
  s_cmp_eq_u32 s19, 2
  s_cbranch_scc1 Lk_p21
  s_cmp_eq_u32 s19, 3
  s_cbranch_scc1 Lk_p32
  s_mov_b32 s76, s20
  s_mov_b32 s77, s21
  s_mov_b32 s78, s22
  s_mov_b32 s3, 256
  s_lshr_b32 s32, s2, 6
  s_lshl_b32 s32, s32, 1
  s_add_u32 s32, s32, s19
  s_lshl_b32 s32, s32, 16
  s_lshl_b32 s33, s16, 19
  s_add_u32 s32, s32, s33
  v_lshrrev_b32 v2, 1, v1
  v_lshlrev_b32 v2, 11, v2
  v_and_b32 v3, 1, v1
  v_lshl_add_u32 v2, v3, 7, v2
  v_add_u32 v24, s32, v2
  s_branch Lk_pg3
Lk_p21:
  s_mov_b32 s76, s24
  s_mov_b32 s77, s25
  s_mov_b32 s78, s26
  s_mov_b32 s3, 1048576
  s_lshl_b32 s32, s16, 17
  s_lshl_b32 s33, s17, 9
  s_add_u32 s32, s32, s33
  v_lshrrev_b32 v2, 2, v1
  v_lshlrev_b32 v2, 13, v2
  v_and_b32 v3, 3, v1
  v_lshl_add_u32 v2, v3, 7, v2
  v_add_u32 v24, s32, v2
Lk_pg3:
  buffer_load_dword v25, v24, s[76:79], s39 offen
  s_add_u32 s39, s39, s3
  buffer_load_dword v25, v24, s[76:79], s39 offen
  s_add_u32 s39, s39, s3
  s_branch Lk_ps4
Lk_p32:
  s_mov_b32 s76, s4
  s_mov_b32 s77, s5
  s_mov_b32 s78, 1835008
  s_mov_b32 s33, 64
  s_mov_b32 s3, 32
  s_cmp_ge_u32 s2, 96
  s_cselect_b32 s76, s64, s76
  s_cselect_b32 s77, s65, s77
  s_cselect_b32 s78, 401408, s78
  s_cselect_b32 s33, 96, s33
  s_cselect_b32 s3, 7, s3
  s_cmp_ge_u32 s2, 103
  s_cselect_b32 s76, s66, s76
  s_cselect_b32 s77, s67, s77
  s_cselect_b32 s78, 401408, s78
  s_cselect_b32 s33, 103, s33
  s_cselect_b32 s3, 7, s3
  s_cmp_ge_u32 s2, 110
  s_cselect_b32 s76, s66, s76
  s_cselect_b32 s77, s67, s77
  s_cselect_b32 s78, 0, s78
  s_cselect_b32 s33, 110, s33
  s_cselect_b32 s3, 1, s3
  s_sub_u32 s32, s2, s33
  v_mul_u32_u24 v2, s3, v1
  v_add_u32 v2, s32, v2
  v_lshlrev_b32 v24, 7, v2
  s_mul_i32 s3, s3, 8192
  s_cmp_ge_u32 s2, 64
  s_cbranch_scc1 Lk_pq5
  s_mov_b32 s76, s8
  s_mov_b32 s77, s9
  s_mov_b32 s78, 3670016
  s_mov_b32 s3, 524288
  s_and_b32 s32, s2, 0x38
  s_lshl_b32 s32, s32, 13
  s_and_b32 s33, s2, 7
  s_lshl_b32 s33, s33, 10
  s_add_u32 s32, s32, s33
  v_lshrrev_b32 v2, 3, v1
  v_lshlrev_b32 v2, 13, v2
  v_and_b32 v3, 7, v1
  v_lshl_add_u32 v2, v3, 7, v2
  v_add_u32 v24, s32, v2
Lk_pq5:
  s_and_b32 s77, s77, 0xffff
Lk_ps4:
  v_lshrrev_b32 v39, 4, v1
  v_bfe_u32 v40, v1, 2, 2
  v_sub_u32 v2, 0, v40
  v_xor_b32 v2, v2, v39
  v_and_b32 v2, 3, v2
  v_and_b32 v3, 15, v1
  v_lshlrev_b32 v3, 6, v3
  v_lshl_add_u32 v3, v2, 4, v3
  s_lshr_b32 s45, s19, 1
  s_and_b32 s46, s19, 1
  v_bfe_u32 v2, v1, 1, 3
  v_xor_b32 v2, v2, v39
  v_and_b32 v4, 15, v1
  v_lshlrev_b32 v4, 7, v4
  v_lshl_add_u32 v4, v2, 4, v4
  s_lshl_b32 s32, s45, 13
  v_add_u32 v14, s32, v4
  v_xor_b32 v41, 64, v14
  v_sub_u32 v5, 0, v39
  v_xor_b32 v5, v5, v1
  v_and_b32 v5, 3, v5
  s_lshl_b32 s32, s45, 12
  s_lshl_b32 s33, s46, 11
  s_add_u32 s32, s32, s33
  v_add_u32 v42, s32, v3
  v_xor_b32 v43, 0x800, v42
  v_lshl_add_u32 v2, v39, 3, v40
  v_and_b32 v3, 3, v1
  v_lshlrev_b32 v3, 3, v3
  v_lshl_add_u32 v44, v2, 6, v3
  v_bfe_u32 v4, v1, 4, 1
  v_lshl_add_u32 v44, v4, 5, v44
  v_xor_b32 v45, 32, v44
  v_lshl_add_u32 v46, v2, 5, v3
  v_lshlrev_b32 v2, 9, v2
  v_add_u32 v2, v2, v3
  s_lshl_b32 s32, s46, 8
  s_add_u32 s32, s32, 0x10000
  v_add_u32 v2, s32, v2
  v_bfe_u32 v3, v1, 2, 3
  v_xor_b32 v4, 0, v3
  v_lshl_add_u32 v15, v4, 5, v2
  v_xor_b32 v4, 1, v3
  v_lshl_add_u32 v32, v4, 5, v2
  v_xor_b32 v4, 2, v3
  v_lshl_add_u32 v33, v4, 5, v2
  v_xor_b32 v4, 3, v3
  v_lshl_add_u32 v34, v4, 5, v2
  v_xor_b32 v4, 4, v3
  v_lshl_add_u32 v35, v4, 5, v2
  v_xor_b32 v4, 5, v3
  v_lshl_add_u32 v36, v4, 5, v2
  v_xor_b32 v4, 6, v3
  v_lshl_add_u32 v37, v4, 5, v2
  v_xor_b32 v4, 7, v3
  v_lshl_add_u32 v38, v4, 5, v2
  v_and_b32 v2, 1, v1
  v_xor_b32 v2, 1, v2
  v_lshlrev_b32 v2, 10, v2
  v_lshl_add_u32 v47, v39, 4, v2
  v_add_u32 v47, 0x3000, v47
  v_mov_b32 v48, 0x3f803f80
  v_mov_b32 v49, 0x3f803f80
  v_mov_b32 v50, 0x3f803f80
  v_mov_b32 v51, 0x3f803f80
  v_lshlrev_b32 v52, 4, v1
  v_lshrrev_b32 v2, 2, v1
  s_lshl_b32 s32, s44, 7
  s_lshl_b32 s33, s19, 5
  s_add_u32 s32, s32, s33
  v_add_u32 v2, s32, v2
  v_mul_u32_u24 v2, 896, v2
  v_lshl_add_u32 v53, v5, 4, v2
  v_add_u32 v54, 0x3400, v53
  s_mov_b32 s55, 0x20000
  s_cmp_lt_u32 s19, 2
  s_cbranch_scc1 Lk_xw6
  s_mov_b32 s52, s68
  s_and_b32 s53, s69, 0xffff
  s_cmp_eq_u32 s19, 2
  s_cselect_b32 s54, 0x188000, 0
  s_cmp_lt_u32 s2, 112
  s_cselect_b32 s54, s54, 0
  s_mov_b32 s47, 114688
  v_lshrrev_b32 v2, 1, v1
  v_mul_u32_u24 v2, 3584, v2
  v_and_b32 v3, 1, v1
  v_lshl_add_u32 v2, v3, 4, v2
  s_and_b32 s32, s2, 7
  s_mul_i32 s32, s32, 14
  s_lshr_b32 s33, s2, 3
  s_add_u32 s32, s32, s33
  s_lshl_b32 s32, s32, 5
  v_add_u32 v55, s32, v2
  s_branch Lk_xd7
Lk_xw6:
  s_mov_b32 s52, s64
  s_and_b32 s53, s65, 0xffff
  s_cmp_lt_u32 s17, 14
  s_cselect_b32 s54, 0x62000, 0
  s_mov_b32 s47, 28672
  v_lshrrev_b32 v2, 2, v1
  s_lshl_b32 s32, s19, 4
  v_add_u32 v2, s32, v2
  v_mul_u32_u24 v2, 896, v2
  v_lshrrev_b32 v3, 4, v1
  v_and_b32 v3, 2, v3
  v_xor_b32 v3, v3, v1
  v_and_b32 v3, 3, v3
  v_lshl_add_u32 v2, v3, 4, v2
  s_lshl_b32 s32, s17, 6
  v_add_u32 v55, s32, v2
Lk_xd7:
  s_mov_b32 s56, s4
  s_and_b32 s57, s5, 0xffff
  s_mov_b32 s58, 0x1c0000
  s_mov_b32 s59, 0x20000
  s_mov_b32 s60, s8
  s_and_b32 s61, s9, 0xffff
  s_mov_b32 s62, 0x380000
  s_mov_b32 s63, 0x20000
  s_mov_b32 s28, s74
  s_and_b32 s29, s75, 0xffff
  s_mov_b32 s30, 0x10000000
  s_mov_b32 s31, 0x20000
  v_bfe_u32 v3, v1, 1, 2
  v_lshrrev_b32 v4, 4, v1
  v_xor_b32 v3, v3, v4
  v_lshlrev_b32 v3, 5, v3
  v_and_b32 v4, 1, v1
  v_lshl_add_u32 v56, v4, 4, v3
  s_lshl_b32 s32, s19, 13
  s_add_u32 s97, s32, 0x20000
  v_lshrrev_b32 v2, 2, v1
  v_lshlrev_b32 v2, 7, v2
  v_and_b32 v3, 3, v1
  v_lshl_add_u32 v2, v3, 3, v2
  v_add_u32 v2, s97, v2
  v_bfe_u32 v3, v1, 3, 2
  v_xor_b32 v4, 0, v3
  v_lshl_add_u32 v28, v4, 5, v2
  v_xor_b32 v4, 1, v3
  v_lshl_add_u32 v29, v4, 5, v2
  v_xor_b32 v4, 2, v3
  v_lshl_add_u32 v30, v4, 5, v2
  v_xor_b32 v4, 3, v3
  v_lshl_add_u32 v31, v4, 5, v2
  s_mov_b64 s[48:49], s[72:73]
  s_mov_b32 s38, s66
  s_mov_b32 s35, s67
  s_lshl_b32 s32, s2, 2
  s_add_u32 s32, s32, s19
  s_lshl_b32 s32, s32, 1
  s_add_u32 s32, s32, 0
  s_mov_b32 s7, 0x20000
  s_cmp_ge_u32 s32, 392
  s_cbranch_scc1 Lk_jo8
  s_mov_b32 s4, s68
  s_and_b32 s5, s69, 0xffff
  s_mov_b32 s6, 1605632
  s_mul_i32 s33, s32, 2341
  s_lshr_b32 s33, s33, 16
  s_mul_i32 s40, s33, 28
  s_sub_u32 s40, s32, s40
  s_mul_i32 s9, s33, 114688
  s_lshl_b32 s41, s40, 7
  s_add_u32 s9, s9, s41
  s_mov_b32 s8, 3584
  s_mul_i32 s33, s33, 7
  s_lshl_b32 s40, s40, 2
  s_add_u32 s41, s40, 0
  s_mul_i32 s42, s41, 9363
  s_lshr_b32 s42, s42, 16
  s_mul_i32 s43, s42, 1017
  s_add_u32 s41, s41, s33
  s_add_u32 s10, s41, s43
  s_add_u32 s41, s40, 1
  s_mul_i32 s42, s41, 9363
  s_lshr_b32 s42, s42, 16
  s_mul_i32 s43, s42, 1017
  s_add_u32 s41, s41, s33
  s_add_u32 s11, s41, s43
  s_add_u32 s41, s40, 2
  s_mul_i32 s42, s41, 9363
  s_lshr_b32 s42, s42, 16
  s_mul_i32 s43, s42, 1017
  s_add_u32 s41, s41, s33
  s_add_u32 s12, s41, s43
  s_add_u32 s41, s40, 3
  s_mul_i32 s42, s41, 9363
  s_lshr_b32 s42, s42, 16
  s_mul_i32 s43, s42, 1017
  s_add_u32 s41, s41, s33
  s_add_u32 s13, s41, s43
  s_branch Lk_jd10
Lk_jo8:
  s_mov_b32 s8, 896
  s_cmp_ge_u32 s32, 1288
  s_cbranch_scc1 Lk_j49
  s_mov_b32 s4, s14
  s_and_b32 s5, s15, 0xffff
  s_mov_b32 s6, 3670016
  s_sub_u32 s32, s32, 392
  s_mul_i32 s33, s32, 9363
  s_lshr_b32 s33, s33, 16
  s_mul_i32 s40, s33, 7
  s_sub_u32 s40, s32, s40
  s_mul_i32 s9, s33, 28672
  s_lshl_b32 s41, s40, 7
  s_add_u32 s9, s9, s41
  s_lshr_b32 s42, s33, 3
  s_lshl_b32 s42, s42, 10
  s_and_b32 s33, s33, 7
  s_lshl_b32 s33, s33, 1
  s_add_u32 s33, s33, s42
  s_lshl_b32 s40, s40, 1
  s_bitcmp1_b32 s42, 10
  s_cselect_b32 s41, 7, 0
  s_add_u32 s40, s40, s41
  s_add_u32 s41, s40, 0
  s_sub_u32 s43, s41, 14
  s_cselect_b32 s41, s41, s43
  s_mul_i32 s41, s41, 24
  s_add_u32 s41, s41, s33
  s_add_u32 s10, s41, 98
  s_add_u32 s11, s41, 99
  s_add_u32 s41, s40, 1
  s_sub_u32 s43, s41, 14
  s_cselect_b32 s41, s41, s43
  s_mul_i32 s41, s41, 24
  s_add_u32 s41, s41, s33
  s_add_u32 s12, s41, 98
  s_add_u32 s13, s41, 99
  s_branch Lk_jd10
Lk_j49:
  s_mov_b32 s4, s70
  s_and_b32 s5, s71, 0xffff
  s_cmp_lt_u32 s32, 1736
  s_cselect_b32 s6, 1605632, 0
  s_sub_u32 s32, s32, 1288
  s_mul_i32 s33, s32, 9363
  s_lshr_b32 s33, s33, 16
  s_mul_i32 s40, s33, 7
  s_sub_u32 s40, s32, s40
  s_lshr_b32 s42, s33, 2
  s_and_b32 s33, s33, 3
  s_mul_i32 s9, s42, 100352
  s_mul_i32 s41, s33, 28672
  s_add_u32 s9, s9, s41
  s_lshl_b32 s41, s40, 7
  s_add_u32 s9, s9, s41
  s_lshl_b32 s42, s42, 10
  s_lshl_b32 s33, s33, 1
  s_add_u32 s33, s33, s42
  s_lshl_b32 s40, s40, 1
  s_bitcmp1_b32 s42, 10
  s_cselect_b32 s41, 7, 0
  s_add_u32 s40, s40, s41
  s_add_u32 s41, s40, 0
  s_sub_u32 s43, s41, 14
  s_cselect_b32 s41, s41, s43
  s_mul_i32 s41, s41, 24
  s_add_u32 s41, s41, s33
  s_add_u32 s10, s41, 114
  s_add_u32 s11, s41, 115
  s_add_u32 s41, s40, 1
  s_sub_u32 s43, s41, 14
  s_cselect_b32 s41, s41, s43
  s_mul_i32 s41, s41, 24
  s_add_u32 s41, s41, s33
  s_add_u32 s12, s41, 114
  s_add_u32 s13, s41, 115
Lk_jd10:
  s_lshr_b32 s40, s10, 10
  s_cmp_ge_u32 s40, 16
  s_cselect_b32 s40, 1100, s40
  s_mul_i32 s40, s40, 229376
  s_bfe_u32 s41, s10, 0x50005
  s_lshl_b32 s41, s41, 14
  s_add_u32 s40, s40, s41
  s_mov_b32 s41, 0x2000000
  s_bitcmp1_b32 s10, 4
  s_cmov_b32 s41, 0x2ffc000
  s_add_u32 s40, s40, s41
  s_and_b32 s41, s10, 15
  s_lshl_b32 s41, s41, 10
  s_add_u32 s10, s40, s41
  s_lshr_b32 s40, s11, 10
  s_cmp_ge_u32 s40, 16
  s_cselect_b32 s40, 1100, s40
  s_mul_i32 s40, s40, 229376
  s_bfe_u32 s41, s11, 0x50005
  s_lshl_b32 s41, s41, 14
  s_add_u32 s40, s40, s41
  s_mov_b32 s41, 0x2000000
  s_bitcmp1_b32 s11, 4
  s_cmov_b32 s41, 0x2ffc000
  s_add_u32 s40, s40, s41
  s_and_b32 s41, s11, 15
  s_lshl_b32 s41, s41, 10
  s_add_u32 s11, s40, s41
  s_lshr_b32 s40, s12, 10
  s_cmp_ge_u32 s40, 16
  s_cselect_b32 s40, 1100, s40
  s_mul_i32 s40, s40, 229376
  s_bfe_u32 s41, s12, 0x50005
  s_lshl_b32 s41, s41, 14
  s_add_u32 s40, s40, s41
  s_mov_b32 s41, 0x2000000
  s_bitcmp1_b32 s12, 4
  s_cmov_b32 s41, 0x2ffc000
  s_add_u32 s40, s40, s41
  s_and_b32 s41, s12, 15
  s_lshl_b32 s41, s41, 10
  s_add_u32 s12, s40, s41
  s_lshr_b32 s40, s13, 10
  s_cmp_ge_u32 s40, 16
  s_cselect_b32 s40, 1100, s40
  s_mul_i32 s40, s40, 229376
  s_bfe_u32 s41, s13, 0x50005
  s_lshl_b32 s41, s41, 14
  s_add_u32 s40, s40, s41
  s_mov_b32 s41, 0x2000000
  s_bitcmp1_b32 s13, 4
  s_cmov_b32 s41, 0x2ffc000
  s_add_u32 s40, s40, s41
  s_and_b32 s41, s13, 15
  s_lshl_b32 s41, s41, 10
  s_add_u32 s13, s40, s41
  v_lshrrev_b32 v26, 3, v1
  v_mul_lo_u32 v26, v26, s8
  v_add_u32 v26, v26, v56
  s_lshl_b32 s8, s8, 3
  s_lshl_b32 s32, s2, 2
  s_add_u32 s32, s32, s19
  s_lshl_b32 s32, s32, 1
  s_add_u32 s32, s32, 1
  s_mov_b32 s67, 0x20000
  s_cmp_ge_u32 s32, 392
  s_cbranch_scc1 Lk_jo11
  s_mov_b32 s64, s68
  s_and_b32 s65, s69, 0xffff
  s_mov_b32 s66, 1605632
  s_mul_i32 s33, s32, 2341
  s_lshr_b32 s33, s33, 16
  s_mul_i32 s40, s33, 28
  s_sub_u32 s40, s32, s40
  s_mul_i32 s73, s33, 114688
  s_lshl_b32 s41, s40, 7
  s_add_u32 s73, s73, s41
  s_mov_b32 s72, 3584
  s_mul_i32 s33, s33, 7
  s_lshl_b32 s40, s40, 2
  s_add_u32 s41, s40, 0
  s_mul_i32 s42, s41, 9363
  s_lshr_b32 s42, s42, 16
  s_mul_i32 s43, s42, 1017
  s_add_u32 s41, s41, s33
  s_add_u32 s98, s41, s43
  s_add_u32 s41, s40, 1
  s_mul_i32 s42, s41, 9363
  s_lshr_b32 s42, s42, 16
  s_mul_i32 s43, s42, 1017
  s_add_u32 s41, s41, s33
  s_add_u32 s99, s41, s43
  s_add_u32 s41, s40, 2
  s_mul_i32 s42, s41, 9363
  s_lshr_b32 s42, s42, 16
  s_mul_i32 s43, s42, 1017
  s_add_u32 s41, s41, s33
  s_add_u32 s100, s41, s43
  s_add_u32 s41, s40, 3
  s_mul_i32 s42, s41, 9363
  s_lshr_b32 s42, s42, 16
  s_mul_i32 s43, s42, 1017
  s_add_u32 s41, s41, s33
  s_add_u32 s101, s41, s43
  s_branch Lk_jd13
Lk_jo11:
  s_mov_b32 s72, 896
  s_cmp_ge_u32 s32, 1288
  s_cbranch_scc1 Lk_j412
  s_mov_b32 s64, s14
  s_and_b32 s65, s15, 0xffff
  s_mov_b32 s66, 3670016
  s_sub_u32 s32, s32, 392
  s_mul_i32 s33, s32, 9363
  s_lshr_b32 s33, s33, 16
  s_mul_i32 s40, s33, 7
  s_sub_u32 s40, s32, s40
  s_mul_i32 s73, s33, 28672
  s_lshl_b32 s41, s40, 7
  s_add_u32 s73, s73, s41
  s_lshr_b32 s42, s33, 3
  s_lshl_b32 s42, s42, 10
  s_and_b32 s33, s33, 7
  s_lshl_b32 s33, s33, 1
  s_add_u32 s33, s33, s42
  s_lshl_b32 s40, s40, 1
  s_bitcmp1_b32 s42, 10
  s_cselect_b32 s41, 7, 0
  s_add_u32 s40, s40, s41
  s_add_u32 s41, s40, 0
  s_sub_u32 s43, s41, 14
  s_cselect_b32 s41, s41, s43
  s_mul_i32 s41, s41, 24
  s_add_u32 s41, s41, s33
  s_add_u32 s98, s41, 98
  s_add_u32 s99, s41, 99
  s_add_u32 s41, s40, 1
  s_sub_u32 s43, s41, 14
  s_cselect_b32 s41, s41, s43
  s_mul_i32 s41, s41, 24
  s_add_u32 s41, s41, s33
  s_add_u32 s100, s41, 98
  s_add_u32 s101, s41, 99
  s_branch Lk_jd13
Lk_j412:
  s_mov_b32 s64, s70
  s_and_b32 s65, s71, 0xffff
  s_cmp_lt_u32 s32, 1736
  s_cselect_b32 s66, 1605632, 0
  s_sub_u32 s32, s32, 1288
  s_mul_i32 s33, s32, 9363
  s_lshr_b32 s33, s33, 16
  s_mul_i32 s40, s33, 7
  s_sub_u32 s40, s32, s40
  s_lshr_b32 s42, s33, 2
  s_and_b32 s33, s33, 3
  s_mul_i32 s73, s42, 100352
  s_mul_i32 s41, s33, 28672
  s_add_u32 s73, s73, s41
  s_lshl_b32 s41, s40, 7
  s_add_u32 s73, s73, s41
  s_lshl_b32 s42, s42, 10
  s_lshl_b32 s33, s33, 1
  s_add_u32 s33, s33, s42
  s_lshl_b32 s40, s40, 1
  s_bitcmp1_b32 s42, 10
  s_cselect_b32 s41, 7, 0
  s_add_u32 s40, s40, s41
  s_add_u32 s41, s40, 0
  s_sub_u32 s43, s41, 14
  s_cselect_b32 s41, s41, s43
  s_mul_i32 s41, s41, 24
  s_add_u32 s41, s41, s33
  s_add_u32 s98, s41, 114
  s_add_u32 s99, s41, 115
  s_add_u32 s41, s40, 1
  s_sub_u32 s43, s41, 14
  s_cselect_b32 s41, s41, s43
  s_mul_i32 s41, s41, 24
  s_add_u32 s41, s41, s33
  s_add_u32 s100, s41, 114
  s_add_u32 s101, s41, 115
Lk_jd13:
  s_lshr_b32 s40, s98, 10
  s_cmp_ge_u32 s40, 16
  s_cselect_b32 s40, 1100, s40
  s_mul_i32 s40, s40, 229376
  s_bfe_u32 s41, s98, 0x50005
  s_lshl_b32 s41, s41, 14
  s_add_u32 s40, s40, s41
  s_mov_b32 s41, 0x2000000
  s_bitcmp1_b32 s98, 4
  s_cmov_b32 s41, 0x2ffc000
  s_add_u32 s40, s40, s41
  s_and_b32 s41, s98, 15
  s_lshl_b32 s41, s41, 10
  s_add_u32 s98, s40, s41
  s_lshr_b32 s40, s99, 10
  s_cmp_ge_u32 s40, 16
  s_cselect_b32 s40, 1100, s40
  s_mul_i32 s40, s40, 229376
  s_bfe_u32 s41, s99, 0x50005
  s_lshl_b32 s41, s41, 14
  s_add_u32 s40, s40, s41
  s_mov_b32 s41, 0x2000000
  s_bitcmp1_b32 s99, 4
  s_cmov_b32 s41, 0x2ffc000
  s_add_u32 s40, s40, s41
  s_and_b32 s41, s99, 15
  s_lshl_b32 s41, s41, 10
  s_add_u32 s99, s40, s41
  s_lshr_b32 s40, s100, 10
  s_cmp_ge_u32 s40, 16
  s_cselect_b32 s40, 1100, s40
  s_mul_i32 s40, s40, 229376
  s_bfe_u32 s41, s100, 0x50005
  s_lshl_b32 s41, s41, 14
  s_add_u32 s40, s40, s41
  s_mov_b32 s41, 0x2000000
  s_bitcmp1_b32 s100, 4
  s_cmov_b32 s41, 0x2ffc000
  s_add_u32 s40, s40, s41
  s_and_b32 s41, s100, 15
  s_lshl_b32 s41, s41, 10
  s_add_u32 s100, s40, s41
  s_lshr_b32 s40, s101, 10
  s_cmp_ge_u32 s40, 16
  s_cselect_b32 s40, 1100, s40
  s_mul_i32 s40, s40, 229376
  s_bfe_u32 s41, s101, 0x50005
  s_lshl_b32 s41, s41, 14
  s_add_u32 s40, s40, s41
  s_mov_b32 s41, 0x2000000
  s_bitcmp1_b32 s101, 4
  s_cmov_b32 s41, 0x2ffc000
  s_add_u32 s40, s40, s41
  s_and_b32 s41, s101, 15
  s_lshl_b32 s41, s41, 10
  s_add_u32 s101, s40, s41
  v_lshrrev_b32 v27, 3, v1
  v_mul_lo_u32 v27, v27, s72
  v_add_u32 v27, v27, v56
  s_lshl_b32 s72, s72, 3
  s_mov_b32 s68, s48
  s_and_b32 s69, s49, 0xffff
  s_mov_b32 s70, 0x380
  s_mov_b32 s71, 0x20000
  s_mov_b32 s14, s38
  s_mov_b32 s15, s35
  s_lshl_b32 s35, s19, 11
  s_lshl_b32 s48, s19, 10
  s_add_u32 s48, s48, 8192
  s_mov_b32 s49, 0
  s_add_u32 m0, s34, 0x8000
  s_nop 0
  buffer_load_dwordx4 v6, s[20:23], s36 offen offset:0 lds
  buffer_load_dwordx4 v7, s[20:23], s36 offen offset:1024 lds
  buffer_load_dwordx4 v8, s[20:23], s36 offen offset:2048 lds
  buffer_load_dwordx4 v9, s[20:23], s36 offen offset:3072 lds
  s_add_u32 s36, s36, 131072
  s_add_u32 m0, s34, 0x18000
  s_nop 0
  buffer_load_dwordx4 v10, s[24:27], s37 offen offset:0 lds
  buffer_load_dwordx4 v11, s[24:27], s37 offen offset:1024 lds
  buffer_load_dwordx4 v12, s[24:27], s37 offen offset:2048 lds
  buffer_load_dwordx4 v13, s[24:27], s37 offen offset:3072 lds
  s_add_u32 s37, s37, 0x40000
  s_waitcnt vmcnt(16)
  s_barrier
  ds_read_b64_tr_b16 v[216:217], v15 offset:49152
  ds_read_b64_tr_b16 v[218:219], v15 offset:51200
  ds_read_b64_tr_b16 v[220:221], v32 offset:49152
  ds_read_b64_tr_b16 v[222:223], v32 offset:51200
  ds_read_b64_tr_b16 v[224:225], v33 offset:49152
  ds_read_b64_tr_b16 v[226:227], v33 offset:51200
  ds_read_b64_tr_b16 v[228:229], v34 offset:49152
  ds_read_b64_tr_b16 v[230:231], v34 offset:51200
  ds_read_b64_tr_b16 v[236:237], v35 offset:49152
  ds_read_b64_tr_b16 v[238:239], v35 offset:51200
  ds_read_b64_tr_b16 v[240:241], v36 offset:49152
  ds_read_b64_tr_b16 v[242:243], v36 offset:51200
  ds_read_b64_tr_b16 v[244:245], v37 offset:49152
  ds_read_b64_tr_b16 v[246:247], v37 offset:51200
  ds_read_b64_tr_b16 v[248:249], v38 offset:49152
  ds_read_b64_tr_b16 v[250:251], v38 offset:51200
  ds_read_b128 v[56:59], v14 offset:0
  ds_read_b64_tr_b16 v[120:121], v15 offset:0
  ds_read_b64_tr_b16 v[122:123], v15 offset:2048
  ds_read_b128 v[60:63], v41 offset:0
  ds_read_b64_tr_b16 v[124:125], v32 offset:0
  ds_read_b64_tr_b16 v[126:127], v32 offset:2048
  ds_read_b128 v[64:67], v14 offset:2048
  ds_read_b64_tr_b16 v[128:129], v33 offset:0
  ds_read_b64_tr_b16 v[130:131], v33 offset:2048
  ds_read_b128 v[68:71], v41 offset:2048
  ds_read_b64_tr_b16 v[132:133], v34 offset:0
  ds_read_b64_tr_b16 v[134:135], v34 offset:2048
  ds_read_b128 v[72:75], v14 offset:4096
  ds_read_b64_tr_b16 v[136:137], v35 offset:0
  ds_read_b64_tr_b16 v[138:139], v35 offset:2048
  ds_read_b128 v[76:79], v41 offset:4096
  ds_read_b64_tr_b16 v[140:141], v36 offset:0
  ds_read_b64_tr_b16 v[142:143], v36 offset:2048
  ds_read_b128 v[80:83], v14 offset:6144
  ds_read_b64_tr_b16 v[144:145], v37 offset:0
  ds_read_b64_tr_b16 v[146:147], v37 offset:2048
  ds_read_b128 v[84:87], v41 offset:6144
  ds_read_b64_tr_b16 v[148:149], v38 offset:0
  ds_read_b64_tr_b16 v[150:151], v38 offset:2048
  s_add_u32 m0, s34, 0xc000
  s_nop 0
  buffer_load_dwordx4 v6, s[20:23], s36 offen offset:0 lds
  buffer_load_dwordx4 v7, s[20:23], s36 offen offset:1024 lds
  buffer_load_dwordx4 v8, s[20:23], s36 offen offset:2048 lds
  buffer_load_dwordx4 v9, s[20:23], s36 offen offset:3072 lds
  s_sub_u32 s36, s36, 130944
  s_cmp_eq_u32 s18, 0
  s_cbranch_scc0 Lk_V
  s_lshl_b32 s40, s17, 20
  s_lshl_b32 s41, s16, 17
  s_add_u32 s40, s40, s41
  s_lshl_b32 s41, s45, 16
  s_add_u32 s40, s40, s41
  s_lshl_b32 s41, s46, 12
  s_add_u32 s40, s40, s41
  s_mov_b32 s41, 8192
  s_mov_b32 s42, 8192
  s_mov_b32 s38, 0
  s_mov_b32 s43, s97
  s_waitcnt lgkmcnt(0)
  s_waitcnt vmcnt(12)
  s_barrier
  v_mfma_f32_16x16x32_bf16 a[0:3], v[216:219], v[56:59], 0
  s_add_u32 m0, s34, 0x1c000
  ds_read_b128 v[88:91], v14 offset:16384
  v_mfma_f32_16x16x32_bf16 a[0:3], v[120:123], v[60:63], a[0:3]
  buffer_load_dwordx4 v10, s[24:27], s37 offen offset:0 lds
  v_mfma_f32_16x16x32_bf16 a[32:35], v[120:123], v[68:71], 0
  ds_read_b64_tr_b16 v[184:185], v15 offset:16384
  v_mfma_f32_16x16x32_bf16 a[32:35], v[216:219], v[64:67], a[32:35]
  v_mfma_f32_16x16x32_bf16 a[36:39], v[220:223], v[64:67], 0
  buffer_load_dwordx4 v11, s[24:27], s37 offen offset:1024 lds
  v_mfma_f32_16x16x32_bf16 a[36:39], v[124:127], v[68:71], a[36:39]
  ds_read_b64_tr_b16 v[186:187], v15 offset:18432
  v_mfma_f32_16x16x32_bf16 a[4:7], v[124:127], v[60:63], 0
  v_mfma_f32_16x16x32_bf16 a[4:7], v[220:223], v[56:59], a[4:7]
  buffer_load_dwordx4 v12, s[24:27], s37 offen offset:2048 lds
  v_mfma_f32_16x16x32_bf16 a[8:11], v[224:227], v[56:59], 0
  ds_read_b128 v[92:95], v41 offset:16384
  v_mfma_f32_16x16x32_bf16 a[8:11], v[128:131], v[60:63], a[8:11]
  v_mfma_f32_16x16x32_bf16 a[40:43], v[128:131], v[68:71], 0
  buffer_load_dwordx4 v13, s[24:27], s37 offen offset:3072 lds
  v_mfma_f32_16x16x32_bf16 a[40:43], v[224:227], v[64:67], a[40:43]
  s_add_u32 s37, s37, 0x40000
  s_add_u32 m0, s34, 0x0
  ds_read_b64_tr_b16 v[188:189], v32 offset:16384
  v_mfma_f32_16x16x32_bf16 a[44:47], v[228:231], v[64:67], 0
  v_mfma_f32_16x16x32_bf16 a[44:47], v[132:135], v[68:71], a[44:47]
  buffer_load_dwordx4 v6, s[20:23], s36 offen offset:0 lds
  v_mfma_f32_16x16x32_bf16 a[12:15], v[132:135], v[60:63], 0
  ds_read_b64_tr_b16 v[190:191], v32 offset:18432
  v_mfma_f32_16x16x32_bf16 a[12:15], v[228:231], v[56:59], a[12:15]
  v_mfma_f32_16x16x32_bf16 a[16:19], v[236:239], v[56:59], 0
  buffer_load_dwordx4 v7, s[20:23], s36 offen offset:1024 lds
  v_mfma_f32_16x16x32_bf16 a[16:19], v[136:139], v[60:63], a[16:19]
  ds_read_b128 v[96:99], v14 offset:18432
  v_mfma_f32_16x16x32_bf16 a[48:51], v[136:139], v[68:71], 0
  v_mfma_f32_16x16x32_bf16 a[48:51], v[236:239], v[64:67], a[48:51]
  buffer_load_dwordx4 v8, s[20:23], s36 offen offset:2048 lds
  v_mfma_f32_16x16x32_bf16 a[52:55], v[240:243], v[64:67], 0
  ds_read_b64_tr_b16 v[192:193], v33 offset:16384
  v_mfma_f32_16x16x32_bf16 a[52:55], v[140:143], v[68:71], a[52:55]
  v_mfma_f32_16x16x32_bf16 a[20:23], v[140:143], v[60:63], 0
  buffer_load_dwordx4 v9, s[20:23], s36 offen offset:3072 lds
  v_mfma_f32_16x16x32_bf16 a[20:23], v[240:243], v[56:59], a[20:23]
  s_add_u32 s36, s36, 131072
  s_add_u32 m0, s34, 0x10000
  ds_read_b64_tr_b16 v[194:195], v33 offset:18432
  v_mfma_f32_16x16x32_bf16 a[24:27], v[244:247], v[56:59], 0
  v_mfma_f32_16x16x32_bf16 a[24:27], v[144:147], v[60:63], a[24:27]
  buffer_load_dwordx4 v10, s[24:27], s37 offen offset:0 lds
  v_mfma_f32_16x16x32_bf16 a[56:59], v[144:147], v[68:71], 0
  ds_read_b128 v[100:103], v41 offset:18432
  v_mfma_f32_16x16x32_bf16 a[56:59], v[244:247], v[64:67], a[56:59]
  v_mfma_f32_16x16x32_bf16 a[60:63], v[248:251], v[64:67], 0
  buffer_load_dwordx4 v11, s[24:27], s37 offen offset:1024 lds
  v_mfma_f32_16x16x32_bf16 a[60:63], v[148:151], v[68:71], a[60:63]
  ds_read_b64_tr_b16 v[196:197], v34 offset:16384
  v_mfma_f32_16x16x32_bf16 a[28:31], v[148:151], v[60:63], 0
  v_mfma_f32_16x16x32_bf16 a[28:31], v[248:251], v[56:59], a[28:31]
  buffer_load_dwordx4 v12, s[24:27], s37 offen offset:2048 lds
  v_mfma_f32_16x16x32_bf16 a[92:95], v[248:251], v[72:75], 0
  ds_read_b64_tr_b16 v[198:199], v34 offset:18432
  v_mfma_f32_16x16x32_bf16 a[92:95], v[148:151], v[76:79], a[92:95]
  v_mfma_f32_16x16x32_bf16 a[124:127], v[148:151], v[84:87], 0
  buffer_load_dwordx4 v13, s[24:27], s37 offen offset:3072 lds
  v_mfma_f32_16x16x32_bf16 a[124:127], v[248:251], v[80:83], a[124:127]
  s_add_u32 s37, s37, 0x40000
  ds_read_b128 v[104:107], v14 offset:20480
  v_mfma_f32_16x16x32_bf16 a[120:123], v[244:247], v[80:83], 0
  v_mfma_f32_16x16x32_bf16 a[120:123], v[144:147], v[84:87], a[120:123]
  ds_read_b64_tr_b16 v[200:201], v35 offset:16384
  v_mfma_f32_16x16x32_bf16 a[88:91], v[144:147], v[76:79], 0
  v_mfma_f32_16x16x32_bf16 a[88:91], v[244:247], v[72:75], a[88:91]
  ds_read_b64_tr_b16 v[202:203], v35 offset:18432
  v_mfma_f32_16x16x32_bf16 a[84:87], v[240:243], v[72:75], 0
  buffer_load_dword v25, v24, s[76:79], s39 offen
  v_mfma_f32_16x16x32_bf16 a[84:87], v[140:143], v[76:79], a[84:87]
  s_add_u32 s39, s39, s3
  s_mov_b32 m0, s43
  ds_read_b128 v[108:111], v41 offset:20480
  v_mfma_f32_16x16x32_bf16 a[116:119], v[140:143], v[84:87], 0
  buffer_load_dwordx4 v26, s[4:7], s9 offen lds
  v_mfma_f32_16x16x32_bf16 a[116:119], v[240:243], v[80:83], a[116:119]
  s_cmp_lt_u32 s38, 3
  s_cselect_b32 s33, s8, 0
  ds_read_b64_tr_b16 v[204:205], v36 offset:16384
  v_mfma_f32_16x16x32_bf16 a[112:115], v[236:239], v[80:83], 0
  s_add_u32 s9, s9, s33
  s_cmp_lt_u32 s38, 3
  s_cselect_b32 s33, 0x400, 0
  v_mfma_f32_16x16x32_bf16 a[112:115], v[136:139], v[84:87], a[112:115]
  s_add_u32 s43, s43, s33
  ds_read_b64_tr_b16 v[206:207], v36 offset:18432
  v_mfma_f32_16x16x32_bf16 a[80:83], v[136:139], v[76:79], 0
  v_mfma_f32_16x16x32_bf16 a[80:83], v[236:239], v[72:75], a[80:83]
  ds_read_b128 v[112:115], v14 offset:22528
  v_mfma_f32_16x16x32_bf16 a[76:79], v[228:231], v[72:75], 0
  v_mfma_f32_16x16x32_bf16 a[76:79], v[132:135], v[76:79], a[76:79]
  ds_read_b64_tr_b16 v[208:209], v37 offset:16384
  v_mfma_f32_16x16x32_bf16 a[108:111], v[132:135], v[84:87], 0
  v_mfma_f32_16x16x32_bf16 a[108:111], v[228:231], v[80:83], a[108:111]
  ds_read_b64_tr_b16 v[210:211], v37 offset:18432
  v_mfma_f32_16x16x32_bf16 a[104:107], v[224:227], v[80:83], 0
  v_mfma_f32_16x16x32_bf16 a[104:107], v[128:131], v[84:87], a[104:107]
  ds_read_b128 v[116:119], v41 offset:22528
  v_mfma_f32_16x16x32_bf16 a[72:75], v[128:131], v[76:79], 0
  v_mfma_f32_16x16x32_bf16 a[72:75], v[224:227], v[72:75], a[72:75]
  ds_read_b64_tr_b16 v[212:213], v38 offset:16384
  v_mfma_f32_16x16x32_bf16 a[68:71], v[220:223], v[72:75], 0
  v_mfma_f32_16x16x32_bf16 a[68:71], v[124:127], v[76:79], a[68:71]
  ds_read_b64_tr_b16 v[214:215], v38 offset:18432
  v_mfma_f32_16x16x32_bf16 a[100:103], v[124:127], v[84:87], 0
  v_mfma_f32_16x16x32_bf16 a[100:103], v[220:223], v[80:83], a[100:103]
  v_mfma_f32_16x16x32_bf16 a[96:99], v[216:219], v[80:83], 0
  v_mfma_f32_16x16x32_bf16 a[96:99], v[120:123], v[84:87], a[96:99]
  v_mfma_f32_16x16x32_bf16 a[64:67], v[120:123], v[76:79], 0
  v_mfma_f32_16x16x32_bf16 a[64:67], v[216:219], v[72:75], a[64:67]
  s_waitcnt lgkmcnt(0)
  s_waitcnt vmcnt(18)
  s_xor_b32 s32, s2, 56
  s_or_b32 s32, s32, s19
  s_cbranch_scc1 Lk_z14
  v_mov_b32 v2, 0
  v_lshlrev_b32 v3, 7, v1
  s_mov_b32 s32, 0x4f00000
  buffer_store_dword v2, v3, s[28:31], s32 offen sc1
  s_mov_b32 s32, 0x4f02000
  buffer_store_dword v2, v3, s[28:31], s32 offen sc1
  s_mov_b32 s32, 0x4f04000
  buffer_store_dword v2, v3, s[28:31], s32 offen sc1
  s_mov_b32 s32, 0x4f06000
  buffer_store_dword v2, v3, s[28:31], s32 offen sc1
  v_mov_b32 v20, 0
  v_mov_b32 v21, 0
  v_mov_b32 v22, 0
  v_mov_b32 v23, 0
  s_mov_b32 s32, 0x4f06000
  buffer_store_dwordx4 v[20:23], v52, s[28:31], s32 offen offset:0 sc1
  buffer_store_dwordx4 v[20:23], v52, s[28:31], s32 offen offset:1024 sc1
  buffer_store_dwordx4 v[20:23], v52, s[28:31], s32 offen offset:2048 sc1
  v_min_u32 v3, 56, v1
  v_mul_u32_u24 v3, 32896, v3
  s_mov_b32 s32, 0x4800000
  buffer_store_dwordx4 v[20:23], v3, s[28:31], s32 offen offset:0 sc1
  buffer_store_dwordx4 v[20:23], v3, s[28:31], s32 offen offset:16 sc1
  buffer_store_dwordx4 v[20:23], v3, s[28:31], s32 offen offset:96 sc1
  buffer_store_dwordx4 v[20:23], v3, s[28:31], s32 offen offset:112 sc1
Lk_z14:
  s_barrier
  v_mfma_f32_16x16x32_bf16 a[128:131], v[216:219], v[88:91], 0
  s_add_u32 m0, s34, 0x4000
  ds_read_b128 v[56:59], v14 offset:32768
  v_mfma_f32_16x16x32_bf16 a[128:131], v[120:123], v[92:95], a[128:131]
  v_mfma_f32_16x16x32_bf16 a[160:163], v[120:123], v[100:103], 0
  ds_read_b64_tr_b16 v[152:153], v15 offset:32768
  v_mfma_f32_16x16x32_bf16 a[160:163], v[216:219], v[96:99], a[160:163]
  v_mfma_f32_16x16x32_bf16 a[164:167], v[220:223], v[96:99], 0
  ds_read_b64_tr_b16 v[154:155], v15 offset:34816
  v_mfma_f32_16x16x32_bf16 a[164:167], v[124:127], v[100:103], a[164:167]
  v_mfma_f32_16x16x32_bf16 a[132:135], v[124:127], v[92:95], 0
  ds_read_b128 v[60:63], v41 offset:32768
  v_mfma_f32_16x16x32_bf16 a[132:135], v[220:223], v[88:91], a[132:135]
  v_mfma_f32_16x16x32_bf16 a[136:139], v[224:227], v[88:91], 0
  ds_read_b64_tr_b16 v[156:157], v32 offset:32768
  v_mfma_f32_16x16x32_bf16 a[136:139], v[128:131], v[92:95], a[136:139]
  v_mfma_f32_16x16x32_bf16 a[168:171], v[128:131], v[100:103], 0
  ds_read_b64_tr_b16 v[158:159], v32 offset:34816
  v_mfma_f32_16x16x32_bf16 a[168:171], v[224:227], v[96:99], a[168:171]
  v_mfma_f32_16x16x32_bf16 a[172:175], v[228:231], v[96:99], 0
  ds_read_b128 v[64:67], v14 offset:34816
  v_mfma_f32_16x16x32_bf16 a[172:175], v[132:135], v[100:103], a[172:175]
  v_mfma_f32_16x16x32_bf16 a[140:143], v[132:135], v[92:95], 0
  ds_read_b64_tr_b16 v[160:161], v33 offset:32768
  v_mfma_f32_16x16x32_bf16 a[140:143], v[228:231], v[88:91], a[140:143]
  v_mfma_f32_16x16x32_bf16 a[144:147], v[236:239], v[88:91], 0
  ds_read_b64_tr_b16 v[162:163], v33 offset:34816
  v_mfma_f32_16x16x32_bf16 a[144:147], v[136:139], v[92:95], a[144:147]
  v_mfma_f32_16x16x32_bf16 a[176:179], v[136:139], v[100:103], 0
  ds_read_b128 v[68:71], v41 offset:34816
  v_mfma_f32_16x16x32_bf16 a[176:179], v[236:239], v[96:99], a[176:179]
  v_mfma_f32_16x16x32_bf16 a[180:183], v[240:243], v[96:99], 0
  ds_read_b64_tr_b16 v[164:165], v34 offset:32768
  v_mfma_f32_16x16x32_bf16 a[180:183], v[140:143], v[100:103], a[180:183]
  v_mfma_f32_16x16x32_bf16 a[148:151], v[140:143], v[92:95], 0
  ds_read_b64_tr_b16 v[166:167], v34 offset:34816
  v_mfma_f32_16x16x32_bf16 a[148:151], v[240:243], v[88:91], a[148:151]
  v_mfma_f32_16x16x32_bf16 a[152:155], v[244:247], v[88:91], 0
  ds_read_b128 v[72:75], v14 offset:36864
  v_mfma_f32_16x16x32_bf16 a[152:155], v[144:147], v[92:95], a[152:155]
  v_mfma_f32_16x16x32_bf16 a[184:187], v[144:147], v[100:103], 0
  ds_read_b64_tr_b16 v[168:169], v35 offset:32768
  v_mfma_f32_16x16x32_bf16 a[184:187], v[244:247], v[96:99], a[184:187]
  v_mfma_f32_16x16x32_bf16 a[188:191], v[248:251], v[96:99], 0
  ds_read_b64_tr_b16 v[170:171], v35 offset:34816
  v_mfma_f32_16x16x32_bf16 a[188:191], v[148:151], v[100:103], a[188:191]
  v_mfma_f32_16x16x32_bf16 a[156:159], v[148:151], v[92:95], 0
  ds_read_b128 v[76:79], v41 offset:36864
  v_mfma_f32_16x16x32_bf16 a[156:159], v[248:251], v[88:91], a[156:159]
  v_mfma_f32_16x16x32_bf16 a[220:223], v[248:251], v[104:107], 0
  ds_read_b64_tr_b16 v[172:173], v36 offset:32768
  v_mfma_f32_16x16x32_bf16 a[220:223], v[148:151], v[108:111], a[220:223]
  v_mfma_f32_16x16x32_bf16 a[252:255], v[148:151], v[116:119], 0
  ds_read_b64_tr_b16 v[174:175], v36 offset:34816
  v_mfma_f32_16x16x32_bf16 a[252:255], v[248:251], v[112:115], a[252:255]
  v_mfma_f32_16x16x32_bf16 a[248:251], v[244:247], v[112:115], 0
  ds_read_b128 v[80:83], v14 offset:38912
  v_mfma_f32_16x16x32_bf16 a[248:251], v[144:147], v[116:119], a[248:251]
  v_mfma_f32_16x16x32_bf16 a[216:219], v[144:147], v[108:111], 0
  ds_read_b64_tr_b16 v[176:177], v37 offset:32768
  v_mfma_f32_16x16x32_bf16 a[216:219], v[244:247], v[104:107], a[216:219]
  v_mfma_f32_16x16x32_bf16 a[212:215], v[240:243], v[104:107], 0
  ds_read_b64_tr_b16 v[178:179], v37 offset:34816
  v_mfma_f32_16x16x32_bf16 a[212:215], v[140:143], v[108:111], a[212:215]
  v_mfma_f32_16x16x32_bf16 a[244:247], v[140:143], v[116:119], 0
  ds_read_b128 v[84:87], v41 offset:38912
  v_mfma_f32_16x16x32_bf16 a[244:247], v[240:243], v[112:115], a[244:247]
  v_mfma_f32_16x16x32_bf16 a[240:243], v[236:239], v[112:115], 0
  ds_read_b64_tr_b16 v[180:181], v38 offset:32768
  v_mfma_f32_16x16x32_bf16 a[240:243], v[136:139], v[116:119], a[240:243]
  v_mfma_f32_16x16x32_bf16 a[208:211], v[136:139], v[108:111], 0
  ds_read_b64_tr_b16 v[182:183], v38 offset:34816
  v_mfma_f32_16x16x32_bf16 a[208:211], v[236:239], v[104:107], a[208:211]
  v_mfma_f32_16x16x32_bf16 a[204:207], v[228:231], v[104:107], 0
  v_mfma_f32_16x16x32_bf16 a[204:207], v[132:135], v[108:111], a[204:207]
  v_mfma_f32_16x16x32_bf16 a[236:239], v[132:135], v[116:119], 0
  v_mfma_f32_16x16x32_bf16 a[236:239], v[228:231], v[112:115], a[236:239]
  v_mfma_f32_16x16x32_bf16 a[232:235], v[224:227], v[112:115], 0
  v_mfma_f32_16x16x32_bf16 a[232:235], v[128:131], v[116:119], a[232:235]
  v_mfma_f32_16x16x32_bf16 a[200:203], v[128:131], v[108:111], 0
  v_mfma_f32_16x16x32_bf16 a[200:203], v[224:227], v[104:107], a[200:203]
  v_mfma_f32_16x16x32_bf16 a[196:199], v[220:223], v[104:107], 0
  v_mfma_f32_16x16x32_bf16 a[196:199], v[124:127], v[108:111], a[196:199]
  v_mfma_f32_16x16x32_bf16 a[228:231], v[124:127], v[116:119], 0
  v_mfma_f32_16x16x32_bf16 a[228:231], v[220:223], v[112:115], a[228:231]
  v_mfma_f32_16x16x32_bf16 a[224:227], v[216:219], v[112:115], 0
  v_mfma_f32_16x16x32_bf16 a[224:227], v[120:123], v[116:119], a[224:227]
  v_mfma_f32_16x16x32_bf16 a[192:195], v[120:123], v[108:111], 0
  v_mfma_f32_16x16x32_bf16 a[192:195], v[216:219], v[104:107], a[192:195]
  s_waitcnt lgkmcnt(0)
  s_waitcnt vmcnt(10)
  s_barrier
  v_mfma_f32_16x16x32_bf16 a[0:3], v[184:187], v[56:59], a[0:3]
  ds_read_b128 v[88:91], v14 offset:49152
  v_mfma_f32_16x16x32_bf16 a[0:3], v[152:155], v[60:63], a[0:3]
  v_mfma_f32_16x16x32_bf16 a[32:35], v[152:155], v[68:71], a[32:35]
  ds_read_b64_tr_b16 v[216:217], v15 offset:49152
  v_mfma_f32_16x16x32_bf16 a[32:35], v[184:187], v[64:67], a[32:35]
  v_mfma_f32_16x16x32_bf16 a[36:39], v[188:191], v[64:67], a[36:39]
  ds_read_b64_tr_b16 v[218:219], v15 offset:51200
  v_mfma_f32_16x16x32_bf16 a[36:39], v[156:159], v[68:71], a[36:39]
  v_mfma_f32_16x16x32_bf16 a[4:7], v[156:159], v[60:63], a[4:7]
  ds_read_b128 v[92:95], v41 offset:49152
  v_mfma_f32_16x16x32_bf16 a[4:7], v[188:191], v[56:59], a[4:7]
  v_mfma_f32_16x16x32_bf16 a[8:11], v[192:195], v[56:59], a[8:11]
  ds_read_b64_tr_b16 v[220:221], v32 offset:49152
  v_mfma_f32_16x16x32_bf16 a[8:11], v[160:163], v[60:63], a[8:11]
  v_mfma_f32_16x16x32_bf16 a[40:43], v[160:163], v[68:71], a[40:43]
  ds_read_b64_tr_b16 v[222:223], v32 offset:51200
  v_mfma_f32_16x16x32_bf16 a[40:43], v[192:195], v[64:67], a[40:43]
  v_mfma_f32_16x16x32_bf16 a[44:47], v[196:199], v[64:67], a[44:47]
  buffer_load_dwordx4 v6, s[20:23], s36 offen offset:0 lds
  v_mfma_f32_16x16x32_bf16 a[44:47], v[164:167], v[68:71], a[44:47]
  ds_read_b128 v[96:99], v14 offset:51200
  v_mfma_f32_16x16x32_bf16 a[12:15], v[164:167], v[60:63], a[12:15]
  v_mfma_f32_16x16x32_bf16 a[12:15], v[196:199], v[56:59], a[12:15]
  ds_read_b64_tr_b16 v[224:225], v33 offset:49152
  v_mfma_f32_16x16x32_bf16 a[16:19], v[200:203], v[56:59], a[16:19]
  buffer_load_dwordx4 v7, s[20:23], s36 offen offset:1024 lds
  v_mfma_f32_16x16x32_bf16 a[16:19], v[168:171], v[60:63], a[16:19]
  ds_read_b64_tr_b16 v[226:227], v33 offset:51200
  v_mfma_f32_16x16x32_bf16 a[48:51], v[168:171], v[68:71], a[48:51]
  v_mfma_f32_16x16x32_bf16 a[48:51], v[200:203], v[64:67], a[48:51]
  ds_read_b128 v[100:103], v41 offset:51200
  v_mfma_f32_16x16x32_bf16 a[52:55], v[204:207], v[64:67], a[52:55]
  buffer_load_dwordx4 v8, s[20:23], s36 offen offset:2048 lds
  v_mfma_f32_16x16x32_bf16 a[52:55], v[172:175], v[68:71], a[52:55]
  ds_read_b64_tr_b16 v[228:229], v34 offset:49152
  v_mfma_f32_16x16x32_bf16 a[20:23], v[172:175], v[60:63], a[20:23]
  v_mfma_f32_16x16x32_bf16 a[20:23], v[204:207], v[56:59], a[20:23]
  ds_read_b64_tr_b16 v[230:231], v34 offset:51200
  v_mfma_f32_16x16x32_bf16 a[24:27], v[208:211], v[56:59], a[24:27]
  buffer_load_dwordx4 v9, s[20:23], s36 offen offset:3072 lds
  v_mfma_f32_16x16x32_bf16 a[24:27], v[176:179], v[60:63], a[24:27]
  s_sub_u32 s36, s36, 130944
  s_add_u32 m0, s34, 0x14000
  ds_read_b128 v[104:107], v14 offset:53248
  v_mfma_f32_16x16x32_bf16 a[56:59], v[176:179], v[68:71], a[56:59]
  v_mfma_f32_16x16x32_bf16 a[56:59], v[208:211], v[64:67], a[56:59]
  ds_read_b64_tr_b16 v[236:237], v35 offset:49152
  v_mfma_f32_16x16x32_bf16 a[60:63], v[212:215], v[64:67], a[60:63]
  buffer_load_dwordx4 v10, s[24:27], s37 offen offset:0 lds
  v_mfma_f32_16x16x32_bf16 a[60:63], v[180:183], v[68:71], a[60:63]
  ds_read_b64_tr_b16 v[238:239], v35 offset:51200
  v_mfma_f32_16x16x32_bf16 a[28:31], v[180:183], v[60:63], a[28:31]
  v_mfma_f32_16x16x32_bf16 a[28:31], v[212:215], v[56:59], a[28:31]
  ds_read_b128 v[108:111], v41 offset:53248
  v_mfma_f32_16x16x32_bf16 a[92:95], v[212:215], v[72:75], a[92:95]
  buffer_load_dwordx4 v11, s[24:27], s37 offen offset:1024 lds
  v_mfma_f32_16x16x32_bf16 a[92:95], v[180:183], v[76:79], a[92:95]
  ds_read_b64_tr_b16 v[240:241], v36 offset:49152
  v_mfma_f32_16x16x32_bf16 a[124:127], v[180:183], v[84:87], a[124:127]
  v_mfma_f32_16x16x32_bf16 a[124:127], v[212:215], v[80:83], a[124:127]
  ds_read_b64_tr_b16 v[242:243], v36 offset:51200
  v_mfma_f32_16x16x32_bf16 a[120:123], v[208:211], v[80:83], a[120:123]
  buffer_load_dwordx4 v12, s[24:27], s37 offen offset:2048 lds
  v_mfma_f32_16x16x32_bf16 a[120:123], v[176:179], v[84:87], a[120:123]
  ds_read_b128 v[112:115], v14 offset:55296
  v_mfma_f32_16x16x32_bf16 a[88:91], v[176:179], v[76:79], a[88:91]
  v_mfma_f32_16x16x32_bf16 a[88:91], v[208:211], v[72:75], a[88:91]
  ds_read_b64_tr_b16 v[244:245], v37 offset:49152
  v_mfma_f32_16x16x32_bf16 a[84:87], v[204:207], v[72:75], a[84:87]
  buffer_load_dwordx4 v13, s[24:27], s37 offen offset:3072 lds
  v_mfma_f32_16x16x32_bf16 a[84:87], v[172:175], v[76:79], a[84:87]
  s_add_u32 s37, s37, 0x40000
  s_add_u32 m0, s34, 0x8000
  ds_read_b64_tr_b16 v[246:247], v37 offset:51200
  v_mfma_f32_16x16x32_bf16 a[116:119], v[172:175], v[84:87], a[116:119]
  v_mfma_f32_16x16x32_bf16 a[116:119], v[204:207], v[80:83], a[116:119]
  ds_read_b128 v[116:119], v41 offset:55296
  v_mfma_f32_16x16x32_bf16 a[112:115], v[200:203], v[80:83], a[112:115]
  buffer_load_dwordx4 v6, s[20:23], s36 offen offset:0 lds
  v_mfma_f32_16x16x32_bf16 a[112:115], v[168:171], v[84:87], a[112:115]
  ds_read_b64_tr_b16 v[248:249], v38 offset:49152
  v_mfma_f32_16x16x32_bf16 a[80:83], v[168:171], v[76:79], a[80:83]
  v_mfma_f32_16x16x32_bf16 a[80:83], v[200:203], v[72:75], a[80:83]
  ds_read_b64_tr_b16 v[250:251], v38 offset:51200
  v_mfma_f32_16x16x32_bf16 a[76:79], v[196:199], v[72:75], a[76:79]
  buffer_load_dwordx4 v7, s[20:23], s36 offen offset:1024 lds
  v_mfma_f32_16x16x32_bf16 a[76:79], v[164:167], v[76:79], a[76:79]
  v_mfma_f32_16x16x32_bf16 a[108:111], v[164:167], v[84:87], a[108:111]
  v_mfma_f32_16x16x32_bf16 a[108:111], v[196:199], v[80:83], a[108:111]
  v_mfma_f32_16x16x32_bf16 a[104:107], v[192:195], v[80:83], a[104:107]
  buffer_load_dwordx4 v8, s[20:23], s36 offen offset:2048 lds
  v_mfma_f32_16x16x32_bf16 a[104:107], v[160:163], v[84:87], a[104:107]
  v_mfma_f32_16x16x32_bf16 a[72:75], v[160:163], v[76:79], a[72:75]
  v_mfma_f32_16x16x32_bf16 a[72:75], v[192:195], v[72:75], a[72:75]
  v_mfma_f32_16x16x32_bf16 a[68:71], v[188:191], v[72:75], a[68:71]
  buffer_load_dwordx4 v9, s[20:23], s36 offen offset:3072 lds
  v_mfma_f32_16x16x32_bf16 a[68:71], v[156:159], v[76:79], a[68:71]
  s_add_u32 s36, s36, 131072
  s_add_u32 m0, s34, 0x18000
  v_mfma_f32_16x16x32_bf16 a[100:103], v[156:159], v[84:87], a[100:103]
  v_mfma_f32_16x16x32_bf16 a[100:103], v[188:191], v[80:83], a[100:103]
  v_mfma_f32_16x16x32_bf16 a[96:99], v[184:187], v[80:83], a[96:99]
  v_mfma_f32_16x16x32_bf16 a[96:99], v[152:155], v[84:87], a[96:99]
  v_mfma_f32_16x16x32_bf16 a[64:67], v[152:155], v[76:79], a[64:67]
  v_mfma_f32_16x16x32_bf16 a[64:67], v[184:187], v[72:75], a[64:67]
  s_waitcnt lgkmcnt(0)
  s_waitcnt vmcnt(14)
  s_barrier
  v_mfma_f32_16x16x32_bf16 a[128:131], v[184:187], v[88:91], a[128:131]
  ds_read_b128 v[56:59], v14 offset:0
  v_mfma_f32_16x16x32_bf16 a[128:131], v[152:155], v[92:95], a[128:131]
  buffer_load_dwordx4 v10, s[24:27], s37 offen offset:0 lds
  v_mfma_f32_16x16x32_bf16 a[160:163], v[152:155], v[100:103], a[160:163]
  ds_read_b64_tr_b16 v[120:121], v15 offset:0
  v_mfma_f32_16x16x32_bf16 a[160:163], v[184:187], v[96:99], a[160:163]
  v_mfma_f32_16x16x32_bf16 a[164:167], v[188:191], v[96:99], a[164:167]
  ds_read_b64_tr_b16 v[122:123], v15 offset:2048
  v_mfma_f32_16x16x32_bf16 a[164:167], v[156:159], v[100:103], a[164:167]
  v_mfma_f32_16x16x32_bf16 a[132:135], v[156:159], v[92:95], a[132:135]
  buffer_load_dwordx4 v11, s[24:27], s37 offen offset:1024 lds
  v_mfma_f32_16x16x32_bf16 a[132:135], v[188:191], v[88:91], a[132:135]
  ds_read_b128 v[60:63], v41 offset:0
  v_mfma_f32_16x16x32_bf16 a[136:139], v[192:195], v[88:91], a[136:139]
  v_mfma_f32_16x16x32_bf16 a[136:139], v[160:163], v[92:95], a[136:139]
  ds_read_b64_tr_b16 v[124:125], v32 offset:0
  v_mfma_f32_16x16x32_bf16 a[168:171], v[160:163], v[100:103], a[168:171]
  v_mfma_f32_16x16x32_bf16 a[168:171], v[192:195], v[96:99], a[168:171]
  buffer_load_dwordx4 v12, s[24:27], s37 offen offset:2048 lds
  v_mfma_f32_16x16x32_bf16 a[172:175], v[196:199], v[96:99], a[172:175]
  ds_read_b64_tr_b16 v[126:127], v32 offset:2048
  v_mfma_f32_16x16x32_bf16 a[172:175], v[164:167], v[100:103], a[172:175]
  v_mfma_f32_16x16x32_bf16 a[140:143], v[164:167], v[92:95], a[140:143]
  ds_read_b128 v[64:67], v14 offset:2048
  v_mfma_f32_16x16x32_bf16 a[140:143], v[196:199], v[88:91], a[140:143]
  v_mfma_f32_16x16x32_bf16 a[144:147], v[200:203], v[88:91], a[144:147]
  buffer_load_dwordx4 v13, s[24:27], s37 offen offset:3072 lds
  v_mfma_f32_16x16x32_bf16 a[144:147], v[168:171], v[92:95], a[144:147]
  s_add_u32 s37, s37, 0x40000
  s_add_u32 m0, s34, 0xc000
  ds_read_b64_tr_b16 v[128:129], v33 offset:0
  v_mfma_f32_16x16x32_bf16 a[176:179], v[168:171], v[100:103], a[176:179]
  v_mfma_f32_16x16x32_bf16 a[176:179], v[200:203], v[96:99], a[176:179]
  ds_read_b64_tr_b16 v[130:131], v33 offset:2048
  v_mfma_f32_16x16x32_bf16 a[180:183], v[204:207], v[96:99], a[180:183]
  v_mfma_f32_16x16x32_bf16 a[180:183], v[172:175], v[100:103], a[180:183]
  buffer_load_dwordx4 v6, s[20:23], s36 offen offset:0 lds
  v_mfma_f32_16x16x32_bf16 a[148:151], v[172:175], v[92:95], a[148:151]
  ds_read_b128 v[68:71], v41 offset:2048
  v_mfma_f32_16x16x32_bf16 a[148:151], v[204:207], v[88:91], a[148:151]
  v_mfma_f32_16x16x32_bf16 a[152:155], v[208:211], v[88:91], a[152:155]
  ds_read_b64_tr_b16 v[132:133], v34 offset:0
  v_mfma_f32_16x16x32_bf16 a[152:155], v[176:179], v[92:95], a[152:155]
  v_mfma_f32_16x16x32_bf16 a[184:187], v[176:179], v[100:103], a[184:187]
  buffer_load_dwordx4 v7, s[20:23], s36 offen offset:1024 lds
  v_mfma_f32_16x16x32_bf16 a[184:187], v[208:211], v[96:99], a[184:187]
  ds_read_b64_tr_b16 v[134:135], v34 offset:2048
  v_mfma_f32_16x16x32_bf16 a[188:191], v[212:215], v[96:99], a[188:191]
  v_mfma_f32_16x16x32_bf16 a[188:191], v[180:183], v[100:103], a[188:191]
  ds_read_b128 v[72:75], v14 offset:4096
  v_mfma_f32_16x16x32_bf16 a[156:159], v[180:183], v[92:95], a[156:159]
  v_mfma_f32_16x16x32_bf16 a[156:159], v[212:215], v[88:91], a[156:159]
  buffer_load_dwordx4 v8, s[20:23], s36 offen offset:2048 lds
  v_mfma_f32_16x16x32_bf16 a[220:223], v[212:215], v[104:107], a[220:223]
  ds_read_b64_tr_b16 v[136:137], v35 offset:0
  v_mfma_f32_16x16x32_bf16 a[220:223], v[180:183], v[108:111], a[220:223]
  v_mfma_f32_16x16x32_bf16 a[252:255], v[180:183], v[116:119], a[252:255]
  ds_read_b64_tr_b16 v[138:139], v35 offset:2048
  v_mfma_f32_16x16x32_bf16 a[252:255], v[212:215], v[112:115], a[252:255]
  v_mfma_f32_16x16x32_bf16 a[248:251], v[208:211], v[112:115], a[248:251]
  buffer_load_dwordx4 v9, s[20:23], s36 offen offset:3072 lds
  v_mfma_f32_16x16x32_bf16 a[248:251], v[176:179], v[116:119], a[248:251]
  s_sub_u32 s36, s36, 130944
  s_add_u32 m0, s34, 0x1c000
  ds_read_b128 v[76:79], v41 offset:4096
  v_mfma_f32_16x16x32_bf16 a[216:219], v[176:179], v[108:111], a[216:219]
  v_mfma_f32_16x16x32_bf16 a[216:219], v[208:211], v[104:107], a[216:219]
  ds_read_b64_tr_b16 v[140:141], v36 offset:0
  v_mfma_f32_16x16x32_bf16 a[212:215], v[204:207], v[104:107], a[212:215]
  v_mfma_f32_16x16x32_bf16 a[212:215], v[172:175], v[108:111], a[212:215]
  buffer_load_dwordx4 v10, s[24:27], s37 offen offset:0 lds
  v_mfma_f32_16x16x32_bf16 a[244:247], v[172:175], v[116:119], a[244:247]
  ds_read_b64_tr_b16 v[142:143], v36 offset:2048
  v_mfma_f32_16x16x32_bf16 a[244:247], v[204:207], v[112:115], a[244:247]
  v_mfma_f32_16x16x32_bf16 a[240:243], v[200:203], v[112:115], a[240:243]
  ds_read_b128 v[80:83], v14 offset:6144
  v_mfma_f32_16x16x32_bf16 a[240:243], v[168:171], v[116:119], a[240:243]
  v_mfma_f32_16x16x32_bf16 a[208:211], v[168:171], v[108:111], a[208:211]
  buffer_load_dwordx4 v11, s[24:27], s37 offen offset:1024 lds
  v_mfma_f32_16x16x32_bf16 a[208:211], v[200:203], v[104:107], a[208:211]
  ds_read_b64_tr_b16 v[144:145], v37 offset:0
  v_mfma_f32_16x16x32_bf16 a[204:207], v[196:199], v[104:107], a[204:207]
  v_mfma_f32_16x16x32_bf16 a[204:207], v[164:167], v[108:111], a[204:207]
  ds_read_b64_tr_b16 v[146:147], v37 offset:2048
  v_mfma_f32_16x16x32_bf16 a[236:239], v[164:167], v[116:119], a[236:239]
  v_mfma_f32_16x16x32_bf16 a[236:239], v[196:199], v[112:115], a[236:239]
  buffer_load_dwordx4 v12, s[24:27], s37 offen offset:2048 lds
  v_mfma_f32_16x16x32_bf16 a[232:235], v[192:195], v[112:115], a[232:235]
  ds_read_b128 v[84:87], v41 offset:6144
  v_mfma_f32_16x16x32_bf16 a[232:235], v[160:163], v[116:119], a[232:235]
  v_mfma_f32_16x16x32_bf16 a[200:203], v[160:163], v[108:111], a[200:203]
  ds_read_b64_tr_b16 v[148:149], v38 offset:0
  v_mfma_f32_16x16x32_bf16 a[200:203], v[192:195], v[104:107], a[200:203]
  v_mfma_f32_16x16x32_bf16 a[196:199], v[188:191], v[104:107], a[196:199]
  buffer_load_dwordx4 v13, s[24:27], s37 offen offset:3072 lds
  v_mfma_f32_16x16x32_bf16 a[196:199], v[156:159], v[108:111], a[196:199]
  s_add_u32 s37, s37, 0x40000
  ds_read_b64_tr_b16 v[150:151], v38 offset:2048
  v_mfma_f32_16x16x32_bf16 a[228:231], v[156:159], v[116:119], a[228:231]
  v_mfma_f32_16x16x32_bf16 a[228:231], v[188:191], v[112:115], a[228:231]
  v_mfma_f32_16x16x32_bf16 a[224:227], v[184:187], v[112:115], a[224:227]
  v_mfma_f32_16x16x32_bf16 a[224:227], v[152:155], v[116:119], a[224:227]
  v_mfma_f32_16x16x32_bf16 a[192:195], v[152:155], v[108:111], a[192:195]
  v_mfma_f32_16x16x32_bf16 a[192:195], v[184:187], v[104:107], a[192:195]
  s_mov_b32 s38, 1
  s_add_u32 s32, s97, 4096
.p2align 6
Lk_loop0:
  s_waitcnt lgkmcnt(0)
  s_waitcnt vmcnt(16)
  s_barrier
  v_mfma_f32_16x16x32_bf16 a[0:3], v[216:219], v[56:59], a[0:3]
  s_add_u32 m0, s34, 0x0
  ds_read_b128 v[88:91], v14 offset:16384
  v_mfma_f32_16x16x32_bf16 a[0:3], v[120:123], v[60:63], a[0:3]
  buffer_load_dwordx4 v6, s[20:23], s36 offen offset:0 lds
  v_mfma_f32_16x16x32_bf16 a[32:35], v[120:123], v[68:71], a[32:35]
  ds_read_b64_tr_b16 v[184:185], v15 offset:16384
  v_mfma_f32_16x16x32_bf16 a[32:35], v[216:219], v[64:67], a[32:35]
  v_mfma_f32_16x16x32_bf16 a[36:39], v[220:223], v[64:67], a[36:39]
  buffer_load_dwordx4 v7, s[20:23], s36 offen offset:1024 lds
  v_mfma_f32_16x16x32_bf16 a[36:39], v[124:127], v[68:71], a[36:39]
  ds_read_b64_tr_b16 v[186:187], v15 offset:18432
  v_mfma_f32_16x16x32_bf16 a[4:7], v[124:127], v[60:63], a[4:7]
  v_mfma_f32_16x16x32_bf16 a[4:7], v[220:223], v[56:59], a[4:7]
  buffer_load_dwordx4 v8, s[20:23], s36 offen offset:2048 lds
  v_mfma_f32_16x16x32_bf16 a[8:11], v[224:227], v[56:59], a[8:11]
  ds_read_b128 v[92:95], v41 offset:16384
  v_mfma_f32_16x16x32_bf16 a[8:11], v[128:131], v[60:63], a[8:11]
  v_mfma_f32_16x16x32_bf16 a[40:43], v[128:131], v[68:71], a[40:43]
  buffer_load_dwordx4 v9, s[20:23], s36 offen offset:3072 lds
  v_mfma_f32_16x16x32_bf16 a[40:43], v[224:227], v[64:67], a[40:43]
  s_add_u32 s36, s36, 131072
  s_add_u32 m0, s34, 0x10000
  ds_read_b64_tr_b16 v[188:189], v32 offset:16384
  v_mfma_f32_16x16x32_bf16 a[44:47], v[228:231], v[64:67], a[44:47]
  v_mfma_f32_16x16x32_bf16 a[44:47], v[132:135], v[68:71], a[44:47]
  buffer_load_dwordx4 v10, s[24:27], s37 offen offset:0 lds
  v_mfma_f32_16x16x32_bf16 a[12:15], v[132:135], v[60:63], a[12:15]
  ds_read_b64_tr_b16 v[190:191], v32 offset:18432
  v_mfma_f32_16x16x32_bf16 a[12:15], v[228:231], v[56:59], a[12:15]
  v_mfma_f32_16x16x32_bf16 a[16:19], v[236:239], v[56:59], a[16:19]
  buffer_load_dwordx4 v11, s[24:27], s37 offen offset:1024 lds
  v_mfma_f32_16x16x32_bf16 a[16:19], v[136:139], v[60:63], a[16:19]
  ds_read_b128 v[96:99], v14 offset:18432
  v_mfma_f32_16x16x32_bf16 a[48:51], v[136:139], v[68:71], a[48:51]
  v_mfma_f32_16x16x32_bf16 a[48:51], v[236:239], v[64:67], a[48:51]
  buffer_load_dwordx4 v12, s[24:27], s37 offen offset:2048 lds
  v_mfma_f32_16x16x32_bf16 a[52:55], v[240:243], v[64:67], a[52:55]
  ds_read_b64_tr_b16 v[192:193], v33 offset:16384
  v_mfma_f32_16x16x32_bf16 a[52:55], v[140:143], v[68:71], a[52:55]
  v_mfma_f32_16x16x32_bf16 a[20:23], v[140:143], v[60:63], a[20:23]
  buffer_load_dwordx4 v13, s[24:27], s37 offen offset:3072 lds
  v_mfma_f32_16x16x32_bf16 a[20:23], v[240:243], v[56:59], a[20:23]
  s_add_u32 s37, s37, 0x40000
  ds_read_b64_tr_b16 v[194:195], v33 offset:18432
  v_mfma_f32_16x16x32_bf16 a[24:27], v[244:247], v[56:59], a[24:27]
  v_mfma_f32_16x16x32_bf16 a[24:27], v[144:147], v[60:63], a[24:27]
  ds_read_b128 v[100:103], v41 offset:18432
  v_mfma_f32_16x16x32_bf16 a[56:59], v[144:147], v[68:71], a[56:59]
  v_mfma_f32_16x16x32_bf16 a[56:59], v[244:247], v[64:67], a[56:59]
  ds_read_b64_tr_b16 v[196:197], v34 offset:16384
  v_mfma_f32_16x16x32_bf16 a[60:63], v[248:251], v[64:67], a[60:63]
  buffer_load_dword v25, v24, s[76:79], s39 offen
  v_mfma_f32_16x16x32_bf16 a[60:63], v[148:151], v[68:71], a[60:63]
  s_add_u32 s39, s39, s3
  s_mov_b32 m0, s43
  ds_read_b64_tr_b16 v[198:199], v34 offset:18432
  v_mfma_f32_16x16x32_bf16 a[28:31], v[148:151], v[60:63], a[28:31]
  buffer_load_dwordx4 v26, s[4:7], s9 offen lds
  v_mfma_f32_16x16x32_bf16 a[28:31], v[248:251], v[56:59], a[28:31]
  s_cmp_lt_u32 s38, 3
  s_cselect_b32 s33, s8, 0
  ds_read_b128 v[104:107], v14 offset:20480
  v_mfma_f32_16x16x32_bf16 a[92:95], v[248:251], v[72:75], a[92:95]
  s_add_u32 s9, s9, s33
  s_cmp_lt_u32 s38, 3
  s_cselect_b32 s33, 0x400, 0
  v_mfma_f32_16x16x32_bf16 a[92:95], v[148:151], v[76:79], a[92:95]
  s_add_u32 s43, s43, s33
  s_mov_b32 m0, s32
  ds_read_b64_tr_b16 v[200:201], v35 offset:16384
  v_mfma_f32_16x16x32_bf16 a[124:127], v[148:151], v[84:87], a[124:127]
  buffer_load_dwordx4 v27, s[64:67], s73 offen lds
  v_mfma_f32_16x16x32_bf16 a[124:127], v[248:251], v[80:83], a[124:127]
  s_cmp_ge_u32 s38, 2
  s_cselect_b32 s33, s72, 0
  ds_read_b64_tr_b16 v[202:203], v35 offset:18432
  v_mfma_f32_16x16x32_bf16 a[120:123], v[244:247], v[80:83], a[120:123]
  s_add_u32 s73, s73, s33
  s_cmp_ge_u32 s38, 2
  s_cselect_b32 s33, 0x400, 0
  v_mfma_f32_16x16x32_bf16 a[120:123], v[144:147], v[84:87], a[120:123]
  s_add_u32 s32, s32, s33
  ds_read_b128 v[108:111], v41 offset:20480
  v_mfma_f32_16x16x32_bf16 a[88:91], v[144:147], v[76:79], a[88:91]
  v_mfma_f32_16x16x32_bf16 a[88:91], v[244:247], v[72:75], a[88:91]
  ds_read_b64_tr_b16 v[204:205], v36 offset:16384
  v_mfma_f32_16x16x32_bf16 a[84:87], v[240:243], v[72:75], a[84:87]
  v_mfma_f32_16x16x32_bf16 a[84:87], v[140:143], v[76:79], a[84:87]
  ds_read_b64_tr_b16 v[206:207], v36 offset:18432
  v_mfma_f32_16x16x32_bf16 a[116:119], v[140:143], v[84:87], a[116:119]
  v_mfma_f32_16x16x32_bf16 a[116:119], v[240:243], v[80:83], a[116:119]
  ds_read_b128 v[112:115], v14 offset:22528
  v_mfma_f32_16x16x32_bf16 a[112:115], v[236:239], v[80:83], a[112:115]
  v_mfma_f32_16x16x32_bf16 a[112:115], v[136:139], v[84:87], a[112:115]
  ds_read_b64_tr_b16 v[208:209], v37 offset:16384
  v_mfma_f32_16x16x32_bf16 a[80:83], v[136:139], v[76:79], a[80:83]
  v_mfma_f32_16x16x32_bf16 a[80:83], v[236:239], v[72:75], a[80:83]
  ds_read_b64_tr_b16 v[210:211], v37 offset:18432
  v_mfma_f32_16x16x32_bf16 a[76:79], v[228:231], v[72:75], a[76:79]
  v_mfma_f32_16x16x32_bf16 a[76:79], v[132:135], v[76:79], a[76:79]
  ds_read_b128 v[116:119], v41 offset:22528
  v_mfma_f32_16x16x32_bf16 a[108:111], v[132:135], v[84:87], a[108:111]
  v_mfma_f32_16x16x32_bf16 a[108:111], v[228:231], v[80:83], a[108:111]
  ds_read_b64_tr_b16 v[212:213], v38 offset:16384
  v_mfma_f32_16x16x32_bf16 a[104:107], v[224:227], v[80:83], a[104:107]
  v_mfma_f32_16x16x32_bf16 a[104:107], v[128:131], v[84:87], a[104:107]
  ds_read_b64_tr_b16 v[214:215], v38 offset:18432
  v_mfma_f32_16x16x32_bf16 a[72:75], v[128:131], v[76:79], a[72:75]
  v_mfma_f32_16x16x32_bf16 a[72:75], v[224:227], v[72:75], a[72:75]
  v_mfma_f32_16x16x32_bf16 a[68:71], v[220:223], v[72:75], a[68:71]
  v_mfma_f32_16x16x32_bf16 a[68:71], v[124:127], v[76:79], a[68:71]
  v_mfma_f32_16x16x32_bf16 a[100:103], v[124:127], v[84:87], a[100:103]
  v_mfma_f32_16x16x32_bf16 a[100:103], v[220:223], v[80:83], a[100:103]
  v_mfma_f32_16x16x32_bf16 a[96:99], v[216:219], v[80:83], a[96:99]
  v_mfma_f32_16x16x32_bf16 a[96:99], v[120:123], v[84:87], a[96:99]
  v_mfma_f32_16x16x32_bf16 a[64:67], v[120:123], v[76:79], a[64:67]
  v_mfma_f32_16x16x32_bf16 a[64:67], v[216:219], v[72:75], a[64:67]
  s_waitcnt lgkmcnt(0)
  s_waitcnt vmcnt(19)
  s_barrier
  v_mfma_f32_16x16x32_bf16 a[128:131], v[216:219], v[88:91], a[128:131]
  s_add_u32 m0, s34, 0x4000
  ds_read_b128 v[56:59], v14 offset:32768
  v_mfma_f32_16x16x32_bf16 a[128:131], v[120:123], v[92:95], a[128:131]
  v_mfma_f32_16x16x32_bf16 a[160:163], v[120:123], v[100:103], a[160:163]
  ds_read_b64_tr_b16 v[152:153], v15 offset:32768
  v_mfma_f32_16x16x32_bf16 a[160:163], v[216:219], v[96:99], a[160:163]
  v_mfma_f32_16x16x32_bf16 a[164:167], v[220:223], v[96:99], a[164:167]
  ds_read_b64_tr_b16 v[154:155], v15 offset:34816
  v_mfma_f32_16x16x32_bf16 a[164:167], v[124:127], v[100:103], a[164:167]
  v_mfma_f32_16x16x32_bf16 a[132:135], v[124:127], v[92:95], a[132:135]
  ds_read_b128 v[60:63], v41 offset:32768
  v_mfma_f32_16x16x32_bf16 a[132:135], v[220:223], v[88:91], a[132:135]
  v_mfma_f32_16x16x32_bf16 a[136:139], v[224:227], v[88:91], a[136:139]
  ds_read_b64_tr_b16 v[156:157], v32 offset:32768
  v_mfma_f32_16x16x32_bf16 a[136:139], v[128:131], v[92:95], a[136:139]
  v_mfma_f32_16x16x32_bf16 a[168:171], v[128:131], v[100:103], a[168:171]
  ds_read_b64_tr_b16 v[158:159], v32 offset:34816
  v_mfma_f32_16x16x32_bf16 a[168:171], v[224:227], v[96:99], a[168:171]
  v_mfma_f32_16x16x32_bf16 a[172:175], v[228:231], v[96:99], a[172:175]
  ds_read_b128 v[64:67], v14 offset:34816
  v_mfma_f32_16x16x32_bf16 a[172:175], v[132:135], v[100:103], a[172:175]
  v_mfma_f32_16x16x32_bf16 a[140:143], v[132:135], v[92:95], a[140:143]
  ds_read_b64_tr_b16 v[160:161], v33 offset:32768
  v_mfma_f32_16x16x32_bf16 a[140:143], v[228:231], v[88:91], a[140:143]
  v_mfma_f32_16x16x32_bf16 a[144:147], v[236:239], v[88:91], a[144:147]
  ds_read_b64_tr_b16 v[162:163], v33 offset:34816
  v_mfma_f32_16x16x32_bf16 a[144:147], v[136:139], v[92:95], a[144:147]
  v_mfma_f32_16x16x32_bf16 a[176:179], v[136:139], v[100:103], a[176:179]
  ds_read_b128 v[68:71], v41 offset:34816
  v_mfma_f32_16x16x32_bf16 a[176:179], v[236:239], v[96:99], a[176:179]
  v_mfma_f32_16x16x32_bf16 a[180:183], v[240:243], v[96:99], a[180:183]
  ds_read_b64_tr_b16 v[164:165], v34 offset:32768
  v_mfma_f32_16x16x32_bf16 a[180:183], v[140:143], v[100:103], a[180:183]
  v_mfma_f32_16x16x32_bf16 a[148:151], v[140:143], v[92:95], a[148:151]
  ds_read_b64_tr_b16 v[166:167], v34 offset:34816
  v_mfma_f32_16x16x32_bf16 a[148:151], v[240:243], v[88:91], a[148:151]
  v_mfma_f32_16x16x32_bf16 a[152:155], v[244:247], v[88:91], a[152:155]
  ds_read_b128 v[72:75], v14 offset:36864
  v_mfma_f32_16x16x32_bf16 a[152:155], v[144:147], v[92:95], a[152:155]
  v_mfma_f32_16x16x32_bf16 a[184:187], v[144:147], v[100:103], a[184:187]
  ds_read_b64_tr_b16 v[168:169], v35 offset:32768
  v_mfma_f32_16x16x32_bf16 a[184:187], v[244:247], v[96:99], a[184:187]
  v_mfma_f32_16x16x32_bf16 a[188:191], v[248:251], v[96:99], a[188:191]
  ds_read_b64_tr_b16 v[170:171], v35 offset:34816
  v_mfma_f32_16x16x32_bf16 a[188:191], v[148:151], v[100:103], a[188:191]
  v_mfma_f32_16x16x32_bf16 a[156:159], v[148:151], v[92:95], a[156:159]
  ds_read_b128 v[76:79], v41 offset:36864
  v_mfma_f32_16x16x32_bf16 a[156:159], v[248:251], v[88:91], a[156:159]
  v_mfma_f32_16x16x32_bf16 a[220:223], v[248:251], v[104:107], a[220:223]
  ds_read_b64_tr_b16 v[172:173], v36 offset:32768
  v_mfma_f32_16x16x32_bf16 a[220:223], v[148:151], v[108:111], a[220:223]
  v_mfma_f32_16x16x32_bf16 a[252:255], v[148:151], v[116:119], a[252:255]
  ds_read_b64_tr_b16 v[174:175], v36 offset:34816
  v_mfma_f32_16x16x32_bf16 a[252:255], v[248:251], v[112:115], a[252:255]
  v_mfma_f32_16x16x32_bf16 a[248:251], v[244:247], v[112:115], a[248:251]
  ds_read_b128 v[80:83], v14 offset:38912
  v_mfma_f32_16x16x32_bf16 a[248:251], v[144:147], v[116:119], a[248:251]
  v_mfma_f32_16x16x32_bf16 a[216:219], v[144:147], v[108:111], a[216:219]
  ds_read_b64_tr_b16 v[176:177], v37 offset:32768
  v_mfma_f32_16x16x32_bf16 a[216:219], v[244:247], v[104:107], a[216:219]
  v_mfma_f32_16x16x32_bf16 a[212:215], v[240:243], v[104:107], a[212:215]
  ds_read_b64_tr_b16 v[178:179], v37 offset:34816
  v_mfma_f32_16x16x32_bf16 a[212:215], v[140:143], v[108:111], a[212:215]
  v_mfma_f32_16x16x32_bf16 a[244:247], v[140:143], v[116:119], a[244:247]
  ds_read_b128 v[84:87], v41 offset:38912
  v_mfma_f32_16x16x32_bf16 a[244:247], v[240:243], v[112:115], a[244:247]
  v_mfma_f32_16x16x32_bf16 a[240:243], v[236:239], v[112:115], a[240:243]
  ds_read_b64_tr_b16 v[180:181], v38 offset:32768
  v_mfma_f32_16x16x32_bf16 a[240:243], v[136:139], v[116:119], a[240:243]
  v_mfma_f32_16x16x32_bf16 a[208:211], v[136:139], v[108:111], a[208:211]
  ds_read_b64_tr_b16 v[182:183], v38 offset:34816
  v_mfma_f32_16x16x32_bf16 a[208:211], v[236:239], v[104:107], a[208:211]
  v_mfma_f32_16x16x32_bf16 a[204:207], v[228:231], v[104:107], a[204:207]
  v_mfma_f32_16x16x32_bf16 a[204:207], v[132:135], v[108:111], a[204:207]
  v_mfma_f32_16x16x32_bf16 a[236:239], v[132:135], v[116:119], a[236:239]
  v_mfma_f32_16x16x32_bf16 a[236:239], v[228:231], v[112:115], a[236:239]
  v_mfma_f32_16x16x32_bf16 a[232:235], v[224:227], v[112:115], a[232:235]
  v_mfma_f32_16x16x32_bf16 a[232:235], v[128:131], v[116:119], a[232:235]
  v_mfma_f32_16x16x32_bf16 a[200:203], v[128:131], v[108:111], a[200:203]
  v_mfma_f32_16x16x32_bf16 a[200:203], v[224:227], v[104:107], a[200:203]
  v_mfma_f32_16x16x32_bf16 a[196:199], v[220:223], v[104:107], a[196:199]
  v_mfma_f32_16x16x32_bf16 a[196:199], v[124:127], v[108:111], a[196:199]
  v_mfma_f32_16x16x32_bf16 a[228:231], v[124:127], v[116:119], a[228:231]
  v_mfma_f32_16x16x32_bf16 a[228:231], v[220:223], v[112:115], a[228:231]
  v_mfma_f32_16x16x32_bf16 a[224:227], v[216:219], v[112:115], a[224:227]
  v_mfma_f32_16x16x32_bf16 a[224:227], v[120:123], v[116:119], a[224:227]
  v_mfma_f32_16x16x32_bf16 a[192:195], v[120:123], v[108:111], a[192:195]
  v_mfma_f32_16x16x32_bf16 a[192:195], v[216:219], v[104:107], a[192:195]
  s_waitcnt lgkmcnt(0)
  s_waitcnt vmcnt(11)
  s_barrier
  v_mfma_f32_16x16x32_bf16 a[0:3], v[184:187], v[56:59], a[0:3]
  ds_read_b128 v[88:91], v14 offset:49152
  v_mfma_f32_16x16x32_bf16 a[0:3], v[152:155], v[60:63], a[0:3]
  v_mfma_f32_16x16x32_bf16 a[32:35], v[152:155], v[68:71], a[32:35]
  ds_read_b64_tr_b16 v[216:217], v15 offset:49152
  v_mfma_f32_16x16x32_bf16 a[32:35], v[184:187], v[64:67], a[32:35]
  v_mfma_f32_16x16x32_bf16 a[36:39], v[188:191], v[64:67], a[36:39]
  ds_read_b64_tr_b16 v[218:219], v15 offset:51200
  v_mfma_f32_16x16x32_bf16 a[36:39], v[156:159], v[68:71], a[36:39]
  v_mfma_f32_16x16x32_bf16 a[4:7], v[156:159], v[60:63], a[4:7]
  ds_read_b128 v[92:95], v41 offset:49152
  v_mfma_f32_16x16x32_bf16 a[4:7], v[188:191], v[56:59], a[4:7]
  v_mfma_f32_16x16x32_bf16 a[8:11], v[192:195], v[56:59], a[8:11]
  ds_read_b64_tr_b16 v[220:221], v32 offset:49152
  v_mfma_f32_16x16x32_bf16 a[8:11], v[160:163], v[60:63], a[8:11]
  v_mfma_f32_16x16x32_bf16 a[40:43], v[160:163], v[68:71], a[40:43]
  ds_read_b64_tr_b16 v[222:223], v32 offset:51200
  v_mfma_f32_16x16x32_bf16 a[40:43], v[192:195], v[64:67], a[40:43]
  v_mfma_f32_16x16x32_bf16 a[44:47], v[196:199], v[64:67], a[44:47]
  buffer_load_dwordx4 v6, s[20:23], s36 offen offset:0 lds
  v_mfma_f32_16x16x32_bf16 a[44:47], v[164:167], v[68:71], a[44:47]
  ds_read_b128 v[96:99], v14 offset:51200
  v_mfma_f32_16x16x32_bf16 a[12:15], v[164:167], v[60:63], a[12:15]
  v_mfma_f32_16x16x32_bf16 a[12:15], v[196:199], v[56:59], a[12:15]
  ds_read_b64_tr_b16 v[224:225], v33 offset:49152
  v_mfma_f32_16x16x32_bf16 a[16:19], v[200:203], v[56:59], a[16:19]
  buffer_load_dwordx4 v7, s[20:23], s36 offen offset:1024 lds
  v_mfma_f32_16x16x32_bf16 a[16:19], v[168:171], v[60:63], a[16:19]
  ds_read_b64_tr_b16 v[226:227], v33 offset:51200
  v_mfma_f32_16x16x32_bf16 a[48:51], v[168:171], v[68:71], a[48:51]
  v_mfma_f32_16x16x32_bf16 a[48:51], v[200:203], v[64:67], a[48:51]
  ds_read_b128 v[100:103], v41 offset:51200
  v_mfma_f32_16x16x32_bf16 a[52:55], v[204:207], v[64:67], a[52:55]
  buffer_load_dwordx4 v8, s[20:23], s36 offen offset:2048 lds
  v_mfma_f32_16x16x32_bf16 a[52:55], v[172:175], v[68:71], a[52:55]
  ds_read_b64_tr_b16 v[228:229], v34 offset:49152
  v_mfma_f32_16x16x32_bf16 a[20:23], v[172:175], v[60:63], a[20:23]
  v_mfma_f32_16x16x32_bf16 a[20:23], v[204:207], v[56:59], a[20:23]
  ds_read_b64_tr_b16 v[230:231], v34 offset:51200
  v_mfma_f32_16x16x32_bf16 a[24:27], v[208:211], v[56:59], a[24:27]
  buffer_load_dwordx4 v9, s[20:23], s36 offen offset:3072 lds
  v_mfma_f32_16x16x32_bf16 a[24:27], v[176:179], v[60:63], a[24:27]
  s_sub_u32 s36, s36, 130944
  s_add_u32 m0, s34, 0x14000
  ds_read_b128 v[104:107], v14 offset:53248
  v_mfma_f32_16x16x32_bf16 a[56:59], v[176:179], v[68:71], a[56:59]
  v_mfma_f32_16x16x32_bf16 a[56:59], v[208:211], v[64:67], a[56:59]
  ds_read_b64_tr_b16 v[236:237], v35 offset:49152
  v_mfma_f32_16x16x32_bf16 a[60:63], v[212:215], v[64:67], a[60:63]
  buffer_load_dwordx4 v10, s[24:27], s37 offen offset:0 lds
  v_mfma_f32_16x16x32_bf16 a[60:63], v[180:183], v[68:71], a[60:63]
  ds_read_b64_tr_b16 v[238:239], v35 offset:51200
  v_mfma_f32_16x16x32_bf16 a[28:31], v[180:183], v[60:63], a[28:31]
  v_mfma_f32_16x16x32_bf16 a[28:31], v[212:215], v[56:59], a[28:31]
  ds_read_b128 v[108:111], v41 offset:53248
  v_mfma_f32_16x16x32_bf16 a[92:95], v[212:215], v[72:75], a[92:95]
  buffer_load_dwordx4 v11, s[24:27], s37 offen offset:1024 lds
  v_mfma_f32_16x16x32_bf16 a[92:95], v[180:183], v[76:79], a[92:95]
  ds_read_b64_tr_b16 v[240:241], v36 offset:49152
  v_mfma_f32_16x16x32_bf16 a[124:127], v[180:183], v[84:87], a[124:127]
  v_mfma_f32_16x16x32_bf16 a[124:127], v[212:215], v[80:83], a[124:127]
  ds_read_b64_tr_b16 v[242:243], v36 offset:51200
  v_mfma_f32_16x16x32_bf16 a[120:123], v[208:211], v[80:83], a[120:123]
  buffer_load_dwordx4 v12, s[24:27], s37 offen offset:2048 lds
  v_mfma_f32_16x16x32_bf16 a[120:123], v[176:179], v[84:87], a[120:123]
  ds_read_b128 v[112:115], v14 offset:55296
  v_mfma_f32_16x16x32_bf16 a[88:91], v[176:179], v[76:79], a[88:91]
  v_mfma_f32_16x16x32_bf16 a[88:91], v[208:211], v[72:75], a[88:91]
  ds_read_b64_tr_b16 v[244:245], v37 offset:49152
  v_mfma_f32_16x16x32_bf16 a[84:87], v[204:207], v[72:75], a[84:87]
  buffer_load_dwordx4 v13, s[24:27], s37 offen offset:3072 lds
  v_mfma_f32_16x16x32_bf16 a[84:87], v[172:175], v[76:79], a[84:87]
  s_add_u32 s37, s37, 0x40000
  s_add_u32 m0, s34, 0x8000
  ds_read_b64_tr_b16 v[246:247], v37 offset:51200
  v_mfma_f32_16x16x32_bf16 a[116:119], v[172:175], v[84:87], a[116:119]
  v_mfma_f32_16x16x32_bf16 a[116:119], v[204:207], v[80:83], a[116:119]
  ds_read_b128 v[116:119], v41 offset:55296
  v_mfma_f32_16x16x32_bf16 a[112:115], v[200:203], v[80:83], a[112:115]
  buffer_load_dwordx4 v6, s[20:23], s36 offen offset:0 lds
  v_mfma_f32_16x16x32_bf16 a[112:115], v[168:171], v[84:87], a[112:115]
  ds_read_b64_tr_b16 v[248:249], v38 offset:49152
  v_mfma_f32_16x16x32_bf16 a[80:83], v[168:171], v[76:79], a[80:83]
  v_mfma_f32_16x16x32_bf16 a[80:83], v[200:203], v[72:75], a[80:83]
  ds_read_b64_tr_b16 v[250:251], v38 offset:51200
  v_mfma_f32_16x16x32_bf16 a[76:79], v[196:199], v[72:75], a[76:79]
  buffer_load_dwordx4 v7, s[20:23], s36 offen offset:1024 lds
  v_mfma_f32_16x16x32_bf16 a[76:79], v[164:167], v[76:79], a[76:79]
  v_mfma_f32_16x16x32_bf16 a[108:111], v[164:167], v[84:87], a[108:111]
  v_mfma_f32_16x16x32_bf16 a[108:111], v[196:199], v[80:83], a[108:111]
  v_mfma_f32_16x16x32_bf16 a[104:107], v[192:195], v[80:83], a[104:107]
  buffer_load_dwordx4 v8, s[20:23], s36 offen offset:2048 lds
  v_mfma_f32_16x16x32_bf16 a[104:107], v[160:163], v[84:87], a[104:107]
  v_mfma_f32_16x16x32_bf16 a[72:75], v[160:163], v[76:79], a[72:75]
  v_mfma_f32_16x16x32_bf16 a[72:75], v[192:195], v[72:75], a[72:75]
  v_mfma_f32_16x16x32_bf16 a[68:71], v[188:191], v[72:75], a[68:71]
  buffer_load_dwordx4 v9, s[20:23], s36 offen offset:3072 lds
  v_mfma_f32_16x16x32_bf16 a[68:71], v[156:159], v[76:79], a[68:71]
  s_add_u32 s36, s36, 131072
  s_add_u32 m0, s34, 0x18000
  v_mfma_f32_16x16x32_bf16 a[100:103], v[156:159], v[84:87], a[100:103]
  v_mfma_f32_16x16x32_bf16 a[100:103], v[188:191], v[80:83], a[100:103]
  v_mfma_f32_16x16x32_bf16 a[96:99], v[184:187], v[80:83], a[96:99]
  v_mfma_f32_16x16x32_bf16 a[96:99], v[152:155], v[84:87], a[96:99]
  v_mfma_f32_16x16x32_bf16 a[64:67], v[152:155], v[76:79], a[64:67]
  v_mfma_f32_16x16x32_bf16 a[64:67], v[184:187], v[72:75], a[64:67]
  s_waitcnt lgkmcnt(0)
  s_waitcnt vmcnt(15)
  s_barrier
  v_mfma_f32_16x16x32_bf16 a[128:131], v[184:187], v[88:91], a[128:131]
  ds_read_b128 v[56:59], v14 offset:0
  v_mfma_f32_16x16x32_bf16 a[128:131], v[152:155], v[92:95], a[128:131]
  buffer_load_dwordx4 v10, s[24:27], s37 offen offset:0 lds
  v_mfma_f32_16x16x32_bf16 a[160:163], v[152:155], v[100:103], a[160:163]
  ds_read_b64_tr_b16 v[120:121], v15 offset:0
  v_mfma_f32_16x16x32_bf16 a[160:163], v[184:187], v[96:99], a[160:163]
  v_mfma_f32_16x16x32_bf16 a[164:167], v[188:191], v[96:99], a[164:167]
  ds_read_b64_tr_b16 v[122:123], v15 offset:2048
  v_mfma_f32_16x16x32_bf16 a[164:167], v[156:159], v[100:103], a[164:167]
  v_mfma_f32_16x16x32_bf16 a[132:135], v[156:159], v[92:95], a[132:135]
  buffer_load_dwordx4 v11, s[24:27], s37 offen offset:1024 lds
  v_mfma_f32_16x16x32_bf16 a[132:135], v[188:191], v[88:91], a[132:135]
  ds_read_b128 v[60:63], v41 offset:0
  v_mfma_f32_16x16x32_bf16 a[136:139], v[192:195], v[88:91], a[136:139]
  v_mfma_f32_16x16x32_bf16 a[136:139], v[160:163], v[92:95], a[136:139]
  ds_read_b64_tr_b16 v[124:125], v32 offset:0
  v_mfma_f32_16x16x32_bf16 a[168:171], v[160:163], v[100:103], a[168:171]
  v_mfma_f32_16x16x32_bf16 a[168:171], v[192:195], v[96:99], a[168:171]
  buffer_load_dwordx4 v12, s[24:27], s37 offen offset:2048 lds
  v_mfma_f32_16x16x32_bf16 a[172:175], v[196:199], v[96:99], a[172:175]
  ds_read_b64_tr_b16 v[126:127], v32 offset:2048
  v_mfma_f32_16x16x32_bf16 a[172:175], v[164:167], v[100:103], a[172:175]
  v_mfma_f32_16x16x32_bf16 a[140:143], v[164:167], v[92:95], a[140:143]
  ds_read_b128 v[64:67], v14 offset:2048
  v_mfma_f32_16x16x32_bf16 a[140:143], v[196:199], v[88:91], a[140:143]
  v_mfma_f32_16x16x32_bf16 a[144:147], v[200:203], v[88:91], a[144:147]
  buffer_load_dwordx4 v13, s[24:27], s37 offen offset:3072 lds
  v_mfma_f32_16x16x32_bf16 a[144:147], v[168:171], v[92:95], a[144:147]
  s_add_u32 s37, s37, 0x40000
  s_add_u32 m0, s34, 0xc000
  ds_read_b64_tr_b16 v[128:129], v33 offset:0
  v_mfma_f32_16x16x32_bf16 a[176:179], v[168:171], v[100:103], a[176:179]
  v_mfma_f32_16x16x32_bf16 a[176:179], v[200:203], v[96:99], a[176:179]
  ds_read_b64_tr_b16 v[130:131], v33 offset:2048
  v_mfma_f32_16x16x32_bf16 a[180:183], v[204:207], v[96:99], a[180:183]
  v_mfma_f32_16x16x32_bf16 a[180:183], v[172:175], v[100:103], a[180:183]
  buffer_load_dwordx4 v6, s[20:23], s36 offen offset:0 lds
  v_mfma_f32_16x16x32_bf16 a[148:151], v[172:175], v[92:95], a[148:151]
  ds_read_b128 v[68:71], v41 offset:2048
  v_mfma_f32_16x16x32_bf16 a[148:151], v[204:207], v[88:91], a[148:151]
  v_mfma_f32_16x16x32_bf16 a[152:155], v[208:211], v[88:91], a[152:155]
  ds_read_b64_tr_b16 v[132:133], v34 offset:0
  v_mfma_f32_16x16x32_bf16 a[152:155], v[176:179], v[92:95], a[152:155]
  v_mfma_f32_16x16x32_bf16 a[184:187], v[176:179], v[100:103], a[184:187]
  buffer_load_dwordx4 v7, s[20:23], s36 offen offset:1024 lds
  v_mfma_f32_16x16x32_bf16 a[184:187], v[208:211], v[96:99], a[184:187]
  ds_read_b64_tr_b16 v[134:135], v34 offset:2048
  v_mfma_f32_16x16x32_bf16 a[188:191], v[212:215], v[96:99], a[188:191]
  v_mfma_f32_16x16x32_bf16 a[188:191], v[180:183], v[100:103], a[188:191]
  ds_read_b128 v[72:75], v14 offset:4096
  v_mfma_f32_16x16x32_bf16 a[156:159], v[180:183], v[92:95], a[156:159]
  v_mfma_f32_16x16x32_bf16 a[156:159], v[212:215], v[88:91], a[156:159]
  buffer_load_dwordx4 v8, s[20:23], s36 offen offset:2048 lds
  v_mfma_f32_16x16x32_bf16 a[220:223], v[212:215], v[104:107], a[220:223]
  ds_read_b64_tr_b16 v[136:137], v35 offset:0
  v_mfma_f32_16x16x32_bf16 a[220:223], v[180:183], v[108:111], a[220:223]
  v_mfma_f32_16x16x32_bf16 a[252:255], v[180:183], v[116:119], a[252:255]
  ds_read_b64_tr_b16 v[138:139], v35 offset:2048
  v_mfma_f32_16x16x32_bf16 a[252:255], v[212:215], v[112:115], a[252:255]
  v_mfma_f32_16x16x32_bf16 a[248:251], v[208:211], v[112:115], a[248:251]
  buffer_load_dwordx4 v9, s[20:23], s36 offen offset:3072 lds
  v_mfma_f32_16x16x32_bf16 a[248:251], v[176:179], v[116:119], a[248:251]
  s_sub_u32 s36, s36, 130944
  s_add_u32 m0, s34, 0x1c000
  ds_read_b128 v[76:79], v41 offset:4096
  v_mfma_f32_16x16x32_bf16 a[216:219], v[176:179], v[108:111], a[216:219]
  v_mfma_f32_16x16x32_bf16 a[216:219], v[208:211], v[104:107], a[216:219]
  ds_read_b64_tr_b16 v[140:141], v36 offset:0
  v_mfma_f32_16x16x32_bf16 a[212:215], v[204:207], v[104:107], a[212:215]
  v_mfma_f32_16x16x32_bf16 a[212:215], v[172:175], v[108:111], a[212:215]
  buffer_load_dwordx4 v10, s[24:27], s37 offen offset:0 lds
  v_mfma_f32_16x16x32_bf16 a[244:247], v[172:175], v[116:119], a[244:247]
  ds_read_b64_tr_b16 v[142:143], v36 offset:2048
  v_mfma_f32_16x16x32_bf16 a[244:247], v[204:207], v[112:115], a[244:247]
  v_mfma_f32_16x16x32_bf16 a[240:243], v[200:203], v[112:115], a[240:243]
  ds_read_b128 v[80:83], v14 offset:6144
  v_mfma_f32_16x16x32_bf16 a[240:243], v[168:171], v[116:119], a[240:243]
  v_mfma_f32_16x16x32_bf16 a[208:211], v[168:171], v[108:111], a[208:211]
  buffer_load_dwordx4 v11, s[24:27], s37 offen offset:1024 lds
  v_mfma_f32_16x16x32_bf16 a[208:211], v[200:203], v[104:107], a[208:211]
  ds_read_b64_tr_b16 v[144:145], v37 offset:0
  v_mfma_f32_16x16x32_bf16 a[204:207], v[196:199], v[104:107], a[204:207]
  v_mfma_f32_16x16x32_bf16 a[204:207], v[164:167], v[108:111], a[204:207]
  ds_read_b64_tr_b16 v[146:147], v37 offset:2048
  v_mfma_f32_16x16x32_bf16 a[236:239], v[164:167], v[116:119], a[236:239]
  v_mfma_f32_16x16x32_bf16 a[236:239], v[196:199], v[112:115], a[236:239]
  buffer_load_dwordx4 v12, s[24:27], s37 offen offset:2048 lds
  v_mfma_f32_16x16x32_bf16 a[232:235], v[192:195], v[112:115], a[232:235]
  ds_read_b128 v[84:87], v41 offset:6144
  v_mfma_f32_16x16x32_bf16 a[232:235], v[160:163], v[116:119], a[232:235]
  v_mfma_f32_16x16x32_bf16 a[200:203], v[160:163], v[108:111], a[200:203]
  ds_read_b64_tr_b16 v[148:149], v38 offset:0
  v_mfma_f32_16x16x32_bf16 a[200:203], v[192:195], v[104:107], a[200:203]
  v_mfma_f32_16x16x32_bf16 a[196:199], v[188:191], v[104:107], a[196:199]
  buffer_load_dwordx4 v13, s[24:27], s37 offen offset:3072 lds
  v_mfma_f32_16x16x32_bf16 a[196:199], v[156:159], v[108:111], a[196:199]
  s_add_u32 s37, s37, 0x40000
  ds_read_b64_tr_b16 v[150:151], v38 offset:2048
  v_mfma_f32_16x16x32_bf16 a[228:231], v[156:159], v[116:119], a[228:231]
  v_mfma_f32_16x16x32_bf16 a[228:231], v[188:191], v[112:115], a[228:231]
  v_mfma_f32_16x16x32_bf16 a[224:227], v[184:187], v[112:115], a[224:227]
  v_mfma_f32_16x16x32_bf16 a[224:227], v[152:155], v[116:119], a[224:227]
  v_mfma_f32_16x16x32_bf16 a[192:195], v[152:155], v[108:111], a[192:195]
  v_mfma_f32_16x16x32_bf16 a[192:195], v[184:187], v[104:107], a[192:195]
  s_add_u32 s38, s38, 1
  s_cmp_lt_u32 s38, 6
  s_cbranch_scc1 Lk_loop0
  s_waitcnt lgkmcnt(0)
  s_waitcnt vmcnt(16)
  s_barrier
  v_mfma_f32_16x16x32_bf16 a[0:3], v[216:219], v[56:59], a[0:3]
  s_add_u32 m0, s34, 0x0
  ds_read_b128 v[88:91], v14 offset:16384
  v_mfma_f32_16x16x32_bf16 a[0:3], v[120:123], v[60:63], a[0:3]
  buffer_load_dwordx4 v6, s[20:23], s36 offen offset:0 lds
  v_mfma_f32_16x16x32_bf16 a[32:35], v[120:123], v[68:71], a[32:35]
  ds_read_b64_tr_b16 v[184:185], v15 offset:16384
  v_mfma_f32_16x16x32_bf16 a[32:35], v[216:219], v[64:67], a[32:35]
  v_mfma_f32_16x16x32_bf16 a[36:39], v[220:223], v[64:67], a[36:39]
  buffer_load_dwordx4 v7, s[20:23], s36 offen offset:1024 lds
  v_mfma_f32_16x16x32_bf16 a[36:39], v[124:127], v[68:71], a[36:39]
  ds_read_b64_tr_b16 v[186:187], v15 offset:18432
  v_mfma_f32_16x16x32_bf16 a[4:7], v[124:127], v[60:63], a[4:7]
  v_mfma_f32_16x16x32_bf16 a[4:7], v[220:223], v[56:59], a[4:7]
  buffer_load_dwordx4 v8, s[20:23], s36 offen offset:2048 lds
  v_mfma_f32_16x16x32_bf16 a[8:11], v[224:227], v[56:59], a[8:11]
  ds_read_b128 v[92:95], v41 offset:16384
  v_mfma_f32_16x16x32_bf16 a[8:11], v[128:131], v[60:63], a[8:11]
  v_mfma_f32_16x16x32_bf16 a[40:43], v[128:131], v[68:71], a[40:43]
  buffer_load_dwordx4 v9, s[20:23], s36 offen offset:3072 lds
  v_mfma_f32_16x16x32_bf16 a[40:43], v[224:227], v[64:67], a[40:43]
  s_add_u32 s36, s36, 131072
  s_add_u32 m0, s34, 0x10000
  ds_read_b64_tr_b16 v[188:189], v32 offset:16384
  v_mfma_f32_16x16x32_bf16 a[44:47], v[228:231], v[64:67], a[44:47]
  v_mfma_f32_16x16x32_bf16 a[44:47], v[132:135], v[68:71], a[44:47]
  buffer_load_dwordx4 v10, s[24:27], s37 offen offset:0 lds
  v_mfma_f32_16x16x32_bf16 a[12:15], v[132:135], v[60:63], a[12:15]
  ds_read_b64_tr_b16 v[190:191], v32 offset:18432
  v_mfma_f32_16x16x32_bf16 a[12:15], v[228:231], v[56:59], a[12:15]
  v_mfma_f32_16x16x32_bf16 a[16:19], v[236:239], v[56:59], a[16:19]
  buffer_load_dwordx4 v11, s[24:27], s37 offen offset:1024 lds
  v_mfma_f32_16x16x32_bf16 a[16:19], v[136:139], v[60:63], a[16:19]
  ds_read_b128 v[96:99], v14 offset:18432
  v_mfma_f32_16x16x32_bf16 a[48:51], v[136:139], v[68:71], a[48:51]
  v_mfma_f32_16x16x32_bf16 a[48:51], v[236:239], v[64:67], a[48:51]
  buffer_load_dwordx4 v12, s[24:27], s37 offen offset:2048 lds
  v_mfma_f32_16x16x32_bf16 a[52:55], v[240:243], v[64:67], a[52:55]
  ds_read_b64_tr_b16 v[192:193], v33 offset:16384
  v_mfma_f32_16x16x32_bf16 a[52:55], v[140:143], v[68:71], a[52:55]
  v_mfma_f32_16x16x32_bf16 a[20:23], v[140:143], v[60:63], a[20:23]
  buffer_load_dwordx4 v13, s[24:27], s37 offen offset:3072 lds
  v_mfma_f32_16x16x32_bf16 a[20:23], v[240:243], v[56:59], a[20:23]
  s_add_u32 s37, s37, 0x40000
  ds_read_b64_tr_b16 v[194:195], v33 offset:18432
  v_mfma_f32_16x16x32_bf16 a[24:27], v[244:247], v[56:59], a[24:27]
  v_mfma_f32_16x16x32_bf16 a[24:27], v[144:147], v[60:63], a[24:27]
  ds_read_b128 v[100:103], v41 offset:18432
  v_mfma_f32_16x16x32_bf16 a[56:59], v[144:147], v[68:71], a[56:59]
  v_mfma_f32_16x16x32_bf16 a[56:59], v[244:247], v[64:67], a[56:59]
  ds_read_b64_tr_b16 v[196:197], v34 offset:16384
  v_mfma_f32_16x16x32_bf16 a[60:63], v[248:251], v[64:67], a[60:63]
  buffer_load_dword v25, v24, s[76:79], s39 offen
  v_mfma_f32_16x16x32_bf16 a[60:63], v[148:151], v[68:71], a[60:63]
  s_add_u32 s39, s39, s3
  ds_read_b64_tr_b16 v[198:199], v34 offset:18432
  v_mfma_f32_16x16x32_bf16 a[28:31], v[148:151], v[60:63], a[28:31]
  v_mfma_f32_16x16x32_bf16 a[28:31], v[248:251], v[56:59], a[28:31]
  ds_read_b128 v[104:107], v14 offset:20480
  v_mfma_f32_16x16x32_bf16 a[92:95], v[248:251], v[72:75], a[92:95]
  v_mfma_f32_16x16x32_bf16 a[92:95], v[148:151], v[76:79], a[92:95]
  ds_read_b64_tr_b16 v[200:201], v35 offset:16384
  v_mfma_f32_16x16x32_bf16 a[124:127], v[148:151], v[84:87], a[124:127]
  v_mfma_f32_16x16x32_bf16 a[124:127], v[248:251], v[80:83], a[124:127]
  ds_read_b64_tr_b16 v[202:203], v35 offset:18432
  v_mfma_f32_16x16x32_bf16 a[120:123], v[244:247], v[80:83], a[120:123]
  v_mfma_f32_16x16x32_bf16 a[120:123], v[144:147], v[84:87], a[120:123]
  ds_read_b128 v[108:111], v41 offset:20480
  v_mfma_f32_16x16x32_bf16 a[88:91], v[144:147], v[76:79], a[88:91]
  v_mfma_f32_16x16x32_bf16 a[88:91], v[244:247], v[72:75], a[88:91]
  ds_read_b64_tr_b16 v[204:205], v36 offset:16384
  v_mfma_f32_16x16x32_bf16 a[84:87], v[240:243], v[72:75], a[84:87]
  v_mfma_f32_16x16x32_bf16 a[84:87], v[140:143], v[76:79], a[84:87]
  ds_read_b64_tr_b16 v[206:207], v36 offset:18432
  v_mfma_f32_16x16x32_bf16 a[116:119], v[140:143], v[84:87], a[116:119]
  v_mfma_f32_16x16x32_bf16 a[116:119], v[240:243], v[80:83], a[116:119]
  ds_read_b128 v[112:115], v14 offset:22528
  v_mfma_f32_16x16x32_bf16 a[112:115], v[236:239], v[80:83], a[112:115]
  v_mfma_f32_16x16x32_bf16 a[112:115], v[136:139], v[84:87], a[112:115]
  ds_read_b64_tr_b16 v[208:209], v37 offset:16384
  v_mfma_f32_16x16x32_bf16 a[80:83], v[136:139], v[76:79], a[80:83]
  v_mfma_f32_16x16x32_bf16 a[80:83], v[236:239], v[72:75], a[80:83]
  ds_read_b64_tr_b16 v[210:211], v37 offset:18432
  v_mfma_f32_16x16x32_bf16 a[76:79], v[228:231], v[72:75], a[76:79]
  v_mfma_f32_16x16x32_bf16 a[76:79], v[132:135], v[76:79], a[76:79]
  ds_read_b128 v[116:119], v41 offset:22528
  v_mfma_f32_16x16x32_bf16 a[108:111], v[132:135], v[84:87], a[108:111]
  v_mfma_f32_16x16x32_bf16 a[108:111], v[228:231], v[80:83], a[108:111]
  ds_read_b64_tr_b16 v[212:213], v38 offset:16384
  v_mfma_f32_16x16x32_bf16 a[104:107], v[224:227], v[80:83], a[104:107]
  v_mfma_f32_16x16x32_bf16 a[104:107], v[128:131], v[84:87], a[104:107]
  ds_read_b64_tr_b16 v[214:215], v38 offset:18432
  v_mfma_f32_16x16x32_bf16 a[72:75], v[128:131], v[76:79], a[72:75]
  v_mfma_f32_16x16x32_bf16 a[72:75], v[224:227], v[72:75], a[72:75]
  v_mfma_f32_16x16x32_bf16 a[68:71], v[220:223], v[72:75], a[68:71]
  v_mfma_f32_16x16x32_bf16 a[68:71], v[124:127], v[76:79], a[68:71]
  v_mfma_f32_16x16x32_bf16 a[100:103], v[124:127], v[84:87], a[100:103]
  v_mfma_f32_16x16x32_bf16 a[100:103], v[220:223], v[80:83], a[100:103]
  v_mfma_f32_16x16x32_bf16 a[96:99], v[216:219], v[80:83], a[96:99]
  v_mfma_f32_16x16x32_bf16 a[96:99], v[120:123], v[84:87], a[96:99]
  v_mfma_f32_16x16x32_bf16 a[64:67], v[120:123], v[76:79], a[64:67]
  v_mfma_f32_16x16x32_bf16 a[64:67], v[216:219], v[72:75], a[64:67]
  s_waitcnt lgkmcnt(0)
  s_waitcnt vmcnt(17)
  s_barrier
  v_mfma_f32_16x16x32_bf16 a[128:131], v[216:219], v[88:91], a[128:131]
  s_add_u32 m0, s34, 0x4000
  ds_read_b128 v[56:59], v14 offset:32768
  v_mfma_f32_16x16x32_bf16 a[128:131], v[120:123], v[92:95], a[128:131]
  v_mfma_f32_16x16x32_bf16 a[160:163], v[120:123], v[100:103], a[160:163]
  ds_read_b64_tr_b16 v[152:153], v15 offset:32768
  v_mfma_f32_16x16x32_bf16 a[160:163], v[216:219], v[96:99], a[160:163]
  v_mfma_f32_16x16x32_bf16 a[164:167], v[220:223], v[96:99], a[164:167]
  ds_read_b64_tr_b16 v[154:155], v15 offset:34816
  v_mfma_f32_16x16x32_bf16 a[164:167], v[124:127], v[100:103], a[164:167]
  v_mfma_f32_16x16x32_bf16 a[132:135], v[124:127], v[92:95], a[132:135]
  ds_read_b128 v[60:63], v41 offset:32768
  v_mfma_f32_16x16x32_bf16 a[132:135], v[220:223], v[88:91], a[132:135]
  v_mfma_f32_16x16x32_bf16 a[136:139], v[224:227], v[88:91], a[136:139]
  ds_read_b64_tr_b16 v[156:157], v32 offset:32768
  v_mfma_f32_16x16x32_bf16 a[136:139], v[128:131], v[92:95], a[136:139]
  v_mfma_f32_16x16x32_bf16 a[168:171], v[128:131], v[100:103], a[168:171]
  ds_read_b64_tr_b16 v[158:159], v32 offset:34816
  v_mfma_f32_16x16x32_bf16 a[168:171], v[224:227], v[96:99], a[168:171]
  v_mfma_f32_16x16x32_bf16 a[172:175], v[228:231], v[96:99], a[172:175]
  ds_read_b128 v[64:67], v14 offset:34816
  v_mfma_f32_16x16x32_bf16 a[172:175], v[132:135], v[100:103], a[172:175]
  v_mfma_f32_16x16x32_bf16 a[140:143], v[132:135], v[92:95], a[140:143]
  ds_read_b64_tr_b16 v[160:161], v33 offset:32768
  v_mfma_f32_16x16x32_bf16 a[140:143], v[228:231], v[88:91], a[140:143]
  v_mfma_f32_16x16x32_bf16 a[144:147], v[236:239], v[88:91], a[144:147]
  ds_read_b64_tr_b16 v[162:163], v33 offset:34816
  v_mfma_f32_16x16x32_bf16 a[144:147], v[136:139], v[92:95], a[144:147]
  v_mfma_f32_16x16x32_bf16 a[176:179], v[136:139], v[100:103], a[176:179]
  ds_read_b128 v[68:71], v41 offset:34816
  v_mfma_f32_16x16x32_bf16 a[176:179], v[236:239], v[96:99], a[176:179]
  v_mfma_f32_16x16x32_bf16 a[180:183], v[240:243], v[96:99], a[180:183]
  ds_read_b64_tr_b16 v[164:165], v34 offset:32768
  v_mfma_f32_16x16x32_bf16 a[180:183], v[140:143], v[100:103], a[180:183]
  v_mfma_f32_16x16x32_bf16 a[148:151], v[140:143], v[92:95], a[148:151]
  ds_read_b64_tr_b16 v[166:167], v34 offset:34816
  v_mfma_f32_16x16x32_bf16 a[148:151], v[240:243], v[88:91], a[148:151]
  v_mfma_f32_16x16x32_bf16 a[152:155], v[244:247], v[88:91], a[152:155]
  ds_read_b128 v[72:75], v14 offset:36864
  v_mfma_f32_16x16x32_bf16 a[152:155], v[144:147], v[92:95], a[152:155]
  v_mfma_f32_16x16x32_bf16 a[184:187], v[144:147], v[100:103], a[184:187]
  ds_read_b64_tr_b16 v[168:169], v35 offset:32768
  v_mfma_f32_16x16x32_bf16 a[184:187], v[244:247], v[96:99], a[184:187]
  v_mfma_f32_16x16x32_bf16 a[188:191], v[248:251], v[96:99], a[188:191]
  ds_read_b64_tr_b16 v[170:171], v35 offset:34816
  v_mfma_f32_16x16x32_bf16 a[188:191], v[148:151], v[100:103], a[188:191]
  v_mfma_f32_16x16x32_bf16 a[156:159], v[148:151], v[92:95], a[156:159]
  ds_read_b128 v[76:79], v41 offset:36864
  v_mfma_f32_16x16x32_bf16 a[156:159], v[248:251], v[88:91], a[156:159]
  v_mfma_f32_16x16x32_bf16 a[220:223], v[248:251], v[104:107], a[220:223]
  ds_read_b64_tr_b16 v[172:173], v36 offset:32768
  v_mfma_f32_16x16x32_bf16 a[220:223], v[148:151], v[108:111], a[220:223]
  v_mfma_f32_16x16x32_bf16 a[252:255], v[148:151], v[116:119], a[252:255]
  ds_read_b64_tr_b16 v[174:175], v36 offset:34816
  v_mfma_f32_16x16x32_bf16 a[252:255], v[248:251], v[112:115], a[252:255]
  v_mfma_f32_16x16x32_bf16 a[248:251], v[244:247], v[112:115], a[248:251]
  ds_read_b128 v[80:83], v14 offset:38912
  v_mfma_f32_16x16x32_bf16 a[248:251], v[144:147], v[116:119], a[248:251]
  v_mfma_f32_16x16x32_bf16 a[216:219], v[144:147], v[108:111], a[216:219]
  ds_read_b64_tr_b16 v[176:177], v37 offset:32768
  v_mfma_f32_16x16x32_bf16 a[216:219], v[244:247], v[104:107], a[216:219]
  v_mfma_f32_16x16x32_bf16 a[212:215], v[240:243], v[104:107], a[212:215]
  ds_read_b64_tr_b16 v[178:179], v37 offset:34816
  v_mfma_f32_16x16x32_bf16 a[212:215], v[140:143], v[108:111], a[212:215]
  v_mfma_f32_16x16x32_bf16 a[244:247], v[140:143], v[116:119], a[244:247]
  ds_read_b128 v[84:87], v41 offset:38912
  v_mfma_f32_16x16x32_bf16 a[244:247], v[240:243], v[112:115], a[244:247]
  v_mfma_f32_16x16x32_bf16 a[240:243], v[236:239], v[112:115], a[240:243]
  ds_read_b64_tr_b16 v[180:181], v38 offset:32768
  v_mfma_f32_16x16x32_bf16 a[240:243], v[136:139], v[116:119], a[240:243]
  v_mfma_f32_16x16x32_bf16 a[208:211], v[136:139], v[108:111], a[208:211]
  ds_read_b64_tr_b16 v[182:183], v38 offset:34816
  v_mfma_f32_16x16x32_bf16 a[208:211], v[236:239], v[104:107], a[208:211]
  v_mfma_f32_16x16x32_bf16 a[204:207], v[228:231], v[104:107], a[204:207]
  v_mfma_f32_16x16x32_bf16 a[204:207], v[132:135], v[108:111], a[204:207]
  v_mfma_f32_16x16x32_bf16 a[236:239], v[132:135], v[116:119], a[236:239]
  v_mfma_f32_16x16x32_bf16 a[236:239], v[228:231], v[112:115], a[236:239]
  v_mfma_f32_16x16x32_bf16 a[232:235], v[224:227], v[112:115], a[232:235]
  v_mfma_f32_16x16x32_bf16 a[232:235], v[128:131], v[116:119], a[232:235]
  v_mfma_f32_16x16x32_bf16 a[200:203], v[128:131], v[108:111], a[200:203]
  v_mfma_f32_16x16x32_bf16 a[200:203], v[224:227], v[104:107], a[200:203]
  v_mfma_f32_16x16x32_bf16 a[196:199], v[220:223], v[104:107], a[196:199]
  v_mfma_f32_16x16x32_bf16 a[196:199], v[124:127], v[108:111], a[196:199]
  v_mfma_f32_16x16x32_bf16 a[228:231], v[124:127], v[116:119], a[228:231]
  v_mfma_f32_16x16x32_bf16 a[228:231], v[220:223], v[112:115], a[228:231]
  v_mfma_f32_16x16x32_bf16 a[224:227], v[216:219], v[112:115], a[224:227]
  v_mfma_f32_16x16x32_bf16 a[224:227], v[120:123], v[116:119], a[224:227]
  v_mfma_f32_16x16x32_bf16 a[192:195], v[120:123], v[108:111], a[192:195]
  v_mfma_f32_16x16x32_bf16 a[192:195], v[216:219], v[104:107], a[192:195]
  s_waitcnt lgkmcnt(0)
  s_waitcnt vmcnt(9)
  s_xor_b32 s32, s2, 56
  s_or_b32 s32, s32, s19
  s_cbranch_scc1 Lk_z15
  v_mov_b32 v2, 1
  v_mov_b32 v3, 0
  s_waitcnt vmcnt(0)
  global_store_dword v3, v2, s[50:51] sc1
Lk_z15:
  s_barrier
  v_mfma_f32_16x16x32_bf16 a[0:3], v[184:187], v[56:59], a[0:3]
  ds_read_b128 v[88:91], v14 offset:49152
  v_mfma_f32_16x16x32_bf16 a[0:3], v[152:155], v[60:63], a[0:3]
  v_mfma_f32_16x16x32_bf16 a[32:35], v[152:155], v[68:71], a[32:35]
  ds_read_b64_tr_b16 v[216:217], v15 offset:49152
  v_mfma_f32_16x16x32_bf16 a[32:35], v[184:187], v[64:67], a[32:35]
  ds_read_b64_tr_b16 v[232:233], v28 offset:0
  v_mfma_f32_16x16x32_bf16 a[36:39], v[188:191], v[64:67], a[36:39]
  ds_read_b64_tr_b16 v[218:219], v15 offset:51200
  v_mfma_f32_16x16x32_bf16 a[36:39], v[156:159], v[68:71], a[36:39]
  ds_read_b64_tr_b16 v[234:235], v28 offset:2048
  v_mfma_f32_16x16x32_bf16 a[4:7], v[156:159], v[60:63], a[4:7]
  ds_read_b128 v[92:95], v41 offset:49152
  v_mfma_f32_16x16x32_bf16 a[4:7], v[188:191], v[56:59], a[4:7]
  ds_read_b64_tr_b16 v[20:21], v29 offset:0
  v_mfma_f32_16x16x32_bf16 a[8:11], v[192:195], v[56:59], a[8:11]
  ds_read_b64_tr_b16 v[220:221], v32 offset:49152
  v_mfma_f32_16x16x32_bf16 a[8:11], v[160:163], v[60:63], a[8:11]
  ds_read_b64_tr_b16 v[22:23], v29 offset:2048
  v_mfma_f32_16x16x32_bf16 a[40:43], v[160:163], v[68:71], a[40:43]
  ds_read_b64_tr_b16 v[222:223], v32 offset:51200
  v_mfma_f32_16x16x32_bf16 a[40:43], v[192:195], v[64:67], a[40:43]
  v_mfma_f32_16x16x32_bf16 a[44:47], v[196:199], v[64:67], a[44:47]
  buffer_load_dwordx4 v6, s[20:23], s36 offen offset:0 lds
  v_mfma_f32_16x16x32_bf16 a[44:47], v[164:167], v[68:71], a[44:47]
  ds_read_b128 v[96:99], v14 offset:51200
  v_mfma_f32_16x16x32_bf16 a[12:15], v[164:167], v[60:63], a[12:15]
  v_mfma_f32_16x16x32_bf16 a[12:15], v[196:199], v[56:59], a[12:15]
  ds_read_b64_tr_b16 v[224:225], v33 offset:49152
  v_mfma_f32_16x16x32_bf16 a[16:19], v[200:203], v[56:59], a[16:19]
  v_mfma_f32_16x16x32_bf16 a[16:19], v[168:171], v[60:63], a[16:19]
  buffer_load_dwordx4 v7, s[20:23], s36 offen offset:1024 lds
  v_mfma_f32_16x16x32_bf16 a[48:51], v[168:171], v[68:71], a[48:51]
  ds_read_b64_tr_b16 v[226:227], v33 offset:51200
  v_mfma_f32_16x16x32_bf16 a[48:51], v[200:203], v[64:67], a[48:51]
  v_mfma_f32_16x16x32_bf16 a[52:55], v[204:207], v[64:67], a[52:55]
  ds_read_b128 v[100:103], v41 offset:51200
  v_mfma_f32_16x16x32_bf16 a[52:55], v[172:175], v[68:71], a[52:55]
  v_mfma_f32_16x16x32_bf16 a[20:23], v[172:175], v[60:63], a[20:23]
  buffer_load_dwordx4 v8, s[20:23], s36 offen offset:2048 lds
  v_mfma_f32_16x16x32_bf16 a[20:23], v[204:207], v[56:59], a[20:23]
  ds_read_b64_tr_b16 v[228:229], v34 offset:49152
  v_mfma_f32_16x16x32_bf16 a[24:27], v[208:211], v[56:59], a[24:27]
  s_waitcnt lgkmcnt(10)
  buffer_store_dwordx4 v[232:235], v52, s[28:31], s10 offen sc1
  v_mfma_f32_16x16x32_bf16 a[24:27], v[176:179], v[60:63], a[24:27]
  ds_read_b64_tr_b16 v[230:231], v34 offset:51200
  v_mfma_f32_16x16x32_bf16 a[56:59], v[176:179], v[68:71], a[56:59]
  v_mfma_f32_16x16x32_bf16 a[56:59], v[208:211], v[64:67], a[56:59]
  buffer_load_dwordx4 v9, s[20:23], s36 offen offset:3072 lds
  v_mfma_f32_16x16x32_bf16 a[60:63], v[212:215], v[64:67], a[60:63]
  s_sub_u32 s36, s36, 130944
  s_add_u32 m0, s34, 0x14000
  ds_read_b128 v[104:107], v14 offset:53248
  v_mfma_f32_16x16x32_bf16 a[60:63], v[180:183], v[68:71], a[60:63]
  v_mfma_f32_16x16x32_bf16 a[28:31], v[180:183], v[60:63], a[28:31]
  ds_read_b64_tr_b16 v[236:237], v35 offset:49152
  v_mfma_f32_16x16x32_bf16 a[28:31], v[212:215], v[56:59], a[28:31]
  v_mfma_f32_16x16x32_bf16 a[92:95], v[212:215], v[72:75], a[92:95]
  buffer_load_dwordx4 v10, s[24:27], s37 offen offset:0 lds
  v_mfma_f32_16x16x32_bf16 a[92:95], v[180:183], v[76:79], a[92:95]
  ds_read_b64_tr_b16 v[238:239], v35 offset:51200
  v_mfma_f32_16x16x32_bf16 a[124:127], v[180:183], v[84:87], a[124:127]
  v_mfma_f32_16x16x32_bf16 a[124:127], v[212:215], v[80:83], a[124:127]
  ds_read_b128 v[108:111], v41 offset:53248
  v_mfma_f32_16x16x32_bf16 a[120:123], v[208:211], v[80:83], a[120:123]
  v_mfma_f32_16x16x32_bf16 a[120:123], v[176:179], v[84:87], a[120:123]
  buffer_load_dwordx4 v11, s[24:27], s37 offen offset:1024 lds
  v_mfma_f32_16x16x32_bf16 a[88:91], v[176:179], v[76:79], a[88:91]
  ds_read_b64_tr_b16 v[240:241], v36 offset:49152
  v_mfma_f32_16x16x32_bf16 a[88:91], v[208:211], v[72:75], a[88:91]
  v_mfma_f32_16x16x32_bf16 a[84:87], v[204:207], v[72:75], a[84:87]
  ds_read_b64_tr_b16 v[242:243], v36 offset:51200
  v_mfma_f32_16x16x32_bf16 a[84:87], v[172:175], v[76:79], a[84:87]
  v_mfma_f32_16x16x32_bf16 a[116:119], v[172:175], v[84:87], a[116:119]
  buffer_load_dwordx4 v12, s[24:27], s37 offen offset:2048 lds
  v_mfma_f32_16x16x32_bf16 a[116:119], v[204:207], v[80:83], a[116:119]
  ds_read_b128 v[112:115], v14 offset:55296
  v_mfma_f32_16x16x32_bf16 a[112:115], v[200:203], v[80:83], a[112:115]
  v_mfma_f32_16x16x32_bf16 a[112:115], v[168:171], v[84:87], a[112:115]
  ds_read_b64_tr_b16 v[244:245], v37 offset:49152
  v_mfma_f32_16x16x32_bf16 a[80:83], v[168:171], v[76:79], a[80:83]
  v_mfma_f32_16x16x32_bf16 a[80:83], v[200:203], v[72:75], a[80:83]
  buffer_load_dwordx4 v13, s[24:27], s37 offen offset:3072 lds
  v_mfma_f32_16x16x32_bf16 a[76:79], v[196:199], v[72:75], a[76:79]
  s_add_u32 s37, s37, 0x40000
  s_add_u32 m0, s34, 0x8000
  ds_read_b64_tr_b16 v[246:247], v37 offset:51200
  v_mfma_f32_16x16x32_bf16 a[76:79], v[164:167], v[76:79], a[76:79]
  v_mfma_f32_16x16x32_bf16 a[108:111], v[164:167], v[84:87], a[108:111]
  ds_read_b128 v[116:119], v41 offset:55296
  v_mfma_f32_16x16x32_bf16 a[108:111], v[196:199], v[80:83], a[108:111]
  v_mfma_f32_16x16x32_bf16 a[104:107], v[192:195], v[80:83], a[104:107]
  buffer_load_dwordx4 v6, s[20:23], s36 offen offset:0 lds
  v_mfma_f32_16x16x32_bf16 a[104:107], v[160:163], v[84:87], a[104:107]
  ds_read_b64_tr_b16 v[248:249], v38 offset:49152
  v_mfma_f32_16x16x32_bf16 a[72:75], v[160:163], v[76:79], a[72:75]
  s_waitcnt lgkmcnt(15)
  buffer_store_dwordx4 v[20:23], v52, s[28:31], s11 offen sc1
  v_mfma_f32_16x16x32_bf16 a[72:75], v[192:195], v[72:75], a[72:75]
  ds_read_b64_tr_b16 v[250:251], v38 offset:51200
  v_mfma_f32_16x16x32_bf16 a[68:71], v[188:191], v[72:75], a[68:71]
  v_mfma_f32_16x16x32_bf16 a[68:71], v[156:159], v[76:79], a[68:71]
  buffer_load_dwordx4 v7, s[20:23], s36 offen offset:1024 lds
  v_mfma_f32_16x16x32_bf16 a[100:103], v[156:159], v[84:87], a[100:103]
  v_mfma_f32_16x16x32_bf16 a[100:103], v[188:191], v[80:83], a[100:103]
  v_mfma_f32_16x16x32_bf16 a[96:99], v[184:187], v[80:83], a[96:99]
  v_mfma_f32_16x16x32_bf16 a[96:99], v[152:155], v[84:87], a[96:99]
  v_mfma_f32_16x16x32_bf16 a[64:67], v[152:155], v[76:79], a[64:67]
  v_mfma_f32_16x16x32_bf16 a[64:67], v[184:187], v[72:75], a[64:67]
  s_waitcnt lgkmcnt(0)
  s_waitcnt vmcnt(13)
  s_barrier
  v_mfma_f32_16x16x32_bf16 a[128:131], v[184:187], v[88:91], a[128:131]
  ds_read_b128 v[56:59], v14 offset:0
  v_mfma_f32_16x16x32_bf16 a[128:131], v[152:155], v[92:95], a[128:131]
  buffer_load_dwordx4 v8, s[20:23], s36 offen offset:2048 lds
  v_mfma_f32_16x16x32_bf16 a[160:163], v[152:155], v[100:103], a[160:163]
  ds_read_b64_tr_b16 v[120:121], v15 offset:0
  v_mfma_f32_16x16x32_bf16 a[160:163], v[184:187], v[96:99], a[160:163]
  ds_read_b64_tr_b16 v[232:233], v30 offset:0
  v_mfma_f32_16x16x32_bf16 a[164:167], v[188:191], v[96:99], a[164:167]
  ds_read_b64_tr_b16 v[122:123], v15 offset:2048
  v_mfma_f32_16x16x32_bf16 a[164:167], v[156:159], v[100:103], a[164:167]
  ds_read_b64_tr_b16 v[234:235], v30 offset:2048
  v_mfma_f32_16x16x32_bf16 a[132:135], v[156:159], v[92:95], a[132:135]
  ds_read_b128 v[60:63], v41 offset:0
  v_mfma_f32_16x16x32_bf16 a[132:135], v[188:191], v[88:91], a[132:135]
  buffer_load_dwordx4 v9, s[20:23], s36 offen offset:3072 lds
  v_mfma_f32_16x16x32_bf16 a[136:139], v[192:195], v[88:91], a[136:139]
  s_add_u32 s36, s36, 131072
  s_add_u32 m0, s34, 0x18000
  ds_read_b64_tr_b16 v[124:125], v32 offset:0
  v_mfma_f32_16x16x32_bf16 a[136:139], v[160:163], v[92:95], a[136:139]
  ds_read_b64_tr_b16 v[20:21], v31 offset:0
  v_mfma_f32_16x16x32_bf16 a[168:171], v[160:163], v[100:103], a[168:171]
  ds_read_b64_tr_b16 v[126:127], v32 offset:2048
  v_mfma_f32_16x16x32_bf16 a[168:171], v[192:195], v[96:99], a[168:171]
  ds_read_b64_tr_b16 v[22:23], v31 offset:2048
  v_mfma_f32_16x16x32_bf16 a[172:175], v[196:199], v[96:99], a[172:175]
  ds_read_b128 v[64:67], v14 offset:2048
  v_mfma_f32_16x16x32_bf16 a[172:175], v[164:167], v[100:103], a[172:175]
  buffer_load_dwordx4 v10, s[24:27], s37 offen offset:0 lds
  v_mfma_f32_16x16x32_bf16 a[140:143], v[164:167], v[92:95], a[140:143]
  ds_read_b64_tr_b16 v[128:129], v33 offset:0
  v_mfma_f32_16x16x32_bf16 a[140:143], v[196:199], v[88:91], a[140:143]
  v_mfma_f32_16x16x32_bf16 a[144:147], v[200:203], v[88:91], a[144:147]
  ds_read_b64_tr_b16 v[130:131], v33 offset:2048
  v_mfma_f32_16x16x32_bf16 a[144:147], v[168:171], v[92:95], a[144:147]
  v_mfma_f32_16x16x32_bf16 a[176:179], v[168:171], v[100:103], a[176:179]
  ds_read_b128 v[68:71], v41 offset:2048
  v_mfma_f32_16x16x32_bf16 a[176:179], v[200:203], v[96:99], a[176:179]
  buffer_load_dwordx4 v11, s[24:27], s37 offen offset:1024 lds
  v_mfma_f32_16x16x32_bf16 a[180:183], v[204:207], v[96:99], a[180:183]
  ds_read_b64_tr_b16 v[132:133], v34 offset:0
  v_mfma_f32_16x16x32_bf16 a[180:183], v[172:175], v[100:103], a[180:183]
  v_mfma_f32_16x16x32_bf16 a[148:151], v[172:175], v[92:95], a[148:151]
  ds_read_b64_tr_b16 v[134:135], v34 offset:2048
  v_mfma_f32_16x16x32_bf16 a[148:151], v[204:207], v[88:91], a[148:151]
  v_mfma_f32_16x16x32_bf16 a[152:155], v[208:211], v[88:91], a[152:155]
  ds_read_b128 v[72:75], v14 offset:4096
  v_mfma_f32_16x16x32_bf16 a[152:155], v[176:179], v[92:95], a[152:155]
  buffer_load_dwordx4 v12, s[24:27], s37 offen offset:2048 lds
  v_mfma_f32_16x16x32_bf16 a[184:187], v[176:179], v[100:103], a[184:187]
  ds_read_b64_tr_b16 v[136:137], v35 offset:0
  v_mfma_f32_16x16x32_bf16 a[184:187], v[208:211], v[96:99], a[184:187]
  s_waitcnt lgkmcnt(13)
  buffer_store_dwordx4 v[232:235], v52, s[28:31], s12 offen sc1
  v_mfma_f32_16x16x32_bf16 a[188:191], v[212:215], v[96:99], a[188:191]
  ds_read_b64_tr_b16 v[138:139], v35 offset:2048
  v_mfma_f32_16x16x32_bf16 a[188:191], v[180:183], v[100:103], a[188:191]
  v_mfma_f32_16x16x32_bf16 a[156:159], v[180:183], v[92:95], a[156:159]
  ds_read_b128 v[76:79], v41 offset:4096
  v_mfma_f32_16x16x32_bf16 a[156:159], v[212:215], v[88:91], a[156:159]
  buffer_load_dwordx4 v13, s[24:27], s37 offen offset:3072 lds
  v_mfma_f32_16x16x32_bf16 a[220:223], v[212:215], v[104:107], a[220:223]
  s_add_u32 s37, s37, 0x40000
  s_add_u32 m0, s34, 0xc000
  ds_read_b64_tr_b16 v[140:141], v36 offset:0
  v_mfma_f32_16x16x32_bf16 a[220:223], v[180:183], v[108:111], a[220:223]
  v_mfma_f32_16x16x32_bf16 a[252:255], v[180:183], v[116:119], a[252:255]
  ds_read_b64_tr_b16 v[142:143], v36 offset:2048
  v_mfma_f32_16x16x32_bf16 a[252:255], v[212:215], v[112:115], a[252:255]
  v_mfma_f32_16x16x32_bf16 a[248:251], v[208:211], v[112:115], a[248:251]
  ds_read_b128 v[80:83], v14 offset:6144
  v_mfma_f32_16x16x32_bf16 a[248:251], v[176:179], v[116:119], a[248:251]
  buffer_load_dwordx4 v6, s[20:23], s36 offen offset:0 lds
  v_mfma_f32_16x16x32_bf16 a[216:219], v[176:179], v[108:111], a[216:219]
  ds_read_b64_tr_b16 v[144:145], v37 offset:0
  v_mfma_f32_16x16x32_bf16 a[216:219], v[208:211], v[104:107], a[216:219]
  v_mfma_f32_16x16x32_bf16 a[212:215], v[204:207], v[104:107], a[212:215]
  ds_read_b64_tr_b16 v[146:147], v37 offset:2048
  v_mfma_f32_16x16x32_bf16 a[212:215], v[172:175], v[108:111], a[212:215]
  v_mfma_f32_16x16x32_bf16 a[244:247], v[172:175], v[116:119], a[244:247]
  ds_read_b128 v[84:87], v41 offset:6144
  v_mfma_f32_16x16x32_bf16 a[244:247], v[204:207], v[112:115], a[244:247]
  buffer_load_dwordx4 v7, s[20:23], s36 offen offset:1024 lds
  v_mfma_f32_16x16x32_bf16 a[240:243], v[200:203], v[112:115], a[240:243]
  ds_read_b64_tr_b16 v[148:149], v38 offset:0
  v_mfma_f32_16x16x32_bf16 a[240:243], v[168:171], v[116:119], a[240:243]
  v_mfma_f32_16x16x32_bf16 a[208:211], v[168:171], v[108:111], a[208:211]
  ds_read_b64_tr_b16 v[150:151], v38 offset:2048
  v_mfma_f32_16x16x32_bf16 a[208:211], v[200:203], v[104:107], a[208:211]
  v_mfma_f32_16x16x32_bf16 a[204:207], v[196:199], v[104:107], a[204:207]
  v_mfma_f32_16x16x32_bf16 a[204:207], v[164:167], v[108:111], a[204:207]
  buffer_load_dwordx4 v8, s[20:23], s36 offen offset:2048 lds
  v_mfma_f32_16x16x32_bf16 a[236:239], v[164:167], v[116:119], a[236:239]
  v_mfma_f32_16x16x32_bf16 a[236:239], v[196:199], v[112:115], a[236:239]
  v_mfma_f32_16x16x32_bf16 a[232:235], v[192:195], v[112:115], a[232:235]
  v_mfma_f32_16x16x32_bf16 a[232:235], v[160:163], v[116:119], a[232:235]
  v_mfma_f32_16x16x32_bf16 a[200:203], v[160:163], v[108:111], a[200:203]
  v_mfma_f32_16x16x32_bf16 a[200:203], v[192:195], v[104:107], a[200:203]
  buffer_load_dwordx4 v9, s[20:23], s36 offen offset:3072 lds
  v_mfma_f32_16x16x32_bf16 a[196:199], v[188:191], v[104:107], a[196:199]
  s_sub_u32 s36, s36, 130944
  s_waitcnt lgkmcnt(15)
  buffer_store_dwordx4 v[20:23], v52, s[28:31], s13 offen sc1
  v_mfma_f32_16x16x32_bf16 a[196:199], v[156:159], v[108:111], a[196:199]
  v_mfma_f32_16x16x32_bf16 a[228:231], v[156:159], v[116:119], a[228:231]
  v_mfma_f32_16x16x32_bf16 a[228:231], v[188:191], v[112:115], a[228:231]
  v_mfma_f32_16x16x32_bf16 a[224:227], v[184:187], v[112:115], a[224:227]
  v_mfma_f32_16x16x32_bf16 a[224:227], v[152:155], v[116:119], a[224:227]
  v_mfma_f32_16x16x32_bf16 a[192:195], v[152:155], v[108:111], a[192:195]
  v_mfma_f32_16x16x32_bf16 a[192:195], v[184:187], v[104:107], a[192:195]
  s_waitcnt lgkmcnt(0)
  s_waitcnt vmcnt(15)
  s_barrier
  v_mfma_f32_16x16x32_bf16 a[0:3], v[216:219], v[56:59], a[0:3]
  s_mov_b32 s36, 0
  s_mov_b32 s37, 0
  ds_read_b128 v[88:91], v14 offset:16384
  v_mfma_f32_16x16x32_bf16 a[0:3], v[120:123], v[60:63], a[0:3]
  s_add_u32 m0, s48, 0x0
  v_mfma_f32_16x16x32_bf16 a[32:35], v[120:123], v[68:71], a[32:35]
  buffer_load_dwordx4 v55, s[52:55], s49 offen lds
  v_mfma_f32_16x16x32_bf16 a[32:35], v[216:219], v[64:67], a[32:35]
  s_add_u32 m0, s34, 0x10000
  s_add_u32 s49, s49, s47
  ds_write_b128 v52, v[48:51] offset:13312
  v_mfma_f32_16x16x32_bf16 a[36:39], v[220:223], v[64:67], a[36:39]
  ds_read_b64_tr_b16 v[232:233], v28 offset:4096
  v_mfma_f32_16x16x32_bf16 a[36:39], v[124:127], v[68:71], a[36:39]
  ds_read_b64_tr_b16 v[184:185], v15 offset:16384
  v_mfma_f32_16x16x32_bf16 a[4:7], v[124:127], v[60:63], a[4:7]
  ds_read_b64_tr_b16 v[234:235], v28 offset:6144
  v_mfma_f32_16x16x32_bf16 a[4:7], v[220:223], v[56:59], a[4:7]
  ds_read_b64_tr_b16 v[186:187], v15 offset:18432
  v_mfma_f32_16x16x32_bf16 a[8:11], v[224:227], v[56:59], a[8:11]
  ds_read_b64_tr_b16 v[20:21], v29 offset:4096
  v_mfma_f32_16x16x32_bf16 a[8:11], v[128:131], v[60:63], a[8:11]
  ds_read_b128 v[92:95], v41 offset:16384
  v_mfma_f32_16x16x32_bf16 a[40:43], v[128:131], v[68:71], a[40:43]
  buffer_load_dwordx4 v10, s[60:63], s37 offen offset:0 lds
  v_mfma_f32_16x16x32_bf16 a[40:43], v[224:227], v[64:67], a[40:43]
  ds_read_b64_tr_b16 v[22:23], v29 offset:6144
  v_mfma_f32_16x16x32_bf16 a[44:47], v[228:231], v[64:67], a[44:47]
  ds_read_b64_tr_b16 v[188:189], v32 offset:16384
  v_mfma_f32_16x16x32_bf16 a[44:47], v[132:135], v[68:71], a[44:47]
  v_mfma_f32_16x16x32_bf16 a[12:15], v[132:135], v[60:63], a[12:15]
  ds_read_b64_tr_b16 v[190:191], v32 offset:18432
  v_mfma_f32_16x16x32_bf16 a[12:15], v[228:231], v[56:59], a[12:15]
  v_mfma_f32_16x16x32_bf16 a[16:19], v[236:239], v[56:59], a[16:19]
  ds_read_b128 v[96:99], v14 offset:18432
  v_mfma_f32_16x16x32_bf16 a[16:19], v[136:139], v[60:63], a[16:19]
  v_mfma_f32_16x16x32_bf16 a[48:51], v[136:139], v[68:71], a[48:51]
  buffer_load_dwordx4 v11, s[60:63], s37 offen offset:1024 lds
  v_mfma_f32_16x16x32_bf16 a[48:51], v[236:239], v[64:67], a[48:51]
  ds_read_b64_tr_b16 v[192:193], v33 offset:16384
  v_mfma_f32_16x16x32_bf16 a[52:55], v[240:243], v[64:67], a[52:55]
  v_mfma_f32_16x16x32_bf16 a[52:55], v[140:143], v[68:71], a[52:55]
  ds_read_b64_tr_b16 v[194:195], v33 offset:18432
  v_mfma_f32_16x16x32_bf16 a[20:23], v[140:143], v[60:63], a[20:23]
  v_mfma_f32_16x16x32_bf16 a[20:23], v[240:243], v[56:59], a[20:23]
  ds_read_b128 v[100:103], v41 offset:18432
  v_mfma_f32_16x16x32_bf16 a[24:27], v[244:247], v[56:59], a[24:27]
  s_waitcnt lgkmcnt(10)
  buffer_store_dwordx4 v[232:235], v52, s[28:31], s98 offen sc1
  v_mfma_f32_16x16x32_bf16 a[24:27], v[144:147], v[60:63], a[24:27]
  ds_read_b64_tr_b16 v[196:197], v34 offset:16384
  v_mfma_f32_16x16x32_bf16 a[56:59], v[144:147], v[68:71], a[56:59]
  buffer_load_dwordx4 v12, s[60:63], s37 offen offset:2048 lds
  v_mfma_f32_16x16x32_bf16 a[56:59], v[244:247], v[64:67], a[56:59]
  ds_read_b64_tr_b16 v[198:199], v34 offset:18432
  v_mfma_f32_16x16x32_bf16 a[60:63], v[248:251], v[64:67], a[60:63]
  v_mfma_f32_16x16x32_bf16 a[60:63], v[148:151], v[68:71], a[60:63]
  ds_read_b128 v[104:107], v14 offset:20480
  v_mfma_f32_16x16x32_bf16 a[28:31], v[148:151], v[60:63], a[28:31]
  v_mfma_f32_16x16x32_bf16 a[28:31], v[248:251], v[56:59], a[28:31]
  ds_read_b64_tr_b16 v[200:201], v35 offset:16384
  v_mfma_f32_16x16x32_bf16 a[92:95], v[248:251], v[72:75], a[92:95]
  v_mfma_f32_16x16x32_bf16 a[92:95], v[148:151], v[76:79], a[92:95]
  ds_read_b64_tr_b16 v[202:203], v35 offset:18432
  v_mfma_f32_16x16x32_bf16 a[124:127], v[148:151], v[84:87], a[124:127]
  buffer_load_dwordx4 v13, s[60:63], s37 offen offset:3072 lds
  v_mfma_f32_16x16x32_bf16 a[124:127], v[248:251], v[80:83], a[124:127]
  s_add_u32 s37, s37, 0x40000
  s_mov_b32 m0, 0x3000
  ds_read_b128 v[108:111], v41 offset:20480
  v_mfma_f32_16x16x32_bf16 a[120:123], v[244:247], v[80:83], a[120:123]
  v_mfma_f32_16x16x32_bf16 a[120:123], v[144:147], v[84:87], a[120:123]
  ds_read_b64_tr_b16 v[204:205], v36 offset:16384
  v_mfma_f32_16x16x32_bf16 a[88:91], v[144:147], v[76:79], a[88:91]
  v_mfma_f32_16x16x32_bf16 a[88:91], v[244:247], v[72:75], a[88:91]
  ds_read_b64_tr_b16 v[206:207], v36 offset:18432
  v_mfma_f32_16x16x32_bf16 a[84:87], v[240:243], v[72:75], a[84:87]
  v_mfma_f32_16x16x32_bf16 a[84:87], v[140:143], v[76:79], a[84:87]
  ds_read_b128 v[112:115], v14 offset:22528
  v_mfma_f32_16x16x32_bf16 a[116:119], v[140:143], v[84:87], a[116:119]
  buffer_load_dwordx4 v52, s[68:71], 0 offen lds
  v_mfma_f32_16x16x32_bf16 a[116:119], v[240:243], v[80:83], a[116:119]
  ds_read_b64_tr_b16 v[208:209], v37 offset:16384
  v_mfma_f32_16x16x32_bf16 a[112:115], v[236:239], v[80:83], a[112:115]
  v_mfma_f32_16x16x32_bf16 a[112:115], v[136:139], v[84:87], a[112:115]
  ds_read_b64_tr_b16 v[210:211], v37 offset:18432
  v_mfma_f32_16x16x32_bf16 a[80:83], v[136:139], v[76:79], a[80:83]
  v_mfma_f32_16x16x32_bf16 a[80:83], v[236:239], v[72:75], a[80:83]
  ds_read_b128 v[116:119], v41 offset:22528
  v_mfma_f32_16x16x32_bf16 a[76:79], v[228:231], v[72:75], a[76:79]
  v_mfma_f32_16x16x32_bf16 a[76:79], v[132:135], v[76:79], a[76:79]
  ds_read_b64_tr_b16 v[212:213], v38 offset:16384
  v_mfma_f32_16x16x32_bf16 a[108:111], v[132:135], v[84:87], a[108:111]
  v_mfma_f32_16x16x32_bf16 a[108:111], v[228:231], v[80:83], a[108:111]
  ds_read_b64_tr_b16 v[214:215], v38 offset:18432
  v_mfma_f32_16x16x32_bf16 a[104:107], v[224:227], v[80:83], a[104:107]
  s_waitcnt lgkmcnt(15)
  buffer_store_dwordx4 v[20:23], v52, s[28:31], s99 offen sc1
  v_mfma_f32_16x16x32_bf16 a[104:107], v[128:131], v[84:87], a[104:107]
  v_mfma_f32_16x16x32_bf16 a[72:75], v[128:131], v[76:79], a[72:75]
  v_mfma_f32_16x16x32_bf16 a[72:75], v[224:227], v[72:75], a[72:75]
  v_mfma_f32_16x16x32_bf16 a[68:71], v[220:223], v[72:75], a[68:71]
  v_mfma_f32_16x16x32_bf16 a[68:71], v[124:127], v[76:79], a[68:71]
  v_mfma_f32_16x16x32_bf16 a[100:103], v[124:127], v[84:87], a[100:103]
  v_mfma_f32_16x16x32_bf16 a[100:103], v[220:223], v[80:83], a[100:103]
  v_mfma_f32_16x16x32_bf16 a[96:99], v[216:219], v[80:83], a[96:99]
  v_mfma_f32_16x16x32_bf16 a[96:99], v[120:123], v[84:87], a[96:99]
  v_mfma_f32_16x16x32_bf16 a[64:67], v[120:123], v[76:79], a[64:67]
  v_mfma_f32_16x16x32_bf16 a[64:67], v[216:219], v[72:75], a[64:67]
  s_waitcnt lgkmcnt(0)
  s_waitcnt vmcnt(13)
  s_barrier
  v_mfma_f32_16x16x32_bf16 a[128:131], v[216:219], v[88:91], a[128:131]
  s_add_u32 m0, s35, 0x0
  s_mov_b32 s4, s14
  ds_read_b128 v[56:59], v14 offset:32768
  v_mfma_f32_16x16x32_bf16 a[128:131], v[120:123], v[92:95], a[128:131]
  s_and_b32 s5, s15, 0xffff
  s_mov_b32 s6, 0x62000
  buffer_load_dwordx4 v53, s[56:59], s36 offen offset:0 lds
  v_mfma_f32_16x16x32_bf16 a[160:163], v[120:123], v[100:103], a[160:163]
  s_add_u32 m0, s35, 0x3fc0
  s_mov_b32 s7, 0x20000
  ds_read_b64_tr_b16 v[152:153], v15 offset:32768
  v_mfma_f32_16x16x32_bf16 a[160:163], v[216:219], v[96:99], a[160:163]
  s_lshl_b32 s69, s17, 20
  s_mul_i32 s79, s17, 229376
  ds_read_b64_tr_b16 v[232:233], v30 offset:4096
  v_mfma_f32_16x16x32_bf16 a[164:167], v[220:223], v[96:99], a[164:167]
  s_mov_b32 s8, s74
  s_and_b32 s9, s75, 0xffff
  ds_read_b64_tr_b16 v[154:155], v15 offset:34816
  v_mfma_f32_16x16x32_bf16 a[164:167], v[124:127], v[100:103], a[164:167]
  s_mov_b32 s10, 0x0
  s_mov_b32 s11, 0x20000
  ds_read_b64_tr_b16 v[234:235], v30 offset:6144
  v_mfma_f32_16x16x32_bf16 a[132:135], v[124:127], v[92:95], a[132:135]
  s_add_u32 s10, s79, 0x2038000
  ds_read_b128 v[60:63], v41 offset:32768
  v_mfma_f32_16x16x32_bf16 a[132:135], v[220:223], v[88:91], a[132:135]
  s_add_u32 s12, s74, 0x1000000
  s_addc_u32 s13, s75, 0
  buffer_load_dwordx4 v53, s[56:59], s36 offen offset:64 lds
  v_mfma_f32_16x16x32_bf16 a[136:139], v[224:227], v[88:91], a[136:139]
  s_add_u32 m0, s35, 0x0
  s_and_b32 s13, s13, 0xffff
  ds_read_b64_tr_b16 v[20:21], v31 offset:4096
  v_mfma_f32_16x16x32_bf16 a[136:139], v[128:131], v[92:95], a[136:139]
  s_mov_b32 s14, 0x0
  s_mov_b32 s15, 0x20000
  ds_read_b64_tr_b16 v[156:157], v32 offset:32768
  v_mfma_f32_16x16x32_bf16 a[168:171], v[128:131], v[100:103], a[168:171]
  s_add_u32 s14, s79, 0x2030800
  ds_read_b64_tr_b16 v[22:23], v31 offset:6144
  v_mfma_f32_16x16x32_bf16 a[168:171], v[224:227], v[96:99], a[168:171]
  s_add_u32 s20, s74, 0x4f00000
  s_addc_u32 s21, s75, 0
  ds_read_b64_tr_b16 v[158:159], v32 offset:34816
  v_mfma_f32_16x16x32_bf16 a[172:175], v[228:231], v[96:99], a[172:175]
  s_and_b32 s21, s21, 0xffff
  s_mov_b32 s22, 0x8000
  s_mov_b32 s23, 0x20000
  v_mfma_f32_16x16x32_bf16 a[172:175], v[132:135], v[100:103], a[172:175]
  s_mov_b32 s24, s50
  s_and_b32 s25, s51, 0xffff
  buffer_load_dwordx4 v54, s[56:59], s36 offen offset:1024 lds
  v_mfma_f32_16x16x32_bf16 a[140:143], v[132:135], v[92:95], a[140:143]
  s_add_u32 m0, s35, 0x3fc0
  s_mov_b32 s26, 0x100
  ds_read_b128 v[64:67], v14 offset:34816
  v_mfma_f32_16x16x32_bf16 a[140:143], v[228:231], v[88:91], a[140:143]
  s_mov_b32 s27, 0x20000
  s_mov_b32 s72, 0x21212224
  s_mov_b32 s73, 0x24202121
  v_mfma_f32_16x16x32_bf16 a[144:147], v[236:239], v[88:91], a[144:147]
  s_lshl_b32 s79, s16, 3
  s_lshr_b64 s[72:73], s[72:73], s79
  ds_read_b64_tr_b16 v[160:161], v33 offset:32768
  v_mfma_f32_16x16x32_bf16 a[144:147], v[136:139], v[92:95], a[144:147]
  s_and_b32 s72, s72, 0xff
  s_add_u32 s70, s69, 0x4000
  s_add_u32 s71, s69, 0x8000
  v_mfma_f32_16x16x32_bf16 a[176:179], v[136:139], v[100:103], a[176:179]
  s_lshr_b32 s73, s79, 3
  s_add_u32 s51, s17, 176
  ds_read_b64_tr_b16 v[162:163], v33 offset:34816
  v_mfma_f32_16x16x32_bf16 a[176:179], v[236:239], v[96:99], a[176:179]
  s_lshl_b32 s51, s51, 7
  buffer_load_dwordx4 v54, s[56:59], s36 offen offset:1088 lds
  v_mfma_f32_16x16x32_bf16 a[180:183], v[240:243], v[96:99], a[180:183]
  s_add_u32 s36, s36, 128
  s_add_u32 m0, s48, 0x4000
  ds_read_b128 v[68:71], v41 offset:34816
  v_mfma_f32_16x16x32_bf16 a[180:183], v[140:143], v[100:103], a[180:183]
  s_cmp_eq_u32 s19, 0
  s_cselect_b32 s79, s51, 0x100000
  v_add_u32 v9, s34, v52
  v_mfma_f32_16x16x32_bf16 a[148:151], v[140:143], v[92:95], a[148:151]
  ds_read_b64_tr_b16 v[164:165], v34 offset:32768
  v_mov_b32 v6, s79
  v_mfma_f32_16x16x32_bf16 a[148:151], v[240:243], v[88:91], a[148:151]
  v_mov_b32 v7, 4
  v_add_u32 v8, s97, v52
  v_mfma_f32_16x16x32_bf16 a[152:155], v[244:247], v[88:91], a[152:155]
  s_waitcnt lgkmcnt(10)
  buffer_store_dwordx4 v[232:235], v52, s[28:31], s100 offen sc1
  v_mfma_f32_16x16x32_bf16 a[152:155], v[144:147], v[92:95], a[152:155]
  buffer_load_dwordx4 v55, s[52:55], s49 offen lds
  v_mfma_f32_16x16x32_bf16 a[184:187], v[144:147], v[100:103], a[184:187]
  s_add_u32 m0, s34, 0x14000
  s_add_u32 s49, s49, s47
  ds_read_b64_tr_b16 v[166:167], v34 offset:34816
  v_mfma_f32_16x16x32_bf16 a[184:187], v[244:247], v[96:99], a[184:187]
  v_mfma_f32_16x16x32_bf16 a[188:191], v[248:251], v[96:99], a[188:191]
  ds_read_b128 v[72:75], v14 offset:36864
  v_mfma_f32_16x16x32_bf16 a[188:191], v[148:151], v[100:103], a[188:191]
  v_mfma_f32_16x16x32_bf16 a[156:159], v[148:151], v[92:95], a[156:159]
  ds_read_b64_tr_b16 v[168:169], v35 offset:32768
  v_mfma_f32_16x16x32_bf16 a[156:159], v[248:251], v[88:91], a[156:159]
  buffer_load_dwordx4 v10, s[60:63], s37 offen offset:0 lds
  v_mfma_f32_16x16x32_bf16 a[220:223], v[248:251], v[104:107], a[220:223]
  ds_read_b64_tr_b16 v[170:171], v35 offset:34816
  v_mfma_f32_16x16x32_bf16 a[220:223], v[148:151], v[108:111], a[220:223]
  v_mfma_f32_16x16x32_bf16 a[252:255], v[148:151], v[116:119], a[252:255]
  ds_read_b128 v[76:79], v41 offset:36864
  v_mfma_f32_16x16x32_bf16 a[252:255], v[248:251], v[112:115], a[252:255]
  v_mfma_f32_16x16x32_bf16 a[248:251], v[244:247], v[112:115], a[248:251]
  ds_read_b64_tr_b16 v[172:173], v36 offset:32768
  v_mfma_f32_16x16x32_bf16 a[248:251], v[144:147], v[116:119], a[248:251]
  buffer_load_dwordx4 v11, s[60:63], s37 offen offset:1024 lds
  v_mfma_f32_16x16x32_bf16 a[216:219], v[144:147], v[108:111], a[216:219]
  ds_read_b64_tr_b16 v[174:175], v36 offset:34816
  v_mfma_f32_16x16x32_bf16 a[216:219], v[244:247], v[104:107], a[216:219]
  v_mfma_f32_16x16x32_bf16 a[212:215], v[240:243], v[104:107], a[212:215]
  ds_read_b128 v[80:83], v14 offset:38912
  v_mfma_f32_16x16x32_bf16 a[212:215], v[140:143], v[108:111], a[212:215]
  v_mfma_f32_16x16x32_bf16 a[244:247], v[140:143], v[116:119], a[244:247]
  ds_read_b64_tr_b16 v[176:177], v37 offset:32768
  v_mfma_f32_16x16x32_bf16 a[244:247], v[240:243], v[112:115], a[244:247]
  buffer_load_dwordx4 v12, s[60:63], s37 offen offset:2048 lds
  v_mfma_f32_16x16x32_bf16 a[240:243], v[236:239], v[112:115], a[240:243]
  ds_read_b64_tr_b16 v[178:179], v37 offset:34816
  v_mfma_f32_16x16x32_bf16 a[240:243], v[136:139], v[116:119], a[240:243]
  v_mfma_f32_16x16x32_bf16 a[208:211], v[136:139], v[108:111], a[208:211]
  ds_read_b128 v[84:87], v41 offset:38912
  v_mfma_f32_16x16x32_bf16 a[208:211], v[236:239], v[104:107], a[208:211]
  v_mfma_f32_16x16x32_bf16 a[204:207], v[228:231], v[104:107], a[204:207]
  ds_read_b64_tr_b16 v[180:181], v38 offset:32768
  v_mfma_f32_16x16x32_bf16 a[204:207], v[132:135], v[108:111], a[204:207]
  buffer_load_dwordx4 v13, s[60:63], s37 offen offset:3072 lds
  v_mfma_f32_16x16x32_bf16 a[236:239], v[132:135], v[116:119], a[236:239]
  s_add_u32 s37, s37, 0x40000
  ds_read_b64_tr_b16 v[182:183], v38 offset:34816
  v_mfma_f32_16x16x32_bf16 a[236:239], v[228:231], v[112:115], a[236:239]
  v_mfma_f32_16x16x32_bf16 a[232:235], v[224:227], v[112:115], a[232:235]
  s_waitcnt lgkmcnt(15)
  buffer_store_dwordx4 v[20:23], v52, s[28:31], s101 offen sc1
  v_mfma_f32_16x16x32_bf16 a[232:235], v[128:131], v[116:119], a[232:235]
  v_mfma_f32_16x16x32_bf16 a[200:203], v[128:131], v[108:111], a[200:203]
  v_mfma_f32_16x16x32_bf16 a[200:203], v[224:227], v[104:107], a[200:203]
  v_mfma_f32_16x16x32_bf16 a[196:199], v[220:223], v[104:107], a[196:199]
  v_mfma_f32_16x16x32_bf16 a[196:199], v[124:127], v[108:111], a[196:199]
  v_mfma_f32_16x16x32_bf16 a[228:231], v[124:127], v[116:119], a[228:231]
  v_mfma_f32_16x16x32_bf16 a[228:231], v[220:223], v[112:115], a[228:231]
  v_mfma_f32_16x16x32_bf16 a[224:227], v[216:219], v[112:115], a[224:227]
  v_mfma_f32_16x16x32_bf16 a[224:227], v[120:123], v[116:119], a[224:227]
  v_mfma_f32_16x16x32_bf16 a[192:195], v[120:123], v[108:111], a[192:195]
  v_mfma_f32_16x16x32_bf16 a[192:195], v[216:219], v[104:107], a[192:195]
  s_waitcnt lgkmcnt(0)
  s_waitcnt vmcnt(20)
  s_barrier
  v_mfma_f32_16x16x32_bf16 a[0:3], v[184:187], v[56:59], a[0:3]
  s_add_u32 m0, s48, 0x8000
  ds_read_b128 v[88:91], v14 offset:49152
  v_mfma_f32_16x16x32_bf16 a[0:3], v[152:155], v[60:63], a[0:3]
  buffer_load_dwordx4 v55, s[52:55], s49 offen lds
  v_mfma_f32_16x16x32_bf16 a[32:35], v[152:155], v[68:71], a[32:35]
  s_add_u32 m0, s34, 0x18000
  s_add_u32 s49, s49, s47
  ds_read_b128 v[92:95], v41 offset:49152
  v_mfma_f32_16x16x32_bf16 a[32:35], v[184:187], v[64:67], a[32:35]
  v_mfma_f32_16x16x32_bf16 a[36:39], v[188:191], v[64:67], a[36:39]
  ds_read_b128 v[96:99], v14 offset:51200
  v_mfma_f32_16x16x32_bf16 a[36:39], v[156:159], v[68:71], a[36:39]
  v_mfma_f32_16x16x32_bf16 a[4:7], v[156:159], v[60:63], a[4:7]
  ds_read_b128 v[100:103], v41 offset:51200
  v_mfma_f32_16x16x32_bf16 a[4:7], v[188:191], v[56:59], a[4:7]
  buffer_load_dwordx4 v10, s[60:63], s37 offen offset:0 lds
  v_mfma_f32_16x16x32_bf16 a[8:11], v[192:195], v[56:59], a[8:11]
  ds_read_b128 v[104:107], v14 offset:53248
  v_mfma_f32_16x16x32_bf16 a[8:11], v[160:163], v[60:63], a[8:11]
  v_mfma_f32_16x16x32_bf16 a[40:43], v[160:163], v[68:71], a[40:43]
  ds_read_b128 v[108:111], v41 offset:53248
  v_mfma_f32_16x16x32_bf16 a[40:43], v[192:195], v[64:67], a[40:43]
  v_mfma_f32_16x16x32_bf16 a[44:47], v[196:199], v[64:67], a[44:47]
  ds_read_b128 v[112:115], v14 offset:55296
  v_mfma_f32_16x16x32_bf16 a[44:47], v[164:167], v[68:71], a[44:47]
  buffer_load_dwordx4 v11, s[60:63], s37 offen offset:1024 lds
  v_mfma_f32_16x16x32_bf16 a[12:15], v[164:167], v[60:63], a[12:15]
  ds_read_b128 v[116:119], v41 offset:55296
  v_mfma_f32_16x16x32_bf16 a[12:15], v[196:199], v[56:59], a[12:15]
  v_mfma_f32_16x16x32_bf16 a[16:19], v[200:203], v[56:59], a[16:19]
  v_mfma_f32_16x16x32_bf16 a[16:19], v[168:171], v[60:63], a[16:19]
  v_mfma_f32_16x16x32_bf16 a[48:51], v[168:171], v[68:71], a[48:51]
  v_mfma_f32_16x16x32_bf16 a[48:51], v[200:203], v[64:67], a[48:51]
  buffer_load_dwordx4 v12, s[60:63], s37 offen offset:2048 lds
  v_mfma_f32_16x16x32_bf16 a[52:55], v[204:207], v[64:67], a[52:55]
  v_mfma_f32_16x16x32_bf16 a[52:55], v[172:175], v[68:71], a[52:55]
  v_mfma_f32_16x16x32_bf16 a[20:23], v[172:175], v[60:63], a[20:23]
  v_mfma_f32_16x16x32_bf16 a[20:23], v[204:207], v[56:59], a[20:23]
  v_mfma_f32_16x16x32_bf16 a[24:27], v[208:211], v[56:59], a[24:27]
  v_mfma_f32_16x16x32_bf16 a[24:27], v[176:179], v[60:63], a[24:27]
  buffer_load_dwordx4 v13, s[60:63], s37 offen offset:3072 lds
  v_mfma_f32_16x16x32_bf16 a[56:59], v[176:179], v[68:71], a[56:59]
  s_add_u32 s37, s37, 0x40000
  v_mfma_f32_16x16x32_bf16 a[56:59], v[208:211], v[64:67], a[56:59]
  v_mfma_f32_16x16x32_bf16 a[60:63], v[212:215], v[64:67], a[60:63]
  v_mfma_f32_16x16x32_bf16 a[60:63], v[180:183], v[68:71], a[60:63]
  v_mfma_f32_16x16x32_bf16 a[28:31], v[180:183], v[60:63], a[28:31]
  v_mfma_f32_16x16x32_bf16 a[28:31], v[212:215], v[56:59], a[28:31]
  v_mfma_f32_16x16x32_bf16 a[92:95], v[212:215], v[72:75], a[92:95]
  v_mfma_f32_16x16x32_bf16 a[92:95], v[180:183], v[76:79], a[92:95]
  v_mfma_f32_16x16x32_bf16 a[124:127], v[180:183], v[84:87], a[124:127]
  v_mfma_f32_16x16x32_bf16 a[124:127], v[212:215], v[80:83], a[124:127]
  v_accvgpr_read_b32 v236, a0
  v_accvgpr_read_b32 v237, a1
  v_mfma_f32_16x16x32_bf16 a[120:123], v[208:211], v[80:83], a[120:123]
  v_accvgpr_read_b32 v238, a2
  v_accvgpr_read_b32 v239, a3
  v_mfma_f32_16x16x32_bf16 a[120:123], v[176:179], v[84:87], a[120:123]
  v_accvgpr_read_b32 v240, a4
  v_accvgpr_read_b32 v241, a5
  v_mfma_f32_16x16x32_bf16 a[88:91], v[176:179], v[76:79], a[88:91]
  v_accvgpr_read_b32 v242, a6
  v_accvgpr_read_b32 v243, a7
  v_mfma_f32_16x16x32_bf16 a[88:91], v[208:211], v[72:75], a[88:91]
  v_cvt_pk_bf16_f32 v244, v236, v237
  v_cvt_pk_bf16_f32 v245, v238, v239
  v_mfma_f32_16x16x32_bf16 a[84:87], v[204:207], v[72:75], a[84:87]
  v_cvt_pk_bf16_f32 v246, v240, v241
  v_cvt_pk_bf16_f32 v247, v242, v243
  v_mfma_f32_16x16x32_bf16 a[84:87], v[172:175], v[76:79], a[84:87]
  ds_write_b128 v8, v[244:247] offset:0
  v_accvgpr_read_b32 v236, a8
  v_mfma_f32_16x16x32_bf16 a[116:119], v[172:175], v[84:87], a[116:119]
  v_accvgpr_read_b32 v237, a9
  v_accvgpr_read_b32 v238, a10
  v_mfma_f32_16x16x32_bf16 a[116:119], v[204:207], v[80:83], a[116:119]
  v_accvgpr_read_b32 v239, a11
  v_accvgpr_read_b32 v240, a12
  v_mfma_f32_16x16x32_bf16 a[112:115], v[200:203], v[80:83], a[112:115]
  v_accvgpr_read_b32 v241, a13
  v_accvgpr_read_b32 v242, a14
  v_mfma_f32_16x16x32_bf16 a[112:115], v[168:171], v[84:87], a[112:115]
  v_accvgpr_read_b32 v243, a15
  v_cvt_pk_bf16_f32 v248, v236, v237
  v_mfma_f32_16x16x32_bf16 a[80:83], v[168:171], v[76:79], a[80:83]
  v_cvt_pk_bf16_f32 v249, v238, v239
  v_cvt_pk_bf16_f32 v250, v240, v241
  v_mfma_f32_16x16x32_bf16 a[80:83], v[200:203], v[72:75], a[80:83]
  v_cvt_pk_bf16_f32 v251, v242, v243
  v_mfma_f32_16x16x32_bf16 a[76:79], v[196:199], v[72:75], a[76:79]
  ds_write_b128 v8, v[248:251] offset:1024
  v_accvgpr_read_b32 v236, a16
  v_mfma_f32_16x16x32_bf16 a[76:79], v[164:167], v[76:79], a[76:79]
  v_accvgpr_read_b32 v237, a17
  v_accvgpr_read_b32 v238, a18
  v_mfma_f32_16x16x32_bf16 a[108:111], v[164:167], v[84:87], a[108:111]
  v_accvgpr_read_b32 v239, a19
  v_accvgpr_read_b32 v240, a20
  v_mfma_f32_16x16x32_bf16 a[108:111], v[196:199], v[80:83], a[108:111]
  v_accvgpr_read_b32 v241, a21
  v_accvgpr_read_b32 v242, a22
  v_mfma_f32_16x16x32_bf16 a[104:107], v[192:195], v[80:83], a[104:107]
  v_accvgpr_read_b32 v243, a23
  v_cvt_pk_bf16_f32 v244, v236, v237
  v_mfma_f32_16x16x32_bf16 a[104:107], v[160:163], v[84:87], a[104:107]
  v_cvt_pk_bf16_f32 v245, v238, v239
  v_cvt_pk_bf16_f32 v246, v240, v241
  v_mfma_f32_16x16x32_bf16 a[72:75], v[160:163], v[76:79], a[72:75]
  v_cvt_pk_bf16_f32 v247, v242, v243
  v_mfma_f32_16x16x32_bf16 a[72:75], v[192:195], v[72:75], a[72:75]
  ds_write_b128 v8, v[244:247] offset:2048
  v_accvgpr_read_b32 v236, a24
  v_mfma_f32_16x16x32_bf16 a[68:71], v[188:191], v[72:75], a[68:71]
  v_accvgpr_read_b32 v237, a25
  v_accvgpr_read_b32 v238, a26
  v_mfma_f32_16x16x32_bf16 a[68:71], v[156:159], v[76:79], a[68:71]
  v_accvgpr_read_b32 v239, a27
  v_accvgpr_read_b32 v240, a28
  v_mfma_f32_16x16x32_bf16 a[100:103], v[156:159], v[84:87], a[100:103]
  v_accvgpr_read_b32 v241, a29
  v_accvgpr_read_b32 v242, a30
  v_mfma_f32_16x16x32_bf16 a[100:103], v[188:191], v[80:83], a[100:103]
  v_accvgpr_read_b32 v243, a31
  v_cvt_pk_bf16_f32 v248, v236, v237
  v_mfma_f32_16x16x32_bf16 a[96:99], v[184:187], v[80:83], a[96:99]
  v_cvt_pk_bf16_f32 v249, v238, v239
  v_cvt_pk_bf16_f32 v250, v240, v241
  v_mfma_f32_16x16x32_bf16 a[96:99], v[152:155], v[84:87], a[96:99]
  v_cvt_pk_bf16_f32 v251, v242, v243
  v_mfma_f32_16x16x32_bf16 a[64:67], v[152:155], v[76:79], a[64:67]
  ds_write_b128 v8, v[248:251] offset:3072
  v_mfma_f32_16x16x32_bf16 a[64:67], v[184:187], v[72:75], a[64:67]
  s_mov_b32 s64, s40
  s_add_u32 s40, s40, s41
  v_accvgpr_read_b32 v236, a32
  s_waitcnt lgkmcnt(0)
  s_waitcnt vmcnt(13)
  s_barrier
  s_lshl_b32 s32, s19, 10
  v_add_u32 v41, s32, v52
  v_mfma_f32_16x16x32_bf16 a[128:131], v[184:187], v[88:91], a[128:131]
  s_add_u32 m0, s35, 0x8000
  ds_read_b128 v[56:59], v42 offset:0
  v_accvgpr_read_b32 v237, a33
  v_mfma_f32_16x16x32_bf16 a[128:131], v[152:155], v[92:95], a[128:131]
  buffer_load_dwordx4 v53, s[56:59], s36 offen offset:0 lds
  v_accvgpr_read_b32 v238, a34
  v_mfma_f32_16x16x32_bf16 a[160:163], v[152:155], v[100:103], a[160:163]
  s_add_u32 m0, s35, 0xbfc0
  ds_read_b128 v[60:63], v42 offset:1024
  v_accvgpr_read_b32 v239, a35
  v_mfma_f32_16x16x32_bf16 a[160:163], v[184:187], v[96:99], a[160:163]
  v_accvgpr_read_b32 v240, a36
  v_accvgpr_read_b32 v241, a37
  v_mfma_f32_16x16x32_bf16 a[164:167], v[188:191], v[96:99], a[164:167]
  ds_read_b64_tr_b16 v[72:73], v44 offset:8192
  v_accvgpr_read_b32 v242, a38
  v_mfma_f32_16x16x32_bf16 a[164:167], v[156:159], v[100:103], a[164:167]
  v_accvgpr_read_b32 v243, a39
  v_cvt_pk_bf16_f32 v244, v236, v237
  v_mfma_f32_16x16x32_bf16 a[132:135], v[156:159], v[92:95], a[132:135]
  ds_read_b64_tr_b16 v[74:75], v44 offset:8448
  v_cvt_pk_bf16_f32 v245, v238, v239
  v_mfma_f32_16x16x32_bf16 a[132:135], v[188:191], v[88:91], a[132:135]
  buffer_load_dwordx4 v53, s[56:59], s36 offen offset:64 lds
  v_cvt_pk_bf16_f32 v246, v240, v241
  v_mfma_f32_16x16x32_bf16 a[136:139], v[192:195], v[88:91], a[136:139]
  s_add_u32 m0, s35, 0x8000
  ds_read_b64_tr_b16 v[76:77], v45 offset:8192
  v_cvt_pk_bf16_f32 v247, v242, v243
  v_mfma_f32_16x16x32_bf16 a[136:139], v[160:163], v[92:95], a[136:139]
  ds_write_b128 v8, v[244:247] offset:4096
  v_accvgpr_read_b32 v236, a40
  v_mfma_f32_16x16x32_bf16 a[168:171], v[160:163], v[100:103], a[168:171]
  ds_read_b64_tr_b16 v[78:79], v45 offset:8448
  v_accvgpr_read_b32 v237, a41
  v_mfma_f32_16x16x32_bf16 a[168:171], v[192:195], v[96:99], a[168:171]
  v_accvgpr_read_b32 v238, a42
  v_accvgpr_read_b32 v239, a43
  v_mfma_f32_16x16x32_bf16 a[172:175], v[196:199], v[96:99], a[172:175]
  ds_read_b128 v[84:87], v47 offset:0
  v_accvgpr_read_b32 v240, a44
  v_mfma_f32_16x16x32_bf16 a[172:175], v[164:167], v[100:103], a[172:175]
  buffer_load_dwordx4 v54, s[56:59], s36 offen offset:1024 lds
  v_accvgpr_read_b32 v241, a45
  v_mfma_f32_16x16x32_bf16 a[140:143], v[164:167], v[92:95], a[140:143]
  s_add_u32 m0, s35, 0xbfc0
  ds_read_b64_tr_b16 v[80:81], v46 offset:10240
  v_accvgpr_read_b32 v242, a46
  v_mfma_f32_16x16x32_bf16 a[140:143], v[196:199], v[88:91], a[140:143]
  v_accvgpr_read_b32 v243, a47
  v_cvt_pk_bf16_f32 v248, v236, v237
  v_mfma_f32_16x16x32_bf16 a[144:147], v[200:203], v[88:91], a[144:147]
  ds_read_b64_tr_b16 v[82:83], v46 offset:10368
  v_cvt_pk_bf16_f32 v249, v238, v239
  v_mfma_f32_16x16x32_bf16 a[144:147], v[168:171], v[92:95], a[144:147]
  v_cvt_pk_bf16_f32 v250, v240, v241
  v_cvt_pk_bf16_f32 v251, v242, v243
  v_mfma_f32_16x16x32_bf16 a[176:179], v[168:171], v[100:103], a[176:179]
  ds_write_b128 v8, v[248:251] offset:5120
  v_accvgpr_read_b32 v236, a48
  v_mfma_f32_16x16x32_bf16 a[176:179], v[200:203], v[96:99], a[176:179]
  buffer_load_dwordx4 v54, s[56:59], s36 offen offset:1088 lds
  v_accvgpr_read_b32 v237, a49
  v_mfma_f32_16x16x32_bf16 a[180:183], v[204:207], v[96:99], a[180:183]
  s_add_u32 s36, s36, 128
  s_add_u32 m0, s48, 0xc000
  ds_read_b128 v[64:67], v43 offset:0
  v_mfma_f32_16x16x32_bf16 a[180:183], v[172:175], v[100:103], a[180:183]
  v_accvgpr_read_b32 v238, a50
  v_accvgpr_read_b32 v239, a51
  v_mfma_f32_16x16x32_bf16 a[148:151], v[172:175], v[92:95], a[148:151]
  ds_read_b128 v[68:71], v43 offset:1024
  v_accvgpr_read_b32 v240, a52
  v_mfma_f32_16x16x32_bf16 a[148:151], v[204:207], v[88:91], a[148:151]
  v_accvgpr_read_b32 v241, a53
  v_accvgpr_read_b32 v242, a54
  v_mfma_f32_16x16x32_bf16 a[152:155], v[208:211], v[88:91], a[152:155]
  ds_read_b64_tr_b16 v[120:121], v15 offset:0
  v_accvgpr_read_b32 v243, a55
  v_mfma_f32_16x16x32_bf16 a[152:155], v[176:179], v[92:95], a[152:155]
  buffer_load_dwordx4 v55, s[52:55], s49 offen lds
  v_cvt_pk_bf16_f32 v244, v236, v237
  v_mfma_f32_16x16x32_bf16 a[184:187], v[176:179], v[100:103], a[184:187]
  s_add_u32 m0, s34, 0x1c000
  s_add_u32 s49, s49, s47
  ds_read_b64_tr_b16 v[122:123], v15 offset:2048
  v_mfma_f32_16x16x32_bf16 a[184:187], v[208:211], v[96:99], a[184:187]
  v_cvt_pk_bf16_f32 v245, v238, v239
  v_cvt_pk_bf16_f32 v246, v240, v241
  v_mfma_f32_16x16x32_bf16 a[188:191], v[212:215], v[96:99], a[188:191]
  ds_read_b64_tr_b16 v[124:125], v32 offset:0
  v_cvt_pk_bf16_f32 v247, v242, v243
  v_mfma_f32_16x16x32_bf16 a[188:191], v[180:183], v[100:103], a[188:191]
  ds_write_b128 v8, v[244:247] offset:6144
  v_accvgpr_read_b32 v236, a56
  v_mfma_f32_16x16x32_bf16 a[156:159], v[180:183], v[92:95], a[156:159]
  ds_read_b64_tr_b16 v[126:127], v32 offset:2048
  v_accvgpr_read_b32 v237, a57
  v_mfma_f32_16x16x32_bf16 a[156:159], v[212:215], v[88:91], a[156:159]
  buffer_load_dwordx4 v10, s[60:63], s37 offen offset:0 lds
  v_accvgpr_read_b32 v238, a58
  v_mfma_f32_16x16x32_bf16 a[220:223], v[212:215], v[104:107], a[220:223]
  ds_read_b64_tr_b16 v[128:129], v33 offset:0
  v_accvgpr_read_b32 v239, a59
  v_mfma_f32_16x16x32_bf16 a[220:223], v[180:183], v[108:111], a[220:223]
  v_accvgpr_read_b32 v240, a60
  v_accvgpr_read_b32 v241, a61
  v_mfma_f32_16x16x32_bf16 a[252:255], v[180:183], v[116:119], a[252:255]
  ds_read_b64_tr_b16 v[130:131], v33 offset:2048
  v_accvgpr_read_b32 v242, a62
  v_mfma_f32_16x16x32_bf16 a[252:255], v[212:215], v[112:115], a[252:255]
  v_accvgpr_read_b32 v243, a63
  v_cvt_pk_bf16_f32 v248, v236, v237
  v_mfma_f32_16x16x32_bf16 a[248:251], v[208:211], v[112:115], a[248:251]
  ds_read_b64_tr_b16 v[132:133], v34 offset:0
  v_cvt_pk_bf16_f32 v249, v238, v239
  v_mfma_f32_16x16x32_bf16 a[248:251], v[176:179], v[116:119], a[248:251]
  buffer_load_dwordx4 v11, s[60:63], s37 offen offset:1024 lds
  v_cvt_pk_bf16_f32 v250, v240, v241
  v_mfma_f32_16x16x32_bf16 a[216:219], v[176:179], v[108:111], a[216:219]
  ds_read_b64_tr_b16 v[134:135], v34 offset:2048
  v_cvt_pk_bf16_f32 v251, v242, v243
  v_mfma_f32_16x16x32_bf16 a[216:219], v[208:211], v[104:107], a[216:219]
  ds_write_b128 v8, v[248:251] offset:7168
  v_mfma_f32_16x16x32_bf16 a[212:215], v[204:207], v[104:107], a[212:215]
  s_mov_b32 s65, s40
  s_add_u32 s40, s40, s42
  ds_read_b64_tr_b16 v[136:137], v35 offset:0
  v_mfma_f32_16x16x32_bf16 a[212:215], v[172:175], v[108:111], a[212:215]
  v_accvgpr_read_b32 v236, a64
  v_accvgpr_read_b32 v237, a65
  v_mfma_f32_16x16x32_bf16 a[244:247], v[172:175], v[116:119], a[244:247]
  ds_read_b64_tr_b16 v[138:139], v35 offset:2048
  v_accvgpr_read_b32 v238, a66
  v_mfma_f32_16x16x32_bf16 a[244:247], v[204:207], v[112:115], a[244:247]
  buffer_load_dwordx4 v12, s[60:63], s37 offen offset:2048 lds
  v_accvgpr_read_b32 v239, a67
  v_mfma_f32_16x16x32_bf16 a[240:243], v[200:203], v[112:115], a[240:243]
  ds_read_b64_tr_b16 v[140:141], v36 offset:0
  v_accvgpr_read_b32 v240, a68
  v_mfma_f32_16x16x32_bf16 a[240:243], v[168:171], v[116:119], a[240:243]
  v_accvgpr_read_b32 v241, a69
  v_accvgpr_read_b32 v242, a70
  v_mfma_f32_16x16x32_bf16 a[208:211], v[168:171], v[108:111], a[208:211]
  ds_read_b64_tr_b16 v[142:143], v36 offset:2048
  v_accvgpr_read_b32 v243, a71
  v_mfma_f32_16x16x32_bf16 a[208:211], v[200:203], v[104:107], a[208:211]
  v_cvt_pk_bf16_f32 v244, v236, v237
  v_cvt_pk_bf16_f32 v245, v238, v239
  v_mfma_f32_16x16x32_bf16 a[204:207], v[196:199], v[104:107], a[204:207]
  ds_read_b64_tr_b16 v[144:145], v37 offset:0
  v_cvt_pk_bf16_f32 v246, v240, v241
  v_mfma_f32_16x16x32_bf16 a[204:207], v[164:167], v[108:111], a[204:207]
  buffer_load_dwordx4 v13, s[60:63], s37 offen offset:3072 lds
  v_cvt_pk_bf16_f32 v247, v242, v243
  v_mfma_f32_16x16x32_bf16 a[236:239], v[164:167], v[116:119], a[236:239]
  s_add_u32 s37, s37, 0x40000
  buffer_store_dwordx4 v[244:247], v52, s[28:31], s40 offen offset:0 sc1
  v_accvgpr_read_b32 v236, a72
  v_mfma_f32_16x16x32_bf16 a[236:239], v[196:199], v[112:115], a[236:239]
  ds_read_b64_tr_b16 v[146:147], v37 offset:2048
  v_accvgpr_read_b32 v237, a73
  v_mfma_f32_16x16x32_bf16 a[232:235], v[192:195], v[112:115], a[232:235]
  v_accvgpr_read_b32 v238, a74
  v_accvgpr_read_b32 v239, a75
  v_mfma_f32_16x16x32_bf16 a[232:235], v[160:163], v[116:119], a[232:235]
  ds_read_b64_tr_b16 v[148:149], v38 offset:0
  v_accvgpr_read_b32 v240, a76
  v_mfma_f32_16x16x32_bf16 a[200:203], v[160:163], v[108:111], a[200:203]
  v_accvgpr_read_b32 v241, a77
  v_accvgpr_read_b32 v242, a78
  v_mfma_f32_16x16x32_bf16 a[200:203], v[192:195], v[104:107], a[200:203]
  ds_read_b64_tr_b16 v[150:151], v38 offset:2048
  v_accvgpr_read_b32 v243, a79
  v_mfma_f32_16x16x32_bf16 a[196:199], v[188:191], v[104:107], a[196:199]
  v_cvt_pk_bf16_f32 v248, v236, v237
  v_cvt_pk_bf16_f32 v249, v238, v239
  v_mfma_f32_16x16x32_bf16 a[196:199], v[156:159], v[108:111], a[196:199]
  v_cvt_pk_bf16_f32 v250, v240, v241
  v_cvt_pk_bf16_f32 v251, v242, v243
  v_mfma_f32_16x16x32_bf16 a[228:231], v[156:159], v[116:119], a[228:231]
  buffer_store_dwordx4 v[248:251], v52, s[28:31], s40 offen offset:1024 sc1
  v_accvgpr_read_b32 v236, a80
  v_mfma_f32_16x16x32_bf16 a[228:231], v[188:191], v[112:115], a[228:231]
  v_accvgpr_read_b32 v237, a81
  v_accvgpr_read_b32 v238, a82
  v_mfma_f32_16x16x32_bf16 a[224:227], v[184:187], v[112:115], a[224:227]
  v_accvgpr_read_b32 v239, a83
  v_accvgpr_read_b32 v240, a84
  v_mfma_f32_16x16x32_bf16 a[224:227], v[152:155], v[116:119], a[224:227]
  v_accvgpr_read_b32 v241, a85
  v_accvgpr_read_b32 v242, a86
  v_mfma_f32_16x16x32_bf16 a[192:195], v[152:155], v[108:111], a[192:195]
  v_accvgpr_read_b32 v243, a87
  v_cvt_pk_bf16_f32 v244, v236, v237
  v_mfma_f32_16x16x32_bf16 a[192:195], v[184:187], v[104:107], a[192:195]
  v_cvt_pk_bf16_f32 v245, v238, v239
  v_cvt_pk_bf16_f32 v246, v240, v241
  s_branch Lk_Q
Lk_V:
  s_lshl_b32 s40, s17, 20
  s_add_u32 s40, s40, 0x1000000
  s_lshl_b32 s41, s16, 17
  s_add_u32 s40, s40, s41
  s_lshl_b32 s41, s45, 16
  s_add_u32 s40, s40, s41
  s_lshl_b32 s41, s46, 13
  s_add_u32 s40, s40, s41
  s_mov_b32 s41, 4096
  s_mov_b32 s42, 12288
  s_mov_b32 s38, 0
  s_mov_b32 s43, s97
  s_waitcnt lgkmcnt(0)
  s_waitcnt vmcnt(12)
  s_barrier
  v_mfma_f32_16x16x32_bf16 a[0:3], v[56:59], v[216:219], 0
  s_add_u32 m0, s34, 0x1c000
  ds_read_b128 v[88:91], v14 offset:16384
  v_mfma_f32_16x16x32_bf16 a[0:3], v[60:63], v[120:123], a[0:3]
  buffer_load_dwordx4 v10, s[24:27], s37 offen offset:0 lds
  v_mfma_f32_16x16x32_bf16 a[4:7], v[68:71], v[120:123], 0
  ds_read_b64_tr_b16 v[184:185], v15 offset:16384
  v_mfma_f32_16x16x32_bf16 a[4:7], v[64:67], v[216:219], a[4:7]
  v_mfma_f32_16x16x32_bf16 a[12:15], v[64:67], v[220:223], 0
  buffer_load_dwordx4 v11, s[24:27], s37 offen offset:1024 lds
  v_mfma_f32_16x16x32_bf16 a[12:15], v[68:71], v[124:127], a[12:15]
  ds_read_b64_tr_b16 v[186:187], v15 offset:18432
  v_mfma_f32_16x16x32_bf16 a[8:11], v[60:63], v[124:127], 0
  v_mfma_f32_16x16x32_bf16 a[8:11], v[56:59], v[220:223], a[8:11]
  buffer_load_dwordx4 v12, s[24:27], s37 offen offset:2048 lds
  v_mfma_f32_16x16x32_bf16 a[16:19], v[56:59], v[224:227], 0
  ds_read_b128 v[92:95], v41 offset:16384
  v_mfma_f32_16x16x32_bf16 a[16:19], v[60:63], v[128:131], a[16:19]
  v_mfma_f32_16x16x32_bf16 a[20:23], v[68:71], v[128:131], 0
  buffer_load_dwordx4 v13, s[24:27], s37 offen offset:3072 lds
  v_mfma_f32_16x16x32_bf16 a[20:23], v[64:67], v[224:227], a[20:23]
  s_add_u32 s37, s37, 0x40000
  s_add_u32 m0, s34, 0x0
  ds_read_b64_tr_b16 v[188:189], v32 offset:16384
  v_mfma_f32_16x16x32_bf16 a[28:31], v[64:67], v[228:231], 0
  v_mfma_f32_16x16x32_bf16 a[28:31], v[68:71], v[132:135], a[28:31]
  buffer_load_dwordx4 v6, s[20:23], s36 offen offset:0 lds
  v_mfma_f32_16x16x32_bf16 a[24:27], v[60:63], v[132:135], 0
  ds_read_b64_tr_b16 v[190:191], v32 offset:18432
  v_mfma_f32_16x16x32_bf16 a[24:27], v[56:59], v[228:231], a[24:27]
  v_mfma_f32_16x16x32_bf16 a[32:35], v[56:59], v[236:239], 0
  buffer_load_dwordx4 v7, s[20:23], s36 offen offset:1024 lds
  v_mfma_f32_16x16x32_bf16 a[32:35], v[60:63], v[136:139], a[32:35]
  ds_read_b128 v[96:99], v14 offset:18432
  v_mfma_f32_16x16x32_bf16 a[36:39], v[68:71], v[136:139], 0
  v_mfma_f32_16x16x32_bf16 a[36:39], v[64:67], v[236:239], a[36:39]
  buffer_load_dwordx4 v8, s[20:23], s36 offen offset:2048 lds
  v_mfma_f32_16x16x32_bf16 a[44:47], v[64:67], v[240:243], 0
  ds_read_b64_tr_b16 v[192:193], v33 offset:16384
  v_mfma_f32_16x16x32_bf16 a[44:47], v[68:71], v[140:143], a[44:47]
  v_mfma_f32_16x16x32_bf16 a[40:43], v[60:63], v[140:143], 0
  buffer_load_dwordx4 v9, s[20:23], s36 offen offset:3072 lds
  v_mfma_f32_16x16x32_bf16 a[40:43], v[56:59], v[240:243], a[40:43]
  s_add_u32 s36, s36, 131072
  s_add_u32 m0, s34, 0x10000
  ds_read_b64_tr_b16 v[194:195], v33 offset:18432
  v_mfma_f32_16x16x32_bf16 a[48:51], v[56:59], v[244:247], 0
  v_mfma_f32_16x16x32_bf16 a[48:51], v[60:63], v[144:147], a[48:51]
  buffer_load_dwordx4 v10, s[24:27], s37 offen offset:0 lds
  v_mfma_f32_16x16x32_bf16 a[52:55], v[68:71], v[144:147], 0
  ds_read_b128 v[100:103], v41 offset:18432
  v_mfma_f32_16x16x32_bf16 a[52:55], v[64:67], v[244:247], a[52:55]
  v_mfma_f32_16x16x32_bf16 a[60:63], v[64:67], v[248:251], 0
  buffer_load_dwordx4 v11, s[24:27], s37 offen offset:1024 lds
  v_mfma_f32_16x16x32_bf16 a[60:63], v[68:71], v[148:151], a[60:63]
  ds_read_b64_tr_b16 v[196:197], v34 offset:16384
  v_mfma_f32_16x16x32_bf16 a[56:59], v[60:63], v[148:151], 0
  v_mfma_f32_16x16x32_bf16 a[56:59], v[56:59], v[248:251], a[56:59]
  buffer_load_dwordx4 v12, s[24:27], s37 offen offset:2048 lds
  v_mfma_f32_16x16x32_bf16 a[120:123], v[72:75], v[248:251], 0
  ds_read_b64_tr_b16 v[198:199], v34 offset:18432
  v_mfma_f32_16x16x32_bf16 a[120:123], v[76:79], v[148:151], a[120:123]
  v_mfma_f32_16x16x32_bf16 a[124:127], v[84:87], v[148:151], 0
  buffer_load_dwordx4 v13, s[24:27], s37 offen offset:3072 lds
  v_mfma_f32_16x16x32_bf16 a[124:127], v[80:83], v[248:251], a[124:127]
  s_add_u32 s37, s37, 0x40000
  ds_read_b128 v[104:107], v14 offset:20480
  v_mfma_f32_16x16x32_bf16 a[116:119], v[80:83], v[244:247], 0
  v_mfma_f32_16x16x32_bf16 a[116:119], v[84:87], v[144:147], a[116:119]
  ds_read_b64_tr_b16 v[200:201], v35 offset:16384
  v_mfma_f32_16x16x32_bf16 a[112:115], v[76:79], v[144:147], 0
  v_mfma_f32_16x16x32_bf16 a[112:115], v[72:75], v[244:247], a[112:115]
  ds_read_b64_tr_b16 v[202:203], v35 offset:18432
  v_mfma_f32_16x16x32_bf16 a[104:107], v[72:75], v[240:243], 0
  buffer_load_dword v25, v24, s[76:79], s39 offen
  v_mfma_f32_16x16x32_bf16 a[104:107], v[76:79], v[140:143], a[104:107]
  s_add_u32 s39, s39, s3
  s_mov_b32 m0, s43
  ds_read_b128 v[108:111], v41 offset:20480
  v_mfma_f32_16x16x32_bf16 a[108:111], v[84:87], v[140:143], 0
  buffer_load_dwordx4 v26, s[4:7], s9 offen lds
  v_mfma_f32_16x16x32_bf16 a[108:111], v[80:83], v[240:243], a[108:111]
  s_cmp_lt_u32 s38, 3
  s_cselect_b32 s33, s8, 0
  ds_read_b64_tr_b16 v[204:205], v36 offset:16384
  v_mfma_f32_16x16x32_bf16 a[100:103], v[80:83], v[236:239], 0
  s_add_u32 s9, s9, s33
  s_cmp_lt_u32 s38, 3
  s_cselect_b32 s33, 0x400, 0
  v_mfma_f32_16x16x32_bf16 a[100:103], v[84:87], v[136:139], a[100:103]
  s_add_u32 s43, s43, s33
  ds_read_b64_tr_b16 v[206:207], v36 offset:18432
  v_mfma_f32_16x16x32_bf16 a[96:99], v[76:79], v[136:139], 0
  v_mfma_f32_16x16x32_bf16 a[96:99], v[72:75], v[236:239], a[96:99]
  ds_read_b128 v[112:115], v14 offset:22528
  v_mfma_f32_16x16x32_bf16 a[88:91], v[72:75], v[228:231], 0
  v_mfma_f32_16x16x32_bf16 a[88:91], v[76:79], v[132:135], a[88:91]
  ds_read_b64_tr_b16 v[208:209], v37 offset:16384
  v_mfma_f32_16x16x32_bf16 a[92:95], v[84:87], v[132:135], 0
  v_mfma_f32_16x16x32_bf16 a[92:95], v[80:83], v[228:231], a[92:95]
  ds_read_b64_tr_b16 v[210:211], v37 offset:18432
  v_mfma_f32_16x16x32_bf16 a[84:87], v[80:83], v[224:227], 0
  v_mfma_f32_16x16x32_bf16 a[84:87], v[84:87], v[128:131], a[84:87]
  ds_read_b128 v[116:119], v41 offset:22528
  v_mfma_f32_16x16x32_bf16 a[80:83], v[76:79], v[128:131], 0
  v_mfma_f32_16x16x32_bf16 a[80:83], v[72:75], v[224:227], a[80:83]
  ds_read_b64_tr_b16 v[212:213], v38 offset:16384
  v_mfma_f32_16x16x32_bf16 a[72:75], v[72:75], v[220:223], 0
  v_mfma_f32_16x16x32_bf16 a[72:75], v[76:79], v[124:127], a[72:75]
  ds_read_b64_tr_b16 v[214:215], v38 offset:18432
  v_mfma_f32_16x16x32_bf16 a[76:79], v[84:87], v[124:127], 0
  v_mfma_f32_16x16x32_bf16 a[76:79], v[80:83], v[220:223], a[76:79]
  v_mfma_f32_16x16x32_bf16 a[68:71], v[80:83], v[216:219], 0
  v_mfma_f32_16x16x32_bf16 a[68:71], v[84:87], v[120:123], a[68:71]
  v_mfma_f32_16x16x32_bf16 a[64:67], v[76:79], v[120:123], 0
  v_mfma_f32_16x16x32_bf16 a[64:67], v[72:75], v[216:219], a[64:67]
  s_waitcnt lgkmcnt(0)
  s_waitcnt vmcnt(18)
  s_xor_b32 s32, s2, 56
  s_or_b32 s32, s32, s19
  s_cbranch_scc1 Lk_z16
  v_mov_b32 v2, 0
  v_lshlrev_b32 v3, 7, v1
  s_mov_b32 s32, 0x4f00000
  buffer_store_dword v2, v3, s[28:31], s32 offen sc1
  s_mov_b32 s32, 0x4f02000
  buffer_store_dword v2, v3, s[28:31], s32 offen sc1
  s_mov_b32 s32, 0x4f04000
  buffer_store_dword v2, v3, s[28:31], s32 offen sc1
  s_mov_b32 s32, 0x4f06000
  buffer_store_dword v2, v3, s[28:31], s32 offen sc1
  v_mov_b32 v20, 0
  v_mov_b32 v21, 0
  v_mov_b32 v22, 0
  v_mov_b32 v23, 0
  s_mov_b32 s32, 0x4f06000
  buffer_store_dwordx4 v[20:23], v52, s[28:31], s32 offen offset:0 sc1
  buffer_store_dwordx4 v[20:23], v52, s[28:31], s32 offen offset:1024 sc1
  buffer_store_dwordx4 v[20:23], v52, s[28:31], s32 offen offset:2048 sc1
  v_min_u32 v3, 56, v1
  v_mul_u32_u24 v3, 32896, v3
  s_mov_b32 s32, 0x4800000
  buffer_store_dwordx4 v[20:23], v3, s[28:31], s32 offen offset:0 sc1
  buffer_store_dwordx4 v[20:23], v3, s[28:31], s32 offen offset:16 sc1
  buffer_store_dwordx4 v[20:23], v3, s[28:31], s32 offen offset:96 sc1
  buffer_store_dwordx4 v[20:23], v3, s[28:31], s32 offen offset:112 sc1
Lk_z16:
  s_barrier
  v_mfma_f32_16x16x32_bf16 a[128:131], v[88:91], v[216:219], 0
  s_add_u32 m0, s34, 0x4000
  ds_read_b128 v[56:59], v14 offset:32768
  v_mfma_f32_16x16x32_bf16 a[128:131], v[92:95], v[120:123], a[128:131]
  v_mfma_f32_16x16x32_bf16 a[132:135], v[100:103], v[120:123], 0
  ds_read_b64_tr_b16 v[152:153], v15 offset:32768
  v_mfma_f32_16x16x32_bf16 a[132:135], v[96:99], v[216:219], a[132:135]
  v_mfma_f32_16x16x32_bf16 a[140:143], v[96:99], v[220:223], 0
  ds_read_b64_tr_b16 v[154:155], v15 offset:34816
  v_mfma_f32_16x16x32_bf16 a[140:143], v[100:103], v[124:127], a[140:143]
  v_mfma_f32_16x16x32_bf16 a[136:139], v[92:95], v[124:127], 0
  ds_read_b128 v[60:63], v41 offset:32768
  v_mfma_f32_16x16x32_bf16 a[136:139], v[88:91], v[220:223], a[136:139]
  v_mfma_f32_16x16x32_bf16 a[144:147], v[88:91], v[224:227], 0
  ds_read_b64_tr_b16 v[156:157], v32 offset:32768
  v_mfma_f32_16x16x32_bf16 a[144:147], v[92:95], v[128:131], a[144:147]
  v_mfma_f32_16x16x32_bf16 a[148:151], v[100:103], v[128:131], 0
  ds_read_b64_tr_b16 v[158:159], v32 offset:34816
  v_mfma_f32_16x16x32_bf16 a[148:151], v[96:99], v[224:227], a[148:151]
  v_mfma_f32_16x16x32_bf16 a[156:159], v[96:99], v[228:231], 0
  ds_read_b128 v[64:67], v14 offset:34816
  v_mfma_f32_16x16x32_bf16 a[156:159], v[100:103], v[132:135], a[156:159]
  v_mfma_f32_16x16x32_bf16 a[152:155], v[92:95], v[132:135], 0
  ds_read_b64_tr_b16 v[160:161], v33 offset:32768
  v_mfma_f32_16x16x32_bf16 a[152:155], v[88:91], v[228:231], a[152:155]
  v_mfma_f32_16x16x32_bf16 a[160:163], v[88:91], v[236:239], 0
  ds_read_b64_tr_b16 v[162:163], v33 offset:34816
  v_mfma_f32_16x16x32_bf16 a[160:163], v[92:95], v[136:139], a[160:163]
  v_mfma_f32_16x16x32_bf16 a[164:167], v[100:103], v[136:139], 0
  ds_read_b128 v[68:71], v41 offset:34816
  v_mfma_f32_16x16x32_bf16 a[164:167], v[96:99], v[236:239], a[164:167]
  v_mfma_f32_16x16x32_bf16 a[172:175], v[96:99], v[240:243], 0
  ds_read_b64_tr_b16 v[164:165], v34 offset:32768
  v_mfma_f32_16x16x32_bf16 a[172:175], v[100:103], v[140:143], a[172:175]
  v_mfma_f32_16x16x32_bf16 a[168:171], v[92:95], v[140:143], 0
  ds_read_b64_tr_b16 v[166:167], v34 offset:34816
  v_mfma_f32_16x16x32_bf16 a[168:171], v[88:91], v[240:243], a[168:171]
  v_mfma_f32_16x16x32_bf16 a[176:179], v[88:91], v[244:247], 0
  ds_read_b128 v[72:75], v14 offset:36864
  v_mfma_f32_16x16x32_bf16 a[176:179], v[92:95], v[144:147], a[176:179]
  v_mfma_f32_16x16x32_bf16 a[180:183], v[100:103], v[144:147], 0
  ds_read_b64_tr_b16 v[168:169], v35 offset:32768
  v_mfma_f32_16x16x32_bf16 a[180:183], v[96:99], v[244:247], a[180:183]
  v_mfma_f32_16x16x32_bf16 a[188:191], v[96:99], v[248:251], 0
  ds_read_b64_tr_b16 v[170:171], v35 offset:34816
  v_mfma_f32_16x16x32_bf16 a[188:191], v[100:103], v[148:151], a[188:191]
  v_mfma_f32_16x16x32_bf16 a[184:187], v[92:95], v[148:151], 0
  ds_read_b128 v[76:79], v41 offset:36864
  v_mfma_f32_16x16x32_bf16 a[184:187], v[88:91], v[248:251], a[184:187]
  v_mfma_f32_16x16x32_bf16 a[248:251], v[104:107], v[248:251], 0
  ds_read_b64_tr_b16 v[172:173], v36 offset:32768
  v_mfma_f32_16x16x32_bf16 a[248:251], v[108:111], v[148:151], a[248:251]
  v_mfma_f32_16x16x32_bf16 a[252:255], v[116:119], v[148:151], 0
  ds_read_b64_tr_b16 v[174:175], v36 offset:34816
  v_mfma_f32_16x16x32_bf16 a[252:255], v[112:115], v[248:251], a[252:255]
  v_mfma_f32_16x16x32_bf16 a[244:247], v[112:115], v[244:247], 0
  ds_read_b128 v[80:83], v14 offset:38912
  v_mfma_f32_16x16x32_bf16 a[244:247], v[116:119], v[144:147], a[244:247]
  v_mfma_f32_16x16x32_bf16 a[240:243], v[108:111], v[144:147], 0
  ds_read_b64_tr_b16 v[176:177], v37 offset:32768
  v_mfma_f32_16x16x32_bf16 a[240:243], v[104:107], v[244:247], a[240:243]
  v_mfma_f32_16x16x32_bf16 a[232:235], v[104:107], v[240:243], 0
  ds_read_b64_tr_b16 v[178:179], v37 offset:34816
  v_mfma_f32_16x16x32_bf16 a[232:235], v[108:111], v[140:143], a[232:235]
  v_mfma_f32_16x16x32_bf16 a[236:239], v[116:119], v[140:143], 0
  ds_read_b128 v[84:87], v41 offset:38912
  v_mfma_f32_16x16x32_bf16 a[236:239], v[112:115], v[240:243], a[236:239]
  v_mfma_f32_16x16x32_bf16 a[228:231], v[112:115], v[236:239], 0
  ds_read_b64_tr_b16 v[180:181], v38 offset:32768
  v_mfma_f32_16x16x32_bf16 a[228:231], v[116:119], v[136:139], a[228:231]
  v_mfma_f32_16x16x32_bf16 a[224:227], v[108:111], v[136:139], 0
  ds_read_b64_tr_b16 v[182:183], v38 offset:34816
  v_mfma_f32_16x16x32_bf16 a[224:227], v[104:107], v[236:239], a[224:227]
  v_mfma_f32_16x16x32_bf16 a[216:219], v[104:107], v[228:231], 0
  v_mfma_f32_16x16x32_bf16 a[216:219], v[108:111], v[132:135], a[216:219]
  v_mfma_f32_16x16x32_bf16 a[220:223], v[116:119], v[132:135], 0
  v_mfma_f32_16x16x32_bf16 a[220:223], v[112:115], v[228:231], a[220:223]
  v_mfma_f32_16x16x32_bf16 a[212:215], v[112:115], v[224:227], 0
  v_mfma_f32_16x16x32_bf16 a[212:215], v[116:119], v[128:131], a[212:215]
  v_mfma_f32_16x16x32_bf16 a[208:211], v[108:111], v[128:131], 0
  v_mfma_f32_16x16x32_bf16 a[208:211], v[104:107], v[224:227], a[208:211]
  v_mfma_f32_16x16x32_bf16 a[200:203], v[104:107], v[220:223], 0
  v_mfma_f32_16x16x32_bf16 a[200:203], v[108:111], v[124:127], a[200:203]
  v_mfma_f32_16x16x32_bf16 a[204:207], v[116:119], v[124:127], 0
  v_mfma_f32_16x16x32_bf16 a[204:207], v[112:115], v[220:223], a[204:207]
  v_mfma_f32_16x16x32_bf16 a[196:199], v[112:115], v[216:219], 0
  v_mfma_f32_16x16x32_bf16 a[196:199], v[116:119], v[120:123], a[196:199]
  v_mfma_f32_16x16x32_bf16 a[192:195], v[108:111], v[120:123], 0
  v_mfma_f32_16x16x32_bf16 a[192:195], v[104:107], v[216:219], a[192:195]
  s_waitcnt lgkmcnt(0)
  s_waitcnt vmcnt(10)
  s_barrier
  v_mfma_f32_16x16x32_bf16 a[0:3], v[56:59], v[184:187], a[0:3]
  ds_read_b128 v[88:91], v14 offset:49152
  v_mfma_f32_16x16x32_bf16 a[0:3], v[60:63], v[152:155], a[0:3]
  v_mfma_f32_16x16x32_bf16 a[4:7], v[68:71], v[152:155], a[4:7]
  ds_read_b64_tr_b16 v[216:217], v15 offset:49152
  v_mfma_f32_16x16x32_bf16 a[4:7], v[64:67], v[184:187], a[4:7]
  v_mfma_f32_16x16x32_bf16 a[12:15], v[64:67], v[188:191], a[12:15]
  ds_read_b64_tr_b16 v[218:219], v15 offset:51200
  v_mfma_f32_16x16x32_bf16 a[12:15], v[68:71], v[156:159], a[12:15]
  v_mfma_f32_16x16x32_bf16 a[8:11], v[60:63], v[156:159], a[8:11]
  ds_read_b128 v[92:95], v41 offset:49152
  v_mfma_f32_16x16x32_bf16 a[8:11], v[56:59], v[188:191], a[8:11]
  v_mfma_f32_16x16x32_bf16 a[16:19], v[56:59], v[192:195], a[16:19]
  ds_read_b64_tr_b16 v[220:221], v32 offset:49152
  v_mfma_f32_16x16x32_bf16 a[16:19], v[60:63], v[160:163], a[16:19]
  v_mfma_f32_16x16x32_bf16 a[20:23], v[68:71], v[160:163], a[20:23]
  ds_read_b64_tr_b16 v[222:223], v32 offset:51200
  v_mfma_f32_16x16x32_bf16 a[20:23], v[64:67], v[192:195], a[20:23]
  v_mfma_f32_16x16x32_bf16 a[28:31], v[64:67], v[196:199], a[28:31]
  buffer_load_dwordx4 v6, s[20:23], s36 offen offset:0 lds
  v_mfma_f32_16x16x32_bf16 a[28:31], v[68:71], v[164:167], a[28:31]
  ds_read_b128 v[96:99], v14 offset:51200
  v_mfma_f32_16x16x32_bf16 a[24:27], v[60:63], v[164:167], a[24:27]
  v_mfma_f32_16x16x32_bf16 a[24:27], v[56:59], v[196:199], a[24:27]
  ds_read_b64_tr_b16 v[224:225], v33 offset:49152
  v_mfma_f32_16x16x32_bf16 a[32:35], v[56:59], v[200:203], a[32:35]
  buffer_load_dwordx4 v7, s[20:23], s36 offen offset:1024 lds
  v_mfma_f32_16x16x32_bf16 a[32:35], v[60:63], v[168:171], a[32:35]
  ds_read_b64_tr_b16 v[226:227], v33 offset:51200
  v_mfma_f32_16x16x32_bf16 a[36:39], v[68:71], v[168:171], a[36:39]
  v_mfma_f32_16x16x32_bf16 a[36:39], v[64:67], v[200:203], a[36:39]
  ds_read_b128 v[100:103], v41 offset:51200
  v_mfma_f32_16x16x32_bf16 a[44:47], v[64:67], v[204:207], a[44:47]
  buffer_load_dwordx4 v8, s[20:23], s36 offen offset:2048 lds
  v_mfma_f32_16x16x32_bf16 a[44:47], v[68:71], v[172:175], a[44:47]
  ds_read_b64_tr_b16 v[228:229], v34 offset:49152
  v_mfma_f32_16x16x32_bf16 a[40:43], v[60:63], v[172:175], a[40:43]
  v_mfma_f32_16x16x32_bf16 a[40:43], v[56:59], v[204:207], a[40:43]
  ds_read_b64_tr_b16 v[230:231], v34 offset:51200
  v_mfma_f32_16x16x32_bf16 a[48:51], v[56:59], v[208:211], a[48:51]
  buffer_load_dwordx4 v9, s[20:23], s36 offen offset:3072 lds
  v_mfma_f32_16x16x32_bf16 a[48:51], v[60:63], v[176:179], a[48:51]
  s_sub_u32 s36, s36, 130944
  s_add_u32 m0, s34, 0x14000
  ds_read_b128 v[104:107], v14 offset:53248
  v_mfma_f32_16x16x32_bf16 a[52:55], v[68:71], v[176:179], a[52:55]
  v_mfma_f32_16x16x32_bf16 a[52:55], v[64:67], v[208:211], a[52:55]
  ds_read_b64_tr_b16 v[236:237], v35 offset:49152
  v_mfma_f32_16x16x32_bf16 a[60:63], v[64:67], v[212:215], a[60:63]
  buffer_load_dwordx4 v10, s[24:27], s37 offen offset:0 lds
  v_mfma_f32_16x16x32_bf16 a[60:63], v[68:71], v[180:183], a[60:63]
  ds_read_b64_tr_b16 v[238:239], v35 offset:51200
  v_mfma_f32_16x16x32_bf16 a[56:59], v[60:63], v[180:183], a[56:59]
  v_mfma_f32_16x16x32_bf16 a[56:59], v[56:59], v[212:215], a[56:59]
  ds_read_b128 v[108:111], v41 offset:53248
  v_mfma_f32_16x16x32_bf16 a[120:123], v[72:75], v[212:215], a[120:123]
  buffer_load_dwordx4 v11, s[24:27], s37 offen offset:1024 lds
  v_mfma_f32_16x16x32_bf16 a[120:123], v[76:79], v[180:183], a[120:123]
  ds_read_b64_tr_b16 v[240:241], v36 offset:49152
  v_mfma_f32_16x16x32_bf16 a[124:127], v[84:87], v[180:183], a[124:127]
  v_mfma_f32_16x16x32_bf16 a[124:127], v[80:83], v[212:215], a[124:127]
  ds_read_b64_tr_b16 v[242:243], v36 offset:51200
  v_mfma_f32_16x16x32_bf16 a[116:119], v[80:83], v[208:211], a[116:119]
  buffer_load_dwordx4 v12, s[24:27], s37 offen offset:2048 lds
  v_mfma_f32_16x16x32_bf16 a[116:119], v[84:87], v[176:179], a[116:119]
  ds_read_b128 v[112:115], v14 offset:55296
  v_mfma_f32_16x16x32_bf16 a[112:115], v[76:79], v[176:179], a[112:115]
  v_mfma_f32_16x16x32_bf16 a[112:115], v[72:75], v[208:211], a[112:115]
  ds_read_b64_tr_b16 v[244:245], v37 offset:49152
  v_mfma_f32_16x16x32_bf16 a[104:107], v[72:75], v[204:207], a[104:107]
  buffer_load_dwordx4 v13, s[24:27], s37 offen offset:3072 lds
  v_mfma_f32_16x16x32_bf16 a[104:107], v[76:79], v[172:175], a[104:107]
  s_add_u32 s37, s37, 0x40000
  s_add_u32 m0, s34, 0x8000
  ds_read_b64_tr_b16 v[246:247], v37 offset:51200
  v_mfma_f32_16x16x32_bf16 a[108:111], v[84:87], v[172:175], a[108:111]
  v_mfma_f32_16x16x32_bf16 a[108:111], v[80:83], v[204:207], a[108:111]
  ds_read_b128 v[116:119], v41 offset:55296
  v_mfma_f32_16x16x32_bf16 a[100:103], v[80:83], v[200:203], a[100:103]
  buffer_load_dwordx4 v6, s[20:23], s36 offen offset:0 lds
  v_mfma_f32_16x16x32_bf16 a[100:103], v[84:87], v[168:171], a[100:103]
  ds_read_b64_tr_b16 v[248:249], v38 offset:49152
  v_mfma_f32_16x16x32_bf16 a[96:99], v[76:79], v[168:171], a[96:99]
  v_mfma_f32_16x16x32_bf16 a[96:99], v[72:75], v[200:203], a[96:99]
  ds_read_b64_tr_b16 v[250:251], v38 offset:51200
  v_mfma_f32_16x16x32_bf16 a[88:91], v[72:75], v[196:199], a[88:91]
  buffer_load_dwordx4 v7, s[20:23], s36 offen offset:1024 lds
  v_mfma_f32_16x16x32_bf16 a[88:91], v[76:79], v[164:167], a[88:91]
  v_mfma_f32_16x16x32_bf16 a[92:95], v[84:87], v[164:167], a[92:95]
  v_mfma_f32_16x16x32_bf16 a[92:95], v[80:83], v[196:199], a[92:95]
  v_mfma_f32_16x16x32_bf16 a[84:87], v[80:83], v[192:195], a[84:87]
  buffer_load_dwordx4 v8, s[20:23], s36 offen offset:2048 lds
  v_mfma_f32_16x16x32_bf16 a[84:87], v[84:87], v[160:163], a[84:87]
  v_mfma_f32_16x16x32_bf16 a[80:83], v[76:79], v[160:163], a[80:83]
  v_mfma_f32_16x16x32_bf16 a[80:83], v[72:75], v[192:195], a[80:83]
  v_mfma_f32_16x16x32_bf16 a[72:75], v[72:75], v[188:191], a[72:75]
  buffer_load_dwordx4 v9, s[20:23], s36 offen offset:3072 lds
  v_mfma_f32_16x16x32_bf16 a[72:75], v[76:79], v[156:159], a[72:75]
  s_add_u32 s36, s36, 131072
  s_add_u32 m0, s34, 0x18000
  v_mfma_f32_16x16x32_bf16 a[76:79], v[84:87], v[156:159], a[76:79]
  v_mfma_f32_16x16x32_bf16 a[76:79], v[80:83], v[188:191], a[76:79]
  v_mfma_f32_16x16x32_bf16 a[68:71], v[80:83], v[184:187], a[68:71]
  v_mfma_f32_16x16x32_bf16 a[68:71], v[84:87], v[152:155], a[68:71]
  v_mfma_f32_16x16x32_bf16 a[64:67], v[76:79], v[152:155], a[64:67]
  v_mfma_f32_16x16x32_bf16 a[64:67], v[72:75], v[184:187], a[64:67]
  s_waitcnt lgkmcnt(0)
  s_waitcnt vmcnt(14)
  s_barrier
  v_mfma_f32_16x16x32_bf16 a[128:131], v[88:91], v[184:187], a[128:131]
  ds_read_b128 v[56:59], v14 offset:0
  v_mfma_f32_16x16x32_bf16 a[128:131], v[92:95], v[152:155], a[128:131]
  buffer_load_dwordx4 v10, s[24:27], s37 offen offset:0 lds
  v_mfma_f32_16x16x32_bf16 a[132:135], v[100:103], v[152:155], a[132:135]
  ds_read_b64_tr_b16 v[120:121], v15 offset:0
  v_mfma_f32_16x16x32_bf16 a[132:135], v[96:99], v[184:187], a[132:135]
  v_mfma_f32_16x16x32_bf16 a[140:143], v[96:99], v[188:191], a[140:143]
  ds_read_b64_tr_b16 v[122:123], v15 offset:2048
  v_mfma_f32_16x16x32_bf16 a[140:143], v[100:103], v[156:159], a[140:143]
  v_mfma_f32_16x16x32_bf16 a[136:139], v[92:95], v[156:159], a[136:139]
  buffer_load_dwordx4 v11, s[24:27], s37 offen offset:1024 lds
  v_mfma_f32_16x16x32_bf16 a[136:139], v[88:91], v[188:191], a[136:139]
  ds_read_b128 v[60:63], v41 offset:0
  v_mfma_f32_16x16x32_bf16 a[144:147], v[88:91], v[192:195], a[144:147]
  v_mfma_f32_16x16x32_bf16 a[144:147], v[92:95], v[160:163], a[144:147]
  ds_read_b64_tr_b16 v[124:125], v32 offset:0
  v_mfma_f32_16x16x32_bf16 a[148:151], v[100:103], v[160:163], a[148:151]
  v_mfma_f32_16x16x32_bf16 a[148:151], v[96:99], v[192:195], a[148:151]
  buffer_load_dwordx4 v12, s[24:27], s37 offen offset:2048 lds
  v_mfma_f32_16x16x32_bf16 a[156:159], v[96:99], v[196:199], a[156:159]
  ds_read_b64_tr_b16 v[126:127], v32 offset:2048
  v_mfma_f32_16x16x32_bf16 a[156:159], v[100:103], v[164:167], a[156:159]
  v_mfma_f32_16x16x32_bf16 a[152:155], v[92:95], v[164:167], a[152:155]
  ds_read_b128 v[64:67], v14 offset:2048
  v_mfma_f32_16x16x32_bf16 a[152:155], v[88:91], v[196:199], a[152:155]
  v_mfma_f32_16x16x32_bf16 a[160:163], v[88:91], v[200:203], a[160:163]
  buffer_load_dwordx4 v13, s[24:27], s37 offen offset:3072 lds
  v_mfma_f32_16x16x32_bf16 a[160:163], v[92:95], v[168:171], a[160:163]
  s_add_u32 s37, s37, 0x40000
  s_add_u32 m0, s34, 0xc000
  ds_read_b64_tr_b16 v[128:129], v33 offset:0
  v_mfma_f32_16x16x32_bf16 a[164:167], v[100:103], v[168:171], a[164:167]
  v_mfma_f32_16x16x32_bf16 a[164:167], v[96:99], v[200:203], a[164:167]
  ds_read_b64_tr_b16 v[130:131], v33 offset:2048
  v_mfma_f32_16x16x32_bf16 a[172:175], v[96:99], v[204:207], a[172:175]
  v_mfma_f32_16x16x32_bf16 a[172:175], v[100:103], v[172:175], a[172:175]
  buffer_load_dwordx4 v6, s[20:23], s36 offen offset:0 lds
  v_mfma_f32_16x16x32_bf16 a[168:171], v[92:95], v[172:175], a[168:171]
  ds_read_b128 v[68:71], v41 offset:2048
  v_mfma_f32_16x16x32_bf16 a[168:171], v[88:91], v[204:207], a[168:171]
  v_mfma_f32_16x16x32_bf16 a[176:179], v[88:91], v[208:211], a[176:179]
  ds_read_b64_tr_b16 v[132:133], v34 offset:0
  v_mfma_f32_16x16x32_bf16 a[176:179], v[92:95], v[176:179], a[176:179]
  v_mfma_f32_16x16x32_bf16 a[180:183], v[100:103], v[176:179], a[180:183]
  buffer_load_dwordx4 v7, s[20:23], s36 offen offset:1024 lds
  v_mfma_f32_16x16x32_bf16 a[180:183], v[96:99], v[208:211], a[180:183]
  ds_read_b64_tr_b16 v[134:135], v34 offset:2048
  v_mfma_f32_16x16x32_bf16 a[188:191], v[96:99], v[212:215], a[188:191]
  v_mfma_f32_16x16x32_bf16 a[188:191], v[100:103], v[180:183], a[188:191]
  ds_read_b128 v[72:75], v14 offset:4096
  v_mfma_f32_16x16x32_bf16 a[184:187], v[92:95], v[180:183], a[184:187]
  v_mfma_f32_16x16x32_bf16 a[184:187], v[88:91], v[212:215], a[184:187]
  buffer_load_dwordx4 v8, s[20:23], s36 offen offset:2048 lds
  v_mfma_f32_16x16x32_bf16 a[248:251], v[104:107], v[212:215], a[248:251]
  ds_read_b64_tr_b16 v[136:137], v35 offset:0
  v_mfma_f32_16x16x32_bf16 a[248:251], v[108:111], v[180:183], a[248:251]
  v_mfma_f32_16x16x32_bf16 a[252:255], v[116:119], v[180:183], a[252:255]
  ds_read_b64_tr_b16 v[138:139], v35 offset:2048
  v_mfma_f32_16x16x32_bf16 a[252:255], v[112:115], v[212:215], a[252:255]
  v_mfma_f32_16x16x32_bf16 a[244:247], v[112:115], v[208:211], a[244:247]
  buffer_load_dwordx4 v9, s[20:23], s36 offen offset:3072 lds
  v_mfma_f32_16x16x32_bf16 a[244:247], v[116:119], v[176:179], a[244:247]
  s_sub_u32 s36, s36, 130944
  s_add_u32 m0, s34, 0x1c000
  ds_read_b128 v[76:79], v41 offset:4096
  v_mfma_f32_16x16x32_bf16 a[240:243], v[108:111], v[176:179], a[240:243]
  v_mfma_f32_16x16x32_bf16 a[240:243], v[104:107], v[208:211], a[240:243]
  ds_read_b64_tr_b16 v[140:141], v36 offset:0
  v_mfma_f32_16x16x32_bf16 a[232:235], v[104:107], v[204:207], a[232:235]
  v_mfma_f32_16x16x32_bf16 a[232:235], v[108:111], v[172:175], a[232:235]
  buffer_load_dwordx4 v10, s[24:27], s37 offen offset:0 lds
  v_mfma_f32_16x16x32_bf16 a[236:239], v[116:119], v[172:175], a[236:239]
  ds_read_b64_tr_b16 v[142:143], v36 offset:2048
  v_mfma_f32_16x16x32_bf16 a[236:239], v[112:115], v[204:207], a[236:239]
  v_mfma_f32_16x16x32_bf16 a[228:231], v[112:115], v[200:203], a[228:231]
  ds_read_b128 v[80:83], v14 offset:6144
  v_mfma_f32_16x16x32_bf16 a[228:231], v[116:119], v[168:171], a[228:231]
  v_mfma_f32_16x16x32_bf16 a[224:227], v[108:111], v[168:171], a[224:227]
  buffer_load_dwordx4 v11, s[24:27], s37 offen offset:1024 lds
  v_mfma_f32_16x16x32_bf16 a[224:227], v[104:107], v[200:203], a[224:227]
  ds_read_b64_tr_b16 v[144:145], v37 offset:0
  v_mfma_f32_16x16x32_bf16 a[216:219], v[104:107], v[196:199], a[216:219]
  v_mfma_f32_16x16x32_bf16 a[216:219], v[108:111], v[164:167], a[216:219]
  ds_read_b64_tr_b16 v[146:147], v37 offset:2048
  v_mfma_f32_16x16x32_bf16 a[220:223], v[116:119], v[164:167], a[220:223]
  v_mfma_f32_16x16x32_bf16 a[220:223], v[112:115], v[196:199], a[220:223]
  buffer_load_dwordx4 v12, s[24:27], s37 offen offset:2048 lds
  v_mfma_f32_16x16x32_bf16 a[212:215], v[112:115], v[192:195], a[212:215]
  ds_read_b128 v[84:87], v41 offset:6144
  v_mfma_f32_16x16x32_bf16 a[212:215], v[116:119], v[160:163], a[212:215]
  v_mfma_f32_16x16x32_bf16 a[208:211], v[108:111], v[160:163], a[208:211]
  ds_read_b64_tr_b16 v[148:149], v38 offset:0
  v_mfma_f32_16x16x32_bf16 a[208:211], v[104:107], v[192:195], a[208:211]
  v_mfma_f32_16x16x32_bf16 a[200:203], v[104:107], v[188:191], a[200:203]
  buffer_load_dwordx4 v13, s[24:27], s37 offen offset:3072 lds
  v_mfma_f32_16x16x32_bf16 a[200:203], v[108:111], v[156:159], a[200:203]
  s_add_u32 s37, s37, 0x40000
  ds_read_b64_tr_b16 v[150:151], v38 offset:2048
  v_mfma_f32_16x16x32_bf16 a[204:207], v[116:119], v[156:159], a[204:207]
  v_mfma_f32_16x16x32_bf16 a[204:207], v[112:115], v[188:191], a[204:207]
  v_mfma_f32_16x16x32_bf16 a[196:199], v[112:115], v[184:187], a[196:199]
  v_mfma_f32_16x16x32_bf16 a[196:199], v[116:119], v[152:155], a[196:199]
  v_mfma_f32_16x16x32_bf16 a[192:195], v[108:111], v[152:155], a[192:195]
  v_mfma_f32_16x16x32_bf16 a[192:195], v[104:107], v[184:187], a[192:195]
  s_mov_b32 s38, 1
  s_add_u32 s32, s97, 4096
.p2align 6
Lk_loop1:
  s_waitcnt lgkmcnt(0)
  s_waitcnt vmcnt(16)
  s_barrier
  v_mfma_f32_16x16x32_bf16 a[0:3], v[56:59], v[216:219], a[0:3]
  s_add_u32 m0, s34, 0x0
  ds_read_b128 v[88:91], v14 offset:16384
  v_mfma_f32_16x16x32_bf16 a[0:3], v[60:63], v[120:123], a[0:3]
  buffer_load_dwordx4 v6, s[20:23], s36 offen offset:0 lds
  v_mfma_f32_16x16x32_bf16 a[4:7], v[68:71], v[120:123], a[4:7]
  ds_read_b64_tr_b16 v[184:185], v15 offset:16384
  v_mfma_f32_16x16x32_bf16 a[4:7], v[64:67], v[216:219], a[4:7]
  v_mfma_f32_16x16x32_bf16 a[12:15], v[64:67], v[220:223], a[12:15]
  buffer_load_dwordx4 v7, s[20:23], s36 offen offset:1024 lds
  v_mfma_f32_16x16x32_bf16 a[12:15], v[68:71], v[124:127], a[12:15]
  ds_read_b64_tr_b16 v[186:187], v15 offset:18432
  v_mfma_f32_16x16x32_bf16 a[8:11], v[60:63], v[124:127], a[8:11]
  v_mfma_f32_16x16x32_bf16 a[8:11], v[56:59], v[220:223], a[8:11]
  buffer_load_dwordx4 v8, s[20:23], s36 offen offset:2048 lds
  v_mfma_f32_16x16x32_bf16 a[16:19], v[56:59], v[224:227], a[16:19]
  ds_read_b128 v[92:95], v41 offset:16384
  v_mfma_f32_16x16x32_bf16 a[16:19], v[60:63], v[128:131], a[16:19]
  v_mfma_f32_16x16x32_bf16 a[20:23], v[68:71], v[128:131], a[20:23]
  buffer_load_dwordx4 v9, s[20:23], s36 offen offset:3072 lds
  v_mfma_f32_16x16x32_bf16 a[20:23], v[64:67], v[224:227], a[20:23]
  s_add_u32 s36, s36, 131072
  s_add_u32 m0, s34, 0x10000
  ds_read_b64_tr_b16 v[188:189], v32 offset:16384
  v_mfma_f32_16x16x32_bf16 a[28:31], v[64:67], v[228:231], a[28:31]
  v_mfma_f32_16x16x32_bf16 a[28:31], v[68:71], v[132:135], a[28:31]
  buffer_load_dwordx4 v10, s[24:27], s37 offen offset:0 lds
  v_mfma_f32_16x16x32_bf16 a[24:27], v[60:63], v[132:135], a[24:27]
  ds_read_b64_tr_b16 v[190:191], v32 offset:18432
  v_mfma_f32_16x16x32_bf16 a[24:27], v[56:59], v[228:231], a[24:27]
  v_mfma_f32_16x16x32_bf16 a[32:35], v[56:59], v[236:239], a[32:35]
  buffer_load_dwordx4 v11, s[24:27], s37 offen offset:1024 lds
  v_mfma_f32_16x16x32_bf16 a[32:35], v[60:63], v[136:139], a[32:35]
  ds_read_b128 v[96:99], v14 offset:18432
  v_mfma_f32_16x16x32_bf16 a[36:39], v[68:71], v[136:139], a[36:39]
  v_mfma_f32_16x16x32_bf16 a[36:39], v[64:67], v[236:239], a[36:39]
  buffer_load_dwordx4 v12, s[24:27], s37 offen offset:2048 lds
  v_mfma_f32_16x16x32_bf16 a[44:47], v[64:67], v[240:243], a[44:47]
  ds_read_b64_tr_b16 v[192:193], v33 offset:16384
  v_mfma_f32_16x16x32_bf16 a[44:47], v[68:71], v[140:143], a[44:47]
  v_mfma_f32_16x16x32_bf16 a[40:43], v[60:63], v[140:143], a[40:43]
  buffer_load_dwordx4 v13, s[24:27], s37 offen offset:3072 lds
  v_mfma_f32_16x16x32_bf16 a[40:43], v[56:59], v[240:243], a[40:43]
  s_add_u32 s37, s37, 0x40000
  ds_read_b64_tr_b16 v[194:195], v33 offset:18432
  v_mfma_f32_16x16x32_bf16 a[48:51], v[56:59], v[244:247], a[48:51]
  v_mfma_f32_16x16x32_bf16 a[48:51], v[60:63], v[144:147], a[48:51]
  ds_read_b128 v[100:103], v41 offset:18432
  v_mfma_f32_16x16x32_bf16 a[52:55], v[68:71], v[144:147], a[52:55]
  v_mfma_f32_16x16x32_bf16 a[52:55], v[64:67], v[244:247], a[52:55]
  ds_read_b64_tr_b16 v[196:197], v34 offset:16384
  v_mfma_f32_16x16x32_bf16 a[60:63], v[64:67], v[248:251], a[60:63]
  buffer_load_dword v25, v24, s[76:79], s39 offen
  v_mfma_f32_16x16x32_bf16 a[60:63], v[68:71], v[148:151], a[60:63]
  s_add_u32 s39, s39, s3
  s_mov_b32 m0, s43
  ds_read_b64_tr_b16 v[198:199], v34 offset:18432
  v_mfma_f32_16x16x32_bf16 a[56:59], v[60:63], v[148:151], a[56:59]
  buffer_load_dwordx4 v26, s[4:7], s9 offen lds
  v_mfma_f32_16x16x32_bf16 a[56:59], v[56:59], v[248:251], a[56:59]
  s_cmp_lt_u32 s38, 3
  s_cselect_b32 s33, s8, 0
  ds_read_b128 v[104:107], v14 offset:20480
  v_mfma_f32_16x16x32_bf16 a[120:123], v[72:75], v[248:251], a[120:123]
  s_add_u32 s9, s9, s33
  s_cmp_lt_u32 s38, 3
  s_cselect_b32 s33, 0x400, 0
  v_mfma_f32_16x16x32_bf16 a[120:123], v[76:79], v[148:151], a[120:123]
  s_add_u32 s43, s43, s33
  s_mov_b32 m0, s32
  ds_read_b64_tr_b16 v[200:201], v35 offset:16384
  v_mfma_f32_16x16x32_bf16 a[124:127], v[84:87], v[148:151], a[124:127]
  buffer_load_dwordx4 v27, s[64:67], s73 offen lds
  v_mfma_f32_16x16x32_bf16 a[124:127], v[80:83], v[248:251], a[124:127]
  s_cmp_ge_u32 s38, 2
  s_cselect_b32 s33, s72, 0
  ds_read_b64_tr_b16 v[202:203], v35 offset:18432
  v_mfma_f32_16x16x32_bf16 a[116:119], v[80:83], v[244:247], a[116:119]
  s_add_u32 s73, s73, s33
  s_cmp_ge_u32 s38, 2
  s_cselect_b32 s33, 0x400, 0
  v_mfma_f32_16x16x32_bf16 a[116:119], v[84:87], v[144:147], a[116:119]
  s_add_u32 s32, s32, s33
  ds_read_b128 v[108:111], v41 offset:20480
  v_mfma_f32_16x16x32_bf16 a[112:115], v[76:79], v[144:147], a[112:115]
  v_mfma_f32_16x16x32_bf16 a[112:115], v[72:75], v[244:247], a[112:115]
  ds_read_b64_tr_b16 v[204:205], v36 offset:16384
  v_mfma_f32_16x16x32_bf16 a[104:107], v[72:75], v[240:243], a[104:107]
  v_mfma_f32_16x16x32_bf16 a[104:107], v[76:79], v[140:143], a[104:107]
  ds_read_b64_tr_b16 v[206:207], v36 offset:18432
  v_mfma_f32_16x16x32_bf16 a[108:111], v[84:87], v[140:143], a[108:111]
  v_mfma_f32_16x16x32_bf16 a[108:111], v[80:83], v[240:243], a[108:111]
  ds_read_b128 v[112:115], v14 offset:22528
  v_mfma_f32_16x16x32_bf16 a[100:103], v[80:83], v[236:239], a[100:103]
  v_mfma_f32_16x16x32_bf16 a[100:103], v[84:87], v[136:139], a[100:103]
  ds_read_b64_tr_b16 v[208:209], v37 offset:16384
  v_mfma_f32_16x16x32_bf16 a[96:99], v[76:79], v[136:139], a[96:99]
  v_mfma_f32_16x16x32_bf16 a[96:99], v[72:75], v[236:239], a[96:99]
  ds_read_b64_tr_b16 v[210:211], v37 offset:18432
  v_mfma_f32_16x16x32_bf16 a[88:91], v[72:75], v[228:231], a[88:91]
  v_mfma_f32_16x16x32_bf16 a[88:91], v[76:79], v[132:135], a[88:91]
  ds_read_b128 v[116:119], v41 offset:22528
  v_mfma_f32_16x16x32_bf16 a[92:95], v[84:87], v[132:135], a[92:95]
  v_mfma_f32_16x16x32_bf16 a[92:95], v[80:83], v[228:231], a[92:95]
  ds_read_b64_tr_b16 v[212:213], v38 offset:16384
  v_mfma_f32_16x16x32_bf16 a[84:87], v[80:83], v[224:227], a[84:87]
  v_mfma_f32_16x16x32_bf16 a[84:87], v[84:87], v[128:131], a[84:87]
  ds_read_b64_tr_b16 v[214:215], v38 offset:18432
  v_mfma_f32_16x16x32_bf16 a[80:83], v[76:79], v[128:131], a[80:83]
  v_mfma_f32_16x16x32_bf16 a[80:83], v[72:75], v[224:227], a[80:83]
  v_mfma_f32_16x16x32_bf16 a[72:75], v[72:75], v[220:223], a[72:75]
  v_mfma_f32_16x16x32_bf16 a[72:75], v[76:79], v[124:127], a[72:75]
  v_mfma_f32_16x16x32_bf16 a[76:79], v[84:87], v[124:127], a[76:79]
  v_mfma_f32_16x16x32_bf16 a[76:79], v[80:83], v[220:223], a[76:79]
  v_mfma_f32_16x16x32_bf16 a[68:71], v[80:83], v[216:219], a[68:71]
  v_mfma_f32_16x16x32_bf16 a[68:71], v[84:87], v[120:123], a[68:71]
  v_mfma_f32_16x16x32_bf16 a[64:67], v[76:79], v[120:123], a[64:67]
  v_mfma_f32_16x16x32_bf16 a[64:67], v[72:75], v[216:219], a[64:67]
  s_waitcnt lgkmcnt(0)
  s_waitcnt vmcnt(19)
  s_barrier
  v_mfma_f32_16x16x32_bf16 a[128:131], v[88:91], v[216:219], a[128:131]
  s_add_u32 m0, s34, 0x4000
  ds_read_b128 v[56:59], v14 offset:32768
  v_mfma_f32_16x16x32_bf16 a[128:131], v[92:95], v[120:123], a[128:131]
  v_mfma_f32_16x16x32_bf16 a[132:135], v[100:103], v[120:123], a[132:135]
  ds_read_b64_tr_b16 v[152:153], v15 offset:32768
  v_mfma_f32_16x16x32_bf16 a[132:135], v[96:99], v[216:219], a[132:135]
  v_mfma_f32_16x16x32_bf16 a[140:143], v[96:99], v[220:223], a[140:143]
  ds_read_b64_tr_b16 v[154:155], v15 offset:34816
  v_mfma_f32_16x16x32_bf16 a[140:143], v[100:103], v[124:127], a[140:143]
  v_mfma_f32_16x16x32_bf16 a[136:139], v[92:95], v[124:127], a[136:139]
  ds_read_b128 v[60:63], v41 offset:32768
  v_mfma_f32_16x16x32_bf16 a[136:139], v[88:91], v[220:223], a[136:139]
  v_mfma_f32_16x16x32_bf16 a[144:147], v[88:91], v[224:227], a[144:147]
  ds_read_b64_tr_b16 v[156:157], v32 offset:32768
  v_mfma_f32_16x16x32_bf16 a[144:147], v[92:95], v[128:131], a[144:147]
  v_mfma_f32_16x16x32_bf16 a[148:151], v[100:103], v[128:131], a[148:151]
  ds_read_b64_tr_b16 v[158:159], v32 offset:34816
  v_mfma_f32_16x16x32_bf16 a[148:151], v[96:99], v[224:227], a[148:151]
  v_mfma_f32_16x16x32_bf16 a[156:159], v[96:99], v[228:231], a[156:159]
  ds_read_b128 v[64:67], v14 offset:34816
  v_mfma_f32_16x16x32_bf16 a[156:159], v[100:103], v[132:135], a[156:159]
  v_mfma_f32_16x16x32_bf16 a[152:155], v[92:95], v[132:135], a[152:155]
  ds_read_b64_tr_b16 v[160:161], v33 offset:32768
  v_mfma_f32_16x16x32_bf16 a[152:155], v[88:91], v[228:231], a[152:155]
  v_mfma_f32_16x16x32_bf16 a[160:163], v[88:91], v[236:239], a[160:163]
  ds_read_b64_tr_b16 v[162:163], v33 offset:34816
  v_mfma_f32_16x16x32_bf16 a[160:163], v[92:95], v[136:139], a[160:163]
  v_mfma_f32_16x16x32_bf16 a[164:167], v[100:103], v[136:139], a[164:167]
  ds_read_b128 v[68:71], v41 offset:34816
  v_mfma_f32_16x16x32_bf16 a[164:167], v[96:99], v[236:239], a[164:167]
  v_mfma_f32_16x16x32_bf16 a[172:175], v[96:99], v[240:243], a[172:175]
  ds_read_b64_tr_b16 v[164:165], v34 offset:32768
  v_mfma_f32_16x16x32_bf16 a[172:175], v[100:103], v[140:143], a[172:175]
  v_mfma_f32_16x16x32_bf16 a[168:171], v[92:95], v[140:143], a[168:171]
  ds_read_b64_tr_b16 v[166:167], v34 offset:34816
  v_mfma_f32_16x16x32_bf16 a[168:171], v[88:91], v[240:243], a[168:171]
  v_mfma_f32_16x16x32_bf16 a[176:179], v[88:91], v[244:247], a[176:179]
  ds_read_b128 v[72:75], v14 offset:36864
  v_mfma_f32_16x16x32_bf16 a[176:179], v[92:95], v[144:147], a[176:179]
  v_mfma_f32_16x16x32_bf16 a[180:183], v[100:103], v[144:147], a[180:183]
  ds_read_b64_tr_b16 v[168:169], v35 offset:32768
  v_mfma_f32_16x16x32_bf16 a[180:183], v[96:99], v[244:247], a[180:183]
  v_mfma_f32_16x16x32_bf16 a[188:191], v[96:99], v[248:251], a[188:191]
  ds_read_b64_tr_b16 v[170:171], v35 offset:34816
  v_mfma_f32_16x16x32_bf16 a[188:191], v[100:103], v[148:151], a[188:191]
  v_mfma_f32_16x16x32_bf16 a[184:187], v[92:95], v[148:151], a[184:187]
  ds_read_b128 v[76:79], v41 offset:36864
  v_mfma_f32_16x16x32_bf16 a[184:187], v[88:91], v[248:251], a[184:187]
  v_mfma_f32_16x16x32_bf16 a[248:251], v[104:107], v[248:251], a[248:251]
  ds_read_b64_tr_b16 v[172:173], v36 offset:32768
  v_mfma_f32_16x16x32_bf16 a[248:251], v[108:111], v[148:151], a[248:251]
  v_mfma_f32_16x16x32_bf16 a[252:255], v[116:119], v[148:151], a[252:255]
  ds_read_b64_tr_b16 v[174:175], v36 offset:34816
  v_mfma_f32_16x16x32_bf16 a[252:255], v[112:115], v[248:251], a[252:255]
  v_mfma_f32_16x16x32_bf16 a[244:247], v[112:115], v[244:247], a[244:247]
  ds_read_b128 v[80:83], v14 offset:38912
  v_mfma_f32_16x16x32_bf16 a[244:247], v[116:119], v[144:147], a[244:247]
  v_mfma_f32_16x16x32_bf16 a[240:243], v[108:111], v[144:147], a[240:243]
  ds_read_b64_tr_b16 v[176:177], v37 offset:32768
  v_mfma_f32_16x16x32_bf16 a[240:243], v[104:107], v[244:247], a[240:243]
  v_mfma_f32_16x16x32_bf16 a[232:235], v[104:107], v[240:243], a[232:235]
  ds_read_b64_tr_b16 v[178:179], v37 offset:34816
  v_mfma_f32_16x16x32_bf16 a[232:235], v[108:111], v[140:143], a[232:235]
  v_mfma_f32_16x16x32_bf16 a[236:239], v[116:119], v[140:143], a[236:239]
  ds_read_b128 v[84:87], v41 offset:38912
  v_mfma_f32_16x16x32_bf16 a[236:239], v[112:115], v[240:243], a[236:239]
  v_mfma_f32_16x16x32_bf16 a[228:231], v[112:115], v[236:239], a[228:231]
  ds_read_b64_tr_b16 v[180:181], v38 offset:32768
  v_mfma_f32_16x16x32_bf16 a[228:231], v[116:119], v[136:139], a[228:231]
  v_mfma_f32_16x16x32_bf16 a[224:227], v[108:111], v[136:139], a[224:227]
  ds_read_b64_tr_b16 v[182:183], v38 offset:34816
  v_mfma_f32_16x16x32_bf16 a[224:227], v[104:107], v[236:239], a[224:227]
  v_mfma_f32_16x16x32_bf16 a[216:219], v[104:107], v[228:231], a[216:219]
  v_mfma_f32_16x16x32_bf16 a[216:219], v[108:111], v[132:135], a[216:219]
  v_mfma_f32_16x16x32_bf16 a[220:223], v[116:119], v[132:135], a[220:223]
  v_mfma_f32_16x16x32_bf16 a[220:223], v[112:115], v[228:231], a[220:223]
  v_mfma_f32_16x16x32_bf16 a[212:215], v[112:115], v[224:227], a[212:215]
  v_mfma_f32_16x16x32_bf16 a[212:215], v[116:119], v[128:131], a[212:215]
  v_mfma_f32_16x16x32_bf16 a[208:211], v[108:111], v[128:131], a[208:211]
  v_mfma_f32_16x16x32_bf16 a[208:211], v[104:107], v[224:227], a[208:211]
  v_mfma_f32_16x16x32_bf16 a[200:203], v[104:107], v[220:223], a[200:203]
  v_mfma_f32_16x16x32_bf16 a[200:203], v[108:111], v[124:127], a[200:203]
  v_mfma_f32_16x16x32_bf16 a[204:207], v[116:119], v[124:127], a[204:207]
  v_mfma_f32_16x16x32_bf16 a[204:207], v[112:115], v[220:223], a[204:207]
  v_mfma_f32_16x16x32_bf16 a[196:199], v[112:115], v[216:219], a[196:199]
  v_mfma_f32_16x16x32_bf16 a[196:199], v[116:119], v[120:123], a[196:199]
  v_mfma_f32_16x16x32_bf16 a[192:195], v[108:111], v[120:123], a[192:195]
  v_mfma_f32_16x16x32_bf16 a[192:195], v[104:107], v[216:219], a[192:195]
  s_waitcnt lgkmcnt(0)
  s_waitcnt vmcnt(11)
  s_barrier
  v_mfma_f32_16x16x32_bf16 a[0:3], v[56:59], v[184:187], a[0:3]
  ds_read_b128 v[88:91], v14 offset:49152
  v_mfma_f32_16x16x32_bf16 a[0:3], v[60:63], v[152:155], a[0:3]
  v_mfma_f32_16x16x32_bf16 a[4:7], v[68:71], v[152:155], a[4:7]
  ds_read_b64_tr_b16 v[216:217], v15 offset:49152
  v_mfma_f32_16x16x32_bf16 a[4:7], v[64:67], v[184:187], a[4:7]
  v_mfma_f32_16x16x32_bf16 a[12:15], v[64:67], v[188:191], a[12:15]
  ds_read_b64_tr_b16 v[218:219], v15 offset:51200
  v_mfma_f32_16x16x32_bf16 a[12:15], v[68:71], v[156:159], a[12:15]
  v_mfma_f32_16x16x32_bf16 a[8:11], v[60:63], v[156:159], a[8:11]
  ds_read_b128 v[92:95], v41 offset:49152
  v_mfma_f32_16x16x32_bf16 a[8:11], v[56:59], v[188:191], a[8:11]
  v_mfma_f32_16x16x32_bf16 a[16:19], v[56:59], v[192:195], a[16:19]
  ds_read_b64_tr_b16 v[220:221], v32 offset:49152
  v_mfma_f32_16x16x32_bf16 a[16:19], v[60:63], v[160:163], a[16:19]
  v_mfma_f32_16x16x32_bf16 a[20:23], v[68:71], v[160:163], a[20:23]
  ds_read_b64_tr_b16 v[222:223], v32 offset:51200
  v_mfma_f32_16x16x32_bf16 a[20:23], v[64:67], v[192:195], a[20:23]
  v_mfma_f32_16x16x32_bf16 a[28:31], v[64:67], v[196:199], a[28:31]
  buffer_load_dwordx4 v6, s[20:23], s36 offen offset:0 lds
  v_mfma_f32_16x16x32_bf16 a[28:31], v[68:71], v[164:167], a[28:31]
  ds_read_b128 v[96:99], v14 offset:51200
  v_mfma_f32_16x16x32_bf16 a[24:27], v[60:63], v[164:167], a[24:27]
  v_mfma_f32_16x16x32_bf16 a[24:27], v[56:59], v[196:199], a[24:27]
  ds_read_b64_tr_b16 v[224:225], v33 offset:49152
  v_mfma_f32_16x16x32_bf16 a[32:35], v[56:59], v[200:203], a[32:35]
  buffer_load_dwordx4 v7, s[20:23], s36 offen offset:1024 lds
  v_mfma_f32_16x16x32_bf16 a[32:35], v[60:63], v[168:171], a[32:35]
  ds_read_b64_tr_b16 v[226:227], v33 offset:51200
  v_mfma_f32_16x16x32_bf16 a[36:39], v[68:71], v[168:171], a[36:39]
  v_mfma_f32_16x16x32_bf16 a[36:39], v[64:67], v[200:203], a[36:39]
  ds_read_b128 v[100:103], v41 offset:51200
  v_mfma_f32_16x16x32_bf16 a[44:47], v[64:67], v[204:207], a[44:47]
  buffer_load_dwordx4 v8, s[20:23], s36 offen offset:2048 lds
  v_mfma_f32_16x16x32_bf16 a[44:47], v[68:71], v[172:175], a[44:47]
  ds_read_b64_tr_b16 v[228:229], v34 offset:49152
  v_mfma_f32_16x16x32_bf16 a[40:43], v[60:63], v[172:175], a[40:43]
  v_mfma_f32_16x16x32_bf16 a[40:43], v[56:59], v[204:207], a[40:43]
  ds_read_b64_tr_b16 v[230:231], v34 offset:51200
  v_mfma_f32_16x16x32_bf16 a[48:51], v[56:59], v[208:211], a[48:51]
  buffer_load_dwordx4 v9, s[20:23], s36 offen offset:3072 lds
  v_mfma_f32_16x16x32_bf16 a[48:51], v[60:63], v[176:179], a[48:51]
  s_sub_u32 s36, s36, 130944
  s_add_u32 m0, s34, 0x14000
  ds_read_b128 v[104:107], v14 offset:53248
  v_mfma_f32_16x16x32_bf16 a[52:55], v[68:71], v[176:179], a[52:55]
  v_mfma_f32_16x16x32_bf16 a[52:55], v[64:67], v[208:211], a[52:55]
  ds_read_b64_tr_b16 v[236:237], v35 offset:49152
  v_mfma_f32_16x16x32_bf16 a[60:63], v[64:67], v[212:215], a[60:63]
  buffer_load_dwordx4 v10, s[24:27], s37 offen offset:0 lds
  v_mfma_f32_16x16x32_bf16 a[60:63], v[68:71], v[180:183], a[60:63]
  ds_read_b64_tr_b16 v[238:239], v35 offset:51200
  v_mfma_f32_16x16x32_bf16 a[56:59], v[60:63], v[180:183], a[56:59]
  v_mfma_f32_16x16x32_bf16 a[56:59], v[56:59], v[212:215], a[56:59]
  ds_read_b128 v[108:111], v41 offset:53248
  v_mfma_f32_16x16x32_bf16 a[120:123], v[72:75], v[212:215], a[120:123]
  buffer_load_dwordx4 v11, s[24:27], s37 offen offset:1024 lds
  v_mfma_f32_16x16x32_bf16 a[120:123], v[76:79], v[180:183], a[120:123]
  ds_read_b64_tr_b16 v[240:241], v36 offset:49152
  v_mfma_f32_16x16x32_bf16 a[124:127], v[84:87], v[180:183], a[124:127]
  v_mfma_f32_16x16x32_bf16 a[124:127], v[80:83], v[212:215], a[124:127]
  ds_read_b64_tr_b16 v[242:243], v36 offset:51200
  v_mfma_f32_16x16x32_bf16 a[116:119], v[80:83], v[208:211], a[116:119]
  buffer_load_dwordx4 v12, s[24:27], s37 offen offset:2048 lds
  v_mfma_f32_16x16x32_bf16 a[116:119], v[84:87], v[176:179], a[116:119]
  ds_read_b128 v[112:115], v14 offset:55296
  v_mfma_f32_16x16x32_bf16 a[112:115], v[76:79], v[176:179], a[112:115]
  v_mfma_f32_16x16x32_bf16 a[112:115], v[72:75], v[208:211], a[112:115]
  ds_read_b64_tr_b16 v[244:245], v37 offset:49152
  v_mfma_f32_16x16x32_bf16 a[104:107], v[72:75], v[204:207], a[104:107]
  buffer_load_dwordx4 v13, s[24:27], s37 offen offset:3072 lds
  v_mfma_f32_16x16x32_bf16 a[104:107], v[76:79], v[172:175], a[104:107]
  s_add_u32 s37, s37, 0x40000
  s_add_u32 m0, s34, 0x8000
  ds_read_b64_tr_b16 v[246:247], v37 offset:51200
  v_mfma_f32_16x16x32_bf16 a[108:111], v[84:87], v[172:175], a[108:111]
  v_mfma_f32_16x16x32_bf16 a[108:111], v[80:83], v[204:207], a[108:111]
  ds_read_b128 v[116:119], v41 offset:55296
  v_mfma_f32_16x16x32_bf16 a[100:103], v[80:83], v[200:203], a[100:103]
  buffer_load_dwordx4 v6, s[20:23], s36 offen offset:0 lds
  v_mfma_f32_16x16x32_bf16 a[100:103], v[84:87], v[168:171], a[100:103]
  ds_read_b64_tr_b16 v[248:249], v38 offset:49152
  v_mfma_f32_16x16x32_bf16 a[96:99], v[76:79], v[168:171], a[96:99]
  v_mfma_f32_16x16x32_bf16 a[96:99], v[72:75], v[200:203], a[96:99]
  ds_read_b64_tr_b16 v[250:251], v38 offset:51200
  v_mfma_f32_16x16x32_bf16 a[88:91], v[72:75], v[196:199], a[88:91]
  buffer_load_dwordx4 v7, s[20:23], s36 offen offset:1024 lds
  v_mfma_f32_16x16x32_bf16 a[88:91], v[76:79], v[164:167], a[88:91]
  v_mfma_f32_16x16x32_bf16 a[92:95], v[84:87], v[164:167], a[92:95]
  v_mfma_f32_16x16x32_bf16 a[92:95], v[80:83], v[196:199], a[92:95]
  v_mfma_f32_16x16x32_bf16 a[84:87], v[80:83], v[192:195], a[84:87]
  buffer_load_dwordx4 v8, s[20:23], s36 offen offset:2048 lds
  v_mfma_f32_16x16x32_bf16 a[84:87], v[84:87], v[160:163], a[84:87]
  v_mfma_f32_16x16x32_bf16 a[80:83], v[76:79], v[160:163], a[80:83]
  v_mfma_f32_16x16x32_bf16 a[80:83], v[72:75], v[192:195], a[80:83]
  v_mfma_f32_16x16x32_bf16 a[72:75], v[72:75], v[188:191], a[72:75]
  buffer_load_dwordx4 v9, s[20:23], s36 offen offset:3072 lds
  v_mfma_f32_16x16x32_bf16 a[72:75], v[76:79], v[156:159], a[72:75]
  s_add_u32 s36, s36, 131072
  s_add_u32 m0, s34, 0x18000
  v_mfma_f32_16x16x32_bf16 a[76:79], v[84:87], v[156:159], a[76:79]
  v_mfma_f32_16x16x32_bf16 a[76:79], v[80:83], v[188:191], a[76:79]
  v_mfma_f32_16x16x32_bf16 a[68:71], v[80:83], v[184:187], a[68:71]
  v_mfma_f32_16x16x32_bf16 a[68:71], v[84:87], v[152:155], a[68:71]
  v_mfma_f32_16x16x32_bf16 a[64:67], v[76:79], v[152:155], a[64:67]
  v_mfma_f32_16x16x32_bf16 a[64:67], v[72:75], v[184:187], a[64:67]
  s_waitcnt lgkmcnt(0)
  s_waitcnt vmcnt(15)
  s_barrier
  v_mfma_f32_16x16x32_bf16 a[128:131], v[88:91], v[184:187], a[128:131]
  ds_read_b128 v[56:59], v14 offset:0
  v_mfma_f32_16x16x32_bf16 a[128:131], v[92:95], v[152:155], a[128:131]
  buffer_load_dwordx4 v10, s[24:27], s37 offen offset:0 lds
  v_mfma_f32_16x16x32_bf16 a[132:135], v[100:103], v[152:155], a[132:135]
  ds_read_b64_tr_b16 v[120:121], v15 offset:0
  v_mfma_f32_16x16x32_bf16 a[132:135], v[96:99], v[184:187], a[132:135]
  v_mfma_f32_16x16x32_bf16 a[140:143], v[96:99], v[188:191], a[140:143]
  ds_read_b64_tr_b16 v[122:123], v15 offset:2048
  v_mfma_f32_16x16x32_bf16 a[140:143], v[100:103], v[156:159], a[140:143]
  v_mfma_f32_16x16x32_bf16 a[136:139], v[92:95], v[156:159], a[136:139]
  buffer_load_dwordx4 v11, s[24:27], s37 offen offset:1024 lds
  v_mfma_f32_16x16x32_bf16 a[136:139], v[88:91], v[188:191], a[136:139]
  ds_read_b128 v[60:63], v41 offset:0
  v_mfma_f32_16x16x32_bf16 a[144:147], v[88:91], v[192:195], a[144:147]
  v_mfma_f32_16x16x32_bf16 a[144:147], v[92:95], v[160:163], a[144:147]
  ds_read_b64_tr_b16 v[124:125], v32 offset:0
  v_mfma_f32_16x16x32_bf16 a[148:151], v[100:103], v[160:163], a[148:151]
  v_mfma_f32_16x16x32_bf16 a[148:151], v[96:99], v[192:195], a[148:151]
  buffer_load_dwordx4 v12, s[24:27], s37 offen offset:2048 lds
  v_mfma_f32_16x16x32_bf16 a[156:159], v[96:99], v[196:199], a[156:159]
  ds_read_b64_tr_b16 v[126:127], v32 offset:2048
  v_mfma_f32_16x16x32_bf16 a[156:159], v[100:103], v[164:167], a[156:159]
  v_mfma_f32_16x16x32_bf16 a[152:155], v[92:95], v[164:167], a[152:155]
  ds_read_b128 v[64:67], v14 offset:2048
  v_mfma_f32_16x16x32_bf16 a[152:155], v[88:91], v[196:199], a[152:155]
  v_mfma_f32_16x16x32_bf16 a[160:163], v[88:91], v[200:203], a[160:163]
  buffer_load_dwordx4 v13, s[24:27], s37 offen offset:3072 lds
  v_mfma_f32_16x16x32_bf16 a[160:163], v[92:95], v[168:171], a[160:163]
  s_add_u32 s37, s37, 0x40000
  s_add_u32 m0, s34, 0xc000
  ds_read_b64_tr_b16 v[128:129], v33 offset:0
  v_mfma_f32_16x16x32_bf16 a[164:167], v[100:103], v[168:171], a[164:167]
  v_mfma_f32_16x16x32_bf16 a[164:167], v[96:99], v[200:203], a[164:167]
  ds_read_b64_tr_b16 v[130:131], v33 offset:2048
  v_mfma_f32_16x16x32_bf16 a[172:175], v[96:99], v[204:207], a[172:175]
  v_mfma_f32_16x16x32_bf16 a[172:175], v[100:103], v[172:175], a[172:175]
  buffer_load_dwordx4 v6, s[20:23], s36 offen offset:0 lds
  v_mfma_f32_16x16x32_bf16 a[168:171], v[92:95], v[172:175], a[168:171]
  ds_read_b128 v[68:71], v41 offset:2048
  v_mfma_f32_16x16x32_bf16 a[168:171], v[88:91], v[204:207], a[168:171]
  v_mfma_f32_16x16x32_bf16 a[176:179], v[88:91], v[208:211], a[176:179]
  ds_read_b64_tr_b16 v[132:133], v34 offset:0
  v_mfma_f32_16x16x32_bf16 a[176:179], v[92:95], v[176:179], a[176:179]
  v_mfma_f32_16x16x32_bf16 a[180:183], v[100:103], v[176:179], a[180:183]
  buffer_load_dwordx4 v7, s[20:23], s36 offen offset:1024 lds
  v_mfma_f32_16x16x32_bf16 a[180:183], v[96:99], v[208:211], a[180:183]
  ds_read_b64_tr_b16 v[134:135], v34 offset:2048
  v_mfma_f32_16x16x32_bf16 a[188:191], v[96:99], v[212:215], a[188:191]
  v_mfma_f32_16x16x32_bf16 a[188:191], v[100:103], v[180:183], a[188:191]
  ds_read_b128 v[72:75], v14 offset:4096
  v_mfma_f32_16x16x32_bf16 a[184:187], v[92:95], v[180:183], a[184:187]
  v_mfma_f32_16x16x32_bf16 a[184:187], v[88:91], v[212:215], a[184:187]
  buffer_load_dwordx4 v8, s[20:23], s36 offen offset:2048 lds
  v_mfma_f32_16x16x32_bf16 a[248:251], v[104:107], v[212:215], a[248:251]
  ds_read_b64_tr_b16 v[136:137], v35 offset:0
  v_mfma_f32_16x16x32_bf16 a[248:251], v[108:111], v[180:183], a[248:251]
  v_mfma_f32_16x16x32_bf16 a[252:255], v[116:119], v[180:183], a[252:255]
  ds_read_b64_tr_b16 v[138:139], v35 offset:2048
  v_mfma_f32_16x16x32_bf16 a[252:255], v[112:115], v[212:215], a[252:255]
  v_mfma_f32_16x16x32_bf16 a[244:247], v[112:115], v[208:211], a[244:247]
  buffer_load_dwordx4 v9, s[20:23], s36 offen offset:3072 lds
  v_mfma_f32_16x16x32_bf16 a[244:247], v[116:119], v[176:179], a[244:247]
  s_sub_u32 s36, s36, 130944
  s_add_u32 m0, s34, 0x1c000
  ds_read_b128 v[76:79], v41 offset:4096
  v_mfma_f32_16x16x32_bf16 a[240:243], v[108:111], v[176:179], a[240:243]
  v_mfma_f32_16x16x32_bf16 a[240:243], v[104:107], v[208:211], a[240:243]
  ds_read_b64_tr_b16 v[140:141], v36 offset:0
  v_mfma_f32_16x16x32_bf16 a[232:235], v[104:107], v[204:207], a[232:235]
  v_mfma_f32_16x16x32_bf16 a[232:235], v[108:111], v[172:175], a[232:235]
  buffer_load_dwordx4 v10, s[24:27], s37 offen offset:0 lds
  v_mfma_f32_16x16x32_bf16 a[236:239], v[116:119], v[172:175], a[236:239]
  ds_read_b64_tr_b16 v[142:143], v36 offset:2048
  v_mfma_f32_16x16x32_bf16 a[236:239], v[112:115], v[204:207], a[236:239]
  v_mfma_f32_16x16x32_bf16 a[228:231], v[112:115], v[200:203], a[228:231]
  ds_read_b128 v[80:83], v14 offset:6144
  v_mfma_f32_16x16x32_bf16 a[228:231], v[116:119], v[168:171], a[228:231]
  v_mfma_f32_16x16x32_bf16 a[224:227], v[108:111], v[168:171], a[224:227]
  buffer_load_dwordx4 v11, s[24:27], s37 offen offset:1024 lds
  v_mfma_f32_16x16x32_bf16 a[224:227], v[104:107], v[200:203], a[224:227]
  ds_read_b64_tr_b16 v[144:145], v37 offset:0
  v_mfma_f32_16x16x32_bf16 a[216:219], v[104:107], v[196:199], a[216:219]
  v_mfma_f32_16x16x32_bf16 a[216:219], v[108:111], v[164:167], a[216:219]
  ds_read_b64_tr_b16 v[146:147], v37 offset:2048
  v_mfma_f32_16x16x32_bf16 a[220:223], v[116:119], v[164:167], a[220:223]
  v_mfma_f32_16x16x32_bf16 a[220:223], v[112:115], v[196:199], a[220:223]
  buffer_load_dwordx4 v12, s[24:27], s37 offen offset:2048 lds
  v_mfma_f32_16x16x32_bf16 a[212:215], v[112:115], v[192:195], a[212:215]
  ds_read_b128 v[84:87], v41 offset:6144
  v_mfma_f32_16x16x32_bf16 a[212:215], v[116:119], v[160:163], a[212:215]
  v_mfma_f32_16x16x32_bf16 a[208:211], v[108:111], v[160:163], a[208:211]
  ds_read_b64_tr_b16 v[148:149], v38 offset:0
  v_mfma_f32_16x16x32_bf16 a[208:211], v[104:107], v[192:195], a[208:211]
  v_mfma_f32_16x16x32_bf16 a[200:203], v[104:107], v[188:191], a[200:203]
  buffer_load_dwordx4 v13, s[24:27], s37 offen offset:3072 lds
  v_mfma_f32_16x16x32_bf16 a[200:203], v[108:111], v[156:159], a[200:203]
  s_add_u32 s37, s37, 0x40000
  ds_read_b64_tr_b16 v[150:151], v38 offset:2048
  v_mfma_f32_16x16x32_bf16 a[204:207], v[116:119], v[156:159], a[204:207]
  v_mfma_f32_16x16x32_bf16 a[204:207], v[112:115], v[188:191], a[204:207]
  v_mfma_f32_16x16x32_bf16 a[196:199], v[112:115], v[184:187], a[196:199]
  v_mfma_f32_16x16x32_bf16 a[196:199], v[116:119], v[152:155], a[196:199]
  v_mfma_f32_16x16x32_bf16 a[192:195], v[108:111], v[152:155], a[192:195]
  v_mfma_f32_16x16x32_bf16 a[192:195], v[104:107], v[184:187], a[192:195]
  s_add_u32 s38, s38, 1
  s_cmp_lt_u32 s38, 6
  s_cbranch_scc1 Lk_loop1
  s_waitcnt lgkmcnt(0)
  s_waitcnt vmcnt(16)
  s_barrier
  v_mfma_f32_16x16x32_bf16 a[0:3], v[56:59], v[216:219], a[0:3]
  s_add_u32 m0, s34, 0x0
  ds_read_b128 v[88:91], v14 offset:16384
  v_mfma_f32_16x16x32_bf16 a[0:3], v[60:63], v[120:123], a[0:3]
  buffer_load_dwordx4 v6, s[20:23], s36 offen offset:0 lds
  v_mfma_f32_16x16x32_bf16 a[4:7], v[68:71], v[120:123], a[4:7]
  ds_read_b64_tr_b16 v[184:185], v15 offset:16384
  v_mfma_f32_16x16x32_bf16 a[4:7], v[64:67], v[216:219], a[4:7]
  v_mfma_f32_16x16x32_bf16 a[12:15], v[64:67], v[220:223], a[12:15]
  buffer_load_dwordx4 v7, s[20:23], s36 offen offset:1024 lds
  v_mfma_f32_16x16x32_bf16 a[12:15], v[68:71], v[124:127], a[12:15]
  ds_read_b64_tr_b16 v[186:187], v15 offset:18432
  v_mfma_f32_16x16x32_bf16 a[8:11], v[60:63], v[124:127], a[8:11]
  v_mfma_f32_16x16x32_bf16 a[8:11], v[56:59], v[220:223], a[8:11]
  buffer_load_dwordx4 v8, s[20:23], s36 offen offset:2048 lds
  v_mfma_f32_16x16x32_bf16 a[16:19], v[56:59], v[224:227], a[16:19]
  ds_read_b128 v[92:95], v41 offset:16384
  v_mfma_f32_16x16x32_bf16 a[16:19], v[60:63], v[128:131], a[16:19]
  v_mfma_f32_16x16x32_bf16 a[20:23], v[68:71], v[128:131], a[20:23]
  buffer_load_dwordx4 v9, s[20:23], s36 offen offset:3072 lds
  v_mfma_f32_16x16x32_bf16 a[20:23], v[64:67], v[224:227], a[20:23]
  s_add_u32 s36, s36, 131072
  s_add_u32 m0, s34, 0x10000
  ds_read_b64_tr_b16 v[188:189], v32 offset:16384
  v_mfma_f32_16x16x32_bf16 a[28:31], v[64:67], v[228:231], a[28:31]
  v_mfma_f32_16x16x32_bf16 a[28:31], v[68:71], v[132:135], a[28:31]
  buffer_load_dwordx4 v10, s[24:27], s37 offen offset:0 lds
  v_mfma_f32_16x16x32_bf16 a[24:27], v[60:63], v[132:135], a[24:27]
  ds_read_b64_tr_b16 v[190:191], v32 offset:18432
  v_mfma_f32_16x16x32_bf16 a[24:27], v[56:59], v[228:231], a[24:27]
  v_mfma_f32_16x16x32_bf16 a[32:35], v[56:59], v[236:239], a[32:35]
  buffer_load_dwordx4 v11, s[24:27], s37 offen offset:1024 lds
  v_mfma_f32_16x16x32_bf16 a[32:35], v[60:63], v[136:139], a[32:35]
  ds_read_b128 v[96:99], v14 offset:18432
  v_mfma_f32_16x16x32_bf16 a[36:39], v[68:71], v[136:139], a[36:39]
  v_mfma_f32_16x16x32_bf16 a[36:39], v[64:67], v[236:239], a[36:39]
  buffer_load_dwordx4 v12, s[24:27], s37 offen offset:2048 lds
  v_mfma_f32_16x16x32_bf16 a[44:47], v[64:67], v[240:243], a[44:47]
  ds_read_b64_tr_b16 v[192:193], v33 offset:16384
  v_mfma_f32_16x16x32_bf16 a[44:47], v[68:71], v[140:143], a[44:47]
  v_mfma_f32_16x16x32_bf16 a[40:43], v[60:63], v[140:143], a[40:43]
  buffer_load_dwordx4 v13, s[24:27], s37 offen offset:3072 lds
  v_mfma_f32_16x16x32_bf16 a[40:43], v[56:59], v[240:243], a[40:43]
  s_add_u32 s37, s37, 0x40000
  ds_read_b64_tr_b16 v[194:195], v33 offset:18432
  v_mfma_f32_16x16x32_bf16 a[48:51], v[56:59], v[244:247], a[48:51]
  v_mfma_f32_16x16x32_bf16 a[48:51], v[60:63], v[144:147], a[48:51]
  ds_read_b128 v[100:103], v41 offset:18432
  v_mfma_f32_16x16x32_bf16 a[52:55], v[68:71], v[144:147], a[52:55]
  v_mfma_f32_16x16x32_bf16 a[52:55], v[64:67], v[244:247], a[52:55]
  ds_read_b64_tr_b16 v[196:197], v34 offset:16384
  v_mfma_f32_16x16x32_bf16 a[60:63], v[64:67], v[248:251], a[60:63]
  buffer_load_dword v25, v24, s[76:79], s39 offen
  v_mfma_f32_16x16x32_bf16 a[60:63], v[68:71], v[148:151], a[60:63]
  s_add_u32 s39, s39, s3
  ds_read_b64_tr_b16 v[198:199], v34 offset:18432
  v_mfma_f32_16x16x32_bf16 a[56:59], v[60:63], v[148:151], a[56:59]
  v_mfma_f32_16x16x32_bf16 a[56:59], v[56:59], v[248:251], a[56:59]
  ds_read_b128 v[104:107], v14 offset:20480
  v_mfma_f32_16x16x32_bf16 a[120:123], v[72:75], v[248:251], a[120:123]
  v_mfma_f32_16x16x32_bf16 a[120:123], v[76:79], v[148:151], a[120:123]
  ds_read_b64_tr_b16 v[200:201], v35 offset:16384
  v_mfma_f32_16x16x32_bf16 a[124:127], v[84:87], v[148:151], a[124:127]
  v_mfma_f32_16x16x32_bf16 a[124:127], v[80:83], v[248:251], a[124:127]
  ds_read_b64_tr_b16 v[202:203], v35 offset:18432
  v_mfma_f32_16x16x32_bf16 a[116:119], v[80:83], v[244:247], a[116:119]
  v_mfma_f32_16x16x32_bf16 a[116:119], v[84:87], v[144:147], a[116:119]
  ds_read_b128 v[108:111], v41 offset:20480
  v_mfma_f32_16x16x32_bf16 a[112:115], v[76:79], v[144:147], a[112:115]
  v_mfma_f32_16x16x32_bf16 a[112:115], v[72:75], v[244:247], a[112:115]
  ds_read_b64_tr_b16 v[204:205], v36 offset:16384
  v_mfma_f32_16x16x32_bf16 a[104:107], v[72:75], v[240:243], a[104:107]
  v_mfma_f32_16x16x32_bf16 a[104:107], v[76:79], v[140:143], a[104:107]
  ds_read_b64_tr_b16 v[206:207], v36 offset:18432
  v_mfma_f32_16x16x32_bf16 a[108:111], v[84:87], v[140:143], a[108:111]
  v_mfma_f32_16x16x32_bf16 a[108:111], v[80:83], v[240:243], a[108:111]
  ds_read_b128 v[112:115], v14 offset:22528
  v_mfma_f32_16x16x32_bf16 a[100:103], v[80:83], v[236:239], a[100:103]
  v_mfma_f32_16x16x32_bf16 a[100:103], v[84:87], v[136:139], a[100:103]
  ds_read_b64_tr_b16 v[208:209], v37 offset:16384
  v_mfma_f32_16x16x32_bf16 a[96:99], v[76:79], v[136:139], a[96:99]
  v_mfma_f32_16x16x32_bf16 a[96:99], v[72:75], v[236:239], a[96:99]
  ds_read_b64_tr_b16 v[210:211], v37 offset:18432
  v_mfma_f32_16x16x32_bf16 a[88:91], v[72:75], v[228:231], a[88:91]
  v_mfma_f32_16x16x32_bf16 a[88:91], v[76:79], v[132:135], a[88:91]
  ds_read_b128 v[116:119], v41 offset:22528
  v_mfma_f32_16x16x32_bf16 a[92:95], v[84:87], v[132:135], a[92:95]
  v_mfma_f32_16x16x32_bf16 a[92:95], v[80:83], v[228:231], a[92:95]
  ds_read_b64_tr_b16 v[212:213], v38 offset:16384
  v_mfma_f32_16x16x32_bf16 a[84:87], v[80:83], v[224:227], a[84:87]
  v_mfma_f32_16x16x32_bf16 a[84:87], v[84:87], v[128:131], a[84:87]
  ds_read_b64_tr_b16 v[214:215], v38 offset:18432
  v_mfma_f32_16x16x32_bf16 a[80:83], v[76:79], v[128:131], a[80:83]
  v_mfma_f32_16x16x32_bf16 a[80:83], v[72:75], v[224:227], a[80:83]
  v_mfma_f32_16x16x32_bf16 a[72:75], v[72:75], v[220:223], a[72:75]
  v_mfma_f32_16x16x32_bf16 a[72:75], v[76:79], v[124:127], a[72:75]
  v_mfma_f32_16x16x32_bf16 a[76:79], v[84:87], v[124:127], a[76:79]
  v_mfma_f32_16x16x32_bf16 a[76:79], v[80:83], v[220:223], a[76:79]
  v_mfma_f32_16x16x32_bf16 a[68:71], v[80:83], v[216:219], a[68:71]
  v_mfma_f32_16x16x32_bf16 a[68:71], v[84:87], v[120:123], a[68:71]
  v_mfma_f32_16x16x32_bf16 a[64:67], v[76:79], v[120:123], a[64:67]
  v_mfma_f32_16x16x32_bf16 a[64:67], v[72:75], v[216:219], a[64:67]
  s_waitcnt lgkmcnt(0)
  s_waitcnt vmcnt(17)
  s_barrier
  v_mfma_f32_16x16x32_bf16 a[128:131], v[88:91], v[216:219], a[128:131]
  s_add_u32 m0, s34, 0x4000
  ds_read_b128 v[56:59], v14 offset:32768
  v_mfma_f32_16x16x32_bf16 a[128:131], v[92:95], v[120:123], a[128:131]
  v_mfma_f32_16x16x32_bf16 a[132:135], v[100:103], v[120:123], a[132:135]
  ds_read_b64_tr_b16 v[152:153], v15 offset:32768
  v_mfma_f32_16x16x32_bf16 a[132:135], v[96:99], v[216:219], a[132:135]
  v_mfma_f32_16x16x32_bf16 a[140:143], v[96:99], v[220:223], a[140:143]
  ds_read_b64_tr_b16 v[154:155], v15 offset:34816
  v_mfma_f32_16x16x32_bf16 a[140:143], v[100:103], v[124:127], a[140:143]
  v_mfma_f32_16x16x32_bf16 a[136:139], v[92:95], v[124:127], a[136:139]
  ds_read_b128 v[60:63], v41 offset:32768
  v_mfma_f32_16x16x32_bf16 a[136:139], v[88:91], v[220:223], a[136:139]
  v_mfma_f32_16x16x32_bf16 a[144:147], v[88:91], v[224:227], a[144:147]
  ds_read_b64_tr_b16 v[156:157], v32 offset:32768
  v_mfma_f32_16x16x32_bf16 a[144:147], v[92:95], v[128:131], a[144:147]
  v_mfma_f32_16x16x32_bf16 a[148:151], v[100:103], v[128:131], a[148:151]
  ds_read_b64_tr_b16 v[158:159], v32 offset:34816
  v_mfma_f32_16x16x32_bf16 a[148:151], v[96:99], v[224:227], a[148:151]
  v_mfma_f32_16x16x32_bf16 a[156:159], v[96:99], v[228:231], a[156:159]
  ds_read_b128 v[64:67], v14 offset:34816
  v_mfma_f32_16x16x32_bf16 a[156:159], v[100:103], v[132:135], a[156:159]
  v_mfma_f32_16x16x32_bf16 a[152:155], v[92:95], v[132:135], a[152:155]
  ds_read_b64_tr_b16 v[160:161], v33 offset:32768
  v_mfma_f32_16x16x32_bf16 a[152:155], v[88:91], v[228:231], a[152:155]
  v_mfma_f32_16x16x32_bf16 a[160:163], v[88:91], v[236:239], a[160:163]
  ds_read_b64_tr_b16 v[162:163], v33 offset:34816
  v_mfma_f32_16x16x32_bf16 a[160:163], v[92:95], v[136:139], a[160:163]
  v_mfma_f32_16x16x32_bf16 a[164:167], v[100:103], v[136:139], a[164:167]
  ds_read_b128 v[68:71], v41 offset:34816
  v_mfma_f32_16x16x32_bf16 a[164:167], v[96:99], v[236:239], a[164:167]
  v_mfma_f32_16x16x32_bf16 a[172:175], v[96:99], v[240:243], a[172:175]
  ds_read_b64_tr_b16 v[164:165], v34 offset:32768
  v_mfma_f32_16x16x32_bf16 a[172:175], v[100:103], v[140:143], a[172:175]
  v_mfma_f32_16x16x32_bf16 a[168:171], v[92:95], v[140:143], a[168:171]
  ds_read_b64_tr_b16 v[166:167], v34 offset:34816
  v_mfma_f32_16x16x32_bf16 a[168:171], v[88:91], v[240:243], a[168:171]
  v_mfma_f32_16x16x32_bf16 a[176:179], v[88:91], v[244:247], a[176:179]
  ds_read_b128 v[72:75], v14 offset:36864
  v_mfma_f32_16x16x32_bf16 a[176:179], v[92:95], v[144:147], a[176:179]
  v_mfma_f32_16x16x32_bf16 a[180:183], v[100:103], v[144:147], a[180:183]
  ds_read_b64_tr_b16 v[168:169], v35 offset:32768
  v_mfma_f32_16x16x32_bf16 a[180:183], v[96:99], v[244:247], a[180:183]
  v_mfma_f32_16x16x32_bf16 a[188:191], v[96:99], v[248:251], a[188:191]
  ds_read_b64_tr_b16 v[170:171], v35 offset:34816
  v_mfma_f32_16x16x32_bf16 a[188:191], v[100:103], v[148:151], a[188:191]
  v_mfma_f32_16x16x32_bf16 a[184:187], v[92:95], v[148:151], a[184:187]
  ds_read_b128 v[76:79], v41 offset:36864
  v_mfma_f32_16x16x32_bf16 a[184:187], v[88:91], v[248:251], a[184:187]
  v_mfma_f32_16x16x32_bf16 a[248:251], v[104:107], v[248:251], a[248:251]
  ds_read_b64_tr_b16 v[172:173], v36 offset:32768
  v_mfma_f32_16x16x32_bf16 a[248:251], v[108:111], v[148:151], a[248:251]
  v_mfma_f32_16x16x32_bf16 a[252:255], v[116:119], v[148:151], a[252:255]
  ds_read_b64_tr_b16 v[174:175], v36 offset:34816
  v_mfma_f32_16x16x32_bf16 a[252:255], v[112:115], v[248:251], a[252:255]
  v_mfma_f32_16x16x32_bf16 a[244:247], v[112:115], v[244:247], a[244:247]
  ds_read_b128 v[80:83], v14 offset:38912
  v_mfma_f32_16x16x32_bf16 a[244:247], v[116:119], v[144:147], a[244:247]
  v_mfma_f32_16x16x32_bf16 a[240:243], v[108:111], v[144:147], a[240:243]
  ds_read_b64_tr_b16 v[176:177], v37 offset:32768
  v_mfma_f32_16x16x32_bf16 a[240:243], v[104:107], v[244:247], a[240:243]
  v_mfma_f32_16x16x32_bf16 a[232:235], v[104:107], v[240:243], a[232:235]
  ds_read_b64_tr_b16 v[178:179], v37 offset:34816
  v_mfma_f32_16x16x32_bf16 a[232:235], v[108:111], v[140:143], a[232:235]
  v_mfma_f32_16x16x32_bf16 a[236:239], v[116:119], v[140:143], a[236:239]
  ds_read_b128 v[84:87], v41 offset:38912
  v_mfma_f32_16x16x32_bf16 a[236:239], v[112:115], v[240:243], a[236:239]
  v_mfma_f32_16x16x32_bf16 a[228:231], v[112:115], v[236:239], a[228:231]
  ds_read_b64_tr_b16 v[180:181], v38 offset:32768
  v_mfma_f32_16x16x32_bf16 a[228:231], v[116:119], v[136:139], a[228:231]
  v_mfma_f32_16x16x32_bf16 a[224:227], v[108:111], v[136:139], a[224:227]
  ds_read_b64_tr_b16 v[182:183], v38 offset:34816
  v_mfma_f32_16x16x32_bf16 a[224:227], v[104:107], v[236:239], a[224:227]
  v_mfma_f32_16x16x32_bf16 a[216:219], v[104:107], v[228:231], a[216:219]
  v_mfma_f32_16x16x32_bf16 a[216:219], v[108:111], v[132:135], a[216:219]
  v_mfma_f32_16x16x32_bf16 a[220:223], v[116:119], v[132:135], a[220:223]
  v_mfma_f32_16x16x32_bf16 a[220:223], v[112:115], v[228:231], a[220:223]
  v_mfma_f32_16x16x32_bf16 a[212:215], v[112:115], v[224:227], a[212:215]
  v_mfma_f32_16x16x32_bf16 a[212:215], v[116:119], v[128:131], a[212:215]
  v_mfma_f32_16x16x32_bf16 a[208:211], v[108:111], v[128:131], a[208:211]
  v_mfma_f32_16x16x32_bf16 a[208:211], v[104:107], v[224:227], a[208:211]
  v_mfma_f32_16x16x32_bf16 a[200:203], v[104:107], v[220:223], a[200:203]
  v_mfma_f32_16x16x32_bf16 a[200:203], v[108:111], v[124:127], a[200:203]
  v_mfma_f32_16x16x32_bf16 a[204:207], v[116:119], v[124:127], a[204:207]
  v_mfma_f32_16x16x32_bf16 a[204:207], v[112:115], v[220:223], a[204:207]
  v_mfma_f32_16x16x32_bf16 a[196:199], v[112:115], v[216:219], a[196:199]
  v_mfma_f32_16x16x32_bf16 a[196:199], v[116:119], v[120:123], a[196:199]
  v_mfma_f32_16x16x32_bf16 a[192:195], v[108:111], v[120:123], a[192:195]
  v_mfma_f32_16x16x32_bf16 a[192:195], v[104:107], v[216:219], a[192:195]
  s_waitcnt lgkmcnt(0)
  s_waitcnt vmcnt(9)
  s_xor_b32 s32, s2, 56
  s_or_b32 s32, s32, s19
  s_cbranch_scc1 Lk_z17
  v_mov_b32 v2, 1
  v_mov_b32 v3, 0
  s_waitcnt vmcnt(0)
  global_store_dword v3, v2, s[50:51] sc1
Lk_z17:
  s_barrier
  v_mfma_f32_16x16x32_bf16 a[0:3], v[56:59], v[184:187], a[0:3]
  ds_read_b128 v[88:91], v14 offset:49152
  v_mfma_f32_16x16x32_bf16 a[0:3], v[60:63], v[152:155], a[0:3]
  v_mfma_f32_16x16x32_bf16 a[4:7], v[68:71], v[152:155], a[4:7]
  ds_read_b64_tr_b16 v[216:217], v15 offset:49152
  v_mfma_f32_16x16x32_bf16 a[4:7], v[64:67], v[184:187], a[4:7]
  ds_read_b64_tr_b16 v[232:233], v28 offset:0
  v_mfma_f32_16x16x32_bf16 a[12:15], v[64:67], v[188:191], a[12:15]
  ds_read_b64_tr_b16 v[218:219], v15 offset:51200
  v_mfma_f32_16x16x32_bf16 a[12:15], v[68:71], v[156:159], a[12:15]
  ds_read_b64_tr_b16 v[234:235], v28 offset:2048
  v_mfma_f32_16x16x32_bf16 a[8:11], v[60:63], v[156:159], a[8:11]
  ds_read_b128 v[92:95], v41 offset:49152
  v_mfma_f32_16x16x32_bf16 a[8:11], v[56:59], v[188:191], a[8:11]
  ds_read_b64_tr_b16 v[20:21], v29 offset:0
  v_mfma_f32_16x16x32_bf16 a[16:19], v[56:59], v[192:195], a[16:19]
  ds_read_b64_tr_b16 v[220:221], v32 offset:49152
  v_mfma_f32_16x16x32_bf16 a[16:19], v[60:63], v[160:163], a[16:19]
  ds_read_b64_tr_b16 v[22:23], v29 offset:2048
  v_mfma_f32_16x16x32_bf16 a[20:23], v[68:71], v[160:163], a[20:23]
  ds_read_b64_tr_b16 v[222:223], v32 offset:51200
  v_mfma_f32_16x16x32_bf16 a[20:23], v[64:67], v[192:195], a[20:23]
  v_mfma_f32_16x16x32_bf16 a[28:31], v[64:67], v[196:199], a[28:31]
  buffer_load_dwordx4 v6, s[20:23], s36 offen offset:0 lds
  v_mfma_f32_16x16x32_bf16 a[28:31], v[68:71], v[164:167], a[28:31]
  ds_read_b128 v[96:99], v14 offset:51200
  v_mfma_f32_16x16x32_bf16 a[24:27], v[60:63], v[164:167], a[24:27]
  v_mfma_f32_16x16x32_bf16 a[24:27], v[56:59], v[196:199], a[24:27]
  ds_read_b64_tr_b16 v[224:225], v33 offset:49152
  v_mfma_f32_16x16x32_bf16 a[32:35], v[56:59], v[200:203], a[32:35]
  v_mfma_f32_16x16x32_bf16 a[32:35], v[60:63], v[168:171], a[32:35]
  buffer_load_dwordx4 v7, s[20:23], s36 offen offset:1024 lds
  v_mfma_f32_16x16x32_bf16 a[36:39], v[68:71], v[168:171], a[36:39]
  ds_read_b64_tr_b16 v[226:227], v33 offset:51200
  v_mfma_f32_16x16x32_bf16 a[36:39], v[64:67], v[200:203], a[36:39]
  v_mfma_f32_16x16x32_bf16 a[44:47], v[64:67], v[204:207], a[44:47]
  ds_read_b128 v[100:103], v41 offset:51200
  v_mfma_f32_16x16x32_bf16 a[44:47], v[68:71], v[172:175], a[44:47]
  v_mfma_f32_16x16x32_bf16 a[40:43], v[60:63], v[172:175], a[40:43]
  buffer_load_dwordx4 v8, s[20:23], s36 offen offset:2048 lds
  v_mfma_f32_16x16x32_bf16 a[40:43], v[56:59], v[204:207], a[40:43]
  ds_read_b64_tr_b16 v[228:229], v34 offset:49152
  v_mfma_f32_16x16x32_bf16 a[48:51], v[56:59], v[208:211], a[48:51]
  s_waitcnt lgkmcnt(10)
  buffer_store_dwordx4 v[232:235], v52, s[28:31], s10 offen sc1
  v_mfma_f32_16x16x32_bf16 a[48:51], v[60:63], v[176:179], a[48:51]
  ds_read_b64_tr_b16 v[230:231], v34 offset:51200
  v_mfma_f32_16x16x32_bf16 a[52:55], v[68:71], v[176:179], a[52:55]
  v_mfma_f32_16x16x32_bf16 a[52:55], v[64:67], v[208:211], a[52:55]
  buffer_load_dwordx4 v9, s[20:23], s36 offen offset:3072 lds
  v_mfma_f32_16x16x32_bf16 a[60:63], v[64:67], v[212:215], a[60:63]
  s_sub_u32 s36, s36, 130944
  s_add_u32 m0, s34, 0x14000
  ds_read_b128 v[104:107], v14 offset:53248
  v_mfma_f32_16x16x32_bf16 a[60:63], v[68:71], v[180:183], a[60:63]
  v_mfma_f32_16x16x32_bf16 a[56:59], v[60:63], v[180:183], a[56:59]
  ds_read_b64_tr_b16 v[236:237], v35 offset:49152
  v_mfma_f32_16x16x32_bf16 a[56:59], v[56:59], v[212:215], a[56:59]
  v_mfma_f32_16x16x32_bf16 a[120:123], v[72:75], v[212:215], a[120:123]
  buffer_load_dwordx4 v10, s[24:27], s37 offen offset:0 lds
  v_mfma_f32_16x16x32_bf16 a[120:123], v[76:79], v[180:183], a[120:123]
  ds_read_b64_tr_b16 v[238:239], v35 offset:51200
  v_mfma_f32_16x16x32_bf16 a[124:127], v[84:87], v[180:183], a[124:127]
  v_mfma_f32_16x16x32_bf16 a[124:127], v[80:83], v[212:215], a[124:127]
  ds_read_b128 v[108:111], v41 offset:53248
  v_mfma_f32_16x16x32_bf16 a[116:119], v[80:83], v[208:211], a[116:119]
  v_mfma_f32_16x16x32_bf16 a[116:119], v[84:87], v[176:179], a[116:119]
  buffer_load_dwordx4 v11, s[24:27], s37 offen offset:1024 lds
  v_mfma_f32_16x16x32_bf16 a[112:115], v[76:79], v[176:179], a[112:115]
  ds_read_b64_tr_b16 v[240:241], v36 offset:49152
  v_mfma_f32_16x16x32_bf16 a[112:115], v[72:75], v[208:211], a[112:115]
  v_mfma_f32_16x16x32_bf16 a[104:107], v[72:75], v[204:207], a[104:107]
  ds_read_b64_tr_b16 v[242:243], v36 offset:51200
  v_mfma_f32_16x16x32_bf16 a[104:107], v[76:79], v[172:175], a[104:107]
  v_mfma_f32_16x16x32_bf16 a[108:111], v[84:87], v[172:175], a[108:111]
  buffer_load_dwordx4 v12, s[24:27], s37 offen offset:2048 lds
  v_mfma_f32_16x16x32_bf16 a[108:111], v[80:83], v[204:207], a[108:111]
  ds_read_b128 v[112:115], v14 offset:55296
  v_mfma_f32_16x16x32_bf16 a[100:103], v[80:83], v[200:203], a[100:103]
  v_mfma_f32_16x16x32_bf16 a[100:103], v[84:87], v[168:171], a[100:103]
  ds_read_b64_tr_b16 v[244:245], v37 offset:49152
  v_mfma_f32_16x16x32_bf16 a[96:99], v[76:79], v[168:171], a[96:99]
  v_mfma_f32_16x16x32_bf16 a[96:99], v[72:75], v[200:203], a[96:99]
  buffer_load_dwordx4 v13, s[24:27], s37 offen offset:3072 lds
  v_mfma_f32_16x16x32_bf16 a[88:91], v[72:75], v[196:199], a[88:91]
  s_add_u32 s37, s37, 0x40000
  s_add_u32 m0, s34, 0x8000
  ds_read_b64_tr_b16 v[246:247], v37 offset:51200
  v_mfma_f32_16x16x32_bf16 a[88:91], v[76:79], v[164:167], a[88:91]
  v_mfma_f32_16x16x32_bf16 a[92:95], v[84:87], v[164:167], a[92:95]
  ds_read_b128 v[116:119], v41 offset:55296
  v_mfma_f32_16x16x32_bf16 a[92:95], v[80:83], v[196:199], a[92:95]
  v_mfma_f32_16x16x32_bf16 a[84:87], v[80:83], v[192:195], a[84:87]
  buffer_load_dwordx4 v6, s[20:23], s36 offen offset:0 lds
  v_mfma_f32_16x16x32_bf16 a[84:87], v[84:87], v[160:163], a[84:87]
  ds_read_b64_tr_b16 v[248:249], v38 offset:49152
  v_mfma_f32_16x16x32_bf16 a[80:83], v[76:79], v[160:163], a[80:83]
  s_waitcnt lgkmcnt(15)
  buffer_store_dwordx4 v[20:23], v52, s[28:31], s11 offen sc1
  v_mfma_f32_16x16x32_bf16 a[80:83], v[72:75], v[192:195], a[80:83]
  ds_read_b64_tr_b16 v[250:251], v38 offset:51200
  v_mfma_f32_16x16x32_bf16 a[72:75], v[72:75], v[188:191], a[72:75]
  v_mfma_f32_16x16x32_bf16 a[72:75], v[76:79], v[156:159], a[72:75]
  buffer_load_dwordx4 v7, s[20:23], s36 offen offset:1024 lds
  v_mfma_f32_16x16x32_bf16 a[76:79], v[84:87], v[156:159], a[76:79]
  v_mfma_f32_16x16x32_bf16 a[76:79], v[80:83], v[188:191], a[76:79]
  v_mfma_f32_16x16x32_bf16 a[68:71], v[80:83], v[184:187], a[68:71]
  v_mfma_f32_16x16x32_bf16 a[68:71], v[84:87], v[152:155], a[68:71]
  v_mfma_f32_16x16x32_bf16 a[64:67], v[76:79], v[152:155], a[64:67]
  v_mfma_f32_16x16x32_bf16 a[64:67], v[72:75], v[184:187], a[64:67]
  s_waitcnt lgkmcnt(0)
  s_waitcnt vmcnt(13)
  s_barrier
  v_mfma_f32_16x16x32_bf16 a[128:131], v[88:91], v[184:187], a[128:131]
  ds_read_b128 v[56:59], v14 offset:0
  v_mfma_f32_16x16x32_bf16 a[128:131], v[92:95], v[152:155], a[128:131]
  buffer_load_dwordx4 v8, s[20:23], s36 offen offset:2048 lds
  v_mfma_f32_16x16x32_bf16 a[132:135], v[100:103], v[152:155], a[132:135]
  ds_read_b64_tr_b16 v[120:121], v15 offset:0
  v_mfma_f32_16x16x32_bf16 a[132:135], v[96:99], v[184:187], a[132:135]
  ds_read_b64_tr_b16 v[232:233], v30 offset:0
  v_mfma_f32_16x16x32_bf16 a[140:143], v[96:99], v[188:191], a[140:143]
  ds_read_b64_tr_b16 v[122:123], v15 offset:2048
  v_mfma_f32_16x16x32_bf16 a[140:143], v[100:103], v[156:159], a[140:143]
  ds_read_b64_tr_b16 v[234:235], v30 offset:2048
  v_mfma_f32_16x16x32_bf16 a[136:139], v[92:95], v[156:159], a[136:139]
  ds_read_b128 v[60:63], v41 offset:0
  v_mfma_f32_16x16x32_bf16 a[136:139], v[88:91], v[188:191], a[136:139]
  buffer_load_dwordx4 v9, s[20:23], s36 offen offset:3072 lds
  v_mfma_f32_16x16x32_bf16 a[144:147], v[88:91], v[192:195], a[144:147]
  s_add_u32 s36, s36, 131072
  s_add_u32 m0, s34, 0x18000
  ds_read_b64_tr_b16 v[124:125], v32 offset:0
  v_mfma_f32_16x16x32_bf16 a[144:147], v[92:95], v[160:163], a[144:147]
  ds_read_b64_tr_b16 v[20:21], v31 offset:0
  v_mfma_f32_16x16x32_bf16 a[148:151], v[100:103], v[160:163], a[148:151]
  ds_read_b64_tr_b16 v[126:127], v32 offset:2048
  v_mfma_f32_16x16x32_bf16 a[148:151], v[96:99], v[192:195], a[148:151]
  ds_read_b64_tr_b16 v[22:23], v31 offset:2048
  v_mfma_f32_16x16x32_bf16 a[156:159], v[96:99], v[196:199], a[156:159]
  ds_read_b128 v[64:67], v14 offset:2048
  v_mfma_f32_16x16x32_bf16 a[156:159], v[100:103], v[164:167], a[156:159]
  buffer_load_dwordx4 v10, s[24:27], s37 offen offset:0 lds
  v_mfma_f32_16x16x32_bf16 a[152:155], v[92:95], v[164:167], a[152:155]
  ds_read_b64_tr_b16 v[128:129], v33 offset:0
  v_mfma_f32_16x16x32_bf16 a[152:155], v[88:91], v[196:199], a[152:155]
  v_mfma_f32_16x16x32_bf16 a[160:163], v[88:91], v[200:203], a[160:163]
  ds_read_b64_tr_b16 v[130:131], v33 offset:2048
  v_mfma_f32_16x16x32_bf16 a[160:163], v[92:95], v[168:171], a[160:163]
  v_mfma_f32_16x16x32_bf16 a[164:167], v[100:103], v[168:171], a[164:167]
  ds_read_b128 v[68:71], v41 offset:2048
  v_mfma_f32_16x16x32_bf16 a[164:167], v[96:99], v[200:203], a[164:167]
  buffer_load_dwordx4 v11, s[24:27], s37 offen offset:1024 lds
  v_mfma_f32_16x16x32_bf16 a[172:175], v[96:99], v[204:207], a[172:175]
  ds_read_b64_tr_b16 v[132:133], v34 offset:0
  v_mfma_f32_16x16x32_bf16 a[172:175], v[100:103], v[172:175], a[172:175]
  v_mfma_f32_16x16x32_bf16 a[168:171], v[92:95], v[172:175], a[168:171]
  ds_read_b64_tr_b16 v[134:135], v34 offset:2048
  v_mfma_f32_16x16x32_bf16 a[168:171], v[88:91], v[204:207], a[168:171]
  v_mfma_f32_16x16x32_bf16 a[176:179], v[88:91], v[208:211], a[176:179]
  ds_read_b128 v[72:75], v14 offset:4096
  v_mfma_f32_16x16x32_bf16 a[176:179], v[92:95], v[176:179], a[176:179]
  buffer_load_dwordx4 v12, s[24:27], s37 offen offset:2048 lds
  v_mfma_f32_16x16x32_bf16 a[180:183], v[100:103], v[176:179], a[180:183]
  ds_read_b64_tr_b16 v[136:137], v35 offset:0
  v_mfma_f32_16x16x32_bf16 a[180:183], v[96:99], v[208:211], a[180:183]
  s_waitcnt lgkmcnt(13)
  buffer_store_dwordx4 v[232:235], v52, s[28:31], s12 offen sc1
  v_mfma_f32_16x16x32_bf16 a[188:191], v[96:99], v[212:215], a[188:191]
  ds_read_b64_tr_b16 v[138:139], v35 offset:2048
  v_mfma_f32_16x16x32_bf16 a[188:191], v[100:103], v[180:183], a[188:191]
  v_mfma_f32_16x16x32_bf16 a[184:187], v[92:95], v[180:183], a[184:187]
  ds_read_b128 v[76:79], v41 offset:4096
  v_mfma_f32_16x16x32_bf16 a[184:187], v[88:91], v[212:215], a[184:187]
  buffer_load_dwordx4 v13, s[24:27], s37 offen offset:3072 lds
  v_mfma_f32_16x16x32_bf16 a[248:251], v[104:107], v[212:215], a[248:251]
  s_add_u32 s37, s37, 0x40000
  s_add_u32 m0, s34, 0xc000
  ds_read_b64_tr_b16 v[140:141], v36 offset:0
  v_mfma_f32_16x16x32_bf16 a[248:251], v[108:111], v[180:183], a[248:251]
  v_mfma_f32_16x16x32_bf16 a[252:255], v[116:119], v[180:183], a[252:255]
  ds_read_b64_tr_b16 v[142:143], v36 offset:2048
  v_mfma_f32_16x16x32_bf16 a[252:255], v[112:115], v[212:215], a[252:255]
  v_mfma_f32_16x16x32_bf16 a[244:247], v[112:115], v[208:211], a[244:247]
  ds_read_b128 v[80:83], v14 offset:6144
  v_mfma_f32_16x16x32_bf16 a[244:247], v[116:119], v[176:179], a[244:247]
  buffer_load_dwordx4 v6, s[20:23], s36 offen offset:0 lds
  v_mfma_f32_16x16x32_bf16 a[240:243], v[108:111], v[176:179], a[240:243]
  ds_read_b64_tr_b16 v[144:145], v37 offset:0
  v_mfma_f32_16x16x32_bf16 a[240:243], v[104:107], v[208:211], a[240:243]
  v_mfma_f32_16x16x32_bf16 a[232:235], v[104:107], v[204:207], a[232:235]
  ds_read_b64_tr_b16 v[146:147], v37 offset:2048
  v_mfma_f32_16x16x32_bf16 a[232:235], v[108:111], v[172:175], a[232:235]
  v_mfma_f32_16x16x32_bf16 a[236:239], v[116:119], v[172:175], a[236:239]
  ds_read_b128 v[84:87], v41 offset:6144
  v_mfma_f32_16x16x32_bf16 a[236:239], v[112:115], v[204:207], a[236:239]
  buffer_load_dwordx4 v7, s[20:23], s36 offen offset:1024 lds
  v_mfma_f32_16x16x32_bf16 a[228:231], v[112:115], v[200:203], a[228:231]
  ds_read_b64_tr_b16 v[148:149], v38 offset:0
  v_mfma_f32_16x16x32_bf16 a[228:231], v[116:119], v[168:171], a[228:231]
  v_mfma_f32_16x16x32_bf16 a[224:227], v[108:111], v[168:171], a[224:227]
  ds_read_b64_tr_b16 v[150:151], v38 offset:2048
  v_mfma_f32_16x16x32_bf16 a[224:227], v[104:107], v[200:203], a[224:227]
  v_mfma_f32_16x16x32_bf16 a[216:219], v[104:107], v[196:199], a[216:219]
  v_mfma_f32_16x16x32_bf16 a[216:219], v[108:111], v[164:167], a[216:219]
  buffer_load_dwordx4 v8, s[20:23], s36 offen offset:2048 lds
  v_mfma_f32_16x16x32_bf16 a[220:223], v[116:119], v[164:167], a[220:223]
  v_mfma_f32_16x16x32_bf16 a[220:223], v[112:115], v[196:199], a[220:223]
  v_mfma_f32_16x16x32_bf16 a[212:215], v[112:115], v[192:195], a[212:215]
  v_mfma_f32_16x16x32_bf16 a[212:215], v[116:119], v[160:163], a[212:215]
  v_mfma_f32_16x16x32_bf16 a[208:211], v[108:111], v[160:163], a[208:211]
  v_mfma_f32_16x16x32_bf16 a[208:211], v[104:107], v[192:195], a[208:211]
  buffer_load_dwordx4 v9, s[20:23], s36 offen offset:3072 lds
  v_mfma_f32_16x16x32_bf16 a[200:203], v[104:107], v[188:191], a[200:203]
  s_sub_u32 s36, s36, 130944
  s_waitcnt lgkmcnt(15)
  buffer_store_dwordx4 v[20:23], v52, s[28:31], s13 offen sc1
  v_mfma_f32_16x16x32_bf16 a[200:203], v[108:111], v[156:159], a[200:203]
  v_mfma_f32_16x16x32_bf16 a[204:207], v[116:119], v[156:159], a[204:207]
  v_mfma_f32_16x16x32_bf16 a[204:207], v[112:115], v[188:191], a[204:207]
  v_mfma_f32_16x16x32_bf16 a[196:199], v[112:115], v[184:187], a[196:199]
  v_mfma_f32_16x16x32_bf16 a[196:199], v[116:119], v[152:155], a[196:199]
  v_mfma_f32_16x16x32_bf16 a[192:195], v[108:111], v[152:155], a[192:195]
  v_mfma_f32_16x16x32_bf16 a[192:195], v[104:107], v[184:187], a[192:195]
  s_waitcnt lgkmcnt(0)
  s_waitcnt vmcnt(15)
  s_barrier
  v_mfma_f32_16x16x32_bf16 a[0:3], v[56:59], v[216:219], a[0:3]
  s_mov_b32 s36, 0
  s_mov_b32 s37, 0
  ds_read_b128 v[88:91], v14 offset:16384
  v_mfma_f32_16x16x32_bf16 a[0:3], v[60:63], v[120:123], a[0:3]
  s_add_u32 m0, s48, 0x0
  v_mfma_f32_16x16x32_bf16 a[4:7], v[68:71], v[120:123], a[4:7]
  buffer_load_dwordx4 v55, s[52:55], s49 offen lds
  v_mfma_f32_16x16x32_bf16 a[4:7], v[64:67], v[216:219], a[4:7]
  s_add_u32 m0, s34, 0x10000
  s_add_u32 s49, s49, s47
  ds_write_b128 v52, v[48:51] offset:13312
  v_mfma_f32_16x16x32_bf16 a[12:15], v[64:67], v[220:223], a[12:15]
  ds_read_b64_tr_b16 v[232:233], v28 offset:4096
  v_mfma_f32_16x16x32_bf16 a[12:15], v[68:71], v[124:127], a[12:15]
  ds_read_b64_tr_b16 v[184:185], v15 offset:16384
  v_mfma_f32_16x16x32_bf16 a[8:11], v[60:63], v[124:127], a[8:11]
  ds_read_b64_tr_b16 v[234:235], v28 offset:6144
  v_mfma_f32_16x16x32_bf16 a[8:11], v[56:59], v[220:223], a[8:11]
  ds_read_b64_tr_b16 v[186:187], v15 offset:18432
  v_mfma_f32_16x16x32_bf16 a[16:19], v[56:59], v[224:227], a[16:19]
  ds_read_b64_tr_b16 v[20:21], v29 offset:4096
  v_mfma_f32_16x16x32_bf16 a[16:19], v[60:63], v[128:131], a[16:19]
  ds_read_b128 v[92:95], v41 offset:16384
  v_mfma_f32_16x16x32_bf16 a[20:23], v[68:71], v[128:131], a[20:23]
  buffer_load_dwordx4 v10, s[60:63], s37 offen offset:0 lds
  v_mfma_f32_16x16x32_bf16 a[20:23], v[64:67], v[224:227], a[20:23]
  ds_read_b64_tr_b16 v[22:23], v29 offset:6144
  v_mfma_f32_16x16x32_bf16 a[28:31], v[64:67], v[228:231], a[28:31]
  ds_read_b64_tr_b16 v[188:189], v32 offset:16384
  v_mfma_f32_16x16x32_bf16 a[28:31], v[68:71], v[132:135], a[28:31]
  v_mfma_f32_16x16x32_bf16 a[24:27], v[60:63], v[132:135], a[24:27]
  ds_read_b64_tr_b16 v[190:191], v32 offset:18432
  v_mfma_f32_16x16x32_bf16 a[24:27], v[56:59], v[228:231], a[24:27]
  v_mfma_f32_16x16x32_bf16 a[32:35], v[56:59], v[236:239], a[32:35]
  ds_read_b128 v[96:99], v14 offset:18432
  v_mfma_f32_16x16x32_bf16 a[32:35], v[60:63], v[136:139], a[32:35]
  v_mfma_f32_16x16x32_bf16 a[36:39], v[68:71], v[136:139], a[36:39]
  buffer_load_dwordx4 v11, s[60:63], s37 offen offset:1024 lds
  v_mfma_f32_16x16x32_bf16 a[36:39], v[64:67], v[236:239], a[36:39]
  ds_read_b64_tr_b16 v[192:193], v33 offset:16384
  v_mfma_f32_16x16x32_bf16 a[44:47], v[64:67], v[240:243], a[44:47]
  v_mfma_f32_16x16x32_bf16 a[44:47], v[68:71], v[140:143], a[44:47]
  ds_read_b64_tr_b16 v[194:195], v33 offset:18432
  v_mfma_f32_16x16x32_bf16 a[40:43], v[60:63], v[140:143], a[40:43]
  v_mfma_f32_16x16x32_bf16 a[40:43], v[56:59], v[240:243], a[40:43]
  ds_read_b128 v[100:103], v41 offset:18432
  v_mfma_f32_16x16x32_bf16 a[48:51], v[56:59], v[244:247], a[48:51]
  s_waitcnt lgkmcnt(10)
  buffer_store_dwordx4 v[232:235], v52, s[28:31], s98 offen sc1
  v_mfma_f32_16x16x32_bf16 a[48:51], v[60:63], v[144:147], a[48:51]
  ds_read_b64_tr_b16 v[196:197], v34 offset:16384
  v_mfma_f32_16x16x32_bf16 a[52:55], v[68:71], v[144:147], a[52:55]
  buffer_load_dwordx4 v12, s[60:63], s37 offen offset:2048 lds
  v_mfma_f32_16x16x32_bf16 a[52:55], v[64:67], v[244:247], a[52:55]
  ds_read_b64_tr_b16 v[198:199], v34 offset:18432
  v_mfma_f32_16x16x32_bf16 a[60:63], v[64:67], v[248:251], a[60:63]
  v_mfma_f32_16x16x32_bf16 a[60:63], v[68:71], v[148:151], a[60:63]
  ds_read_b128 v[104:107], v14 offset:20480
  v_mfma_f32_16x16x32_bf16 a[56:59], v[60:63], v[148:151], a[56:59]
  v_mfma_f32_16x16x32_bf16 a[56:59], v[56:59], v[248:251], a[56:59]
  ds_read_b64_tr_b16 v[200:201], v35 offset:16384
  v_mfma_f32_16x16x32_bf16 a[120:123], v[72:75], v[248:251], a[120:123]
  v_mfma_f32_16x16x32_bf16 a[120:123], v[76:79], v[148:151], a[120:123]
  ds_read_b64_tr_b16 v[202:203], v35 offset:18432
  v_mfma_f32_16x16x32_bf16 a[124:127], v[84:87], v[148:151], a[124:127]
  buffer_load_dwordx4 v13, s[60:63], s37 offen offset:3072 lds
  v_mfma_f32_16x16x32_bf16 a[124:127], v[80:83], v[248:251], a[124:127]
  s_add_u32 s37, s37, 0x40000
  s_mov_b32 m0, 0x3000
  ds_read_b128 v[108:111], v41 offset:20480
  v_mfma_f32_16x16x32_bf16 a[116:119], v[80:83], v[244:247], a[116:119]
  v_mfma_f32_16x16x32_bf16 a[116:119], v[84:87], v[144:147], a[116:119]
  ds_read_b64_tr_b16 v[204:205], v36 offset:16384
  v_mfma_f32_16x16x32_bf16 a[112:115], v[76:79], v[144:147], a[112:115]
  v_mfma_f32_16x16x32_bf16 a[112:115], v[72:75], v[244:247], a[112:115]
  ds_read_b64_tr_b16 v[206:207], v36 offset:18432
  v_mfma_f32_16x16x32_bf16 a[104:107], v[72:75], v[240:243], a[104:107]
  v_mfma_f32_16x16x32_bf16 a[104:107], v[76:79], v[140:143], a[104:107]
  ds_read_b128 v[112:115], v14 offset:22528
  v_mfma_f32_16x16x32_bf16 a[108:111], v[84:87], v[140:143], a[108:111]
  buffer_load_dwordx4 v52, s[68:71], 0 offen lds
  v_mfma_f32_16x16x32_bf16 a[108:111], v[80:83], v[240:243], a[108:111]
  ds_read_b64_tr_b16 v[208:209], v37 offset:16384
  v_mfma_f32_16x16x32_bf16 a[100:103], v[80:83], v[236:239], a[100:103]
  v_mfma_f32_16x16x32_bf16 a[100:103], v[84:87], v[136:139], a[100:103]
  ds_read_b64_tr_b16 v[210:211], v37 offset:18432
  v_mfma_f32_16x16x32_bf16 a[96:99], v[76:79], v[136:139], a[96:99]
  v_mfma_f32_16x16x32_bf16 a[96:99], v[72:75], v[236:239], a[96:99]
  ds_read_b128 v[116:119], v41 offset:22528
  v_mfma_f32_16x16x32_bf16 a[88:91], v[72:75], v[228:231], a[88:91]
  v_mfma_f32_16x16x32_bf16 a[88:91], v[76:79], v[132:135], a[88:91]
  ds_read_b64_tr_b16 v[212:213], v38 offset:16384
  v_mfma_f32_16x16x32_bf16 a[92:95], v[84:87], v[132:135], a[92:95]
  v_mfma_f32_16x16x32_bf16 a[92:95], v[80:83], v[228:231], a[92:95]
  ds_read_b64_tr_b16 v[214:215], v38 offset:18432
  v_mfma_f32_16x16x32_bf16 a[84:87], v[80:83], v[224:227], a[84:87]
  s_waitcnt lgkmcnt(15)
  buffer_store_dwordx4 v[20:23], v52, s[28:31], s99 offen sc1
  v_mfma_f32_16x16x32_bf16 a[84:87], v[84:87], v[128:131], a[84:87]
  v_mfma_f32_16x16x32_bf16 a[80:83], v[76:79], v[128:131], a[80:83]
  v_mfma_f32_16x16x32_bf16 a[80:83], v[72:75], v[224:227], a[80:83]
  v_mfma_f32_16x16x32_bf16 a[72:75], v[72:75], v[220:223], a[72:75]
  v_mfma_f32_16x16x32_bf16 a[72:75], v[76:79], v[124:127], a[72:75]
  v_mfma_f32_16x16x32_bf16 a[76:79], v[84:87], v[124:127], a[76:79]
  v_mfma_f32_16x16x32_bf16 a[76:79], v[80:83], v[220:223], a[76:79]
  v_mfma_f32_16x16x32_bf16 a[68:71], v[80:83], v[216:219], a[68:71]
  v_mfma_f32_16x16x32_bf16 a[68:71], v[84:87], v[120:123], a[68:71]
  v_mfma_f32_16x16x32_bf16 a[64:67], v[76:79], v[120:123], a[64:67]
  v_mfma_f32_16x16x32_bf16 a[64:67], v[72:75], v[216:219], a[64:67]
  s_waitcnt lgkmcnt(0)
  s_waitcnt vmcnt(13)
  s_barrier
  v_mfma_f32_16x16x32_bf16 a[128:131], v[88:91], v[216:219], a[128:131]
  s_add_u32 m0, s35, 0x0
  s_mov_b32 s4, s14
  ds_read_b128 v[56:59], v14 offset:32768
  v_mfma_f32_16x16x32_bf16 a[128:131], v[92:95], v[120:123], a[128:131]
  s_and_b32 s5, s15, 0xffff
  s_mov_b32 s6, 0x62000
  buffer_load_dwordx4 v53, s[56:59], s36 offen offset:0 lds
  v_mfma_f32_16x16x32_bf16 a[132:135], v[100:103], v[120:123], a[132:135]
  s_add_u32 m0, s35, 0x3fc0
  s_mov_b32 s7, 0x20000
  ds_read_b64_tr_b16 v[152:153], v15 offset:32768
  v_mfma_f32_16x16x32_bf16 a[132:135], v[96:99], v[216:219], a[132:135]
  s_lshl_b32 s69, s17, 20
  s_mul_i32 s79, s17, 229376
  ds_read_b64_tr_b16 v[232:233], v30 offset:4096
  v_mfma_f32_16x16x32_bf16 a[140:143], v[96:99], v[220:223], a[140:143]
  s_mov_b32 s8, s74
  s_and_b32 s9, s75, 0xffff
  ds_read_b64_tr_b16 v[154:155], v15 offset:34816
  v_mfma_f32_16x16x32_bf16 a[140:143], v[100:103], v[124:127], a[140:143]
  s_mov_b32 s10, 0x0
  s_mov_b32 s11, 0x20000
  ds_read_b64_tr_b16 v[234:235], v30 offset:6144
  v_mfma_f32_16x16x32_bf16 a[136:139], v[92:95], v[124:127], a[136:139]
  s_add_u32 s10, s79, 0x2038000
  ds_read_b128 v[60:63], v41 offset:32768
  v_mfma_f32_16x16x32_bf16 a[136:139], v[88:91], v[220:223], a[136:139]
  s_add_u32 s12, s74, 0x1000000
  s_addc_u32 s13, s75, 0
  buffer_load_dwordx4 v53, s[56:59], s36 offen offset:64 lds
  v_mfma_f32_16x16x32_bf16 a[144:147], v[88:91], v[224:227], a[144:147]
  s_add_u32 m0, s35, 0x0
  s_and_b32 s13, s13, 0xffff
  ds_read_b64_tr_b16 v[20:21], v31 offset:4096
  v_mfma_f32_16x16x32_bf16 a[144:147], v[92:95], v[128:131], a[144:147]
  s_mov_b32 s14, 0x0
  s_mov_b32 s15, 0x20000
  ds_read_b64_tr_b16 v[156:157], v32 offset:32768
  v_mfma_f32_16x16x32_bf16 a[148:151], v[100:103], v[128:131], a[148:151]
  s_add_u32 s14, s79, 0x2030800
  ds_read_b64_tr_b16 v[22:23], v31 offset:6144
  v_mfma_f32_16x16x32_bf16 a[148:151], v[96:99], v[224:227], a[148:151]
  s_add_u32 s20, s74, 0x4f00000
  s_addc_u32 s21, s75, 0
  ds_read_b64_tr_b16 v[158:159], v32 offset:34816
  v_mfma_f32_16x16x32_bf16 a[156:159], v[96:99], v[228:231], a[156:159]
  s_and_b32 s21, s21, 0xffff
  s_mov_b32 s22, 0x8000
  s_mov_b32 s23, 0x20000
  v_mfma_f32_16x16x32_bf16 a[156:159], v[100:103], v[132:135], a[156:159]
  s_mov_b32 s24, s50
  s_and_b32 s25, s51, 0xffff
  buffer_load_dwordx4 v54, s[56:59], s36 offen offset:1024 lds
  v_mfma_f32_16x16x32_bf16 a[152:155], v[92:95], v[132:135], a[152:155]
  s_add_u32 m0, s35, 0x3fc0
  s_mov_b32 s26, 0x100
  ds_read_b128 v[64:67], v14 offset:34816
  v_mfma_f32_16x16x32_bf16 a[152:155], v[88:91], v[228:231], a[152:155]
  s_mov_b32 s27, 0x20000
  s_mov_b32 s72, 0x21212224
  s_mov_b32 s73, 0x24202121
  v_mfma_f32_16x16x32_bf16 a[160:163], v[88:91], v[236:239], a[160:163]
  s_sub_u32 s79, 7, s16
  s_lshl_b32 s79, s79, 3
  ds_read_b64_tr_b16 v[160:161], v33 offset:32768
  v_mfma_f32_16x16x32_bf16 a[160:163], v[92:95], v[136:139], a[160:163]
  s_lshr_b64 s[72:73], s[72:73], s79
  s_and_b32 s72, s72, 0xff
  s_add_u32 s70, s69, 0x4000
  v_mfma_f32_16x16x32_bf16 a[164:167], v[100:103], v[136:139], a[164:167]
  s_add_u32 s71, s69, 0x8000
  s_lshr_b32 s73, s79, 3
  ds_read_b64_tr_b16 v[162:163], v33 offset:34816
  v_mfma_f32_16x16x32_bf16 a[164:167], v[96:99], v[236:239], a[164:167]
  s_add_u32 s51, s17, 176
  s_lshl_b32 s51, s51, 7
  buffer_load_dwordx4 v54, s[56:59], s36 offen offset:1088 lds
  v_mfma_f32_16x16x32_bf16 a[172:175], v[96:99], v[240:243], a[172:175]
  s_add_u32 s36, s36, 128
  s_add_u32 m0, s48, 0x4000
  ds_read_b128 v[68:71], v41 offset:34816
  v_mfma_f32_16x16x32_bf16 a[172:175], v[100:103], v[140:143], a[172:175]
  s_cmp_eq_u32 s19, 0
  s_cselect_b32 s79, s51, 0x100000
  v_add_u32 v9, s34, v52
  v_mfma_f32_16x16x32_bf16 a[168:171], v[92:95], v[140:143], a[168:171]
  ds_read_b64_tr_b16 v[164:165], v34 offset:32768
  v_mov_b32 v6, s79
  v_mfma_f32_16x16x32_bf16 a[168:171], v[88:91], v[240:243], a[168:171]
  v_mov_b32 v7, 4
  v_add_u32 v8, s97, v52
  v_mfma_f32_16x16x32_bf16 a[176:179], v[88:91], v[244:247], a[176:179]
  s_waitcnt lgkmcnt(10)
  buffer_store_dwordx4 v[232:235], v52, s[28:31], s100 offen sc1
  v_mfma_f32_16x16x32_bf16 a[176:179], v[92:95], v[144:147], a[176:179]
  buffer_load_dwordx4 v55, s[52:55], s49 offen lds
  v_mfma_f32_16x16x32_bf16 a[180:183], v[100:103], v[144:147], a[180:183]
  s_add_u32 m0, s34, 0x14000
  s_add_u32 s49, s49, s47
  ds_read_b64_tr_b16 v[166:167], v34 offset:34816
  v_mfma_f32_16x16x32_bf16 a[180:183], v[96:99], v[244:247], a[180:183]
  v_mfma_f32_16x16x32_bf16 a[188:191], v[96:99], v[248:251], a[188:191]
  ds_read_b128 v[72:75], v14 offset:36864
  v_mfma_f32_16x16x32_bf16 a[188:191], v[100:103], v[148:151], a[188:191]
  v_mfma_f32_16x16x32_bf16 a[184:187], v[92:95], v[148:151], a[184:187]
  ds_read_b64_tr_b16 v[168:169], v35 offset:32768
  v_mfma_f32_16x16x32_bf16 a[184:187], v[88:91], v[248:251], a[184:187]
  buffer_load_dwordx4 v10, s[60:63], s37 offen offset:0 lds
  v_mfma_f32_16x16x32_bf16 a[248:251], v[104:107], v[248:251], a[248:251]
  ds_read_b64_tr_b16 v[170:171], v35 offset:34816
  v_mfma_f32_16x16x32_bf16 a[248:251], v[108:111], v[148:151], a[248:251]
  v_mfma_f32_16x16x32_bf16 a[252:255], v[116:119], v[148:151], a[252:255]
  ds_read_b128 v[76:79], v41 offset:36864
  v_mfma_f32_16x16x32_bf16 a[252:255], v[112:115], v[248:251], a[252:255]
  v_mfma_f32_16x16x32_bf16 a[244:247], v[112:115], v[244:247], a[244:247]
  ds_read_b64_tr_b16 v[172:173], v36 offset:32768
  v_mfma_f32_16x16x32_bf16 a[244:247], v[116:119], v[144:147], a[244:247]
  buffer_load_dwordx4 v11, s[60:63], s37 offen offset:1024 lds
  v_mfma_f32_16x16x32_bf16 a[240:243], v[108:111], v[144:147], a[240:243]
  ds_read_b64_tr_b16 v[174:175], v36 offset:34816
  v_mfma_f32_16x16x32_bf16 a[240:243], v[104:107], v[244:247], a[240:243]
  v_mfma_f32_16x16x32_bf16 a[232:235], v[104:107], v[240:243], a[232:235]
  ds_read_b128 v[80:83], v14 offset:38912
  v_mfma_f32_16x16x32_bf16 a[232:235], v[108:111], v[140:143], a[232:235]
  v_mfma_f32_16x16x32_bf16 a[236:239], v[116:119], v[140:143], a[236:239]
  ds_read_b64_tr_b16 v[176:177], v37 offset:32768
  v_mfma_f32_16x16x32_bf16 a[236:239], v[112:115], v[240:243], a[236:239]
  buffer_load_dwordx4 v12, s[60:63], s37 offen offset:2048 lds
  v_mfma_f32_16x16x32_bf16 a[228:231], v[112:115], v[236:239], a[228:231]
  ds_read_b64_tr_b16 v[178:179], v37 offset:34816
  v_mfma_f32_16x16x32_bf16 a[228:231], v[116:119], v[136:139], a[228:231]
  v_mfma_f32_16x16x32_bf16 a[224:227], v[108:111], v[136:139], a[224:227]
  ds_read_b128 v[84:87], v41 offset:38912
  v_mfma_f32_16x16x32_bf16 a[224:227], v[104:107], v[236:239], a[224:227]
  v_mfma_f32_16x16x32_bf16 a[216:219], v[104:107], v[228:231], a[216:219]
  ds_read_b64_tr_b16 v[180:181], v38 offset:32768
  v_mfma_f32_16x16x32_bf16 a[216:219], v[108:111], v[132:135], a[216:219]
  buffer_load_dwordx4 v13, s[60:63], s37 offen offset:3072 lds
  v_mfma_f32_16x16x32_bf16 a[220:223], v[116:119], v[132:135], a[220:223]
  s_add_u32 s37, s37, 0x40000
  ds_read_b64_tr_b16 v[182:183], v38 offset:34816
  v_mfma_f32_16x16x32_bf16 a[220:223], v[112:115], v[228:231], a[220:223]
  v_mfma_f32_16x16x32_bf16 a[212:215], v[112:115], v[224:227], a[212:215]
  s_waitcnt lgkmcnt(15)
  buffer_store_dwordx4 v[20:23], v52, s[28:31], s101 offen sc1
  v_mfma_f32_16x16x32_bf16 a[212:215], v[116:119], v[128:131], a[212:215]
  v_mfma_f32_16x16x32_bf16 a[208:211], v[108:111], v[128:131], a[208:211]
  v_mfma_f32_16x16x32_bf16 a[208:211], v[104:107], v[224:227], a[208:211]
  v_mfma_f32_16x16x32_bf16 a[200:203], v[104:107], v[220:223], a[200:203]
  v_mfma_f32_16x16x32_bf16 a[200:203], v[108:111], v[124:127], a[200:203]
  v_mfma_f32_16x16x32_bf16 a[204:207], v[116:119], v[124:127], a[204:207]
  v_mfma_f32_16x16x32_bf16 a[204:207], v[112:115], v[220:223], a[204:207]
  v_mfma_f32_16x16x32_bf16 a[196:199], v[112:115], v[216:219], a[196:199]
  v_mfma_f32_16x16x32_bf16 a[196:199], v[116:119], v[120:123], a[196:199]
  v_mfma_f32_16x16x32_bf16 a[192:195], v[108:111], v[120:123], a[192:195]
  v_mfma_f32_16x16x32_bf16 a[192:195], v[104:107], v[216:219], a[192:195]
  s_waitcnt lgkmcnt(0)
  s_waitcnt vmcnt(20)
  s_barrier
  v_mfma_f32_16x16x32_bf16 a[0:3], v[56:59], v[184:187], a[0:3]
  s_add_u32 m0, s48, 0x8000
  ds_read_b128 v[88:91], v14 offset:49152
  v_mfma_f32_16x16x32_bf16 a[0:3], v[60:63], v[152:155], a[0:3]
  buffer_load_dwordx4 v55, s[52:55], s49 offen lds
  v_mfma_f32_16x16x32_bf16 a[4:7], v[68:71], v[152:155], a[4:7]
  s_add_u32 m0, s34, 0x18000
  s_add_u32 s49, s49, s47
  ds_read_b128 v[92:95], v41 offset:49152
  v_mfma_f32_16x16x32_bf16 a[4:7], v[64:67], v[184:187], a[4:7]
  v_mfma_f32_16x16x32_bf16 a[12:15], v[64:67], v[188:191], a[12:15]
  ds_read_b128 v[96:99], v14 offset:51200
  v_mfma_f32_16x16x32_bf16 a[12:15], v[68:71], v[156:159], a[12:15]
  v_mfma_f32_16x16x32_bf16 a[8:11], v[60:63], v[156:159], a[8:11]
  ds_read_b128 v[100:103], v41 offset:51200
  v_mfma_f32_16x16x32_bf16 a[8:11], v[56:59], v[188:191], a[8:11]
  buffer_load_dwordx4 v10, s[60:63], s37 offen offset:0 lds
  v_mfma_f32_16x16x32_bf16 a[16:19], v[56:59], v[192:195], a[16:19]
  ds_read_b128 v[104:107], v14 offset:53248
  v_mfma_f32_16x16x32_bf16 a[16:19], v[60:63], v[160:163], a[16:19]
  v_mfma_f32_16x16x32_bf16 a[20:23], v[68:71], v[160:163], a[20:23]
  ds_read_b128 v[108:111], v41 offset:53248
  v_mfma_f32_16x16x32_bf16 a[20:23], v[64:67], v[192:195], a[20:23]
  v_mfma_f32_16x16x32_bf16 a[28:31], v[64:67], v[196:199], a[28:31]
  ds_read_b128 v[112:115], v14 offset:55296
  v_mfma_f32_16x16x32_bf16 a[28:31], v[68:71], v[164:167], a[28:31]
  buffer_load_dwordx4 v11, s[60:63], s37 offen offset:1024 lds
  v_mfma_f32_16x16x32_bf16 a[24:27], v[60:63], v[164:167], a[24:27]
  ds_read_b128 v[116:119], v41 offset:55296
  v_mfma_f32_16x16x32_bf16 a[24:27], v[56:59], v[196:199], a[24:27]
  v_mfma_f32_16x16x32_bf16 a[32:35], v[56:59], v[200:203], a[32:35]
  v_mfma_f32_16x16x32_bf16 a[32:35], v[60:63], v[168:171], a[32:35]
  v_mfma_f32_16x16x32_bf16 a[36:39], v[68:71], v[168:171], a[36:39]
  v_mfma_f32_16x16x32_bf16 a[36:39], v[64:67], v[200:203], a[36:39]
  buffer_load_dwordx4 v12, s[60:63], s37 offen offset:2048 lds
  v_mfma_f32_16x16x32_bf16 a[44:47], v[64:67], v[204:207], a[44:47]
  v_mfma_f32_16x16x32_bf16 a[44:47], v[68:71], v[172:175], a[44:47]
  v_mfma_f32_16x16x32_bf16 a[40:43], v[60:63], v[172:175], a[40:43]
  v_mfma_f32_16x16x32_bf16 a[40:43], v[56:59], v[204:207], a[40:43]
  v_mfma_f32_16x16x32_bf16 a[48:51], v[56:59], v[208:211], a[48:51]
  v_mfma_f32_16x16x32_bf16 a[48:51], v[60:63], v[176:179], a[48:51]
  buffer_load_dwordx4 v13, s[60:63], s37 offen offset:3072 lds
  v_mfma_f32_16x16x32_bf16 a[52:55], v[68:71], v[176:179], a[52:55]
  s_add_u32 s37, s37, 0x40000
  v_mfma_f32_16x16x32_bf16 a[52:55], v[64:67], v[208:211], a[52:55]
  v_mfma_f32_16x16x32_bf16 a[60:63], v[64:67], v[212:215], a[60:63]
  v_mfma_f32_16x16x32_bf16 a[60:63], v[68:71], v[180:183], a[60:63]
  v_mfma_f32_16x16x32_bf16 a[56:59], v[60:63], v[180:183], a[56:59]
  v_mfma_f32_16x16x32_bf16 a[56:59], v[56:59], v[212:215], a[56:59]
  v_mfma_f32_16x16x32_bf16 a[120:123], v[72:75], v[212:215], a[120:123]
  v_mfma_f32_16x16x32_bf16 a[120:123], v[76:79], v[180:183], a[120:123]
  v_mfma_f32_16x16x32_bf16 a[124:127], v[84:87], v[180:183], a[124:127]
  v_mfma_f32_16x16x32_bf16 a[124:127], v[80:83], v[212:215], a[124:127]
  v_accvgpr_read_b32 v236, a0
  v_accvgpr_read_b32 v237, a1
  v_mfma_f32_16x16x32_bf16 a[116:119], v[80:83], v[208:211], a[116:119]
  v_accvgpr_read_b32 v238, a2
  v_accvgpr_read_b32 v239, a3
  v_mfma_f32_16x16x32_bf16 a[116:119], v[84:87], v[176:179], a[116:119]
  v_accvgpr_read_b32 v240, a4
  v_accvgpr_read_b32 v241, a5
  v_mfma_f32_16x16x32_bf16 a[112:115], v[76:79], v[176:179], a[112:115]
  v_accvgpr_read_b32 v242, a6
  v_accvgpr_read_b32 v243, a7
  v_mfma_f32_16x16x32_bf16 a[112:115], v[72:75], v[208:211], a[112:115]
  v_cvt_pk_bf16_f32 v244, v236, v237
  v_cvt_pk_bf16_f32 v245, v238, v239
  v_mfma_f32_16x16x32_bf16 a[104:107], v[72:75], v[204:207], a[104:107]
  v_cvt_pk_bf16_f32 v246, v240, v241
  v_cvt_pk_bf16_f32 v247, v242, v243
  v_mfma_f32_16x16x32_bf16 a[104:107], v[76:79], v[172:175], a[104:107]
  ds_write_b128 v8, v[244:247] offset:0
  v_accvgpr_read_b32 v236, a8
  v_mfma_f32_16x16x32_bf16 a[108:111], v[84:87], v[172:175], a[108:111]
  v_accvgpr_read_b32 v237, a9
  v_accvgpr_read_b32 v238, a10
  v_mfma_f32_16x16x32_bf16 a[108:111], v[80:83], v[204:207], a[108:111]
  v_accvgpr_read_b32 v239, a11
  v_accvgpr_read_b32 v240, a12
  v_mfma_f32_16x16x32_bf16 a[100:103], v[80:83], v[200:203], a[100:103]
  v_accvgpr_read_b32 v241, a13
  v_accvgpr_read_b32 v242, a14
  v_mfma_f32_16x16x32_bf16 a[100:103], v[84:87], v[168:171], a[100:103]
  v_accvgpr_read_b32 v243, a15
  v_cvt_pk_bf16_f32 v248, v236, v237
  v_mfma_f32_16x16x32_bf16 a[96:99], v[76:79], v[168:171], a[96:99]
  v_cvt_pk_bf16_f32 v249, v238, v239
  v_cvt_pk_bf16_f32 v250, v240, v241
  v_mfma_f32_16x16x32_bf16 a[96:99], v[72:75], v[200:203], a[96:99]
  v_cvt_pk_bf16_f32 v251, v242, v243
  v_mfma_f32_16x16x32_bf16 a[88:91], v[72:75], v[196:199], a[88:91]
  ds_write_b128 v8, v[248:251] offset:1024
  v_accvgpr_read_b32 v236, a16
  v_mfma_f32_16x16x32_bf16 a[88:91], v[76:79], v[164:167], a[88:91]
  v_accvgpr_read_b32 v237, a17
  v_accvgpr_read_b32 v238, a18
  v_mfma_f32_16x16x32_bf16 a[92:95], v[84:87], v[164:167], a[92:95]
  v_accvgpr_read_b32 v239, a19
  v_accvgpr_read_b32 v240, a20
  v_mfma_f32_16x16x32_bf16 a[92:95], v[80:83], v[196:199], a[92:95]
  v_accvgpr_read_b32 v241, a21
  v_accvgpr_read_b32 v242, a22
  v_mfma_f32_16x16x32_bf16 a[84:87], v[80:83], v[192:195], a[84:87]
  v_accvgpr_read_b32 v243, a23
  v_cvt_pk_bf16_f32 v244, v236, v237
  v_mfma_f32_16x16x32_bf16 a[84:87], v[84:87], v[160:163], a[84:87]
  v_cvt_pk_bf16_f32 v245, v238, v239
  v_cvt_pk_bf16_f32 v246, v240, v241
  v_mfma_f32_16x16x32_bf16 a[80:83], v[76:79], v[160:163], a[80:83]
  v_cvt_pk_bf16_f32 v247, v242, v243
  v_mfma_f32_16x16x32_bf16 a[80:83], v[72:75], v[192:195], a[80:83]
  ds_write_b128 v8, v[244:247] offset:2048
  v_accvgpr_read_b32 v236, a24
  v_mfma_f32_16x16x32_bf16 a[72:75], v[72:75], v[188:191], a[72:75]
  v_accvgpr_read_b32 v237, a25
  v_accvgpr_read_b32 v238, a26
  v_mfma_f32_16x16x32_bf16 a[72:75], v[76:79], v[156:159], a[72:75]
  v_accvgpr_read_b32 v239, a27
  v_accvgpr_read_b32 v240, a28
  v_mfma_f32_16x16x32_bf16 a[76:79], v[84:87], v[156:159], a[76:79]
  v_accvgpr_read_b32 v241, a29
  v_accvgpr_read_b32 v242, a30
  v_mfma_f32_16x16x32_bf16 a[76:79], v[80:83], v[188:191], a[76:79]
  v_accvgpr_read_b32 v243, a31
  v_cvt_pk_bf16_f32 v248, v236, v237
  v_mfma_f32_16x16x32_bf16 a[68:71], v[80:83], v[184:187], a[68:71]
  v_cvt_pk_bf16_f32 v249, v238, v239
  v_cvt_pk_bf16_f32 v250, v240, v241
  v_mfma_f32_16x16x32_bf16 a[68:71], v[84:87], v[152:155], a[68:71]
  v_cvt_pk_bf16_f32 v251, v242, v243
  v_mfma_f32_16x16x32_bf16 a[64:67], v[76:79], v[152:155], a[64:67]
  ds_write_b128 v8, v[248:251] offset:3072
  v_mfma_f32_16x16x32_bf16 a[64:67], v[72:75], v[184:187], a[64:67]
  s_mov_b32 s64, s40
  s_add_u32 s40, s40, s41
  v_accvgpr_read_b32 v236, a32
  s_waitcnt lgkmcnt(0)
  s_waitcnt vmcnt(13)
  s_barrier
  s_lshl_b32 s32, s19, 10
  v_add_u32 v41, s32, v52
  v_mfma_f32_16x16x32_bf16 a[128:131], v[88:91], v[184:187], a[128:131]
  s_add_u32 m0, s35, 0x8000
  ds_read_b128 v[56:59], v42 offset:0
  v_accvgpr_read_b32 v237, a33
  v_mfma_f32_16x16x32_bf16 a[128:131], v[92:95], v[152:155], a[128:131]
  buffer_load_dwordx4 v53, s[56:59], s36 offen offset:0 lds
  v_accvgpr_read_b32 v238, a34
  v_mfma_f32_16x16x32_bf16 a[132:135], v[100:103], v[152:155], a[132:135]
  s_add_u32 m0, s35, 0xbfc0
  ds_read_b128 v[60:63], v42 offset:1024
  v_accvgpr_read_b32 v239, a35
  v_mfma_f32_16x16x32_bf16 a[132:135], v[96:99], v[184:187], a[132:135]
  v_accvgpr_read_b32 v240, a36
  v_accvgpr_read_b32 v241, a37
  v_mfma_f32_16x16x32_bf16 a[140:143], v[96:99], v[188:191], a[140:143]
  ds_read_b64_tr_b16 v[72:73], v44 offset:8192
  v_accvgpr_read_b32 v242, a38
  v_mfma_f32_16x16x32_bf16 a[140:143], v[100:103], v[156:159], a[140:143]
  v_accvgpr_read_b32 v243, a39
  v_cvt_pk_bf16_f32 v244, v236, v237
  v_mfma_f32_16x16x32_bf16 a[136:139], v[92:95], v[156:159], a[136:139]
  ds_read_b64_tr_b16 v[74:75], v44 offset:8448
  v_cvt_pk_bf16_f32 v245, v238, v239
  v_mfma_f32_16x16x32_bf16 a[136:139], v[88:91], v[188:191], a[136:139]
  buffer_load_dwordx4 v53, s[56:59], s36 offen offset:64 lds
  v_cvt_pk_bf16_f32 v246, v240, v241
  v_mfma_f32_16x16x32_bf16 a[144:147], v[88:91], v[192:195], a[144:147]
  s_add_u32 m0, s35, 0x8000
  ds_read_b64_tr_b16 v[76:77], v45 offset:8192
  v_cvt_pk_bf16_f32 v247, v242, v243
  v_mfma_f32_16x16x32_bf16 a[144:147], v[92:95], v[160:163], a[144:147]
  ds_write_b128 v8, v[244:247] offset:4096
  v_accvgpr_read_b32 v236, a40
  v_mfma_f32_16x16x32_bf16 a[148:151], v[100:103], v[160:163], a[148:151]
  ds_read_b64_tr_b16 v[78:79], v45 offset:8448
  v_accvgpr_read_b32 v237, a41
  v_mfma_f32_16x16x32_bf16 a[148:151], v[96:99], v[192:195], a[148:151]
  v_accvgpr_read_b32 v238, a42
  v_accvgpr_read_b32 v239, a43
  v_mfma_f32_16x16x32_bf16 a[156:159], v[96:99], v[196:199], a[156:159]
  ds_read_b128 v[84:87], v47 offset:0
  v_accvgpr_read_b32 v240, a44
  v_mfma_f32_16x16x32_bf16 a[156:159], v[100:103], v[164:167], a[156:159]
  buffer_load_dwordx4 v54, s[56:59], s36 offen offset:1024 lds
  v_accvgpr_read_b32 v241, a45
  v_mfma_f32_16x16x32_bf16 a[152:155], v[92:95], v[164:167], a[152:155]
  s_add_u32 m0, s35, 0xbfc0
  ds_read_b64_tr_b16 v[80:81], v46 offset:10240
  v_accvgpr_read_b32 v242, a46
  v_mfma_f32_16x16x32_bf16 a[152:155], v[88:91], v[196:199], a[152:155]
  v_accvgpr_read_b32 v243, a47
  v_cvt_pk_bf16_f32 v248, v236, v237
  v_mfma_f32_16x16x32_bf16 a[160:163], v[88:91], v[200:203], a[160:163]
  ds_read_b64_tr_b16 v[82:83], v46 offset:10368
  v_cvt_pk_bf16_f32 v249, v238, v239
  v_mfma_f32_16x16x32_bf16 a[160:163], v[92:95], v[168:171], a[160:163]
  v_cvt_pk_bf16_f32 v250, v240, v241
  v_cvt_pk_bf16_f32 v251, v242, v243
  v_mfma_f32_16x16x32_bf16 a[164:167], v[100:103], v[168:171], a[164:167]
  ds_write_b128 v8, v[248:251] offset:5120
  v_accvgpr_read_b32 v236, a48
  v_mfma_f32_16x16x32_bf16 a[164:167], v[96:99], v[200:203], a[164:167]
  buffer_load_dwordx4 v54, s[56:59], s36 offen offset:1088 lds
  v_accvgpr_read_b32 v237, a49
  v_mfma_f32_16x16x32_bf16 a[172:175], v[96:99], v[204:207], a[172:175]
  s_add_u32 s36, s36, 128
  s_add_u32 m0, s48, 0xc000
  ds_read_b128 v[64:67], v43 offset:0
  v_mfma_f32_16x16x32_bf16 a[172:175], v[100:103], v[172:175], a[172:175]
  v_accvgpr_read_b32 v238, a50
  v_accvgpr_read_b32 v239, a51
  v_mfma_f32_16x16x32_bf16 a[168:171], v[92:95], v[172:175], a[168:171]
  ds_read_b128 v[68:71], v43 offset:1024
  v_accvgpr_read_b32 v240, a52
  v_mfma_f32_16x16x32_bf16 a[168:171], v[88:91], v[204:207], a[168:171]
  v_accvgpr_read_b32 v241, a53
  v_accvgpr_read_b32 v242, a54
  v_mfma_f32_16x16x32_bf16 a[176:179], v[88:91], v[208:211], a[176:179]
  ds_read_b64_tr_b16 v[120:121], v15 offset:0
  v_accvgpr_read_b32 v243, a55
  v_mfma_f32_16x16x32_bf16 a[176:179], v[92:95], v[176:179], a[176:179]
  buffer_load_dwordx4 v55, s[52:55], s49 offen lds
  v_cvt_pk_bf16_f32 v244, v236, v237
  v_mfma_f32_16x16x32_bf16 a[180:183], v[100:103], v[176:179], a[180:183]
  s_add_u32 m0, s34, 0x1c000
  s_add_u32 s49, s49, s47
  ds_read_b64_tr_b16 v[122:123], v15 offset:2048
  v_mfma_f32_16x16x32_bf16 a[180:183], v[96:99], v[208:211], a[180:183]
  v_cvt_pk_bf16_f32 v245, v238, v239
  v_cvt_pk_bf16_f32 v246, v240, v241
  v_mfma_f32_16x16x32_bf16 a[188:191], v[96:99], v[212:215], a[188:191]
  ds_read_b64_tr_b16 v[124:125], v32 offset:0
  v_cvt_pk_bf16_f32 v247, v242, v243
  v_mfma_f32_16x16x32_bf16 a[188:191], v[100:103], v[180:183], a[188:191]
  ds_write_b128 v8, v[244:247] offset:6144
  v_accvgpr_read_b32 v236, a56
  v_mfma_f32_16x16x32_bf16 a[184:187], v[92:95], v[180:183], a[184:187]
  ds_read_b64_tr_b16 v[126:127], v32 offset:2048
  v_accvgpr_read_b32 v237, a57
  v_mfma_f32_16x16x32_bf16 a[184:187], v[88:91], v[212:215], a[184:187]
  buffer_load_dwordx4 v10, s[60:63], s37 offen offset:0 lds
  v_accvgpr_read_b32 v238, a58
  v_mfma_f32_16x16x32_bf16 a[248:251], v[104:107], v[212:215], a[248:251]
  ds_read_b64_tr_b16 v[128:129], v33 offset:0
  v_accvgpr_read_b32 v239, a59
  v_mfma_f32_16x16x32_bf16 a[248:251], v[108:111], v[180:183], a[248:251]
  v_accvgpr_read_b32 v240, a60
  v_accvgpr_read_b32 v241, a61
  v_mfma_f32_16x16x32_bf16 a[252:255], v[116:119], v[180:183], a[252:255]
  ds_read_b64_tr_b16 v[130:131], v33 offset:2048
  v_accvgpr_read_b32 v242, a62
  v_mfma_f32_16x16x32_bf16 a[252:255], v[112:115], v[212:215], a[252:255]
  v_accvgpr_read_b32 v243, a63
  v_cvt_pk_bf16_f32 v248, v236, v237
  v_mfma_f32_16x16x32_bf16 a[244:247], v[112:115], v[208:211], a[244:247]
  ds_read_b64_tr_b16 v[132:133], v34 offset:0
  v_cvt_pk_bf16_f32 v249, v238, v239
  v_mfma_f32_16x16x32_bf16 a[244:247], v[116:119], v[176:179], a[244:247]
  buffer_load_dwordx4 v11, s[60:63], s37 offen offset:1024 lds
  v_cvt_pk_bf16_f32 v250, v240, v241
  v_mfma_f32_16x16x32_bf16 a[240:243], v[108:111], v[176:179], a[240:243]
  ds_read_b64_tr_b16 v[134:135], v34 offset:2048
  v_cvt_pk_bf16_f32 v251, v242, v243
  v_mfma_f32_16x16x32_bf16 a[240:243], v[104:107], v[208:211], a[240:243]
  ds_write_b128 v8, v[248:251] offset:7168
  v_mfma_f32_16x16x32_bf16 a[232:235], v[104:107], v[204:207], a[232:235]
  s_mov_b32 s65, s40
  s_add_u32 s40, s40, s42
  ds_read_b64_tr_b16 v[136:137], v35 offset:0
  v_mfma_f32_16x16x32_bf16 a[232:235], v[108:111], v[172:175], a[232:235]
  v_accvgpr_read_b32 v236, a64
  v_accvgpr_read_b32 v237, a65
  v_mfma_f32_16x16x32_bf16 a[236:239], v[116:119], v[172:175], a[236:239]
  ds_read_b64_tr_b16 v[138:139], v35 offset:2048
  v_accvgpr_read_b32 v238, a66
  v_mfma_f32_16x16x32_bf16 a[236:239], v[112:115], v[204:207], a[236:239]
  buffer_load_dwordx4 v12, s[60:63], s37 offen offset:2048 lds
  v_accvgpr_read_b32 v239, a67
  v_mfma_f32_16x16x32_bf16 a[228:231], v[112:115], v[200:203], a[228:231]
  ds_read_b64_tr_b16 v[140:141], v36 offset:0
  v_accvgpr_read_b32 v240, a68
  v_mfma_f32_16x16x32_bf16 a[228:231], v[116:119], v[168:171], a[228:231]
  v_accvgpr_read_b32 v241, a69
  v_accvgpr_read_b32 v242, a70
  v_mfma_f32_16x16x32_bf16 a[224:227], v[108:111], v[168:171], a[224:227]
  ds_read_b64_tr_b16 v[142:143], v36 offset:2048
  v_accvgpr_read_b32 v243, a71
  v_mfma_f32_16x16x32_bf16 a[224:227], v[104:107], v[200:203], a[224:227]
  v_cvt_pk_bf16_f32 v244, v236, v237
  v_cvt_pk_bf16_f32 v245, v238, v239
  v_mfma_f32_16x16x32_bf16 a[216:219], v[104:107], v[196:199], a[216:219]
  ds_read_b64_tr_b16 v[144:145], v37 offset:0
  v_cvt_pk_bf16_f32 v246, v240, v241
  v_mfma_f32_16x16x32_bf16 a[216:219], v[108:111], v[164:167], a[216:219]
  buffer_load_dwordx4 v13, s[60:63], s37 offen offset:3072 lds
  v_cvt_pk_bf16_f32 v247, v242, v243
  v_mfma_f32_16x16x32_bf16 a[220:223], v[116:119], v[164:167], a[220:223]
  s_add_u32 s37, s37, 0x40000
  buffer_store_dwordx4 v[244:247], v52, s[28:31], s40 offen offset:0 sc1
  v_accvgpr_read_b32 v236, a72
  v_mfma_f32_16x16x32_bf16 a[220:223], v[112:115], v[196:199], a[220:223]
  ds_read_b64_tr_b16 v[146:147], v37 offset:2048
  v_accvgpr_read_b32 v237, a73
  v_mfma_f32_16x16x32_bf16 a[212:215], v[112:115], v[192:195], a[212:215]
  v_accvgpr_read_b32 v238, a74
  v_accvgpr_read_b32 v239, a75
  v_mfma_f32_16x16x32_bf16 a[212:215], v[116:119], v[160:163], a[212:215]
  ds_read_b64_tr_b16 v[148:149], v38 offset:0
  v_accvgpr_read_b32 v240, a76
  v_mfma_f32_16x16x32_bf16 a[208:211], v[108:111], v[160:163], a[208:211]
  v_accvgpr_read_b32 v241, a77
  v_accvgpr_read_b32 v242, a78
  v_mfma_f32_16x16x32_bf16 a[208:211], v[104:107], v[192:195], a[208:211]
  ds_read_b64_tr_b16 v[150:151], v38 offset:2048
  v_accvgpr_read_b32 v243, a79
  v_mfma_f32_16x16x32_bf16 a[200:203], v[104:107], v[188:191], a[200:203]
  v_cvt_pk_bf16_f32 v248, v236, v237
  v_cvt_pk_bf16_f32 v249, v238, v239
  v_mfma_f32_16x16x32_bf16 a[200:203], v[108:111], v[156:159], a[200:203]
  v_cvt_pk_bf16_f32 v250, v240, v241
  v_cvt_pk_bf16_f32 v251, v242, v243
  v_mfma_f32_16x16x32_bf16 a[204:207], v[116:119], v[156:159], a[204:207]
  buffer_store_dwordx4 v[248:251], v52, s[28:31], s40 offen offset:1024 sc1
  v_accvgpr_read_b32 v236, a80
  v_mfma_f32_16x16x32_bf16 a[204:207], v[112:115], v[188:191], a[204:207]
  v_accvgpr_read_b32 v237, a81
  v_accvgpr_read_b32 v238, a82
  v_mfma_f32_16x16x32_bf16 a[196:199], v[112:115], v[184:187], a[196:199]
  v_accvgpr_read_b32 v239, a83
  v_accvgpr_read_b32 v240, a84
  v_mfma_f32_16x16x32_bf16 a[196:199], v[116:119], v[152:155], a[196:199]
  v_accvgpr_read_b32 v241, a85
  v_accvgpr_read_b32 v242, a86
  v_mfma_f32_16x16x32_bf16 a[192:195], v[108:111], v[152:155], a[192:195]
  v_accvgpr_read_b32 v243, a87
  v_cvt_pk_bf16_f32 v244, v236, v237
  v_mfma_f32_16x16x32_bf16 a[192:195], v[104:107], v[184:187], a[192:195]
  v_cvt_pk_bf16_f32 v245, v238, v239
  v_cvt_pk_bf16_f32 v246, v240, v241
Lk_Q:
  s_cmp_lt_u32 s16, 2
  s_cbranch_scc1 Lk_qe18
  s_waitcnt lgkmcnt(0)
  s_waitcnt vmcnt(17)
  s_barrier
  v_mfma_f32_16x16x32_bf16 v[216:219], v[72:75], v[56:59], 0
  s_add_u32 m0, s48, 0x0
  ds_read_b128 v[88:91], v42 offset:16384
  v_cvt_pk_bf16_f32 v247, v242, v243
  v_mfma_f32_16x16x32_bf16 v[220:223], v[76:79], v[56:59], 0
  buffer_load_dwordx4 v55, s[52:55], s49 offen lds
  v_mfma_f32_16x16x32_bf16 v[224:227], v[72:75], v[60:63], 0
  s_add_u32 m0, s34, 0x10000
  s_add_u32 s49, s49, s47
  ds_read_b128 v[92:95], v42 offset:17408
  v_mfma_f32_16x16x32_bf16 v[228:231], v[76:79], v[60:63], 0
  ds_read_b64_tr_b16 v[104:105], v44 offset:24576
  v_mfma_f32_16x16x32_bf16 v[16:19], v[72:75], v[48:51], 0
  ds_read_b64_tr_b16 v[106:107], v44 offset:24832
  v_mfma_f32_16x16x32_bf16 v[20:23], v[76:79], v[48:51], 0
  ds_read_b64_tr_b16 v[108:109], v45 offset:24576
  v_mfma_f32_16x16x32_bf16 v[24:27], v[84:87], v[56:59], 0
  ds_read_b64_tr_b16 v[110:111], v45 offset:24832
  v_mfma_f32_16x16x32_bf16 v[28:31], v[84:87], v[60:63], 0
  v_mfma_f32_16x16x32_bf16 v[232:235], v[80:83], v[48:51], 0
  buffer_load_dwordx4 v10, s[60:63], s37 offen offset:0 lds
  v_mfma_f32_16x16x32_bf16 v[184:187], v[120:123], v[68:71], 0
  ds_read_b128 v[116:119], v47 offset:64
  v_mfma_f32_16x16x32_bf16 v[188:191], v[124:127], v[68:71], 0
  ds_read_b64_tr_b16 v[112:113], v46 offset:26624
  v_mfma_f32_16x16x32_bf16 v[192:195], v[128:131], v[68:71], 0
  ds_read_b64_tr_b16 v[114:115], v46 offset:26752
  v_mfma_f32_16x16x32_bf16 v[196:199], v[132:135], v[68:71], 0
  ds_read_b128 v[96:99], v43 offset:16384
  v_mfma_f32_16x16x32_bf16 v[200:203], v[136:139], v[68:71], 0
  ds_read_b128 v[100:103], v43 offset:17408
  v_mfma_f32_16x16x32_bf16 v[204:207], v[140:143], v[68:71], 0
  v_mfma_f32_16x16x32_bf16 v[208:211], v[144:147], v[68:71], 0
  buffer_load_dwordx4 v11, s[60:63], s37 offen offset:1024 lds
  v_mfma_f32_16x16x32_bf16 v[212:215], v[148:151], v[68:71], 0
  ds_read_b64_tr_b16 v[152:153], v15 offset:16384
  v_mfma_f32_16x16x32_bf16 a[28:31], v[148:151], v[56:59], 0
  ds_read_b64_tr_b16 v[154:155], v15 offset:18432
  v_mfma_f32_16x16x32_bf16 a[24:27], v[144:147], v[56:59], 0
  ds_read_b64_tr_b16 v[156:157], v32 offset:16384
  v_mfma_f32_16x16x32_bf16 a[20:23], v[140:143], v[56:59], 0
  ds_read_b64_tr_b16 v[158:159], v32 offset:18432
  v_mfma_f32_16x16x32_bf16 a[16:19], v[136:139], v[56:59], 0
  ds_read_b64_tr_b16 v[160:161], v33 offset:16384
  v_mfma_f32_16x16x32_bf16 a[12:15], v[132:135], v[56:59], 0
  v_mfma_f32_16x16x32_bf16 a[8:11], v[128:131], v[56:59], 0
  buffer_load_dwordx4 v12, s[60:63], s37 offen offset:2048 lds
  v_mfma_f32_16x16x32_bf16 a[4:7], v[124:127], v[56:59], 0
  ds_read_b64_tr_b16 v[162:163], v33 offset:18432
  v_mfma_f32_16x16x32_bf16 a[0:3], v[120:123], v[56:59], 0
  ds_read_b64_tr_b16 v[164:165], v34 offset:16384
  v_mfma_f32_16x16x32_bf16 a[32:35], v[120:123], v[60:63], 0
  ds_read_b64_tr_b16 v[166:167], v34 offset:18432
  v_mfma_f32_16x16x32_bf16 a[36:39], v[124:127], v[60:63], 0
  ds_read_b64_tr_b16 v[168:169], v35 offset:16384
  v_mfma_f32_16x16x32_bf16 a[40:43], v[128:131], v[60:63], 0
  ds_read_b64_tr_b16 v[170:171], v35 offset:18432
  v_mfma_f32_16x16x32_bf16 a[44:47], v[132:135], v[60:63], 0
  v_mfma_f32_16x16x32_bf16 a[48:51], v[136:139], v[60:63], 0
  buffer_load_dwordx4 v13, s[60:63], s37 offen offset:3072 lds
  v_mfma_f32_16x16x32_bf16 a[52:55], v[140:143], v[60:63], 0
  s_add_u32 s37, s37, 0x40000
  ds_read_b64_tr_b16 v[172:173], v36 offset:16384
  v_mfma_f32_16x16x32_bf16 a[56:59], v[144:147], v[60:63], 0
  ds_read_b64_tr_b16 v[174:175], v36 offset:18432
  v_mfma_f32_16x16x32_bf16 a[60:63], v[148:151], v[60:63], 0
  ds_read_b64_tr_b16 v[176:177], v37 offset:16384
  buffer_store_dwordx4 v[244:247], v52, s[28:31], s40 offen offset:2048 sc1
  v_accvgpr_read_b32 v236, a88
  v_accvgpr_read_b32 v237, a89
  v_accvgpr_read_b32 v238, a90
  v_accvgpr_read_b32 v239, a91
  v_accvgpr_read_b32 v240, a92
  v_accvgpr_read_b32 v241, a93
  v_accvgpr_read_b32 v242, a94
  v_accvgpr_read_b32 v243, a95
  v_cvt_pk_bf16_f32 v248, v236, v237
  v_cvt_pk_bf16_f32 v249, v238, v239
  v_cvt_pk_bf16_f32 v250, v240, v241
  v_cvt_pk_bf16_f32 v251, v242, v243
  buffer_store_dwordx4 v[248:251], v52, s[28:31], s40 offen offset:3072 sc1
  s_mov_b32 s66, s40
  s_add_u32 s40, s40, s41
  v_mfma_f32_16x16x32_bf16 a[92:95], v[148:151], v[64:67], 0
  ds_read_b64_tr_b16 v[178:179], v37 offset:18432
  v_mfma_f32_16x16x32_bf16 a[88:91], v[144:147], v[64:67], 0
  ds_read_b64_tr_b16 v[180:181], v38 offset:16384
  v_mfma_f32_16x16x32_bf16 a[84:87], v[140:143], v[64:67], 0
  v_mfma_f32_16x16x32_bf16 a[80:83], v[136:139], v[64:67], 0
  ds_read_b64_tr_b16 v[182:183], v38 offset:18432
  v_mfma_f32_16x16x32_bf16 a[76:79], v[132:135], v[64:67], 0
  v_mfma_f32_16x16x32_bf16 a[72:75], v[128:131], v[64:67], 0
  v_mfma_f32_16x16x32_bf16 a[68:71], v[124:127], v[64:67], 0
  v_mfma_f32_16x16x32_bf16 a[64:67], v[120:123], v[64:67], 0
  v_accvgpr_read_b32 v236, a96
  v_accvgpr_read_b32 v237, a97
  v_accvgpr_read_b32 v238, a98
  v_accvgpr_read_b32 v239, a99
  v_accvgpr_read_b32 v240, a100
  v_accvgpr_read_b32 v241, a101
  v_accvgpr_read_b32 v242, a102
  v_accvgpr_read_b32 v243, a103
  v_mfma_f32_16x16x32_bf16 a[96:99], v[56:59], v[56:59], 0
  v_mfma_f32_16x16x32_bf16 a[100:103], v[60:63], v[60:63], 0
  s_waitcnt lgkmcnt(0)
  s_waitcnt vmcnt(15)
  s_barrier
  v_mfma_f32_16x16x32_bf16 v[216:219], v[104:107], v[88:91], v[216:219]
  s_add_u32 m0, s35, 0x0
  ds_read_b128 v[56:59], v42 offset:32768
  v_cvt_pk_bf16_f32 v244, v236, v237
  v_mfma_f32_16x16x32_bf16 v[220:223], v[108:111], v[88:91], v[220:223]
  buffer_load_dwordx4 v53, s[56:59], s36 offen offset:0 lds
  v_cvt_pk_bf16_f32 v245, v238, v239
  v_mfma_f32_16x16x32_bf16 v[224:227], v[104:107], v[92:95], v[224:227]
  s_add_u32 m0, s35, 0x3fc0
  ds_read_b128 v[60:63], v42 offset:33792
  v_cvt_pk_bf16_f32 v246, v240, v241
  v_mfma_f32_16x16x32_bf16 v[228:231], v[108:111], v[92:95], v[228:231]
  ds_read_b64_tr_b16 v[72:73], v44 offset:40960
  v_cvt_pk_bf16_f32 v247, v242, v243
  v_mfma_f32_16x16x32_bf16 v[16:19], v[104:107], v[48:51], v[16:19]
  buffer_store_dwordx4 v[244:247], v52, s[28:31], s40 offen offset:0 sc1
  v_accvgpr_read_b32 v236, a104
  v_mfma_f32_16x16x32_bf16 v[20:23], v[108:111], v[48:51], v[20:23]
  buffer_load_dwordx4 v53, s[56:59], s36 offen offset:64 lds
  v_accvgpr_read_b32 v237, a105
  v_mfma_f32_16x16x32_bf16 v[24:27], v[116:119], v[88:91], v[24:27]
  s_add_u32 m0, s35, 0x0
  ds_read_b64_tr_b16 v[74:75], v44 offset:41216
  v_accvgpr_read_b32 v238, a106
  v_mfma_f32_16x16x32_bf16 v[28:31], v[116:119], v[92:95], v[28:31]
  ds_read_b64_tr_b16 v[76:77], v45 offset:40960
  v_accvgpr_read_b32 v239, a107
  v_mfma_f32_16x16x32_bf16 v[232:235], v[112:115], v[48:51], v[232:235]
  ds_read_b64_tr_b16 v[78:79], v45 offset:41216
  v_accvgpr_read_b32 v240, a108
  v_mfma_f32_16x16x32_bf16 v[184:187], v[152:155], v[100:103], v[184:187]
  buffer_load_dwordx4 v54, s[56:59], s36 offen offset:1024 lds
  v_accvgpr_read_b32 v241, a109
  v_mfma_f32_16x16x32_bf16 a[64:67], v[152:155], v[96:99], a[64:67]
  s_add_u32 m0, s35, 0x3fc0
  ds_read_b128 v[84:87], v47 offset:128
  v_accvgpr_read_b32 v242, a110
  v_mfma_f32_16x16x32_bf16 a[68:71], v[156:159], v[96:99], a[68:71]
  ds_read_b64_tr_b16 v[80:81], v46 offset:43008
  v_accvgpr_read_b32 v243, a111
  v_mfma_f32_16x16x32_bf16 v[188:191], v[156:159], v[100:103], v[188:191]
  ds_read_b64_tr_b16 v[82:83], v46 offset:43136
  v_cvt_pk_bf16_f32 v248, v236, v237
  v_mfma_f32_16x16x32_bf16 v[192:195], v[160:163], v[100:103], v[192:195]
  buffer_load_dwordx4 v54, s[56:59], s36 offen offset:1088 lds
  v_cvt_pk_bf16_f32 v249, v238, v239
  v_mfma_f32_16x16x32_bf16 a[72:75], v[160:163], v[96:99], a[72:75]
  s_add_u32 s36, s36, 128
  s_add_u32 m0, s48, 0x4000
  ds_read_b128 v[64:67], v43 offset:32768
  v_mfma_f32_16x16x32_bf16 a[76:79], v[164:167], v[96:99], a[76:79]
  ds_read_b128 v[68:71], v43 offset:33792
  v_cvt_pk_bf16_f32 v250, v240, v241
  v_mfma_f32_16x16x32_bf16 v[196:199], v[164:167], v[100:103], v[196:199]
  ds_read_b64_tr_b16 v[120:121], v15 offset:32768
  v_cvt_pk_bf16_f32 v251, v242, v243
  v_mfma_f32_16x16x32_bf16 v[200:203], v[168:171], v[100:103], v[200:203]
  buffer_load_dwordx4 v55, s[52:55], s49 offen lds
  v_mfma_f32_16x16x32_bf16 a[80:83], v[168:171], v[96:99], a[80:83]
  s_add_u32 m0, s34, 0x14000
  s_add_u32 s49, s49, s47
  ds_read_b64_tr_b16 v[122:123], v15 offset:34816
  v_mfma_f32_16x16x32_bf16 a[84:87], v[172:175], v[96:99], a[84:87]
  ds_read_b64_tr_b16 v[124:125], v32 offset:32768
  v_mfma_f32_16x16x32_bf16 v[204:207], v[172:175], v[100:103], v[204:207]
  ds_read_b64_tr_b16 v[126:127], v32 offset:34816
  v_mfma_f32_16x16x32_bf16 v[208:211], v[176:179], v[100:103], v[208:211]
  buffer_load_dwordx4 v10, s[60:63], s37 offen offset:0 lds
  v_mfma_f32_16x16x32_bf16 a[88:91], v[176:179], v[96:99], a[88:91]
  ds_read_b64_tr_b16 v[128:129], v33 offset:32768
  v_mfma_f32_16x16x32_bf16 a[92:95], v[180:183], v[96:99], a[92:95]
  ds_read_b64_tr_b16 v[130:131], v33 offset:34816
  v_mfma_f32_16x16x32_bf16 v[212:215], v[180:183], v[100:103], v[212:215]
  ds_read_b64_tr_b16 v[132:133], v34 offset:32768
  v_mfma_f32_16x16x32_bf16 a[28:31], v[180:183], v[88:91], a[28:31]
  buffer_load_dwordx4 v11, s[60:63], s37 offen offset:1024 lds
  v_mfma_f32_16x16x32_bf16 a[60:63], v[180:183], v[92:95], a[60:63]
  ds_read_b64_tr_b16 v[134:135], v34 offset:34816
  v_mfma_f32_16x16x32_bf16 a[56:59], v[176:179], v[92:95], a[56:59]
  ds_read_b64_tr_b16 v[136:137], v35 offset:32768
  v_mfma_f32_16x16x32_bf16 a[24:27], v[176:179], v[88:91], a[24:27]
  ds_read_b64_tr_b16 v[138:139], v35 offset:34816
  v_mfma_f32_16x16x32_bf16 a[20:23], v[172:175], v[88:91], a[20:23]
  buffer_load_dwordx4 v12, s[60:63], s37 offen offset:2048 lds
  v_mfma_f32_16x16x32_bf16 a[52:55], v[172:175], v[92:95], a[52:55]
  ds_read_b64_tr_b16 v[140:141], v36 offset:32768
  v_mfma_f32_16x16x32_bf16 a[48:51], v[168:171], v[92:95], a[48:51]
  ds_read_b64_tr_b16 v[142:143], v36 offset:34816
  v_mfma_f32_16x16x32_bf16 a[16:19], v[168:171], v[88:91], a[16:19]
  ds_read_b64_tr_b16 v[144:145], v37 offset:32768
  v_mfma_f32_16x16x32_bf16 a[12:15], v[164:167], v[88:91], a[12:15]
  buffer_load_dwordx4 v13, s[60:63], s37 offen offset:3072 lds
  v_mfma_f32_16x16x32_bf16 a[44:47], v[164:167], v[92:95], a[44:47]
  s_add_u32 s37, s37, 0x40000
  ds_read_b64_tr_b16 v[146:147], v37 offset:34816
  v_mfma_f32_16x16x32_bf16 a[40:43], v[160:163], v[92:95], a[40:43]
  ds_read_b64_tr_b16 v[148:149], v38 offset:32768
  v_mfma_f32_16x16x32_bf16 a[8:11], v[160:163], v[88:91], a[8:11]
  ds_read_b64_tr_b16 v[150:151], v38 offset:34816
  v_mfma_f32_16x16x32_bf16 a[4:7], v[156:159], v[88:91], a[4:7]
  v_mfma_f32_16x16x32_bf16 a[36:39], v[156:159], v[92:95], a[36:39]
  v_mfma_f32_16x16x32_bf16 a[32:35], v[152:155], v[92:95], a[32:35]
  v_mfma_f32_16x16x32_bf16 a[0:3], v[152:155], v[88:91], a[0:3]
  v_mfma_f32_16x16x32_bf16 a[96:99], v[88:91], v[88:91], a[96:99]
  v_mfma_f32_16x16x32_bf16 a[100:103], v[92:95], v[92:95], a[100:103]
  s_waitcnt lgkmcnt(0)
  s_waitcnt vmcnt(19)
  s_barrier
  v_mfma_f32_16x16x32_bf16 v[216:219], v[72:75], v[56:59], v[216:219]
  s_add_u32 m0, s48, 0x8000
  buffer_store_dwordx4 v[248:251], v52, s[28:31], s40 offen offset:1024 sc1
  v_accvgpr_read_b32 v236, a112
  v_mfma_f32_16x16x32_bf16 v[220:223], v[76:79], v[56:59], v[220:223]
  buffer_load_dwordx4 v55, s[52:55], s49 offen lds
  v_accvgpr_read_b32 v237, a113
  v_mfma_f32_16x16x32_bf16 v[224:227], v[72:75], v[60:63], v[224:227]
  s_add_u32 m0, s34, 0x18000
  s_add_u32 s49, s49, s47
  ds_read_b128 v[88:91], v42 offset:49152
  v_mfma_f32_16x16x32_bf16 v[228:231], v[76:79], v[60:63], v[228:231]
  ds_read_b128 v[92:95], v42 offset:50176
  v_accvgpr_read_b32 v238, a114
  v_mfma_f32_16x16x32_bf16 v[16:19], v[72:75], v[48:51], v[16:19]
  ds_read_b64_tr_b16 v[104:105], v44 offset:57344
  v_accvgpr_read_b32 v239, a115
  v_mfma_f32_16x16x32_bf16 v[20:23], v[76:79], v[48:51], v[20:23]
  ds_read_b64_tr_b16 v[106:107], v44 offset:57600
  v_accvgpr_read_b32 v240, a116
  v_mfma_f32_16x16x32_bf16 v[24:27], v[84:87], v[56:59], v[24:27]
  ds_read_b64_tr_b16 v[108:109], v45 offset:57344
  v_accvgpr_read_b32 v241, a117
  v_mfma_f32_16x16x32_bf16 v[28:31], v[84:87], v[60:63], v[28:31]
  v_accvgpr_read_b32 v242, a118
  v_accvgpr_read_b32 v243, a119
  v_mfma_f32_16x16x32_bf16 v[232:235], v[80:83], v[48:51], v[232:235]
  buffer_load_dwordx4 v10, s[60:63], s37 offen offset:0 lds
  v_cvt_pk_bf16_f32 v244, v236, v237
  v_mfma_f32_16x16x32_bf16 v[184:187], v[120:123], v[68:71], v[184:187]
  ds_read_b64_tr_b16 v[110:111], v45 offset:57600
  v_cvt_pk_bf16_f32 v245, v238, v239
  v_mfma_f32_16x16x32_bf16 a[64:67], v[120:123], v[64:67], a[64:67]
  ds_read_b128 v[116:119], v47 offset:192
  v_cvt_pk_bf16_f32 v246, v240, v241
  v_mfma_f32_16x16x32_bf16 a[68:71], v[124:127], v[64:67], a[68:71]
  ds_read_b64_tr_b16 v[112:113], v46 offset:59392
  v_cvt_pk_bf16_f32 v247, v242, v243
  v_mfma_f32_16x16x32_bf16 v[188:191], v[124:127], v[68:71], v[188:191]
  ds_read_b64_tr_b16 v[114:115], v46 offset:59520
  v_mfma_f32_16x16x32_bf16 v[192:195], v[128:131], v[68:71], v[192:195]
  ds_read_b128 v[96:99], v43 offset:49152
  v_mfma_f32_16x16x32_bf16 a[72:75], v[128:131], v[64:67], a[72:75]
  v_mfma_f32_16x16x32_bf16 a[76:79], v[132:135], v[64:67], a[76:79]
  buffer_load_dwordx4 v11, s[60:63], s37 offen offset:1024 lds
  v_mfma_f32_16x16x32_bf16 v[196:199], v[132:135], v[68:71], v[196:199]
  ds_read_b128 v[100:103], v43 offset:50176
  v_mfma_f32_16x16x32_bf16 v[200:203], v[136:139], v[68:71], v[200:203]
  ds_read_b64_tr_b16 v[152:153], v15 offset:49152
  v_mfma_f32_16x16x32_bf16 a[80:83], v[136:139], v[64:67], a[80:83]
  ds_read_b64_tr_b16 v[154:155], v15 offset:51200
  v_mfma_f32_16x16x32_bf16 a[84:87], v[140:143], v[64:67], a[84:87]
  ds_read_b64_tr_b16 v[156:157], v32 offset:49152
  v_mfma_f32_16x16x32_bf16 v[204:207], v[140:143], v[68:71], v[204:207]
  ds_read_b64_tr_b16 v[158:159], v32 offset:51200
  v_mfma_f32_16x16x32_bf16 v[208:211], v[144:147], v[68:71], v[208:211]
  v_mfma_f32_16x16x32_bf16 a[88:91], v[144:147], v[64:67], a[88:91]
  buffer_load_dwordx4 v12, s[60:63], s37 offen offset:2048 lds
  v_mfma_f32_16x16x32_bf16 a[92:95], v[148:151], v[64:67], a[92:95]
  ds_read_b64_tr_b16 v[160:161], v33 offset:49152
  v_mfma_f32_16x16x32_bf16 v[212:215], v[148:151], v[68:71], v[212:215]
  ds_read_b64_tr_b16 v[162:163], v33 offset:51200
  v_mfma_f32_16x16x32_bf16 a[28:31], v[148:151], v[56:59], a[28:31]
  ds_read_b64_tr_b16 v[164:165], v34 offset:49152
  v_mfma_f32_16x16x32_bf16 a[60:63], v[148:151], v[60:63], a[60:63]
  ds_read_b64_tr_b16 v[166:167], v34 offset:51200
  v_mfma_f32_16x16x32_bf16 a[56:59], v[144:147], v[60:63], a[56:59]
  ds_read_b64_tr_b16 v[168:169], v35 offset:49152
  v_mfma_f32_16x16x32_bf16 a[24:27], v[144:147], v[56:59], a[24:27]
  v_mfma_f32_16x16x32_bf16 a[20:23], v[140:143], v[56:59], a[20:23]
  buffer_load_dwordx4 v13, s[60:63], s37 offen offset:3072 lds
  v_mfma_f32_16x16x32_bf16 a[52:55], v[140:143], v[60:63], a[52:55]
  s_add_u32 s37, s37, 0x40000
  ds_read_b64_tr_b16 v[170:171], v35 offset:51200
  v_mfma_f32_16x16x32_bf16 a[48:51], v[136:139], v[60:63], a[48:51]
  ds_read_b64_tr_b16 v[172:173], v36 offset:49152
  v_mfma_f32_16x16x32_bf16 a[16:19], v[136:139], v[56:59], a[16:19]
  ds_read_b64_tr_b16 v[174:175], v36 offset:51200
  v_mfma_f32_16x16x32_bf16 a[12:15], v[132:135], v[56:59], a[12:15]
  ds_read_b64_tr_b16 v[176:177], v37 offset:49152
  v_mfma_f32_16x16x32_bf16 a[44:47], v[132:135], v[60:63], a[44:47]
  ds_read_b64_tr_b16 v[178:179], v37 offset:51200
  v_mfma_f32_16x16x32_bf16 a[40:43], v[128:131], v[60:63], a[40:43]
  v_mfma_f32_16x16x32_bf16 a[8:11], v[128:131], v[56:59], a[8:11]
  ds_read_b64_tr_b16 v[180:181], v38 offset:49152
  v_mfma_f32_16x16x32_bf16 a[4:7], v[124:127], v[56:59], a[4:7]
  ds_read_b64_tr_b16 v[182:183], v38 offset:51200
  v_mfma_f32_16x16x32_bf16 a[36:39], v[124:127], v[60:63], a[36:39]
  v_mfma_f32_16x16x32_bf16 a[32:35], v[120:123], v[60:63], a[32:35]
  v_mfma_f32_16x16x32_bf16 a[0:3], v[120:123], v[56:59], a[0:3]
  v_mfma_f32_16x16x32_bf16 a[96:99], v[56:59], v[56:59], a[96:99]
  v_mfma_f32_16x16x32_bf16 a[100:103], v[60:63], v[60:63], a[100:103]
  s_waitcnt lgkmcnt(0)
  s_waitcnt vmcnt(12)
  s_barrier
  v_mfma_f32_16x16x32_bf16 v[216:219], v[104:107], v[88:91], v[216:219]
  s_add_u32 m0, s35, 0x8000
  buffer_store_dwordx4 v[244:247], v52, s[28:31], s40 offen offset:2048 sc1
  v_accvgpr_read_b32 v236, a120
  v_mfma_f32_16x16x32_bf16 v[220:223], v[108:111], v[88:91], v[220:223]
  buffer_load_dwordx4 v53, s[56:59], s36 offen offset:0 lds
  v_accvgpr_read_b32 v237, a121
  v_mfma_f32_16x16x32_bf16 v[224:227], v[104:107], v[92:95], v[224:227]
  s_add_u32 m0, s35, 0xbfc0
  ds_read_b128 v[56:59], v42 offset:0
  v_accvgpr_read_b32 v238, a122
  v_mfma_f32_16x16x32_bf16 v[228:231], v[108:111], v[92:95], v[228:231]
  ds_read_b128 v[60:63], v42 offset:1024
  v_accvgpr_read_b32 v239, a123
  v_mfma_f32_16x16x32_bf16 v[16:19], v[104:107], v[48:51], v[16:19]
  ds_read_b64_tr_b16 v[72:73], v44 offset:8192
  v_accvgpr_read_b32 v240, a124
  v_mfma_f32_16x16x32_bf16 v[20:23], v[108:111], v[48:51], v[20:23]
  buffer_load_dwordx4 v53, s[56:59], s36 offen offset:64 lds
  v_accvgpr_read_b32 v241, a125
  v_mfma_f32_16x16x32_bf16 v[24:27], v[116:119], v[88:91], v[24:27]
  s_add_u32 m0, s35, 0x8000
  ds_read_b64_tr_b16 v[74:75], v44 offset:8448
  v_accvgpr_read_b32 v242, a126
  v_mfma_f32_16x16x32_bf16 v[28:31], v[116:119], v[92:95], v[28:31]
  ds_read_b64_tr_b16 v[76:77], v45 offset:8192
  v_accvgpr_read_b32 v243, a127
  v_mfma_f32_16x16x32_bf16 v[232:235], v[112:115], v[48:51], v[232:235]
  ds_read_b64_tr_b16 v[78:79], v45 offset:8448
  v_cvt_pk_bf16_f32 v248, v236, v237
  v_mfma_f32_16x16x32_bf16 v[184:187], v[152:155], v[100:103], v[184:187]
  buffer_load_dwordx4 v54, s[56:59], s36 offen offset:1024 lds
  v_cvt_pk_bf16_f32 v249, v238, v239
  v_mfma_f32_16x16x32_bf16 a[64:67], v[152:155], v[96:99], a[64:67]
  s_add_u32 m0, s35, 0xbfc0
  ds_read_b128 v[84:87], v47 offset:256
  v_cvt_pk_bf16_f32 v250, v240, v241
  v_mfma_f32_16x16x32_bf16 a[68:71], v[156:159], v[96:99], a[68:71]
  ds_read_b64_tr_b16 v[80:81], v46 offset:10240
  v_cvt_pk_bf16_f32 v251, v242, v243
  v_mfma_f32_16x16x32_bf16 v[188:191], v[156:159], v[100:103], v[188:191]
  ds_read_b64_tr_b16 v[82:83], v46 offset:10368
  v_mfma_f32_16x16x32_bf16 v[192:195], v[160:163], v[100:103], v[192:195]
  buffer_load_dwordx4 v54, s[56:59], s36 offen offset:1088 lds
  v_mfma_f32_16x16x32_bf16 a[72:75], v[160:163], v[96:99], a[72:75]
  s_add_u32 s36, s36, 128
  s_add_u32 m0, s48, 0xc000
  ds_read_b128 v[64:67], v43 offset:0
  v_mfma_f32_16x16x32_bf16 a[76:79], v[164:167], v[96:99], a[76:79]
  ds_read_b128 v[68:71], v43 offset:1024
  v_mfma_f32_16x16x32_bf16 v[196:199], v[164:167], v[100:103], v[196:199]
  ds_read_b64_tr_b16 v[120:121], v15 offset:0
  v_mfma_f32_16x16x32_bf16 v[200:203], v[168:171], v[100:103], v[200:203]
  buffer_load_dwordx4 v55, s[52:55], s49 offen lds
  v_mfma_f32_16x16x32_bf16 a[80:83], v[168:171], v[96:99], a[80:83]
  s_add_u32 m0, s34, 0x1c000
  s_add_u32 s49, s49, s47
  ds_read_b64_tr_b16 v[122:123], v15 offset:2048
  v_mfma_f32_16x16x32_bf16 a[84:87], v[172:175], v[96:99], a[84:87]
  ds_read_b64_tr_b16 v[124:125], v32 offset:0
  v_mfma_f32_16x16x32_bf16 v[204:207], v[172:175], v[100:103], v[204:207]
  ds_read_b64_tr_b16 v[126:127], v32 offset:2048
  v_mfma_f32_16x16x32_bf16 v[208:211], v[176:179], v[100:103], v[208:211]
  buffer_load_dwordx4 v10, s[60:63], s37 offen offset:0 lds
  v_mfma_f32_16x16x32_bf16 a[88:91], v[176:179], v[96:99], a[88:91]
  ds_read_b64_tr_b16 v[128:129], v33 offset:0
  v_mfma_f32_16x16x32_bf16 a[92:95], v[180:183], v[96:99], a[92:95]
  ds_read_b64_tr_b16 v[130:131], v33 offset:2048
  v_mfma_f32_16x16x32_bf16 v[212:215], v[180:183], v[100:103], v[212:215]
  ds_read_b64_tr_b16 v[132:133], v34 offset:0
  v_mfma_f32_16x16x32_bf16 a[28:31], v[180:183], v[88:91], a[28:31]
  buffer_load_dwordx4 v11, s[60:63], s37 offen offset:1024 lds
  v_mfma_f32_16x16x32_bf16 a[60:63], v[180:183], v[92:95], a[60:63]
  ds_read_b64_tr_b16 v[134:135], v34 offset:2048
  v_mfma_f32_16x16x32_bf16 a[56:59], v[176:179], v[92:95], a[56:59]
  ds_read_b64_tr_b16 v[136:137], v35 offset:0
  v_mfma_f32_16x16x32_bf16 a[24:27], v[176:179], v[88:91], a[24:27]
  ds_read_b64_tr_b16 v[138:139], v35 offset:2048
  v_mfma_f32_16x16x32_bf16 a[20:23], v[172:175], v[88:91], a[20:23]
  buffer_load_dwordx4 v12, s[60:63], s37 offen offset:2048 lds
  v_mfma_f32_16x16x32_bf16 a[52:55], v[172:175], v[92:95], a[52:55]
  ds_read_b64_tr_b16 v[140:141], v36 offset:0
  v_mfma_f32_16x16x32_bf16 a[48:51], v[168:171], v[92:95], a[48:51]
  ds_read_b64_tr_b16 v[142:143], v36 offset:2048
  v_mfma_f32_16x16x32_bf16 a[16:19], v[168:171], v[88:91], a[16:19]
  ds_read_b64_tr_b16 v[144:145], v37 offset:0
  v_mfma_f32_16x16x32_bf16 a[12:15], v[164:167], v[88:91], a[12:15]
  buffer_load_dwordx4 v13, s[60:63], s37 offen offset:3072 lds
  v_mfma_f32_16x16x32_bf16 a[44:47], v[164:167], v[92:95], a[44:47]
  s_add_u32 s37, s37, 0x40000
  ds_read_b64_tr_b16 v[146:147], v37 offset:2048
  v_mfma_f32_16x16x32_bf16 a[40:43], v[160:163], v[92:95], a[40:43]
  ds_read_b64_tr_b16 v[148:149], v38 offset:0
  v_mfma_f32_16x16x32_bf16 a[8:11], v[160:163], v[88:91], a[8:11]
  ds_read_b64_tr_b16 v[150:151], v38 offset:2048
  v_mfma_f32_16x16x32_bf16 a[4:7], v[156:159], v[88:91], a[4:7]
  v_mfma_f32_16x16x32_bf16 a[36:39], v[156:159], v[92:95], a[36:39]
  v_mfma_f32_16x16x32_bf16 a[32:35], v[152:155], v[92:95], a[32:35]
  v_mfma_f32_16x16x32_bf16 a[0:3], v[152:155], v[88:91], a[0:3]
  v_mfma_f32_16x16x32_bf16 a[96:99], v[88:91], v[88:91], a[96:99]
  v_mfma_f32_16x16x32_bf16 a[100:103], v[92:95], v[92:95], a[100:103]
  s_waitcnt lgkmcnt(0)
  s_waitcnt vmcnt(16)
  s_barrier
  v_mfma_f32_16x16x32_bf16 v[216:219], v[72:75], v[56:59], v[216:219]
  s_add_u32 m0, s48, 0x0
  buffer_store_dwordx4 v[248:251], v52, s[28:31], s40 offen offset:3072 sc1
  v_mfma_f32_16x16x32_bf16 v[220:223], v[76:79], v[56:59], v[220:223]
  s_add_u32 s40, s40, s42
  buffer_load_dwordx4 v55, s[52:55], s49 offen lds
  v_accvgpr_read_b32 v236, a128
  v_mfma_f32_16x16x32_bf16 v[224:227], v[72:75], v[60:63], v[224:227]
  s_add_u32 m0, s34, 0x10000
  s_add_u32 s49, s49, s47
  ds_read_b128 v[88:91], v42 offset:16384
  v_mfma_f32_16x16x32_bf16 v[228:231], v[76:79], v[60:63], v[228:231]
  ds_read_b128 v[92:95], v42 offset:17408
  v_accvgpr_read_b32 v237, a129
  v_mfma_f32_16x16x32_bf16 v[16:19], v[72:75], v[48:51], v[16:19]
  ds_read_b64_tr_b16 v[104:105], v44 offset:24576
  v_accvgpr_read_b32 v238, a130
  v_mfma_f32_16x16x32_bf16 v[20:23], v[76:79], v[48:51], v[20:23]
  ds_read_b64_tr_b16 v[106:107], v44 offset:24832
  v_accvgpr_read_b32 v239, a131
  v_mfma_f32_16x16x32_bf16 v[24:27], v[84:87], v[56:59], v[24:27]
  ds_read_b64_tr_b16 v[108:109], v45 offset:24576
  v_accvgpr_read_b32 v240, a132
  v_mfma_f32_16x16x32_bf16 v[28:31], v[84:87], v[60:63], v[28:31]
  v_accvgpr_read_b32 v241, a133
  v_accvgpr_read_b32 v242, a134
  v_mfma_f32_16x16x32_bf16 v[232:235], v[80:83], v[48:51], v[232:235]
  buffer_load_dwordx4 v10, s[60:63], s37 offen offset:0 lds
  v_accvgpr_read_b32 v243, a135
  v_mfma_f32_16x16x32_bf16 v[184:187], v[120:123], v[68:71], v[184:187]
  ds_read_b64_tr_b16 v[110:111], v45 offset:24832
  v_cvt_pk_bf16_f32 v244, v236, v237
  v_mfma_f32_16x16x32_bf16 a[64:67], v[120:123], v[64:67], a[64:67]
  ds_read_b128 v[116:119], v47 offset:320
  v_cvt_pk_bf16_f32 v245, v238, v239
  v_mfma_f32_16x16x32_bf16 a[68:71], v[124:127], v[64:67], a[68:71]
  ds_read_b64_tr_b16 v[112:113], v46 offset:26624
  v_cvt_pk_bf16_f32 v246, v240, v241
  v_mfma_f32_16x16x32_bf16 v[188:191], v[124:127], v[68:71], v[188:191]
  ds_read_b64_tr_b16 v[114:115], v46 offset:26752
  v_cvt_pk_bf16_f32 v247, v242, v243
  v_mfma_f32_16x16x32_bf16 v[192:195], v[128:131], v[68:71], v[192:195]
  ds_read_b128 v[96:99], v43 offset:16384
  v_mfma_f32_16x16x32_bf16 a[72:75], v[128:131], v[64:67], a[72:75]
  v_mfma_f32_16x16x32_bf16 a[76:79], v[132:135], v[64:67], a[76:79]
  buffer_load_dwordx4 v11, s[60:63], s37 offen offset:1024 lds
  v_mfma_f32_16x16x32_bf16 v[196:199], v[132:135], v[68:71], v[196:199]
  ds_read_b128 v[100:103], v43 offset:17408
  v_mfma_f32_16x16x32_bf16 v[200:203], v[136:139], v[68:71], v[200:203]
  ds_read_b64_tr_b16 v[152:153], v15 offset:16384
  v_mfma_f32_16x16x32_bf16 a[80:83], v[136:139], v[64:67], a[80:83]
  ds_read_b64_tr_b16 v[154:155], v15 offset:18432
  v_mfma_f32_16x16x32_bf16 a[84:87], v[140:143], v[64:67], a[84:87]
  ds_read_b64_tr_b16 v[156:157], v32 offset:16384
  v_mfma_f32_16x16x32_bf16 v[204:207], v[140:143], v[68:71], v[204:207]
  ds_read_b64_tr_b16 v[158:159], v32 offset:18432
  v_mfma_f32_16x16x32_bf16 v[208:211], v[144:147], v[68:71], v[208:211]
  v_mfma_f32_16x16x32_bf16 a[88:91], v[144:147], v[64:67], a[88:91]
  buffer_load_dwordx4 v12, s[60:63], s37 offen offset:2048 lds
  v_mfma_f32_16x16x32_bf16 a[92:95], v[148:151], v[64:67], a[92:95]
  ds_read_b64_tr_b16 v[160:161], v33 offset:16384
  v_mfma_f32_16x16x32_bf16 v[212:215], v[148:151], v[68:71], v[212:215]
  ds_read_b64_tr_b16 v[162:163], v33 offset:18432
  v_mfma_f32_16x16x32_bf16 a[28:31], v[148:151], v[56:59], a[28:31]
  ds_read_b64_tr_b16 v[164:165], v34 offset:16384
  v_mfma_f32_16x16x32_bf16 a[60:63], v[148:151], v[60:63], a[60:63]
  ds_read_b64_tr_b16 v[166:167], v34 offset:18432
  v_mfma_f32_16x16x32_bf16 a[56:59], v[144:147], v[60:63], a[56:59]
  ds_read_b64_tr_b16 v[168:169], v35 offset:16384
  v_mfma_f32_16x16x32_bf16 a[24:27], v[144:147], v[56:59], a[24:27]
  v_mfma_f32_16x16x32_bf16 a[20:23], v[140:143], v[56:59], a[20:23]
  buffer_load_dwordx4 v13, s[60:63], s37 offen offset:3072 lds
  v_mfma_f32_16x16x32_bf16 a[52:55], v[140:143], v[60:63], a[52:55]
  s_add_u32 s37, s37, 0x40000
  ds_read_b64_tr_b16 v[170:171], v35 offset:18432
  v_mfma_f32_16x16x32_bf16 a[48:51], v[136:139], v[60:63], a[48:51]
  ds_read_b64_tr_b16 v[172:173], v36 offset:16384
  v_mfma_f32_16x16x32_bf16 a[16:19], v[136:139], v[56:59], a[16:19]
  ds_read_b64_tr_b16 v[174:175], v36 offset:18432
  v_mfma_f32_16x16x32_bf16 a[12:15], v[132:135], v[56:59], a[12:15]
  ds_read_b64_tr_b16 v[176:177], v37 offset:16384
  v_mfma_f32_16x16x32_bf16 a[44:47], v[132:135], v[60:63], a[44:47]
  ds_read_b64_tr_b16 v[178:179], v37 offset:18432
  v_mfma_f32_16x16x32_bf16 a[40:43], v[128:131], v[60:63], a[40:43]
  v_mfma_f32_16x16x32_bf16 a[8:11], v[128:131], v[56:59], a[8:11]
  ds_read_b64_tr_b16 v[180:181], v38 offset:16384
  v_mfma_f32_16x16x32_bf16 a[4:7], v[124:127], v[56:59], a[4:7]
  ds_read_b64_tr_b16 v[182:183], v38 offset:18432
  v_mfma_f32_16x16x32_bf16 a[36:39], v[124:127], v[60:63], a[36:39]
  v_mfma_f32_16x16x32_bf16 a[32:35], v[120:123], v[60:63], a[32:35]
  v_mfma_f32_16x16x32_bf16 a[0:3], v[120:123], v[56:59], a[0:3]
  v_mfma_f32_16x16x32_bf16 a[96:99], v[56:59], v[56:59], a[96:99]
  v_mfma_f32_16x16x32_bf16 a[100:103], v[60:63], v[60:63], a[100:103]
  s_waitcnt lgkmcnt(0)
  s_waitcnt vmcnt(12)
  s_barrier
  v_mfma_f32_16x16x32_bf16 v[216:219], v[104:107], v[88:91], v[216:219]
  s_add_u32 m0, s35, 0x0
  buffer_store_dwordx4 v[244:247], v52, s[28:31], s40 offen offset:0 sc1
  v_accvgpr_read_b32 v236, a136
  v_mfma_f32_16x16x32_bf16 v[220:223], v[108:111], v[88:91], v[220:223]
  buffer_load_dwordx4 v53, s[56:59], s36 offen offset:0 lds
  v_accvgpr_read_b32 v237, a137
  v_mfma_f32_16x16x32_bf16 v[224:227], v[104:107], v[92:95], v[224:227]
  s_add_u32 m0, s35, 0x3fc0
  ds_read_b128 v[56:59], v42 offset:32768
  v_accvgpr_read_b32 v238, a138
  v_mfma_f32_16x16x32_bf16 v[228:231], v[108:111], v[92:95], v[228:231]
  ds_read_b128 v[60:63], v42 offset:33792
  v_accvgpr_read_b32 v239, a139
  v_mfma_f32_16x16x32_bf16 v[16:19], v[104:107], v[48:51], v[16:19]
  ds_read_b64_tr_b16 v[72:73], v44 offset:40960
  v_accvgpr_read_b32 v240, a140
  v_mfma_f32_16x16x32_bf16 v[20:23], v[108:111], v[48:51], v[20:23]
  buffer_load_dwordx4 v53, s[56:59], s36 offen offset:64 lds
  v_accvgpr_read_b32 v241, a141
  v_mfma_f32_16x16x32_bf16 v[24:27], v[116:119], v[88:91], v[24:27]
  s_add_u32 m0, s35, 0x0
  ds_read_b64_tr_b16 v[74:75], v44 offset:41216
  v_accvgpr_read_b32 v242, a142
  v_mfma_f32_16x16x32_bf16 v[28:31], v[116:119], v[92:95], v[28:31]
  ds_read_b64_tr_b16 v[76:77], v45 offset:40960
  v_accvgpr_read_b32 v243, a143
  v_mfma_f32_16x16x32_bf16 v[232:235], v[112:115], v[48:51], v[232:235]
  ds_read_b64_tr_b16 v[78:79], v45 offset:41216
  v_cvt_pk_bf16_f32 v248, v236, v237
  v_mfma_f32_16x16x32_bf16 v[184:187], v[152:155], v[100:103], v[184:187]
  buffer_load_dwordx4 v54, s[56:59], s36 offen offset:1024 lds
  v_cvt_pk_bf16_f32 v249, v238, v239
  v_mfma_f32_16x16x32_bf16 a[64:67], v[152:155], v[96:99], a[64:67]
  s_add_u32 m0, s35, 0x3fc0
  ds_read_b128 v[84:87], v47 offset:384
  v_cvt_pk_bf16_f32 v250, v240, v241
  v_mfma_f32_16x16x32_bf16 a[68:71], v[156:159], v[96:99], a[68:71]
  ds_read_b64_tr_b16 v[80:81], v46 offset:43008
  v_cvt_pk_bf16_f32 v251, v242, v243
  v_mfma_f32_16x16x32_bf16 v[188:191], v[156:159], v[100:103], v[188:191]
  ds_read_b64_tr_b16 v[82:83], v46 offset:43136
  v_mfma_f32_16x16x32_bf16 v[192:195], v[160:163], v[100:103], v[192:195]
  buffer_load_dwordx4 v54, s[56:59], s36 offen offset:1088 lds
  v_mfma_f32_16x16x32_bf16 a[72:75], v[160:163], v[96:99], a[72:75]
  s_add_u32 s36, s36, 128
  s_add_u32 m0, s48, 0x4000
  ds_read_b128 v[64:67], v43 offset:32768
  v_mfma_f32_16x16x32_bf16 a[76:79], v[164:167], v[96:99], a[76:79]
  ds_read_b128 v[68:71], v43 offset:33792
  v_mfma_f32_16x16x32_bf16 v[196:199], v[164:167], v[100:103], v[196:199]
  ds_read_b64_tr_b16 v[120:121], v15 offset:32768
  v_mfma_f32_16x16x32_bf16 v[200:203], v[168:171], v[100:103], v[200:203]
  buffer_load_dwordx4 v55, s[52:55], s49 offen lds
  v_mfma_f32_16x16x32_bf16 a[80:83], v[168:171], v[96:99], a[80:83]
  s_add_u32 m0, s34, 0x14000
  s_add_u32 s49, s49, s47
  ds_read_b64_tr_b16 v[122:123], v15 offset:34816
  v_mfma_f32_16x16x32_bf16 a[84:87], v[172:175], v[96:99], a[84:87]
  ds_read_b64_tr_b16 v[124:125], v32 offset:32768
  v_mfma_f32_16x16x32_bf16 v[204:207], v[172:175], v[100:103], v[204:207]
  ds_read_b64_tr_b16 v[126:127], v32 offset:34816
  v_mfma_f32_16x16x32_bf16 v[208:211], v[176:179], v[100:103], v[208:211]
  buffer_load_dwordx4 v10, s[60:63], s37 offen offset:0 lds
  v_mfma_f32_16x16x32_bf16 a[88:91], v[176:179], v[96:99], a[88:91]
  ds_read_b64_tr_b16 v[128:129], v33 offset:32768
  v_mfma_f32_16x16x32_bf16 a[92:95], v[180:183], v[96:99], a[92:95]
  ds_read_b64_tr_b16 v[130:131], v33 offset:34816
  v_mfma_f32_16x16x32_bf16 v[212:215], v[180:183], v[100:103], v[212:215]
  ds_read_b64_tr_b16 v[132:133], v34 offset:32768
  v_mfma_f32_16x16x32_bf16 a[28:31], v[180:183], v[88:91], a[28:31]
  buffer_load_dwordx4 v11, s[60:63], s37 offen offset:1024 lds
  v_mfma_f32_16x16x32_bf16 a[60:63], v[180:183], v[92:95], a[60:63]
  ds_read_b64_tr_b16 v[134:135], v34 offset:34816
  v_mfma_f32_16x16x32_bf16 a[56:59], v[176:179], v[92:95], a[56:59]
  ds_read_b64_tr_b16 v[136:137], v35 offset:32768
  v_mfma_f32_16x16x32_bf16 a[24:27], v[176:179], v[88:91], a[24:27]
  ds_read_b64_tr_b16 v[138:139], v35 offset:34816
  v_mfma_f32_16x16x32_bf16 a[20:23], v[172:175], v[88:91], a[20:23]
  buffer_load_dwordx4 v12, s[60:63], s37 offen offset:2048 lds
  v_mfma_f32_16x16x32_bf16 a[52:55], v[172:175], v[92:95], a[52:55]
  ds_read_b64_tr_b16 v[140:141], v36 offset:32768
  v_mfma_f32_16x16x32_bf16 a[48:51], v[168:171], v[92:95], a[48:51]
  ds_read_b64_tr_b16 v[142:143], v36 offset:34816
  v_mfma_f32_16x16x32_bf16 a[16:19], v[168:171], v[88:91], a[16:19]
  ds_read_b64_tr_b16 v[144:145], v37 offset:32768
  v_mfma_f32_16x16x32_bf16 a[12:15], v[164:167], v[88:91], a[12:15]
  buffer_load_dwordx4 v13, s[60:63], s37 offen offset:3072 lds
  v_mfma_f32_16x16x32_bf16 a[44:47], v[164:167], v[92:95], a[44:47]
  s_add_u32 s37, s37, 0x40000
  ds_read_b64_tr_b16 v[146:147], v37 offset:34816
  v_mfma_f32_16x16x32_bf16 a[40:43], v[160:163], v[92:95], a[40:43]
  ds_read_b64_tr_b16 v[148:149], v38 offset:32768
  v_mfma_f32_16x16x32_bf16 a[8:11], v[160:163], v[88:91], a[8:11]
  ds_read_b64_tr_b16 v[150:151], v38 offset:34816
  v_mfma_f32_16x16x32_bf16 a[4:7], v[156:159], v[88:91], a[4:7]
  buffer_load_dword v14, off, s[24:27], 0 sc1
  v_mfma_f32_16x16x32_bf16 a[36:39], v[156:159], v[92:95], a[36:39]
  v_mfma_f32_16x16x32_bf16 a[32:35], v[152:155], v[92:95], a[32:35]
  v_mfma_f32_16x16x32_bf16 a[0:3], v[152:155], v[88:91], a[0:3]
  v_mfma_f32_16x16x32_bf16 a[96:99], v[88:91], v[88:91], a[96:99]
  v_mfma_f32_16x16x32_bf16 a[100:103], v[92:95], v[92:95], a[100:103]
  s_waitcnt lgkmcnt(0)
  s_waitcnt vmcnt(17)
  s_barrier
  v_mfma_f32_16x16x32_bf16 v[216:219], v[72:75], v[56:59], v[216:219]
  s_add_u32 m0, s48, 0x8000
  buffer_store_dwordx4 v[248:251], v52, s[28:31], s40 offen offset:1024 sc1
  v_accvgpr_read_b32 v236, a144
  v_mfma_f32_16x16x32_bf16 v[220:223], v[76:79], v[56:59], v[220:223]
  buffer_load_dwordx4 v55, s[52:55], s49 offen lds
  v_accvgpr_read_b32 v237, a145
  v_mfma_f32_16x16x32_bf16 v[224:227], v[72:75], v[60:63], v[224:227]
  s_add_u32 m0, s34, 0x18000
  s_add_u32 s49, s49, s47
  ds_read_b128 v[88:91], v42 offset:49152
  v_mfma_f32_16x16x32_bf16 v[228:231], v[76:79], v[60:63], v[228:231]
  ds_read_b128 v[92:95], v42 offset:50176
  v_accvgpr_read_b32 v238, a146
  v_mfma_f32_16x16x32_bf16 v[16:19], v[72:75], v[48:51], v[16:19]
  ds_read_b64_tr_b16 v[104:105], v44 offset:57344
  v_accvgpr_read_b32 v239, a147
  v_mfma_f32_16x16x32_bf16 v[20:23], v[76:79], v[48:51], v[20:23]
  ds_read_b64_tr_b16 v[106:107], v44 offset:57600
  v_accvgpr_read_b32 v240, a148
  v_mfma_f32_16x16x32_bf16 v[24:27], v[84:87], v[56:59], v[24:27]
  ds_read_b64_tr_b16 v[108:109], v45 offset:57344
  v_accvgpr_read_b32 v241, a149
  v_mfma_f32_16x16x32_bf16 v[28:31], v[84:87], v[60:63], v[28:31]
  v_accvgpr_read_b32 v242, a150
  v_accvgpr_read_b32 v243, a151
  v_mfma_f32_16x16x32_bf16 v[232:235], v[80:83], v[48:51], v[232:235]
  buffer_load_dwordx4 v10, s[60:63], s37 offen offset:0 lds
  v_cvt_pk_bf16_f32 v244, v236, v237
  v_mfma_f32_16x16x32_bf16 v[184:187], v[120:123], v[68:71], v[184:187]
  ds_read_b64_tr_b16 v[110:111], v45 offset:57600
  v_cvt_pk_bf16_f32 v245, v238, v239
  v_mfma_f32_16x16x32_bf16 a[64:67], v[120:123], v[64:67], a[64:67]
  ds_read_b128 v[116:119], v47 offset:448
  v_cvt_pk_bf16_f32 v246, v240, v241
  v_mfma_f32_16x16x32_bf16 a[68:71], v[124:127], v[64:67], a[68:71]
  ds_read_b64_tr_b16 v[112:113], v46 offset:59392
  v_cvt_pk_bf16_f32 v247, v242, v243
  v_mfma_f32_16x16x32_bf16 v[188:191], v[124:127], v[68:71], v[188:191]
  ds_read_b64_tr_b16 v[114:115], v46 offset:59520
  v_mfma_f32_16x16x32_bf16 v[192:195], v[128:131], v[68:71], v[192:195]
  ds_read_b128 v[96:99], v43 offset:49152
  v_mfma_f32_16x16x32_bf16 a[72:75], v[128:131], v[64:67], a[72:75]
  v_mfma_f32_16x16x32_bf16 a[76:79], v[132:135], v[64:67], a[76:79]
  buffer_load_dwordx4 v11, s[60:63], s37 offen offset:1024 lds
  v_mfma_f32_16x16x32_bf16 v[196:199], v[132:135], v[68:71], v[196:199]
  ds_read_b128 v[100:103], v43 offset:50176
  v_mfma_f32_16x16x32_bf16 v[200:203], v[136:139], v[68:71], v[200:203]
  ds_read_b64_tr_b16 v[152:153], v15 offset:49152
  v_mfma_f32_16x16x32_bf16 a[80:83], v[136:139], v[64:67], a[80:83]
  ds_read_b64_tr_b16 v[154:155], v15 offset:51200
  v_mfma_f32_16x16x32_bf16 a[84:87], v[140:143], v[64:67], a[84:87]
  ds_read_b64_tr_b16 v[156:157], v32 offset:49152
  v_mfma_f32_16x16x32_bf16 v[204:207], v[140:143], v[68:71], v[204:207]
  ds_read_b64_tr_b16 v[158:159], v32 offset:51200
  v_mfma_f32_16x16x32_bf16 v[208:211], v[144:147], v[68:71], v[208:211]
  v_mfma_f32_16x16x32_bf16 a[88:91], v[144:147], v[64:67], a[88:91]
  buffer_load_dwordx4 v12, s[60:63], s37 offen offset:2048 lds
  v_mfma_f32_16x16x32_bf16 a[92:95], v[148:151], v[64:67], a[92:95]
  ds_read_b64_tr_b16 v[160:161], v33 offset:49152
  v_mfma_f32_16x16x32_bf16 v[212:215], v[148:151], v[68:71], v[212:215]
  ds_read_b64_tr_b16 v[162:163], v33 offset:51200
  v_mfma_f32_16x16x32_bf16 a[28:31], v[148:151], v[56:59], a[28:31]
  ds_read_b64_tr_b16 v[164:165], v34 offset:49152
  v_mfma_f32_16x16x32_bf16 a[60:63], v[148:151], v[60:63], a[60:63]
  ds_read_b64_tr_b16 v[166:167], v34 offset:51200
  v_mfma_f32_16x16x32_bf16 a[56:59], v[144:147], v[60:63], a[56:59]
  ds_read_b64_tr_b16 v[168:169], v35 offset:49152
  v_mfma_f32_16x16x32_bf16 a[24:27], v[144:147], v[56:59], a[24:27]
  v_mfma_f32_16x16x32_bf16 a[20:23], v[140:143], v[56:59], a[20:23]
  buffer_load_dwordx4 v13, s[60:63], s37 offen offset:3072 lds
  v_mfma_f32_16x16x32_bf16 a[52:55], v[140:143], v[60:63], a[52:55]
  s_add_u32 s37, s37, 0x40000
  ds_read_b64_tr_b16 v[170:171], v35 offset:51200
  v_mfma_f32_16x16x32_bf16 a[48:51], v[136:139], v[60:63], a[48:51]
  ds_read_b64_tr_b16 v[172:173], v36 offset:49152
  v_mfma_f32_16x16x32_bf16 a[16:19], v[136:139], v[56:59], a[16:19]
  ds_read_b64_tr_b16 v[174:175], v36 offset:51200
  v_mfma_f32_16x16x32_bf16 a[12:15], v[132:135], v[56:59], a[12:15]
  ds_read_b64_tr_b16 v[176:177], v37 offset:49152
  v_mfma_f32_16x16x32_bf16 a[44:47], v[132:135], v[60:63], a[44:47]
  ds_read_b64_tr_b16 v[178:179], v37 offset:51200
  v_mfma_f32_16x16x32_bf16 a[40:43], v[128:131], v[60:63], a[40:43]
  v_mfma_f32_16x16x32_bf16 a[8:11], v[128:131], v[56:59], a[8:11]
  ds_read_b64_tr_b16 v[180:181], v38 offset:49152
  v_mfma_f32_16x16x32_bf16 a[4:7], v[124:127], v[56:59], a[4:7]
  ds_read_b64_tr_b16 v[182:183], v38 offset:51200
  v_mfma_f32_16x16x32_bf16 a[36:39], v[124:127], v[60:63], a[36:39]
  v_mfma_f32_16x16x32_bf16 a[32:35], v[120:123], v[60:63], a[32:35]
  v_mfma_f32_16x16x32_bf16 a[0:3], v[120:123], v[56:59], a[0:3]
  v_mfma_f32_16x16x32_bf16 a[96:99], v[56:59], v[56:59], a[96:99]
  v_mfma_f32_16x16x32_bf16 a[100:103], v[60:63], v[60:63], a[100:103]
  s_waitcnt lgkmcnt(0)
  s_waitcnt vmcnt(13)
  s_barrier
  v_mfma_f32_16x16x32_bf16 v[216:219], v[104:107], v[88:91], v[216:219]
  s_add_u32 m0, s35, 0x8000
  buffer_store_dwordx4 v[244:247], v52, s[28:31], s40 offen offset:2048 sc1
  v_accvgpr_read_b32 v236, a152
  v_mfma_f32_16x16x32_bf16 v[220:223], v[108:111], v[88:91], v[220:223]
  buffer_load_dwordx4 v53, s[56:59], s36 offen offset:0 lds
  v_accvgpr_read_b32 v237, a153
  v_mfma_f32_16x16x32_bf16 v[224:227], v[104:107], v[92:95], v[224:227]
  s_add_u32 m0, s35, 0xbfc0
  ds_read_b128 v[56:59], v42 offset:0
  v_accvgpr_read_b32 v238, a154
  v_mfma_f32_16x16x32_bf16 v[228:231], v[108:111], v[92:95], v[228:231]
  ds_read_b128 v[60:63], v42 offset:1024
  v_accvgpr_read_b32 v239, a155
  v_mfma_f32_16x16x32_bf16 v[16:19], v[104:107], v[48:51], v[16:19]
  ds_read_b64_tr_b16 v[72:73], v44 offset:8192
  v_accvgpr_read_b32 v240, a156
  v_mfma_f32_16x16x32_bf16 v[20:23], v[108:111], v[48:51], v[20:23]
  buffer_load_dwordx4 v53, s[56:59], s36 offen offset:64 lds
  v_accvgpr_read_b32 v241, a157
  v_mfma_f32_16x16x32_bf16 v[24:27], v[116:119], v[88:91], v[24:27]
  s_add_u32 m0, s35, 0x8000
  ds_read_b64_tr_b16 v[74:75], v44 offset:8448
  v_accvgpr_read_b32 v242, a158
  v_mfma_f32_16x16x32_bf16 v[28:31], v[116:119], v[92:95], v[28:31]
  ds_read_b64_tr_b16 v[76:77], v45 offset:8192
  v_accvgpr_read_b32 v243, a159
  v_mfma_f32_16x16x32_bf16 v[232:235], v[112:115], v[48:51], v[232:235]
  ds_read_b64_tr_b16 v[78:79], v45 offset:8448
  v_cvt_pk_bf16_f32 v248, v236, v237
  v_mfma_f32_16x16x32_bf16 v[184:187], v[152:155], v[100:103], v[184:187]
  buffer_load_dwordx4 v54, s[56:59], s36 offen offset:1024 lds
  v_cvt_pk_bf16_f32 v249, v238, v239
  v_mfma_f32_16x16x32_bf16 a[64:67], v[152:155], v[96:99], a[64:67]
  s_add_u32 m0, s35, 0xbfc0
  ds_read_b128 v[84:87], v47 offset:512
  v_cvt_pk_bf16_f32 v250, v240, v241
  v_mfma_f32_16x16x32_bf16 a[68:71], v[156:159], v[96:99], a[68:71]
  ds_read_b64_tr_b16 v[80:81], v46 offset:10240
  v_cvt_pk_bf16_f32 v251, v242, v243
  v_mfma_f32_16x16x32_bf16 v[188:191], v[156:159], v[100:103], v[188:191]
  ds_read_b64_tr_b16 v[82:83], v46 offset:10368
  v_mfma_f32_16x16x32_bf16 v[192:195], v[160:163], v[100:103], v[192:195]
  buffer_load_dwordx4 v54, s[56:59], s36 offen offset:1088 lds
  v_mfma_f32_16x16x32_bf16 a[72:75], v[160:163], v[96:99], a[72:75]
  s_add_u32 s36, s36, 128
  s_add_u32 m0, s48, 0xc000
  ds_read_b128 v[64:67], v43 offset:0
  v_mfma_f32_16x16x32_bf16 a[76:79], v[164:167], v[96:99], a[76:79]
  ds_read_b128 v[68:71], v43 offset:1024
  v_mfma_f32_16x16x32_bf16 v[196:199], v[164:167], v[100:103], v[196:199]
  ds_read_b64_tr_b16 v[120:121], v15 offset:0
  v_mfma_f32_16x16x32_bf16 v[200:203], v[168:171], v[100:103], v[200:203]
  buffer_load_dwordx4 v55, s[52:55], s49 offen lds
  v_mfma_f32_16x16x32_bf16 a[80:83], v[168:171], v[96:99], a[80:83]
  s_add_u32 m0, s34, 0x1c000
  s_add_u32 s49, s49, s47
  ds_read_b64_tr_b16 v[122:123], v15 offset:2048
  v_mfma_f32_16x16x32_bf16 a[84:87], v[172:175], v[96:99], a[84:87]
  ds_read_b64_tr_b16 v[124:125], v32 offset:0
  v_mfma_f32_16x16x32_bf16 v[204:207], v[172:175], v[100:103], v[204:207]
  ds_read_b64_tr_b16 v[126:127], v32 offset:2048
  v_mfma_f32_16x16x32_bf16 v[208:211], v[176:179], v[100:103], v[208:211]
  buffer_load_dwordx4 v10, s[60:63], s37 offen offset:0 lds
  v_mfma_f32_16x16x32_bf16 a[88:91], v[176:179], v[96:99], a[88:91]
  ds_read_b64_tr_b16 v[128:129], v33 offset:0
  v_mfma_f32_16x16x32_bf16 a[92:95], v[180:183], v[96:99], a[92:95]
  ds_read_b64_tr_b16 v[130:131], v33 offset:2048
  v_mfma_f32_16x16x32_bf16 v[212:215], v[180:183], v[100:103], v[212:215]
  ds_read_b64_tr_b16 v[132:133], v34 offset:0
  v_mfma_f32_16x16x32_bf16 a[28:31], v[180:183], v[88:91], a[28:31]
  buffer_load_dwordx4 v11, s[60:63], s37 offen offset:1024 lds
  v_mfma_f32_16x16x32_bf16 a[60:63], v[180:183], v[92:95], a[60:63]
  ds_read_b64_tr_b16 v[134:135], v34 offset:2048
  v_mfma_f32_16x16x32_bf16 a[56:59], v[176:179], v[92:95], a[56:59]
  ds_read_b64_tr_b16 v[136:137], v35 offset:0
  v_mfma_f32_16x16x32_bf16 a[24:27], v[176:179], v[88:91], a[24:27]
  ds_read_b64_tr_b16 v[138:139], v35 offset:2048
  v_mfma_f32_16x16x32_bf16 a[20:23], v[172:175], v[88:91], a[20:23]
  buffer_load_dwordx4 v12, s[60:63], s37 offen offset:2048 lds
  v_mfma_f32_16x16x32_bf16 a[52:55], v[172:175], v[92:95], a[52:55]
  ds_read_b64_tr_b16 v[140:141], v36 offset:0
  v_mfma_f32_16x16x32_bf16 a[48:51], v[168:171], v[92:95], a[48:51]
  ds_read_b64_tr_b16 v[142:143], v36 offset:2048
  v_mfma_f32_16x16x32_bf16 a[16:19], v[168:171], v[88:91], a[16:19]
  ds_read_b64_tr_b16 v[144:145], v37 offset:0
  v_mfma_f32_16x16x32_bf16 a[12:15], v[164:167], v[88:91], a[12:15]
  buffer_load_dwordx4 v13, s[60:63], s37 offen offset:3072 lds
  v_mfma_f32_16x16x32_bf16 a[44:47], v[164:167], v[92:95], a[44:47]
  s_add_u32 s37, s37, 0x40000
  ds_read_b64_tr_b16 v[146:147], v37 offset:2048
  v_mfma_f32_16x16x32_bf16 a[40:43], v[160:163], v[92:95], a[40:43]
  ds_read_b64_tr_b16 v[148:149], v38 offset:0
  v_mfma_f32_16x16x32_bf16 a[8:11], v[160:163], v[88:91], a[8:11]
  ds_read_b64_tr_b16 v[150:151], v38 offset:2048
  v_mfma_f32_16x16x32_bf16 a[4:7], v[156:159], v[88:91], a[4:7]
  v_mfma_f32_16x16x32_bf16 a[36:39], v[156:159], v[92:95], a[36:39]
  v_mfma_f32_16x16x32_bf16 a[32:35], v[152:155], v[92:95], a[32:35]
  v_mfma_f32_16x16x32_bf16 a[0:3], v[152:155], v[88:91], a[0:3]
  v_mfma_f32_16x16x32_bf16 a[96:99], v[88:91], v[88:91], a[96:99]
  v_mfma_f32_16x16x32_bf16 a[100:103], v[92:95], v[92:95], a[100:103]
  s_waitcnt lgkmcnt(0)
  s_waitcnt vmcnt(17)
  s_barrier
  v_mfma_f32_16x16x32_bf16 v[216:219], v[72:75], v[56:59], v[216:219]
  s_add_u32 m0, s48, 0x0
  buffer_store_dwordx4 v[248:251], v52, s[28:31], s40 offen offset:3072 sc1
  v_mfma_f32_16x16x32_bf16 v[220:223], v[76:79], v[56:59], v[220:223]
  s_add_u32 s40, s40, s41
  buffer_load_dwordx4 v55, s[52:55], s49 offen lds
  v_accvgpr_read_b32 v236, a160
  v_mfma_f32_16x16x32_bf16 v[224:227], v[72:75], v[60:63], v[224:227]
  s_add_u32 m0, s34, 0x10000
  s_add_u32 s49, s49, s47
  ds_read_b128 v[88:91], v42 offset:16384
  v_mfma_f32_16x16x32_bf16 v[228:231], v[76:79], v[60:63], v[228:231]
  ds_read_b128 v[92:95], v42 offset:17408
  v_accvgpr_read_b32 v237, a161
  v_mfma_f32_16x16x32_bf16 v[16:19], v[72:75], v[48:51], v[16:19]
  ds_read_b64_tr_b16 v[104:105], v44 offset:24576
  v_accvgpr_read_b32 v238, a162
  v_mfma_f32_16x16x32_bf16 v[20:23], v[76:79], v[48:51], v[20:23]
  ds_read_b64_tr_b16 v[106:107], v44 offset:24832
  v_accvgpr_read_b32 v239, a163
  v_mfma_f32_16x16x32_bf16 v[24:27], v[84:87], v[56:59], v[24:27]
  ds_read_b64_tr_b16 v[108:109], v45 offset:24576
  v_accvgpr_read_b32 v240, a164
  v_mfma_f32_16x16x32_bf16 v[28:31], v[84:87], v[60:63], v[28:31]
  v_accvgpr_read_b32 v241, a165
  v_accvgpr_read_b32 v242, a166
  v_mfma_f32_16x16x32_bf16 v[232:235], v[80:83], v[48:51], v[232:235]
  buffer_load_dwordx4 v10, s[60:63], s37 offen offset:0 lds
  v_accvgpr_read_b32 v243, a167
  v_mfma_f32_16x16x32_bf16 v[184:187], v[120:123], v[68:71], v[184:187]
  ds_read_b64_tr_b16 v[110:111], v45 offset:24832
  v_cvt_pk_bf16_f32 v244, v236, v237
  v_mfma_f32_16x16x32_bf16 a[64:67], v[120:123], v[64:67], a[64:67]
  ds_read_b128 v[116:119], v47 offset:576
  v_cvt_pk_bf16_f32 v245, v238, v239
  v_mfma_f32_16x16x32_bf16 a[68:71], v[124:127], v[64:67], a[68:71]
  ds_read_b64_tr_b16 v[112:113], v46 offset:26624
  v_cvt_pk_bf16_f32 v246, v240, v241
  v_mfma_f32_16x16x32_bf16 v[188:191], v[124:127], v[68:71], v[188:191]
  ds_read_b64_tr_b16 v[114:115], v46 offset:26752
  v_cvt_pk_bf16_f32 v247, v242, v243
  v_mfma_f32_16x16x32_bf16 v[192:195], v[128:131], v[68:71], v[192:195]
  ds_read_b128 v[96:99], v43 offset:16384
  v_mfma_f32_16x16x32_bf16 a[72:75], v[128:131], v[64:67], a[72:75]
  v_mfma_f32_16x16x32_bf16 a[76:79], v[132:135], v[64:67], a[76:79]
  buffer_load_dwordx4 v11, s[60:63], s37 offen offset:1024 lds
  v_mfma_f32_16x16x32_bf16 v[196:199], v[132:135], v[68:71], v[196:199]
  ds_read_b128 v[100:103], v43 offset:17408
  v_mfma_f32_16x16x32_bf16 v[200:203], v[136:139], v[68:71], v[200:203]
  ds_read_b64_tr_b16 v[152:153], v15 offset:16384
  v_mfma_f32_16x16x32_bf16 a[80:83], v[136:139], v[64:67], a[80:83]
  ds_read_b64_tr_b16 v[154:155], v15 offset:18432
  v_mfma_f32_16x16x32_bf16 a[84:87], v[140:143], v[64:67], a[84:87]
  ds_read_b64_tr_b16 v[156:157], v32 offset:16384
  v_mfma_f32_16x16x32_bf16 v[204:207], v[140:143], v[68:71], v[204:207]
  ds_read_b64_tr_b16 v[158:159], v32 offset:18432
  v_mfma_f32_16x16x32_bf16 v[208:211], v[144:147], v[68:71], v[208:211]
  v_mfma_f32_16x16x32_bf16 a[88:91], v[144:147], v[64:67], a[88:91]
  buffer_load_dwordx4 v12, s[60:63], s37 offen offset:2048 lds
  v_mfma_f32_16x16x32_bf16 a[92:95], v[148:151], v[64:67], a[92:95]
  ds_read_b64_tr_b16 v[160:161], v33 offset:16384
  v_mfma_f32_16x16x32_bf16 v[212:215], v[148:151], v[68:71], v[212:215]
  ds_read_b64_tr_b16 v[162:163], v33 offset:18432
  v_mfma_f32_16x16x32_bf16 a[28:31], v[148:151], v[56:59], a[28:31]
  ds_read_b64_tr_b16 v[164:165], v34 offset:16384
  v_mfma_f32_16x16x32_bf16 a[60:63], v[148:151], v[60:63], a[60:63]
  ds_read_b64_tr_b16 v[166:167], v34 offset:18432
  v_mfma_f32_16x16x32_bf16 a[56:59], v[144:147], v[60:63], a[56:59]
  ds_read_b64_tr_b16 v[168:169], v35 offset:16384
  v_mfma_f32_16x16x32_bf16 a[24:27], v[144:147], v[56:59], a[24:27]
  v_mfma_f32_16x16x32_bf16 a[20:23], v[140:143], v[56:59], a[20:23]
  buffer_load_dwordx4 v13, s[60:63], s37 offen offset:3072 lds
  v_mfma_f32_16x16x32_bf16 a[52:55], v[140:143], v[60:63], a[52:55]
  s_add_u32 s37, s37, 0x40000
  ds_read_b64_tr_b16 v[170:171], v35 offset:18432
  v_mfma_f32_16x16x32_bf16 a[48:51], v[136:139], v[60:63], a[48:51]
  ds_read_b64_tr_b16 v[172:173], v36 offset:16384
  v_mfma_f32_16x16x32_bf16 a[16:19], v[136:139], v[56:59], a[16:19]
  ds_read_b64_tr_b16 v[174:175], v36 offset:18432
  v_mfma_f32_16x16x32_bf16 a[12:15], v[132:135], v[56:59], a[12:15]
  ds_read_b64_tr_b16 v[176:177], v37 offset:16384
  v_mfma_f32_16x16x32_bf16 a[44:47], v[132:135], v[60:63], a[44:47]
  ds_read_b64_tr_b16 v[178:179], v37 offset:18432
  v_mfma_f32_16x16x32_bf16 a[40:43], v[128:131], v[60:63], a[40:43]
  v_mfma_f32_16x16x32_bf16 a[8:11], v[128:131], v[56:59], a[8:11]
  ds_read_b64_tr_b16 v[180:181], v38 offset:16384
  v_mfma_f32_16x16x32_bf16 a[4:7], v[124:127], v[56:59], a[4:7]
  ds_read_b64_tr_b16 v[182:183], v38 offset:18432
  v_mfma_f32_16x16x32_bf16 a[36:39], v[124:127], v[60:63], a[36:39]
  v_mfma_f32_16x16x32_bf16 a[32:35], v[120:123], v[60:63], a[32:35]
  v_mfma_f32_16x16x32_bf16 a[0:3], v[120:123], v[56:59], a[0:3]
  v_mfma_f32_16x16x32_bf16 a[96:99], v[56:59], v[56:59], a[96:99]
  v_mfma_f32_16x16x32_bf16 a[100:103], v[60:63], v[60:63], a[100:103]
  s_waitcnt lgkmcnt(0)
  s_waitcnt vmcnt(12)
  s_barrier
  v_mfma_f32_16x16x32_bf16 v[216:219], v[104:107], v[88:91], v[216:219]
  s_add_u32 m0, s35, 0x0
  buffer_store_dwordx4 v[244:247], v52, s[28:31], s40 offen offset:0 sc1
  v_accvgpr_read_b32 v236, a168
  v_mfma_f32_16x16x32_bf16 v[220:223], v[108:111], v[88:91], v[220:223]
  buffer_load_dwordx4 v53, s[56:59], s36 offen offset:0 lds
  v_accvgpr_read_b32 v237, a169
  v_mfma_f32_16x16x32_bf16 v[224:227], v[104:107], v[92:95], v[224:227]
  s_add_u32 m0, s35, 0x3fc0
  ds_read_b128 v[56:59], v42 offset:32768
  v_accvgpr_read_b32 v238, a170
  v_mfma_f32_16x16x32_bf16 v[228:231], v[108:111], v[92:95], v[228:231]
  ds_read_b128 v[60:63], v42 offset:33792
  v_accvgpr_read_b32 v239, a171
  v_mfma_f32_16x16x32_bf16 v[16:19], v[104:107], v[48:51], v[16:19]
  ds_read_b64_tr_b16 v[72:73], v44 offset:40960
  v_accvgpr_read_b32 v240, a172
  v_mfma_f32_16x16x32_bf16 v[20:23], v[108:111], v[48:51], v[20:23]
  buffer_load_dwordx4 v53, s[56:59], s36 offen offset:64 lds
  v_accvgpr_read_b32 v241, a173
  v_mfma_f32_16x16x32_bf16 v[24:27], v[116:119], v[88:91], v[24:27]
  s_add_u32 m0, s35, 0x0
  ds_read_b64_tr_b16 v[74:75], v44 offset:41216
  v_accvgpr_read_b32 v242, a174
  v_mfma_f32_16x16x32_bf16 v[28:31], v[116:119], v[92:95], v[28:31]
  ds_read_b64_tr_b16 v[76:77], v45 offset:40960
  v_accvgpr_read_b32 v243, a175
  v_mfma_f32_16x16x32_bf16 v[232:235], v[112:115], v[48:51], v[232:235]
  ds_read_b64_tr_b16 v[78:79], v45 offset:41216
  v_cvt_pk_bf16_f32 v248, v236, v237
  v_mfma_f32_16x16x32_bf16 v[184:187], v[152:155], v[100:103], v[184:187]
  buffer_load_dwordx4 v54, s[56:59], s36 offen offset:1024 lds
  v_cvt_pk_bf16_f32 v249, v238, v239
  v_mfma_f32_16x16x32_bf16 a[64:67], v[152:155], v[96:99], a[64:67]
  s_add_u32 m0, s35, 0x3fc0
  ds_read_b128 v[84:87], v47 offset:640
  v_cvt_pk_bf16_f32 v250, v240, v241
  v_mfma_f32_16x16x32_bf16 a[68:71], v[156:159], v[96:99], a[68:71]
  ds_read_b64_tr_b16 v[80:81], v46 offset:43008
  v_cvt_pk_bf16_f32 v251, v242, v243
  v_mfma_f32_16x16x32_bf16 v[188:191], v[156:159], v[100:103], v[188:191]
  ds_read_b64_tr_b16 v[82:83], v46 offset:43136
  v_mfma_f32_16x16x32_bf16 v[192:195], v[160:163], v[100:103], v[192:195]
  buffer_load_dwordx4 v54, s[56:59], s36 offen offset:1088 lds
  v_mfma_f32_16x16x32_bf16 a[72:75], v[160:163], v[96:99], a[72:75]
  s_add_u32 s36, s36, 128
  s_add_u32 m0, s48, 0x4000
  ds_read_b128 v[64:67], v43 offset:32768
  v_mfma_f32_16x16x32_bf16 a[76:79], v[164:167], v[96:99], a[76:79]
  ds_read_b128 v[68:71], v43 offset:33792
  v_mfma_f32_16x16x32_bf16 v[196:199], v[164:167], v[100:103], v[196:199]
  ds_read_b64_tr_b16 v[120:121], v15 offset:32768
  v_mfma_f32_16x16x32_bf16 v[200:203], v[168:171], v[100:103], v[200:203]
  buffer_load_dwordx4 v55, s[52:55], s49 offen lds
  v_mfma_f32_16x16x32_bf16 a[80:83], v[168:171], v[96:99], a[80:83]
  s_add_u32 m0, s34, 0x14000
  s_add_u32 s49, s49, s47
  ds_read_b64_tr_b16 v[122:123], v15 offset:34816
  v_mfma_f32_16x16x32_bf16 a[84:87], v[172:175], v[96:99], a[84:87]
  ds_read_b64_tr_b16 v[124:125], v32 offset:32768
  v_mfma_f32_16x16x32_bf16 v[204:207], v[172:175], v[100:103], v[204:207]
  ds_read_b64_tr_b16 v[126:127], v32 offset:34816
  v_mfma_f32_16x16x32_bf16 v[208:211], v[176:179], v[100:103], v[208:211]
  buffer_load_dwordx4 v10, s[60:63], s37 offen offset:0 lds
  v_mfma_f32_16x16x32_bf16 a[88:91], v[176:179], v[96:99], a[88:91]
  ds_read_b64_tr_b16 v[128:129], v33 offset:32768
  v_mfma_f32_16x16x32_bf16 a[92:95], v[180:183], v[96:99], a[92:95]
  ds_read_b64_tr_b16 v[130:131], v33 offset:34816
  v_mfma_f32_16x16x32_bf16 v[212:215], v[180:183], v[100:103], v[212:215]
  ds_read_b64_tr_b16 v[132:133], v34 offset:32768
  v_mfma_f32_16x16x32_bf16 a[28:31], v[180:183], v[88:91], a[28:31]
  buffer_load_dwordx4 v11, s[60:63], s37 offen offset:1024 lds
  v_mfma_f32_16x16x32_bf16 a[60:63], v[180:183], v[92:95], a[60:63]
  ds_read_b64_tr_b16 v[134:135], v34 offset:34816
  v_mfma_f32_16x16x32_bf16 a[56:59], v[176:179], v[92:95], a[56:59]
  ds_read_b64_tr_b16 v[136:137], v35 offset:32768
  v_mfma_f32_16x16x32_bf16 a[24:27], v[176:179], v[88:91], a[24:27]
  ds_read_b64_tr_b16 v[138:139], v35 offset:34816
  v_mfma_f32_16x16x32_bf16 a[20:23], v[172:175], v[88:91], a[20:23]
  buffer_load_dwordx4 v12, s[60:63], s37 offen offset:2048 lds
  v_mfma_f32_16x16x32_bf16 a[52:55], v[172:175], v[92:95], a[52:55]
  ds_read_b64_tr_b16 v[140:141], v36 offset:32768
  v_mfma_f32_16x16x32_bf16 a[48:51], v[168:171], v[92:95], a[48:51]
  ds_read_b64_tr_b16 v[142:143], v36 offset:34816
  v_mfma_f32_16x16x32_bf16 a[16:19], v[168:171], v[88:91], a[16:19]
  ds_read_b64_tr_b16 v[144:145], v37 offset:32768
  v_mfma_f32_16x16x32_bf16 a[12:15], v[164:167], v[88:91], a[12:15]
  buffer_load_dwordx4 v13, s[60:63], s37 offen offset:3072 lds
  v_mfma_f32_16x16x32_bf16 a[44:47], v[164:167], v[92:95], a[44:47]
  s_add_u32 s37, s37, 0x40000
  ds_read_b64_tr_b16 v[146:147], v37 offset:34816
  v_mfma_f32_16x16x32_bf16 a[40:43], v[160:163], v[92:95], a[40:43]
  ds_read_b64_tr_b16 v[148:149], v38 offset:32768
  v_mfma_f32_16x16x32_bf16 a[8:11], v[160:163], v[88:91], a[8:11]
  ds_read_b64_tr_b16 v[150:151], v38 offset:34816
  v_mfma_f32_16x16x32_bf16 a[4:7], v[156:159], v[88:91], a[4:7]
  v_mfma_f32_16x16x32_bf16 a[36:39], v[156:159], v[92:95], a[36:39]
  v_mfma_f32_16x16x32_bf16 a[32:35], v[152:155], v[92:95], a[32:35]
  v_mfma_f32_16x16x32_bf16 a[0:3], v[152:155], v[88:91], a[0:3]
  v_mfma_f32_16x16x32_bf16 a[96:99], v[88:91], v[88:91], a[96:99]
  v_mfma_f32_16x16x32_bf16 a[100:103], v[92:95], v[92:95], a[100:103]
  s_waitcnt lgkmcnt(0)
  v_mov_b32 v3, 1
  v_mov_b32 v4, 0
  s_cmp_lg_u32 s19, 0
  s_cbranch_scc1 Lk_go21
  v_cmp_lt_u32 vcc, v14, v3
  s_nop 4
  s_cbranch_vccz Lk_go21
  s_mov_b32 s43, 0
Lk_poll20:
  s_sleep 3
  buffer_load_dword v14, v4, s[24:27], 0 offen offset:0 sc1
  s_waitcnt vmcnt(0)
  v_cmp_lt_u32 vcc, v14, v3
  s_nop 4
  s_cbranch_vccz Lk_go21
  s_add_u32 s43, s43, 1
  s_cmp_lt_u32 s43, 0x40000
  s_cbranch_scc1 Lk_poll20
Lk_go21:
  s_waitcnt vmcnt(16)
  s_barrier
  v_mfma_f32_16x16x32_bf16 v[216:219], v[72:75], v[56:59], v[216:219]
  buffer_load_dword v10, v6, s[20:23], 0 offen sc1
  v_mfma_f32_16x16x32_bf16 v[220:223], v[76:79], v[56:59], v[220:223]
  buffer_store_dwordx4 v[248:251], v52, s[28:31], s40 offen offset:1024 sc1
  v_accvgpr_read_b32 v236, a176
  v_mfma_f32_16x16x32_bf16 v[224:227], v[72:75], v[60:63], v[224:227]
  ds_read_b128 v[88:91], v42 offset:49152
  v_accvgpr_read_b32 v237, a177
  v_mfma_f32_16x16x32_bf16 v[228:231], v[76:79], v[60:63], v[228:231]
  ds_read_b128 v[92:95], v42 offset:50176
  v_accvgpr_read_b32 v238, a178
  v_mfma_f32_16x16x32_bf16 v[16:19], v[72:75], v[48:51], v[16:19]
  ds_read_b64_tr_b16 v[104:105], v44 offset:57344
  v_accvgpr_read_b32 v239, a179
  v_mfma_f32_16x16x32_bf16 v[20:23], v[76:79], v[48:51], v[20:23]
  ds_read_b64_tr_b16 v[106:107], v44 offset:57600
  v_accvgpr_read_b32 v240, a180
  v_mfma_f32_16x16x32_bf16 v[24:27], v[84:87], v[56:59], v[24:27]
  ds_read_b64_tr_b16 v[108:109], v45 offset:57344
  v_accvgpr_read_b32 v241, a181
  v_mfma_f32_16x16x32_bf16 v[28:31], v[84:87], v[60:63], v[28:31]
  v_accvgpr_read_b32 v242, a182
  v_accvgpr_read_b32 v243, a183
  v_mfma_f32_16x16x32_bf16 v[232:235], v[80:83], v[48:51], v[232:235]
  ds_read_b64_tr_b16 v[110:111], v45 offset:57600
  v_cvt_pk_bf16_f32 v244, v236, v237
  v_mfma_f32_16x16x32_bf16 v[184:187], v[120:123], v[68:71], v[184:187]
  ds_read_b128 v[116:119], v47 offset:704
  v_cvt_pk_bf16_f32 v245, v238, v239
  v_mfma_f32_16x16x32_bf16 a[64:67], v[120:123], v[64:67], a[64:67]
  ds_read_b64_tr_b16 v[112:113], v46 offset:59392
  v_cvt_pk_bf16_f32 v246, v240, v241
  v_mfma_f32_16x16x32_bf16 a[68:71], v[124:127], v[64:67], a[68:71]
  ds_read_b64_tr_b16 v[114:115], v46 offset:59520
  v_cvt_pk_bf16_f32 v247, v242, v243
  v_mfma_f32_16x16x32_bf16 v[188:191], v[124:127], v[68:71], v[188:191]
  v_mfma_f32_16x16x32_bf16 v[192:195], v[128:131], v[68:71], v[192:195]
  ds_read_b128 v[96:99], v43 offset:49152
  v_mfma_f32_16x16x32_bf16 a[72:75], v[128:131], v[64:67], a[72:75]
  buffer_store_dwordx4 v[244:247], v52, s[28:31], s40 offen offset:2048 sc1
  v_accvgpr_read_b32 v236, a184
  v_mfma_f32_16x16x32_bf16 a[76:79], v[132:135], v[64:67], a[76:79]
  ds_read_b128 v[100:103], v43 offset:50176
  v_accvgpr_read_b32 v237, a185
  v_mfma_f32_16x16x32_bf16 v[196:199], v[132:135], v[68:71], v[196:199]
  ds_read_b64_tr_b16 v[152:153], v15 offset:49152
  v_accvgpr_read_b32 v238, a186
  v_mfma_f32_16x16x32_bf16 v[200:203], v[136:139], v[68:71], v[200:203]
  ds_read_b64_tr_b16 v[154:155], v15 offset:51200
  v_accvgpr_read_b32 v239, a187
  v_mfma_f32_16x16x32_bf16 a[80:83], v[136:139], v[64:67], a[80:83]
  ds_read_b64_tr_b16 v[156:157], v32 offset:49152
  v_accvgpr_read_b32 v240, a188
  v_mfma_f32_16x16x32_bf16 a[84:87], v[140:143], v[64:67], a[84:87]
  ds_read_b64_tr_b16 v[158:159], v32 offset:51200
  v_accvgpr_read_b32 v241, a189
  v_mfma_f32_16x16x32_bf16 v[204:207], v[140:143], v[68:71], v[204:207]
  v_accvgpr_read_b32 v242, a190
  v_accvgpr_read_b32 v243, a191
  v_mfma_f32_16x16x32_bf16 v[208:211], v[144:147], v[68:71], v[208:211]
  ds_read_b64_tr_b16 v[160:161], v33 offset:49152
  v_cvt_pk_bf16_f32 v248, v236, v237
  v_mfma_f32_16x16x32_bf16 a[88:91], v[144:147], v[64:67], a[88:91]
  ds_read_b64_tr_b16 v[162:163], v33 offset:51200
  v_cvt_pk_bf16_f32 v249, v238, v239
  v_mfma_f32_16x16x32_bf16 a[92:95], v[148:151], v[64:67], a[92:95]
  ds_read_b64_tr_b16 v[164:165], v34 offset:49152
  v_cvt_pk_bf16_f32 v250, v240, v241
  v_mfma_f32_16x16x32_bf16 v[212:215], v[148:151], v[68:71], v[212:215]
  ds_read_b64_tr_b16 v[166:167], v34 offset:51200
  v_cvt_pk_bf16_f32 v251, v242, v243
  v_mfma_f32_16x16x32_bf16 a[28:31], v[148:151], v[56:59], a[28:31]
  v_mfma_f32_16x16x32_bf16 a[60:63], v[148:151], v[60:63], a[60:63]
  ds_read_b64_tr_b16 v[168:169], v35 offset:49152
  v_mfma_f32_16x16x32_bf16 a[56:59], v[144:147], v[60:63], a[56:59]
  buffer_store_dwordx4 v[248:251], v52, s[28:31], s40 offen offset:3072 sc1
  v_mfma_f32_16x16x32_bf16 a[24:27], v[144:147], v[56:59], a[24:27]
  s_add_u32 s40, s40, s42
  ds_read_b64_tr_b16 v[170:171], v35 offset:51200
  v_accvgpr_read_b32 v236, a192
  v_mfma_f32_16x16x32_bf16 a[20:23], v[140:143], v[56:59], a[20:23]
  ds_read_b64_tr_b16 v[172:173], v36 offset:49152
  v_accvgpr_read_b32 v237, a193
  v_mfma_f32_16x16x32_bf16 a[52:55], v[140:143], v[60:63], a[52:55]
  ds_read_b64_tr_b16 v[174:175], v36 offset:51200
  v_accvgpr_read_b32 v238, a194
  v_mfma_f32_16x16x32_bf16 a[48:51], v[136:139], v[60:63], a[48:51]
  ds_read_b64_tr_b16 v[176:177], v37 offset:49152
  v_accvgpr_read_b32 v239, a195
  v_mfma_f32_16x16x32_bf16 a[16:19], v[136:139], v[56:59], a[16:19]
  ds_read_b64_tr_b16 v[178:179], v37 offset:51200
  v_accvgpr_read_b32 v240, a196
  v_mfma_f32_16x16x32_bf16 a[12:15], v[132:135], v[56:59], a[12:15]
  v_accvgpr_read_b32 v241, a197
  v_accvgpr_read_b32 v242, a198
  v_mfma_f32_16x16x32_bf16 a[44:47], v[132:135], v[60:63], a[44:47]
  ds_read_b64_tr_b16 v[180:181], v38 offset:49152
  v_accvgpr_read_b32 v243, a199
  v_mfma_f32_16x16x32_bf16 a[40:43], v[128:131], v[60:63], a[40:43]
  ds_read_b64_tr_b16 v[182:183], v38 offset:51200
  v_cvt_pk_bf16_f32 v244, v236, v237
  v_mfma_f32_16x16x32_bf16 a[8:11], v[128:131], v[56:59], a[8:11]
  v_cvt_pk_bf16_f32 v245, v238, v239
  v_cvt_pk_bf16_f32 v246, v240, v241
  v_mfma_f32_16x16x32_bf16 a[4:7], v[124:127], v[56:59], a[4:7]
  v_cvt_pk_bf16_f32 v247, v242, v243
  v_mfma_f32_16x16x32_bf16 a[36:39], v[124:127], v[60:63], a[36:39]
  v_mfma_f32_16x16x32_bf16 a[32:35], v[120:123], v[60:63], a[32:35]
  v_mfma_f32_16x16x32_bf16 a[0:3], v[120:123], v[56:59], a[0:3]
  v_mfma_f32_16x16x32_bf16 a[96:99], v[56:59], v[56:59], a[96:99]
  v_mfma_f32_16x16x32_bf16 a[100:103], v[60:63], v[60:63], a[100:103]
  s_waitcnt lgkmcnt(0)
  s_waitcnt vmcnt(10)
  s_barrier
  v_mfma_f32_16x16x32_bf16 v[216:219], v[104:107], v[88:91], v[216:219]
  buffer_store_dwordx4 v[244:247], v52, s[28:31], s40 offen offset:0 sc1
  v_accvgpr_read_b32 v236, a200
  v_mfma_f32_16x16x32_bf16 v[220:223], v[108:111], v[88:91], v[220:223]
  ds_read_b128 v[56:59], v42 offset:0
  v_accvgpr_read_b32 v237, a201
  v_mfma_f32_16x16x32_bf16 v[224:227], v[104:107], v[92:95], v[224:227]
  ds_read_b128 v[60:63], v42 offset:1024
  v_accvgpr_read_b32 v238, a202
  v_mfma_f32_16x16x32_bf16 v[228:231], v[108:111], v[92:95], v[228:231]
  ds_read_b64_tr_b16 v[72:73], v44 offset:8192
  v_accvgpr_read_b32 v239, a203
  v_mfma_f32_16x16x32_bf16 v[16:19], v[104:107], v[48:51], v[16:19]
  ds_read_b64_tr_b16 v[74:75], v44 offset:8448
  v_accvgpr_read_b32 v240, a204
  v_mfma_f32_16x16x32_bf16 v[20:23], v[108:111], v[48:51], v[20:23]
  ds_read_b64_tr_b16 v[76:77], v45 offset:8192
  v_accvgpr_read_b32 v241, a205
  v_mfma_f32_16x16x32_bf16 v[24:27], v[116:119], v[88:91], v[24:27]
  v_accvgpr_read_b32 v242, a206
  v_accvgpr_read_b32 v243, a207
  v_mfma_f32_16x16x32_bf16 v[28:31], v[116:119], v[92:95], v[28:31]
  ds_read_b64_tr_b16 v[78:79], v45 offset:8448
  v_cvt_pk_bf16_f32 v248, v236, v237
  v_mfma_f32_16x16x32_bf16 v[232:235], v[112:115], v[48:51], v[232:235]
  ds_read_b128 v[84:87], v47 offset:768
  v_cvt_pk_bf16_f32 v249, v238, v239
  v_mfma_f32_16x16x32_bf16 v[184:187], v[152:155], v[100:103], v[184:187]
  ds_read_b64_tr_b16 v[80:81], v46 offset:10240
  v_cvt_pk_bf16_f32 v250, v240, v241
  v_mfma_f32_16x16x32_bf16 a[64:67], v[152:155], v[96:99], a[64:67]
  ds_read_b64_tr_b16 v[82:83], v46 offset:10368
  v_cvt_pk_bf16_f32 v251, v242, v243
  v_mfma_f32_16x16x32_bf16 a[68:71], v[156:159], v[96:99], a[68:71]
  v_mfma_f32_16x16x32_bf16 v[188:191], v[156:159], v[100:103], v[188:191]
  ds_read_b128 v[64:67], v43 offset:0
  v_mfma_f32_16x16x32_bf16 v[192:195], v[160:163], v[100:103], v[192:195]
  ds_read_b128 v[68:71], v43 offset:1024
  v_mfma_f32_16x16x32_bf16 a[72:75], v[160:163], v[96:99], a[72:75]
  buffer_store_dwordx4 v[248:251], v52, s[28:31], s40 offen offset:1024 sc1
  v_accvgpr_read_b32 v236, a208
  v_mfma_f32_16x16x32_bf16 a[76:79], v[164:167], v[96:99], a[76:79]
  ds_read_b64_tr_b16 v[120:121], v15 offset:0
  v_accvgpr_read_b32 v237, a209
  v_mfma_f32_16x16x32_bf16 v[196:199], v[164:167], v[100:103], v[196:199]
  ds_read_b64_tr_b16 v[122:123], v15 offset:2048
  v_accvgpr_read_b32 v238, a210
  v_mfma_f32_16x16x32_bf16 v[200:203], v[168:171], v[100:103], v[200:203]
  ds_read_b64_tr_b16 v[124:125], v32 offset:0
  v_accvgpr_read_b32 v239, a211
  v_mfma_f32_16x16x32_bf16 a[80:83], v[168:171], v[96:99], a[80:83]
  ds_read_b64_tr_b16 v[126:127], v32 offset:2048
  v_accvgpr_read_b32 v240, a212
  v_mfma_f32_16x16x32_bf16 a[84:87], v[172:175], v[96:99], a[84:87]
  ds_read_b64_tr_b16 v[128:129], v33 offset:0
  v_accvgpr_read_b32 v241, a213
  v_mfma_f32_16x16x32_bf16 v[204:207], v[172:175], v[100:103], v[204:207]
  v_accvgpr_read_b32 v242, a214
  v_accvgpr_read_b32 v243, a215
  v_mfma_f32_16x16x32_bf16 v[208:211], v[176:179], v[100:103], v[208:211]
  ds_read_b64_tr_b16 v[130:131], v33 offset:2048
  v_cvt_pk_bf16_f32 v244, v236, v237
  v_mfma_f32_16x16x32_bf16 a[88:91], v[176:179], v[96:99], a[88:91]
  ds_read_b64_tr_b16 v[132:133], v34 offset:0
  v_cvt_pk_bf16_f32 v245, v238, v239
  v_mfma_f32_16x16x32_bf16 a[92:95], v[180:183], v[96:99], a[92:95]
  ds_read_b64_tr_b16 v[134:135], v34 offset:2048
  v_cvt_pk_bf16_f32 v246, v240, v241
  v_mfma_f32_16x16x32_bf16 v[212:215], v[180:183], v[100:103], v[212:215]
  ds_read_b64_tr_b16 v[136:137], v35 offset:0
  v_cvt_pk_bf16_f32 v247, v242, v243
  v_mfma_f32_16x16x32_bf16 a[28:31], v[180:183], v[88:91], a[28:31]
  v_mfma_f32_16x16x32_bf16 a[60:63], v[180:183], v[92:95], a[60:63]
  ds_read_b64_tr_b16 v[138:139], v35 offset:2048
  v_mfma_f32_16x16x32_bf16 a[56:59], v[176:179], v[92:95], a[56:59]
  buffer_store_dwordx4 v[244:247], v52, s[28:31], s40 offen offset:2048 sc1
  v_accvgpr_read_b32 v236, a216
  v_mfma_f32_16x16x32_bf16 a[24:27], v[176:179], v[88:91], a[24:27]
  ds_read_b64_tr_b16 v[140:141], v36 offset:0
  v_accvgpr_read_b32 v237, a217
  v_mfma_f32_16x16x32_bf16 a[20:23], v[172:175], v[88:91], a[20:23]
  ds_read_b64_tr_b16 v[142:143], v36 offset:2048
  v_accvgpr_read_b32 v238, a218
  v_mfma_f32_16x16x32_bf16 a[52:55], v[172:175], v[92:95], a[52:55]
  ds_read_b64_tr_b16 v[144:145], v37 offset:0
  v_accvgpr_read_b32 v239, a219
  v_mfma_f32_16x16x32_bf16 a[48:51], v[168:171], v[92:95], a[48:51]
  ds_read_b64_tr_b16 v[146:147], v37 offset:2048
  v_accvgpr_read_b32 v240, a220
  v_mfma_f32_16x16x32_bf16 a[16:19], v[168:171], v[88:91], a[16:19]
  ds_read_b64_tr_b16 v[148:149], v38 offset:0
  v_accvgpr_read_b32 v241, a221
  v_mfma_f32_16x16x32_bf16 a[12:15], v[164:167], v[88:91], a[12:15]
  v_accvgpr_read_b32 v242, a222
  v_accvgpr_read_b32 v243, a223
  v_mfma_f32_16x16x32_bf16 a[44:47], v[164:167], v[92:95], a[44:47]
  ds_read_b64_tr_b16 v[150:151], v38 offset:2048
  v_cvt_pk_bf16_f32 v248, v236, v237
  v_mfma_f32_16x16x32_bf16 a[40:43], v[160:163], v[92:95], a[40:43]
  v_cvt_pk_bf16_f32 v249, v238, v239
  v_cvt_pk_bf16_f32 v250, v240, v241
  v_mfma_f32_16x16x32_bf16 a[8:11], v[160:163], v[88:91], a[8:11]
  v_cvt_pk_bf16_f32 v251, v242, v243
  v_mfma_f32_16x16x32_bf16 a[4:7], v[156:159], v[88:91], a[4:7]
  v_mfma_f32_16x16x32_bf16 a[36:39], v[156:159], v[92:95], a[36:39]
  v_mfma_f32_16x16x32_bf16 a[32:35], v[152:155], v[92:95], a[32:35]
  v_mfma_f32_16x16x32_bf16 a[0:3], v[152:155], v[88:91], a[0:3]
  v_mfma_f32_16x16x32_bf16 a[96:99], v[88:91], v[88:91], a[96:99]
  v_mfma_f32_16x16x32_bf16 a[100:103], v[92:95], v[92:95], a[100:103]
  s_waitcnt lgkmcnt(0)
  s_waitcnt vmcnt(7)
  s_barrier
  v_mfma_f32_16x16x32_bf16 v[216:219], v[72:75], v[56:59], v[216:219]
  buffer_store_dwordx4 v[248:251], v52, s[28:31], s40 offen offset:3072 sc1
  v_mfma_f32_16x16x32_bf16 v[220:223], v[76:79], v[56:59], v[220:223]
  s_add_u32 s40, s40, s41
  ds_read_b128 v[88:91], v42 offset:16384
  v_accvgpr_read_b32 v236, a224
  v_mfma_f32_16x16x32_bf16 v[224:227], v[72:75], v[60:63], v[224:227]
  ds_read_b128 v[92:95], v42 offset:17408
  v_accvgpr_read_b32 v237, a225
  v_mfma_f32_16x16x32_bf16 v[228:231], v[76:79], v[60:63], v[228:231]
  ds_read_b64_tr_b16 v[104:105], v44 offset:24576
  v_accvgpr_read_b32 v238, a226
  v_mfma_f32_16x16x32_bf16 v[16:19], v[72:75], v[48:51], v[16:19]
  ds_read_b64_tr_b16 v[106:107], v44 offset:24832
  v_accvgpr_read_b32 v239, a227
  v_mfma_f32_16x16x32_bf16 v[20:23], v[76:79], v[48:51], v[20:23]
  ds_read_b64_tr_b16 v[108:109], v45 offset:24576
  v_accvgpr_read_b32 v240, a228
  v_mfma_f32_16x16x32_bf16 v[24:27], v[84:87], v[56:59], v[24:27]
  v_accvgpr_read_b32 v241, a229
  v_accvgpr_read_b32 v242, a230
  v_mfma_f32_16x16x32_bf16 v[28:31], v[84:87], v[60:63], v[28:31]
  ds_read_b64_tr_b16 v[110:111], v45 offset:24832
  v_accvgpr_read_b32 v243, a231
  v_mfma_f32_16x16x32_bf16 v[232:235], v[80:83], v[48:51], v[232:235]
  ds_read_b128 v[116:119], v47 offset:832
  v_cvt_pk_bf16_f32 v244, v236, v237
  v_mfma_f32_16x16x32_bf16 v[184:187], v[120:123], v[68:71], v[184:187]
  ds_read_b64_tr_b16 v[112:113], v46 offset:26624
  v_cvt_pk_bf16_f32 v245, v238, v239
  v_mfma_f32_16x16x32_bf16 a[64:67], v[120:123], v[64:67], a[64:67]
  ds_read_b64_tr_b16 v[114:115], v46 offset:26752
  v_cvt_pk_bf16_f32 v246, v240, v241
  v_mfma_f32_16x16x32_bf16 a[68:71], v[124:127], v[64:67], a[68:71]
  v_cvt_pk_bf16_f32 v247, v242, v243
  v_mfma_f32_16x16x32_bf16 v[188:191], v[124:127], v[68:71], v[188:191]
  ds_read_b128 v[96:99], v43 offset:16384
  v_mfma_f32_16x16x32_bf16 v[192:195], v[128:131], v[68:71], v[192:195]
  ds_read_b128 v[100:103], v43 offset:17408
  v_mfma_f32_16x16x32_bf16 a[72:75], v[128:131], v[64:67], a[72:75]
  buffer_store_dwordx4 v[244:247], v52, s[28:31], s40 offen offset:0 sc1
  v_accvgpr_read_b32 v236, a232
  v_mfma_f32_16x16x32_bf16 a[76:79], v[132:135], v[64:67], a[76:79]
  ds_read_b64_tr_b16 v[152:153], v15 offset:16384
  v_accvgpr_read_b32 v237, a233
  v_mfma_f32_16x16x32_bf16 v[196:199], v[132:135], v[68:71], v[196:199]
  ds_read_b64_tr_b16 v[154:155], v15 offset:18432
  v_accvgpr_read_b32 v238, a234
  v_mfma_f32_16x16x32_bf16 v[200:203], v[136:139], v[68:71], v[200:203]
  ds_read_b64_tr_b16 v[156:157], v32 offset:16384
  v_accvgpr_read_b32 v239, a235
  v_mfma_f32_16x16x32_bf16 a[80:83], v[136:139], v[64:67], a[80:83]
  ds_read_b64_tr_b16 v[158:159], v32 offset:18432
  v_accvgpr_read_b32 v240, a236
  v_mfma_f32_16x16x32_bf16 a[84:87], v[140:143], v[64:67], a[84:87]
  ds_read_b64_tr_b16 v[160:161], v33 offset:16384
  v_accvgpr_read_b32 v241, a237
  v_mfma_f32_16x16x32_bf16 v[204:207], v[140:143], v[68:71], v[204:207]
  v_accvgpr_read_b32 v242, a238
  v_accvgpr_read_b32 v243, a239
  v_mfma_f32_16x16x32_bf16 v[208:211], v[144:147], v[68:71], v[208:211]
  ds_read_b64_tr_b16 v[162:163], v33 offset:18432
  v_cvt_pk_bf16_f32 v248, v236, v237
  v_mfma_f32_16x16x32_bf16 a[88:91], v[144:147], v[64:67], a[88:91]
  ds_read_b64_tr_b16 v[164:165], v34 offset:16384
  v_cvt_pk_bf16_f32 v249, v238, v239
  v_mfma_f32_16x16x32_bf16 a[92:95], v[148:151], v[64:67], a[92:95]
  ds_read_b64_tr_b16 v[166:167], v34 offset:18432
  v_cvt_pk_bf16_f32 v250, v240, v241
  v_mfma_f32_16x16x32_bf16 v[212:215], v[148:151], v[68:71], v[212:215]
  ds_read_b64_tr_b16 v[168:169], v35 offset:16384
  v_cvt_pk_bf16_f32 v251, v242, v243
  v_mfma_f32_16x16x32_bf16 a[28:31], v[148:151], v[56:59], a[28:31]
  v_mfma_f32_16x16x32_bf16 a[60:63], v[148:151], v[60:63], a[60:63]
  ds_read_b64_tr_b16 v[170:171], v35 offset:18432
  v_mfma_f32_16x16x32_bf16 a[56:59], v[144:147], v[60:63], a[56:59]
  buffer_store_dwordx4 v[248:251], v52, s[28:31], s40 offen offset:1024 sc1
  v_accvgpr_read_b32 v236, a240
  v_mfma_f32_16x16x32_bf16 a[24:27], v[144:147], v[56:59], a[24:27]
  ds_read_b64_tr_b16 v[172:173], v36 offset:16384
  v_accvgpr_read_b32 v237, a241
  v_mfma_f32_16x16x32_bf16 a[20:23], v[140:143], v[56:59], a[20:23]
  ds_read_b64_tr_b16 v[174:175], v36 offset:18432
  v_accvgpr_read_b32 v238, a242
  v_mfma_f32_16x16x32_bf16 a[52:55], v[140:143], v[60:63], a[52:55]
  ds_read_b64_tr_b16 v[176:177], v37 offset:16384
  v_accvgpr_read_b32 v239, a243
  v_mfma_f32_16x16x32_bf16 a[48:51], v[136:139], v[60:63], a[48:51]
  ds_read_b64_tr_b16 v[178:179], v37 offset:18432
  v_accvgpr_read_b32 v240, a244
  v_mfma_f32_16x16x32_bf16 a[16:19], v[136:139], v[56:59], a[16:19]
  ds_read_b64_tr_b16 v[180:181], v38 offset:16384
  v_accvgpr_read_b32 v241, a245
  v_mfma_f32_16x16x32_bf16 a[12:15], v[132:135], v[56:59], a[12:15]
  v_accvgpr_read_b32 v242, a246
  v_accvgpr_read_b32 v243, a247
  v_mfma_f32_16x16x32_bf16 a[44:47], v[132:135], v[60:63], a[44:47]
  ds_read_b64_tr_b16 v[182:183], v38 offset:18432
  v_cvt_pk_bf16_f32 v244, v236, v237
  v_mfma_f32_16x16x32_bf16 a[40:43], v[128:131], v[60:63], a[40:43]
  v_cvt_pk_bf16_f32 v245, v238, v239
  v_cvt_pk_bf16_f32 v246, v240, v241
  v_mfma_f32_16x16x32_bf16 a[8:11], v[128:131], v[56:59], a[8:11]
  v_cvt_pk_bf16_f32 v247, v242, v243
  v_mfma_f32_16x16x32_bf16 a[4:7], v[124:127], v[56:59], a[4:7]
  v_mfma_f32_16x16x32_bf16 a[36:39], v[124:127], v[60:63], a[36:39]
  v_mfma_f32_16x16x32_bf16 a[32:35], v[120:123], v[60:63], a[32:35]
  v_mfma_f32_16x16x32_bf16 a[0:3], v[120:123], v[56:59], a[0:3]
  v_mfma_f32_16x16x32_bf16 a[96:99], v[56:59], v[56:59], a[96:99]
  v_mfma_f32_16x16x32_bf16 a[100:103], v[60:63], v[60:63], a[100:103]
  s_waitcnt lgkmcnt(0)
  s_cmp_lg_u32 s19, 0
  s_cbranch_scc1 Lk_go23
  s_waitcnt vmcnt(9)
  v_cmp_lt_u32 vcc, v10, v7
  s_nop 4
  s_cbranch_vccz Lk_go23
  s_mov_b32 s43, 0
Lk_poll22:
  s_sleep 3
  buffer_load_dword v10, v6, s[20:23], 0 offen offset:0 sc1
  s_waitcnt vmcnt(0)
  v_cmp_lt_u32 vcc, v10, v7
  s_nop 4
  s_cbranch_vccz Lk_go23
  s_add_u32 s43, s43, 1
  s_cmp_lt_u32 s43, 0x40000
  s_cbranch_scc1 Lk_poll22
Lk_go23:
  s_mov_b32 s50, s17
  s_cmp_eq_u32 s44, 7
  s_cselect_b32 s32, 32, s72
  s_and_b32 s78, s32, 1
  s_lshl_b32 s3, s32, 14
  s_sub_u32 s76, s10, 245760
  s_cmp_ge_u32 s44, 7
  s_cbranch_scc1 Lk_sp24
  s_xor_b32 s78, s78, 1
  s_lshl_b32 s76, s50, 20
  s_add_u32 s76, s76, s3
  s_lshl_b32 s3, s44, 2
  s_add_u32 s3, s3, 5
  s_lshl_b32 s3, s3, 14
Lk_sp24:
  s_add_u32 s3, s3, s69
  s_lshl_b32 s68, s78, 15
  s_add_u32 s68, s68, s34
  s_cmp_eq_u32 s78, 0
  s_cselect_b32 s39, s70, s71
  s_cselect_b32 s38, s71, s70
  s_cselect_b32 s77, 0x10000, 0
  s_add_u32 s77, s77, s34
  s_barrier
  v_mfma_f32_16x16x32_bf16 v[216:219], v[104:107], v[88:91], v[216:219]
  s_mov_b32 m0, s68
  v_mfma_f32_16x16x32_bf16 v[220:223], v[108:111], v[88:91], v[220:223]
  buffer_load_dwordx4 v9, s[8:11], s69 offen offset:0 sc1 lds
  v_mfma_f32_16x16x32_bf16 v[224:227], v[104:107], v[92:95], v[224:227]
  v_mfma_f32_16x16x32_bf16 v[228:231], v[108:111], v[92:95], v[228:231]
  v_mfma_f32_16x16x32_bf16 v[16:19], v[104:107], v[48:51], v[16:19]
  v_mfma_f32_16x16x32_bf16 v[20:23], v[108:111], v[48:51], v[20:23]
  buffer_load_dwordx4 v9, s[8:11], s69 offen offset:1024 sc1 lds
  v_mfma_f32_16x16x32_bf16 v[24:27], v[116:119], v[88:91], v[24:27]
  v_mfma_f32_16x16x32_bf16 v[28:31], v[116:119], v[92:95], v[28:31]
  v_mfma_f32_16x16x32_bf16 v[232:235], v[112:115], v[48:51], v[232:235]
  v_mfma_f32_16x16x32_bf16 v[184:187], v[152:155], v[100:103], v[184:187]
  buffer_load_dwordx4 v9, s[8:11], s69 offen offset:2048 sc1 lds
  v_mfma_f32_16x16x32_bf16 a[64:67], v[152:155], v[96:99], a[64:67]
  v_mfma_f32_16x16x32_bf16 a[68:71], v[156:159], v[96:99], a[68:71]
  v_mfma_f32_16x16x32_bf16 v[188:191], v[156:159], v[100:103], v[188:191]
  v_mfma_f32_16x16x32_bf16 v[192:195], v[160:163], v[100:103], v[192:195]
  buffer_load_dwordx4 v9, s[8:11], s69 offen offset:3072 sc1 lds
  v_mfma_f32_16x16x32_bf16 a[72:75], v[160:163], v[96:99], a[72:75]
  s_add_u32 m0, s68, 0x8000
  v_mfma_f32_16x16x32_bf16 a[76:79], v[164:167], v[96:99], a[76:79]
  v_mfma_f32_16x16x32_bf16 v[196:199], v[164:167], v[100:103], v[196:199]
  v_mfma_f32_16x16x32_bf16 v[200:203], v[168:171], v[100:103], v[200:203]
  buffer_load_dwordx4 v9, s[8:11], s70 offen offset:0 sc1 lds
  v_mfma_f32_16x16x32_bf16 a[80:83], v[168:171], v[96:99], a[80:83]
  v_mfma_f32_16x16x32_bf16 a[84:87], v[172:175], v[96:99], a[84:87]
  v_mfma_f32_16x16x32_bf16 v[204:207], v[172:175], v[100:103], v[204:207]
  v_mfma_f32_16x16x32_bf16 v[208:211], v[176:179], v[100:103], v[208:211]
  buffer_load_dwordx4 v9, s[8:11], s70 offen offset:1024 sc1 lds
  v_mfma_f32_16x16x32_bf16 a[88:91], v[176:179], v[96:99], a[88:91]
  v_mfma_f32_16x16x32_bf16 a[92:95], v[180:183], v[96:99], a[92:95]
  v_mfma_f32_16x16x32_bf16 v[212:215], v[180:183], v[100:103], v[212:215]
  v_mfma_f32_16x16x32_bf16 a[28:31], v[180:183], v[88:91], a[28:31]
  buffer_load_dwordx4 v9, s[8:11], s70 offen offset:2048 sc1 lds
  v_mfma_f32_16x16x32_bf16 a[60:63], v[180:183], v[92:95], a[60:63]
  v_mfma_f32_16x16x32_bf16 a[56:59], v[176:179], v[92:95], a[56:59]
  v_mfma_f32_16x16x32_bf16 a[24:27], v[176:179], v[88:91], a[24:27]
  v_mfma_f32_16x16x32_bf16 a[20:23], v[172:175], v[88:91], a[20:23]
  buffer_load_dwordx4 v9, s[8:11], s70 offen offset:3072 sc1 lds
  v_mfma_f32_16x16x32_bf16 a[52:55], v[172:175], v[92:95], a[52:55]
  s_add_u32 m0, s68, 0x14000
  v_mfma_f32_16x16x32_bf16 a[48:51], v[168:171], v[92:95], a[48:51]
  v_mfma_f32_16x16x32_bf16 a[16:19], v[168:171], v[88:91], a[16:19]
  v_mfma_f32_16x16x32_bf16 a[12:15], v[164:167], v[88:91], a[12:15]
  v_mfma_f32_16x16x32_bf16 a[44:47], v[164:167], v[92:95], a[44:47]
  v_mfma_f32_16x16x32_bf16 a[40:43], v[160:163], v[92:95], a[40:43]
  v_mfma_f32_16x16x32_bf16 a[8:11], v[160:163], v[88:91], a[8:11]
  v_mfma_f32_16x16x32_bf16 a[4:7], v[156:159], v[88:91], a[4:7]
  v_mfma_f32_16x16x32_bf16 a[36:39], v[156:159], v[92:95], a[36:39]
  v_mfma_f32_16x16x32_bf16 a[32:35], v[152:155], v[92:95], a[32:35]
  v_mfma_f32_16x16x32_bf16 a[0:3], v[152:155], v[88:91], a[0:3]
  v_mfma_f32_16x16x32_bf16 a[96:99], v[88:91], v[88:91], a[96:99]
  v_mfma_f32_16x16x32_bf16 a[100:103], v[92:95], v[92:95], a[100:103]
  v_mov_b32 v120, 0x3db8aa3b
  v_mov_b32 v121, 0x3db8aa3b
  s_xor_b32 s32, s46, 1
  s_lshl_b32 s32, s32, 13
  s_lshl_b32 s33, s45, 15
  s_add_u32 s32, s32, s33
  s_add_u32 s32, s32, 0x4000
  v_add_u32 v5, s32, v52
  buffer_store_dwordx4 v[244:247], v52, s[28:31], s40 offen offset:2048 sc1
  v_accvgpr_read_b32 v236, a248
  v_accvgpr_read_b32 v237, a249
  v_accvgpr_read_b32 v238, a250
  v_accvgpr_read_b32 v239, a251
  v_accvgpr_read_b32 v240, a252
  v_accvgpr_read_b32 v241, a253
  v_accvgpr_read_b32 v242, a254
  v_accvgpr_read_b32 v243, a255
  v_cvt_pk_bf16_f32 v248, v236, v237
  v_cvt_pk_bf16_f32 v249, v238, v239
  v_cvt_pk_bf16_f32 v250, v240, v241
  v_cvt_pk_bf16_f32 v251, v242, v243
  v_pk_mul_f32 v[184:185], v[184:185], v[120:121]
  v_pk_mul_f32 v[186:187], v[186:187], v[120:121]
  v_pk_mul_f32 v[188:189], v[188:189], v[120:121]
  v_pk_mul_f32 v[190:191], v[190:191], v[120:121]
  v_cvt_pk_bf16_f32 v104, v184, v185
  v_cvt_pk_bf16_f32 v105, v186, v187
  v_cvt_pk_bf16_f32 v106, v188, v189
  v_cvt_pk_bf16_f32 v107, v190, v191
  ds_write_b128 v5, v[104:107] offset:4096
  v_pk_mul_f32 v[192:193], v[192:193], v[120:121]
  v_pk_mul_f32 v[194:195], v[194:195], v[120:121]
  v_pk_mul_f32 v[196:197], v[196:197], v[120:121]
  v_pk_mul_f32 v[198:199], v[198:199], v[120:121]
  v_cvt_pk_bf16_f32 v108, v192, v193
  v_cvt_pk_bf16_f32 v109, v194, v195
  v_cvt_pk_bf16_f32 v110, v196, v197
  v_cvt_pk_bf16_f32 v111, v198, v199
  ds_write_b128 v5, v[108:111] offset:5120
  v_pk_mul_f32 v[200:201], v[200:201], v[120:121]
  v_pk_mul_f32 v[202:203], v[202:203], v[120:121]
  v_pk_mul_f32 v[204:205], v[204:205], v[120:121]
  v_pk_mul_f32 v[206:207], v[206:207], v[120:121]
  v_cvt_pk_bf16_f32 v112, v200, v201
  v_cvt_pk_bf16_f32 v113, v202, v203
  v_cvt_pk_bf16_f32 v114, v204, v205
  v_cvt_pk_bf16_f32 v115, v206, v207
  ds_write_b128 v5, v[112:115] offset:6144
  buffer_store_dwordx4 v[248:251], v52, s[28:31], s40 offen offset:3072 sc1
  s_add_u32 s40, s40, s42
  ds_read_b128 v[236:239], v8 offset:0
  ds_read_b128 v[240:243], v8 offset:1024
  v_nop
  v_nop
  v_pk_mul_f32 v[208:209], v[208:209], v[120:121]
  v_pk_mul_f32 v[210:211], v[210:211], v[120:121]
  v_pk_mul_f32 v[212:213], v[212:213], v[120:121]
  v_pk_mul_f32 v[214:215], v[214:215], v[120:121]
  v_cvt_pk_bf16_f32 v116, v208, v209
  v_cvt_pk_bf16_f32 v117, v210, v211
  v_cvt_pk_bf16_f32 v118, v212, v213
  v_cvt_pk_bf16_f32 v119, v214, v215
  ds_write_b128 v5, v[116:119] offset:7168
  v_accvgpr_read_b32 v128, a64
  v_accvgpr_read_b32 v129, a65
  v_accvgpr_read_b32 v130, a66
  v_accvgpr_read_b32 v131, a67
  v_accvgpr_read_b32 v132, a68
  v_accvgpr_read_b32 v133, a69
  v_accvgpr_read_b32 v134, a70
  v_accvgpr_read_b32 v135, a71
  v_pk_mul_f32 v[128:129], v[128:129], v[120:121]
  v_pk_mul_f32 v[130:131], v[130:131], v[120:121]
  v_pk_mul_f32 v[132:133], v[132:133], v[120:121]
  v_pk_mul_f32 v[134:135], v[134:135], v[120:121]
  v_cvt_pk_bf16_f32 v88, v128, v129
  v_cvt_pk_bf16_f32 v89, v130, v131
  v_cvt_pk_bf16_f32 v90, v132, v133
  v_cvt_pk_bf16_f32 v91, v134, v135
  ds_write_b128 v5, v[88:91] offset:0
  v_accvgpr_read_b32 v136, a72
  v_accvgpr_read_b32 v137, a73
  v_accvgpr_read_b32 v138, a74
  v_accvgpr_read_b32 v139, a75
  v_accvgpr_read_b32 v140, a76
  v_accvgpr_read_b32 v141, a77
  v_accvgpr_read_b32 v142, a78
  v_accvgpr_read_b32 v143, a79
  v_pk_mul_f32 v[136:137], v[136:137], v[120:121]
  v_pk_mul_f32 v[138:139], v[138:139], v[120:121]
  v_pk_mul_f32 v[140:141], v[140:141], v[120:121]
  v_pk_mul_f32 v[142:143], v[142:143], v[120:121]
  v_cvt_pk_bf16_f32 v92, v136, v137
  v_cvt_pk_bf16_f32 v93, v138, v139
  v_cvt_pk_bf16_f32 v94, v140, v141
  v_cvt_pk_bf16_f32 v95, v142, v143
  ds_write_b128 v5, v[92:95] offset:1024
  s_waitcnt lgkmcnt(4)
  buffer_store_dwordx4 v[236:239], v52, s[28:31], s64 offen offset:0 sc1
  v_accvgpr_read_b32 v128, a80
  v_accvgpr_read_b32 v129, a81
  v_accvgpr_read_b32 v130, a82
  v_accvgpr_read_b32 v131, a83
  v_accvgpr_read_b32 v132, a84
  v_accvgpr_read_b32 v133, a85
  v_accvgpr_read_b32 v134, a86
  v_accvgpr_read_b32 v135, a87
  v_pk_mul_f32 v[128:129], v[128:129], v[120:121]
  v_pk_mul_f32 v[130:131], v[130:131], v[120:121]
  v_pk_mul_f32 v[132:133], v[132:133], v[120:121]
  v_pk_mul_f32 v[134:135], v[134:135], v[120:121]
  v_cvt_pk_bf16_f32 v96, v128, v129
  v_cvt_pk_bf16_f32 v97, v130, v131
  v_cvt_pk_bf16_f32 v98, v132, v133
  v_cvt_pk_bf16_f32 v99, v134, v135
  ds_write_b128 v5, v[96:99] offset:2048
  v_accvgpr_read_b32 v136, a88
  v_accvgpr_read_b32 v137, a89
  v_accvgpr_read_b32 v138, a90
  v_accvgpr_read_b32 v139, a91
  v_accvgpr_read_b32 v140, a92
  v_accvgpr_read_b32 v141, a93
  v_accvgpr_read_b32 v142, a94
  v_accvgpr_read_b32 v143, a95
  v_pk_mul_f32 v[136:137], v[136:137], v[120:121]
  v_pk_mul_f32 v[138:139], v[138:139], v[120:121]
  v_pk_mul_f32 v[140:141], v[140:141], v[120:121]
  v_pk_mul_f32 v[142:143], v[142:143], v[120:121]
  v_cvt_pk_bf16_f32 v100, v136, v137
  v_cvt_pk_bf16_f32 v101, v138, v139
  v_cvt_pk_bf16_f32 v102, v140, v141
  v_cvt_pk_bf16_f32 v103, v142, v143
  ds_write_b128 v5, v[100:103] offset:3072
  v_accvgpr_read_b32 v128, a0
  v_accvgpr_read_b32 v129, a1
  v_accvgpr_read_b32 v130, a2
  v_accvgpr_read_b32 v131, a3
  v_accvgpr_read_b32 v132, a4
  v_accvgpr_read_b32 v133, a5
  v_accvgpr_read_b32 v134, a6
  v_accvgpr_read_b32 v135, a7
  v_pk_mul_f32 v[128:129], v[128:129], v[120:121]
  v_pk_mul_f32 v[130:131], v[130:131], v[120:121]
  v_pk_mul_f32 v[132:133], v[132:133], v[120:121]
  v_pk_mul_f32 v[134:135], v[134:135], v[120:121]
  v_cvt_pk_bf16_f32 v56, v128, v129
  v_cvt_pk_bf16_f32 v57, v130, v131
  v_cvt_pk_bf16_f32 v58, v132, v133
  v_cvt_pk_bf16_f32 v59, v134, v135
  s_waitcnt lgkmcnt(5)
  buffer_store_dwordx4 v[240:243], v52, s[28:31], s64 offen offset:1024 sc1
  ds_read_b128 v[236:239], v8 offset:2048
  ds_read_b128 v[240:243], v8 offset:3072
  v_nop
  v_nop
  v_accvgpr_read_b32 v136, a8
  v_accvgpr_read_b32 v137, a9
  v_accvgpr_read_b32 v138, a10
  v_accvgpr_read_b32 v139, a11
  v_accvgpr_read_b32 v140, a12
  v_accvgpr_read_b32 v141, a13
  v_accvgpr_read_b32 v142, a14
  v_accvgpr_read_b32 v143, a15
  v_pk_mul_f32 v[136:137], v[136:137], v[120:121]
  v_pk_mul_f32 v[138:139], v[138:139], v[120:121]
  v_pk_mul_f32 v[140:141], v[140:141], v[120:121]
  v_pk_mul_f32 v[142:143], v[142:143], v[120:121]
  v_cvt_pk_bf16_f32 v60, v136, v137
  v_cvt_pk_bf16_f32 v61, v138, v139
  v_cvt_pk_bf16_f32 v62, v140, v141
  v_cvt_pk_bf16_f32 v63, v142, v143
  s_waitcnt lgkmcnt(0)
  s_barrier
  v_accvgpr_read_b32 v128, a16
  v_accvgpr_read_b32 v129, a17
  v_accvgpr_read_b32 v130, a18
  v_accvgpr_read_b32 v131, a19
  v_accvgpr_read_b32 v132, a20
  v_accvgpr_read_b32 v133, a21
  v_accvgpr_read_b32 v134, a22
  v_accvgpr_read_b32 v135, a23
  v_pk_mul_f32 v[128:129], v[128:129], v[120:121]
  v_pk_mul_f32 v[130:131], v[130:131], v[120:121]
  v_pk_mul_f32 v[132:133], v[132:133], v[120:121]
  v_pk_mul_f32 v[134:135], v[134:135], v[120:121]
  v_cvt_pk_bf16_f32 v64, v128, v129
  v_cvt_pk_bf16_f32 v65, v130, v131
  v_cvt_pk_bf16_f32 v66, v132, v133
  v_cvt_pk_bf16_f32 v67, v134, v135
  v_accvgpr_read_b32 v136, a24
  v_accvgpr_read_b32 v137, a25
  v_accvgpr_read_b32 v138, a26
  v_accvgpr_read_b32 v139, a27
  v_accvgpr_read_b32 v140, a28
  v_accvgpr_read_b32 v141, a29
  v_accvgpr_read_b32 v142, a30
  v_accvgpr_read_b32 v143, a31
  v_pk_mul_f32 v[136:137], v[136:137], v[120:121]
  v_pk_mul_f32 v[138:139], v[138:139], v[120:121]
  v_pk_mul_f32 v[140:141], v[140:141], v[120:121]
  v_pk_mul_f32 v[142:143], v[142:143], v[120:121]
  v_cvt_pk_bf16_f32 v68, v136, v137
  v_cvt_pk_bf16_f32 v69, v138, v139
  v_cvt_pk_bf16_f32 v70, v140, v141
  v_cvt_pk_bf16_f32 v71, v142, v143
  buffer_store_dwordx4 v[236:239], v52, s[28:31], s64 offen offset:2048 sc1
  v_accvgpr_read_b32 v128, a32
  v_accvgpr_read_b32 v129, a33
  v_accvgpr_read_b32 v130, a34
  v_accvgpr_read_b32 v131, a35
  v_accvgpr_read_b32 v132, a36
  v_accvgpr_read_b32 v133, a37
  v_accvgpr_read_b32 v134, a38
  v_accvgpr_read_b32 v135, a39
  v_pk_mul_f32 v[128:129], v[128:129], v[120:121]
  v_pk_mul_f32 v[130:131], v[130:131], v[120:121]
  v_pk_mul_f32 v[132:133], v[132:133], v[120:121]
  v_pk_mul_f32 v[134:135], v[134:135], v[120:121]
  v_cvt_pk_bf16_f32 v72, v128, v129
  v_cvt_pk_bf16_f32 v73, v130, v131
  v_cvt_pk_bf16_f32 v74, v132, v133
  v_cvt_pk_bf16_f32 v75, v134, v135
  v_accvgpr_read_b32 v136, a40
  v_accvgpr_read_b32 v137, a41
  v_accvgpr_read_b32 v138, a42
  v_accvgpr_read_b32 v139, a43
  v_accvgpr_read_b32 v140, a44
  v_accvgpr_read_b32 v141, a45
  v_accvgpr_read_b32 v142, a46
  v_accvgpr_read_b32 v143, a47
  v_pk_mul_f32 v[136:137], v[136:137], v[120:121]
  v_pk_mul_f32 v[138:139], v[138:139], v[120:121]
  v_pk_mul_f32 v[140:141], v[140:141], v[120:121]
  v_pk_mul_f32 v[142:143], v[142:143], v[120:121]
  v_cvt_pk_bf16_f32 v76, v136, v137
  v_cvt_pk_bf16_f32 v77, v138, v139
  v_cvt_pk_bf16_f32 v78, v140, v141
  v_cvt_pk_bf16_f32 v79, v142, v143
  v_accvgpr_read_b32 v128, a48
  v_accvgpr_read_b32 v129, a49
  v_accvgpr_read_b32 v130, a50
  v_accvgpr_read_b32 v131, a51
  v_accvgpr_read_b32 v132, a52
  v_accvgpr_read_b32 v133, a53
  v_accvgpr_read_b32 v134, a54
  v_accvgpr_read_b32 v135, a55
  v_pk_mul_f32 v[128:129], v[128:129], v[120:121]
  v_pk_mul_f32 v[130:131], v[130:131], v[120:121]
  v_pk_mul_f32 v[132:133], v[132:133], v[120:121]
  v_pk_mul_f32 v[134:135], v[134:135], v[120:121]
  v_cvt_pk_bf16_f32 v80, v128, v129
  v_cvt_pk_bf16_f32 v81, v130, v131
  v_cvt_pk_bf16_f32 v82, v132, v133
  v_cvt_pk_bf16_f32 v83, v134, v135
  buffer_store_dwordx4 v[240:243], v52, s[28:31], s64 offen offset:3072 sc1
  ds_read_b128 v[236:239], v8 offset:4096
  ds_read_b128 v[240:243], v8 offset:5120
  v_nop
  v_nop
  v_accvgpr_read_b32 v136, a56
  v_accvgpr_read_b32 v137, a57
  v_accvgpr_read_b32 v138, a58
  v_accvgpr_read_b32 v139, a59
  v_accvgpr_read_b32 v140, a60
  v_accvgpr_read_b32 v141, a61
  v_accvgpr_read_b32 v142, a62
  v_accvgpr_read_b32 v143, a63
  v_pk_mul_f32 v[136:137], v[136:137], v[120:121]
  v_pk_mul_f32 v[138:139], v[138:139], v[120:121]
  v_pk_mul_f32 v[140:141], v[140:141], v[120:121]
  v_pk_mul_f32 v[142:143], v[142:143], v[120:121]
  v_cvt_pk_bf16_f32 v84, v136, v137
  v_cvt_pk_bf16_f32 v85, v138, v139
  v_cvt_pk_bf16_f32 v86, v140, v141
  v_cvt_pk_bf16_f32 v87, v142, v143
  s_waitcnt lgkmcnt(1)
  buffer_store_dwordx4 v[236:239], v52, s[28:31], s65 offen offset:0 sc1
  s_waitcnt lgkmcnt(0)
  buffer_store_dwordx4 v[240:243], v52, s[28:31], s65 offen offset:1024 sc1
  ds_read_b128 v[236:239], v8 offset:6144
  ds_read_b128 v[240:243], v8 offset:7168
  v_nop
  v_nop
  s_waitcnt lgkmcnt(1)
  buffer_store_dwordx4 v[236:239], v52, s[28:31], s65 offen offset:2048 sc1
  s_waitcnt lgkmcnt(0)
  buffer_store_dwordx4 v[240:243], v52, s[28:31], s65 offen offset:3072 sc1
  s_branch Lk_qj19
Lk_qe18:
  buffer_load_dword v14, off, s[24:27], 0 sc1
  v_cvt_pk_bf16_f32 v247, v242, v243
  buffer_store_dwordx4 v[244:247], v52, s[28:31], s40 offen offset:2048 sc1
  v_accvgpr_read_b32 v236, a88
  v_accvgpr_read_b32 v237, a89
  v_accvgpr_read_b32 v238, a90
  v_accvgpr_read_b32 v239, a91
  v_accvgpr_read_b32 v240, a92
  v_accvgpr_read_b32 v241, a93
  v_accvgpr_read_b32 v242, a94
  v_accvgpr_read_b32 v243, a95
  v_cvt_pk_bf16_f32 v248, v236, v237
  v_cvt_pk_bf16_f32 v249, v238, v239
  v_cvt_pk_bf16_f32 v250, v240, v241
  v_cvt_pk_bf16_f32 v251, v242, v243
  buffer_store_dwordx4 v[248:251], v52, s[28:31], s40 offen offset:3072 sc1
  s_mov_b32 s66, s40
  s_add_u32 s40, s40, s41
  v_accvgpr_read_b32 v236, a96
  v_accvgpr_read_b32 v237, a97
  v_accvgpr_read_b32 v238, a98
  v_accvgpr_read_b32 v239, a99
  v_accvgpr_read_b32 v240, a100
  v_accvgpr_read_b32 v241, a101
  v_accvgpr_read_b32 v242, a102
  v_accvgpr_read_b32 v243, a103
  v_cvt_pk_bf16_f32 v244, v236, v237
  v_cvt_pk_bf16_f32 v245, v238, v239
  v_cvt_pk_bf16_f32 v246, v240, v241
  v_cvt_pk_bf16_f32 v247, v242, v243
  buffer_store_dwordx4 v[244:247], v52, s[28:31], s40 offen offset:0 sc1
  v_accvgpr_read_b32 v236, a104
  v_accvgpr_read_b32 v237, a105
  v_accvgpr_read_b32 v238, a106
  v_accvgpr_read_b32 v239, a107
  v_accvgpr_read_b32 v240, a108
  v_accvgpr_read_b32 v241, a109
  v_accvgpr_read_b32 v242, a110
  v_accvgpr_read_b32 v243, a111
  v_cvt_pk_bf16_f32 v248, v236, v237
  v_cvt_pk_bf16_f32 v249, v238, v239
  v_cvt_pk_bf16_f32 v250, v240, v241
  v_cvt_pk_bf16_f32 v251, v242, v243
  buffer_store_dwordx4 v[248:251], v52, s[28:31], s40 offen offset:1024 sc1
  v_accvgpr_read_b32 v236, a112
  v_accvgpr_read_b32 v237, a113
  v_accvgpr_read_b32 v238, a114
  v_accvgpr_read_b32 v239, a115
  v_accvgpr_read_b32 v240, a116
  v_accvgpr_read_b32 v241, a117
  v_accvgpr_read_b32 v242, a118
  v_accvgpr_read_b32 v243, a119
  v_cvt_pk_bf16_f32 v244, v236, v237
  v_cvt_pk_bf16_f32 v245, v238, v239
  v_cvt_pk_bf16_f32 v246, v240, v241
  v_cvt_pk_bf16_f32 v247, v242, v243
  buffer_store_dwordx4 v[244:247], v52, s[28:31], s40 offen offset:2048 sc1
  v_accvgpr_read_b32 v236, a120
  v_accvgpr_read_b32 v237, a121
  v_accvgpr_read_b32 v238, a122
  v_accvgpr_read_b32 v239, a123
  v_accvgpr_read_b32 v240, a124
  v_accvgpr_read_b32 v241, a125
  v_accvgpr_read_b32 v242, a126
  v_accvgpr_read_b32 v243, a127
  v_cvt_pk_bf16_f32 v248, v236, v237
  v_cvt_pk_bf16_f32 v249, v238, v239
  v_cvt_pk_bf16_f32 v250, v240, v241
  v_cvt_pk_bf16_f32 v251, v242, v243
  buffer_store_dwordx4 v[248:251], v52, s[28:31], s40 offen offset:3072 sc1
  s_add_u32 s40, s40, s42
  v_accvgpr_read_b32 v236, a128
  v_accvgpr_read_b32 v237, a129
  v_accvgpr_read_b32 v238, a130
  v_accvgpr_read_b32 v239, a131
  v_accvgpr_read_b32 v240, a132
  v_accvgpr_read_b32 v241, a133
  v_accvgpr_read_b32 v242, a134
  v_accvgpr_read_b32 v243, a135
  v_cvt_pk_bf16_f32 v244, v236, v237
  v_cvt_pk_bf16_f32 v245, v238, v239
  v_cvt_pk_bf16_f32 v246, v240, v241
  v_cvt_pk_bf16_f32 v247, v242, v243
  buffer_store_dwordx4 v[244:247], v52, s[28:31], s40 offen offset:0 sc1
  v_accvgpr_read_b32 v236, a136
  v_accvgpr_read_b32 v237, a137
  v_accvgpr_read_b32 v238, a138
  v_accvgpr_read_b32 v239, a139
  v_accvgpr_read_b32 v240, a140
  v_accvgpr_read_b32 v241, a141
  v_accvgpr_read_b32 v242, a142
  v_accvgpr_read_b32 v243, a143
  v_cvt_pk_bf16_f32 v248, v236, v237
  v_cvt_pk_bf16_f32 v249, v238, v239
  v_cvt_pk_bf16_f32 v250, v240, v241
  v_cvt_pk_bf16_f32 v251, v242, v243
  buffer_store_dwordx4 v[248:251], v52, s[28:31], s40 offen offset:1024 sc1
  v_accvgpr_read_b32 v236, a144
  v_accvgpr_read_b32 v237, a145
  v_accvgpr_read_b32 v238, a146
  v_accvgpr_read_b32 v239, a147
  v_accvgpr_read_b32 v240, a148
  v_accvgpr_read_b32 v241, a149
  v_accvgpr_read_b32 v242, a150
  v_accvgpr_read_b32 v243, a151
  v_cvt_pk_bf16_f32 v244, v236, v237
  v_cvt_pk_bf16_f32 v245, v238, v239
  v_cvt_pk_bf16_f32 v246, v240, v241
  v_cvt_pk_bf16_f32 v247, v242, v243
  buffer_store_dwordx4 v[244:247], v52, s[28:31], s40 offen offset:2048 sc1
  v_accvgpr_read_b32 v236, a152
  v_accvgpr_read_b32 v237, a153
  v_accvgpr_read_b32 v238, a154
  v_accvgpr_read_b32 v239, a155
  v_accvgpr_read_b32 v240, a156
  v_accvgpr_read_b32 v241, a157
  v_accvgpr_read_b32 v242, a158
  v_accvgpr_read_b32 v243, a159
  v_cvt_pk_bf16_f32 v248, v236, v237
  v_cvt_pk_bf16_f32 v249, v238, v239
  v_cvt_pk_bf16_f32 v250, v240, v241
  v_cvt_pk_bf16_f32 v251, v242, v243
  buffer_store_dwordx4 v[248:251], v52, s[28:31], s40 offen offset:3072 sc1
  s_add_u32 s40, s40, s41
  v_accvgpr_read_b32 v236, a160
  v_accvgpr_read_b32 v237, a161
  v_accvgpr_read_b32 v238, a162
  v_accvgpr_read_b32 v239, a163
  v_accvgpr_read_b32 v240, a164
  v_accvgpr_read_b32 v241, a165
  v_accvgpr_read_b32 v242, a166
  v_accvgpr_read_b32 v243, a167
  v_cvt_pk_bf16_f32 v244, v236, v237
  v_cvt_pk_bf16_f32 v245, v238, v239
  v_cvt_pk_bf16_f32 v246, v240, v241
  v_cvt_pk_bf16_f32 v247, v242, v243
  buffer_store_dwordx4 v[244:247], v52, s[28:31], s40 offen offset:0 sc1
  v_accvgpr_read_b32 v236, a168
  v_accvgpr_read_b32 v237, a169
  v_accvgpr_read_b32 v238, a170
  v_accvgpr_read_b32 v239, a171
  v_accvgpr_read_b32 v240, a172
  v_accvgpr_read_b32 v241, a173
  v_accvgpr_read_b32 v242, a174
  v_accvgpr_read_b32 v243, a175
  v_cvt_pk_bf16_f32 v248, v236, v237
  v_cvt_pk_bf16_f32 v249, v238, v239
  v_cvt_pk_bf16_f32 v250, v240, v241
  v_cvt_pk_bf16_f32 v251, v242, v243
  buffer_store_dwordx4 v[248:251], v52, s[28:31], s40 offen offset:1024 sc1
  v_accvgpr_read_b32 v236, a176
  v_accvgpr_read_b32 v237, a177
  v_accvgpr_read_b32 v238, a178
  v_accvgpr_read_b32 v239, a179
  v_accvgpr_read_b32 v240, a180
  v_accvgpr_read_b32 v241, a181
  v_accvgpr_read_b32 v242, a182
  v_accvgpr_read_b32 v243, a183
  v_cvt_pk_bf16_f32 v244, v236, v237
  v_cvt_pk_bf16_f32 v245, v238, v239
  v_cvt_pk_bf16_f32 v246, v240, v241
  v_cvt_pk_bf16_f32 v247, v242, v243
  buffer_store_dwordx4 v[244:247], v52, s[28:31], s40 offen offset:2048 sc1
  v_accvgpr_read_b32 v236, a184
  v_accvgpr_read_b32 v237, a185
  v_accvgpr_read_b32 v238, a186
  v_accvgpr_read_b32 v239, a187
  v_accvgpr_read_b32 v240, a188
  v_accvgpr_read_b32 v241, a189
  v_accvgpr_read_b32 v242, a190
  v_accvgpr_read_b32 v243, a191
  v_cvt_pk_bf16_f32 v248, v236, v237
  v_cvt_pk_bf16_f32 v249, v238, v239
  v_cvt_pk_bf16_f32 v250, v240, v241
  v_cvt_pk_bf16_f32 v251, v242, v243
  buffer_store_dwordx4 v[248:251], v52, s[28:31], s40 offen offset:3072 sc1
  s_add_u32 s40, s40, s42
  v_accvgpr_read_b32 v236, a192
  v_accvgpr_read_b32 v237, a193
  v_accvgpr_read_b32 v238, a194
  v_accvgpr_read_b32 v239, a195
  v_accvgpr_read_b32 v240, a196
  v_accvgpr_read_b32 v241, a197
  v_accvgpr_read_b32 v242, a198
  v_accvgpr_read_b32 v243, a199
  v_cvt_pk_bf16_f32 v244, v236, v237
  v_cvt_pk_bf16_f32 v245, v238, v239
  v_cvt_pk_bf16_f32 v246, v240, v241
  v_cvt_pk_bf16_f32 v247, v242, v243
  buffer_store_dwordx4 v[244:247], v52, s[28:31], s40 offen offset:0 sc1
  v_accvgpr_read_b32 v236, a200
  v_accvgpr_read_b32 v237, a201
  v_accvgpr_read_b32 v238, a202
  v_accvgpr_read_b32 v239, a203
  v_accvgpr_read_b32 v240, a204
  v_accvgpr_read_b32 v241, a205
  v_accvgpr_read_b32 v242, a206
  v_accvgpr_read_b32 v243, a207
  v_cvt_pk_bf16_f32 v248, v236, v237
  v_cvt_pk_bf16_f32 v249, v238, v239
  v_cvt_pk_bf16_f32 v250, v240, v241
  v_cvt_pk_bf16_f32 v251, v242, v243
  buffer_store_dwordx4 v[248:251], v52, s[28:31], s40 offen offset:1024 sc1
  v_accvgpr_read_b32 v236, a208
  v_accvgpr_read_b32 v237, a209
  v_accvgpr_read_b32 v238, a210
  v_accvgpr_read_b32 v239, a211
  v_accvgpr_read_b32 v240, a212
  v_accvgpr_read_b32 v241, a213
  v_accvgpr_read_b32 v242, a214
  v_accvgpr_read_b32 v243, a215
  v_cvt_pk_bf16_f32 v244, v236, v237
  v_cvt_pk_bf16_f32 v245, v238, v239
  v_cvt_pk_bf16_f32 v246, v240, v241
  v_cvt_pk_bf16_f32 v247, v242, v243
  buffer_store_dwordx4 v[244:247], v52, s[28:31], s40 offen offset:2048 sc1
  v_accvgpr_read_b32 v236, a216
  v_accvgpr_read_b32 v237, a217
  v_accvgpr_read_b32 v238, a218
  v_accvgpr_read_b32 v239, a219
  v_accvgpr_read_b32 v240, a220
  v_accvgpr_read_b32 v241, a221
  v_accvgpr_read_b32 v242, a222
  v_accvgpr_read_b32 v243, a223
  v_cvt_pk_bf16_f32 v248, v236, v237
  v_cvt_pk_bf16_f32 v249, v238, v239
  v_cvt_pk_bf16_f32 v250, v240, v241
  v_cvt_pk_bf16_f32 v251, v242, v243
  buffer_store_dwordx4 v[248:251], v52, s[28:31], s40 offen offset:3072 sc1
  s_add_u32 s40, s40, s41
  v_accvgpr_read_b32 v236, a224
  v_accvgpr_read_b32 v237, a225
  v_accvgpr_read_b32 v238, a226
  v_accvgpr_read_b32 v239, a227
  v_accvgpr_read_b32 v240, a228
  v_accvgpr_read_b32 v241, a229
  v_accvgpr_read_b32 v242, a230
  v_accvgpr_read_b32 v243, a231
  v_cvt_pk_bf16_f32 v244, v236, v237
  v_cvt_pk_bf16_f32 v245, v238, v239
  v_cvt_pk_bf16_f32 v246, v240, v241
  v_cvt_pk_bf16_f32 v247, v242, v243
  buffer_store_dwordx4 v[244:247], v52, s[28:31], s40 offen offset:0 sc1
  v_accvgpr_read_b32 v236, a232
  v_accvgpr_read_b32 v237, a233
  v_accvgpr_read_b32 v238, a234
  v_accvgpr_read_b32 v239, a235
  v_accvgpr_read_b32 v240, a236
  v_accvgpr_read_b32 v241, a237
  v_accvgpr_read_b32 v242, a238
  v_accvgpr_read_b32 v243, a239
  v_cvt_pk_bf16_f32 v248, v236, v237
  v_cvt_pk_bf16_f32 v249, v238, v239
  v_cvt_pk_bf16_f32 v250, v240, v241
  v_cvt_pk_bf16_f32 v251, v242, v243
  buffer_store_dwordx4 v[248:251], v52, s[28:31], s40 offen offset:1024 sc1
  v_accvgpr_read_b32 v236, a240
  v_accvgpr_read_b32 v237, a241
  v_accvgpr_read_b32 v238, a242
  v_accvgpr_read_b32 v239, a243
  v_accvgpr_read_b32 v240, a244
  v_accvgpr_read_b32 v241, a245
  v_accvgpr_read_b32 v242, a246
  v_accvgpr_read_b32 v243, a247
  v_cvt_pk_bf16_f32 v244, v236, v237
  v_cvt_pk_bf16_f32 v245, v238, v239
  v_cvt_pk_bf16_f32 v246, v240, v241
  v_cvt_pk_bf16_f32 v247, v242, v243
  buffer_store_dwordx4 v[244:247], v52, s[28:31], s40 offen offset:2048 sc1
  v_accvgpr_read_b32 v236, a248
  v_accvgpr_read_b32 v237, a249
  v_accvgpr_read_b32 v238, a250
  v_accvgpr_read_b32 v239, a251
  v_accvgpr_read_b32 v240, a252
  v_accvgpr_read_b32 v241, a253
  v_accvgpr_read_b32 v242, a254
  v_accvgpr_read_b32 v243, a255
  v_cvt_pk_bf16_f32 v248, v236, v237
  v_cvt_pk_bf16_f32 v249, v238, v239
  v_cvt_pk_bf16_f32 v250, v240, v241
  v_cvt_pk_bf16_f32 v251, v242, v243
  buffer_store_dwordx4 v[248:251], v52, s[28:31], s40 offen offset:3072 sc1
  s_add_u32 s40, s40, s42
  ds_read_b128 v[236:239], v8 offset:0
  ds_read_b128 v[240:243], v8 offset:1024
  v_nop
  v_nop
  s_waitcnt lgkmcnt(1)
  buffer_store_dwordx4 v[236:239], v52, s[28:31], s64 offen offset:0 sc1
  s_waitcnt lgkmcnt(0)
  buffer_store_dwordx4 v[240:243], v52, s[28:31], s64 offen offset:1024 sc1
  ds_read_b128 v[236:239], v8 offset:2048
  ds_read_b128 v[240:243], v8 offset:3072
  v_nop
  v_nop
  s_waitcnt lgkmcnt(1)
  buffer_store_dwordx4 v[236:239], v52, s[28:31], s64 offen offset:2048 sc1
  s_waitcnt lgkmcnt(0)
  buffer_store_dwordx4 v[240:243], v52, s[28:31], s64 offen offset:3072 sc1
  ds_read_b128 v[236:239], v8 offset:4096
  ds_read_b128 v[240:243], v8 offset:5120
  v_nop
  v_nop
  s_waitcnt lgkmcnt(1)
  buffer_store_dwordx4 v[236:239], v52, s[28:31], s65 offen offset:0 sc1
  s_waitcnt lgkmcnt(0)
  buffer_store_dwordx4 v[240:243], v52, s[28:31], s65 offen offset:1024 sc1
  ds_read_b128 v[236:239], v8 offset:6144
  ds_read_b128 v[240:243], v8 offset:7168
  v_nop
  v_nop
  s_waitcnt lgkmcnt(1)
  buffer_store_dwordx4 v[236:239], v52, s[28:31], s65 offen offset:2048 sc1
  s_waitcnt lgkmcnt(0)
  buffer_store_dwordx4 v[240:243], v52, s[28:31], s65 offen offset:3072 sc1
  s_waitcnt lgkmcnt(0)
  s_waitcnt vmcnt(48)
  s_barrier
  v_mfma_f32_16x16x32_bf16 v[216:219], v[72:75], v[56:59], 0
  s_add_u32 m0, s48, 0x0
  ds_read_b128 v[88:91], v42 offset:16384
  v_mfma_f32_16x16x32_bf16 v[220:223], v[76:79], v[56:59], 0
  buffer_load_dwordx4 v55, s[52:55], s49 offen lds
  v_mfma_f32_16x16x32_bf16 v[224:227], v[72:75], v[60:63], 0
  s_add_u32 m0, s34, 0x10000
  s_add_u32 s49, s49, s47
  ds_read_b128 v[92:95], v42 offset:17408
  v_mfma_f32_16x16x32_bf16 v[228:231], v[76:79], v[60:63], 0
  ds_read_b64_tr_b16 v[104:105], v44 offset:24576
  v_mfma_f32_16x16x32_bf16 v[16:19], v[72:75], v[48:51], 0
  ds_read_b64_tr_b16 v[106:107], v44 offset:24832
  v_mfma_f32_16x16x32_bf16 v[20:23], v[76:79], v[48:51], 0
  ds_read_b64_tr_b16 v[108:109], v45 offset:24576
  v_mfma_f32_16x16x32_bf16 v[24:27], v[84:87], v[56:59], 0
  ds_read_b64_tr_b16 v[110:111], v45 offset:24832
  v_mfma_f32_16x16x32_bf16 v[28:31], v[84:87], v[60:63], 0
  v_mfma_f32_16x16x32_bf16 v[232:235], v[80:83], v[48:51], 0
  buffer_load_dwordx4 v10, s[60:63], s37 offen offset:0 lds
  v_mfma_f32_16x16x32_bf16 v[184:187], v[120:123], v[68:71], 0
  ds_read_b128 v[116:119], v47 offset:64
  v_mfma_f32_16x16x32_bf16 v[188:191], v[124:127], v[68:71], 0
  ds_read_b64_tr_b16 v[112:113], v46 offset:26624
  v_mfma_f32_16x16x32_bf16 v[192:195], v[128:131], v[68:71], 0
  ds_read_b64_tr_b16 v[114:115], v46 offset:26752
  v_mfma_f32_16x16x32_bf16 v[196:199], v[132:135], v[68:71], 0
  ds_read_b128 v[96:99], v43 offset:16384
  v_mfma_f32_16x16x32_bf16 v[200:203], v[136:139], v[68:71], 0
  ds_read_b128 v[100:103], v43 offset:17408
  v_mfma_f32_16x16x32_bf16 v[204:207], v[140:143], v[68:71], 0
  v_mfma_f32_16x16x32_bf16 v[208:211], v[144:147], v[68:71], 0
  buffer_load_dwordx4 v11, s[60:63], s37 offen offset:1024 lds
  v_mfma_f32_16x16x32_bf16 v[212:215], v[148:151], v[68:71], 0
  ds_read_b64_tr_b16 v[152:153], v15 offset:16384
  v_mfma_f32_16x16x32_bf16 a[28:31], v[148:151], v[56:59], 0
  ds_read_b64_tr_b16 v[154:155], v15 offset:18432
  v_mfma_f32_16x16x32_bf16 a[24:27], v[144:147], v[56:59], 0
  ds_read_b64_tr_b16 v[156:157], v32 offset:16384
  v_mfma_f32_16x16x32_bf16 a[20:23], v[140:143], v[56:59], 0
  ds_read_b64_tr_b16 v[158:159], v32 offset:18432
  v_mfma_f32_16x16x32_bf16 a[16:19], v[136:139], v[56:59], 0
  ds_read_b64_tr_b16 v[160:161], v33 offset:16384
  v_mfma_f32_16x16x32_bf16 a[12:15], v[132:135], v[56:59], 0
  v_mfma_f32_16x16x32_bf16 a[8:11], v[128:131], v[56:59], 0
  buffer_load_dwordx4 v12, s[60:63], s37 offen offset:2048 lds
  v_mfma_f32_16x16x32_bf16 a[4:7], v[124:127], v[56:59], 0
  ds_read_b64_tr_b16 v[162:163], v33 offset:18432
  v_mfma_f32_16x16x32_bf16 a[0:3], v[120:123], v[56:59], 0
  ds_read_b64_tr_b16 v[164:165], v34 offset:16384
  v_mfma_f32_16x16x32_bf16 a[32:35], v[120:123], v[60:63], 0
  ds_read_b64_tr_b16 v[166:167], v34 offset:18432
  v_mfma_f32_16x16x32_bf16 a[36:39], v[124:127], v[60:63], 0
  ds_read_b64_tr_b16 v[168:169], v35 offset:16384
  v_mfma_f32_16x16x32_bf16 a[40:43], v[128:131], v[60:63], 0
  ds_read_b64_tr_b16 v[170:171], v35 offset:18432
  v_mfma_f32_16x16x32_bf16 a[44:47], v[132:135], v[60:63], 0
  v_mfma_f32_16x16x32_bf16 a[48:51], v[136:139], v[60:63], 0
  buffer_load_dwordx4 v13, s[60:63], s37 offen offset:3072 lds
  v_mfma_f32_16x16x32_bf16 a[52:55], v[140:143], v[60:63], 0
  s_add_u32 s37, s37, 0x40000
  ds_read_b64_tr_b16 v[172:173], v36 offset:16384
  v_mfma_f32_16x16x32_bf16 a[56:59], v[144:147], v[60:63], 0
  ds_read_b64_tr_b16 v[174:175], v36 offset:18432
  v_mfma_f32_16x16x32_bf16 a[60:63], v[148:151], v[60:63], 0
  ds_read_b64_tr_b16 v[176:177], v37 offset:16384
  v_mfma_f32_16x16x32_bf16 a[92:95], v[148:151], v[64:67], 0
  ds_read_b64_tr_b16 v[178:179], v37 offset:18432
  v_mfma_f32_16x16x32_bf16 a[88:91], v[144:147], v[64:67], 0
  ds_read_b64_tr_b16 v[180:181], v38 offset:16384
  v_mfma_f32_16x16x32_bf16 a[84:87], v[140:143], v[64:67], 0
  v_mfma_f32_16x16x32_bf16 a[80:83], v[136:139], v[64:67], 0
  ds_read_b64_tr_b16 v[182:183], v38 offset:18432
  v_mfma_f32_16x16x32_bf16 a[76:79], v[132:135], v[64:67], 0
  v_mfma_f32_16x16x32_bf16 a[72:75], v[128:131], v[64:67], 0
  v_mfma_f32_16x16x32_bf16 a[68:71], v[124:127], v[64:67], 0
  v_mfma_f32_16x16x32_bf16 a[64:67], v[120:123], v[64:67], 0
  v_mfma_f32_16x16x32_bf16 a[96:99], v[56:59], v[56:59], 0
  v_mfma_f32_16x16x32_bf16 a[100:103], v[60:63], v[60:63], 0
  s_waitcnt lgkmcnt(0)
  s_waitcnt vmcnt(44)
  s_barrier
  v_mfma_f32_16x16x32_bf16 v[216:219], v[104:107], v[88:91], v[216:219]
  s_add_u32 m0, s35, 0x0
  ds_read_b128 v[56:59], v42 offset:32768
  v_mfma_f32_16x16x32_bf16 v[220:223], v[108:111], v[88:91], v[220:223]
  buffer_load_dwordx4 v53, s[56:59], s36 offen offset:0 lds
  v_mfma_f32_16x16x32_bf16 v[224:227], v[104:107], v[92:95], v[224:227]
  s_add_u32 m0, s35, 0x3fc0
  ds_read_b128 v[60:63], v42 offset:33792
  v_mfma_f32_16x16x32_bf16 v[228:231], v[108:111], v[92:95], v[228:231]
  ds_read_b64_tr_b16 v[72:73], v44 offset:40960
  v_mfma_f32_16x16x32_bf16 v[16:19], v[104:107], v[48:51], v[16:19]
  ds_read_b64_tr_b16 v[74:75], v44 offset:41216
  v_mfma_f32_16x16x32_bf16 v[20:23], v[108:111], v[48:51], v[20:23]
  buffer_load_dwordx4 v53, s[56:59], s36 offen offset:64 lds
  v_mfma_f32_16x16x32_bf16 v[24:27], v[116:119], v[88:91], v[24:27]
  s_add_u32 m0, s35, 0x0
  ds_read_b64_tr_b16 v[76:77], v45 offset:40960
  v_mfma_f32_16x16x32_bf16 v[28:31], v[116:119], v[92:95], v[28:31]
  ds_read_b64_tr_b16 v[78:79], v45 offset:41216
  v_mfma_f32_16x16x32_bf16 v[232:235], v[112:115], v[48:51], v[232:235]
  ds_read_b128 v[84:87], v47 offset:128
  v_mfma_f32_16x16x32_bf16 v[184:187], v[152:155], v[100:103], v[184:187]
  buffer_load_dwordx4 v54, s[56:59], s36 offen offset:1024 lds
  v_mfma_f32_16x16x32_bf16 a[64:67], v[152:155], v[96:99], a[64:67]
  s_add_u32 m0, s35, 0x3fc0
  ds_read_b64_tr_b16 v[80:81], v46 offset:43008
  v_mfma_f32_16x16x32_bf16 a[68:71], v[156:159], v[96:99], a[68:71]
  ds_read_b64_tr_b16 v[82:83], v46 offset:43136
  v_mfma_f32_16x16x32_bf16 v[188:191], v[156:159], v[100:103], v[188:191]
  ds_read_b128 v[64:67], v43 offset:32768
  v_mfma_f32_16x16x32_bf16 v[192:195], v[160:163], v[100:103], v[192:195]
  buffer_load_dwordx4 v54, s[56:59], s36 offen offset:1088 lds
  v_mfma_f32_16x16x32_bf16 a[72:75], v[160:163], v[96:99], a[72:75]
  s_add_u32 s36, s36, 128
  s_add_u32 m0, s48, 0x4000
  ds_read_b128 v[68:71], v43 offset:33792
  v_mfma_f32_16x16x32_bf16 a[76:79], v[164:167], v[96:99], a[76:79]
  ds_read_b64_tr_b16 v[120:121], v15 offset:32768
  v_mfma_f32_16x16x32_bf16 v[196:199], v[164:167], v[100:103], v[196:199]
  ds_read_b64_tr_b16 v[122:123], v15 offset:34816
  v_mfma_f32_16x16x32_bf16 v[200:203], v[168:171], v[100:103], v[200:203]
  buffer_load_dwordx4 v55, s[52:55], s49 offen lds
  v_mfma_f32_16x16x32_bf16 a[80:83], v[168:171], v[96:99], a[80:83]
  s_add_u32 m0, s34, 0x14000
  s_add_u32 s49, s49, s47
  ds_read_b64_tr_b16 v[124:125], v32 offset:32768
  v_mfma_f32_16x16x32_bf16 a[84:87], v[172:175], v[96:99], a[84:87]
  ds_read_b64_tr_b16 v[126:127], v32 offset:34816
  v_mfma_f32_16x16x32_bf16 v[204:207], v[172:175], v[100:103], v[204:207]
  ds_read_b64_tr_b16 v[128:129], v33 offset:32768
  v_mfma_f32_16x16x32_bf16 v[208:211], v[176:179], v[100:103], v[208:211]
  buffer_load_dwordx4 v10, s[60:63], s37 offen offset:0 lds
  v_mfma_f32_16x16x32_bf16 a[88:91], v[176:179], v[96:99], a[88:91]
  ds_read_b64_tr_b16 v[130:131], v33 offset:34816
  v_mfma_f32_16x16x32_bf16 a[92:95], v[180:183], v[96:99], a[92:95]
  ds_read_b64_tr_b16 v[132:133], v34 offset:32768
  v_mfma_f32_16x16x32_bf16 v[212:215], v[180:183], v[100:103], v[212:215]
  ds_read_b64_tr_b16 v[134:135], v34 offset:34816
  v_mfma_f32_16x16x32_bf16 a[28:31], v[180:183], v[88:91], a[28:31]
  buffer_load_dwordx4 v11, s[60:63], s37 offen offset:1024 lds
  v_mfma_f32_16x16x32_bf16 a[60:63], v[180:183], v[92:95], a[60:63]
  ds_read_b64_tr_b16 v[136:137], v35 offset:32768
  v_mfma_f32_16x16x32_bf16 a[56:59], v[176:179], v[92:95], a[56:59]
  ds_read_b64_tr_b16 v[138:139], v35 offset:34816
  v_mfma_f32_16x16x32_bf16 a[24:27], v[176:179], v[88:91], a[24:27]
  ds_read_b64_tr_b16 v[140:141], v36 offset:32768
  v_mfma_f32_16x16x32_bf16 a[20:23], v[172:175], v[88:91], a[20:23]
  buffer_load_dwordx4 v12, s[60:63], s37 offen offset:2048 lds
  v_mfma_f32_16x16x32_bf16 a[52:55], v[172:175], v[92:95], a[52:55]
  ds_read_b64_tr_b16 v[142:143], v36 offset:34816
  v_mfma_f32_16x16x32_bf16 a[48:51], v[168:171], v[92:95], a[48:51]
  ds_read_b64_tr_b16 v[144:145], v37 offset:32768
  v_mfma_f32_16x16x32_bf16 a[16:19], v[168:171], v[88:91], a[16:19]
  ds_read_b64_tr_b16 v[146:147], v37 offset:34816
  v_mfma_f32_16x16x32_bf16 a[12:15], v[164:167], v[88:91], a[12:15]
  buffer_load_dwordx4 v13, s[60:63], s37 offen offset:3072 lds
  v_mfma_f32_16x16x32_bf16 a[44:47], v[164:167], v[92:95], a[44:47]
  s_add_u32 s37, s37, 0x40000
  ds_read_b64_tr_b16 v[148:149], v38 offset:32768
  v_mfma_f32_16x16x32_bf16 a[40:43], v[160:163], v[92:95], a[40:43]
  ds_read_b64_tr_b16 v[150:151], v38 offset:34816
  v_mfma_f32_16x16x32_bf16 a[8:11], v[160:163], v[88:91], a[8:11]
  v_mfma_f32_16x16x32_bf16 a[4:7], v[156:159], v[88:91], a[4:7]
  v_mfma_f32_16x16x32_bf16 a[36:39], v[156:159], v[92:95], a[36:39]
  v_mfma_f32_16x16x32_bf16 a[32:35], v[152:155], v[92:95], a[32:35]
  v_mfma_f32_16x16x32_bf16 a[0:3], v[152:155], v[88:91], a[0:3]
  v_mfma_f32_16x16x32_bf16 a[96:99], v[88:91], v[88:91], a[96:99]
  v_mfma_f32_16x16x32_bf16 a[100:103], v[92:95], v[92:95], a[100:103]
  s_waitcnt lgkmcnt(0)
  s_waitcnt vmcnt(0)
  v_mov_b32 v3, 1
  v_mov_b32 v4, 0
  s_cmp_lg_u32 s19, 0
  s_cbranch_scc1 Lk_go26
  v_cmp_lt_u32 vcc, v14, v3
  s_nop 4
  s_cbranch_vccz Lk_go26
  s_mov_b32 s43, 0
Lk_poll25:
  s_sleep 3
  buffer_load_dword v14, v4, s[24:27], 0 offen offset:0 sc1
  s_waitcnt vmcnt(0)
  v_cmp_lt_u32 vcc, v14, v3
  s_nop 4
  s_cbranch_vccz Lk_go26
  s_add_u32 s43, s43, 1
  s_cmp_lt_u32 s43, 0x40000
  s_cbranch_scc1 Lk_poll25
Lk_go26:
  s_barrier
  s_cmp_lg_u32 s19, 0
  s_cbranch_scc1 Lk_sig27
  v_mov_b32 v2, 1
  s_mov_b64 exec, 1
  buffer_atomic_add v2, off, s[20:23], s51 sc1
  s_mov_b64 exec, -1
Lk_sig27:
  v_mfma_f32_16x16x32_bf16 v[216:219], v[72:75], v[56:59], v[216:219]
  s_add_u32 m0, s48, 0x8000
  ds_read_b128 v[88:91], v42 offset:49152
  v_mfma_f32_16x16x32_bf16 v[220:223], v[76:79], v[56:59], v[220:223]
  buffer_load_dwordx4 v55, s[52:55], s49 offen lds
  v_mfma_f32_16x16x32_bf16 v[224:227], v[72:75], v[60:63], v[224:227]
  s_add_u32 m0, s34, 0x18000
  s_add_u32 s49, s49, s47
  ds_read_b128 v[92:95], v42 offset:50176
  v_mfma_f32_16x16x32_bf16 v[228:231], v[76:79], v[60:63], v[228:231]
  ds_read_b64_tr_b16 v[104:105], v44 offset:57344
  v_mfma_f32_16x16x32_bf16 v[16:19], v[72:75], v[48:51], v[16:19]
  ds_read_b64_tr_b16 v[106:107], v44 offset:57600
  v_mfma_f32_16x16x32_bf16 v[20:23], v[76:79], v[48:51], v[20:23]
  ds_read_b64_tr_b16 v[108:109], v45 offset:57344
  v_mfma_f32_16x16x32_bf16 v[24:27], v[84:87], v[56:59], v[24:27]
  ds_read_b64_tr_b16 v[110:111], v45 offset:57600
  v_mfma_f32_16x16x32_bf16 v[28:31], v[84:87], v[60:63], v[28:31]
  v_mfma_f32_16x16x32_bf16 v[232:235], v[80:83], v[48:51], v[232:235]
  buffer_load_dwordx4 v10, s[60:63], s37 offen offset:0 lds
  v_mfma_f32_16x16x32_bf16 v[184:187], v[120:123], v[68:71], v[184:187]
  ds_read_b128 v[116:119], v47 offset:192
  v_mfma_f32_16x16x32_bf16 a[64:67], v[120:123], v[64:67], a[64:67]
  ds_read_b64_tr_b16 v[112:113], v46 offset:59392
  v_mfma_f32_16x16x32_bf16 a[68:71], v[124:127], v[64:67], a[68:71]
  ds_read_b64_tr_b16 v[114:115], v46 offset:59520
  v_mfma_f32_16x16x32_bf16 v[188:191], v[124:127], v[68:71], v[188:191]
  ds_read_b128 v[96:99], v43 offset:49152
  v_mfma_f32_16x16x32_bf16 v[192:195], v[128:131], v[68:71], v[192:195]
  ds_read_b128 v[100:103], v43 offset:50176
  v_mfma_f32_16x16x32_bf16 a[72:75], v[128:131], v[64:67], a[72:75]
  v_mfma_f32_16x16x32_bf16 a[76:79], v[132:135], v[64:67], a[76:79]
  buffer_load_dwordx4 v11, s[60:63], s37 offen offset:1024 lds
  v_mfma_f32_16x16x32_bf16 v[196:199], v[132:135], v[68:71], v[196:199]
  ds_read_b64_tr_b16 v[152:153], v15 offset:49152
  v_mfma_f32_16x16x32_bf16 v[200:203], v[136:139], v[68:71], v[200:203]
  ds_read_b64_tr_b16 v[154:155], v15 offset:51200
  v_mfma_f32_16x16x32_bf16 a[80:83], v[136:139], v[64:67], a[80:83]
  ds_read_b64_tr_b16 v[156:157], v32 offset:49152
  v_mfma_f32_16x16x32_bf16 a[84:87], v[140:143], v[64:67], a[84:87]
  ds_read_b64_tr_b16 v[158:159], v32 offset:51200
  v_mfma_f32_16x16x32_bf16 v[204:207], v[140:143], v[68:71], v[204:207]
  ds_read_b64_tr_b16 v[160:161], v33 offset:49152
  v_mfma_f32_16x16x32_bf16 v[208:211], v[144:147], v[68:71], v[208:211]
  v_mfma_f32_16x16x32_bf16 a[88:91], v[144:147], v[64:67], a[88:91]
  buffer_load_dwordx4 v12, s[60:63], s37 offen offset:2048 lds
  v_mfma_f32_16x16x32_bf16 a[92:95], v[148:151], v[64:67], a[92:95]
  ds_read_b64_tr_b16 v[162:163], v33 offset:51200
  v_mfma_f32_16x16x32_bf16 v[212:215], v[148:151], v[68:71], v[212:215]
  ds_read_b64_tr_b16 v[164:165], v34 offset:49152
  v_mfma_f32_16x16x32_bf16 a[28:31], v[148:151], v[56:59], a[28:31]
  ds_read_b64_tr_b16 v[166:167], v34 offset:51200
  v_mfma_f32_16x16x32_bf16 a[60:63], v[148:151], v[60:63], a[60:63]
  ds_read_b64_tr_b16 v[168:169], v35 offset:49152
  v_mfma_f32_16x16x32_bf16 a[56:59], v[144:147], v[60:63], a[56:59]
  ds_read_b64_tr_b16 v[170:171], v35 offset:51200
  v_mfma_f32_16x16x32_bf16 a[24:27], v[144:147], v[56:59], a[24:27]
  v_mfma_f32_16x16x32_bf16 a[20:23], v[140:143], v[56:59], a[20:23]
  buffer_load_dwordx4 v13, s[60:63], s37 offen offset:3072 lds
  v_mfma_f32_16x16x32_bf16 a[52:55], v[140:143], v[60:63], a[52:55]
  s_add_u32 s37, s37, 0x40000
  ds_read_b64_tr_b16 v[172:173], v36 offset:49152
  v_mfma_f32_16x16x32_bf16 a[48:51], v[136:139], v[60:63], a[48:51]
  ds_read_b64_tr_b16 v[174:175], v36 offset:51200
  v_mfma_f32_16x16x32_bf16 a[16:19], v[136:139], v[56:59], a[16:19]
  ds_read_b64_tr_b16 v[176:177], v37 offset:49152
  v_mfma_f32_16x16x32_bf16 a[12:15], v[132:135], v[56:59], a[12:15]
  ds_read_b64_tr_b16 v[178:179], v37 offset:51200
  v_mfma_f32_16x16x32_bf16 a[44:47], v[132:135], v[60:63], a[44:47]
  ds_read_b64_tr_b16 v[180:181], v38 offset:49152
  v_mfma_f32_16x16x32_bf16 a[40:43], v[128:131], v[60:63], a[40:43]
  v_mfma_f32_16x16x32_bf16 a[8:11], v[128:131], v[56:59], a[8:11]
  ds_read_b64_tr_b16 v[182:183], v38 offset:51200
  v_mfma_f32_16x16x32_bf16 a[4:7], v[124:127], v[56:59], a[4:7]
  v_mfma_f32_16x16x32_bf16 a[36:39], v[124:127], v[60:63], a[36:39]
  v_mfma_f32_16x16x32_bf16 a[32:35], v[120:123], v[60:63], a[32:35]
  v_mfma_f32_16x16x32_bf16 a[0:3], v[120:123], v[56:59], a[0:3]
  v_mfma_f32_16x16x32_bf16 a[96:99], v[56:59], v[56:59], a[96:99]
  v_mfma_f32_16x16x32_bf16 a[100:103], v[60:63], v[60:63], a[100:103]
  s_waitcnt lgkmcnt(0)
  s_barrier
  v_mfma_f32_16x16x32_bf16 v[216:219], v[104:107], v[88:91], v[216:219]
  s_add_u32 m0, s35, 0x8000
  ds_read_b128 v[56:59], v42 offset:0
  v_mfma_f32_16x16x32_bf16 v[220:223], v[108:111], v[88:91], v[220:223]
  buffer_load_dwordx4 v53, s[56:59], s36 offen offset:0 lds
  v_mfma_f32_16x16x32_bf16 v[224:227], v[104:107], v[92:95], v[224:227]
  s_add_u32 m0, s35, 0xbfc0
  ds_read_b128 v[60:63], v42 offset:1024
  v_mfma_f32_16x16x32_bf16 v[228:231], v[108:111], v[92:95], v[228:231]
  ds_read_b64_tr_b16 v[72:73], v44 offset:8192
  v_mfma_f32_16x16x32_bf16 v[16:19], v[104:107], v[48:51], v[16:19]
  ds_read_b64_tr_b16 v[74:75], v44 offset:8448
  v_mfma_f32_16x16x32_bf16 v[20:23], v[108:111], v[48:51], v[20:23]
  buffer_load_dwordx4 v53, s[56:59], s36 offen offset:64 lds
  v_mfma_f32_16x16x32_bf16 v[24:27], v[116:119], v[88:91], v[24:27]
  s_add_u32 m0, s35, 0x8000
  ds_read_b64_tr_b16 v[76:77], v45 offset:8192
  v_mfma_f32_16x16x32_bf16 v[28:31], v[116:119], v[92:95], v[28:31]
  ds_read_b64_tr_b16 v[78:79], v45 offset:8448
  v_mfma_f32_16x16x32_bf16 v[232:235], v[112:115], v[48:51], v[232:235]
  ds_read_b128 v[84:87], v47 offset:256
  v_mfma_f32_16x16x32_bf16 v[184:187], v[152:155], v[100:103], v[184:187]
  buffer_load_dwordx4 v54, s[56:59], s36 offen offset:1024 lds
  v_mfma_f32_16x16x32_bf16 a[64:67], v[152:155], v[96:99], a[64:67]
  s_add_u32 m0, s35, 0xbfc0
  ds_read_b64_tr_b16 v[80:81], v46 offset:10240
  v_mfma_f32_16x16x32_bf16 a[68:71], v[156:159], v[96:99], a[68:71]
  ds_read_b64_tr_b16 v[82:83], v46 offset:10368
  v_mfma_f32_16x16x32_bf16 v[188:191], v[156:159], v[100:103], v[188:191]
  ds_read_b128 v[64:67], v43 offset:0
  v_mfma_f32_16x16x32_bf16 v[192:195], v[160:163], v[100:103], v[192:195]
  buffer_load_dwordx4 v54, s[56:59], s36 offen offset:1088 lds
  v_mfma_f32_16x16x32_bf16 a[72:75], v[160:163], v[96:99], a[72:75]
  s_add_u32 s36, s36, 128
  s_add_u32 m0, s48, 0xc000
  ds_read_b128 v[68:71], v43 offset:1024
  v_mfma_f32_16x16x32_bf16 a[76:79], v[164:167], v[96:99], a[76:79]
  ds_read_b64_tr_b16 v[120:121], v15 offset:0
  v_mfma_f32_16x16x32_bf16 v[196:199], v[164:167], v[100:103], v[196:199]
  ds_read_b64_tr_b16 v[122:123], v15 offset:2048
  v_mfma_f32_16x16x32_bf16 v[200:203], v[168:171], v[100:103], v[200:203]
  buffer_load_dwordx4 v55, s[52:55], s49 offen lds
  v_mfma_f32_16x16x32_bf16 a[80:83], v[168:171], v[96:99], a[80:83]
  s_add_u32 m0, s34, 0x1c000
  s_add_u32 s49, s49, s47
  ds_read_b64_tr_b16 v[124:125], v32 offset:0
  v_mfma_f32_16x16x32_bf16 a[84:87], v[172:175], v[96:99], a[84:87]
  ds_read_b64_tr_b16 v[126:127], v32 offset:2048
  v_mfma_f32_16x16x32_bf16 v[204:207], v[172:175], v[100:103], v[204:207]
  ds_read_b64_tr_b16 v[128:129], v33 offset:0
  v_mfma_f32_16x16x32_bf16 v[208:211], v[176:179], v[100:103], v[208:211]
  buffer_load_dwordx4 v10, s[60:63], s37 offen offset:0 lds
  v_mfma_f32_16x16x32_bf16 a[88:91], v[176:179], v[96:99], a[88:91]
  ds_read_b64_tr_b16 v[130:131], v33 offset:2048
  v_mfma_f32_16x16x32_bf16 a[92:95], v[180:183], v[96:99], a[92:95]
  ds_read_b64_tr_b16 v[132:133], v34 offset:0
  v_mfma_f32_16x16x32_bf16 v[212:215], v[180:183], v[100:103], v[212:215]
  ds_read_b64_tr_b16 v[134:135], v34 offset:2048
  v_mfma_f32_16x16x32_bf16 a[28:31], v[180:183], v[88:91], a[28:31]
  buffer_load_dwordx4 v11, s[60:63], s37 offen offset:1024 lds
  v_mfma_f32_16x16x32_bf16 a[60:63], v[180:183], v[92:95], a[60:63]
  ds_read_b64_tr_b16 v[136:137], v35 offset:0
  v_mfma_f32_16x16x32_bf16 a[56:59], v[176:179], v[92:95], a[56:59]
  ds_read_b64_tr_b16 v[138:139], v35 offset:2048
  v_mfma_f32_16x16x32_bf16 a[24:27], v[176:179], v[88:91], a[24:27]
  ds_read_b64_tr_b16 v[140:141], v36 offset:0
  v_mfma_f32_16x16x32_bf16 a[20:23], v[172:175], v[88:91], a[20:23]
  buffer_load_dwordx4 v12, s[60:63], s37 offen offset:2048 lds
  v_mfma_f32_16x16x32_bf16 a[52:55], v[172:175], v[92:95], a[52:55]
  ds_read_b64_tr_b16 v[142:143], v36 offset:2048
  v_mfma_f32_16x16x32_bf16 a[48:51], v[168:171], v[92:95], a[48:51]
  ds_read_b64_tr_b16 v[144:145], v37 offset:0
  v_mfma_f32_16x16x32_bf16 a[16:19], v[168:171], v[88:91], a[16:19]
  ds_read_b64_tr_b16 v[146:147], v37 offset:2048
  v_mfma_f32_16x16x32_bf16 a[12:15], v[164:167], v[88:91], a[12:15]
  buffer_load_dwordx4 v13, s[60:63], s37 offen offset:3072 lds
  v_mfma_f32_16x16x32_bf16 a[44:47], v[164:167], v[92:95], a[44:47]
  s_add_u32 s37, s37, 0x40000
  ds_read_b64_tr_b16 v[148:149], v38 offset:0
  v_mfma_f32_16x16x32_bf16 a[40:43], v[160:163], v[92:95], a[40:43]
  ds_read_b64_tr_b16 v[150:151], v38 offset:2048
  v_mfma_f32_16x16x32_bf16 a[8:11], v[160:163], v[88:91], a[8:11]
  v_mfma_f32_16x16x32_bf16 a[4:7], v[156:159], v[88:91], a[4:7]
  v_mfma_f32_16x16x32_bf16 a[36:39], v[156:159], v[92:95], a[36:39]
  v_mfma_f32_16x16x32_bf16 a[32:35], v[152:155], v[92:95], a[32:35]
  v_mfma_f32_16x16x32_bf16 a[0:3], v[152:155], v[88:91], a[0:3]
  v_mfma_f32_16x16x32_bf16 a[96:99], v[88:91], v[88:91], a[96:99]
  v_mfma_f32_16x16x32_bf16 a[100:103], v[92:95], v[92:95], a[100:103]
  s_waitcnt lgkmcnt(0)
  s_barrier
  v_mfma_f32_16x16x32_bf16 v[216:219], v[72:75], v[56:59], v[216:219]
  s_add_u32 m0, s48, 0x0
  ds_read_b128 v[88:91], v42 offset:16384
  v_mfma_f32_16x16x32_bf16 v[220:223], v[76:79], v[56:59], v[220:223]
  buffer_load_dwordx4 v55, s[52:55], s49 offen lds
  v_mfma_f32_16x16x32_bf16 v[224:227], v[72:75], v[60:63], v[224:227]
  s_add_u32 m0, s34, 0x10000
  s_add_u32 s49, s49, s47
  ds_read_b128 v[92:95], v42 offset:17408
  v_mfma_f32_16x16x32_bf16 v[228:231], v[76:79], v[60:63], v[228:231]
  ds_read_b64_tr_b16 v[104:105], v44 offset:24576
  v_mfma_f32_16x16x32_bf16 v[16:19], v[72:75], v[48:51], v[16:19]
  ds_read_b64_tr_b16 v[106:107], v44 offset:24832
  v_mfma_f32_16x16x32_bf16 v[20:23], v[76:79], v[48:51], v[20:23]
  ds_read_b64_tr_b16 v[108:109], v45 offset:24576
  v_mfma_f32_16x16x32_bf16 v[24:27], v[84:87], v[56:59], v[24:27]
  ds_read_b64_tr_b16 v[110:111], v45 offset:24832
  v_mfma_f32_16x16x32_bf16 v[28:31], v[84:87], v[60:63], v[28:31]
  v_mfma_f32_16x16x32_bf16 v[232:235], v[80:83], v[48:51], v[232:235]
  buffer_load_dwordx4 v10, s[60:63], s37 offen offset:0 lds
  v_mfma_f32_16x16x32_bf16 v[184:187], v[120:123], v[68:71], v[184:187]
  ds_read_b128 v[116:119], v47 offset:320
  v_mfma_f32_16x16x32_bf16 a[64:67], v[120:123], v[64:67], a[64:67]
  ds_read_b64_tr_b16 v[112:113], v46 offset:26624
  v_mfma_f32_16x16x32_bf16 a[68:71], v[124:127], v[64:67], a[68:71]
  ds_read_b64_tr_b16 v[114:115], v46 offset:26752
  v_mfma_f32_16x16x32_bf16 v[188:191], v[124:127], v[68:71], v[188:191]
  ds_read_b128 v[96:99], v43 offset:16384
  v_mfma_f32_16x16x32_bf16 v[192:195], v[128:131], v[68:71], v[192:195]
  ds_read_b128 v[100:103], v43 offset:17408
  v_mfma_f32_16x16x32_bf16 a[72:75], v[128:131], v[64:67], a[72:75]
  v_mfma_f32_16x16x32_bf16 a[76:79], v[132:135], v[64:67], a[76:79]
  buffer_load_dwordx4 v11, s[60:63], s37 offen offset:1024 lds
  v_mfma_f32_16x16x32_bf16 v[196:199], v[132:135], v[68:71], v[196:199]
  ds_read_b64_tr_b16 v[152:153], v15 offset:16384
  v_mfma_f32_16x16x32_bf16 v[200:203], v[136:139], v[68:71], v[200:203]
  ds_read_b64_tr_b16 v[154:155], v15 offset:18432
  v_mfma_f32_16x16x32_bf16 a[80:83], v[136:139], v[64:67], a[80:83]
  ds_read_b64_tr_b16 v[156:157], v32 offset:16384
  v_mfma_f32_16x16x32_bf16 a[84:87], v[140:143], v[64:67], a[84:87]
  ds_read_b64_tr_b16 v[158:159], v32 offset:18432
  v_mfma_f32_16x16x32_bf16 v[204:207], v[140:143], v[68:71], v[204:207]
  ds_read_b64_tr_b16 v[160:161], v33 offset:16384
  v_mfma_f32_16x16x32_bf16 v[208:211], v[144:147], v[68:71], v[208:211]
  v_mfma_f32_16x16x32_bf16 a[88:91], v[144:147], v[64:67], a[88:91]
  buffer_load_dwordx4 v12, s[60:63], s37 offen offset:2048 lds
  v_mfma_f32_16x16x32_bf16 a[92:95], v[148:151], v[64:67], a[92:95]
  ds_read_b64_tr_b16 v[162:163], v33 offset:18432
  v_mfma_f32_16x16x32_bf16 v[212:215], v[148:151], v[68:71], v[212:215]
  ds_read_b64_tr_b16 v[164:165], v34 offset:16384
  v_mfma_f32_16x16x32_bf16 a[28:31], v[148:151], v[56:59], a[28:31]
  ds_read_b64_tr_b16 v[166:167], v34 offset:18432
  v_mfma_f32_16x16x32_bf16 a[60:63], v[148:151], v[60:63], a[60:63]
  ds_read_b64_tr_b16 v[168:169], v35 offset:16384
  v_mfma_f32_16x16x32_bf16 a[56:59], v[144:147], v[60:63], a[56:59]
  ds_read_b64_tr_b16 v[170:171], v35 offset:18432
  v_mfma_f32_16x16x32_bf16 a[24:27], v[144:147], v[56:59], a[24:27]
  v_mfma_f32_16x16x32_bf16 a[20:23], v[140:143], v[56:59], a[20:23]
  buffer_load_dwordx4 v13, s[60:63], s37 offen offset:3072 lds
  v_mfma_f32_16x16x32_bf16 a[52:55], v[140:143], v[60:63], a[52:55]
  s_add_u32 s37, s37, 0x40000
  ds_read_b64_tr_b16 v[172:173], v36 offset:16384
  v_mfma_f32_16x16x32_bf16 a[48:51], v[136:139], v[60:63], a[48:51]
  ds_read_b64_tr_b16 v[174:175], v36 offset:18432
  v_mfma_f32_16x16x32_bf16 a[16:19], v[136:139], v[56:59], a[16:19]
  ds_read_b64_tr_b16 v[176:177], v37 offset:16384
  v_mfma_f32_16x16x32_bf16 a[12:15], v[132:135], v[56:59], a[12:15]
  ds_read_b64_tr_b16 v[178:179], v37 offset:18432
  v_mfma_f32_16x16x32_bf16 a[44:47], v[132:135], v[60:63], a[44:47]
  ds_read_b64_tr_b16 v[180:181], v38 offset:16384
  v_mfma_f32_16x16x32_bf16 a[40:43], v[128:131], v[60:63], a[40:43]
  v_mfma_f32_16x16x32_bf16 a[8:11], v[128:131], v[56:59], a[8:11]
  ds_read_b64_tr_b16 v[182:183], v38 offset:18432
  v_mfma_f32_16x16x32_bf16 a[4:7], v[124:127], v[56:59], a[4:7]
  v_mfma_f32_16x16x32_bf16 a[36:39], v[124:127], v[60:63], a[36:39]
  v_mfma_f32_16x16x32_bf16 a[32:35], v[120:123], v[60:63], a[32:35]
  v_mfma_f32_16x16x32_bf16 a[0:3], v[120:123], v[56:59], a[0:3]
  v_mfma_f32_16x16x32_bf16 a[96:99], v[56:59], v[56:59], a[96:99]
  v_mfma_f32_16x16x32_bf16 a[100:103], v[60:63], v[60:63], a[100:103]
  s_waitcnt lgkmcnt(0)
  s_waitcnt vmcnt(11)
  s_barrier
  v_mfma_f32_16x16x32_bf16 v[216:219], v[104:107], v[88:91], v[216:219]
  s_add_u32 m0, s35, 0x0
  ds_read_b128 v[56:59], v42 offset:32768
  v_mfma_f32_16x16x32_bf16 v[220:223], v[108:111], v[88:91], v[220:223]
  buffer_load_dwordx4 v53, s[56:59], s36 offen offset:0 lds
  v_mfma_f32_16x16x32_bf16 v[224:227], v[104:107], v[92:95], v[224:227]
  s_add_u32 m0, s35, 0x3fc0
  ds_read_b128 v[60:63], v42 offset:33792
  v_mfma_f32_16x16x32_bf16 v[228:231], v[108:111], v[92:95], v[228:231]
  ds_read_b64_tr_b16 v[72:73], v44 offset:40960
  v_mfma_f32_16x16x32_bf16 v[16:19], v[104:107], v[48:51], v[16:19]
  ds_read_b64_tr_b16 v[74:75], v44 offset:41216
  v_mfma_f32_16x16x32_bf16 v[20:23], v[108:111], v[48:51], v[20:23]
  buffer_load_dwordx4 v53, s[56:59], s36 offen offset:64 lds
  v_mfma_f32_16x16x32_bf16 v[24:27], v[116:119], v[88:91], v[24:27]
  s_add_u32 m0, s35, 0x0
  ds_read_b64_tr_b16 v[76:77], v45 offset:40960
  v_mfma_f32_16x16x32_bf16 v[28:31], v[116:119], v[92:95], v[28:31]
  ds_read_b64_tr_b16 v[78:79], v45 offset:41216
  v_mfma_f32_16x16x32_bf16 v[232:235], v[112:115], v[48:51], v[232:235]
  ds_read_b128 v[84:87], v47 offset:384
  v_mfma_f32_16x16x32_bf16 v[184:187], v[152:155], v[100:103], v[184:187]
  buffer_load_dwordx4 v54, s[56:59], s36 offen offset:1024 lds
  v_mfma_f32_16x16x32_bf16 a[64:67], v[152:155], v[96:99], a[64:67]
  s_add_u32 m0, s35, 0x3fc0
  ds_read_b64_tr_b16 v[80:81], v46 offset:43008
  v_mfma_f32_16x16x32_bf16 a[68:71], v[156:159], v[96:99], a[68:71]
  ds_read_b64_tr_b16 v[82:83], v46 offset:43136
  v_mfma_f32_16x16x32_bf16 v[188:191], v[156:159], v[100:103], v[188:191]
  ds_read_b128 v[64:67], v43 offset:32768
  v_mfma_f32_16x16x32_bf16 v[192:195], v[160:163], v[100:103], v[192:195]
  buffer_load_dwordx4 v54, s[56:59], s36 offen offset:1088 lds
  v_mfma_f32_16x16x32_bf16 a[72:75], v[160:163], v[96:99], a[72:75]
  s_add_u32 s36, s36, 128
  s_add_u32 m0, s48, 0x4000
  ds_read_b128 v[68:71], v43 offset:33792
  v_mfma_f32_16x16x32_bf16 a[76:79], v[164:167], v[96:99], a[76:79]
  ds_read_b64_tr_b16 v[120:121], v15 offset:32768
  v_mfma_f32_16x16x32_bf16 v[196:199], v[164:167], v[100:103], v[196:199]
  ds_read_b64_tr_b16 v[122:123], v15 offset:34816
  v_mfma_f32_16x16x32_bf16 v[200:203], v[168:171], v[100:103], v[200:203]
  buffer_load_dwordx4 v55, s[52:55], s49 offen lds
  v_mfma_f32_16x16x32_bf16 a[80:83], v[168:171], v[96:99], a[80:83]
  s_add_u32 m0, s34, 0x14000
  s_add_u32 s49, s49, s47
  ds_read_b64_tr_b16 v[124:125], v32 offset:32768
  v_mfma_f32_16x16x32_bf16 a[84:87], v[172:175], v[96:99], a[84:87]
  ds_read_b64_tr_b16 v[126:127], v32 offset:34816
  v_mfma_f32_16x16x32_bf16 v[204:207], v[172:175], v[100:103], v[204:207]
  ds_read_b64_tr_b16 v[128:129], v33 offset:32768
  v_mfma_f32_16x16x32_bf16 v[208:211], v[176:179], v[100:103], v[208:211]
  buffer_load_dwordx4 v10, s[60:63], s37 offen offset:0 lds
  v_mfma_f32_16x16x32_bf16 a[88:91], v[176:179], v[96:99], a[88:91]
  ds_read_b64_tr_b16 v[130:131], v33 offset:34816
  v_mfma_f32_16x16x32_bf16 a[92:95], v[180:183], v[96:99], a[92:95]
  ds_read_b64_tr_b16 v[132:133], v34 offset:32768
  v_mfma_f32_16x16x32_bf16 v[212:215], v[180:183], v[100:103], v[212:215]
  ds_read_b64_tr_b16 v[134:135], v34 offset:34816
  v_mfma_f32_16x16x32_bf16 a[28:31], v[180:183], v[88:91], a[28:31]
  buffer_load_dwordx4 v11, s[60:63], s37 offen offset:1024 lds
  v_mfma_f32_16x16x32_bf16 a[60:63], v[180:183], v[92:95], a[60:63]
  ds_read_b64_tr_b16 v[136:137], v35 offset:32768
  v_mfma_f32_16x16x32_bf16 a[56:59], v[176:179], v[92:95], a[56:59]
  ds_read_b64_tr_b16 v[138:139], v35 offset:34816
  v_mfma_f32_16x16x32_bf16 a[24:27], v[176:179], v[88:91], a[24:27]
  ds_read_b64_tr_b16 v[140:141], v36 offset:32768
  v_mfma_f32_16x16x32_bf16 a[20:23], v[172:175], v[88:91], a[20:23]
  buffer_load_dwordx4 v12, s[60:63], s37 offen offset:2048 lds
  v_mfma_f32_16x16x32_bf16 a[52:55], v[172:175], v[92:95], a[52:55]
  ds_read_b64_tr_b16 v[142:143], v36 offset:34816
  v_mfma_f32_16x16x32_bf16 a[48:51], v[168:171], v[92:95], a[48:51]
  ds_read_b64_tr_b16 v[144:145], v37 offset:32768
  v_mfma_f32_16x16x32_bf16 a[16:19], v[168:171], v[88:91], a[16:19]
  ds_read_b64_tr_b16 v[146:147], v37 offset:34816
  v_mfma_f32_16x16x32_bf16 a[12:15], v[164:167], v[88:91], a[12:15]
  buffer_load_dwordx4 v13, s[60:63], s37 offen offset:3072 lds
  v_mfma_f32_16x16x32_bf16 a[44:47], v[164:167], v[92:95], a[44:47]
  s_add_u32 s37, s37, 0x40000
  ds_read_b64_tr_b16 v[148:149], v38 offset:32768
  v_mfma_f32_16x16x32_bf16 a[40:43], v[160:163], v[92:95], a[40:43]
  ds_read_b64_tr_b16 v[150:151], v38 offset:34816
  v_mfma_f32_16x16x32_bf16 a[8:11], v[160:163], v[88:91], a[8:11]
  v_mfma_f32_16x16x32_bf16 a[4:7], v[156:159], v[88:91], a[4:7]
  v_mfma_f32_16x16x32_bf16 a[36:39], v[156:159], v[92:95], a[36:39]
  v_mfma_f32_16x16x32_bf16 a[32:35], v[152:155], v[92:95], a[32:35]
  v_mfma_f32_16x16x32_bf16 a[0:3], v[152:155], v[88:91], a[0:3]
  v_mfma_f32_16x16x32_bf16 a[96:99], v[88:91], v[88:91], a[96:99]
  v_mfma_f32_16x16x32_bf16 a[100:103], v[92:95], v[92:95], a[100:103]
  s_waitcnt lgkmcnt(0)
  s_waitcnt vmcnt(14)
  s_barrier
  v_mfma_f32_16x16x32_bf16 v[216:219], v[72:75], v[56:59], v[216:219]
  s_add_u32 m0, s48, 0x8000
  ds_read_b128 v[88:91], v42 offset:49152
  v_mfma_f32_16x16x32_bf16 v[220:223], v[76:79], v[56:59], v[220:223]
  buffer_load_dwordx4 v55, s[52:55], s49 offen lds
  v_mfma_f32_16x16x32_bf16 v[224:227], v[72:75], v[60:63], v[224:227]
  s_add_u32 m0, s34, 0x18000
  s_add_u32 s49, s49, s47
  ds_read_b128 v[92:95], v42 offset:50176
  v_mfma_f32_16x16x32_bf16 v[228:231], v[76:79], v[60:63], v[228:231]
  ds_read_b64_tr_b16 v[104:105], v44 offset:57344
  v_mfma_f32_16x16x32_bf16 v[16:19], v[72:75], v[48:51], v[16:19]
  ds_read_b64_tr_b16 v[106:107], v44 offset:57600
  v_mfma_f32_16x16x32_bf16 v[20:23], v[76:79], v[48:51], v[20:23]
  ds_read_b64_tr_b16 v[108:109], v45 offset:57344
  v_mfma_f32_16x16x32_bf16 v[24:27], v[84:87], v[56:59], v[24:27]
  ds_read_b64_tr_b16 v[110:111], v45 offset:57600
  v_mfma_f32_16x16x32_bf16 v[28:31], v[84:87], v[60:63], v[28:31]
  v_mfma_f32_16x16x32_bf16 v[232:235], v[80:83], v[48:51], v[232:235]
  buffer_load_dwordx4 v10, s[60:63], s37 offen offset:0 lds
  v_mfma_f32_16x16x32_bf16 v[184:187], v[120:123], v[68:71], v[184:187]
  ds_read_b128 v[116:119], v47 offset:448
  v_mfma_f32_16x16x32_bf16 a[64:67], v[120:123], v[64:67], a[64:67]
  ds_read_b64_tr_b16 v[112:113], v46 offset:59392
  v_mfma_f32_16x16x32_bf16 a[68:71], v[124:127], v[64:67], a[68:71]
  ds_read_b64_tr_b16 v[114:115], v46 offset:59520
  v_mfma_f32_16x16x32_bf16 v[188:191], v[124:127], v[68:71], v[188:191]
  ds_read_b128 v[96:99], v43 offset:49152
  v_mfma_f32_16x16x32_bf16 v[192:195], v[128:131], v[68:71], v[192:195]
  ds_read_b128 v[100:103], v43 offset:50176
  v_mfma_f32_16x16x32_bf16 a[72:75], v[128:131], v[64:67], a[72:75]
  v_mfma_f32_16x16x32_bf16 a[76:79], v[132:135], v[64:67], a[76:79]
  buffer_load_dwordx4 v11, s[60:63], s37 offen offset:1024 lds
  v_mfma_f32_16x16x32_bf16 v[196:199], v[132:135], v[68:71], v[196:199]
  ds_read_b64_tr_b16 v[152:153], v15 offset:49152
  v_mfma_f32_16x16x32_bf16 v[200:203], v[136:139], v[68:71], v[200:203]
  ds_read_b64_tr_b16 v[154:155], v15 offset:51200
  v_mfma_f32_16x16x32_bf16 a[80:83], v[136:139], v[64:67], a[80:83]
  ds_read_b64_tr_b16 v[156:157], v32 offset:49152
  v_mfma_f32_16x16x32_bf16 a[84:87], v[140:143], v[64:67], a[84:87]
  ds_read_b64_tr_b16 v[158:159], v32 offset:51200
  v_mfma_f32_16x16x32_bf16 v[204:207], v[140:143], v[68:71], v[204:207]
  ds_read_b64_tr_b16 v[160:161], v33 offset:49152
  v_mfma_f32_16x16x32_bf16 v[208:211], v[144:147], v[68:71], v[208:211]
  v_mfma_f32_16x16x32_bf16 a[88:91], v[144:147], v[64:67], a[88:91]
  buffer_load_dwordx4 v12, s[60:63], s37 offen offset:2048 lds
  v_mfma_f32_16x16x32_bf16 a[92:95], v[148:151], v[64:67], a[92:95]
  ds_read_b64_tr_b16 v[162:163], v33 offset:51200
  v_mfma_f32_16x16x32_bf16 v[212:215], v[148:151], v[68:71], v[212:215]
  ds_read_b64_tr_b16 v[164:165], v34 offset:49152
  v_mfma_f32_16x16x32_bf16 a[28:31], v[148:151], v[56:59], a[28:31]
  ds_read_b64_tr_b16 v[166:167], v34 offset:51200
  v_mfma_f32_16x16x32_bf16 a[60:63], v[148:151], v[60:63], a[60:63]
  ds_read_b64_tr_b16 v[168:169], v35 offset:49152
  v_mfma_f32_16x16x32_bf16 a[56:59], v[144:147], v[60:63], a[56:59]
  ds_read_b64_tr_b16 v[170:171], v35 offset:51200
  v_mfma_f32_16x16x32_bf16 a[24:27], v[144:147], v[56:59], a[24:27]
  v_mfma_f32_16x16x32_bf16 a[20:23], v[140:143], v[56:59], a[20:23]
  buffer_load_dwordx4 v13, s[60:63], s37 offen offset:3072 lds
  v_mfma_f32_16x16x32_bf16 a[52:55], v[140:143], v[60:63], a[52:55]
  s_add_u32 s37, s37, 0x40000
  ds_read_b64_tr_b16 v[172:173], v36 offset:49152
  v_mfma_f32_16x16x32_bf16 a[48:51], v[136:139], v[60:63], a[48:51]
  ds_read_b64_tr_b16 v[174:175], v36 offset:51200
  v_mfma_f32_16x16x32_bf16 a[16:19], v[136:139], v[56:59], a[16:19]
  ds_read_b64_tr_b16 v[176:177], v37 offset:49152
  v_mfma_f32_16x16x32_bf16 a[12:15], v[132:135], v[56:59], a[12:15]
  ds_read_b64_tr_b16 v[178:179], v37 offset:51200
  v_mfma_f32_16x16x32_bf16 a[44:47], v[132:135], v[60:63], a[44:47]
  ds_read_b64_tr_b16 v[180:181], v38 offset:49152
  v_mfma_f32_16x16x32_bf16 a[40:43], v[128:131], v[60:63], a[40:43]
  v_mfma_f32_16x16x32_bf16 a[8:11], v[128:131], v[56:59], a[8:11]
  ds_read_b64_tr_b16 v[182:183], v38 offset:51200
  v_mfma_f32_16x16x32_bf16 a[4:7], v[124:127], v[56:59], a[4:7]
  v_mfma_f32_16x16x32_bf16 a[36:39], v[124:127], v[60:63], a[36:39]
  v_mfma_f32_16x16x32_bf16 a[32:35], v[120:123], v[60:63], a[32:35]
  v_mfma_f32_16x16x32_bf16 a[0:3], v[120:123], v[56:59], a[0:3]
  v_mfma_f32_16x16x32_bf16 a[96:99], v[56:59], v[56:59], a[96:99]
  v_mfma_f32_16x16x32_bf16 a[100:103], v[60:63], v[60:63], a[100:103]
  s_waitcnt lgkmcnt(0)
  s_waitcnt vmcnt(11)
  s_barrier
  v_mfma_f32_16x16x32_bf16 v[216:219], v[104:107], v[88:91], v[216:219]
  s_add_u32 m0, s35, 0x8000
  ds_read_b128 v[56:59], v42 offset:0
  v_mfma_f32_16x16x32_bf16 v[220:223], v[108:111], v[88:91], v[220:223]
  buffer_load_dwordx4 v53, s[56:59], s36 offen offset:0 lds
  v_mfma_f32_16x16x32_bf16 v[224:227], v[104:107], v[92:95], v[224:227]
  s_add_u32 m0, s35, 0xbfc0
  ds_read_b128 v[60:63], v42 offset:1024
  v_mfma_f32_16x16x32_bf16 v[228:231], v[108:111], v[92:95], v[228:231]
  ds_read_b64_tr_b16 v[72:73], v44 offset:8192
  v_mfma_f32_16x16x32_bf16 v[16:19], v[104:107], v[48:51], v[16:19]
  ds_read_b64_tr_b16 v[74:75], v44 offset:8448
  v_mfma_f32_16x16x32_bf16 v[20:23], v[108:111], v[48:51], v[20:23]
  buffer_load_dwordx4 v53, s[56:59], s36 offen offset:64 lds
  v_mfma_f32_16x16x32_bf16 v[24:27], v[116:119], v[88:91], v[24:27]
  s_add_u32 m0, s35, 0x8000
  ds_read_b64_tr_b16 v[76:77], v45 offset:8192
  v_mfma_f32_16x16x32_bf16 v[28:31], v[116:119], v[92:95], v[28:31]
  ds_read_b64_tr_b16 v[78:79], v45 offset:8448
  v_mfma_f32_16x16x32_bf16 v[232:235], v[112:115], v[48:51], v[232:235]
  ds_read_b128 v[84:87], v47 offset:512
  v_mfma_f32_16x16x32_bf16 v[184:187], v[152:155], v[100:103], v[184:187]
  buffer_load_dwordx4 v54, s[56:59], s36 offen offset:1024 lds
  v_mfma_f32_16x16x32_bf16 a[64:67], v[152:155], v[96:99], a[64:67]
  s_add_u32 m0, s35, 0xbfc0
  ds_read_b64_tr_b16 v[80:81], v46 offset:10240
  v_mfma_f32_16x16x32_bf16 a[68:71], v[156:159], v[96:99], a[68:71]
  ds_read_b64_tr_b16 v[82:83], v46 offset:10368
  v_mfma_f32_16x16x32_bf16 v[188:191], v[156:159], v[100:103], v[188:191]
  ds_read_b128 v[64:67], v43 offset:0
  v_mfma_f32_16x16x32_bf16 v[192:195], v[160:163], v[100:103], v[192:195]
  buffer_load_dwordx4 v54, s[56:59], s36 offen offset:1088 lds
  v_mfma_f32_16x16x32_bf16 a[72:75], v[160:163], v[96:99], a[72:75]
  s_add_u32 s36, s36, 128
  s_add_u32 m0, s48, 0xc000
  ds_read_b128 v[68:71], v43 offset:1024
  v_mfma_f32_16x16x32_bf16 a[76:79], v[164:167], v[96:99], a[76:79]
  ds_read_b64_tr_b16 v[120:121], v15 offset:0
  v_mfma_f32_16x16x32_bf16 v[196:199], v[164:167], v[100:103], v[196:199]
  ds_read_b64_tr_b16 v[122:123], v15 offset:2048
  v_mfma_f32_16x16x32_bf16 v[200:203], v[168:171], v[100:103], v[200:203]
  buffer_load_dwordx4 v55, s[52:55], s49 offen lds
  v_mfma_f32_16x16x32_bf16 a[80:83], v[168:171], v[96:99], a[80:83]
  s_add_u32 m0, s34, 0x1c000
  s_add_u32 s49, s49, s47
  ds_read_b64_tr_b16 v[124:125], v32 offset:0
  v_mfma_f32_16x16x32_bf16 a[84:87], v[172:175], v[96:99], a[84:87]
  ds_read_b64_tr_b16 v[126:127], v32 offset:2048
  v_mfma_f32_16x16x32_bf16 v[204:207], v[172:175], v[100:103], v[204:207]
  ds_read_b64_tr_b16 v[128:129], v33 offset:0
  v_mfma_f32_16x16x32_bf16 v[208:211], v[176:179], v[100:103], v[208:211]
  buffer_load_dwordx4 v10, s[60:63], s37 offen offset:0 lds
  v_mfma_f32_16x16x32_bf16 a[88:91], v[176:179], v[96:99], a[88:91]
  ds_read_b64_tr_b16 v[130:131], v33 offset:2048
  v_mfma_f32_16x16x32_bf16 a[92:95], v[180:183], v[96:99], a[92:95]
  ds_read_b64_tr_b16 v[132:133], v34 offset:0
  v_mfma_f32_16x16x32_bf16 v[212:215], v[180:183], v[100:103], v[212:215]
  ds_read_b64_tr_b16 v[134:135], v34 offset:2048
  v_mfma_f32_16x16x32_bf16 a[28:31], v[180:183], v[88:91], a[28:31]
  buffer_load_dwordx4 v11, s[60:63], s37 offen offset:1024 lds
  v_mfma_f32_16x16x32_bf16 a[60:63], v[180:183], v[92:95], a[60:63]
  ds_read_b64_tr_b16 v[136:137], v35 offset:0
  v_mfma_f32_16x16x32_bf16 a[56:59], v[176:179], v[92:95], a[56:59]
  ds_read_b64_tr_b16 v[138:139], v35 offset:2048
  v_mfma_f32_16x16x32_bf16 a[24:27], v[176:179], v[88:91], a[24:27]
  ds_read_b64_tr_b16 v[140:141], v36 offset:0
  v_mfma_f32_16x16x32_bf16 a[20:23], v[172:175], v[88:91], a[20:23]
  buffer_load_dwordx4 v12, s[60:63], s37 offen offset:2048 lds
  v_mfma_f32_16x16x32_bf16 a[52:55], v[172:175], v[92:95], a[52:55]
  ds_read_b64_tr_b16 v[142:143], v36 offset:2048
  v_mfma_f32_16x16x32_bf16 a[48:51], v[168:171], v[92:95], a[48:51]
  ds_read_b64_tr_b16 v[144:145], v37 offset:0
  v_mfma_f32_16x16x32_bf16 a[16:19], v[168:171], v[88:91], a[16:19]
  ds_read_b64_tr_b16 v[146:147], v37 offset:2048
  v_mfma_f32_16x16x32_bf16 a[12:15], v[164:167], v[88:91], a[12:15]
  buffer_load_dwordx4 v13, s[60:63], s37 offen offset:3072 lds
  v_mfma_f32_16x16x32_bf16 a[44:47], v[164:167], v[92:95], a[44:47]
  s_add_u32 s37, s37, 0x40000
  ds_read_b64_tr_b16 v[148:149], v38 offset:0
  v_mfma_f32_16x16x32_bf16 a[40:43], v[160:163], v[92:95], a[40:43]
  ds_read_b64_tr_b16 v[150:151], v38 offset:2048
  v_mfma_f32_16x16x32_bf16 a[8:11], v[160:163], v[88:91], a[8:11]
  v_mfma_f32_16x16x32_bf16 a[4:7], v[156:159], v[88:91], a[4:7]
  v_mfma_f32_16x16x32_bf16 a[36:39], v[156:159], v[92:95], a[36:39]
  v_mfma_f32_16x16x32_bf16 a[32:35], v[152:155], v[92:95], a[32:35]
  v_mfma_f32_16x16x32_bf16 a[0:3], v[152:155], v[88:91], a[0:3]
  v_mfma_f32_16x16x32_bf16 a[96:99], v[88:91], v[88:91], a[96:99]
  v_mfma_f32_16x16x32_bf16 a[100:103], v[92:95], v[92:95], a[100:103]
  s_waitcnt lgkmcnt(0)
  s_waitcnt vmcnt(14)
  s_barrier
  v_mfma_f32_16x16x32_bf16 v[216:219], v[72:75], v[56:59], v[216:219]
  s_add_u32 m0, s48, 0x0
  ds_read_b128 v[88:91], v42 offset:16384
  v_mfma_f32_16x16x32_bf16 v[220:223], v[76:79], v[56:59], v[220:223]
  buffer_load_dwordx4 v55, s[52:55], s49 offen lds
  v_mfma_f32_16x16x32_bf16 v[224:227], v[72:75], v[60:63], v[224:227]
  s_add_u32 m0, s34, 0x10000
  s_add_u32 s49, s49, s47
  ds_read_b128 v[92:95], v42 offset:17408
  v_mfma_f32_16x16x32_bf16 v[228:231], v[76:79], v[60:63], v[228:231]
  ds_read_b64_tr_b16 v[104:105], v44 offset:24576
  v_mfma_f32_16x16x32_bf16 v[16:19], v[72:75], v[48:51], v[16:19]
  ds_read_b64_tr_b16 v[106:107], v44 offset:24832
  v_mfma_f32_16x16x32_bf16 v[20:23], v[76:79], v[48:51], v[20:23]
  ds_read_b64_tr_b16 v[108:109], v45 offset:24576
  v_mfma_f32_16x16x32_bf16 v[24:27], v[84:87], v[56:59], v[24:27]
  ds_read_b64_tr_b16 v[110:111], v45 offset:24832
  v_mfma_f32_16x16x32_bf16 v[28:31], v[84:87], v[60:63], v[28:31]
  v_mfma_f32_16x16x32_bf16 v[232:235], v[80:83], v[48:51], v[232:235]
  buffer_load_dwordx4 v10, s[60:63], s37 offen offset:0 lds
  v_mfma_f32_16x16x32_bf16 v[184:187], v[120:123], v[68:71], v[184:187]
  ds_read_b128 v[116:119], v47 offset:576
  v_mfma_f32_16x16x32_bf16 a[64:67], v[120:123], v[64:67], a[64:67]
  ds_read_b64_tr_b16 v[112:113], v46 offset:26624
  v_mfma_f32_16x16x32_bf16 a[68:71], v[124:127], v[64:67], a[68:71]
  ds_read_b64_tr_b16 v[114:115], v46 offset:26752
  v_mfma_f32_16x16x32_bf16 v[188:191], v[124:127], v[68:71], v[188:191]
  ds_read_b128 v[96:99], v43 offset:16384
  v_mfma_f32_16x16x32_bf16 v[192:195], v[128:131], v[68:71], v[192:195]
  ds_read_b128 v[100:103], v43 offset:17408
  v_mfma_f32_16x16x32_bf16 a[72:75], v[128:131], v[64:67], a[72:75]
  v_mfma_f32_16x16x32_bf16 a[76:79], v[132:135], v[64:67], a[76:79]
  buffer_load_dwordx4 v11, s[60:63], s37 offen offset:1024 lds
  v_mfma_f32_16x16x32_bf16 v[196:199], v[132:135], v[68:71], v[196:199]
  ds_read_b64_tr_b16 v[152:153], v15 offset:16384
  v_mfma_f32_16x16x32_bf16 v[200:203], v[136:139], v[68:71], v[200:203]
  ds_read_b64_tr_b16 v[154:155], v15 offset:18432
  v_mfma_f32_16x16x32_bf16 a[80:83], v[136:139], v[64:67], a[80:83]
  ds_read_b64_tr_b16 v[156:157], v32 offset:16384
  v_mfma_f32_16x16x32_bf16 a[84:87], v[140:143], v[64:67], a[84:87]
  ds_read_b64_tr_b16 v[158:159], v32 offset:18432
  v_mfma_f32_16x16x32_bf16 v[204:207], v[140:143], v[68:71], v[204:207]
  ds_read_b64_tr_b16 v[160:161], v33 offset:16384
  v_mfma_f32_16x16x32_bf16 v[208:211], v[144:147], v[68:71], v[208:211]
  v_mfma_f32_16x16x32_bf16 a[88:91], v[144:147], v[64:67], a[88:91]
  buffer_load_dwordx4 v12, s[60:63], s37 offen offset:2048 lds
  v_mfma_f32_16x16x32_bf16 a[92:95], v[148:151], v[64:67], a[92:95]
  ds_read_b64_tr_b16 v[162:163], v33 offset:18432
  v_mfma_f32_16x16x32_bf16 v[212:215], v[148:151], v[68:71], v[212:215]
  ds_read_b64_tr_b16 v[164:165], v34 offset:16384
  v_mfma_f32_16x16x32_bf16 a[28:31], v[148:151], v[56:59], a[28:31]
  ds_read_b64_tr_b16 v[166:167], v34 offset:18432
  v_mfma_f32_16x16x32_bf16 a[60:63], v[148:151], v[60:63], a[60:63]
  ds_read_b64_tr_b16 v[168:169], v35 offset:16384
  v_mfma_f32_16x16x32_bf16 a[56:59], v[144:147], v[60:63], a[56:59]
  ds_read_b64_tr_b16 v[170:171], v35 offset:18432
  v_mfma_f32_16x16x32_bf16 a[24:27], v[144:147], v[56:59], a[24:27]
  v_mfma_f32_16x16x32_bf16 a[20:23], v[140:143], v[56:59], a[20:23]
  buffer_load_dwordx4 v13, s[60:63], s37 offen offset:3072 lds
  v_mfma_f32_16x16x32_bf16 a[52:55], v[140:143], v[60:63], a[52:55]
  s_add_u32 s37, s37, 0x40000
  ds_read_b64_tr_b16 v[172:173], v36 offset:16384
  v_mfma_f32_16x16x32_bf16 a[48:51], v[136:139], v[60:63], a[48:51]
  ds_read_b64_tr_b16 v[174:175], v36 offset:18432
  v_mfma_f32_16x16x32_bf16 a[16:19], v[136:139], v[56:59], a[16:19]
  ds_read_b64_tr_b16 v[176:177], v37 offset:16384
  v_mfma_f32_16x16x32_bf16 a[12:15], v[132:135], v[56:59], a[12:15]
  ds_read_b64_tr_b16 v[178:179], v37 offset:18432
  v_mfma_f32_16x16x32_bf16 a[44:47], v[132:135], v[60:63], a[44:47]
  ds_read_b64_tr_b16 v[180:181], v38 offset:16384
  v_mfma_f32_16x16x32_bf16 a[40:43], v[128:131], v[60:63], a[40:43]
  v_mfma_f32_16x16x32_bf16 a[8:11], v[128:131], v[56:59], a[8:11]
  ds_read_b64_tr_b16 v[182:183], v38 offset:18432
  v_mfma_f32_16x16x32_bf16 a[4:7], v[124:127], v[56:59], a[4:7]
  v_mfma_f32_16x16x32_bf16 a[36:39], v[124:127], v[60:63], a[36:39]
  v_mfma_f32_16x16x32_bf16 a[32:35], v[120:123], v[60:63], a[32:35]
  v_mfma_f32_16x16x32_bf16 a[0:3], v[120:123], v[56:59], a[0:3]
  v_mfma_f32_16x16x32_bf16 a[96:99], v[56:59], v[56:59], a[96:99]
  v_mfma_f32_16x16x32_bf16 a[100:103], v[60:63], v[60:63], a[100:103]
  s_waitcnt lgkmcnt(0)
  s_waitcnt vmcnt(11)
  s_barrier
  v_mfma_f32_16x16x32_bf16 v[216:219], v[104:107], v[88:91], v[216:219]
  s_add_u32 m0, s35, 0x0
  ds_read_b128 v[56:59], v42 offset:32768
  v_mfma_f32_16x16x32_bf16 v[220:223], v[108:111], v[88:91], v[220:223]
  buffer_load_dwordx4 v53, s[56:59], s36 offen offset:0 lds
  v_mfma_f32_16x16x32_bf16 v[224:227], v[104:107], v[92:95], v[224:227]
  s_add_u32 m0, s35, 0x3fc0
  ds_read_b128 v[60:63], v42 offset:33792
  v_mfma_f32_16x16x32_bf16 v[228:231], v[108:111], v[92:95], v[228:231]
  ds_read_b64_tr_b16 v[72:73], v44 offset:40960
  v_mfma_f32_16x16x32_bf16 v[16:19], v[104:107], v[48:51], v[16:19]
  ds_read_b64_tr_b16 v[74:75], v44 offset:41216
  v_mfma_f32_16x16x32_bf16 v[20:23], v[108:111], v[48:51], v[20:23]
  buffer_load_dwordx4 v53, s[56:59], s36 offen offset:64 lds
  v_mfma_f32_16x16x32_bf16 v[24:27], v[116:119], v[88:91], v[24:27]
  s_add_u32 m0, s35, 0x0
  ds_read_b64_tr_b16 v[76:77], v45 offset:40960
  v_mfma_f32_16x16x32_bf16 v[28:31], v[116:119], v[92:95], v[28:31]
  ds_read_b64_tr_b16 v[78:79], v45 offset:41216
  v_mfma_f32_16x16x32_bf16 v[232:235], v[112:115], v[48:51], v[232:235]
  ds_read_b128 v[84:87], v47 offset:640
  v_mfma_f32_16x16x32_bf16 v[184:187], v[152:155], v[100:103], v[184:187]
  buffer_load_dwordx4 v54, s[56:59], s36 offen offset:1024 lds
  v_mfma_f32_16x16x32_bf16 a[64:67], v[152:155], v[96:99], a[64:67]
  s_add_u32 m0, s35, 0x3fc0
  ds_read_b64_tr_b16 v[80:81], v46 offset:43008
  v_mfma_f32_16x16x32_bf16 a[68:71], v[156:159], v[96:99], a[68:71]
  ds_read_b64_tr_b16 v[82:83], v46 offset:43136
  v_mfma_f32_16x16x32_bf16 v[188:191], v[156:159], v[100:103], v[188:191]
  ds_read_b128 v[64:67], v43 offset:32768
  v_mfma_f32_16x16x32_bf16 v[192:195], v[160:163], v[100:103], v[192:195]
  buffer_load_dwordx4 v54, s[56:59], s36 offen offset:1088 lds
  v_mfma_f32_16x16x32_bf16 a[72:75], v[160:163], v[96:99], a[72:75]
  s_add_u32 s36, s36, 128
  s_add_u32 m0, s48, 0x4000
  ds_read_b128 v[68:71], v43 offset:33792
  v_mfma_f32_16x16x32_bf16 a[76:79], v[164:167], v[96:99], a[76:79]
  ds_read_b64_tr_b16 v[120:121], v15 offset:32768
  v_mfma_f32_16x16x32_bf16 v[196:199], v[164:167], v[100:103], v[196:199]
  ds_read_b64_tr_b16 v[122:123], v15 offset:34816
  v_mfma_f32_16x16x32_bf16 v[200:203], v[168:171], v[100:103], v[200:203]
  buffer_load_dwordx4 v55, s[52:55], s49 offen lds
  v_mfma_f32_16x16x32_bf16 a[80:83], v[168:171], v[96:99], a[80:83]
  s_add_u32 m0, s34, 0x14000
  s_add_u32 s49, s49, s47
  ds_read_b64_tr_b16 v[124:125], v32 offset:32768
  v_mfma_f32_16x16x32_bf16 a[84:87], v[172:175], v[96:99], a[84:87]
  ds_read_b64_tr_b16 v[126:127], v32 offset:34816
  v_mfma_f32_16x16x32_bf16 v[204:207], v[172:175], v[100:103], v[204:207]
  ds_read_b64_tr_b16 v[128:129], v33 offset:32768
  v_mfma_f32_16x16x32_bf16 v[208:211], v[176:179], v[100:103], v[208:211]
  buffer_load_dwordx4 v10, s[60:63], s37 offen offset:0 lds
  v_mfma_f32_16x16x32_bf16 a[88:91], v[176:179], v[96:99], a[88:91]
  ds_read_b64_tr_b16 v[130:131], v33 offset:34816
  v_mfma_f32_16x16x32_bf16 a[92:95], v[180:183], v[96:99], a[92:95]
  ds_read_b64_tr_b16 v[132:133], v34 offset:32768
  v_mfma_f32_16x16x32_bf16 v[212:215], v[180:183], v[100:103], v[212:215]
  ds_read_b64_tr_b16 v[134:135], v34 offset:34816
  v_mfma_f32_16x16x32_bf16 a[28:31], v[180:183], v[88:91], a[28:31]
  buffer_load_dwordx4 v11, s[60:63], s37 offen offset:1024 lds
  v_mfma_f32_16x16x32_bf16 a[60:63], v[180:183], v[92:95], a[60:63]
  ds_read_b64_tr_b16 v[136:137], v35 offset:32768
  v_mfma_f32_16x16x32_bf16 a[56:59], v[176:179], v[92:95], a[56:59]
  ds_read_b64_tr_b16 v[138:139], v35 offset:34816
  v_mfma_f32_16x16x32_bf16 a[24:27], v[176:179], v[88:91], a[24:27]
  ds_read_b64_tr_b16 v[140:141], v36 offset:32768
  v_mfma_f32_16x16x32_bf16 a[20:23], v[172:175], v[88:91], a[20:23]
  buffer_load_dwordx4 v12, s[60:63], s37 offen offset:2048 lds
  v_mfma_f32_16x16x32_bf16 a[52:55], v[172:175], v[92:95], a[52:55]
  ds_read_b64_tr_b16 v[142:143], v36 offset:34816
  v_mfma_f32_16x16x32_bf16 a[48:51], v[168:171], v[92:95], a[48:51]
  ds_read_b64_tr_b16 v[144:145], v37 offset:32768
  v_mfma_f32_16x16x32_bf16 a[16:19], v[168:171], v[88:91], a[16:19]
  ds_read_b64_tr_b16 v[146:147], v37 offset:34816
  v_mfma_f32_16x16x32_bf16 a[12:15], v[164:167], v[88:91], a[12:15]
  buffer_load_dwordx4 v13, s[60:63], s37 offen offset:3072 lds
  v_mfma_f32_16x16x32_bf16 a[44:47], v[164:167], v[92:95], a[44:47]
  s_add_u32 s37, s37, 0x40000
  ds_read_b64_tr_b16 v[148:149], v38 offset:32768
  v_mfma_f32_16x16x32_bf16 a[40:43], v[160:163], v[92:95], a[40:43]
  ds_read_b64_tr_b16 v[150:151], v38 offset:34816
  v_mfma_f32_16x16x32_bf16 a[8:11], v[160:163], v[88:91], a[8:11]
  v_mfma_f32_16x16x32_bf16 a[4:7], v[156:159], v[88:91], a[4:7]
  v_mfma_f32_16x16x32_bf16 a[36:39], v[156:159], v[92:95], a[36:39]
  v_mfma_f32_16x16x32_bf16 a[32:35], v[152:155], v[92:95], a[32:35]
  v_mfma_f32_16x16x32_bf16 a[0:3], v[152:155], v[88:91], a[0:3]
  v_mfma_f32_16x16x32_bf16 a[96:99], v[88:91], v[88:91], a[96:99]
  v_mfma_f32_16x16x32_bf16 a[100:103], v[92:95], v[92:95], a[100:103]
  s_waitcnt lgkmcnt(0)
  s_waitcnt vmcnt(14)
  s_barrier
  v_mfma_f32_16x16x32_bf16 v[216:219], v[72:75], v[56:59], v[216:219]
  buffer_load_dword v10, v6, s[20:23], 0 offen sc1
  v_mfma_f32_16x16x32_bf16 v[220:223], v[76:79], v[56:59], v[220:223]
  ds_read_b128 v[88:91], v42 offset:49152
  v_mfma_f32_16x16x32_bf16 v[224:227], v[72:75], v[60:63], v[224:227]
  ds_read_b128 v[92:95], v42 offset:50176
  v_mfma_f32_16x16x32_bf16 v[228:231], v[76:79], v[60:63], v[228:231]
  ds_read_b64_tr_b16 v[104:105], v44 offset:57344
  v_mfma_f32_16x16x32_bf16 v[16:19], v[72:75], v[48:51], v[16:19]
  ds_read_b64_tr_b16 v[106:107], v44 offset:57600
  v_mfma_f32_16x16x32_bf16 v[20:23], v[76:79], v[48:51], v[20:23]
  ds_read_b64_tr_b16 v[108:109], v45 offset:57344
  v_mfma_f32_16x16x32_bf16 v[24:27], v[84:87], v[56:59], v[24:27]
  v_mfma_f32_16x16x32_bf16 v[28:31], v[84:87], v[60:63], v[28:31]
  ds_read_b64_tr_b16 v[110:111], v45 offset:57600
  v_mfma_f32_16x16x32_bf16 v[232:235], v[80:83], v[48:51], v[232:235]
  ds_read_b128 v[116:119], v47 offset:704
  v_mfma_f32_16x16x32_bf16 v[184:187], v[120:123], v[68:71], v[184:187]
  ds_read_b64_tr_b16 v[112:113], v46 offset:59392
  v_mfma_f32_16x16x32_bf16 a[64:67], v[120:123], v[64:67], a[64:67]
  ds_read_b64_tr_b16 v[114:115], v46 offset:59520
  v_mfma_f32_16x16x32_bf16 a[68:71], v[124:127], v[64:67], a[68:71]
  v_mfma_f32_16x16x32_bf16 v[188:191], v[124:127], v[68:71], v[188:191]
  ds_read_b128 v[96:99], v43 offset:49152
  v_mfma_f32_16x16x32_bf16 v[192:195], v[128:131], v[68:71], v[192:195]
  ds_read_b128 v[100:103], v43 offset:50176
  v_mfma_f32_16x16x32_bf16 a[72:75], v[128:131], v[64:67], a[72:75]
  ds_read_b64_tr_b16 v[152:153], v15 offset:49152
  v_mfma_f32_16x16x32_bf16 a[76:79], v[132:135], v[64:67], a[76:79]
  ds_read_b64_tr_b16 v[154:155], v15 offset:51200
  v_mfma_f32_16x16x32_bf16 v[196:199], v[132:135], v[68:71], v[196:199]
  v_mfma_f32_16x16x32_bf16 v[200:203], v[136:139], v[68:71], v[200:203]
  ds_read_b64_tr_b16 v[156:157], v32 offset:49152
  v_mfma_f32_16x16x32_bf16 a[80:83], v[136:139], v[64:67], a[80:83]
  ds_read_b64_tr_b16 v[158:159], v32 offset:51200
  v_mfma_f32_16x16x32_bf16 a[84:87], v[140:143], v[64:67], a[84:87]
  ds_read_b64_tr_b16 v[160:161], v33 offset:49152
  v_mfma_f32_16x16x32_bf16 v[204:207], v[140:143], v[68:71], v[204:207]
  ds_read_b64_tr_b16 v[162:163], v33 offset:51200
  v_mfma_f32_16x16x32_bf16 v[208:211], v[144:147], v[68:71], v[208:211]
  v_mfma_f32_16x16x32_bf16 a[88:91], v[144:147], v[64:67], a[88:91]
  ds_read_b64_tr_b16 v[164:165], v34 offset:49152
  v_mfma_f32_16x16x32_bf16 a[92:95], v[148:151], v[64:67], a[92:95]
  ds_read_b64_tr_b16 v[166:167], v34 offset:51200
  v_mfma_f32_16x16x32_bf16 v[212:215], v[148:151], v[68:71], v[212:215]
  ds_read_b64_tr_b16 v[168:169], v35 offset:49152
  v_mfma_f32_16x16x32_bf16 a[28:31], v[148:151], v[56:59], a[28:31]
  ds_read_b64_tr_b16 v[170:171], v35 offset:51200
  v_mfma_f32_16x16x32_bf16 a[60:63], v[148:151], v[60:63], a[60:63]
  v_mfma_f32_16x16x32_bf16 a[56:59], v[144:147], v[60:63], a[56:59]
  ds_read_b64_tr_b16 v[172:173], v36 offset:49152
  v_mfma_f32_16x16x32_bf16 a[24:27], v[144:147], v[56:59], a[24:27]
  ds_read_b64_tr_b16 v[174:175], v36 offset:51200
  v_mfma_f32_16x16x32_bf16 a[20:23], v[140:143], v[56:59], a[20:23]
  ds_read_b64_tr_b16 v[176:177], v37 offset:49152
  v_mfma_f32_16x16x32_bf16 a[52:55], v[140:143], v[60:63], a[52:55]
  ds_read_b64_tr_b16 v[178:179], v37 offset:51200
  v_mfma_f32_16x16x32_bf16 a[48:51], v[136:139], v[60:63], a[48:51]
  v_mfma_f32_16x16x32_bf16 a[16:19], v[136:139], v[56:59], a[16:19]
  ds_read_b64_tr_b16 v[180:181], v38 offset:49152
  v_mfma_f32_16x16x32_bf16 a[12:15], v[132:135], v[56:59], a[12:15]
  ds_read_b64_tr_b16 v[182:183], v38 offset:51200
  v_mfma_f32_16x16x32_bf16 a[44:47], v[132:135], v[60:63], a[44:47]
  v_mfma_f32_16x16x32_bf16 a[40:43], v[128:131], v[60:63], a[40:43]
  v_mfma_f32_16x16x32_bf16 a[8:11], v[128:131], v[56:59], a[8:11]
  v_mfma_f32_16x16x32_bf16 a[4:7], v[124:127], v[56:59], a[4:7]
  v_mfma_f32_16x16x32_bf16 a[36:39], v[124:127], v[60:63], a[36:39]
  v_mfma_f32_16x16x32_bf16 a[32:35], v[120:123], v[60:63], a[32:35]
  v_mfma_f32_16x16x32_bf16 a[0:3], v[120:123], v[56:59], a[0:3]
  v_mfma_f32_16x16x32_bf16 a[96:99], v[56:59], v[56:59], a[96:99]
  v_mfma_f32_16x16x32_bf16 a[100:103], v[60:63], v[60:63], a[100:103]
  s_waitcnt lgkmcnt(0)
  s_waitcnt vmcnt(7)
  s_barrier
  v_mfma_f32_16x16x32_bf16 v[216:219], v[104:107], v[88:91], v[216:219]
  ds_read_b128 v[56:59], v42 offset:0
  v_mfma_f32_16x16x32_bf16 v[220:223], v[108:111], v[88:91], v[220:223]
  ds_read_b128 v[60:63], v42 offset:1024
  v_mfma_f32_16x16x32_bf16 v[224:227], v[104:107], v[92:95], v[224:227]
  ds_read_b64_tr_b16 v[72:73], v44 offset:8192
  v_mfma_f32_16x16x32_bf16 v[228:231], v[108:111], v[92:95], v[228:231]
  ds_read_b64_tr_b16 v[74:75], v44 offset:8448
  v_mfma_f32_16x16x32_bf16 v[16:19], v[104:107], v[48:51], v[16:19]
  v_mfma_f32_16x16x32_bf16 v[20:23], v[108:111], v[48:51], v[20:23]
  ds_read_b64_tr_b16 v[76:77], v45 offset:8192
  v_mfma_f32_16x16x32_bf16 v[24:27], v[116:119], v[88:91], v[24:27]
  ds_read_b64_tr_b16 v[78:79], v45 offset:8448
  v_mfma_f32_16x16x32_bf16 v[28:31], v[116:119], v[92:95], v[28:31]
  ds_read_b128 v[84:87], v47 offset:768
  v_mfma_f32_16x16x32_bf16 v[232:235], v[112:115], v[48:51], v[232:235]
  ds_read_b64_tr_b16 v[80:81], v46 offset:10240
  v_mfma_f32_16x16x32_bf16 v[184:187], v[152:155], v[100:103], v[184:187]
  v_mfma_f32_16x16x32_bf16 a[64:67], v[152:155], v[96:99], a[64:67]
  ds_read_b64_tr_b16 v[82:83], v46 offset:10368
  v_mfma_f32_16x16x32_bf16 a[68:71], v[156:159], v[96:99], a[68:71]
  ds_read_b128 v[64:67], v43 offset:0
  v_mfma_f32_16x16x32_bf16 v[188:191], v[156:159], v[100:103], v[188:191]
  ds_read_b128 v[68:71], v43 offset:1024
  v_mfma_f32_16x16x32_bf16 v[192:195], v[160:163], v[100:103], v[192:195]
  ds_read_b64_tr_b16 v[120:121], v15 offset:0
  v_mfma_f32_16x16x32_bf16 a[72:75], v[160:163], v[96:99], a[72:75]
  v_mfma_f32_16x16x32_bf16 a[76:79], v[164:167], v[96:99], a[76:79]
  ds_read_b64_tr_b16 v[122:123], v15 offset:2048
  v_mfma_f32_16x16x32_bf16 v[196:199], v[164:167], v[100:103], v[196:199]
  ds_read_b64_tr_b16 v[124:125], v32 offset:0
  v_mfma_f32_16x16x32_bf16 v[200:203], v[168:171], v[100:103], v[200:203]
  ds_read_b64_tr_b16 v[126:127], v32 offset:2048
  v_mfma_f32_16x16x32_bf16 a[80:83], v[168:171], v[96:99], a[80:83]
  ds_read_b64_tr_b16 v[128:129], v33 offset:0
  v_mfma_f32_16x16x32_bf16 a[84:87], v[172:175], v[96:99], a[84:87]
  v_mfma_f32_16x16x32_bf16 v[204:207], v[172:175], v[100:103], v[204:207]
  ds_read_b64_tr_b16 v[130:131], v33 offset:2048
  v_mfma_f32_16x16x32_bf16 v[208:211], v[176:179], v[100:103], v[208:211]
  ds_read_b64_tr_b16 v[132:133], v34 offset:0
  v_mfma_f32_16x16x32_bf16 a[88:91], v[176:179], v[96:99], a[88:91]
  ds_read_b64_tr_b16 v[134:135], v34 offset:2048
  v_mfma_f32_16x16x32_bf16 a[92:95], v[180:183], v[96:99], a[92:95]
  ds_read_b64_tr_b16 v[136:137], v35 offset:0
  v_mfma_f32_16x16x32_bf16 v[212:215], v[180:183], v[100:103], v[212:215]
  v_mfma_f32_16x16x32_bf16 a[28:31], v[180:183], v[88:91], a[28:31]
  ds_read_b64_tr_b16 v[138:139], v35 offset:2048
  v_mfma_f32_16x16x32_bf16 a[60:63], v[180:183], v[92:95], a[60:63]
  ds_read_b64_tr_b16 v[140:141], v36 offset:0
  v_mfma_f32_16x16x32_bf16 a[56:59], v[176:179], v[92:95], a[56:59]
  ds_read_b64_tr_b16 v[142:143], v36 offset:2048
  v_mfma_f32_16x16x32_bf16 a[24:27], v[176:179], v[88:91], a[24:27]
  ds_read_b64_tr_b16 v[144:145], v37 offset:0
  v_mfma_f32_16x16x32_bf16 a[20:23], v[172:175], v[88:91], a[20:23]
  v_mfma_f32_16x16x32_bf16 a[52:55], v[172:175], v[92:95], a[52:55]
  ds_read_b64_tr_b16 v[146:147], v37 offset:2048
  v_mfma_f32_16x16x32_bf16 a[48:51], v[168:171], v[92:95], a[48:51]
  ds_read_b64_tr_b16 v[148:149], v38 offset:0
  v_mfma_f32_16x16x32_bf16 a[16:19], v[168:171], v[88:91], a[16:19]
  ds_read_b64_tr_b16 v[150:151], v38 offset:2048
  v_mfma_f32_16x16x32_bf16 a[12:15], v[164:167], v[88:91], a[12:15]
  v_mfma_f32_16x16x32_bf16 a[44:47], v[164:167], v[92:95], a[44:47]
  v_mfma_f32_16x16x32_bf16 a[40:43], v[160:163], v[92:95], a[40:43]
  v_mfma_f32_16x16x32_bf16 a[8:11], v[160:163], v[88:91], a[8:11]
  v_mfma_f32_16x16x32_bf16 a[4:7], v[156:159], v[88:91], a[4:7]
  v_mfma_f32_16x16x32_bf16 a[36:39], v[156:159], v[92:95], a[36:39]
  v_mfma_f32_16x16x32_bf16 a[32:35], v[152:155], v[92:95], a[32:35]
  v_mfma_f32_16x16x32_bf16 a[0:3], v[152:155], v[88:91], a[0:3]
  v_mfma_f32_16x16x32_bf16 a[96:99], v[88:91], v[88:91], a[96:99]
  v_mfma_f32_16x16x32_bf16 a[100:103], v[92:95], v[92:95], a[100:103]
  s_waitcnt lgkmcnt(0)
  s_waitcnt vmcnt(1)
  s_barrier
  v_mfma_f32_16x16x32_bf16 v[216:219], v[72:75], v[56:59], v[216:219]
  ds_read_b128 v[88:91], v42 offset:16384
  v_mfma_f32_16x16x32_bf16 v[220:223], v[76:79], v[56:59], v[220:223]
  ds_read_b128 v[92:95], v42 offset:17408
  v_mfma_f32_16x16x32_bf16 v[224:227], v[72:75], v[60:63], v[224:227]
  ds_read_b64_tr_b16 v[104:105], v44 offset:24576
  v_mfma_f32_16x16x32_bf16 v[228:231], v[76:79], v[60:63], v[228:231]
  ds_read_b64_tr_b16 v[106:107], v44 offset:24832
  v_mfma_f32_16x16x32_bf16 v[16:19], v[72:75], v[48:51], v[16:19]
  v_mfma_f32_16x16x32_bf16 v[20:23], v[76:79], v[48:51], v[20:23]
  ds_read_b64_tr_b16 v[108:109], v45 offset:24576
  v_mfma_f32_16x16x32_bf16 v[24:27], v[84:87], v[56:59], v[24:27]
  ds_read_b64_tr_b16 v[110:111], v45 offset:24832
  v_mfma_f32_16x16x32_bf16 v[28:31], v[84:87], v[60:63], v[28:31]
  ds_read_b128 v[116:119], v47 offset:832
  v_mfma_f32_16x16x32_bf16 v[232:235], v[80:83], v[48:51], v[232:235]
  ds_read_b64_tr_b16 v[112:113], v46 offset:26624
  v_mfma_f32_16x16x32_bf16 v[184:187], v[120:123], v[68:71], v[184:187]
  v_mfma_f32_16x16x32_bf16 a[64:67], v[120:123], v[64:67], a[64:67]
  ds_read_b64_tr_b16 v[114:115], v46 offset:26752
  v_mfma_f32_16x16x32_bf16 a[68:71], v[124:127], v[64:67], a[68:71]
  ds_read_b128 v[96:99], v43 offset:16384
  v_mfma_f32_16x16x32_bf16 v[188:191], v[124:127], v[68:71], v[188:191]
  ds_read_b128 v[100:103], v43 offset:17408
  v_mfma_f32_16x16x32_bf16 v[192:195], v[128:131], v[68:71], v[192:195]
  ds_read_b64_tr_b16 v[152:153], v15 offset:16384
  v_mfma_f32_16x16x32_bf16 a[72:75], v[128:131], v[64:67], a[72:75]
  v_mfma_f32_16x16x32_bf16 a[76:79], v[132:135], v[64:67], a[76:79]
  ds_read_b64_tr_b16 v[154:155], v15 offset:18432
  v_mfma_f32_16x16x32_bf16 v[196:199], v[132:135], v[68:71], v[196:199]
  ds_read_b64_tr_b16 v[156:157], v32 offset:16384
  v_mfma_f32_16x16x32_bf16 v[200:203], v[136:139], v[68:71], v[200:203]
  ds_read_b64_tr_b16 v[158:159], v32 offset:18432
  v_mfma_f32_16x16x32_bf16 a[80:83], v[136:139], v[64:67], a[80:83]
  ds_read_b64_tr_b16 v[160:161], v33 offset:16384
  v_mfma_f32_16x16x32_bf16 a[84:87], v[140:143], v[64:67], a[84:87]
  v_mfma_f32_16x16x32_bf16 v[204:207], v[140:143], v[68:71], v[204:207]
  ds_read_b64_tr_b16 v[162:163], v33 offset:18432
  v_mfma_f32_16x16x32_bf16 v[208:211], v[144:147], v[68:71], v[208:211]
  ds_read_b64_tr_b16 v[164:165], v34 offset:16384
  v_mfma_f32_16x16x32_bf16 a[88:91], v[144:147], v[64:67], a[88:91]
  ds_read_b64_tr_b16 v[166:167], v34 offset:18432
  v_mfma_f32_16x16x32_bf16 a[92:95], v[148:151], v[64:67], a[92:95]
  ds_read_b64_tr_b16 v[168:169], v35 offset:16384
  v_mfma_f32_16x16x32_bf16 v[212:215], v[148:151], v[68:71], v[212:215]
  v_mfma_f32_16x16x32_bf16 a[28:31], v[148:151], v[56:59], a[28:31]
  ds_read_b64_tr_b16 v[170:171], v35 offset:18432
  v_mfma_f32_16x16x32_bf16 a[60:63], v[148:151], v[60:63], a[60:63]
  ds_read_b64_tr_b16 v[172:173], v36 offset:16384
  v_mfma_f32_16x16x32_bf16 a[56:59], v[144:147], v[60:63], a[56:59]
  ds_read_b64_tr_b16 v[174:175], v36 offset:18432
  v_mfma_f32_16x16x32_bf16 a[24:27], v[144:147], v[56:59], a[24:27]
  ds_read_b64_tr_b16 v[176:177], v37 offset:16384
  v_mfma_f32_16x16x32_bf16 a[20:23], v[140:143], v[56:59], a[20:23]
  v_mfma_f32_16x16x32_bf16 a[52:55], v[140:143], v[60:63], a[52:55]
  ds_read_b64_tr_b16 v[178:179], v37 offset:18432
  v_mfma_f32_16x16x32_bf16 a[48:51], v[136:139], v[60:63], a[48:51]
  ds_read_b64_tr_b16 v[180:181], v38 offset:16384
  v_mfma_f32_16x16x32_bf16 a[16:19], v[136:139], v[56:59], a[16:19]
  ds_read_b64_tr_b16 v[182:183], v38 offset:18432
  v_mfma_f32_16x16x32_bf16 a[12:15], v[132:135], v[56:59], a[12:15]
  v_mfma_f32_16x16x32_bf16 a[44:47], v[132:135], v[60:63], a[44:47]
  v_mfma_f32_16x16x32_bf16 a[40:43], v[128:131], v[60:63], a[40:43]
  v_mfma_f32_16x16x32_bf16 a[8:11], v[128:131], v[56:59], a[8:11]
  v_mfma_f32_16x16x32_bf16 a[4:7], v[124:127], v[56:59], a[4:7]
  v_mfma_f32_16x16x32_bf16 a[36:39], v[124:127], v[60:63], a[36:39]
  v_mfma_f32_16x16x32_bf16 a[32:35], v[120:123], v[60:63], a[32:35]
  v_mfma_f32_16x16x32_bf16 a[0:3], v[120:123], v[56:59], a[0:3]
  v_mfma_f32_16x16x32_bf16 a[96:99], v[56:59], v[56:59], a[96:99]
  v_mfma_f32_16x16x32_bf16 a[100:103], v[60:63], v[60:63], a[100:103]
  s_waitcnt lgkmcnt(0)
  s_cmp_lg_u32 s19, 0
  s_cbranch_scc1 Lk_go29
  s_waitcnt vmcnt(0)
  v_cmp_lt_u32 vcc, v10, v7
  s_nop 4
  s_cbranch_vccz Lk_go29
  s_mov_b32 s43, 0
Lk_poll28:
  s_sleep 3
  buffer_load_dword v10, v6, s[20:23], 0 offen offset:0 sc1
  s_waitcnt vmcnt(0)
  v_cmp_lt_u32 vcc, v10, v7
  s_nop 4
  s_cbranch_vccz Lk_go29
  s_add_u32 s43, s43, 1
  s_cmp_lt_u32 s43, 0x40000
  s_cbranch_scc1 Lk_poll28
Lk_go29:
  s_mov_b32 s50, s17
  s_cmp_eq_u32 s44, 7
  s_cselect_b32 s32, 32, s72
  s_and_b32 s78, s32, 1
  s_lshl_b32 s3, s32, 14
  s_sub_u32 s76, s10, 245760
  s_cmp_ge_u32 s44, 7
  s_cbranch_scc1 Lk_sp30
  s_xor_b32 s78, s78, 1
  s_lshl_b32 s76, s50, 20
  s_add_u32 s76, s76, s3
  s_lshl_b32 s3, s44, 2
  s_add_u32 s3, s3, 5
  s_lshl_b32 s3, s3, 14
Lk_sp30:
  s_add_u32 s3, s3, s69
  s_lshl_b32 s68, s78, 15
  s_add_u32 s68, s68, s34
  s_cmp_eq_u32 s78, 0
  s_cselect_b32 s39, s70, s71
  s_cselect_b32 s38, s71, s70
  s_cselect_b32 s77, 0x10000, 0
  s_add_u32 s77, s77, s34
  s_barrier
  v_mfma_f32_16x16x32_bf16 v[216:219], v[104:107], v[88:91], v[216:219]
  s_mov_b32 m0, s68
  v_mfma_f32_16x16x32_bf16 v[220:223], v[108:111], v[88:91], v[220:223]
  buffer_load_dwordx4 v9, s[8:11], s69 offen offset:0 sc1 lds
  v_mfma_f32_16x16x32_bf16 v[224:227], v[104:107], v[92:95], v[224:227]
  v_mfma_f32_16x16x32_bf16 v[228:231], v[108:111], v[92:95], v[228:231]
  v_mfma_f32_16x16x32_bf16 v[16:19], v[104:107], v[48:51], v[16:19]
  v_mfma_f32_16x16x32_bf16 v[20:23], v[108:111], v[48:51], v[20:23]
  buffer_load_dwordx4 v9, s[8:11], s69 offen offset:1024 sc1 lds
  v_mfma_f32_16x16x32_bf16 v[24:27], v[116:119], v[88:91], v[24:27]
  v_mfma_f32_16x16x32_bf16 v[28:31], v[116:119], v[92:95], v[28:31]
  v_mfma_f32_16x16x32_bf16 v[232:235], v[112:115], v[48:51], v[232:235]
  v_mfma_f32_16x16x32_bf16 v[184:187], v[152:155], v[100:103], v[184:187]
  buffer_load_dwordx4 v9, s[8:11], s69 offen offset:2048 sc1 lds
  v_mfma_f32_16x16x32_bf16 a[64:67], v[152:155], v[96:99], a[64:67]
  v_mfma_f32_16x16x32_bf16 a[68:71], v[156:159], v[96:99], a[68:71]
  v_mfma_f32_16x16x32_bf16 v[188:191], v[156:159], v[100:103], v[188:191]
  v_mfma_f32_16x16x32_bf16 v[192:195], v[160:163], v[100:103], v[192:195]
  buffer_load_dwordx4 v9, s[8:11], s69 offen offset:3072 sc1 lds
  v_mfma_f32_16x16x32_bf16 a[72:75], v[160:163], v[96:99], a[72:75]
  s_add_u32 m0, s68, 0x8000
  v_mfma_f32_16x16x32_bf16 a[76:79], v[164:167], v[96:99], a[76:79]
  v_mfma_f32_16x16x32_bf16 v[196:199], v[164:167], v[100:103], v[196:199]
  v_mfma_f32_16x16x32_bf16 v[200:203], v[168:171], v[100:103], v[200:203]
  buffer_load_dwordx4 v9, s[8:11], s70 offen offset:0 sc1 lds
  v_mfma_f32_16x16x32_bf16 a[80:83], v[168:171], v[96:99], a[80:83]
  v_mfma_f32_16x16x32_bf16 a[84:87], v[172:175], v[96:99], a[84:87]
  v_mfma_f32_16x16x32_bf16 v[204:207], v[172:175], v[100:103], v[204:207]
  v_mfma_f32_16x16x32_bf16 v[208:211], v[176:179], v[100:103], v[208:211]
  buffer_load_dwordx4 v9, s[8:11], s70 offen offset:1024 sc1 lds
  v_mfma_f32_16x16x32_bf16 a[88:91], v[176:179], v[96:99], a[88:91]
  v_mfma_f32_16x16x32_bf16 a[92:95], v[180:183], v[96:99], a[92:95]
  v_mfma_f32_16x16x32_bf16 v[212:215], v[180:183], v[100:103], v[212:215]
  v_mfma_f32_16x16x32_bf16 a[28:31], v[180:183], v[88:91], a[28:31]
  buffer_load_dwordx4 v9, s[8:11], s70 offen offset:2048 sc1 lds
  v_mfma_f32_16x16x32_bf16 a[60:63], v[180:183], v[92:95], a[60:63]
  v_mfma_f32_16x16x32_bf16 a[56:59], v[176:179], v[92:95], a[56:59]
  v_mfma_f32_16x16x32_bf16 a[24:27], v[176:179], v[88:91], a[24:27]
  v_mfma_f32_16x16x32_bf16 a[20:23], v[172:175], v[88:91], a[20:23]
  buffer_load_dwordx4 v9, s[8:11], s70 offen offset:3072 sc1 lds
  v_mfma_f32_16x16x32_bf16 a[52:55], v[172:175], v[92:95], a[52:55]
  s_add_u32 m0, s68, 0x14000
  v_mfma_f32_16x16x32_bf16 a[48:51], v[168:171], v[92:95], a[48:51]
  v_mfma_f32_16x16x32_bf16 a[16:19], v[168:171], v[88:91], a[16:19]
  v_mfma_f32_16x16x32_bf16 a[12:15], v[164:167], v[88:91], a[12:15]
  v_mfma_f32_16x16x32_bf16 a[44:47], v[164:167], v[92:95], a[44:47]
  v_mfma_f32_16x16x32_bf16 a[40:43], v[160:163], v[92:95], a[40:43]
  v_mfma_f32_16x16x32_bf16 a[8:11], v[160:163], v[88:91], a[8:11]
  v_mfma_f32_16x16x32_bf16 a[4:7], v[156:159], v[88:91], a[4:7]
  v_mfma_f32_16x16x32_bf16 a[36:39], v[156:159], v[92:95], a[36:39]
  v_mfma_f32_16x16x32_bf16 a[32:35], v[152:155], v[92:95], a[32:35]
  v_mfma_f32_16x16x32_bf16 a[0:3], v[152:155], v[88:91], a[0:3]
  v_mfma_f32_16x16x32_bf16 a[96:99], v[88:91], v[88:91], a[96:99]
  v_mfma_f32_16x16x32_bf16 a[100:103], v[92:95], v[92:95], a[100:103]
  v_mov_b32 v120, 0x3db8aa3b
  v_mov_b32 v121, 0x3db8aa3b
  s_xor_b32 s32, s46, 1
  s_lshl_b32 s32, s32, 13
  s_lshl_b32 s33, s45, 15
  s_add_u32 s32, s32, s33
  s_add_u32 s32, s32, 0x4000
  v_add_u32 v5, s32, v52
  v_pk_mul_f32 v[184:185], v[184:185], v[120:121]
  v_pk_mul_f32 v[186:187], v[186:187], v[120:121]
  v_pk_mul_f32 v[188:189], v[188:189], v[120:121]
  v_pk_mul_f32 v[190:191], v[190:191], v[120:121]
  v_cvt_pk_bf16_f32 v104, v184, v185
  v_cvt_pk_bf16_f32 v105, v186, v187
  v_cvt_pk_bf16_f32 v106, v188, v189
  v_cvt_pk_bf16_f32 v107, v190, v191
  ds_write_b128 v5, v[104:107] offset:4096
  v_pk_mul_f32 v[192:193], v[192:193], v[120:121]
  v_pk_mul_f32 v[194:195], v[194:195], v[120:121]
  v_pk_mul_f32 v[196:197], v[196:197], v[120:121]
  v_pk_mul_f32 v[198:199], v[198:199], v[120:121]
  v_cvt_pk_bf16_f32 v108, v192, v193
  v_cvt_pk_bf16_f32 v109, v194, v195
  v_cvt_pk_bf16_f32 v110, v196, v197
  v_cvt_pk_bf16_f32 v111, v198, v199
  ds_write_b128 v5, v[108:111] offset:5120
  v_pk_mul_f32 v[200:201], v[200:201], v[120:121]
  v_pk_mul_f32 v[202:203], v[202:203], v[120:121]
  v_pk_mul_f32 v[204:205], v[204:205], v[120:121]
  v_pk_mul_f32 v[206:207], v[206:207], v[120:121]
  v_cvt_pk_bf16_f32 v112, v200, v201
  v_cvt_pk_bf16_f32 v113, v202, v203
  v_cvt_pk_bf16_f32 v114, v204, v205
  v_cvt_pk_bf16_f32 v115, v206, v207
  ds_write_b128 v5, v[112:115] offset:6144
  v_pk_mul_f32 v[208:209], v[208:209], v[120:121]
  v_pk_mul_f32 v[210:211], v[210:211], v[120:121]
  v_pk_mul_f32 v[212:213], v[212:213], v[120:121]
  v_pk_mul_f32 v[214:215], v[214:215], v[120:121]
  v_cvt_pk_bf16_f32 v116, v208, v209
  v_cvt_pk_bf16_f32 v117, v210, v211
  v_cvt_pk_bf16_f32 v118, v212, v213
  v_cvt_pk_bf16_f32 v119, v214, v215
  ds_write_b128 v5, v[116:119] offset:7168
  v_accvgpr_read_b32 v128, a64
  v_accvgpr_read_b32 v129, a65
  v_accvgpr_read_b32 v130, a66
  v_accvgpr_read_b32 v131, a67
  v_accvgpr_read_b32 v132, a68
  v_accvgpr_read_b32 v133, a69
  v_accvgpr_read_b32 v134, a70
  v_accvgpr_read_b32 v135, a71
  v_pk_mul_f32 v[128:129], v[128:129], v[120:121]
  v_pk_mul_f32 v[130:131], v[130:131], v[120:121]
  v_pk_mul_f32 v[132:133], v[132:133], v[120:121]
  v_pk_mul_f32 v[134:135], v[134:135], v[120:121]
  v_cvt_pk_bf16_f32 v88, v128, v129
  v_cvt_pk_bf16_f32 v89, v130, v131
  v_cvt_pk_bf16_f32 v90, v132, v133
  v_cvt_pk_bf16_f32 v91, v134, v135
  ds_write_b128 v5, v[88:91] offset:0
  v_accvgpr_read_b32 v136, a72
  v_accvgpr_read_b32 v137, a73
  v_accvgpr_read_b32 v138, a74
  v_accvgpr_read_b32 v139, a75
  v_accvgpr_read_b32 v140, a76
  v_accvgpr_read_b32 v141, a77
  v_accvgpr_read_b32 v142, a78
  v_accvgpr_read_b32 v143, a79
  v_pk_mul_f32 v[136:137], v[136:137], v[120:121]
  v_pk_mul_f32 v[138:139], v[138:139], v[120:121]
  v_pk_mul_f32 v[140:141], v[140:141], v[120:121]
  v_pk_mul_f32 v[142:143], v[142:143], v[120:121]
  v_cvt_pk_bf16_f32 v92, v136, v137
  v_cvt_pk_bf16_f32 v93, v138, v139
  v_cvt_pk_bf16_f32 v94, v140, v141
  v_cvt_pk_bf16_f32 v95, v142, v143
  ds_write_b128 v5, v[92:95] offset:1024
  v_accvgpr_read_b32 v128, a80
  v_accvgpr_read_b32 v129, a81
  v_accvgpr_read_b32 v130, a82
  v_accvgpr_read_b32 v131, a83
  v_accvgpr_read_b32 v132, a84
  v_accvgpr_read_b32 v133, a85
  v_accvgpr_read_b32 v134, a86
  v_accvgpr_read_b32 v135, a87
  v_pk_mul_f32 v[128:129], v[128:129], v[120:121]
  v_pk_mul_f32 v[130:131], v[130:131], v[120:121]
  v_pk_mul_f32 v[132:133], v[132:133], v[120:121]
  v_pk_mul_f32 v[134:135], v[134:135], v[120:121]
  v_cvt_pk_bf16_f32 v96, v128, v129
  v_cvt_pk_bf16_f32 v97, v130, v131
  v_cvt_pk_bf16_f32 v98, v132, v133
  v_cvt_pk_bf16_f32 v99, v134, v135
  ds_write_b128 v5, v[96:99] offset:2048
  v_accvgpr_read_b32 v136, a88
  v_accvgpr_read_b32 v137, a89
  v_accvgpr_read_b32 v138, a90
  v_accvgpr_read_b32 v139, a91
  v_accvgpr_read_b32 v140, a92
  v_accvgpr_read_b32 v141, a93
  v_accvgpr_read_b32 v142, a94
  v_accvgpr_read_b32 v143, a95
  v_pk_mul_f32 v[136:137], v[136:137], v[120:121]
  v_pk_mul_f32 v[138:139], v[138:139], v[120:121]
  v_pk_mul_f32 v[140:141], v[140:141], v[120:121]
  v_pk_mul_f32 v[142:143], v[142:143], v[120:121]
  v_cvt_pk_bf16_f32 v100, v136, v137
  v_cvt_pk_bf16_f32 v101, v138, v139
  v_cvt_pk_bf16_f32 v102, v140, v141
  v_cvt_pk_bf16_f32 v103, v142, v143
  ds_write_b128 v5, v[100:103] offset:3072
  v_accvgpr_read_b32 v128, a0
  v_accvgpr_read_b32 v129, a1
  v_accvgpr_read_b32 v130, a2
  v_accvgpr_read_b32 v131, a3
  v_accvgpr_read_b32 v132, a4
  v_accvgpr_read_b32 v133, a5
  v_accvgpr_read_b32 v134, a6
  v_accvgpr_read_b32 v135, a7
  v_pk_mul_f32 v[128:129], v[128:129], v[120:121]
  v_pk_mul_f32 v[130:131], v[130:131], v[120:121]
  v_pk_mul_f32 v[132:133], v[132:133], v[120:121]
  v_pk_mul_f32 v[134:135], v[134:135], v[120:121]
  v_cvt_pk_bf16_f32 v56, v128, v129
  v_cvt_pk_bf16_f32 v57, v130, v131
  v_cvt_pk_bf16_f32 v58, v132, v133
  v_cvt_pk_bf16_f32 v59, v134, v135
  v_accvgpr_read_b32 v136, a8
  v_accvgpr_read_b32 v137, a9
  v_accvgpr_read_b32 v138, a10
  v_accvgpr_read_b32 v139, a11
  v_accvgpr_read_b32 v140, a12
  v_accvgpr_read_b32 v141, a13
  v_accvgpr_read_b32 v142, a14
  v_accvgpr_read_b32 v143, a15
  v_pk_mul_f32 v[136:137], v[136:137], v[120:121]
  v_pk_mul_f32 v[138:139], v[138:139], v[120:121]
  v_pk_mul_f32 v[140:141], v[140:141], v[120:121]
  v_pk_mul_f32 v[142:143], v[142:143], v[120:121]
  v_cvt_pk_bf16_f32 v60, v136, v137
  v_cvt_pk_bf16_f32 v61, v138, v139
  v_cvt_pk_bf16_f32 v62, v140, v141
  v_cvt_pk_bf16_f32 v63, v142, v143
  s_waitcnt lgkmcnt(0)
  s_barrier
  v_accvgpr_read_b32 v128, a16
  v_accvgpr_read_b32 v129, a17
  v_accvgpr_read_b32 v130, a18
  v_accvgpr_read_b32 v131, a19
  v_accvgpr_read_b32 v132, a20
  v_accvgpr_read_b32 v133, a21
  v_accvgpr_read_b32 v134, a22
  v_accvgpr_read_b32 v135, a23
  v_pk_mul_f32 v[128:129], v[128:129], v[120:121]
  v_pk_mul_f32 v[130:131], v[130:131], v[120:121]
  v_pk_mul_f32 v[132:133], v[132:133], v[120:121]
  v_pk_mul_f32 v[134:135], v[134:135], v[120:121]
  v_cvt_pk_bf16_f32 v64, v128, v129
  v_cvt_pk_bf16_f32 v65, v130, v131
  v_cvt_pk_bf16_f32 v66, v132, v133
  v_cvt_pk_bf16_f32 v67, v134, v135
  v_accvgpr_read_b32 v136, a24
  v_accvgpr_read_b32 v137, a25
  v_accvgpr_read_b32 v138, a26
  v_accvgpr_read_b32 v139, a27
  v_accvgpr_read_b32 v140, a28
  v_accvgpr_read_b32 v141, a29
  v_accvgpr_read_b32 v142, a30
  v_accvgpr_read_b32 v143, a31
  v_pk_mul_f32 v[136:137], v[136:137], v[120:121]
  v_pk_mul_f32 v[138:139], v[138:139], v[120:121]
  v_pk_mul_f32 v[140:141], v[140:141], v[120:121]
  v_pk_mul_f32 v[142:143], v[142:143], v[120:121]
  v_cvt_pk_bf16_f32 v68, v136, v137
  v_cvt_pk_bf16_f32 v69, v138, v139
  v_cvt_pk_bf16_f32 v70, v140, v141
  v_cvt_pk_bf16_f32 v71, v142, v143
  v_accvgpr_read_b32 v128, a32
  v_accvgpr_read_b32 v129, a33
  v_accvgpr_read_b32 v130, a34
  v_accvgpr_read_b32 v131, a35
  v_accvgpr_read_b32 v132, a36
  v_accvgpr_read_b32 v133, a37
  v_accvgpr_read_b32 v134, a38
  v_accvgpr_read_b32 v135, a39
  v_pk_mul_f32 v[128:129], v[128:129], v[120:121]
  v_pk_mul_f32 v[130:131], v[130:131], v[120:121]
  v_pk_mul_f32 v[132:133], v[132:133], v[120:121]
  v_pk_mul_f32 v[134:135], v[134:135], v[120:121]
  v_cvt_pk_bf16_f32 v72, v128, v129
  v_cvt_pk_bf16_f32 v73, v130, v131
  v_cvt_pk_bf16_f32 v74, v132, v133
  v_cvt_pk_bf16_f32 v75, v134, v135
  v_accvgpr_read_b32 v136, a40
  v_accvgpr_read_b32 v137, a41
  v_accvgpr_read_b32 v138, a42
  v_accvgpr_read_b32 v139, a43
  v_accvgpr_read_b32 v140, a44
  v_accvgpr_read_b32 v141, a45
  v_accvgpr_read_b32 v142, a46
  v_accvgpr_read_b32 v143, a47
  v_pk_mul_f32 v[136:137], v[136:137], v[120:121]
  v_pk_mul_f32 v[138:139], v[138:139], v[120:121]
  v_pk_mul_f32 v[140:141], v[140:141], v[120:121]
  v_pk_mul_f32 v[142:143], v[142:143], v[120:121]
  v_cvt_pk_bf16_f32 v76, v136, v137
  v_cvt_pk_bf16_f32 v77, v138, v139
  v_cvt_pk_bf16_f32 v78, v140, v141
  v_cvt_pk_bf16_f32 v79, v142, v143
  v_accvgpr_read_b32 v128, a48
  v_accvgpr_read_b32 v129, a49
  v_accvgpr_read_b32 v130, a50
  v_accvgpr_read_b32 v131, a51
  v_accvgpr_read_b32 v132, a52
  v_accvgpr_read_b32 v133, a53
  v_accvgpr_read_b32 v134, a54
  v_accvgpr_read_b32 v135, a55
  v_pk_mul_f32 v[128:129], v[128:129], v[120:121]
  v_pk_mul_f32 v[130:131], v[130:131], v[120:121]
  v_pk_mul_f32 v[132:133], v[132:133], v[120:121]
  v_pk_mul_f32 v[134:135], v[134:135], v[120:121]
  v_cvt_pk_bf16_f32 v80, v128, v129
  v_cvt_pk_bf16_f32 v81, v130, v131
  v_cvt_pk_bf16_f32 v82, v132, v133
  v_cvt_pk_bf16_f32 v83, v134, v135
  v_accvgpr_read_b32 v136, a56
  v_accvgpr_read_b32 v137, a57
  v_accvgpr_read_b32 v138, a58
  v_accvgpr_read_b32 v139, a59
  v_accvgpr_read_b32 v140, a60
  v_accvgpr_read_b32 v141, a61
  v_accvgpr_read_b32 v142, a62
  v_accvgpr_read_b32 v143, a63
  v_pk_mul_f32 v[136:137], v[136:137], v[120:121]
  v_pk_mul_f32 v[138:139], v[138:139], v[120:121]
  v_pk_mul_f32 v[140:141], v[140:141], v[120:121]
  v_pk_mul_f32 v[142:143], v[142:143], v[120:121]
  v_cvt_pk_bf16_f32 v84, v136, v137
  v_cvt_pk_bf16_f32 v85, v138, v139
  v_cvt_pk_bf16_f32 v86, v140, v141
  v_cvt_pk_bf16_f32 v87, v142, v143
Lk_qj19:
  v_xor_b32 v5, 0x2000, v5
  s_cmp_eq_u32 s46, 1
  s_cbranch_scc1 Lk_wn32
  ds_read_b128 a[16:19], v5 offset:0
  ds_read_b128 a[20:23], v5 offset:1024
  ds_read_b128 a[24:27], v5 offset:2048
  ds_read_b128 a[28:31], v5 offset:3072
  ds_read_b128 a[48:51], v5 offset:4096
  ds_read_b128 a[52:55], v5 offset:5120
  ds_read_b128 a[56:59], v5 offset:6144
  ds_read_b128 a[60:63], v5 offset:7168
  v_accvgpr_write_b32 a0, v56
  v_accvgpr_write_b32 a1, v57
  v_accvgpr_write_b32 a2, v58
  v_accvgpr_write_b32 a3, v59
  v_accvgpr_write_b32 a4, v60
  v_accvgpr_write_b32 a5, v61
  v_accvgpr_write_b32 a6, v62
  v_accvgpr_write_b32 a7, v63
  v_accvgpr_write_b32 a8, v64
  v_accvgpr_write_b32 a9, v65
  v_accvgpr_write_b32 a10, v66
  v_accvgpr_write_b32 a11, v67
  v_accvgpr_write_b32 a12, v68
  v_accvgpr_write_b32 a13, v69
  v_accvgpr_write_b32 a14, v70
  v_accvgpr_write_b32 a15, v71
  v_accvgpr_write_b32 a32, v72
  v_accvgpr_write_b32 a33, v73
  v_accvgpr_write_b32 a34, v74
  v_accvgpr_write_b32 a35, v75
  v_accvgpr_write_b32 a36, v76
  v_accvgpr_write_b32 a37, v77
  v_accvgpr_write_b32 a38, v78
  v_accvgpr_write_b32 a39, v79
  v_accvgpr_write_b32 a40, v80
  v_accvgpr_write_b32 a41, v81
  v_accvgpr_write_b32 a42, v82
  v_accvgpr_write_b32 a43, v83
  v_accvgpr_write_b32 a44, v84
  v_accvgpr_write_b32 a45, v85
  v_accvgpr_write_b32 a46, v86
  v_accvgpr_write_b32 a47, v87
  s_branch Lk_qd31
Lk_wn32:
  ds_read_b128 a[0:3], v5 offset:0
  ds_read_b128 a[4:7], v5 offset:1024
  ds_read_b128 a[8:11], v5 offset:2048
  ds_read_b128 a[12:15], v5 offset:3072
  ds_read_b128 a[32:35], v5 offset:4096
  ds_read_b128 a[36:39], v5 offset:5120
  ds_read_b128 a[40:43], v5 offset:6144
  ds_read_b128 a[44:47], v5 offset:7168
  v_accvgpr_write_b32 a16, v56
  v_accvgpr_write_b32 a17, v57
  v_accvgpr_write_b32 a18, v58
  v_accvgpr_write_b32 a19, v59
  v_accvgpr_write_b32 a20, v60
  v_accvgpr_write_b32 a21, v61
  v_accvgpr_write_b32 a22, v62
  v_accvgpr_write_b32 a23, v63
  v_accvgpr_write_b32 a24, v64
  v_accvgpr_write_b32 a25, v65
  v_accvgpr_write_b32 a26, v66
  v_accvgpr_write_b32 a27, v67
  v_accvgpr_write_b32 a28, v68
  v_accvgpr_write_b32 a29, v69
  v_accvgpr_write_b32 a30, v70
  v_accvgpr_write_b32 a31, v71
  v_accvgpr_write_b32 a48, v72
  v_accvgpr_write_b32 a49, v73
  v_accvgpr_write_b32 a50, v74
  v_accvgpr_write_b32 a51, v75
  v_accvgpr_write_b32 a52, v76
  v_accvgpr_write_b32 a53, v77
  v_accvgpr_write_b32 a54, v78
  v_accvgpr_write_b32 a55, v79
  v_accvgpr_write_b32 a56, v80
  v_accvgpr_write_b32 a57, v81
  v_accvgpr_write_b32 a58, v82
  v_accvgpr_write_b32 a59, v83
  v_accvgpr_write_b32 a60, v84
  v_accvgpr_write_b32 a61, v85
  v_accvgpr_write_b32 a62, v86
  v_accvgpr_write_b32 a63, v87
Lk_qd31:
  s_lshl_b32 s40, s17, 20
  s_add_u32 s40, s40, 0x7000000
  s_lshl_b32 s41, s44, 16
  s_add_u32 s40, s40, s41
  s_lshl_b32 s41, s45, 15
  s_add_u32 s40, s40, s41
  s_lshl_b32 s41, s46, 12
  s_add_u32 s40, s40, s41
  s_cmp_le_u32 s44, 8
  s_cselect_b32 s40, 0x10000000, s40
  s_lshl_b32 s41, s46, 14
  s_add_u32 s36, s40, s41
  s_add_u32 s37, s36, 8192
  s_xor_b32 s41, s41, 0x4000
  s_add_u32 s48, s40, s41
  s_add_u32 s49, s48, 8192
  buffer_store_dwordx4 v[56:59], v52, s[28:31], s36 offen offset:0 sc1
  buffer_store_dwordx4 v[60:63], v52, s[28:31], s36 offen offset:1024 sc1
  buffer_store_dwordx4 v[64:67], v52, s[28:31], s36 offen offset:2048 sc1
  buffer_store_dwordx4 v[68:71], v52, s[28:31], s36 offen offset:3072 sc1
  v_accvgpr_read_b32 v236, a96
  v_accvgpr_read_b32 v237, a97
  v_accvgpr_read_b32 v238, a98
  v_accvgpr_read_b32 v239, a99
  v_accvgpr_read_b32 v240, a100
  v_accvgpr_read_b32 v241, a101
  v_accvgpr_read_b32 v242, a102
  v_accvgpr_read_b32 v243, a103
  v_lshrrev_b32 v2, 4, v1
  s_cmp_ge_u32 s2, 112
  s_cbranch_scc1 Lk_n333
  s_cmp_lg_u32 s19, 0
  s_cbranch_scc1 Lk_n333
  v_and_b32 v4, 1, v1
  v_lshlrev_b32 v4, 6, v4
  v_lshl_add_u32 v3, v2, 4, v4
  s_and_b32 s32, s2, 7
  s_mul_i32 s32, s32, 14
  s_lshr_b32 s33, s2, 3
  s_add_u32 s32, s32, s33
  s_lshl_b32 s32, s32, 7
  s_add_u32 s32, s32, 0x4e00000
  buffer_store_dwordx4 v[232:235], v3, s[28:31], s32 offen sc1
Lk_n333:
  v_and_b32 v3, 15, v1
  s_lshl_b32 s32, s44, 7
  s_lshl_b32 s33, s19, 5
  s_add_u32 s32, s32, s33
  v_add_u32 v3, s32, v3
  v_mul_f32 v25, 0xbfb8aa3b, v25
  v_mul_f32 v29, 0xbfb8aa3b, v29
  v_exp_f32 v25, v25
  v_exp_f32 v29, v29
  v_add_f32 v25, 1.0, v25
  v_add_f32 v29, 1.0, v29
  v_rcp_f32 v25, v25
  v_rcp_f32 v29, v29
  v_accvgpr_write_b32 a128, v25
  v_accvgpr_write_b32 a129, v29
  s_cmp_lt_u32 s17, 14
  s_cbranch_scc1 Lk_h34
  buffer_store_dwordx4 v[72:75], v52, s[28:31], s37 offen offset:0 sc1
  buffer_store_dwordx4 v[76:79], v52, s[28:31], s37 offen offset:1024 sc1
  buffer_store_dwordx4 v[80:83], v52, s[28:31], s37 offen offset:2048 sc1
  buffer_store_dwordx4 v[84:87], v52, s[28:31], s37 offen offset:3072 sc1
  buffer_store_dwordx4 v[88:91], v52, s[28:31], s48 offen offset:0 sc1
  buffer_store_dwordx4 v[92:95], v52, s[28:31], s48 offen offset:1024 sc1
  buffer_store_dwordx4 v[96:99], v52, s[28:31], s48 offen offset:2048 sc1
  buffer_store_dwordx4 v[100:103], v52, s[28:31], s48 offen offset:3072 sc1
  buffer_store_dwordx4 v[104:107], v52, s[28:31], s49 offen offset:0 sc1
  buffer_store_dwordx4 v[108:111], v52, s[28:31], s49 offen offset:1024 sc1
  buffer_store_dwordx4 v[112:115], v52, s[28:31], s49 offen offset:2048 sc1
  buffer_store_dwordx4 v[116:119], v52, s[28:31], s49 offen offset:3072 sc1
  s_cmp_lg_u32 s17, 14
  s_cbranch_scc1 Lk_fin35
  v_lshlrev_b32 v3, 2, v3
  s_mov_b32 s32, 0x4c00000
  buffer_store_dword v25, v3, s[28:31], s32 offen offset:0 sc1
  buffer_store_dword v29, v3, s[28:31], s32 offen offset:64 sc1
  s_branch Lk_fin35
Lk_h34:
  v_lshlrev_b32 v3, 4, v3
  v_bfe_u32 v4, v1, 4, 1
  v_lshrrev_b32 v5, 5, v1
  v_lshl_add_u32 v4, v4, 1, v5
  v_mul_u32_u24 v4, 32896, v4
  v_add_u32 v3, v3, v4
  v_lshlrev_b32 v2, 2, v2
  v_and_b32 v4, 15, v1
  v_sub_u32 v4, v4, v2
  v_mov_b32 v32, 0
  v_mov_b32 v33, 0
  v_cmp_eq_u32 vcc, 0, v4
  s_nop 1
  v_cndmask_b32 v32, v32, v236, vcc
  v_cndmask_b32 v33, v33, v240, vcc
  v_cmp_eq_u32 vcc, 1, v4
  s_nop 1
  v_cndmask_b32 v32, v32, v237, vcc
  v_cndmask_b32 v33, v33, v241, vcc
  v_cmp_eq_u32 vcc, 2, v4
  s_nop 1
  v_cndmask_b32 v32, v32, v238, vcc
  v_cndmask_b32 v33, v33, v242, vcc
  v_cmp_eq_u32 vcc, 3, v4
  s_nop 1
  v_cndmask_b32 v32, v32, v239, vcc
  v_cndmask_b32 v33, v33, v243, vcc
  buffer_store_dwordx4 v[72:75], v52, s[28:31], s37 offen offset:0 sc1
  buffer_store_dwordx4 v[76:79], v52, s[28:31], s37 offen offset:1024 sc1
  v_mov_b32 v2, v32
  v_mov_b32 v4, v33
  s_nop 0
  v_permlane32_swap_b32 v32, v2
  v_permlane32_swap_b32 v33, v4
  v_add_f32 v32, v32, v2
  v_add_f32 v33, v33, v4
  v_mov_b32 v2, v32
  v_mov_b32 v4, v33
  s_nop 0
  v_permlane16_swap_b32 v32, v2
  v_permlane16_swap_b32 v33, v4
  v_add_f32 v32, v32, v2
  v_add_f32 v33, v33, v4
  buffer_store_dwordx4 v[80:83], v52, s[28:31], s37 offen offset:2048 sc1
  buffer_store_dwordx4 v[84:87], v52, s[28:31], s37 offen offset:3072 sc1
  s_mov_b32 s40, 0x3b124925
  s_mul_i32 s32, s17, 131584
  s_add_u32 s32, s32, 0x4800080
  v_mul_f32 v24, s40, v24
  v_mul_f32 v2, v24, v24
  v_fma_f32 v2, v32, s40, -v2
  v_max_f32 v2, 0, v2
  v_add_f32 v2, 0x3727c5ac, v2
  v_rsq_f32 v4, v2
  v_sqrt_f32 v27, v2
  v_mul_f32 v25, 0xc0135761, v4
  v_mul_f32 v26, v4, v4
  v_mul_f32 v26, v26, v4
  v_mul_f32 v26, 0xbdd2d3e8, v26
  v_mul_f32 v28, s40, v28
  v_mul_f32 v2, v28, v28
  v_fma_f32 v2, v33, s40, -v2
  v_max_f32 v2, 0, v2
  v_add_f32 v2, 0x3727c5ac, v2
  v_rsq_f32 v4, v2
  v_sqrt_f32 v31, v2
  v_mul_f32 v29, 0xc0135761, v4
  v_mul_f32 v30, v4, v4
  v_mul_f32 v30, v30, v4
  v_mul_f32 v30, 0xbdd2d3e8, v30
  buffer_store_dwordx4 v[88:91], v52, s[28:31], s48 offen offset:0 sc1
  v_fma_f32 v216, -v24, v16, v216
  v_fma_f32 v217, -v24, v17, v217
  v_fma_f32 v218, -v24, v18, v218
  v_fma_f32 v219, -v24, v19, v219
  v_fma_f32 v220, -v24, v20, v220
  v_fma_f32 v221, -v24, v21, v221
  v_fma_f32 v222, -v24, v22, v222
  v_fma_f32 v223, -v24, v23, v223
  v_fma_f32 v224, -v28, v16, v224
  v_fma_f32 v225, -v28, v17, v225
  buffer_store_dwordx4 v[92:95], v52, s[28:31], s48 offen offset:1024 sc1
  v_fma_f32 v226, -v28, v18, v226
  v_fma_f32 v227, -v28, v19, v227
  v_fma_f32 v228, -v28, v20, v228
  v_fma_f32 v229, -v28, v21, v229
  v_fma_f32 v230, -v28, v22, v230
  v_fma_f32 v231, -v28, v23, v231
  v_mul_f32 v152, v216, v216
  v_mul_f32 v153, v217, v217
  v_mul_f32 v154, v218, v218
  v_mul_f32 v155, v219, v219
  buffer_store_dwordx4 v[96:99], v52, s[28:31], s48 offen offset:2048 sc1
  v_mul_f32 v156, v220, v220
  v_mul_f32 v157, v221, v221
  v_mul_f32 v158, v222, v222
  v_mul_f32 v159, v223, v223
  v_mul_f32 v160, v224, v224
  v_mul_f32 v161, v225, v225
  v_mul_f32 v162, v226, v226
  v_mul_f32 v163, v227, v227
  v_mul_f32 v164, v228, v228
  v_mul_f32 v165, v229, v229
  buffer_store_dwordx4 v[100:103], v52, s[28:31], s48 offen offset:3072 sc1
  v_mul_f32 v166, v230, v230
  v_mul_f32 v167, v231, v231
  v_fma_f32 v152, v152, v26, v25
  v_fma_f32 v153, v153, v26, v25
  v_fma_f32 v154, v154, v26, v25
  v_fma_f32 v155, v155, v26, v25
  v_fma_f32 v156, v156, v26, v25
  v_fma_f32 v157, v157, v26, v25
  v_fma_f32 v158, v158, v26, v25
  v_fma_f32 v159, v159, v26, v25
  buffer_store_dwordx4 v[104:107], v52, s[28:31], s49 offen offset:0 sc1
  v_fma_f32 v160, v160, v30, v29
  v_fma_f32 v161, v161, v30, v29
  v_fma_f32 v162, v162, v30, v29
  v_fma_f32 v163, v163, v30, v29
  v_fma_f32 v164, v164, v30, v29
  v_fma_f32 v165, v165, v30, v29
  v_fma_f32 v166, v166, v30, v29
  v_fma_f32 v167, v167, v30, v29
  v_mul_f32 v152, v152, v216
  v_mul_f32 v153, v153, v217
  buffer_store_dwordx4 v[108:111], v52, s[28:31], s49 offen offset:1024 sc1
  v_mul_f32 v154, v154, v218
  v_mul_f32 v155, v155, v219
  v_mul_f32 v156, v156, v220
  v_mul_f32 v157, v157, v221
  v_mul_f32 v158, v158, v222
  v_mul_f32 v159, v159, v223
  v_mul_f32 v160, v160, v224
  v_mul_f32 v161, v161, v225
  v_mul_f32 v162, v162, v226
  v_mul_f32 v163, v163, v227
  buffer_store_dwordx4 v[112:115], v52, s[28:31], s49 offen offset:2048 sc1
  v_mul_f32 v164, v164, v228
  v_mul_f32 v165, v165, v229
  v_mul_f32 v166, v166, v230
  v_mul_f32 v167, v167, v231
  v_exp_f32 v152, v152
  v_exp_f32 v153, v153
  v_exp_f32 v154, v154
  v_exp_f32 v155, v155
  v_exp_f32 v156, v156
  v_exp_f32 v157, v157
  buffer_store_dwordx4 v[116:119], v52, s[28:31], s49 offen offset:3072 sc1
  v_exp_f32 v158, v158
  v_exp_f32 v159, v159
  v_exp_f32 v160, v160
  v_exp_f32 v161, v161
  v_exp_f32 v162, v162
  v_exp_f32 v163, v163
  v_exp_f32 v164, v164
  v_exp_f32 v165, v165
  v_exp_f32 v166, v166
  v_exp_f32 v167, v167
  v_fma_f32 v152, v152, v27, v27
  v_fma_f32 v153, v153, v27, v27
  v_fma_f32 v154, v154, v27, v27
  v_fma_f32 v155, v155, v27, v27
  v_fma_f32 v156, v156, v27, v27
  v_fma_f32 v157, v157, v27, v27
  v_fma_f32 v158, v158, v27, v27
  v_fma_f32 v159, v159, v27, v27
  v_fma_f32 v160, v160, v31, v31
  v_fma_f32 v161, v161, v31, v31
  v_fma_f32 v162, v162, v31, v31
  v_fma_f32 v163, v163, v31, v31
  v_fma_f32 v164, v164, v31, v31
  v_fma_f32 v165, v165, v31, v31
  v_fma_f32 v166, v166, v31, v31
  v_fma_f32 v167, v167, v31, v31
  v_rcp_f32 v152, v152
  v_rcp_f32 v153, v153
  v_rcp_f32 v154, v154
  v_rcp_f32 v155, v155
  v_rcp_f32 v156, v156
  v_rcp_f32 v157, v157
  v_rcp_f32 v158, v158
  v_rcp_f32 v159, v159
  v_rcp_f32 v160, v160
  v_rcp_f32 v161, v161
  v_rcp_f32 v162, v162
  v_rcp_f32 v163, v163
  v_rcp_f32 v164, v164
  v_rcp_f32 v165, v165
  v_rcp_f32 v166, v166
  v_rcp_f32 v167, v167
  v_mul_f32 v216, v216, v152
  v_mul_f32 v217, v217, v153
  v_mul_f32 v218, v218, v154
  v_mul_f32 v219, v219, v155
  v_mul_f32 v220, v220, v156
  v_mul_f32 v221, v221, v157
  v_mul_f32 v222, v222, v158
  v_mul_f32 v223, v223, v159
  v_mul_f32 v224, v224, v160
  v_mul_f32 v225, v225, v161
  v_mul_f32 v226, v226, v162
  v_mul_f32 v227, v227, v163
  v_mul_f32 v228, v228, v164
  v_mul_f32 v229, v229, v165
  v_mul_f32 v230, v230, v166
  v_mul_f32 v231, v231, v167
  v_cvt_pk_bf16_f32 v236, v216, v217
  v_cvt_pk_bf16_f32 v237, v218, v219
  v_cvt_pk_bf16_f32 v238, v220, v221
  v_cvt_pk_bf16_f32 v239, v222, v223
  v_cvt_pk_bf16_f32 v240, v224, v225
  v_cvt_pk_bf16_f32 v241, v226, v227
  v_cvt_pk_bf16_f32 v242, v228, v229
  v_cvt_pk_bf16_f32 v243, v230, v231
  v_permlane16_swap_b32 v236, v238
  v_permlane16_swap_b32 v237, v239
  v_permlane16_swap_b32 v240, v242
  v_permlane16_swap_b32 v241, v243
Lk_fin35:
  buffer_load_dwordx4 v9, s[12:15], s69 offen offset:0 sc1 lds
  buffer_load_dwordx4 v9, s[12:15], s69 offen offset:1024 sc1 lds
  buffer_load_dwordx4 v9, s[12:15], s69 offen offset:2048 sc1 lds
  buffer_load_dwordx4 v9, s[12:15], s69 offen offset:3072 sc1 lds
  s_add_u32 m0, s68, 0x10000
  s_nop 0
  buffer_load_dwordx4 v9, s[8:11], s71 offen offset:0 sc1 lds
  buffer_load_dwordx4 v9, s[8:11], s71 offen offset:1024 sc1 lds
  buffer_load_dwordx4 v9, s[8:11], s71 offen offset:2048 sc1 lds
  buffer_load_dwordx4 v9, s[8:11], s71 offen offset:3072 sc1 lds
  s_cmp_ge_u32 s17, 14
  s_cbranch_scc1 Lk_nh36
  buffer_store_dwordx4 v[236:239], v3, s[28:31], s32 offen offset:0 sc1
  buffer_store_dwordx4 v[240:243], v3, s[28:31], s32 offen offset:256 sc1
Lk_nh36:
  s_nop 1
  v_lshlrev_b32 v2, 4, v1
  s_lshl_b32 s40, s19, 12
  v_add_u32 v3, s40, v2
  v_mov_b32 v116, v2
  v_accvgpr_read_b32 v124, a128
  v_accvgpr_read_b32 v125, a129
  s_mov_b32 s52, 1
  s_add_u32 s60, s74, 0x4800000
  s_addc_u32 s61, s75, 0
  s_and_b32 s61, s61, 0xffff
  s_mov_b32 s62, 0x1c9c80
  s_mov_b32 s63, 0x20000
  s_mov_b32 s36, 0
  s_cmp_eq_u32 s18, 0
  s_cbranch_scc1 Lk_B37
  s_mov_b32 s99, 0
  s_mov_b32 s101, s72
  s_mov_b32 s53, 1
  s_sub_u32 s16, 7, s16
  s_cmp_eq_u32 s16, 7
  s_cselect_b32 s98, 1, 0
  s_cselect_b32 s97, 0, 2
  s_sub_u32 s48, s16, 1
  s_cmp_lt_u32 s48, 6
  s_cbranch_scc1 Lk_task39
  s_mov_b32 s48, 7
  s_branch Lk_go38
Lk_B37:
  s_mov_b32 s98, 1
  s_lshl_b32 s101, s16, 2
  s_add_u32 s101, s101, 4
  s_cmp_ge_u32 s16, 3
  s_cselect_b32 s53, 1, 0
  s_cmp_eq_u32 s16, 7
  s_cselect_b32 s97, 0, 1
  s_cselect_b32 s99, 0, 1
  s_cselect_b32 s48, 6, 7
  s_cbranch_scc0 Lk_go38
Lk_task39:
  v_and_b32 v120, 15, v1
  s_lshl_b32 s40, s19, 5
  s_lshl_b32 s41, s17, 7
  s_add_u32 s40, s40, s41
  v_add_u32 v120, s40, v120
  v_lshrrev_b32 v121, 4, v1
  v_mul_u32_u24 v122, 32896, v121
  v_lshl_add_u32 v122, v120, 4, v122
  v_add_u32 v81, 96, v122
  v_lshrrev_b32 v123, 5, v1
  v_lshl_add_u32 v83, v123, 6, v81
  v_lshl_add_u32 v82, v123, 5, v81
  v_add_u32 v82, 16, v82
  v_mul_u32_u24 v120, 896, v120
  v_lshl_add_u32 v120, v123, 4, v120
  v_and_b32 v121, 1, v121
  v_lshl_add_u32 v104, v121, 5, v120
  v_lshrrev_b32 v120, 3, v1
  s_lshl_b32 s32, s19, 3
  v_add_u32 v120, s32, v120
  v_mul_u32_u24 v120, 896, v120
  s_lshl_b32 s32, s46, 1
  v_or_b32 v121, s32, v121
  v_bfe_u32 v122, v1, 1, 2
  v_xor_b32 v121, v121, v122
  v_lshl_add_u32 v120, v121, 5, v120
  v_and_b32 v122, 1, v1
  v_lshl_add_u32 v80, v122, 4, v120
Lk_go38:
  v_lshrrev_b32 v120, 4, v1
  v_lshlrev_b32 v120, 2, v120
  v_and_b32 v121, 15, v1
  v_add_u32 v122, 0, v120
  v_cmp_le_u32 s[64:65], v122, v121
  v_add_u32 v122, 1, v120
  v_cmp_le_u32 s[66:67], v122, v121
  v_add_u32 v122, 2, v120
  v_cmp_le_u32 s[68:69], v122, v121
  v_add_u32 v122, 3, v120
  v_cmp_le_u32 s[70:71], v122, v121
  v_mov_b32 v88, 0
  v_mov_b32 v92, 0
  v_mov_b64 v[52:53], 0
  v_mov_b64 v[54:55], 0
  v_mov_b64 v[56:57], 0
  v_mov_b64 v[58:59], 0
  v_mov_b64 v[60:61], 0
  v_mov_b64 v[62:63], 0
  v_mov_b64 v[64:65], 0
  v_mov_b64 v[66:67], 0
  v_mov_b32 v112, 0
  v_mov_b32 v114, 0
  s_sub_u32 s35, 3, s19
  s_mul_i32 s35, s35, s98
  s_sub_u32 s33, s101, s35
  s_sub_u32 s33, s33, 1
  s_waitcnt vmcnt(24) lgkmcnt(0)
  s_barrier
  s_cmp_eq_u32 s78, 1
  s_cbranch_scc1 Lk_pre1
Lk_pre0:
  ds_read_b128 a[64:67], v116 offset:0
  ds_read_b128 a[68:71], v116 offset:1024
  ds_read_b128 a[72:75], v116 offset:2048
  ds_read_b128 a[76:79], v116 offset:3072
  ds_read_b128 a[80:83], v116 offset:4096
  ds_read_b128 a[84:87], v116 offset:5120
  ds_read_b128 a[88:91], v116 offset:6144
  ds_read_b128 a[92:95], v116 offset:7168
  ds_read_b128 a[96:99], v116 offset:8192
  ds_read_b128 a[100:103], v116 offset:9216
  ds_read_b128 a[104:107], v116 offset:10240
  ds_read_b128 a[108:111], v116 offset:11264
  ds_read_b128 a[112:115], v116 offset:12288
  ds_read_b128 a[116:119], v116 offset:13312
  ds_read_b128 a[120:123], v116 offset:14336
  ds_read_b128 a[124:127], v116 offset:15360
  s_add_u32 m0, s77, 0xc000
  s_nop 0
  buffer_load_dwordx4 v3, s[12:15], s39 offen offset:0 sc1 lds
  buffer_load_dwordx4 v3, s[12:15], s39 offen offset:1024 sc1 lds
  buffer_load_dwordx4 v3, s[12:15], s39 offen offset:2048 sc1 lds
  buffer_load_dwordx4 v3, s[12:15], s39 offen offset:3072 sc1 lds
  s_add_u32 s39, s38, 0x4000
  s_cmp_eq_u32 s39, s3
  s_cselect_b32 s39, s76, s39
  s_add_u32 m0, s77, 0x8000
  s_nop 0
  buffer_load_dwordx4 v3, s[8:11], s39 offen offset:0 sc1 lds
  buffer_load_dwordx4 v3, s[8:11], s39 offen offset:1024 sc1 lds
  buffer_load_dwordx4 v3, s[8:11], s39 offen offset:2048 sc1 lds
  buffer_load_dwordx4 v3, s[8:11], s39 offen offset:3072 sc1 lds
  s_xor_b32 s77, s77, 0x10000
  s_branch Lk_P1
Lk_pre1:
  ds_read_b128 a[64:67], v116 offset:32768
  ds_read_b128 a[68:71], v116 offset:33792
  ds_read_b128 a[72:75], v116 offset:34816
  ds_read_b128 a[76:79], v116 offset:35840
  ds_read_b128 a[80:83], v116 offset:36864
  ds_read_b128 a[84:87], v116 offset:37888
  ds_read_b128 a[88:91], v116 offset:38912
  ds_read_b128 a[92:95], v116 offset:39936
  ds_read_b128 a[96:99], v116 offset:40960
  ds_read_b128 a[100:103], v116 offset:41984
  ds_read_b128 a[104:107], v116 offset:43008
  ds_read_b128 a[108:111], v116 offset:44032
  ds_read_b128 a[112:115], v116 offset:45056
  ds_read_b128 a[116:119], v116 offset:46080
  ds_read_b128 a[120:123], v116 offset:47104
  ds_read_b128 a[124:127], v116 offset:48128
  v_xor_b32 v116, 0x10000, v116
  s_add_u32 m0, s77, 0x4000
  s_nop 0
  buffer_load_dwordx4 v3, s[12:15], s38 offen offset:0 sc1 lds
  buffer_load_dwordx4 v3, s[12:15], s38 offen offset:1024 sc1 lds
  buffer_load_dwordx4 v3, s[12:15], s38 offen offset:2048 sc1 lds
  buffer_load_dwordx4 v3, s[12:15], s38 offen offset:3072 sc1 lds
  s_add_u32 s38, s39, 0x4000
  s_cmp_eq_u32 s38, s3
  s_cselect_b32 s38, s76, s38
  s_mov_b32 m0, s77
  s_nop 0
  buffer_load_dwordx4 v3, s[8:11], s38 offen offset:0 sc1 lds
  buffer_load_dwordx4 v3, s[8:11], s38 offen offset:1024 sc1 lds
  buffer_load_dwordx4 v3, s[8:11], s38 offen offset:2048 sc1 lds
  buffer_load_dwordx4 v3, s[8:11], s38 offen offset:3072 sc1 lds
  s_branch Lk_P0
Lk_P0:
  s_cmp_lg_u32 s33, 0
  s_cbranch_scc1 Lk_nm40
  v_mov_b32 v120, 0xf149f2ca
  v_cndmask_b32 v52, v120, v52, s[64:65]
  v_cndmask_b32 v64, v120, v64, s[64:65]
  v_mov_b32 v60, v120
  v_cndmask_b32 v53, v120, v53, s[66:67]
  v_cndmask_b32 v65, v120, v65, s[66:67]
  v_mov_b32 v61, v120
  v_cndmask_b32 v54, v120, v54, s[68:69]
  v_cndmask_b32 v66, v120, v66, s[68:69]
  v_mov_b32 v62, v120
  v_cndmask_b32 v55, v120, v55, s[70:71]
  v_cndmask_b32 v67, v120, v67, s[70:71]
  v_mov_b32 v63, v120
Lk_nm40:
  s_cmp_lg_u32 s52, 0
  s_cbranch_scc1 Lk_s41
  s_waitcnt vmcnt(16)
Lk_s41:
  s_waitcnt lgkmcnt(0)
  s_barrier
  v_mfma_f32_16x16x32_bf16 v[4:7], a[64:67], a[0:3], v[52:55]
  s_add_u32 m0, s77, 0xc000
  v_mov_b64 v[128:129], 0
  v_mov_b64 v[130:131], 0
  v_mfma_f32_16x16x32_bf16 v[8:11], a[64:67], a[32:35], v[56:59]
  ds_read_b128 a[64:67], v116 offset:0
  v_mov_b64 v[132:133], 0
  v_mfma_f32_16x16x32_bf16 v[4:7], a[68:71], a[4:7], v[4:7]
  buffer_load_dwordx4 v3, s[12:15], s39 offen offset:0 sc1 lds
  v_mov_b64 v[134:135], 0
  v_mfma_f32_16x16x32_bf16 v[8:11], a[68:71], a[36:39], v[8:11]
  ds_read_b128 a[68:71], v116 offset:1024
  v_mov_b64 v[136:137], 0
  v_mfma_f32_16x16x32_bf16 v[4:7], a[72:75], a[8:11], v[4:7]
  v_mov_b64 v[138:139], 0
  v_mov_b64 v[140:141], 0
  v_mfma_f32_16x16x32_bf16 v[8:11], a[72:75], a[40:43], v[8:11]
  ds_read_b128 a[72:75], v116 offset:2048
  v_mov_b64 v[142:143], 0
  v_mfma_f32_16x16x32_bf16 v[4:7], a[76:79], a[12:15], v[4:7]
  buffer_load_dwordx4 v3, s[12:15], s39 offen offset:1024 sc1 lds
  v_mov_b64 v[144:145], 0
  v_mfma_f32_16x16x32_bf16 v[8:11], a[76:79], a[44:47], v[8:11]
  ds_read_b128 a[76:79], v116 offset:3072
  v_mov_b64 v[146:147], 0
  v_mfma_f32_16x16x32_bf16 v[4:7], a[80:83], a[16:19], v[4:7]
  v_mov_b64 v[148:149], 0
  v_mov_b64 v[150:151], 0
  v_mfma_f32_16x16x32_bf16 v[8:11], a[80:83], a[48:51], v[8:11]
  ds_read_b128 a[80:83], v116 offset:4096
  v_mov_b64 v[152:153], 0
  v_mfma_f32_16x16x32_bf16 v[4:7], a[84:87], a[20:23], v[4:7]
  buffer_load_dwordx4 v3, s[12:15], s39 offen offset:2048 sc1 lds
  v_mov_b64 v[154:155], 0
  v_mfma_f32_16x16x32_bf16 v[8:11], a[84:87], a[52:55], v[8:11]
  ds_read_b128 a[84:87], v116 offset:5120
  v_mov_b64 v[156:157], 0
  v_mfma_f32_16x16x32_bf16 v[4:7], a[88:91], a[24:27], v[4:7]
  v_mov_b64 v[158:159], 0
  v_mov_b64 v[160:161], 0
  v_mfma_f32_16x16x32_bf16 v[8:11], a[88:91], a[56:59], v[8:11]
  ds_read_b128 a[88:91], v116 offset:6144
  v_mov_b64 v[162:163], 0
  v_mfma_f32_16x16x32_bf16 v[4:7], a[92:95], a[28:31], v[4:7]
  buffer_load_dwordx4 v3, s[12:15], s39 offen offset:3072 sc1 lds
  v_mov_b64 v[164:165], 0
  v_mfma_f32_16x16x32_bf16 v[8:11], a[92:95], a[60:63], v[8:11]
  s_add_u32 s39, s38, 0x4000
  ds_read_b128 a[92:95], v116 offset:7168
  v_mov_b64 v[166:167], 0
  v_mfma_f32_16x16x32_bf16 v[12:15], a[96:99], a[0:3], v[60:63]
  s_cmp_eq_u32 s39, s3
  s_cselect_b32 s39, s76, s39
  s_add_u32 m0, s77, 0x8000
  v_mfma_f32_16x16x32_bf16 v[16:19], a[96:99], a[32:35], v[64:67]
  ds_read_b128 a[96:99], v116 offset:8192
  v_mov_b64 v[168:169], 0
  v_mfma_f32_16x16x32_bf16 v[12:15], a[100:103], a[4:7], v[12:15]
  buffer_load_dwordx4 v3, s[8:11], s39 offen offset:0 sc1 lds
  v_mov_b64 v[170:171], 0
  v_mfma_f32_16x16x32_bf16 v[16:19], a[100:103], a[36:39], v[16:19]
  ds_read_b128 a[100:103], v116 offset:9216
  v_mov_b64 v[172:173], 0
  v_mfma_f32_16x16x32_bf16 v[12:15], a[104:107], a[8:11], v[12:15]
  v_mov_b64 v[174:175], 0
  v_mov_b64 v[176:177], 0
  v_mfma_f32_16x16x32_bf16 v[16:19], a[104:107], a[40:43], v[16:19]
  ds_read_b128 a[104:107], v116 offset:10240
  v_mov_b64 v[178:179], 0
  v_mfma_f32_16x16x32_bf16 v[12:15], a[108:111], a[12:15], v[12:15]
  buffer_load_dwordx4 v3, s[8:11], s39 offen offset:1024 sc1 lds
  v_mov_b64 v[180:181], 0
  v_mfma_f32_16x16x32_bf16 v[16:19], a[108:111], a[44:47], v[16:19]
  ds_read_b128 a[108:111], v116 offset:11264
  v_mov_b64 v[182:183], 0
  v_mfma_f32_16x16x32_bf16 v[12:15], a[112:115], a[16:19], v[12:15]
  v_mov_b64 v[184:185], 0
  v_mov_b64 v[186:187], 0
  v_mfma_f32_16x16x32_bf16 v[16:19], a[112:115], a[48:51], v[16:19]
  ds_read_b128 a[112:115], v116 offset:12288
  v_mov_b64 v[188:189], 0
  v_mfma_f32_16x16x32_bf16 v[12:15], a[116:119], a[20:23], v[12:15]
  buffer_load_dwordx4 v3, s[8:11], s39 offen offset:2048 sc1 lds
  v_mov_b64 v[190:191], 0
  v_mfma_f32_16x16x32_bf16 v[16:19], a[116:119], a[52:55], v[16:19]
  ds_read_b128 a[116:119], v116 offset:13312
  v_mov_b64 v[192:193], 0
  v_mfma_f32_16x16x32_bf16 v[12:15], a[120:123], a[24:27], v[12:15]
  v_mov_b64 v[194:195], 0
  v_mov_b64 v[196:197], 0
  v_mfma_f32_16x16x32_bf16 v[16:19], a[120:123], a[56:59], v[16:19]
  ds_read_b128 a[120:123], v116 offset:14336
  v_mov_b64 v[198:199], 0
  v_mfma_f32_16x16x32_bf16 v[12:15], a[124:127], a[28:31], v[12:15]
  buffer_load_dwordx4 v3, s[8:11], s39 offen offset:3072 sc1 lds
  v_mov_b64 v[200:201], 0
  v_mfma_f32_16x16x32_bf16 v[16:19], a[124:127], a[60:63], v[16:19]
  s_xor_b32 s77, s77, 0x10000
  ds_read_b128 a[124:127], v116 offset:15360
  v_mov_b64 v[202:203], 0
  v_mov_b64 v[204:205], 0
  v_mov_b64 v[206:207], 0
  v_mov_b64 v[208:209], 0
  v_mov_b64 v[210:211], 0
  v_mov_b64 v[212:213], 0
  v_mov_b64 v[214:215], 0
  v_mov_b64 v[216:217], 0
  v_mov_b64 v[218:219], 0
  v_mov_b64 v[220:221], 0
  v_mov_b64 v[222:223], 0
  v_mov_b64 v[224:225], 0
  v_mov_b64 v[226:227], 0
  v_mov_b64 v[228:229], 0
  v_mov_b64 v[230:231], 0
  v_mov_b64 v[232:233], 0
  v_mov_b64 v[234:235], 0
  v_mov_b64 v[236:237], 0
  v_mov_b64 v[238:239], 0
  v_mov_b64 v[240:241], 0
  v_mov_b64 v[242:243], 0
  v_mov_b64 v[244:245], 0
  v_mov_b64 v[246:247], 0
  v_mov_b64 v[248:249], 0
  v_mov_b64 v[250:251], 0
  v_mov_b64 v[252:253], 0
  v_mov_b64 v[254:255], 0
  v_max3_f32 v122, v4, v5, v6
  v_max3_f32 v122, v122, v7, v12
  v_max3_f32 v122, v122, v13, v14
  v_max_f32 v122, v122, v15
  v_max3_f32 v123, v8, v9, v10
  v_max3_f32 v123, v123, v11, v16
  v_max3_f32 v123, v123, v17, v18
  v_max_f32 v123, v123, v19
  v_mov_b32 v120, v122
  v_mov_b32 v121, v123
  s_nop 0
  v_permlane32_swap_b32 v122, v120
  v_permlane32_swap_b32 v123, v121
  v_max_f32 v122, v122, v120
  v_max_f32 v123, v123, v121
  v_mov_b32 v120, v122
  v_mov_b32 v121, v123
  s_nop 0
  v_permlane16_swap_b32 v122, v120
  v_permlane16_swap_b32 v123, v121
  v_max_f32 v122, v122, v120
  v_max_f32 v123, v123, v121
  v_add_f32 v122, 0x42200000, v122
  v_add_f32 v123, 0x42200000, v123
  v_sub_f32 v4, v4, v122
  v_sub_f32 v5, v5, v122
  v_sub_f32 v6, v6, v122
  v_sub_f32 v7, v7, v122
  v_sub_f32 v8, v8, v123
  v_sub_f32 v9, v9, v123
  v_sub_f32 v10, v10, v123
  v_sub_f32 v11, v11, v123
  v_sub_f32 v12, v12, v122
  v_sub_f32 v13, v13, v122
  v_sub_f32 v14, v14, v122
  v_sub_f32 v15, v15, v122
  v_sub_f32 v16, v16, v123
  v_sub_f32 v17, v17, v123
  v_sub_f32 v18, v18, v123
  v_sub_f32 v19, v19, v123
  v_sub_f32 v52, v52, v122
  v_sub_f32 v53, v53, v122
  v_sub_f32 v54, v54, v122
  v_sub_f32 v55, v55, v122
  v_sub_f32 v56, v56, v123
  v_sub_f32 v57, v57, v123
  v_sub_f32 v58, v58, v123
  v_sub_f32 v59, v59, v123
  v_sub_f32 v60, v60, v122
  v_sub_f32 v61, v61, v122
  v_sub_f32 v62, v62, v122
  v_sub_f32 v63, v63, v122
  v_sub_f32 v64, v64, v123
  v_sub_f32 v65, v65, v123
  v_sub_f32 v66, v66, v123
  v_sub_f32 v67, v67, v123
  v_sub_f32 v112, v112, v122
  v_sub_f32 v114, v114, v123
  v_exp_f32 v96, v4
  v_exp_f32 v97, v5
  v_exp_f32 v98, v6
  v_exp_f32 v99, v7
  v_add_f32 v76, v96, v97
  v_cvt_pk_bf16_f32 v36, v96, v97
  v_exp_f32 v100, v8
  v_exp_f32 v101, v9
  v_add_f32 v76, v76, v98
  v_add_f32 v76, v76, v99
  v_cvt_pk_bf16_f32 v37, v98, v99
  v_exp_f32 v102, v10
  v_exp_f32 v103, v11
  v_add_f32 v77, v100, v101
  v_cvt_pk_bf16_f32 v40, v100, v101
  v_exp_f32 v96, v12
  v_exp_f32 v97, v13
  v_add_f32 v77, v77, v102
  v_add_f32 v77, v77, v103
  v_cvt_pk_bf16_f32 v41, v102, v103
  v_add_f32 v76, v76, v96
  v_add_f32 v76, v76, v97
  v_cvt_pk_bf16_f32 v38, v96, v97
  s_mov_b32 s37, 1
  s_branch Lk_pd
Lk_P1:
  s_cmp_lg_u32 s33, 0
  s_cbranch_scc1 Lk_nm42
  v_mov_b32 v120, 0xf149f2ca
  v_cndmask_b32 v52, v120, v52, s[64:65]
  v_cndmask_b32 v64, v120, v64, s[64:65]
  v_mov_b32 v60, v120
  v_cndmask_b32 v53, v120, v53, s[66:67]
  v_cndmask_b32 v65, v120, v65, s[66:67]
  v_mov_b32 v61, v120
  v_cndmask_b32 v54, v120, v54, s[68:69]
  v_cndmask_b32 v66, v120, v66, s[68:69]
  v_mov_b32 v62, v120
  v_cndmask_b32 v55, v120, v55, s[70:71]
  v_cndmask_b32 v67, v120, v67, s[70:71]
  v_mov_b32 v63, v120
Lk_nm42:
  s_cmp_lg_u32 s52, 0
  s_cbranch_scc1 Lk_s43
  s_waitcnt vmcnt(16)
Lk_s43:
  s_waitcnt lgkmcnt(0)
  s_barrier
  v_mfma_f32_16x16x32_bf16 v[20:23], a[64:67], a[0:3], v[52:55]
  s_add_u32 m0, s77, 0x4000
  v_mov_b64 v[128:129], 0
  v_mov_b64 v[130:131], 0
  v_mfma_f32_16x16x32_bf16 v[24:27], a[64:67], a[32:35], v[56:59]
  ds_read_b128 a[64:67], v116 offset:32768
  v_mov_b64 v[132:133], 0
  v_mfma_f32_16x16x32_bf16 v[20:23], a[68:71], a[4:7], v[20:23]
  buffer_load_dwordx4 v3, s[12:15], s38 offen offset:0 sc1 lds
  v_mov_b64 v[134:135], 0
  v_mfma_f32_16x16x32_bf16 v[24:27], a[68:71], a[36:39], v[24:27]
  ds_read_b128 a[68:71], v116 offset:33792
  v_mov_b64 v[136:137], 0
  v_mfma_f32_16x16x32_bf16 v[20:23], a[72:75], a[8:11], v[20:23]
  v_mov_b64 v[138:139], 0
  v_mov_b64 v[140:141], 0
  v_mfma_f32_16x16x32_bf16 v[24:27], a[72:75], a[40:43], v[24:27]
  ds_read_b128 a[72:75], v116 offset:34816
  v_mov_b64 v[142:143], 0
  v_mfma_f32_16x16x32_bf16 v[20:23], a[76:79], a[12:15], v[20:23]
  buffer_load_dwordx4 v3, s[12:15], s38 offen offset:1024 sc1 lds
  v_mov_b64 v[144:145], 0
  v_mfma_f32_16x16x32_bf16 v[24:27], a[76:79], a[44:47], v[24:27]
  ds_read_b128 a[76:79], v116 offset:35840
  v_mov_b64 v[146:147], 0
  v_mfma_f32_16x16x32_bf16 v[20:23], a[80:83], a[16:19], v[20:23]
  v_mov_b64 v[148:149], 0
  v_mov_b64 v[150:151], 0
  v_mfma_f32_16x16x32_bf16 v[24:27], a[80:83], a[48:51], v[24:27]
  ds_read_b128 a[80:83], v116 offset:36864
  v_mov_b64 v[152:153], 0
  v_mfma_f32_16x16x32_bf16 v[20:23], a[84:87], a[20:23], v[20:23]
  buffer_load_dwordx4 v3, s[12:15], s38 offen offset:2048 sc1 lds
  v_mov_b64 v[154:155], 0
  v_mfma_f32_16x16x32_bf16 v[24:27], a[84:87], a[52:55], v[24:27]
  ds_read_b128 a[84:87], v116 offset:37888
  v_mov_b64 v[156:157], 0
  v_mfma_f32_16x16x32_bf16 v[20:23], a[88:91], a[24:27], v[20:23]
  v_mov_b64 v[158:159], 0
  v_mov_b64 v[160:161], 0
  v_mfma_f32_16x16x32_bf16 v[24:27], a[88:91], a[56:59], v[24:27]
  ds_read_b128 a[88:91], v116 offset:38912
  v_mov_b64 v[162:163], 0
  v_mfma_f32_16x16x32_bf16 v[20:23], a[92:95], a[28:31], v[20:23]
  buffer_load_dwordx4 v3, s[12:15], s38 offen offset:3072 sc1 lds
  v_mov_b64 v[164:165], 0
  v_mfma_f32_16x16x32_bf16 v[24:27], a[92:95], a[60:63], v[24:27]
  s_add_u32 s38, s39, 0x4000
  ds_read_b128 a[92:95], v116 offset:39936
  v_mov_b64 v[166:167], 0
  v_mfma_f32_16x16x32_bf16 v[28:31], a[96:99], a[0:3], v[60:63]
  s_cmp_eq_u32 s38, s3
  s_cselect_b32 s38, s76, s38
  s_mov_b32 m0, s77
  v_mfma_f32_16x16x32_bf16 v[32:35], a[96:99], a[32:35], v[64:67]
  ds_read_b128 a[96:99], v116 offset:40960
  v_mov_b64 v[168:169], 0
  v_mfma_f32_16x16x32_bf16 v[28:31], a[100:103], a[4:7], v[28:31]
  buffer_load_dwordx4 v3, s[8:11], s38 offen offset:0 sc1 lds
  v_mov_b64 v[170:171], 0
  v_mfma_f32_16x16x32_bf16 v[32:35], a[100:103], a[36:39], v[32:35]
  ds_read_b128 a[100:103], v116 offset:41984
  v_mov_b64 v[172:173], 0
  v_mfma_f32_16x16x32_bf16 v[28:31], a[104:107], a[8:11], v[28:31]
  v_mov_b64 v[174:175], 0
  v_mov_b64 v[176:177], 0
  v_mfma_f32_16x16x32_bf16 v[32:35], a[104:107], a[40:43], v[32:35]
  ds_read_b128 a[104:107], v116 offset:43008
  v_mov_b64 v[178:179], 0
  v_mfma_f32_16x16x32_bf16 v[28:31], a[108:111], a[12:15], v[28:31]
  buffer_load_dwordx4 v3, s[8:11], s38 offen offset:1024 sc1 lds
  v_mov_b64 v[180:181], 0
  v_mfma_f32_16x16x32_bf16 v[32:35], a[108:111], a[44:47], v[32:35]
  ds_read_b128 a[108:111], v116 offset:44032
  v_mov_b64 v[182:183], 0
  v_mfma_f32_16x16x32_bf16 v[28:31], a[112:115], a[16:19], v[28:31]
  v_mov_b64 v[184:185], 0
  v_mov_b64 v[186:187], 0
  v_mfma_f32_16x16x32_bf16 v[32:35], a[112:115], a[48:51], v[32:35]
  ds_read_b128 a[112:115], v116 offset:45056
  v_mov_b64 v[188:189], 0
  v_mfma_f32_16x16x32_bf16 v[28:31], a[116:119], a[20:23], v[28:31]
  buffer_load_dwordx4 v3, s[8:11], s38 offen offset:2048 sc1 lds
  v_mov_b64 v[190:191], 0
  v_mfma_f32_16x16x32_bf16 v[32:35], a[116:119], a[52:55], v[32:35]
  ds_read_b128 a[116:119], v116 offset:46080
  v_mov_b64 v[192:193], 0
  v_mfma_f32_16x16x32_bf16 v[28:31], a[120:123], a[24:27], v[28:31]
  v_mov_b64 v[194:195], 0
  v_mov_b64 v[196:197], 0
  v_mfma_f32_16x16x32_bf16 v[32:35], a[120:123], a[56:59], v[32:35]
  ds_read_b128 a[120:123], v116 offset:47104
  v_mov_b64 v[198:199], 0
  v_mfma_f32_16x16x32_bf16 v[28:31], a[124:127], a[28:31], v[28:31]
  buffer_load_dwordx4 v3, s[8:11], s38 offen offset:3072 sc1 lds
  v_mov_b64 v[200:201], 0
  v_mfma_f32_16x16x32_bf16 v[32:35], a[124:127], a[60:63], v[32:35]
  ds_read_b128 a[124:127], v116 offset:48128
  v_mov_b64 v[202:203], 0
  v_xor_b32 v116, 0x10000, v116
  v_mov_b64 v[204:205], 0
  v_mov_b64 v[206:207], 0
  v_mov_b64 v[208:209], 0
  v_mov_b64 v[210:211], 0
  v_mov_b64 v[212:213], 0
  v_mov_b64 v[214:215], 0
  v_mov_b64 v[216:217], 0
  v_mov_b64 v[218:219], 0
  v_mov_b64 v[220:221], 0
  v_mov_b64 v[222:223], 0
  v_mov_b64 v[224:225], 0
  v_mov_b64 v[226:227], 0
  v_mov_b64 v[228:229], 0
  v_mov_b64 v[230:231], 0
  v_mov_b64 v[232:233], 0
  v_mov_b64 v[234:235], 0
  v_mov_b64 v[236:237], 0
  v_mov_b64 v[238:239], 0
  v_mov_b64 v[240:241], 0
  v_mov_b64 v[242:243], 0
  v_mov_b64 v[244:245], 0
  v_mov_b64 v[246:247], 0
  v_mov_b64 v[248:249], 0
  v_mov_b64 v[250:251], 0
  v_mov_b64 v[252:253], 0
  v_mov_b64 v[254:255], 0
  v_max3_f32 v122, v20, v21, v22
  v_max3_f32 v122, v122, v23, v28
  v_max3_f32 v122, v122, v29, v30
  v_max_f32 v122, v122, v31
  v_max3_f32 v123, v24, v25, v26
  v_max3_f32 v123, v123, v27, v32
  v_max3_f32 v123, v123, v33, v34
  v_max_f32 v123, v123, v35
  v_mov_b32 v120, v122
  v_mov_b32 v121, v123
  s_nop 0
  v_permlane32_swap_b32 v122, v120
  v_permlane32_swap_b32 v123, v121
  v_max_f32 v122, v122, v120
  v_max_f32 v123, v123, v121
  v_mov_b32 v120, v122
  v_mov_b32 v121, v123
  s_nop 0
  v_permlane16_swap_b32 v122, v120
  v_permlane16_swap_b32 v123, v121
  v_max_f32 v122, v122, v120
  v_max_f32 v123, v123, v121
  v_add_f32 v122, 0x42200000, v122
  v_add_f32 v123, 0x42200000, v123
  v_sub_f32 v20, v20, v122
  v_sub_f32 v21, v21, v122
  v_sub_f32 v22, v22, v122
  v_sub_f32 v23, v23, v122
  v_sub_f32 v24, v24, v123
  v_sub_f32 v25, v25, v123
  v_sub_f32 v26, v26, v123
  v_sub_f32 v27, v27, v123
  v_sub_f32 v28, v28, v122
  v_sub_f32 v29, v29, v122
  v_sub_f32 v30, v30, v122
  v_sub_f32 v31, v31, v122
  v_sub_f32 v32, v32, v123
  v_sub_f32 v33, v33, v123
  v_sub_f32 v34, v34, v123
  v_sub_f32 v35, v35, v123
  v_sub_f32 v52, v52, v122
  v_sub_f32 v53, v53, v122
  v_sub_f32 v54, v54, v122
  v_sub_f32 v55, v55, v122
  v_sub_f32 v56, v56, v123
  v_sub_f32 v57, v57, v123
  v_sub_f32 v58, v58, v123
  v_sub_f32 v59, v59, v123
  v_sub_f32 v60, v60, v122
  v_sub_f32 v61, v61, v122
  v_sub_f32 v62, v62, v122
  v_sub_f32 v63, v63, v122
  v_sub_f32 v64, v64, v123
  v_sub_f32 v65, v65, v123
  v_sub_f32 v66, v66, v123
  v_sub_f32 v67, v67, v123
  v_sub_f32 v112, v112, v122
  v_sub_f32 v114, v114, v123
  v_exp_f32 v96, v20
  v_exp_f32 v97, v21
  v_exp_f32 v98, v22
  v_exp_f32 v99, v23
  v_add_f32 v78, v96, v97
  v_cvt_pk_bf16_f32 v44, v96, v97
  v_exp_f32 v100, v24
  v_exp_f32 v101, v25
  v_add_f32 v78, v78, v98
  v_add_f32 v78, v78, v99
  v_cvt_pk_bf16_f32 v45, v98, v99
  v_exp_f32 v102, v26
  v_exp_f32 v103, v27
  v_add_f32 v79, v100, v101
  v_cvt_pk_bf16_f32 v48, v100, v101
  v_exp_f32 v96, v28
  v_exp_f32 v97, v29
  v_add_f32 v79, v79, v102
  v_add_f32 v79, v79, v103
  v_cvt_pk_bf16_f32 v49, v102, v103
  v_add_f32 v78, v78, v96
  v_add_f32 v78, v78, v97
  v_cvt_pk_bf16_f32 v46, v96, v97
  s_mov_b32 s37, 0
  s_branch Lk_pd
Lk_pd:
  s_mov_b32 s34, s33
  s_cmp_eq_u32 s52, 0
  s_cbranch_scc1 Lk_pd46
  s_waitcnt vmcnt(0)
  s_barrier
  s_cmp_lg_u32 s19, 0
  s_cbranch_scc1 Lk_pd47
  s_lshl_b32 s40, s17, 7
  v_mov_b32 v120, s40
  s_add_u32 s40, s44, 16
  s_lshl_b32 s40, s40, 7
  v_writelane_b32 v120, s40, 1
  v_mov_b32 v121, 1
  s_mov_b64 exec, 3
  buffer_atomic_add v121, v120, s[20:23], 0 offen sc1
  s_mov_b64 exec, -1
Lk_pd47:
  s_mov_b32 s52, 0
  s_cmp_eq_u32 s53, 0
  s_cbranch_scc1 Lk_pd49
  s_mov_b32 s36, 2
  s_sub_u32 s34, s34, 10
  s_mov_b32 s33, 9
  s_branch Lk_pd45
Lk_pd49:
  s_cmp_lg_u32 s44, 0
  s_cbranch_scc1 Lk_pd48
  s_lshl_b32 s40, s50, 7
  v_mov_b32 v120, s40
  v_mov_b32 v121, 16
  v_mov_b32 v119, 0
  s_cmp_lg_u32 s19, 0
  s_cbranch_scc1 Lk_go51
  v_cmp_lt_u32 vcc, v119, v121
  s_nop 4
  s_cbranch_vccz Lk_go51
  s_mov_b32 s43, 0
Lk_poll50:
  s_sleep 3
  buffer_load_dword v119, v120, s[20:23], 0 offen offset:0 sc1
  s_waitcnt vmcnt(0)
  v_cmp_lt_u32 vcc, v119, v121
  s_nop 4
  s_cbranch_vccz Lk_go51
  s_add_u32 s43, s43, 1
  s_cmp_lt_u32 s43, 0x40000
  s_cbranch_scc1 Lk_poll50
Lk_go51:
  s_barrier
  s_branch Lk_pd44
Lk_pd46:
  s_cmp_eq_u32 s53, 0
  s_cbranch_scc1 Lk_pd44
Lk_pd48:
  s_sub_u32 s34, s34, 2
  s_mov_b32 s33, 1
  s_branch Lk_pd45
Lk_H0:
  s_cmp_eq_u32 s36, 7
  s_cbranch_scc1 Lk_T0
  s_mov_b32 s37, 0
  s_mov_b32 s33, 0
  s_add_u32 s36, s36, 1
  s_cmp_le_u32 s36, 6
  s_cbranch_scc1 Lk_ev
  v_mov_b32 v120, 0xf149f2ca
  v_cndmask_b32 v52, v120, v52, s[64:65]
  v_cndmask_b32 v64, v120, v64, s[64:65]
  v_mov_b32 v60, v120
  v_cndmask_b32 v53, v120, v53, s[66:67]
  v_cndmask_b32 v65, v120, v65, s[66:67]
  v_mov_b32 v61, v120
  v_cndmask_b32 v54, v120, v54, s[68:69]
  v_cndmask_b32 v66, v120, v66, s[68:69]
  v_mov_b32 v62, v120
  v_cndmask_b32 v55, v120, v55, s[70:71]
  v_cndmask_b32 v67, v120, v67, s[70:71]
  v_mov_b32 v63, v120
  s_branch Lk_M0
Lk_H1:
  s_cmp_eq_u32 s36, 7
  s_cbranch_scc1 Lk_T1
  s_mov_b32 s37, 1
  s_mov_b32 s33, 0
  s_add_u32 s36, s36, 1
  s_cmp_le_u32 s36, 6
  s_cbranch_scc1 Lk_ev
  v_mov_b32 v120, 0xf149f2ca
  v_cndmask_b32 v52, v120, v52, s[64:65]
  v_cndmask_b32 v64, v120, v64, s[64:65]
  v_mov_b32 v60, v120
  v_cndmask_b32 v53, v120, v53, s[66:67]
  v_cndmask_b32 v65, v120, v65, s[66:67]
  v_mov_b32 v61, v120
  v_cndmask_b32 v54, v120, v54, s[68:69]
  v_cndmask_b32 v66, v120, v66, s[68:69]
  v_mov_b32 v62, v120
  v_cndmask_b32 v55, v120, v55, s[70:71]
  v_cndmask_b32 v67, v120, v67, s[70:71]
  v_mov_b32 v63, v120
  s_branch Lk_M1
Lk_ev:
  s_cmp_eq_u32 s36, 2
  s_cbranch_scc1 Lk_ev54
  s_cmp_eq_u32 s36, 3
  s_cbranch_scc1 Lk_ev55
  s_cmp_eq_u32 s36, 4
  s_cbranch_scc1 Lk_ev56
  s_cmp_eq_u32 s36, 5
  s_cbranch_scc1 Lk_ev57
  s_cmp_eq_u32 s36, 6
  s_cbranch_scc1 Lk_ev58
  s_lshl_b32 s40, s50, 7
  v_mov_b32 v120, s40
  v_mov_b32 v121, 16
  buffer_load_dword v119, v120, s[20:23], 0 offen sc1
  s_branch Lk_ev59
Lk_ev54:
  s_lshl_b32 s40, s50, 7
  v_mov_b32 v120, s40
  v_mov_b32 v121, 16
  s_waitcnt vmcnt(8)
  v_cmp_lt_u32 vcc, v119, v121
  s_nop 4
  s_cbranch_vccz Lk_go61
  s_mov_b32 s43, 0
Lk_poll60:
  s_sleep 3
  buffer_load_dword v119, v120, s[20:23], 0 offen offset:0 sc1
  s_waitcnt vmcnt(0)
  v_cmp_lt_u32 vcc, v119, v121
  s_nop 4
  s_cbranch_vccz Lk_go61
  s_add_u32 s43, s43, 1
  s_cmp_lt_u32 s43, 0x40000
  s_cbranch_scc1 Lk_poll60
Lk_go61:
  s_cmp_eq_u32 s53, 0
  s_cbranch_scc1 Lk_pd44
  s_sub_u32 s34, s34, 7
  s_mov_b32 s33, 6
  s_branch Lk_pd45
Lk_ev55:
  v_and_b32 v120, 15, v1
  v_lshlrev_b32 v120, 7, v120
  v_add_u32 v120, 2048, v120
  v_mov_b32 v121, 16
  buffer_load_dword v119, v120, s[20:23], 0 offen sc1
  s_cmp_eq_u32 s48, 7
  s_cbranch_scc1 Lk_ev59
  s_lshl_b32 s41, s19, 10
  s_add_u32 s41, s41, 0x20000
  s_lshl_b32 s54, s48, 7
  s_add_u32 m0, s41, 0x0
  s_nop 0
  buffer_load_dwordx4 v80, s[4:7], s54 offen lds
  s_add_u32 s54, s54, 28672
  s_add_u32 m0, s41, 0x1000
  s_nop 0
  buffer_load_dwordx4 v80, s[4:7], s54 offen lds
  s_add_u32 s54, s54, 28672
  s_add_u32 m0, s41, 0x2000
  s_nop 0
  buffer_load_dwordx4 v80, s[4:7], s54 offen lds
  s_add_u32 s54, s54, 28672
  s_add_u32 m0, s41, 0x3000
  s_nop 0
  buffer_load_dwordx4 v80, s[4:7], s54 offen lds
  s_add_u32 s54, s54, 28672
  s_add_u32 m0, s41, 0x4000
  s_nop 0
  buffer_load_dwordx4 v80, s[4:7], s54 offen lds
  s_add_u32 s54, s54, 28672
  s_add_u32 m0, s41, 0x5000
  s_nop 0
  buffer_load_dwordx4 v80, s[4:7], s54 offen lds
  s_add_u32 s54, s54, 28672
  s_add_u32 m0, s41, 0x6000
  s_nop 0
  buffer_load_dwordx4 v80, s[4:7], s54 offen lds
  s_lshl_b32 s40, s48, 7
  s_add_u32 s41, s40, 14336
  buffer_load_dwordx4 v[68:71], v104, s[56:59], s40 offen offset:0
  buffer_load_dwordx4 v[72:75], v104, s[56:59], s40 offen offset:64
  buffer_load_dwordx4 v[84:87], v104, s[56:59], s41 offen offset:0
  buffer_load_dwordx4 v[108:111], v104, s[56:59], s41 offen offset:64
  s_branch Lk_ev59
Lk_ev56:
  v_and_b32 v120, 15, v1
  v_lshlrev_b32 v120, 7, v120
  v_add_u32 v120, 2048, v120
  v_mov_b32 v121, 16
  s_waitcnt vmcnt(8)
  v_cmp_lt_u32 vcc, v119, v121
  s_nop 4
  s_cbranch_vccz Lk_go63
  s_mov_b32 s43, 0
Lk_poll62:
  s_sleep 3
  buffer_load_dword v119, v120, s[20:23], 0 offen offset:0 sc1
  s_waitcnt vmcnt(0)
  v_cmp_lt_u32 vcc, v119, v121
  s_nop 4
  s_cbranch_vccz Lk_go63
  s_add_u32 s43, s43, 1
  s_cmp_lt_u32 s43, 0x40000
  s_cbranch_scc1 Lk_poll62
Lk_go63:
  s_lshl_b32 s41, s19, 10
  s_add_u32 m0, s41, 0x27000
  s_mul_i32 s40, s17, 896
  s_add_u32 s40, s40, 0x4e00000
  buffer_load_dwordx4 v2, s[28:31], s40 offen sc1 lds
  s_cmp_eq_u32 s48, 7
  s_cbranch_scc1 Lk_pd44
  s_mov_b32 s55, 0x0
  buffer_load_dwordx4 a[192:195], v81, s[60:63], s55 offen offset:16 sc1
  buffer_load_dwordx4 a[196:199], v81, s[60:63], s55 offen offset:272 sc1
  s_add_u32 s55, s55, 0x20200
  buffer_load_dwordx4 a[200:203], v81, s[60:63], s55 offen offset:16 sc1
  buffer_load_dwordx4 a[204:207], v81, s[60:63], s55 offen offset:272 sc1
  s_add_u32 s55, s55, 0x20200
  buffer_load_dwordx4 a[208:211], v81, s[60:63], s55 offen offset:16 sc1
  buffer_load_dwordx4 a[212:215], v81, s[60:63], s55 offen offset:272 sc1
  s_add_u32 s55, s55, 0x20200
  buffer_load_dwordx4 a[216:219], v82, s[60:63], s55 offen offset:0 sc1
  buffer_load_dwordx4 a[220:223], v82, s[60:63], s55 offen offset:256 sc1
  s_branch Lk_ev59
Lk_ev57:
  s_waitcnt vmcnt(12)
  s_waitcnt lgkmcnt(0)
  s_barrier
  s_cmp_eq_u32 s37, 0
  s_cselect_b32 s41, 0x8000, 0
  s_and_b32 s47, s77, 0x10000
  s_add_u32 s47, s47, s41
  s_lshl_b32 s41, s19, 10
  s_add_u32 s41, s41, s47
  v_bfe_u32 v120, v1, 2, 2
  v_lshrrev_b32 v121, 4, v1
  v_lshl_add_u32 v120, v121, 3, v120
  v_lshlrev_b32 v120, 7, v120
  v_and_b32 v121, 3, v1
  s_mov_b32 s55, 0x80800
  buffer_load_dwordx4 a[224:227], v81, s[60:63], s55 offen offset:48 sc1
  v_lshl_add_u32 v120, v121, 3, v120
  v_bfe_u32 v121, v1, 3, 2
  v_xor_b32 v122, 0, v121
  v_lshl_add_u32 v122, v122, 5, v120
  v_add_u32 v96, 0x20000, v122
  buffer_load_dwordx4 a[228:231], v81, s[60:63], s55 offen offset:304 sc1
  v_add_u32 v100, s47, v122
  v_xor_b32 v122, 1, v121
  v_lshl_add_u32 v122, v122, 5, v120
  v_add_u32 v97, 0x20000, v122
  v_add_u32 v101, s47, v122
  s_add_u32 s55, s55, 0x20200
  buffer_load_dwordx4 a[232:235], v81, s[60:63], s55 offen offset:48 sc1
  v_xor_b32 v122, 2, v121
  v_lshl_add_u32 v122, v122, 5, v120
  v_add_u32 v98, 0x20000, v122
  v_add_u32 v102, s47, v122
  v_xor_b32 v122, 3, v121
  buffer_load_dwordx4 a[236:239], v81, s[60:63], s55 offen offset:304 sc1
  v_lshl_add_u32 v122, v122, 5, v120
  v_add_u32 v99, 0x20000, v122
  v_add_u32 v103, s47, v122
  ds_read_b64_tr_b16 a[128:129], v96 offset:0
  ds_read_b64_tr_b16 a[130:131], v96 offset:512
  ds_read_b64_tr_b16 a[132:133], v97 offset:0
  ds_read_b64_tr_b16 a[134:135], v97 offset:512
  ds_read_b64_tr_b16 a[136:137], v98 offset:0
  ds_read_b64_tr_b16 a[138:139], v98 offset:512
  ds_read_b64_tr_b16 a[140:141], v99 offset:0
  ds_read_b64_tr_b16 a[142:143], v99 offset:512
  s_lshl_b32 s54, s48, 7
  s_add_u32 s54, s54, 200704
  s_add_u32 m0, s41, 0x0
  s_nop 0
  buffer_load_dwordx4 v80, s[4:7], s54 offen lds
  s_add_u32 s54, s54, 28672
  s_add_u32 m0, s41, 0x1000
  s_nop 0
  buffer_load_dwordx4 v80, s[4:7], s54 offen lds
  s_add_u32 s54, s54, 28672
  s_add_u32 m0, s41, 0x2000
  s_nop 0
  buffer_load_dwordx4 v80, s[4:7], s54 offen lds
  s_add_u32 s54, s54, 28672
  s_add_u32 m0, s41, 0x3000
  s_waitcnt vmcnt(22) lgkmcnt(6)
  v_mfma_f32_16x16x32_bf16 a[160:163], a[128:131], a[192:195], 0
  ds_read_b64_tr_b16 a[144:145], v96 offset:4096
  s_waitcnt vmcnt(21)
  v_mfma_f32_16x16x32_bf16 a[176:179], a[128:131], a[196:199], 0
  ds_read_b64_tr_b16 a[146:147], v96 offset:4608
  s_waitcnt lgkmcnt(6)
  v_mfma_f32_16x16x32_bf16 a[164:167], a[132:135], a[192:195], 0
  ds_read_b64_tr_b16 a[148:149], v97 offset:4096
  v_mfma_f32_16x16x32_bf16 a[180:183], a[132:135], a[196:199], 0
  ds_read_b64_tr_b16 a[150:151], v97 offset:4608
  s_waitcnt lgkmcnt(6)
  v_mfma_f32_16x16x32_bf16 a[168:171], a[136:139], a[192:195], 0
  ds_read_b64_tr_b16 a[152:153], v98 offset:4096
  v_mfma_f32_16x16x32_bf16 a[184:187], a[136:139], a[196:199], 0
  ds_read_b64_tr_b16 a[154:155], v98 offset:4608
  s_waitcnt lgkmcnt(6)
  v_mfma_f32_16x16x32_bf16 a[172:175], a[140:143], a[192:195], 0
  ds_read_b64_tr_b16 a[156:157], v99 offset:4096
  v_mfma_f32_16x16x32_bf16 a[188:191], a[140:143], a[196:199], 0
  ds_read_b64_tr_b16 a[158:159], v99 offset:4608
  buffer_load_dwordx4 v80, s[4:7], s54 offen lds
  s_add_u32 s54, s54, 28672
  s_add_u32 m0, s41, 0x4000
  s_nop 0
  buffer_load_dwordx4 v80, s[4:7], s54 offen lds
  s_add_u32 s54, s54, 28672
  s_add_u32 m0, s41, 0x5000
  s_nop 0
  buffer_load_dwordx4 v80, s[4:7], s54 offen lds
  s_add_u32 s54, s54, 28672
  s_add_u32 m0, s41, 0x6000
  s_waitcnt vmcnt(23) lgkmcnt(6)
  v_mfma_f32_16x16x32_bf16 a[160:163], a[144:147], a[200:203], a[160:163]
  ds_read_b64_tr_b16 a[128:129], v96 offset:8192
  s_waitcnt vmcnt(22)
  v_mfma_f32_16x16x32_bf16 a[176:179], a[144:147], a[204:207], a[176:179]
  ds_read_b64_tr_b16 a[130:131], v96 offset:8704
  s_waitcnt lgkmcnt(6)
  v_mfma_f32_16x16x32_bf16 a[164:167], a[148:151], a[200:203], a[164:167]
  ds_read_b64_tr_b16 a[132:133], v97 offset:8192
  v_mfma_f32_16x16x32_bf16 a[180:183], a[148:151], a[204:207], a[180:183]
  ds_read_b64_tr_b16 a[134:135], v97 offset:8704
  s_waitcnt lgkmcnt(6)
  v_mfma_f32_16x16x32_bf16 a[168:171], a[152:155], a[200:203], a[168:171]
  ds_read_b64_tr_b16 a[136:137], v98 offset:8192
  v_mfma_f32_16x16x32_bf16 a[184:187], a[152:155], a[204:207], a[184:187]
  ds_read_b64_tr_b16 a[138:139], v98 offset:8704
  s_waitcnt lgkmcnt(6)
  v_mfma_f32_16x16x32_bf16 a[172:175], a[156:159], a[200:203], a[172:175]
  ds_read_b64_tr_b16 a[140:141], v99 offset:8192
  v_mfma_f32_16x16x32_bf16 a[188:191], a[156:159], a[204:207], a[188:191]
  ds_read_b64_tr_b16 a[142:143], v99 offset:8704
  buffer_load_dwordx4 v80, s[4:7], s54 offen lds
  s_mov_b32 s55, 0xc0c00
  buffer_load_dwordx4 a[240:243], v81, s[60:63], s55 offen offset:48 sc1
  buffer_load_dwordx4 a[244:247], v81, s[60:63], s55 offen offset:304 sc1
  s_add_u32 s55, s55, 0x20200
  s_waitcnt vmcnt(24) lgkmcnt(6)
  v_mfma_f32_16x16x32_bf16 a[160:163], a[128:131], a[208:211], a[160:163]
  ds_read_b64_tr_b16 a[144:145], v96 offset:12288
  s_waitcnt vmcnt(23)
  v_mfma_f32_16x16x32_bf16 a[176:179], a[128:131], a[212:215], a[176:179]
  ds_read_b64_tr_b16 a[146:147], v96 offset:12800
  s_waitcnt lgkmcnt(6)
  v_mfma_f32_16x16x32_bf16 a[164:167], a[132:135], a[208:211], a[164:167]
  ds_read_b64_tr_b16 a[148:149], v97 offset:12288
  v_mfma_f32_16x16x32_bf16 a[180:183], a[132:135], a[212:215], a[180:183]
  ds_read_b64_tr_b16 a[150:151], v97 offset:12800
  s_waitcnt lgkmcnt(6)
  v_mfma_f32_16x16x32_bf16 a[168:171], a[136:139], a[208:211], a[168:171]
  ds_read_b64_tr_b16 a[152:153], v98 offset:12288
  v_mfma_f32_16x16x32_bf16 a[184:187], a[136:139], a[212:215], a[184:187]
  ds_read_b64_tr_b16 a[154:155], v98 offset:12800
  s_waitcnt lgkmcnt(6)
  v_mfma_f32_16x16x32_bf16 a[172:175], a[140:143], a[208:211], a[172:175]
  ds_read_b64_tr_b16 a[156:157], v99 offset:12288
  v_mfma_f32_16x16x32_bf16 a[188:191], a[140:143], a[212:215], a[188:191]
  ds_read_b64_tr_b16 a[158:159], v99 offset:12800
  buffer_load_dwordx4 a[248:251], v81, s[60:63], s55 offen offset:0 sc1
  buffer_load_dwordx4 a[252:255], v81, s[60:63], s55 offen offset:256 sc1
  s_mov_b32 s55, 0x101000
  buffer_load_dwordx4 a[192:195], v81, s[60:63], s55 offen offset:0 sc1
  s_waitcnt vmcnt(25) lgkmcnt(6)
  v_mfma_f32_16x16x32_bf16 a[160:163], a[144:147], a[216:219], a[160:163]
  ds_read_b64_tr_b16 a[128:129], v96 offset:16384
  s_waitcnt vmcnt(24)
  v_mfma_f32_16x16x32_bf16 a[176:179], a[144:147], a[220:223], a[176:179]
  ds_read_b64_tr_b16 a[130:131], v96 offset:16896
  s_waitcnt lgkmcnt(6)
  v_mfma_f32_16x16x32_bf16 a[164:167], a[148:151], a[216:219], a[164:167]
  ds_read_b64_tr_b16 a[132:133], v97 offset:16384
  v_mfma_f32_16x16x32_bf16 a[180:183], a[148:151], a[220:223], a[180:183]
  ds_read_b64_tr_b16 a[134:135], v97 offset:16896
  s_waitcnt lgkmcnt(6)
  v_mfma_f32_16x16x32_bf16 a[168:171], a[152:155], a[216:219], a[168:171]
  ds_read_b64_tr_b16 a[136:137], v98 offset:16384
  v_mfma_f32_16x16x32_bf16 a[184:187], a[152:155], a[220:223], a[184:187]
  ds_read_b64_tr_b16 a[138:139], v98 offset:16896
  s_waitcnt lgkmcnt(6)
  v_mfma_f32_16x16x32_bf16 a[172:175], a[156:159], a[216:219], a[172:175]
  ds_read_b64_tr_b16 a[140:141], v99 offset:16384
  v_mfma_f32_16x16x32_bf16 a[188:191], a[156:159], a[220:223], a[188:191]
  ds_read_b64_tr_b16 a[142:143], v99 offset:16896
  buffer_load_dwordx4 a[196:199], v81, s[60:63], s55 offen offset:256 sc1
  s_mov_b32 s55, 0x121200
  buffer_load_dwordx4 a[200:203], v81, s[60:63], s55 offen offset:0 sc1
  buffer_load_dwordx4 a[204:207], v81, s[60:63], s55 offen offset:256 sc1
  s_mov_b32 s55, 0x141400
  s_waitcnt vmcnt(18) lgkmcnt(6)
  v_mfma_f32_16x16x32_bf16 a[160:163], a[128:131], a[224:227], a[160:163]
  ds_read_b64_tr_b16 a[144:145], v96 offset:20480
  s_waitcnt vmcnt(17)
  v_mfma_f32_16x16x32_bf16 a[176:179], a[128:131], a[228:231], a[176:179]
  ds_read_b64_tr_b16 a[146:147], v96 offset:20992
  s_waitcnt lgkmcnt(6)
  v_mfma_f32_16x16x32_bf16 a[164:167], a[132:135], a[224:227], a[164:167]
  ds_read_b64_tr_b16 a[148:149], v97 offset:20480
  v_mfma_f32_16x16x32_bf16 a[180:183], a[132:135], a[228:231], a[180:183]
  ds_read_b64_tr_b16 a[150:151], v97 offset:20992
  s_waitcnt lgkmcnt(6)
  v_mfma_f32_16x16x32_bf16 a[168:171], a[136:139], a[224:227], a[168:171]
  ds_read_b64_tr_b16 a[152:153], v98 offset:20480
  v_mfma_f32_16x16x32_bf16 a[184:187], a[136:139], a[228:231], a[184:187]
  ds_read_b64_tr_b16 a[154:155], v98 offset:20992
  s_waitcnt lgkmcnt(6)
  v_mfma_f32_16x16x32_bf16 a[172:175], a[140:143], a[224:227], a[172:175]
  ds_read_b64_tr_b16 a[156:157], v99 offset:20480
  v_mfma_f32_16x16x32_bf16 a[188:191], a[140:143], a[228:231], a[188:191]
  ds_read_b64_tr_b16 a[158:159], v99 offset:20992
  buffer_load_dwordx4 a[208:211], v83, s[60:63], s55 offen offset:0 sc1
  buffer_load_dwordx4 a[212:215], v83, s[60:63], s55 offen offset:256 sc1
  s_mov_b32 s55, 0x161600
  buffer_load_dwordx4 a[216:219], v81, s[60:63], s55 offen offset:64 sc1
  s_waitcnt vmcnt(19) lgkmcnt(6)
  v_mfma_f32_16x16x32_bf16 a[160:163], a[144:147], a[232:235], a[160:163]
  ds_read_b64_tr_b16 a[128:129], v96 offset:24576
  s_waitcnt vmcnt(18)
  v_mfma_f32_16x16x32_bf16 a[176:179], a[144:147], a[236:239], a[176:179]
  ds_read_b64_tr_b16 a[130:131], v96 offset:25088
  s_waitcnt lgkmcnt(6)
  v_mfma_f32_16x16x32_bf16 a[164:167], a[148:151], a[232:235], a[164:167]
  ds_read_b64_tr_b16 a[132:133], v97 offset:24576
  v_mfma_f32_16x16x32_bf16 a[180:183], a[148:151], a[236:239], a[180:183]
  ds_read_b64_tr_b16 a[134:135], v97 offset:25088
  s_waitcnt lgkmcnt(6)
  v_mfma_f32_16x16x32_bf16 a[168:171], a[152:155], a[232:235], a[168:171]
  ds_read_b64_tr_b16 a[136:137], v98 offset:24576
  v_mfma_f32_16x16x32_bf16 a[184:187], a[152:155], a[236:239], a[184:187]
  ds_read_b64_tr_b16 a[138:139], v98 offset:25088
  s_waitcnt lgkmcnt(6)
  v_mfma_f32_16x16x32_bf16 a[172:175], a[156:159], a[232:235], a[172:175]
  ds_read_b64_tr_b16 a[140:141], v99 offset:24576
  v_mfma_f32_16x16x32_bf16 a[188:191], a[156:159], a[236:239], a[188:191]
  ds_read_b64_tr_b16 a[142:143], v99 offset:25088
  s_waitcnt vmcnt(11)
  s_barrier
  buffer_load_dwordx4 a[220:223], v81, s[60:63], s55 offen offset:320 sc1
  s_mov_b32 s55, 0x181800
  buffer_load_dwordx4 a[224:227], v81, s[60:63], s55 offen offset:64 sc1
  buffer_load_dwordx4 a[228:231], v81, s[60:63], s55 offen offset:320 sc1
  s_mov_b32 s55, 0x1a1a00
  s_waitcnt vmcnt(13) lgkmcnt(6)
  v_mfma_f32_16x16x32_bf16 a[160:163], a[128:131], a[240:243], a[160:163]
  ds_read_b64_tr_b16 a[144:145], v100 offset:0
  s_waitcnt vmcnt(12)
  v_mfma_f32_16x16x32_bf16 a[176:179], a[128:131], a[244:247], a[176:179]
  ds_read_b64_tr_b16 a[146:147], v100 offset:512
  s_waitcnt lgkmcnt(6)
  v_mfma_f32_16x16x32_bf16 a[164:167], a[132:135], a[240:243], a[164:167]
  ds_read_b64_tr_b16 a[148:149], v101 offset:0
  v_mfma_f32_16x16x32_bf16 a[180:183], a[132:135], a[244:247], a[180:183]
  ds_read_b64_tr_b16 a[150:151], v101 offset:512
  s_waitcnt lgkmcnt(6)
  v_mfma_f32_16x16x32_bf16 a[168:171], a[136:139], a[240:243], a[168:171]
  ds_read_b64_tr_b16 a[152:153], v102 offset:0
  v_mfma_f32_16x16x32_bf16 a[184:187], a[136:139], a[244:247], a[184:187]
  ds_read_b64_tr_b16 a[154:155], v102 offset:512
  s_waitcnt lgkmcnt(6)
  v_mfma_f32_16x16x32_bf16 a[172:175], a[140:143], a[240:243], a[172:175]
  ds_read_b64_tr_b16 a[156:157], v103 offset:0
  v_mfma_f32_16x16x32_bf16 a[188:191], a[140:143], a[244:247], a[188:191]
  ds_read_b64_tr_b16 a[158:159], v103 offset:512
  buffer_load_dwordx4 a[232:235], v81, s[60:63], s55 offen offset:64 sc1
  buffer_load_dwordx4 a[236:239], v81, s[60:63], s55 offen offset:320 sc1
  s_waitcnt vmcnt(13) lgkmcnt(6)
  v_mfma_f32_16x16x32_bf16 a[160:163], a[144:147], a[248:251], a[160:163]
  ds_read_b64_tr_b16 a[128:129], v100 offset:4096
  s_waitcnt vmcnt(12)
  v_mfma_f32_16x16x32_bf16 a[176:179], a[144:147], a[252:255], a[176:179]
  ds_read_b64_tr_b16 a[130:131], v100 offset:4608
  s_waitcnt lgkmcnt(6)
  v_mfma_f32_16x16x32_bf16 a[164:167], a[148:151], a[248:251], a[164:167]
  ds_read_b64_tr_b16 a[132:133], v101 offset:4096
  v_mfma_f32_16x16x32_bf16 a[180:183], a[148:151], a[252:255], a[180:183]
  ds_read_b64_tr_b16 a[134:135], v101 offset:4608
  s_waitcnt lgkmcnt(6)
  v_mfma_f32_16x16x32_bf16 a[168:171], a[152:155], a[248:251], a[168:171]
  ds_read_b64_tr_b16 a[136:137], v102 offset:4096
  v_mfma_f32_16x16x32_bf16 a[184:187], a[152:155], a[252:255], a[184:187]
  ds_read_b64_tr_b16 a[138:139], v102 offset:4608
  s_waitcnt lgkmcnt(6)
  v_mfma_f32_16x16x32_bf16 a[172:175], a[156:159], a[248:251], a[172:175]
  ds_read_b64_tr_b16 a[140:141], v103 offset:4096
  v_mfma_f32_16x16x32_bf16 a[188:191], a[156:159], a[252:255], a[188:191]
  ds_read_b64_tr_b16 a[142:143], v103 offset:4608
  s_waitcnt vmcnt(11) lgkmcnt(6)
  v_mfma_f32_16x16x32_bf16 a[160:163], a[128:131], a[192:195], a[160:163]
  ds_read_b64_tr_b16 a[144:145], v100 offset:8192
  s_waitcnt vmcnt(10)
  v_mfma_f32_16x16x32_bf16 a[176:179], a[128:131], a[196:199], a[176:179]
  ds_read_b64_tr_b16 a[146:147], v100 offset:8704
  s_waitcnt lgkmcnt(6)
  v_mfma_f32_16x16x32_bf16 a[164:167], a[132:135], a[192:195], a[164:167]
  ds_read_b64_tr_b16 a[148:149], v101 offset:8192
  v_mfma_f32_16x16x32_bf16 a[180:183], a[132:135], a[196:199], a[180:183]
  ds_read_b64_tr_b16 a[150:151], v101 offset:8704
  s_waitcnt lgkmcnt(6)
  v_mfma_f32_16x16x32_bf16 a[168:171], a[136:139], a[192:195], a[168:171]
  ds_read_b64_tr_b16 a[152:153], v102 offset:8192
  v_mfma_f32_16x16x32_bf16 a[184:187], a[136:139], a[196:199], a[184:187]
  ds_read_b64_tr_b16 a[154:155], v102 offset:8704
  s_waitcnt lgkmcnt(6)
  v_mfma_f32_16x16x32_bf16 a[172:175], a[140:143], a[192:195], a[172:175]
  ds_read_b64_tr_b16 a[156:157], v103 offset:8192
  v_mfma_f32_16x16x32_bf16 a[188:191], a[140:143], a[196:199], a[188:191]
  ds_read_b64_tr_b16 a[158:159], v103 offset:8704
  s_waitcnt vmcnt(9) lgkmcnt(6)
  v_mfma_f32_16x16x32_bf16 a[160:163], a[144:147], a[200:203], a[160:163]
  ds_read_b64_tr_b16 a[128:129], v100 offset:12288
  s_waitcnt vmcnt(8)
  v_mfma_f32_16x16x32_bf16 a[176:179], a[144:147], a[204:207], a[176:179]
  ds_read_b64_tr_b16 a[130:131], v100 offset:12800
  s_waitcnt lgkmcnt(6)
  v_mfma_f32_16x16x32_bf16 a[164:167], a[148:151], a[200:203], a[164:167]
  ds_read_b64_tr_b16 a[132:133], v101 offset:12288
  v_mfma_f32_16x16x32_bf16 a[180:183], a[148:151], a[204:207], a[180:183]
  ds_read_b64_tr_b16 a[134:135], v101 offset:12800
  s_waitcnt lgkmcnt(6)
  v_mfma_f32_16x16x32_bf16 a[168:171], a[152:155], a[200:203], a[168:171]
  ds_read_b64_tr_b16 a[136:137], v102 offset:12288
  v_mfma_f32_16x16x32_bf16 a[184:187], a[152:155], a[204:207], a[184:187]
  ds_read_b64_tr_b16 a[138:139], v102 offset:12800
  s_waitcnt lgkmcnt(6)
  v_mfma_f32_16x16x32_bf16 a[172:175], a[156:159], a[200:203], a[172:175]
  ds_read_b64_tr_b16 a[140:141], v103 offset:12288
  v_mfma_f32_16x16x32_bf16 a[188:191], a[156:159], a[204:207], a[188:191]
  ds_read_b64_tr_b16 a[142:143], v103 offset:12800
  s_waitcnt vmcnt(7) lgkmcnt(6)
  v_mfma_f32_16x16x32_bf16 a[160:163], a[128:131], a[208:211], a[160:163]
  ds_read_b64_tr_b16 a[144:145], v100 offset:16384
  s_waitcnt vmcnt(6)
  v_mfma_f32_16x16x32_bf16 a[176:179], a[128:131], a[212:215], a[176:179]
  ds_read_b64_tr_b16 a[146:147], v100 offset:16896
  s_waitcnt lgkmcnt(6)
  v_mfma_f32_16x16x32_bf16 a[164:167], a[132:135], a[208:211], a[164:167]
  ds_read_b64_tr_b16 a[148:149], v101 offset:16384
  v_mfma_f32_16x16x32_bf16 a[180:183], a[132:135], a[212:215], a[180:183]
  ds_read_b64_tr_b16 a[150:151], v101 offset:16896
  s_waitcnt lgkmcnt(6)
  v_mfma_f32_16x16x32_bf16 a[168:171], a[136:139], a[208:211], a[168:171]
  ds_read_b64_tr_b16 a[152:153], v102 offset:16384
  v_mfma_f32_16x16x32_bf16 a[184:187], a[136:139], a[212:215], a[184:187]
  ds_read_b64_tr_b16 a[154:155], v102 offset:16896
  s_waitcnt lgkmcnt(6)
  v_mfma_f32_16x16x32_bf16 a[172:175], a[140:143], a[208:211], a[172:175]
  ds_read_b64_tr_b16 a[156:157], v103 offset:16384
  v_mfma_f32_16x16x32_bf16 a[188:191], a[140:143], a[212:215], a[188:191]
  ds_read_b64_tr_b16 a[158:159], v103 offset:16896
  s_waitcnt vmcnt(5) lgkmcnt(6)
  v_mfma_f32_16x16x32_bf16 a[160:163], a[144:147], a[216:219], a[160:163]
  ds_read_b64_tr_b16 a[128:129], v100 offset:20480
  s_waitcnt vmcnt(4)
  v_mfma_f32_16x16x32_bf16 a[176:179], a[144:147], a[220:223], a[176:179]
  ds_read_b64_tr_b16 a[130:131], v100 offset:20992
  s_waitcnt lgkmcnt(6)
  v_mfma_f32_16x16x32_bf16 a[164:167], a[148:151], a[216:219], a[164:167]
  ds_read_b64_tr_b16 a[132:133], v101 offset:20480
  v_mfma_f32_16x16x32_bf16 a[180:183], a[148:151], a[220:223], a[180:183]
  ds_read_b64_tr_b16 a[134:135], v101 offset:20992
  s_waitcnt lgkmcnt(6)
  v_mfma_f32_16x16x32_bf16 a[168:171], a[152:155], a[216:219], a[168:171]
  ds_read_b64_tr_b16 a[136:137], v102 offset:20480
  v_mfma_f32_16x16x32_bf16 a[184:187], a[152:155], a[220:223], a[184:187]
  ds_read_b64_tr_b16 a[138:139], v102 offset:20992
  s_waitcnt lgkmcnt(6)
  v_mfma_f32_16x16x32_bf16 a[172:175], a[156:159], a[216:219], a[172:175]
  ds_read_b64_tr_b16 a[140:141], v103 offset:20480
  v_mfma_f32_16x16x32_bf16 a[188:191], a[156:159], a[220:223], a[188:191]
  ds_read_b64_tr_b16 a[142:143], v103 offset:20992
  s_waitcnt vmcnt(3) lgkmcnt(6)
  v_mfma_f32_16x16x32_bf16 a[160:163], a[128:131], a[224:227], a[160:163]
  ds_read_b64_tr_b16 a[144:145], v100 offset:24576
  v_permlane16_swap_b32 v68, v70
  s_waitcnt vmcnt(2)
  v_mfma_f32_16x16x32_bf16 a[176:179], a[128:131], a[228:231], a[176:179]
  ds_read_b64_tr_b16 a[146:147], v100 offset:25088
  v_permlane16_swap_b32 v69, v71
  s_waitcnt lgkmcnt(6)
  v_mfma_f32_16x16x32_bf16 a[164:167], a[132:135], a[224:227], a[164:167]
  ds_read_b64_tr_b16 a[148:149], v101 offset:24576
  v_permlane16_swap_b32 v72, v74
  v_mfma_f32_16x16x32_bf16 a[180:183], a[132:135], a[228:231], a[180:183]
  ds_read_b64_tr_b16 a[150:151], v101 offset:25088
  v_permlane16_swap_b32 v73, v75
  s_waitcnt lgkmcnt(6)
  v_mfma_f32_16x16x32_bf16 a[168:171], a[136:139], a[224:227], a[168:171]
  ds_read_b64_tr_b16 a[152:153], v102 offset:24576
  v_permlane16_swap_b32 v84, v86
  v_mfma_f32_16x16x32_bf16 a[184:187], a[136:139], a[228:231], a[184:187]
  ds_read_b64_tr_b16 a[154:155], v102 offset:25088
  v_permlane16_swap_b32 v85, v87
  s_waitcnt lgkmcnt(6)
  v_mfma_f32_16x16x32_bf16 a[172:175], a[140:143], a[224:227], a[172:175]
  ds_read_b64_tr_b16 a[156:157], v103 offset:24576
  v_permlane16_swap_b32 v108, v110
  v_mfma_f32_16x16x32_bf16 a[188:191], a[140:143], a[228:231], a[188:191]
  ds_read_b64_tr_b16 a[158:159], v103 offset:25088
  v_permlane16_swap_b32 v109, v111
  s_waitcnt vmcnt(1) lgkmcnt(6)
  v_mfma_f32_16x16x32_bf16 a[160:163], a[144:147], a[232:235], a[160:163]
  s_waitcnt vmcnt(0)
  v_mfma_f32_16x16x32_bf16 a[176:179], a[144:147], a[236:239], a[176:179]
  s_waitcnt lgkmcnt(4)
  v_mfma_f32_16x16x32_bf16 a[164:167], a[148:151], a[232:235], a[164:167]
  v_mfma_f32_16x16x32_bf16 a[180:183], a[148:151], a[236:239], a[180:183]
  s_waitcnt lgkmcnt(2)
  v_mfma_f32_16x16x32_bf16 a[168:171], a[152:155], a[232:235], a[168:171]
  v_mfma_f32_16x16x32_bf16 a[184:187], a[152:155], a[236:239], a[184:187]
  s_waitcnt lgkmcnt(0)
  v_mfma_f32_16x16x32_bf16 a[172:175], a[156:159], a[232:235], a[172:175]
  v_mfma_f32_16x16x32_bf16 a[188:191], a[156:159], a[236:239], a[188:191]
  v_mov_b32 v123, 0x3f803f80
  v_mov_b32 v104, 0
  v_mov_b32 v105, 0
  v_mov_b32 v106, 0
  v_mov_b32 v107, 0
  s_lshl_b32 s40, s17, 3
  s_lshl_b32 s41, s19, 1
  s_add_u32 s40, s40, s41
  s_mul_i32 s41, s40, 7
  s_add_u32 s41, s41, s48
  s_lshl_b32 s41, s41, 11
  s_add_u32 s41, s41, 0x4a00000
  v_lshlrev_b32 v96, 16, v68
  v_and_b32 v97, 0xffff0000, v68
  v_lshlrev_b32 v98, 16, v69
  v_and_b32 v99, 0xffff0000, v69
  v_accvgpr_read_b32 v100, a160
  v_accvgpr_read_b32 v101, a161
  v_accvgpr_read_b32 v102, a162
  v_accvgpr_read_b32 v103, a163
  v_pk_add_f32 v[100:101], v[100:101], v[96:97]
  v_pk_add_f32 v[102:103], v[102:103], v[98:99]
  v_cvt_pk_bf16_f32 v68, v100, v101
  v_cvt_pk_bf16_f32 v69, v102, v103
  v_lshlrev_b32 v96, 16, v70
  v_and_b32 v97, 0xffff0000, v70
  v_lshlrev_b32 v98, 16, v71
  v_and_b32 v99, 0xffff0000, v71
  v_accvgpr_read_b32 v100, a164
  v_accvgpr_read_b32 v101, a165
  v_accvgpr_read_b32 v102, a166
  v_accvgpr_read_b32 v103, a167
  v_pk_add_f32 v[100:101], v[100:101], v[96:97]
  v_pk_add_f32 v[102:103], v[102:103], v[98:99]
  v_cvt_pk_bf16_f32 v70, v100, v101
  v_cvt_pk_bf16_f32 v71, v102, v103
  buffer_store_dwordx4 v[68:71], v2, s[28:31], s41 offen offset:0 sc1
  v_dot2c_f32_bf16 v104, v68, v123
  v_dot2c_f32_bf16 v105, v68, v68
  v_dot2c_f32_bf16 v104, v69, v123
  v_dot2c_f32_bf16 v105, v69, v69
  v_dot2c_f32_bf16 v104, v70, v123
  v_dot2c_f32_bf16 v105, v70, v70
  v_dot2c_f32_bf16 v104, v71, v123
  v_dot2c_f32_bf16 v105, v71, v71
  v_lshlrev_b32 v96, 16, v72
  v_and_b32 v97, 0xffff0000, v72
  v_lshlrev_b32 v98, 16, v73
  v_and_b32 v99, 0xffff0000, v73
  v_accvgpr_read_b32 v100, a168
  v_accvgpr_read_b32 v101, a169
  v_accvgpr_read_b32 v102, a170
  v_accvgpr_read_b32 v103, a171
  v_pk_add_f32 v[100:101], v[100:101], v[96:97]
  v_pk_add_f32 v[102:103], v[102:103], v[98:99]
  v_cvt_pk_bf16_f32 v72, v100, v101
  v_cvt_pk_bf16_f32 v73, v102, v103
  v_lshlrev_b32 v96, 16, v74
  v_and_b32 v97, 0xffff0000, v74
  v_lshlrev_b32 v98, 16, v75
  v_and_b32 v99, 0xffff0000, v75
  v_accvgpr_read_b32 v100, a172
  v_accvgpr_read_b32 v101, a173
  v_accvgpr_read_b32 v102, a174
  v_accvgpr_read_b32 v103, a175
  v_pk_add_f32 v[100:101], v[100:101], v[96:97]
  v_pk_add_f32 v[102:103], v[102:103], v[98:99]
  v_cvt_pk_bf16_f32 v74, v100, v101
  v_cvt_pk_bf16_f32 v75, v102, v103
  buffer_store_dwordx4 v[72:75], v2, s[28:31], s41 offen offset:1024 sc1
  v_dot2c_f32_bf16 v104, v72, v123
  v_dot2c_f32_bf16 v105, v72, v72
  v_dot2c_f32_bf16 v104, v73, v123
  v_dot2c_f32_bf16 v105, v73, v73
  v_dot2c_f32_bf16 v104, v74, v123
  v_dot2c_f32_bf16 v105, v74, v74
  v_dot2c_f32_bf16 v104, v75, v123
  v_dot2c_f32_bf16 v105, v75, v75
  s_add_u32 s41, s41, 14336
  v_lshlrev_b32 v96, 16, v84
  v_and_b32 v97, 0xffff0000, v84
  v_lshlrev_b32 v98, 16, v85
  v_and_b32 v99, 0xffff0000, v85
  v_accvgpr_read_b32 v100, a176
  v_accvgpr_read_b32 v101, a177
  v_accvgpr_read_b32 v102, a178
  v_accvgpr_read_b32 v103, a179
  v_pk_add_f32 v[100:101], v[100:101], v[96:97]
  v_pk_add_f32 v[102:103], v[102:103], v[98:99]
  v_cvt_pk_bf16_f32 v84, v100, v101
  v_cvt_pk_bf16_f32 v85, v102, v103
  v_lshlrev_b32 v96, 16, v86
  v_and_b32 v97, 0xffff0000, v86
  v_lshlrev_b32 v98, 16, v87
  v_and_b32 v99, 0xffff0000, v87
  v_accvgpr_read_b32 v100, a180
  v_accvgpr_read_b32 v101, a181
  v_accvgpr_read_b32 v102, a182
  v_accvgpr_read_b32 v103, a183
  v_pk_add_f32 v[100:101], v[100:101], v[96:97]
  v_pk_add_f32 v[102:103], v[102:103], v[98:99]
  v_cvt_pk_bf16_f32 v86, v100, v101
  v_cvt_pk_bf16_f32 v87, v102, v103
  buffer_store_dwordx4 v[84:87], v2, s[28:31], s41 offen offset:0 sc1
  v_dot2c_f32_bf16 v106, v84, v123
  v_dot2c_f32_bf16 v107, v84, v84
  v_dot2c_f32_bf16 v106, v85, v123
  v_dot2c_f32_bf16 v107, v85, v85
  v_dot2c_f32_bf16 v106, v86, v123
  v_dot2c_f32_bf16 v107, v86, v86
  v_dot2c_f32_bf16 v106, v87, v123
  v_dot2c_f32_bf16 v107, v87, v87
  v_lshlrev_b32 v96, 16, v108
  v_and_b32 v97, 0xffff0000, v108
  v_lshlrev_b32 v98, 16, v109
  v_and_b32 v99, 0xffff0000, v109
  v_accvgpr_read_b32 v100, a184
  v_accvgpr_read_b32 v101, a185
  v_accvgpr_read_b32 v102, a186
  v_accvgpr_read_b32 v103, a187
  v_pk_add_f32 v[100:101], v[100:101], v[96:97]
  v_pk_add_f32 v[102:103], v[102:103], v[98:99]
  v_cvt_pk_bf16_f32 v108, v100, v101
  v_cvt_pk_bf16_f32 v109, v102, v103
  v_lshlrev_b32 v96, 16, v110
  v_and_b32 v97, 0xffff0000, v110
  v_lshlrev_b32 v98, 16, v111
  v_and_b32 v99, 0xffff0000, v111
  v_accvgpr_read_b32 v100, a188
  v_accvgpr_read_b32 v101, a189
  v_accvgpr_read_b32 v102, a190
  v_accvgpr_read_b32 v103, a191
  v_pk_add_f32 v[100:101], v[100:101], v[96:97]
  v_pk_add_f32 v[102:103], v[102:103], v[98:99]
  v_cvt_pk_bf16_f32 v110, v100, v101
  v_cvt_pk_bf16_f32 v111, v102, v103
  buffer_store_dwordx4 v[108:111], v2, s[28:31], s41 offen offset:1024 sc1
  v_dot2c_f32_bf16 v106, v108, v123
  v_dot2c_f32_bf16 v107, v108, v108
  v_dot2c_f32_bf16 v106, v109, v123
  v_dot2c_f32_bf16 v107, v109, v109
  v_dot2c_f32_bf16 v106, v110, v123
  v_dot2c_f32_bf16 v107, v110, v110
  v_dot2c_f32_bf16 v106, v111, v123
  v_dot2c_f32_bf16 v107, v111, v111
  v_mov_b32 v96, v104
  v_mov_b32 v97, v105
  v_mov_b32 v98, v106
  v_mov_b32 v99, v107
  v_permlane32_swap_b32 v104, v96
  v_permlane32_swap_b32 v105, v97
  v_permlane32_swap_b32 v106, v98
  v_permlane32_swap_b32 v107, v99
  v_add_f32 v104, v104, v96
  v_add_f32 v105, v105, v97
  v_add_f32 v106, v106, v98
  v_add_f32 v107, v107, v99
  v_mov_b32 v96, v104
  v_mov_b32 v97, v105
  v_mov_b32 v98, v106
  v_mov_b32 v99, v107
  v_permlane16_swap_b32 v104, v96
  v_permlane16_swap_b32 v105, v97
  v_permlane16_swap_b32 v106, v98
  v_permlane16_swap_b32 v107, v99
  v_add_f32 v104, v104, v96
  v_add_f32 v105, v105, v97
  v_add_f32 v106, v106, v98
  v_add_f32 v107, v107, v99
  s_lshl_b32 s40, s40, 2
  s_add_u32 s40, s40, s48
  s_lshl_b32 s40, s40, 8
  s_add_u32 s40, s40, 0x4d00000
  s_mov_b64 exec, 0xffff
  buffer_store_dwordx4 v[104:107], v2, s[28:31], s40 offen sc1
  s_mov_b64 exec, -1
  s_sub_u32 s34, s34, 3
  s_mov_b32 s33, 2
  s_branch Lk_pd45
Lk_ev58:
  s_add_u32 s40, s17, 32
  s_lshl_b32 s40, s40, 7
  s_cmp_lg_u32 s19, 0
  s_cbranch_scc1 Lk_sig64
  v_mov_b32 v120, 1
  s_mov_b64 exec, 1
  buffer_atomic_add v120, off, s[20:23], s40 sc1
  s_mov_b64 exec, -1
Lk_sig64:
Lk_pd44:
  s_sub_u32 s36, 7, s98
  s_cmp_eq_u32 s34, 0
  s_cbranch_scc1 Lk_tl65
  s_add_u32 s40, s98, 1
  s_sub_u32 s33, s34, s40
  s_cbranch_scc0 Lk_pd45
  s_cmp_eq_u32 s37, 0
  s_cbranch_scc1 Lk_H0
  s_branch Lk_H1
Lk_tl65:
  s_cmp_eq_u32 s37, 0
  s_cbranch_scc1 Lk_T0
  s_branch Lk_T1
Lk_ev59:
  s_sub_u32 s34, s34, 1
Lk_pd45:
  s_cmp_eq_u32 s37, 0
  s_cbranch_scc1 Lk_M0
  s_branch Lk_M1
.p2align 6
Lk_M0:
  s_waitcnt vmcnt(16) lgkmcnt(0)
  s_barrier
  v_mfma_f32_16x16x32_bf16 v[4:7], a[64:67], a[0:3], v[52:55]
  s_add_u32 m0, s77, 0xc000
  ds_read_b128 a[128:131], v116 offset:16384
  v_mfma_f32_16x16x32_bf16 v[4:7], a[68:71], a[4:7], v[4:7]
  ds_read_b128 a[132:135], v116 offset:17408
  v_mfma_f32_16x16x32_bf16 v[4:7], a[72:75], a[8:11], v[4:7]
  buffer_load_dwordx4 v3, s[12:15], s39 offen offset:0 sc1 lds
  v_mfma_f32_16x16x32_bf16 v[4:7], a[76:79], a[12:15], v[4:7]
  ds_read_b128 a[136:139], v116 offset:18432
  v_mfma_f32_16x16x32_bf16 v[4:7], a[80:83], a[16:19], v[4:7]
  v_exp_f32 v98, v30
  v_mfma_f32_16x16x32_bf16 v[4:7], a[84:87], a[20:23], v[4:7]
  ds_read_b128 a[140:143], v116 offset:19456
  v_mfma_f32_16x16x32_bf16 v[4:7], a[88:91], a[24:27], v[4:7]
  v_exp_f32 v99, v31
  v_mfma_f32_16x16x32_bf16 v[4:7], a[92:95], a[28:31], v[4:7]
  ds_read_b128 a[144:147], v116 offset:20480
  v_add_f32 v78, v78, v98
  v_mfma_f32_16x16x32_bf16 v[8:11], a[64:67], a[32:35], v[56:59]
  v_exp_f32 v100, v32
  v_mfma_f32_16x16x32_bf16 v[8:11], a[68:71], a[36:39], v[8:11]
  ds_read_b128 a[148:151], v116 offset:21504
  v_add_f32 v78, v78, v99
  v_mfma_f32_16x16x32_bf16 v[8:11], a[72:75], a[40:43], v[8:11]
  buffer_load_dwordx4 v3, s[12:15], s39 offen offset:1024 sc1 lds
  v_cvt_pk_bf16_f32 v47, v98, v99
  v_mfma_f32_16x16x32_bf16 v[8:11], a[76:79], a[44:47], v[8:11]
  ds_read_b128 a[152:155], v116 offset:22528
  v_mfma_f32_16x16x32_bf16 v[8:11], a[80:83], a[48:51], v[8:11]
  v_exp_f32 v101, v33
  v_mfma_f32_16x16x32_bf16 v[8:11], a[84:87], a[52:55], v[8:11]
  ds_read_b128 a[156:159], v116 offset:23552
  v_add_f32 v79, v79, v100
  v_mfma_f32_16x16x32_bf16 v[8:11], a[88:91], a[56:59], v[8:11]
  v_exp_f32 v102, v34
  v_mfma_f32_16x16x32_bf16 v[8:11], a[92:95], a[60:63], v[8:11]
  ds_read_b128 a[160:163], v116 offset:24576
  v_add_f32 v79, v79, v101
  v_mfma_f32_16x16x32_bf16 v[12:15], a[96:99], a[0:3], v[60:63]
  v_exp_f32 v103, v35
  v_mfma_f32_16x16x32_bf16 v[12:15], a[100:103], a[4:7], v[12:15]
  ds_read_b128 a[164:167], v116 offset:25600
  v_cvt_pk_bf16_f32 v50, v100, v101
  v_mfma_f32_16x16x32_bf16 v[12:15], a[104:107], a[8:11], v[12:15]
  buffer_load_dwordx4 v3, s[12:15], s39 offen offset:2048 sc1 lds
  v_add_f32 v79, v79, v102
  v_mfma_f32_16x16x32_bf16 v[12:15], a[108:111], a[12:15], v[12:15]
  ds_read_b128 a[168:171], v116 offset:26624
  v_add_f32 v79, v79, v103
  v_mfma_f32_16x16x32_bf16 v[12:15], a[112:115], a[16:19], v[12:15]
  ds_read_b128 a[172:175], v116 offset:27648
  v_cvt_pk_bf16_f32 v51, v102, v103
  v_mfma_f32_16x16x32_bf16 v[12:15], a[116:119], a[20:23], v[12:15]
  ds_read_b128 a[176:179], v116 offset:28672
  v_max_f32 v117, v78, v79
  v_mfma_f32_16x16x32_bf16 v[12:15], a[120:123], a[24:27], v[12:15]
  ds_read_b128 a[180:183], v116 offset:29696
  v_cmp_ngt_f32 vcc, 2.0, v117
  v_mfma_f32_16x16x32_bf16 v[12:15], a[124:127], a[28:31], v[12:15]
  ds_read_b128 a[184:187], v116 offset:30720
  v_mfma_f32_16x16x32_bf16 v[16:19], a[96:99], a[32:35], v[64:67]
  ds_read_b128 a[188:191], v116 offset:31744
  v_mfma_f32_16x16x32_bf16 v[16:19], a[100:103], a[36:39], v[16:19]
  v_mfma_f32_16x16x32_bf16 v[16:19], a[104:107], a[40:43], v[16:19]
  buffer_load_dwordx4 v3, s[12:15], s39 offen offset:3072 sc1 lds
  v_mfma_f32_16x16x32_bf16 v[16:19], a[108:111], a[44:47], v[16:19]
  s_add_u32 s39, s38, 0x4000
  s_cmp_eq_u32 s39, s3
  s_cselect_b32 s39, s76, s39
  v_mfma_f32_16x16x32_bf16 v[16:19], a[112:115], a[48:51], v[16:19]
  s_add_u32 m0, s77, 0x8000
  v_mfma_f32_16x16x32_bf16 v[16:19], a[116:119], a[52:55], v[16:19]
  v_mfma_f32_16x16x32_bf16 v[16:19], a[120:123], a[56:59], v[16:19]
  v_mfma_f32_16x16x32_bf16 v[16:19], a[124:127], a[60:63], v[16:19]
  s_waitcnt lgkmcnt(0)
  s_cbranch_vccnz Lk_R0
Lk_Rr0:
  v_mfma_f32_16x16x32_bf16 v[128:131], a[128:131], v[44:47], v[128:131]
  ds_read_b128 a[64:67], v116 offset:0
  v_add_f32 v88, v88, v78
  v_mfma_f32_16x16x32_bf16 v[132:135], a[128:131], v[48:51], v[132:135]
  ds_read_b128 a[68:71], v116 offset:1024
  v_add_f32 v92, v92, v79
  v_mfma_f32_16x16x32_bf16 v[140:143], a[132:135], v[48:51], v[140:143]
  buffer_load_dwordx4 v3, s[8:11], s39 offen offset:0 sc1 lds
  v_mfma_f32_16x16x32_bf16 v[136:139], a[132:135], v[44:47], v[136:139]
  ds_read_b128 a[72:75], v116 offset:2048
  v_mfma_f32_16x16x32_bf16 v[144:147], a[136:139], v[44:47], v[144:147]
  v_exp_f32 v96, v4
  v_mfma_f32_16x16x32_bf16 v[148:151], a[136:139], v[48:51], v[148:151]
  ds_read_b128 a[76:79], v116 offset:3072
  v_mfma_f32_16x16x32_bf16 v[156:159], a[140:143], v[48:51], v[156:159]
  v_exp_f32 v97, v5
  v_mfma_f32_16x16x32_bf16 v[152:155], a[140:143], v[44:47], v[152:155]
  ds_read_b128 a[80:83], v116 offset:4096
  v_add_f32 v76, v96, v97
  v_mfma_f32_16x16x32_bf16 v[160:163], a[144:147], v[44:47], v[160:163]
  v_exp_f32 v98, v6
  v_mfma_f32_16x16x32_bf16 v[164:167], a[144:147], v[48:51], v[164:167]
  ds_read_b128 a[84:87], v116 offset:5120
  v_cvt_pk_bf16_f32 v36, v96, v97
  v_mfma_f32_16x16x32_bf16 v[172:175], a[148:151], v[48:51], v[172:175]
  buffer_load_dwordx4 v3, s[8:11], s39 offen offset:1024 sc1 lds
  v_mfma_f32_16x16x32_bf16 v[168:171], a[148:151], v[44:47], v[168:171]
  ds_read_b128 a[88:91], v116 offset:6144
  v_mfma_f32_16x16x32_bf16 v[176:179], a[152:155], v[44:47], v[176:179]
  v_exp_f32 v99, v7
  v_mfma_f32_16x16x32_bf16 v[180:183], a[152:155], v[48:51], v[180:183]
  ds_read_b128 a[92:95], v116 offset:7168
  v_add_f32 v76, v76, v98
  v_mfma_f32_16x16x32_bf16 v[188:191], a[156:159], v[48:51], v[188:191]
  v_exp_f32 v100, v8
  v_mfma_f32_16x16x32_bf16 v[184:187], a[156:159], v[44:47], v[184:187]
  ds_read_b128 a[96:99], v116 offset:8192
  v_add_f32 v76, v76, v99
  v_mfma_f32_16x16x32_bf16 v[192:195], a[160:163], v[44:47], v[192:195]
  v_exp_f32 v101, v9
  v_mfma_f32_16x16x32_bf16 v[196:199], a[160:163], v[48:51], v[196:199]
  ds_read_b128 a[100:103], v116 offset:9216
  v_cvt_pk_bf16_f32 v37, v98, v99
  v_mfma_f32_16x16x32_bf16 v[204:207], a[164:167], v[48:51], v[204:207]
  v_exp_f32 v102, v10
  v_mfma_f32_16x16x32_bf16 v[200:203], a[164:167], v[44:47], v[200:203]
  ds_read_b128 a[104:107], v116 offset:10240
  v_add_f32 v77, v100, v101
  v_mfma_f32_16x16x32_bf16 v[208:211], a[168:171], v[44:47], v[208:211]
  v_exp_f32 v103, v11
  v_mfma_f32_16x16x32_bf16 v[212:215], a[168:171], v[48:51], v[212:215]
  ds_read_b128 a[108:111], v116 offset:11264
  v_cvt_pk_bf16_f32 v40, v100, v101
  v_mfma_f32_16x16x32_bf16 v[220:223], a[172:175], v[48:51], v[220:223]
  v_exp_f32 v96, v12
  v_mfma_f32_16x16x32_bf16 v[216:219], a[172:175], v[44:47], v[216:219]
  ds_read_b128 a[112:115], v116 offset:12288
  v_add_f32 v77, v77, v102
  v_mfma_f32_16x16x32_bf16 v[224:227], a[176:179], v[44:47], v[224:227]
  v_exp_f32 v97, v13
  v_mfma_f32_16x16x32_bf16 v[228:231], a[176:179], v[48:51], v[228:231]
  ds_read_b128 a[116:119], v116 offset:13312
  v_add_f32 v77, v77, v103
  v_mfma_f32_16x16x32_bf16 v[236:239], a[180:183], v[48:51], v[236:239]
  ds_read_b128 a[120:123], v116 offset:14336
  v_cvt_pk_bf16_f32 v41, v102, v103
  v_mfma_f32_16x16x32_bf16 v[232:235], a[180:183], v[44:47], v[232:235]
  ds_read_b128 a[124:127], v116 offset:15360
  v_add_f32 v76, v76, v96
  v_mfma_f32_16x16x32_bf16 v[240:243], a[184:187], v[44:47], v[240:243]
  buffer_load_dwordx4 v3, s[8:11], s39 offen offset:2048 sc1 lds
  v_add_f32 v76, v76, v97
  v_mfma_f32_16x16x32_bf16 v[244:247], a[184:187], v[48:51], v[244:247]
  v_cvt_pk_bf16_f32 v38, v96, v97
  v_mfma_f32_16x16x32_bf16 v[252:255], a[188:191], v[48:51], v[252:255]
  buffer_load_dwordx4 v3, s[8:11], s39 offen offset:3072 sc1 lds
  v_mfma_f32_16x16x32_bf16 v[248:251], a[188:191], v[44:47], v[248:251]
  s_xor_b32 s77, s77, 0x10000
  s_sub_u32 s33, s33, 1
  s_cbranch_scc1 Lk_H1
Lk_M1:
  s_waitcnt vmcnt(16) lgkmcnt(0)
  s_barrier
  v_mfma_f32_16x16x32_bf16 v[20:23], a[64:67], a[0:3], v[52:55]
  s_add_u32 m0, s77, 0x4000
  ds_read_b128 a[128:131], v116 offset:49152
  v_mfma_f32_16x16x32_bf16 v[20:23], a[68:71], a[4:7], v[20:23]
  ds_read_b128 a[132:135], v116 offset:50176
  v_mfma_f32_16x16x32_bf16 v[20:23], a[72:75], a[8:11], v[20:23]
  buffer_load_dwordx4 v3, s[12:15], s38 offen offset:0 sc1 lds
  v_mfma_f32_16x16x32_bf16 v[20:23], a[76:79], a[12:15], v[20:23]
  ds_read_b128 a[136:139], v116 offset:51200
  v_mfma_f32_16x16x32_bf16 v[20:23], a[80:83], a[16:19], v[20:23]
  v_exp_f32 v98, v14
  v_mfma_f32_16x16x32_bf16 v[20:23], a[84:87], a[20:23], v[20:23]
  ds_read_b128 a[140:143], v116 offset:52224
  v_mfma_f32_16x16x32_bf16 v[20:23], a[88:91], a[24:27], v[20:23]
  v_exp_f32 v99, v15
  v_mfma_f32_16x16x32_bf16 v[20:23], a[92:95], a[28:31], v[20:23]
  ds_read_b128 a[144:147], v116 offset:53248
  v_add_f32 v76, v76, v98
  v_mfma_f32_16x16x32_bf16 v[24:27], a[64:67], a[32:35], v[56:59]
  v_exp_f32 v100, v16
  v_mfma_f32_16x16x32_bf16 v[24:27], a[68:71], a[36:39], v[24:27]
  ds_read_b128 a[148:151], v116 offset:54272
  v_add_f32 v76, v76, v99
  v_mfma_f32_16x16x32_bf16 v[24:27], a[72:75], a[40:43], v[24:27]
  buffer_load_dwordx4 v3, s[12:15], s38 offen offset:1024 sc1 lds
  v_cvt_pk_bf16_f32 v39, v98, v99
  v_mfma_f32_16x16x32_bf16 v[24:27], a[76:79], a[44:47], v[24:27]
  ds_read_b128 a[152:155], v116 offset:55296
  v_mfma_f32_16x16x32_bf16 v[24:27], a[80:83], a[48:51], v[24:27]
  v_exp_f32 v101, v17
  v_mfma_f32_16x16x32_bf16 v[24:27], a[84:87], a[52:55], v[24:27]
  ds_read_b128 a[156:159], v116 offset:56320
  v_add_f32 v77, v77, v100
  v_mfma_f32_16x16x32_bf16 v[24:27], a[88:91], a[56:59], v[24:27]
  v_exp_f32 v102, v18
  v_mfma_f32_16x16x32_bf16 v[24:27], a[92:95], a[60:63], v[24:27]
  ds_read_b128 a[160:163], v116 offset:57344
  v_add_f32 v77, v77, v101
  v_mfma_f32_16x16x32_bf16 v[28:31], a[96:99], a[0:3], v[60:63]
  v_exp_f32 v103, v19
  v_mfma_f32_16x16x32_bf16 v[28:31], a[100:103], a[4:7], v[28:31]
  ds_read_b128 a[164:167], v116 offset:58368
  v_cvt_pk_bf16_f32 v42, v100, v101
  v_mfma_f32_16x16x32_bf16 v[28:31], a[104:107], a[8:11], v[28:31]
  buffer_load_dwordx4 v3, s[12:15], s38 offen offset:2048 sc1 lds
  v_add_f32 v77, v77, v102
  v_mfma_f32_16x16x32_bf16 v[28:31], a[108:111], a[12:15], v[28:31]
  ds_read_b128 a[168:171], v116 offset:59392
  v_add_f32 v77, v77, v103
  v_mfma_f32_16x16x32_bf16 v[28:31], a[112:115], a[16:19], v[28:31]
  ds_read_b128 a[172:175], v116 offset:60416
  v_cvt_pk_bf16_f32 v43, v102, v103
  v_mfma_f32_16x16x32_bf16 v[28:31], a[116:119], a[20:23], v[28:31]
  ds_read_b128 a[176:179], v116 offset:61440
  v_max_f32 v117, v76, v77
  v_mfma_f32_16x16x32_bf16 v[28:31], a[120:123], a[24:27], v[28:31]
  ds_read_b128 a[180:183], v116 offset:62464
  v_cmp_ngt_f32 vcc, 2.0, v117
  v_mfma_f32_16x16x32_bf16 v[28:31], a[124:127], a[28:31], v[28:31]
  ds_read_b128 a[184:187], v116 offset:63488
  v_mfma_f32_16x16x32_bf16 v[32:35], a[96:99], a[32:35], v[64:67]
  ds_read_b128 a[188:191], v116 offset:64512
  v_mfma_f32_16x16x32_bf16 v[32:35], a[100:103], a[36:39], v[32:35]
  v_mfma_f32_16x16x32_bf16 v[32:35], a[104:107], a[40:43], v[32:35]
  buffer_load_dwordx4 v3, s[12:15], s38 offen offset:3072 sc1 lds
  v_mfma_f32_16x16x32_bf16 v[32:35], a[108:111], a[44:47], v[32:35]
  s_add_u32 s38, s39, 0x4000
  s_cmp_eq_u32 s38, s3
  s_cselect_b32 s38, s76, s38
  v_mfma_f32_16x16x32_bf16 v[32:35], a[112:115], a[48:51], v[32:35]
  s_mov_b32 m0, s77
  v_mfma_f32_16x16x32_bf16 v[32:35], a[116:119], a[52:55], v[32:35]
  v_mfma_f32_16x16x32_bf16 v[32:35], a[120:123], a[56:59], v[32:35]
  v_mfma_f32_16x16x32_bf16 v[32:35], a[124:127], a[60:63], v[32:35]
  s_waitcnt lgkmcnt(0)
  s_cbranch_vccnz Lk_R1
Lk_Rr1:
  v_mfma_f32_16x16x32_bf16 v[128:131], a[128:131], v[36:39], v[128:131]
  ds_read_b128 a[64:67], v116 offset:32768
  v_add_f32 v88, v88, v76
  v_mfma_f32_16x16x32_bf16 v[132:135], a[128:131], v[40:43], v[132:135]
  ds_read_b128 a[68:71], v116 offset:33792
  v_add_f32 v92, v92, v77
  v_mfma_f32_16x16x32_bf16 v[140:143], a[132:135], v[40:43], v[140:143]
  buffer_load_dwordx4 v3, s[8:11], s38 offen offset:0 sc1 lds
  v_mfma_f32_16x16x32_bf16 v[136:139], a[132:135], v[36:39], v[136:139]
  ds_read_b128 a[72:75], v116 offset:34816
  v_mfma_f32_16x16x32_bf16 v[144:147], a[136:139], v[36:39], v[144:147]
  v_exp_f32 v96, v20
  v_mfma_f32_16x16x32_bf16 v[148:151], a[136:139], v[40:43], v[148:151]
  ds_read_b128 a[76:79], v116 offset:35840
  v_mfma_f32_16x16x32_bf16 v[156:159], a[140:143], v[40:43], v[156:159]
  v_exp_f32 v97, v21
  v_mfma_f32_16x16x32_bf16 v[152:155], a[140:143], v[36:39], v[152:155]
  ds_read_b128 a[80:83], v116 offset:36864
  v_add_f32 v78, v96, v97
  v_mfma_f32_16x16x32_bf16 v[160:163], a[144:147], v[36:39], v[160:163]
  v_exp_f32 v98, v22
  v_mfma_f32_16x16x32_bf16 v[164:167], a[144:147], v[40:43], v[164:167]
  ds_read_b128 a[84:87], v116 offset:37888
  v_cvt_pk_bf16_f32 v44, v96, v97
  v_mfma_f32_16x16x32_bf16 v[172:175], a[148:151], v[40:43], v[172:175]
  buffer_load_dwordx4 v3, s[8:11], s38 offen offset:1024 sc1 lds
  v_mfma_f32_16x16x32_bf16 v[168:171], a[148:151], v[36:39], v[168:171]
  ds_read_b128 a[88:91], v116 offset:38912
  v_mfma_f32_16x16x32_bf16 v[176:179], a[152:155], v[36:39], v[176:179]
  v_exp_f32 v99, v23
  v_mfma_f32_16x16x32_bf16 v[180:183], a[152:155], v[40:43], v[180:183]
  ds_read_b128 a[92:95], v116 offset:39936
  v_add_f32 v78, v78, v98
  v_mfma_f32_16x16x32_bf16 v[188:191], a[156:159], v[40:43], v[188:191]
  v_exp_f32 v100, v24
  v_mfma_f32_16x16x32_bf16 v[184:187], a[156:159], v[36:39], v[184:187]
  ds_read_b128 a[96:99], v116 offset:40960
  v_add_f32 v78, v78, v99
  v_mfma_f32_16x16x32_bf16 v[192:195], a[160:163], v[36:39], v[192:195]
  v_exp_f32 v101, v25
  v_mfma_f32_16x16x32_bf16 v[196:199], a[160:163], v[40:43], v[196:199]
  ds_read_b128 a[100:103], v116 offset:41984
  v_cvt_pk_bf16_f32 v45, v98, v99
  v_mfma_f32_16x16x32_bf16 v[204:207], a[164:167], v[40:43], v[204:207]
  v_exp_f32 v102, v26
  v_mfma_f32_16x16x32_bf16 v[200:203], a[164:167], v[36:39], v[200:203]
  ds_read_b128 a[104:107], v116 offset:43008
  v_add_f32 v79, v100, v101
  v_mfma_f32_16x16x32_bf16 v[208:211], a[168:171], v[36:39], v[208:211]
  v_exp_f32 v103, v27
  v_mfma_f32_16x16x32_bf16 v[212:215], a[168:171], v[40:43], v[212:215]
  ds_read_b128 a[108:111], v116 offset:44032
  v_cvt_pk_bf16_f32 v48, v100, v101
  v_mfma_f32_16x16x32_bf16 v[220:223], a[172:175], v[40:43], v[220:223]
  v_exp_f32 v96, v28
  v_mfma_f32_16x16x32_bf16 v[216:219], a[172:175], v[36:39], v[216:219]
  ds_read_b128 a[112:115], v116 offset:45056
  v_add_f32 v79, v79, v102
  v_mfma_f32_16x16x32_bf16 v[224:227], a[176:179], v[36:39], v[224:227]
  v_exp_f32 v97, v29
  v_mfma_f32_16x16x32_bf16 v[228:231], a[176:179], v[40:43], v[228:231]
  ds_read_b128 a[116:119], v116 offset:46080
  v_add_f32 v79, v79, v103
  v_mfma_f32_16x16x32_bf16 v[236:239], a[180:183], v[40:43], v[236:239]
  ds_read_b128 a[120:123], v116 offset:47104
  v_cvt_pk_bf16_f32 v49, v102, v103
  v_mfma_f32_16x16x32_bf16 v[232:235], a[180:183], v[36:39], v[232:235]
  ds_read_b128 a[124:127], v116 offset:48128
  v_xor_b32 v116, 0x10000, v116
  v_mfma_f32_16x16x32_bf16 v[240:243], a[184:187], v[36:39], v[240:243]
  buffer_load_dwordx4 v3, s[8:11], s38 offen offset:2048 sc1 lds
  v_add_f32 v78, v78, v96
  v_mfma_f32_16x16x32_bf16 v[244:247], a[184:187], v[40:43], v[244:247]
  v_add_f32 v78, v78, v97
  v_cvt_pk_bf16_f32 v46, v96, v97
  v_mfma_f32_16x16x32_bf16 v[252:255], a[188:191], v[40:43], v[252:255]
  buffer_load_dwordx4 v3, s[8:11], s38 offen offset:3072 sc1 lds
  v_mfma_f32_16x16x32_bf16 v[248:251], a[188:191], v[36:39], v[248:251]
  s_sub_u32 s33, s33, 1
  s_cbranch_scc0 Lk_M0
  s_branch Lk_H0
Lk_R0:
  v_max3_f32 v122, v20, v21, v22
  v_max3_f32 v122, v122, v23, v28
  v_max3_f32 v122, v122, v29, v30
  v_max_f32 v122, v122, v31
  v_max3_f32 v123, v24, v25, v26
  v_max3_f32 v123, v123, v27, v32
  v_max3_f32 v123, v123, v33, v34
  v_max_f32 v123, v123, v35
  v_mov_b32 v120, v122
  v_mov_b32 v121, v123
  s_nop 0
  v_permlane32_swap_b32 v122, v120
  v_permlane32_swap_b32 v123, v121
  v_max_f32 v122, v122, v120
  v_max_f32 v123, v123, v121
  v_mov_b32 v120, v122
  v_mov_b32 v121, v123
  s_nop 0
  v_permlane16_swap_b32 v122, v120
  v_permlane16_swap_b32 v123, v121
  v_max_f32 v122, v122, v120
  v_max_f32 v123, v123, v121
  v_add_f32 v122, 0x42200000, v122
  v_max_f32 v122, 0, v122
  v_add_f32 v123, 0x42200000, v123
  v_max_f32 v123, 0, v123
  v_sub_f32 v20, v20, v122
  v_sub_f32 v21, v21, v122
  v_sub_f32 v22, v22, v122
  v_sub_f32 v23, v23, v122
  v_sub_f32 v24, v24, v123
  v_sub_f32 v25, v25, v123
  v_sub_f32 v26, v26, v123
  v_sub_f32 v27, v27, v123
  v_sub_f32 v28, v28, v122
  v_sub_f32 v29, v29, v122
  v_sub_f32 v30, v30, v122
  v_sub_f32 v31, v31, v122
  v_sub_f32 v32, v32, v123
  v_sub_f32 v33, v33, v123
  v_sub_f32 v34, v34, v123
  v_sub_f32 v35, v35, v123
  v_sub_f32 v4, v4, v122
  v_sub_f32 v5, v5, v122
  v_sub_f32 v6, v6, v122
  v_sub_f32 v7, v7, v122
  v_sub_f32 v8, v8, v123
  v_sub_f32 v9, v9, v123
  v_sub_f32 v10, v10, v123
  v_sub_f32 v11, v11, v123
  v_sub_f32 v12, v12, v122
  v_sub_f32 v13, v13, v122
  v_sub_f32 v14, v14, v122
  v_sub_f32 v15, v15, v122
  v_sub_f32 v16, v16, v123
  v_sub_f32 v17, v17, v123
  v_sub_f32 v18, v18, v123
  v_sub_f32 v19, v19, v123
  v_sub_f32 v52, v52, v122
  v_sub_f32 v53, v53, v122
  v_sub_f32 v54, v54, v122
  v_sub_f32 v55, v55, v122
  v_sub_f32 v56, v56, v123
  v_sub_f32 v57, v57, v123
  v_sub_f32 v58, v58, v123
  v_sub_f32 v59, v59, v123
  v_sub_f32 v60, v60, v122
  v_sub_f32 v61, v61, v122
  v_sub_f32 v62, v62, v122
  v_sub_f32 v63, v63, v122
  v_sub_f32 v64, v64, v123
  v_sub_f32 v65, v65, v123
  v_sub_f32 v66, v66, v123
  v_sub_f32 v67, v67, v123
  v_sub_f32 v112, v112, v122
  v_sub_f32 v114, v114, v123
  v_exp_f32 v122, -v122
  v_exp_f32 v123, -v123
  v_mul_f32 v128, v128, v122
  v_mul_f32 v129, v129, v122
  v_mul_f32 v130, v130, v122
  v_mul_f32 v131, v131, v122
  v_mul_f32 v132, v132, v123
  v_mul_f32 v133, v133, v123
  v_mul_f32 v134, v134, v123
  v_mul_f32 v135, v135, v123
  v_mul_f32 v136, v136, v122
  v_mul_f32 v137, v137, v122
  v_mul_f32 v138, v138, v122
  v_mul_f32 v139, v139, v122
  v_mul_f32 v140, v140, v123
  v_mul_f32 v141, v141, v123
  v_mul_f32 v142, v142, v123
  v_mul_f32 v143, v143, v123
  v_mul_f32 v144, v144, v122
  v_mul_f32 v145, v145, v122
  v_mul_f32 v146, v146, v122
  v_mul_f32 v147, v147, v122
  v_mul_f32 v148, v148, v123
  v_mul_f32 v149, v149, v123
  v_mul_f32 v150, v150, v123
  v_mul_f32 v151, v151, v123
  v_mul_f32 v152, v152, v122
  v_mul_f32 v153, v153, v122
  v_mul_f32 v154, v154, v122
  v_mul_f32 v155, v155, v122
  v_mul_f32 v156, v156, v123
  v_mul_f32 v157, v157, v123
  v_mul_f32 v158, v158, v123
  v_mul_f32 v159, v159, v123
  v_mul_f32 v160, v160, v122
  v_mul_f32 v161, v161, v122
  v_mul_f32 v162, v162, v122
  v_mul_f32 v163, v163, v122
  v_mul_f32 v164, v164, v123
  v_mul_f32 v165, v165, v123
  v_mul_f32 v166, v166, v123
  v_mul_f32 v167, v167, v123
  v_mul_f32 v168, v168, v122
  v_mul_f32 v169, v169, v122
  v_mul_f32 v170, v170, v122
  v_mul_f32 v171, v171, v122
  v_mul_f32 v172, v172, v123
  v_mul_f32 v173, v173, v123
  v_mul_f32 v174, v174, v123
  v_mul_f32 v175, v175, v123
  v_mul_f32 v176, v176, v122
  v_mul_f32 v177, v177, v122
  v_mul_f32 v178, v178, v122
  v_mul_f32 v179, v179, v122
  v_mul_f32 v180, v180, v123
  v_mul_f32 v181, v181, v123
  v_mul_f32 v182, v182, v123
  v_mul_f32 v183, v183, v123
  v_mul_f32 v184, v184, v122
  v_mul_f32 v185, v185, v122
  v_mul_f32 v186, v186, v122
  v_mul_f32 v187, v187, v122
  v_mul_f32 v188, v188, v123
  v_mul_f32 v189, v189, v123
  v_mul_f32 v190, v190, v123
  v_mul_f32 v191, v191, v123
  v_mul_f32 v192, v192, v122
  v_mul_f32 v193, v193, v122
  v_mul_f32 v194, v194, v122
  v_mul_f32 v195, v195, v122
  v_mul_f32 v196, v196, v123
  v_mul_f32 v197, v197, v123
  v_mul_f32 v198, v198, v123
  v_mul_f32 v199, v199, v123
  v_mul_f32 v200, v200, v122
  v_mul_f32 v201, v201, v122
  v_mul_f32 v202, v202, v122
  v_mul_f32 v203, v203, v122
  v_mul_f32 v204, v204, v123
  v_mul_f32 v205, v205, v123
  v_mul_f32 v206, v206, v123
  v_mul_f32 v207, v207, v123
  v_mul_f32 v208, v208, v122
  v_mul_f32 v209, v209, v122
  v_mul_f32 v210, v210, v122
  v_mul_f32 v211, v211, v122
  v_mul_f32 v212, v212, v123
  v_mul_f32 v213, v213, v123
  v_mul_f32 v214, v214, v123
  v_mul_f32 v215, v215, v123
  v_mul_f32 v216, v216, v122
  v_mul_f32 v217, v217, v122
  v_mul_f32 v218, v218, v122
  v_mul_f32 v219, v219, v122
  v_mul_f32 v220, v220, v123
  v_mul_f32 v221, v221, v123
  v_mul_f32 v222, v222, v123
  v_mul_f32 v223, v223, v123
  v_mul_f32 v224, v224, v122
  v_mul_f32 v225, v225, v122
  v_mul_f32 v226, v226, v122
  v_mul_f32 v227, v227, v122
  v_mul_f32 v228, v228, v123
  v_mul_f32 v229, v229, v123
  v_mul_f32 v230, v230, v123
  v_mul_f32 v231, v231, v123
  v_mul_f32 v232, v232, v122
  v_mul_f32 v233, v233, v122
  v_mul_f32 v234, v234, v122
  v_mul_f32 v235, v235, v122
  v_mul_f32 v236, v236, v123
  v_mul_f32 v237, v237, v123
  v_mul_f32 v238, v238, v123
  v_mul_f32 v239, v239, v123
  v_mul_f32 v240, v240, v122
  v_mul_f32 v241, v241, v122
  v_mul_f32 v242, v242, v122
  v_mul_f32 v243, v243, v122
  v_mul_f32 v244, v244, v123
  v_mul_f32 v245, v245, v123
  v_mul_f32 v246, v246, v123
  v_mul_f32 v247, v247, v123
  v_mul_f32 v248, v248, v122
  v_mul_f32 v249, v249, v122
  v_mul_f32 v250, v250, v122
  v_mul_f32 v251, v251, v122
  v_mul_f32 v252, v252, v123
  v_mul_f32 v253, v253, v123
  v_mul_f32 v254, v254, v123
  v_mul_f32 v255, v255, v123
  v_mul_f32 v88, v88, v122
  v_mul_f32 v92, v92, v123
  v_exp_f32 v96, v20
  v_exp_f32 v97, v21
  v_exp_f32 v98, v22
  v_exp_f32 v99, v23
  v_add_f32 v78, v96, v97
  v_cvt_pk_bf16_f32 v44, v96, v97
  v_exp_f32 v100, v24
  v_exp_f32 v101, v25
  v_add_f32 v78, v78, v98
  v_add_f32 v78, v78, v99
  v_cvt_pk_bf16_f32 v45, v98, v99
  v_exp_f32 v102, v26
  v_exp_f32 v103, v27
  v_add_f32 v79, v100, v101
  v_cvt_pk_bf16_f32 v48, v100, v101
  v_exp_f32 v96, v28
  v_exp_f32 v97, v29
  v_add_f32 v79, v79, v102
  v_add_f32 v79, v79, v103
  v_cvt_pk_bf16_f32 v49, v102, v103
  v_exp_f32 v98, v30
  v_exp_f32 v99, v31
  v_add_f32 v78, v78, v96
  v_add_f32 v78, v78, v97
  v_cvt_pk_bf16_f32 v46, v96, v97
  v_exp_f32 v100, v32
  v_exp_f32 v101, v33
  v_add_f32 v78, v78, v98
  v_add_f32 v78, v78, v99
  v_cvt_pk_bf16_f32 v47, v98, v99
  v_exp_f32 v102, v34
  v_exp_f32 v103, v35
  v_add_f32 v79, v79, v100
  v_add_f32 v79, v79, v101
  v_cvt_pk_bf16_f32 v50, v100, v101
  v_add_f32 v79, v79, v102
  v_add_f32 v79, v79, v103
  v_cvt_pk_bf16_f32 v51, v102, v103
  s_branch Lk_Rr0
Lk_RT0:
  v_max3_f32 v122, v20, v21, v22
  v_max3_f32 v122, v122, v23, v28
  v_max3_f32 v122, v122, v29, v30
  v_max_f32 v122, v122, v31
  v_max3_f32 v123, v24, v25, v26
  v_max3_f32 v123, v123, v27, v32
  v_max3_f32 v123, v123, v33, v34
  v_max_f32 v123, v123, v35
  v_mov_b32 v120, v122
  v_mov_b32 v121, v123
  s_nop 0
  v_permlane32_swap_b32 v122, v120
  v_permlane32_swap_b32 v123, v121
  v_max_f32 v122, v122, v120
  v_max_f32 v123, v123, v121
  v_mov_b32 v120, v122
  v_mov_b32 v121, v123
  s_nop 0
  v_permlane16_swap_b32 v122, v120
  v_permlane16_swap_b32 v123, v121
  v_max_f32 v122, v122, v120
  v_max_f32 v123, v123, v121
  v_add_f32 v122, 0x42200000, v122
  v_max_f32 v122, 0, v122
  v_add_f32 v123, 0x42200000, v123
  v_max_f32 v123, 0, v123
  v_sub_f32 v20, v20, v122
  v_sub_f32 v21, v21, v122
  v_sub_f32 v22, v22, v122
  v_sub_f32 v23, v23, v122
  v_sub_f32 v24, v24, v123
  v_sub_f32 v25, v25, v123
  v_sub_f32 v26, v26, v123
  v_sub_f32 v27, v27, v123
  v_sub_f32 v28, v28, v122
  v_sub_f32 v29, v29, v122
  v_sub_f32 v30, v30, v122
  v_sub_f32 v31, v31, v122
  v_sub_f32 v32, v32, v123
  v_sub_f32 v33, v33, v123
  v_sub_f32 v34, v34, v123
  v_sub_f32 v35, v35, v123
  v_sub_f32 v52, v52, v122
  v_sub_f32 v53, v53, v122
  v_sub_f32 v54, v54, v122
  v_sub_f32 v55, v55, v122
  v_sub_f32 v56, v56, v123
  v_sub_f32 v57, v57, v123
  v_sub_f32 v58, v58, v123
  v_sub_f32 v59, v59, v123
  v_sub_f32 v60, v60, v122
  v_sub_f32 v61, v61, v122
  v_sub_f32 v62, v62, v122
  v_sub_f32 v63, v63, v122
  v_sub_f32 v64, v64, v123
  v_sub_f32 v65, v65, v123
  v_sub_f32 v66, v66, v123
  v_sub_f32 v67, v67, v123
  v_sub_f32 v112, v112, v122
  v_sub_f32 v114, v114, v123
  v_exp_f32 v122, -v122
  v_exp_f32 v123, -v123
  v_mul_f32 v128, v128, v122
  v_mul_f32 v129, v129, v122
  v_mul_f32 v130, v130, v122
  v_mul_f32 v131, v131, v122
  v_mul_f32 v132, v132, v123
  v_mul_f32 v133, v133, v123
  v_mul_f32 v134, v134, v123
  v_mul_f32 v135, v135, v123
  v_mul_f32 v136, v136, v122
  v_mul_f32 v137, v137, v122
  v_mul_f32 v138, v138, v122
  v_mul_f32 v139, v139, v122
  v_mul_f32 v140, v140, v123
  v_mul_f32 v141, v141, v123
  v_mul_f32 v142, v142, v123
  v_mul_f32 v143, v143, v123
  v_mul_f32 v144, v144, v122
  v_mul_f32 v145, v145, v122
  v_mul_f32 v146, v146, v122
  v_mul_f32 v147, v147, v122
  v_mul_f32 v148, v148, v123
  v_mul_f32 v149, v149, v123
  v_mul_f32 v150, v150, v123
  v_mul_f32 v151, v151, v123
  v_mul_f32 v152, v152, v122
  v_mul_f32 v153, v153, v122
  v_mul_f32 v154, v154, v122
  v_mul_f32 v155, v155, v122
  v_mul_f32 v156, v156, v123
  v_mul_f32 v157, v157, v123
  v_mul_f32 v158, v158, v123
  v_mul_f32 v159, v159, v123
  v_mul_f32 v160, v160, v122
  v_mul_f32 v161, v161, v122
  v_mul_f32 v162, v162, v122
  v_mul_f32 v163, v163, v122
  v_mul_f32 v164, v164, v123
  v_mul_f32 v165, v165, v123
  v_mul_f32 v166, v166, v123
  v_mul_f32 v167, v167, v123
  v_mul_f32 v168, v168, v122
  v_mul_f32 v169, v169, v122
  v_mul_f32 v170, v170, v122
  v_mul_f32 v171, v171, v122
  v_mul_f32 v172, v172, v123
  v_mul_f32 v173, v173, v123
  v_mul_f32 v174, v174, v123
  v_mul_f32 v175, v175, v123
  v_mul_f32 v176, v176, v122
  v_mul_f32 v177, v177, v122
  v_mul_f32 v178, v178, v122
  v_mul_f32 v179, v179, v122
  v_mul_f32 v180, v180, v123
  v_mul_f32 v181, v181, v123
  v_mul_f32 v182, v182, v123
  v_mul_f32 v183, v183, v123
  v_mul_f32 v184, v184, v122
  v_mul_f32 v185, v185, v122
  v_mul_f32 v186, v186, v122
  v_mul_f32 v187, v187, v122
  v_mul_f32 v188, v188, v123
  v_mul_f32 v189, v189, v123
  v_mul_f32 v190, v190, v123
  v_mul_f32 v191, v191, v123
  v_mul_f32 v192, v192, v122
  v_mul_f32 v193, v193, v122
  v_mul_f32 v194, v194, v122
  v_mul_f32 v195, v195, v122
  v_mul_f32 v196, v196, v123
  v_mul_f32 v197, v197, v123
  v_mul_f32 v198, v198, v123
  v_mul_f32 v199, v199, v123
  v_mul_f32 v200, v200, v122
  v_mul_f32 v201, v201, v122
  v_mul_f32 v202, v202, v122
  v_mul_f32 v203, v203, v122
  v_mul_f32 v204, v204, v123
  v_mul_f32 v205, v205, v123
  v_mul_f32 v206, v206, v123
  v_mul_f32 v207, v207, v123
  v_mul_f32 v208, v208, v122
  v_mul_f32 v209, v209, v122
  v_mul_f32 v210, v210, v122
  v_mul_f32 v211, v211, v122
  v_mul_f32 v212, v212, v123
  v_mul_f32 v213, v213, v123
  v_mul_f32 v214, v214, v123
  v_mul_f32 v215, v215, v123
  v_mul_f32 v216, v216, v122
  v_mul_f32 v217, v217, v122
  v_mul_f32 v218, v218, v122
  v_mul_f32 v219, v219, v122
  v_mul_f32 v220, v220, v123
  v_mul_f32 v221, v221, v123
  v_mul_f32 v222, v222, v123
  v_mul_f32 v223, v223, v123
  v_mul_f32 v224, v224, v122
  v_mul_f32 v225, v225, v122
  v_mul_f32 v226, v226, v122
  v_mul_f32 v227, v227, v122
  v_mul_f32 v228, v228, v123
  v_mul_f32 v229, v229, v123
  v_mul_f32 v230, v230, v123
  v_mul_f32 v231, v231, v123
  v_mul_f32 v232, v232, v122
  v_mul_f32 v233, v233, v122
  v_mul_f32 v234, v234, v122
  v_mul_f32 v235, v235, v122
  v_mul_f32 v236, v236, v123
  v_mul_f32 v237, v237, v123
  v_mul_f32 v238, v238, v123
  v_mul_f32 v239, v239, v123
  v_mul_f32 v240, v240, v122
  v_mul_f32 v241, v241, v122
  v_mul_f32 v242, v242, v122
  v_mul_f32 v243, v243, v122
  v_mul_f32 v244, v244, v123
  v_mul_f32 v245, v245, v123
  v_mul_f32 v246, v246, v123
  v_mul_f32 v247, v247, v123
  v_mul_f32 v248, v248, v122
  v_mul_f32 v249, v249, v122
  v_mul_f32 v250, v250, v122
  v_mul_f32 v251, v251, v122
  v_mul_f32 v252, v252, v123
  v_mul_f32 v253, v253, v123
  v_mul_f32 v254, v254, v123
  v_mul_f32 v255, v255, v123
  v_mul_f32 v88, v88, v122
  v_mul_f32 v92, v92, v123
  v_exp_f32 v96, v20
  v_exp_f32 v97, v21
  v_exp_f32 v98, v22
  v_exp_f32 v99, v23
  v_add_f32 v78, v96, v97
  v_cvt_pk_bf16_f32 v44, v96, v97
  v_exp_f32 v100, v24
  v_exp_f32 v101, v25
  v_add_f32 v78, v78, v98
  v_add_f32 v78, v78, v99
  v_cvt_pk_bf16_f32 v45, v98, v99
  v_exp_f32 v102, v26
  v_exp_f32 v103, v27
  v_add_f32 v79, v100, v101
  v_cvt_pk_bf16_f32 v48, v100, v101
  v_exp_f32 v96, v28
  v_exp_f32 v97, v29
  v_add_f32 v79, v79, v102
  v_add_f32 v79, v79, v103
  v_cvt_pk_bf16_f32 v49, v102, v103
  v_exp_f32 v98, v30
  v_exp_f32 v99, v31
  v_add_f32 v78, v78, v96
  v_add_f32 v78, v78, v97
  v_cvt_pk_bf16_f32 v46, v96, v97
  v_exp_f32 v100, v32
  v_exp_f32 v101, v33
  v_add_f32 v78, v78, v98
  v_add_f32 v78, v78, v99
  v_cvt_pk_bf16_f32 v47, v98, v99
  v_exp_f32 v102, v34
  v_exp_f32 v103, v35
  v_add_f32 v79, v79, v100
  v_add_f32 v79, v79, v101
  v_cvt_pk_bf16_f32 v50, v100, v101
  v_add_f32 v79, v79, v102
  v_add_f32 v79, v79, v103
  v_cvt_pk_bf16_f32 v51, v102, v103
  s_branch Lk_RTr0
Lk_R1:
  v_max3_f32 v122, v4, v5, v6
  v_max3_f32 v122, v122, v7, v12
  v_max3_f32 v122, v122, v13, v14
  v_max_f32 v122, v122, v15
  v_max3_f32 v123, v8, v9, v10
  v_max3_f32 v123, v123, v11, v16
  v_max3_f32 v123, v123, v17, v18
  v_max_f32 v123, v123, v19
  v_mov_b32 v120, v122
  v_mov_b32 v121, v123
  s_nop 0
  v_permlane32_swap_b32 v122, v120
  v_permlane32_swap_b32 v123, v121
  v_max_f32 v122, v122, v120
  v_max_f32 v123, v123, v121
  v_mov_b32 v120, v122
  v_mov_b32 v121, v123
  s_nop 0
  v_permlane16_swap_b32 v122, v120
  v_permlane16_swap_b32 v123, v121
  v_max_f32 v122, v122, v120
  v_max_f32 v123, v123, v121
  v_add_f32 v122, 0x42200000, v122
  v_max_f32 v122, 0, v122
  v_add_f32 v123, 0x42200000, v123
  v_max_f32 v123, 0, v123
  v_sub_f32 v4, v4, v122
  v_sub_f32 v5, v5, v122
  v_sub_f32 v6, v6, v122
  v_sub_f32 v7, v7, v122
  v_sub_f32 v8, v8, v123
  v_sub_f32 v9, v9, v123
  v_sub_f32 v10, v10, v123
  v_sub_f32 v11, v11, v123
  v_sub_f32 v12, v12, v122
  v_sub_f32 v13, v13, v122
  v_sub_f32 v14, v14, v122
  v_sub_f32 v15, v15, v122
  v_sub_f32 v16, v16, v123
  v_sub_f32 v17, v17, v123
  v_sub_f32 v18, v18, v123
  v_sub_f32 v19, v19, v123
  v_sub_f32 v20, v20, v122
  v_sub_f32 v21, v21, v122
  v_sub_f32 v22, v22, v122
  v_sub_f32 v23, v23, v122
  v_sub_f32 v24, v24, v123
  v_sub_f32 v25, v25, v123
  v_sub_f32 v26, v26, v123
  v_sub_f32 v27, v27, v123
  v_sub_f32 v28, v28, v122
  v_sub_f32 v29, v29, v122
  v_sub_f32 v30, v30, v122
  v_sub_f32 v31, v31, v122
  v_sub_f32 v32, v32, v123
  v_sub_f32 v33, v33, v123
  v_sub_f32 v34, v34, v123
  v_sub_f32 v35, v35, v123
  v_sub_f32 v52, v52, v122
  v_sub_f32 v53, v53, v122
  v_sub_f32 v54, v54, v122
  v_sub_f32 v55, v55, v122
  v_sub_f32 v56, v56, v123
  v_sub_f32 v57, v57, v123
  v_sub_f32 v58, v58, v123
  v_sub_f32 v59, v59, v123
  v_sub_f32 v60, v60, v122
  v_sub_f32 v61, v61, v122
  v_sub_f32 v62, v62, v122
  v_sub_f32 v63, v63, v122
  v_sub_f32 v64, v64, v123
  v_sub_f32 v65, v65, v123
  v_sub_f32 v66, v66, v123
  v_sub_f32 v67, v67, v123
  v_sub_f32 v112, v112, v122
  v_sub_f32 v114, v114, v123
  v_exp_f32 v122, -v122
  v_exp_f32 v123, -v123
  v_mul_f32 v128, v128, v122
  v_mul_f32 v129, v129, v122
  v_mul_f32 v130, v130, v122
  v_mul_f32 v131, v131, v122
  v_mul_f32 v132, v132, v123
  v_mul_f32 v133, v133, v123
  v_mul_f32 v134, v134, v123
  v_mul_f32 v135, v135, v123
  v_mul_f32 v136, v136, v122
  v_mul_f32 v137, v137, v122
  v_mul_f32 v138, v138, v122
  v_mul_f32 v139, v139, v122
  v_mul_f32 v140, v140, v123
  v_mul_f32 v141, v141, v123
  v_mul_f32 v142, v142, v123
  v_mul_f32 v143, v143, v123
  v_mul_f32 v144, v144, v122
  v_mul_f32 v145, v145, v122
  v_mul_f32 v146, v146, v122
  v_mul_f32 v147, v147, v122
  v_mul_f32 v148, v148, v123
  v_mul_f32 v149, v149, v123
  v_mul_f32 v150, v150, v123
  v_mul_f32 v151, v151, v123
  v_mul_f32 v152, v152, v122
  v_mul_f32 v153, v153, v122
  v_mul_f32 v154, v154, v122
  v_mul_f32 v155, v155, v122
  v_mul_f32 v156, v156, v123
  v_mul_f32 v157, v157, v123
  v_mul_f32 v158, v158, v123
  v_mul_f32 v159, v159, v123
  v_mul_f32 v160, v160, v122
  v_mul_f32 v161, v161, v122
  v_mul_f32 v162, v162, v122
  v_mul_f32 v163, v163, v122
  v_mul_f32 v164, v164, v123
  v_mul_f32 v165, v165, v123
  v_mul_f32 v166, v166, v123
  v_mul_f32 v167, v167, v123
  v_mul_f32 v168, v168, v122
  v_mul_f32 v169, v169, v122
  v_mul_f32 v170, v170, v122
  v_mul_f32 v171, v171, v122
  v_mul_f32 v172, v172, v123
  v_mul_f32 v173, v173, v123
  v_mul_f32 v174, v174, v123
  v_mul_f32 v175, v175, v123
  v_mul_f32 v176, v176, v122
  v_mul_f32 v177, v177, v122
  v_mul_f32 v178, v178, v122
  v_mul_f32 v179, v179, v122
  v_mul_f32 v180, v180, v123
  v_mul_f32 v181, v181, v123
  v_mul_f32 v182, v182, v123
  v_mul_f32 v183, v183, v123
  v_mul_f32 v184, v184, v122
  v_mul_f32 v185, v185, v122
  v_mul_f32 v186, v186, v122
  v_mul_f32 v187, v187, v122
  v_mul_f32 v188, v188, v123
  v_mul_f32 v189, v189, v123
  v_mul_f32 v190, v190, v123
  v_mul_f32 v191, v191, v123
  v_mul_f32 v192, v192, v122
  v_mul_f32 v193, v193, v122
  v_mul_f32 v194, v194, v122
  v_mul_f32 v195, v195, v122
  v_mul_f32 v196, v196, v123
  v_mul_f32 v197, v197, v123
  v_mul_f32 v198, v198, v123
  v_mul_f32 v199, v199, v123
  v_mul_f32 v200, v200, v122
  v_mul_f32 v201, v201, v122
  v_mul_f32 v202, v202, v122
  v_mul_f32 v203, v203, v122
  v_mul_f32 v204, v204, v123
  v_mul_f32 v205, v205, v123
  v_mul_f32 v206, v206, v123
  v_mul_f32 v207, v207, v123
  v_mul_f32 v208, v208, v122
  v_mul_f32 v209, v209, v122
  v_mul_f32 v210, v210, v122
  v_mul_f32 v211, v211, v122
  v_mul_f32 v212, v212, v123
  v_mul_f32 v213, v213, v123
  v_mul_f32 v214, v214, v123
  v_mul_f32 v215, v215, v123
  v_mul_f32 v216, v216, v122
  v_mul_f32 v217, v217, v122
  v_mul_f32 v218, v218, v122
  v_mul_f32 v219, v219, v122
  v_mul_f32 v220, v220, v123
  v_mul_f32 v221, v221, v123
  v_mul_f32 v222, v222, v123
  v_mul_f32 v223, v223, v123
  v_mul_f32 v224, v224, v122
  v_mul_f32 v225, v225, v122
  v_mul_f32 v226, v226, v122
  v_mul_f32 v227, v227, v122
  v_mul_f32 v228, v228, v123
  v_mul_f32 v229, v229, v123
  v_mul_f32 v230, v230, v123
  v_mul_f32 v231, v231, v123
  v_mul_f32 v232, v232, v122
  v_mul_f32 v233, v233, v122
  v_mul_f32 v234, v234, v122
  v_mul_f32 v235, v235, v122
  v_mul_f32 v236, v236, v123
  v_mul_f32 v237, v237, v123
  v_mul_f32 v238, v238, v123
  v_mul_f32 v239, v239, v123
  v_mul_f32 v240, v240, v122
  v_mul_f32 v241, v241, v122
  v_mul_f32 v242, v242, v122
  v_mul_f32 v243, v243, v122
  v_mul_f32 v244, v244, v123
  v_mul_f32 v245, v245, v123
  v_mul_f32 v246, v246, v123
  v_mul_f32 v247, v247, v123
  v_mul_f32 v248, v248, v122
  v_mul_f32 v249, v249, v122
  v_mul_f32 v250, v250, v122
  v_mul_f32 v251, v251, v122
  v_mul_f32 v252, v252, v123
  v_mul_f32 v253, v253, v123
  v_mul_f32 v254, v254, v123
  v_mul_f32 v255, v255, v123
  v_mul_f32 v88, v88, v122
  v_mul_f32 v92, v92, v123
  v_exp_f32 v96, v4
  v_exp_f32 v97, v5
  v_exp_f32 v98, v6
  v_exp_f32 v99, v7
  v_add_f32 v76, v96, v97
  v_cvt_pk_bf16_f32 v36, v96, v97
  v_exp_f32 v100, v8
  v_exp_f32 v101, v9
  v_add_f32 v76, v76, v98
  v_add_f32 v76, v76, v99
  v_cvt_pk_bf16_f32 v37, v98, v99
  v_exp_f32 v102, v10
  v_exp_f32 v103, v11
  v_add_f32 v77, v100, v101
  v_cvt_pk_bf16_f32 v40, v100, v101
  v_exp_f32 v96, v12
  v_exp_f32 v97, v13
  v_add_f32 v77, v77, v102
  v_add_f32 v77, v77, v103
  v_cvt_pk_bf16_f32 v41, v102, v103
  v_exp_f32 v98, v14
  v_exp_f32 v99, v15
  v_add_f32 v76, v76, v96
  v_add_f32 v76, v76, v97
  v_cvt_pk_bf16_f32 v38, v96, v97
  v_exp_f32 v100, v16
  v_exp_f32 v101, v17
  v_add_f32 v76, v76, v98
  v_add_f32 v76, v76, v99
  v_cvt_pk_bf16_f32 v39, v98, v99
  v_exp_f32 v102, v18
  v_exp_f32 v103, v19
  v_add_f32 v77, v77, v100
  v_add_f32 v77, v77, v101
  v_cvt_pk_bf16_f32 v42, v100, v101
  v_add_f32 v77, v77, v102
  v_add_f32 v77, v77, v103
  v_cvt_pk_bf16_f32 v43, v102, v103
  s_branch Lk_Rr1
Lk_RT1:
  v_max3_f32 v122, v4, v5, v6
  v_max3_f32 v122, v122, v7, v12
  v_max3_f32 v122, v122, v13, v14
  v_max_f32 v122, v122, v15
  v_max3_f32 v123, v8, v9, v10
  v_max3_f32 v123, v123, v11, v16
  v_max3_f32 v123, v123, v17, v18
  v_max_f32 v123, v123, v19
  v_mov_b32 v120, v122
  v_mov_b32 v121, v123
  s_nop 0
  v_permlane32_swap_b32 v122, v120
  v_permlane32_swap_b32 v123, v121
  v_max_f32 v122, v122, v120
  v_max_f32 v123, v123, v121
  v_mov_b32 v120, v122
  v_mov_b32 v121, v123
  s_nop 0
  v_permlane16_swap_b32 v122, v120
  v_permlane16_swap_b32 v123, v121
  v_max_f32 v122, v122, v120
  v_max_f32 v123, v123, v121
  v_add_f32 v122, 0x42200000, v122
  v_max_f32 v122, 0, v122
  v_add_f32 v123, 0x42200000, v123
  v_max_f32 v123, 0, v123
  v_sub_f32 v4, v4, v122
  v_sub_f32 v5, v5, v122
  v_sub_f32 v6, v6, v122
  v_sub_f32 v7, v7, v122
  v_sub_f32 v8, v8, v123
  v_sub_f32 v9, v9, v123
  v_sub_f32 v10, v10, v123
  v_sub_f32 v11, v11, v123
  v_sub_f32 v12, v12, v122
  v_sub_f32 v13, v13, v122
  v_sub_f32 v14, v14, v122
  v_sub_f32 v15, v15, v122
  v_sub_f32 v16, v16, v123
  v_sub_f32 v17, v17, v123
  v_sub_f32 v18, v18, v123
  v_sub_f32 v19, v19, v123
  v_sub_f32 v52, v52, v122
  v_sub_f32 v53, v53, v122
  v_sub_f32 v54, v54, v122
  v_sub_f32 v55, v55, v122
  v_sub_f32 v56, v56, v123
  v_sub_f32 v57, v57, v123
  v_sub_f32 v58, v58, v123
  v_sub_f32 v59, v59, v123
  v_sub_f32 v60, v60, v122
  v_sub_f32 v61, v61, v122
  v_sub_f32 v62, v62, v122
  v_sub_f32 v63, v63, v122
  v_sub_f32 v64, v64, v123
  v_sub_f32 v65, v65, v123
  v_sub_f32 v66, v66, v123
  v_sub_f32 v67, v67, v123
  v_sub_f32 v112, v112, v122
  v_sub_f32 v114, v114, v123
  v_exp_f32 v122, -v122
  v_exp_f32 v123, -v123
  v_mul_f32 v128, v128, v122
  v_mul_f32 v129, v129, v122
  v_mul_f32 v130, v130, v122
  v_mul_f32 v131, v131, v122
  v_mul_f32 v132, v132, v123
  v_mul_f32 v133, v133, v123
  v_mul_f32 v134, v134, v123
  v_mul_f32 v135, v135, v123
  v_mul_f32 v136, v136, v122
  v_mul_f32 v137, v137, v122
  v_mul_f32 v138, v138, v122
  v_mul_f32 v139, v139, v122
  v_mul_f32 v140, v140, v123
  v_mul_f32 v141, v141, v123
  v_mul_f32 v142, v142, v123
  v_mul_f32 v143, v143, v123
  v_mul_f32 v144, v144, v122
  v_mul_f32 v145, v145, v122
  v_mul_f32 v146, v146, v122
  v_mul_f32 v147, v147, v122
  v_mul_f32 v148, v148, v123
  v_mul_f32 v149, v149, v123
  v_mul_f32 v150, v150, v123
  v_mul_f32 v151, v151, v123
  v_mul_f32 v152, v152, v122
  v_mul_f32 v153, v153, v122
  v_mul_f32 v154, v154, v122
  v_mul_f32 v155, v155, v122
  v_mul_f32 v156, v156, v123
  v_mul_f32 v157, v157, v123
  v_mul_f32 v158, v158, v123
  v_mul_f32 v159, v159, v123
  v_mul_f32 v160, v160, v122
  v_mul_f32 v161, v161, v122
  v_mul_f32 v162, v162, v122
  v_mul_f32 v163, v163, v122
  v_mul_f32 v164, v164, v123
  v_mul_f32 v165, v165, v123
  v_mul_f32 v166, v166, v123
  v_mul_f32 v167, v167, v123
  v_mul_f32 v168, v168, v122
  v_mul_f32 v169, v169, v122
  v_mul_f32 v170, v170, v122
  v_mul_f32 v171, v171, v122
  v_mul_f32 v172, v172, v123
  v_mul_f32 v173, v173, v123
  v_mul_f32 v174, v174, v123
  v_mul_f32 v175, v175, v123
  v_mul_f32 v176, v176, v122
  v_mul_f32 v177, v177, v122
  v_mul_f32 v178, v178, v122
  v_mul_f32 v179, v179, v122
  v_mul_f32 v180, v180, v123
  v_mul_f32 v181, v181, v123
  v_mul_f32 v182, v182, v123
  v_mul_f32 v183, v183, v123
  v_mul_f32 v184, v184, v122
  v_mul_f32 v185, v185, v122
  v_mul_f32 v186, v186, v122
  v_mul_f32 v187, v187, v122
  v_mul_f32 v188, v188, v123
  v_mul_f32 v189, v189, v123
  v_mul_f32 v190, v190, v123
  v_mul_f32 v191, v191, v123
  v_mul_f32 v192, v192, v122
  v_mul_f32 v193, v193, v122
  v_mul_f32 v194, v194, v122
  v_mul_f32 v195, v195, v122
  v_mul_f32 v196, v196, v123
  v_mul_f32 v197, v197, v123
  v_mul_f32 v198, v198, v123
  v_mul_f32 v199, v199, v123
  v_mul_f32 v200, v200, v122
  v_mul_f32 v201, v201, v122
  v_mul_f32 v202, v202, v122
  v_mul_f32 v203, v203, v122
  v_mul_f32 v204, v204, v123
  v_mul_f32 v205, v205, v123
  v_mul_f32 v206, v206, v123
  v_mul_f32 v207, v207, v123
  v_mul_f32 v208, v208, v122
  v_mul_f32 v209, v209, v122
  v_mul_f32 v210, v210, v122
  v_mul_f32 v211, v211, v122
  v_mul_f32 v212, v212, v123
  v_mul_f32 v213, v213, v123
  v_mul_f32 v214, v214, v123
  v_mul_f32 v215, v215, v123
  v_mul_f32 v216, v216, v122
  v_mul_f32 v217, v217, v122
  v_mul_f32 v218, v218, v122
  v_mul_f32 v219, v219, v122
  v_mul_f32 v220, v220, v123
  v_mul_f32 v221, v221, v123
  v_mul_f32 v222, v222, v123
  v_mul_f32 v223, v223, v123
  v_mul_f32 v224, v224, v122
  v_mul_f32 v225, v225, v122
  v_mul_f32 v226, v226, v122
  v_mul_f32 v227, v227, v122
  v_mul_f32 v228, v228, v123
  v_mul_f32 v229, v229, v123
  v_mul_f32 v230, v230, v123
  v_mul_f32 v231, v231, v123
  v_mul_f32 v232, v232, v122
  v_mul_f32 v233, v233, v122
  v_mul_f32 v234, v234, v122
  v_mul_f32 v235, v235, v122
  v_mul_f32 v236, v236, v123
  v_mul_f32 v237, v237, v123
  v_mul_f32 v238, v238, v123
  v_mul_f32 v239, v239, v123
  v_mul_f32 v240, v240, v122
  v_mul_f32 v241, v241, v122
  v_mul_f32 v242, v242, v122
  v_mul_f32 v243, v243, v122
  v_mul_f32 v244, v244, v123
  v_mul_f32 v245, v245, v123
  v_mul_f32 v246, v246, v123
  v_mul_f32 v247, v247, v123
  v_mul_f32 v248, v248, v122
  v_mul_f32 v249, v249, v122
  v_mul_f32 v250, v250, v122
  v_mul_f32 v251, v251, v122
  v_mul_f32 v252, v252, v123
  v_mul_f32 v253, v253, v123
  v_mul_f32 v254, v254, v123
  v_mul_f32 v255, v255, v123
  v_mul_f32 v88, v88, v122
  v_mul_f32 v92, v92, v123
  v_exp_f32 v96, v4
  v_exp_f32 v97, v5
  v_exp_f32 v98, v6
  v_exp_f32 v99, v7
  v_add_f32 v76, v96, v97
  v_cvt_pk_bf16_f32 v36, v96, v97
  v_exp_f32 v100, v8
  v_exp_f32 v101, v9
  v_add_f32 v76, v76, v98
  v_add_f32 v76, v76, v99
  v_cvt_pk_bf16_f32 v37, v98, v99
  v_exp_f32 v102, v10
  v_exp_f32 v103, v11
  v_add_f32 v77, v100, v101
  v_cvt_pk_bf16_f32 v40, v100, v101
  v_exp_f32 v96, v12
  v_exp_f32 v97, v13
  v_add_f32 v77, v77, v102
  v_add_f32 v77, v77, v103
  v_cvt_pk_bf16_f32 v41, v102, v103
  v_exp_f32 v98, v14
  v_exp_f32 v99, v15
  v_add_f32 v76, v76, v96
  v_add_f32 v76, v76, v97
  v_cvt_pk_bf16_f32 v38, v96, v97
  v_exp_f32 v100, v16
  v_exp_f32 v101, v17
  v_add_f32 v76, v76, v98
  v_add_f32 v76, v76, v99
  v_cvt_pk_bf16_f32 v39, v98, v99
  v_exp_f32 v102, v18
  v_exp_f32 v103, v19
  v_add_f32 v77, v77, v100
  v_add_f32 v77, v77, v101
  v_cvt_pk_bf16_f32 v42, v100, v101
  v_add_f32 v77, v77, v102
  v_add_f32 v77, v77, v103
  v_cvt_pk_bf16_f32 v43, v102, v103
  s_branch Lk_RTr1
Lk_T0:
  s_cmp_lg_u32 s99, 0
  s_cbranch_scc1 Lk_t67
  s_add_u32 s40, s44, 32
  s_lshl_b32 s40, s40, 7
  buffer_load_dword v119, off, s[20:23], s40 sc1
Lk_t67:
  s_waitcnt vmcnt(16) lgkmcnt(0)
  s_barrier
  v_exp_f32 v98, v30
  ds_read_b128 a[128:131], v116 offset:16384
  v_exp_f32 v99, v31
  ds_read_b128 a[132:135], v116 offset:17408
  v_exp_f32 v100, v32
  ds_read_b128 a[136:139], v116 offset:18432
  v_exp_f32 v101, v33
  ds_read_b128 a[140:143], v116 offset:19456
  v_add_f32 v78, v78, v98
  ds_read_b128 a[144:147], v116 offset:20480
  v_add_f32 v78, v78, v99
  ds_read_b128 a[148:151], v116 offset:21504
  v_cvt_pk_bf16_f32 v47, v98, v99
  ds_read_b128 a[152:155], v116 offset:22528
  v_exp_f32 v102, v34
  ds_read_b128 a[156:159], v116 offset:23552
  v_exp_f32 v103, v35
  ds_read_b128 a[160:163], v116 offset:24576
  v_add_f32 v79, v79, v100
  ds_read_b128 a[164:167], v116 offset:25600
  v_add_f32 v79, v79, v101
  ds_read_b128 a[168:171], v116 offset:26624
  v_cvt_pk_bf16_f32 v50, v100, v101
  ds_read_b128 a[172:175], v116 offset:27648
  v_add_f32 v79, v79, v102
  ds_read_b128 a[176:179], v116 offset:28672
  v_add_f32 v79, v79, v103
  ds_read_b128 a[180:183], v116 offset:29696
  v_cvt_pk_bf16_f32 v51, v102, v103
  ds_read_b128 a[184:187], v116 offset:30720
  v_max_f32 v117, v78, v79
  ds_read_b128 a[188:191], v116 offset:31744
  v_cmp_ngt_f32 vcc, 2.0, v117
  s_nop 4
  s_cbranch_vccnz Lk_RT0
Lk_RTr0:
  s_cmp_lg_u32 s99, 0
  s_cbranch_scc1 Lk_ny70
  s_lshl_b32 s49, s44, 3
  s_lshl_b32 s41, s19, 1
  s_add_u32 s49, s49, s41
  s_mul_i32 s54, s49, 14336
  s_add_u32 s54, s54, 0x4a00000
  s_add_u32 s55, s54, 14336
  s_getpc_b64 s[40:41]
Lk_pc71:
  s_add_u32 s40, s40, Lk_epi-Lk_pc71
  s_addc_u32 s41, s41, 0
  v_and_b32 v120, 63, v0
  v_lshlrev_b32 v120, 7, v120
  s_lshr_b32 s42, s2, 3
  s_lshl_b32 s42, s42, 2
  s_add_u32 s42, s42, s19
  v_add_u32 v120, s42, v120
  v_lshlrev_b32 v120, 7, v120
  v_min_u32 v120, Lk_end-Lk_epi, v120
  s_mov_b64 exec, 7
  global_load_dword v118, v120, s[40:41]
  s_mov_b64 exec, -1
  s_lshl_b32 s32, s49, 10
  s_add_u32 s32, s32, 0x4d00000
  s_waitcnt lgkmcnt(15)
  v_mfma_f32_16x16x32_bf16 v[128:131], a[128:131], v[44:47], v[128:131]
  s_add_u32 m0, s77, 0xc000
  v_add_f32 v88, v88, v78
  v_add_f32 v92, v92, v79
  v_mfma_f32_16x16x32_bf16 v[132:135], a[128:131], v[48:51], v[132:135]
  buffer_load_dwordx4 v3, s[12:15], s39 offen offset:0 sc1 lds
  s_waitcnt lgkmcnt(14)
  v_mfma_f32_16x16x32_bf16 v[140:143], a[132:135], v[48:51], v[140:143]
  ds_read_b128 a[64:67], v116 offset:0
  v_mfma_f32_16x16x32_bf16 v[136:139], a[132:135], v[44:47], v[136:139]
  buffer_load_dwordx4 v3, s[12:15], s39 offen offset:1024 sc1 lds
  s_waitcnt lgkmcnt(14)
  v_mfma_f32_16x16x32_bf16 v[144:147], a[136:139], v[44:47], v[144:147]
  ds_read_b128 a[68:71], v116 offset:1024
  v_mfma_f32_16x16x32_bf16 v[148:151], a[136:139], v[48:51], v[148:151]
  buffer_load_dwordx4 v3, s[12:15], s39 offen offset:2048 sc1 lds
  s_waitcnt lgkmcnt(14)
  v_mfma_f32_16x16x32_bf16 v[156:159], a[140:143], v[48:51], v[156:159]
  ds_read_b128 a[72:75], v116 offset:2048
  v_mfma_f32_16x16x32_bf16 v[152:155], a[140:143], v[44:47], v[152:155]
  buffer_load_dwordx4 v3, s[12:15], s39 offen offset:3072 sc1 lds
  s_waitcnt lgkmcnt(14)
  v_mfma_f32_16x16x32_bf16 v[160:163], a[144:147], v[44:47], v[160:163]
  s_add_u32 s39, s38, 0x4000
  ds_read_b128 a[76:79], v116 offset:3072
  v_mfma_f32_16x16x32_bf16 v[164:167], a[144:147], v[48:51], v[164:167]
  s_cmp_eq_u32 s39, s3
  s_cselect_b32 s39, s76, s39
  ds_read_b128 a[80:83], v116 offset:4096
  s_waitcnt lgkmcnt(15)
  v_mfma_f32_16x16x32_bf16 v[172:175], a[148:151], v[48:51], v[172:175]
  s_add_u32 m0, s77, 0x8000
  ds_read_b128 a[84:87], v116 offset:5120
  v_mfma_f32_16x16x32_bf16 v[168:171], a[148:151], v[44:47], v[168:171]
  buffer_load_dwordx4 v3, s[8:11], s39 offen offset:0 sc1 lds
  s_waitcnt lgkmcnt(15)
  v_mfma_f32_16x16x32_bf16 v[176:179], a[152:155], v[44:47], v[176:179]
  ds_read_b128 a[88:91], v116 offset:6144
  v_mfma_f32_16x16x32_bf16 v[180:183], a[152:155], v[48:51], v[180:183]
  buffer_load_dwordx4 v3, s[8:11], s39 offen offset:1024 sc1 lds
  s_add_u32 s40, s44, 32
  s_lshl_b32 s40, s40, 7
  v_mov_b32 v120, s40
  v_mov_b32 v121, 7
  s_waitcnt vmcnt(7)
  v_cmp_lt_u32 vcc, v119, v121
  s_nop 4
  s_cbranch_vccz Lk_go73
  s_mov_b32 s43, 0
Lk_poll72:
  s_sleep 3
  buffer_load_dword v119, v120, s[20:23], 0 offen offset:0 sc1
  s_waitcnt vmcnt(0)
  v_cmp_lt_u32 vcc, v119, v121
  s_nop 4
  s_cbranch_vccz Lk_go73
  s_add_u32 s43, s43, 1
  s_cmp_lt_u32 s43, 0x40000
  s_cbranch_scc1 Lk_poll72
Lk_go73:
  s_waitcnt lgkmcnt(15)
  v_mfma_f32_16x16x32_bf16 v[188:191], a[156:159], v[48:51], v[188:191]
  buffer_load_dwordx4 v3, s[8:11], s39 offen offset:2048 sc1 lds
  v_mfma_f32_16x16x32_bf16 v[184:187], a[156:159], v[44:47], v[184:187]
  ds_read_b128 a[92:95], v116 offset:7168
  s_waitcnt lgkmcnt(15)
  v_mfma_f32_16x16x32_bf16 v[192:195], a[160:163], v[44:47], v[192:195]
  buffer_load_dwordx4 v3, s[8:11], s39 offen offset:3072 sc1 lds
  v_mfma_f32_16x16x32_bf16 v[196:199], a[160:163], v[48:51], v[196:199]
  s_xor_b32 s77, s77, 0x10000
  ds_read_b128 a[96:99], v116 offset:8192
  s_waitcnt lgkmcnt(15)
  v_mfma_f32_16x16x32_bf16 v[204:207], a[164:167], v[48:51], v[204:207]
  buffer_load_dwordx4 v[68:71], v2, s[28:31], s32 offen offset:0 sc1
  v_mfma_f32_16x16x32_bf16 v[200:203], a[164:167], v[44:47], v[200:203]
  ds_read_b128 a[100:103], v116 offset:9216
  s_waitcnt lgkmcnt(15)
  v_mfma_f32_16x16x32_bf16 v[208:211], a[168:171], v[44:47], v[208:211]
  buffer_load_dwordx4 v[72:75], v2, s[28:31], s32 offen offset:1024 sc1
  v_mfma_f32_16x16x32_bf16 v[212:215], a[168:171], v[48:51], v[212:215]
  ds_read_b128 a[104:107], v116 offset:10240
  s_waitcnt lgkmcnt(15)
  v_mfma_f32_16x16x32_bf16 v[220:223], a[172:175], v[48:51], v[220:223]
  buffer_load_dwordx4 a[0:3], v2, s[28:31], s54 offen offset:0 sc1
  v_mfma_f32_16x16x32_bf16 v[216:219], a[172:175], v[44:47], v[216:219]
  ds_read_b128 a[108:111], v116 offset:11264
  s_waitcnt lgkmcnt(15)
  v_mfma_f32_16x16x32_bf16 v[224:227], a[176:179], v[44:47], v[224:227]
  buffer_load_dwordx4 a[4:7], v2, s[28:31], s55 offen offset:0 sc1
  v_mfma_f32_16x16x32_bf16 v[228:231], a[176:179], v[48:51], v[228:231]
  ds_read_b128 a[112:115], v116 offset:12288
  s_waitcnt lgkmcnt(15)
  v_mfma_f32_16x16x32_bf16 v[236:239], a[180:183], v[48:51], v[236:239]
  buffer_load_dwordx4 a[8:11], v2, s[28:31], s54 offen offset:1024 sc1
  v_mfma_f32_16x16x32_bf16 v[232:235], a[180:183], v[44:47], v[232:235]
  ds_read_b128 a[116:119], v116 offset:13312
  s_waitcnt lgkmcnt(15)
  v_mfma_f32_16x16x32_bf16 v[240:243], a[184:187], v[44:47], v[240:243]
  buffer_load_dwordx4 a[12:15], v2, s[28:31], s55 offen offset:1024 sc1
  v_mfma_f32_16x16x32_bf16 v[244:247], a[184:187], v[48:51], v[244:247]
  ds_read_b128 a[120:123], v116 offset:14336
  s_waitcnt lgkmcnt(15)
  v_mfma_f32_16x16x32_bf16 v[252:255], a[188:191], v[48:51], v[252:255]
  buffer_load_dwordx4 a[16:19], v2, s[28:31], s54 offen offset:2048 sc1
  v_mfma_f32_16x16x32_bf16 v[248:251], a[188:191], v[44:47], v[248:251]
  ds_read_b128 a[124:127], v116 offset:15360
  buffer_load_dwordx4 a[20:23], v2, s[28:31], s55 offen offset:2048 sc1
  buffer_load_dwordx4 a[24:27], v2, s[28:31], s54 offen offset:3072 sc1
  buffer_load_dwordx4 a[28:31], v2, s[28:31], s55 offen offset:3072 sc1
  s_branch Lk_I1
Lk_ny70:
  s_waitcnt lgkmcnt(15)
  v_mfma_f32_16x16x32_bf16 v[128:131], a[128:131], v[44:47], v[128:131]
  s_add_u32 m0, s77, 0xc000
  v_add_f32 v88, v88, v78
  v_add_f32 v92, v92, v79
  v_mfma_f32_16x16x32_bf16 v[132:135], a[128:131], v[48:51], v[132:135]
  buffer_load_dwordx4 v3, s[12:15], s39 offen offset:0 sc1 lds
  s_waitcnt lgkmcnt(14)
  v_mfma_f32_16x16x32_bf16 v[140:143], a[132:135], v[48:51], v[140:143]
  buffer_load_dwordx4 v3, s[12:15], s39 offen offset:1024 sc1 lds
  v_mfma_f32_16x16x32_bf16 v[136:139], a[132:135], v[44:47], v[136:139]
  ds_read_b128 a[64:67], v116 offset:0
  s_waitcnt lgkmcnt(14)
  v_mfma_f32_16x16x32_bf16 v[144:147], a[136:139], v[44:47], v[144:147]
  buffer_load_dwordx4 v3, s[12:15], s39 offen offset:2048 sc1 lds
  v_mfma_f32_16x16x32_bf16 v[148:151], a[136:139], v[48:51], v[148:151]
  buffer_load_dwordx4 v3, s[12:15], s39 offen offset:3072 sc1 lds
  s_waitcnt lgkmcnt(13)
  v_mfma_f32_16x16x32_bf16 v[156:159], a[140:143], v[48:51], v[156:159]
  s_add_u32 s39, s38, 0x4000
  ds_read_b128 a[68:71], v116 offset:1024
  v_mfma_f32_16x16x32_bf16 v[152:155], a[140:143], v[44:47], v[152:155]
  s_cmp_eq_u32 s39, s3
  s_cselect_b32 s39, s76, s39
  ds_read_b128 a[72:75], v116 offset:2048
  s_waitcnt lgkmcnt(14)
  v_mfma_f32_16x16x32_bf16 v[160:163], a[144:147], v[44:47], v[160:163]
  s_add_u32 m0, s77, 0x8000
  ds_read_b128 a[76:79], v116 offset:3072
  v_mfma_f32_16x16x32_bf16 v[164:167], a[144:147], v[48:51], v[164:167]
  buffer_load_dwordx4 v3, s[8:11], s39 offen offset:0 sc1 lds
  s_waitcnt lgkmcnt(14)
  v_mfma_f32_16x16x32_bf16 v[172:175], a[148:151], v[48:51], v[172:175]
  buffer_load_dwordx4 v3, s[8:11], s39 offen offset:1024 sc1 lds
  v_mfma_f32_16x16x32_bf16 v[168:171], a[148:151], v[44:47], v[168:171]
  ds_read_b128 a[80:83], v116 offset:4096
  s_waitcnt lgkmcnt(14)
  v_mfma_f32_16x16x32_bf16 v[176:179], a[152:155], v[44:47], v[176:179]
  buffer_load_dwordx4 v3, s[8:11], s39 offen offset:2048 sc1 lds
  v_mfma_f32_16x16x32_bf16 v[180:183], a[152:155], v[48:51], v[180:183]
  buffer_load_dwordx4 v3, s[8:11], s39 offen offset:3072 sc1 lds
  s_waitcnt lgkmcnt(13)
  v_mfma_f32_16x16x32_bf16 v[188:191], a[156:159], v[48:51], v[188:191]
  s_xor_b32 s77, s77, 0x10000
  ds_read_b128 a[84:87], v116 offset:5120
  v_mfma_f32_16x16x32_bf16 v[184:187], a[156:159], v[44:47], v[184:187]
  s_lshl_b32 s54, s50, 20
  s_sub_u32 s55, 15, s44
  ds_read_b128 a[88:91], v116 offset:6144
  s_waitcnt lgkmcnt(14)
  v_mfma_f32_16x16x32_bf16 v[192:195], a[160:163], v[44:47], v[192:195]
  s_lshl_b32 s55, s55, 16
  s_add_u32 s54, s54, s55
  ds_read_b128 a[92:95], v116 offset:7168
  v_mfma_f32_16x16x32_bf16 v[196:199], a[160:163], v[48:51], v[196:199]
  s_lshl_b32 s55, s19, 14
  s_add_u32 s54, s54, s55
  ds_read_b128 a[96:99], v116 offset:8192
  s_waitcnt lgkmcnt(15)
  v_mfma_f32_16x16x32_bf16 v[204:207], a[164:167], v[48:51], v[204:207]
  s_add_u32 s54, s54, 0x7000000
  ds_read_b128 a[100:103], v116 offset:9216
  v_mfma_f32_16x16x32_bf16 v[200:203], a[164:167], v[44:47], v[200:203]
  buffer_load_dwordx4 a[0:3], v2, s[28:31], s54 offen offset:0 sc1
  s_waitcnt lgkmcnt(15)
  v_mfma_f32_16x16x32_bf16 v[208:211], a[168:171], v[44:47], v[208:211]
  buffer_load_dwordx4 a[4:7], v2, s[28:31], s54 offen offset:1024 sc1
  v_mfma_f32_16x16x32_bf16 v[212:215], a[168:171], v[48:51], v[212:215]
  ds_read_b128 a[104:107], v116 offset:10240
  s_waitcnt lgkmcnt(15)
  v_mfma_f32_16x16x32_bf16 v[220:223], a[172:175], v[48:51], v[220:223]
  buffer_load_dwordx4 a[8:11], v2, s[28:31], s54 offen offset:2048 sc1
  v_mfma_f32_16x16x32_bf16 v[216:219], a[172:175], v[44:47], v[216:219]
  buffer_load_dwordx4 a[12:15], v2, s[28:31], s54 offen offset:3072 sc1
  s_waitcnt lgkmcnt(14)
  v_mfma_f32_16x16x32_bf16 v[224:227], a[176:179], v[44:47], v[224:227]
  s_add_u32 s54, s54, 0x1000
  ds_read_b128 a[108:111], v116 offset:11264
  v_mfma_f32_16x16x32_bf16 v[228:231], a[176:179], v[48:51], v[228:231]
  buffer_load_dwordx4 a[16:19], v2, s[28:31], s54 offen offset:0 sc1
  s_waitcnt lgkmcnt(14)
  v_mfma_f32_16x16x32_bf16 v[236:239], a[180:183], v[48:51], v[236:239]
  ds_read_b128 a[112:115], v116 offset:12288
  v_mfma_f32_16x16x32_bf16 v[232:235], a[180:183], v[44:47], v[232:235]
  buffer_load_dwordx4 a[20:23], v2, s[28:31], s54 offen offset:1024 sc1
  s_waitcnt lgkmcnt(14)
  v_mfma_f32_16x16x32_bf16 v[240:243], a[184:187], v[44:47], v[240:243]
  ds_read_b128 a[116:119], v116 offset:13312
  v_mfma_f32_16x16x32_bf16 v[244:247], a[184:187], v[48:51], v[244:247]
  buffer_load_dwordx4 a[24:27], v2, s[28:31], s54 offen offset:2048 sc1
  s_waitcnt lgkmcnt(14)
  v_mfma_f32_16x16x32_bf16 v[252:255], a[188:191], v[48:51], v[252:255]
  buffer_load_dwordx4 a[28:31], v2, s[28:31], s54 offen offset:3072 sc1
  v_mfma_f32_16x16x32_bf16 v[248:251], a[188:191], v[44:47], v[248:251]
  s_add_u32 s54, s54, 0x1000
  ds_read_b128 a[120:123], v116 offset:14336
  ds_read_b128 a[124:127], v116 offset:15360
  s_branch Lk_I1
Lk_T1:
  s_cmp_lg_u32 s99, 0
  s_cbranch_scc1 Lk_t74
  s_add_u32 s40, s44, 32
  s_lshl_b32 s40, s40, 7
  buffer_load_dword v119, off, s[20:23], s40 sc1
Lk_t74:
  s_waitcnt vmcnt(16) lgkmcnt(0)
  s_barrier
  v_exp_f32 v98, v14
  ds_read_b128 a[128:131], v116 offset:49152
  v_exp_f32 v99, v15
  ds_read_b128 a[132:135], v116 offset:50176
  v_exp_f32 v100, v16
  ds_read_b128 a[136:139], v116 offset:51200
  v_exp_f32 v101, v17
  ds_read_b128 a[140:143], v116 offset:52224
  v_add_f32 v76, v76, v98
  ds_read_b128 a[144:147], v116 offset:53248
  v_add_f32 v76, v76, v99
  ds_read_b128 a[148:151], v116 offset:54272
  v_cvt_pk_bf16_f32 v39, v98, v99
  ds_read_b128 a[152:155], v116 offset:55296
  v_exp_f32 v102, v18
  ds_read_b128 a[156:159], v116 offset:56320
  v_exp_f32 v103, v19
  ds_read_b128 a[160:163], v116 offset:57344
  v_add_f32 v77, v77, v100
  ds_read_b128 a[164:167], v116 offset:58368
  v_add_f32 v77, v77, v101
  ds_read_b128 a[168:171], v116 offset:59392
  v_cvt_pk_bf16_f32 v42, v100, v101
  ds_read_b128 a[172:175], v116 offset:60416
  v_add_f32 v77, v77, v102
  ds_read_b128 a[176:179], v116 offset:61440
  v_add_f32 v77, v77, v103
  ds_read_b128 a[180:183], v116 offset:62464
  v_cvt_pk_bf16_f32 v43, v102, v103
  ds_read_b128 a[184:187], v116 offset:63488
  v_max_f32 v117, v76, v77
  ds_read_b128 a[188:191], v116 offset:64512
  v_cmp_ngt_f32 vcc, 2.0, v117
  s_nop 4
  s_cbranch_vccnz Lk_RT1
Lk_RTr1:
  s_cmp_lg_u32 s99, 0
  s_cbranch_scc1 Lk_ny77
  s_lshl_b32 s49, s44, 3
  s_lshl_b32 s41, s19, 1
  s_add_u32 s49, s49, s41
  s_mul_i32 s54, s49, 14336
  s_add_u32 s54, s54, 0x4a00000
  s_add_u32 s55, s54, 14336
  s_getpc_b64 s[40:41]
Lk_pc78:
  s_add_u32 s40, s40, Lk_epi-Lk_pc78
  s_addc_u32 s41, s41, 0
  v_and_b32 v120, 63, v0
  v_lshlrev_b32 v120, 7, v120
  s_lshr_b32 s42, s2, 3
  s_lshl_b32 s42, s42, 2
  s_add_u32 s42, s42, s19
  v_add_u32 v120, s42, v120
  v_lshlrev_b32 v120, 7, v120
  v_min_u32 v120, Lk_end-Lk_epi, v120
  s_mov_b64 exec, 7
  global_load_dword v118, v120, s[40:41]
  s_mov_b64 exec, -1
  s_lshl_b32 s32, s49, 10
  s_add_u32 s32, s32, 0x4d00000
  s_waitcnt lgkmcnt(15)
  v_mfma_f32_16x16x32_bf16 v[128:131], a[128:131], v[36:39], v[128:131]
  s_add_u32 m0, s77, 0x4000
  v_add_f32 v88, v88, v76
  v_add_f32 v92, v92, v77
  v_mfma_f32_16x16x32_bf16 v[132:135], a[128:131], v[40:43], v[132:135]
  buffer_load_dwordx4 v3, s[12:15], s38 offen offset:0 sc1 lds
  s_waitcnt lgkmcnt(14)
  v_mfma_f32_16x16x32_bf16 v[140:143], a[132:135], v[40:43], v[140:143]
  ds_read_b128 a[64:67], v116 offset:32768
  v_mfma_f32_16x16x32_bf16 v[136:139], a[132:135], v[36:39], v[136:139]
  buffer_load_dwordx4 v3, s[12:15], s38 offen offset:1024 sc1 lds
  s_waitcnt lgkmcnt(14)
  v_mfma_f32_16x16x32_bf16 v[144:147], a[136:139], v[36:39], v[144:147]
  ds_read_b128 a[68:71], v116 offset:33792
  v_mfma_f32_16x16x32_bf16 v[148:151], a[136:139], v[40:43], v[148:151]
  buffer_load_dwordx4 v3, s[12:15], s38 offen offset:2048 sc1 lds
  s_waitcnt lgkmcnt(14)
  v_mfma_f32_16x16x32_bf16 v[156:159], a[140:143], v[40:43], v[156:159]
  ds_read_b128 a[72:75], v116 offset:34816
  v_mfma_f32_16x16x32_bf16 v[152:155], a[140:143], v[36:39], v[152:155]
  buffer_load_dwordx4 v3, s[12:15], s38 offen offset:3072 sc1 lds
  s_waitcnt lgkmcnt(14)
  v_mfma_f32_16x16x32_bf16 v[160:163], a[144:147], v[36:39], v[160:163]
  s_add_u32 s38, s39, 0x4000
  ds_read_b128 a[76:79], v116 offset:35840
  v_mfma_f32_16x16x32_bf16 v[164:167], a[144:147], v[40:43], v[164:167]
  s_cmp_eq_u32 s38, s3
  s_cselect_b32 s38, s76, s38
  ds_read_b128 a[80:83], v116 offset:36864
  s_waitcnt lgkmcnt(15)
  v_mfma_f32_16x16x32_bf16 v[172:175], a[148:151], v[40:43], v[172:175]
  s_mov_b32 m0, s77
  ds_read_b128 a[84:87], v116 offset:37888
  v_mfma_f32_16x16x32_bf16 v[168:171], a[148:151], v[36:39], v[168:171]
  buffer_load_dwordx4 v3, s[8:11], s38 offen offset:0 sc1 lds
  s_waitcnt lgkmcnt(15)
  v_mfma_f32_16x16x32_bf16 v[176:179], a[152:155], v[36:39], v[176:179]
  ds_read_b128 a[88:91], v116 offset:38912
  v_mfma_f32_16x16x32_bf16 v[180:183], a[152:155], v[40:43], v[180:183]
  buffer_load_dwordx4 v3, s[8:11], s38 offen offset:1024 sc1 lds
  s_add_u32 s40, s44, 32
  s_lshl_b32 s40, s40, 7
  v_mov_b32 v120, s40
  v_mov_b32 v121, 7
  s_waitcnt vmcnt(7)
  v_cmp_lt_u32 vcc, v119, v121
  s_nop 4
  s_cbranch_vccz Lk_go80
  s_mov_b32 s43, 0
Lk_poll79:
  s_sleep 3
  buffer_load_dword v119, v120, s[20:23], 0 offen offset:0 sc1
  s_waitcnt vmcnt(0)
  v_cmp_lt_u32 vcc, v119, v121
  s_nop 4
  s_cbranch_vccz Lk_go80
  s_add_u32 s43, s43, 1
  s_cmp_lt_u32 s43, 0x40000
  s_cbranch_scc1 Lk_poll79
Lk_go80:
  s_waitcnt lgkmcnt(15)
  v_mfma_f32_16x16x32_bf16 v[188:191], a[156:159], v[40:43], v[188:191]
  buffer_load_dwordx4 v3, s[8:11], s38 offen offset:2048 sc1 lds
  v_mfma_f32_16x16x32_bf16 v[184:187], a[156:159], v[36:39], v[184:187]
  ds_read_b128 a[92:95], v116 offset:39936
  s_waitcnt lgkmcnt(15)
  v_mfma_f32_16x16x32_bf16 v[192:195], a[160:163], v[36:39], v[192:195]
  buffer_load_dwordx4 v3, s[8:11], s38 offen offset:3072 sc1 lds
  v_mfma_f32_16x16x32_bf16 v[196:199], a[160:163], v[40:43], v[196:199]
  ds_read_b128 a[96:99], v116 offset:40960
  s_waitcnt lgkmcnt(15)
  v_mfma_f32_16x16x32_bf16 v[204:207], a[164:167], v[40:43], v[204:207]
  buffer_load_dwordx4 v[68:71], v2, s[28:31], s32 offen offset:0 sc1
  v_mfma_f32_16x16x32_bf16 v[200:203], a[164:167], v[36:39], v[200:203]
  ds_read_b128 a[100:103], v116 offset:41984
  s_waitcnt lgkmcnt(15)
  v_mfma_f32_16x16x32_bf16 v[208:211], a[168:171], v[36:39], v[208:211]
  buffer_load_dwordx4 v[72:75], v2, s[28:31], s32 offen offset:1024 sc1
  v_mfma_f32_16x16x32_bf16 v[212:215], a[168:171], v[40:43], v[212:215]
  ds_read_b128 a[104:107], v116 offset:43008
  s_waitcnt lgkmcnt(15)
  v_mfma_f32_16x16x32_bf16 v[220:223], a[172:175], v[40:43], v[220:223]
  buffer_load_dwordx4 a[0:3], v2, s[28:31], s54 offen offset:0 sc1
  v_mfma_f32_16x16x32_bf16 v[216:219], a[172:175], v[36:39], v[216:219]
  ds_read_b128 a[108:111], v116 offset:44032
  s_waitcnt lgkmcnt(15)
  v_mfma_f32_16x16x32_bf16 v[224:227], a[176:179], v[36:39], v[224:227]
  buffer_load_dwordx4 a[4:7], v2, s[28:31], s55 offen offset:0 sc1
  v_mfma_f32_16x16x32_bf16 v[228:231], a[176:179], v[40:43], v[228:231]
  ds_read_b128 a[112:115], v116 offset:45056
  s_waitcnt lgkmcnt(15)
  v_mfma_f32_16x16x32_bf16 v[236:239], a[180:183], v[40:43], v[236:239]
  buffer_load_dwordx4 a[8:11], v2, s[28:31], s54 offen offset:1024 sc1
  v_mfma_f32_16x16x32_bf16 v[232:235], a[180:183], v[36:39], v[232:235]
  ds_read_b128 a[116:119], v116 offset:46080
  s_waitcnt lgkmcnt(15)
  v_mfma_f32_16x16x32_bf16 v[240:243], a[184:187], v[36:39], v[240:243]
  buffer_load_dwordx4 a[12:15], v2, s[28:31], s55 offen offset:1024 sc1
  v_mfma_f32_16x16x32_bf16 v[244:247], a[184:187], v[40:43], v[244:247]
  ds_read_b128 a[120:123], v116 offset:47104
  s_waitcnt lgkmcnt(15)
  v_mfma_f32_16x16x32_bf16 v[252:255], a[188:191], v[40:43], v[252:255]
  buffer_load_dwordx4 a[16:19], v2, s[28:31], s54 offen offset:2048 sc1
  v_mfma_f32_16x16x32_bf16 v[248:251], a[188:191], v[36:39], v[248:251]
  ds_read_b128 a[124:127], v116 offset:48128
  v_xor_b32 v116, 0x10000, v116
  buffer_load_dwordx4 a[20:23], v2, s[28:31], s55 offen offset:2048 sc1
  buffer_load_dwordx4 a[24:27], v2, s[28:31], s54 offen offset:3072 sc1
  buffer_load_dwordx4 a[28:31], v2, s[28:31], s55 offen offset:3072 sc1
  s_branch Lk_I0
Lk_ny77:
  s_waitcnt lgkmcnt(15)
  v_mfma_f32_16x16x32_bf16 v[128:131], a[128:131], v[36:39], v[128:131]
  s_add_u32 m0, s77, 0x4000
  v_add_f32 v88, v88, v76
  v_add_f32 v92, v92, v77
  v_mfma_f32_16x16x32_bf16 v[132:135], a[128:131], v[40:43], v[132:135]
  buffer_load_dwordx4 v3, s[12:15], s38 offen offset:0 sc1 lds
  s_waitcnt lgkmcnt(14)
  v_mfma_f32_16x16x32_bf16 v[140:143], a[132:135], v[40:43], v[140:143]
  buffer_load_dwordx4 v3, s[12:15], s38 offen offset:1024 sc1 lds
  v_mfma_f32_16x16x32_bf16 v[136:139], a[132:135], v[36:39], v[136:139]
  ds_read_b128 a[64:67], v116 offset:32768
  s_waitcnt lgkmcnt(14)
  v_mfma_f32_16x16x32_bf16 v[144:147], a[136:139], v[36:39], v[144:147]
  buffer_load_dwordx4 v3, s[12:15], s38 offen offset:2048 sc1 lds
  v_mfma_f32_16x16x32_bf16 v[148:151], a[136:139], v[40:43], v[148:151]
  buffer_load_dwordx4 v3, s[12:15], s38 offen offset:3072 sc1 lds
  s_waitcnt lgkmcnt(13)
  v_mfma_f32_16x16x32_bf16 v[156:159], a[140:143], v[40:43], v[156:159]
  s_add_u32 s38, s39, 0x4000
  ds_read_b128 a[68:71], v116 offset:33792
  v_mfma_f32_16x16x32_bf16 v[152:155], a[140:143], v[36:39], v[152:155]
  s_cmp_eq_u32 s38, s3
  s_cselect_b32 s38, s76, s38
  ds_read_b128 a[72:75], v116 offset:34816
  s_waitcnt lgkmcnt(14)
  v_mfma_f32_16x16x32_bf16 v[160:163], a[144:147], v[36:39], v[160:163]
  s_mov_b32 m0, s77
  ds_read_b128 a[76:79], v116 offset:35840
  v_mfma_f32_16x16x32_bf16 v[164:167], a[144:147], v[40:43], v[164:167]
  buffer_load_dwordx4 v3, s[8:11], s38 offen offset:0 sc1 lds
  s_waitcnt lgkmcnt(14)
  v_mfma_f32_16x16x32_bf16 v[172:175], a[148:151], v[40:43], v[172:175]
  buffer_load_dwordx4 v3, s[8:11], s38 offen offset:1024 sc1 lds
  v_mfma_f32_16x16x32_bf16 v[168:171], a[148:151], v[36:39], v[168:171]
  ds_read_b128 a[80:83], v116 offset:36864
  s_waitcnt lgkmcnt(14)
  v_mfma_f32_16x16x32_bf16 v[176:179], a[152:155], v[36:39], v[176:179]
  buffer_load_dwordx4 v3, s[8:11], s38 offen offset:2048 sc1 lds
  v_mfma_f32_16x16x32_bf16 v[180:183], a[152:155], v[40:43], v[180:183]
  buffer_load_dwordx4 v3, s[8:11], s38 offen offset:3072 sc1 lds
  s_waitcnt lgkmcnt(13)
  v_mfma_f32_16x16x32_bf16 v[188:191], a[156:159], v[40:43], v[188:191]
  s_lshl_b32 s54, s50, 20
  s_sub_u32 s55, 15, s44
  ds_read_b128 a[84:87], v116 offset:37888
  v_mfma_f32_16x16x32_bf16 v[184:187], a[156:159], v[36:39], v[184:187]
  s_lshl_b32 s55, s55, 16
  s_add_u32 s54, s54, s55
  ds_read_b128 a[88:91], v116 offset:38912
  s_waitcnt lgkmcnt(14)
  v_mfma_f32_16x16x32_bf16 v[192:195], a[160:163], v[36:39], v[192:195]
  s_lshl_b32 s55, s19, 14
  s_add_u32 s54, s54, s55
  ds_read_b128 a[92:95], v116 offset:39936
  v_mfma_f32_16x16x32_bf16 v[196:199], a[160:163], v[40:43], v[196:199]
  s_add_u32 s54, s54, 0x7000000
  ds_read_b128 a[96:99], v116 offset:40960
  s_waitcnt lgkmcnt(15)
  v_mfma_f32_16x16x32_bf16 v[204:207], a[164:167], v[40:43], v[204:207]
  buffer_load_dwordx4 a[0:3], v2, s[28:31], s54 offen offset:0 sc1
  v_mfma_f32_16x16x32_bf16 v[200:203], a[164:167], v[36:39], v[200:203]
  buffer_load_dwordx4 a[4:7], v2, s[28:31], s54 offen offset:1024 sc1
  s_waitcnt lgkmcnt(14)
  v_mfma_f32_16x16x32_bf16 v[208:211], a[168:171], v[36:39], v[208:211]
  ds_read_b128 a[100:103], v116 offset:41984
  v_mfma_f32_16x16x32_bf16 v[212:215], a[168:171], v[40:43], v[212:215]
  buffer_load_dwordx4 a[8:11], v2, s[28:31], s54 offen offset:2048 sc1
  s_waitcnt lgkmcnt(14)
  v_mfma_f32_16x16x32_bf16 v[220:223], a[172:175], v[40:43], v[220:223]
  buffer_load_dwordx4 a[12:15], v2, s[28:31], s54 offen offset:3072 sc1
  v_mfma_f32_16x16x32_bf16 v[216:219], a[172:175], v[36:39], v[216:219]
  s_add_u32 s54, s54, 0x1000
  ds_read_b128 a[104:107], v116 offset:43008
  s_waitcnt lgkmcnt(14)
  v_mfma_f32_16x16x32_bf16 v[224:227], a[176:179], v[36:39], v[224:227]
  buffer_load_dwordx4 a[16:19], v2, s[28:31], s54 offen offset:0 sc1
  v_mfma_f32_16x16x32_bf16 v[228:231], a[176:179], v[40:43], v[228:231]
  ds_read_b128 a[108:111], v116 offset:44032
  s_waitcnt lgkmcnt(14)
  v_mfma_f32_16x16x32_bf16 v[236:239], a[180:183], v[40:43], v[236:239]
  buffer_load_dwordx4 a[20:23], v2, s[28:31], s54 offen offset:1024 sc1
  v_mfma_f32_16x16x32_bf16 v[232:235], a[180:183], v[36:39], v[232:235]
  ds_read_b128 a[112:115], v116 offset:45056
  s_waitcnt lgkmcnt(14)
  v_mfma_f32_16x16x32_bf16 v[240:243], a[184:187], v[36:39], v[240:243]
  buffer_load_dwordx4 a[24:27], v2, s[28:31], s54 offen offset:2048 sc1
  v_mfma_f32_16x16x32_bf16 v[244:247], a[184:187], v[40:43], v[244:247]
  buffer_load_dwordx4 a[28:31], v2, s[28:31], s54 offen offset:3072 sc1
  s_waitcnt lgkmcnt(13)
  v_mfma_f32_16x16x32_bf16 v[252:255], a[188:191], v[40:43], v[252:255]
  s_add_u32 s54, s54, 0x1000
  ds_read_b128 a[116:119], v116 offset:46080
  v_mfma_f32_16x16x32_bf16 v[248:251], a[188:191], v[36:39], v[248:251]
  ds_read_b128 a[120:123], v116 offset:47104
  ds_read_b128 a[124:127], v116 offset:48128
  v_xor_b32 v116, 0x10000, v116
  s_branch Lk_I0
Lk_I0:
  s_mov_b32 s37, 0
  s_sub_u32 s35, s35, 1
  s_cbranch_scc1 Lk_epi
  s_waitcnt vmcnt(16) lgkmcnt(0)
  s_barrier
  ds_read_b128 a[64:67], v116 offset:0
  ds_read_b128 a[68:71], v116 offset:1024
  ds_read_b128 a[72:75], v116 offset:2048
  ds_read_b128 a[76:79], v116 offset:3072
  ds_read_b128 a[80:83], v116 offset:4096
  ds_read_b128 a[84:87], v116 offset:5120
  ds_read_b128 a[88:91], v116 offset:6144
  ds_read_b128 a[92:95], v116 offset:7168
  ds_read_b128 a[96:99], v116 offset:8192
  ds_read_b128 a[100:103], v116 offset:9216
  ds_read_b128 a[104:107], v116 offset:10240
  ds_read_b128 a[108:111], v116 offset:11264
  ds_read_b128 a[112:115], v116 offset:12288
  ds_read_b128 a[116:119], v116 offset:13312
  ds_read_b128 a[120:123], v116 offset:14336
  ds_read_b128 a[124:127], v116 offset:15360
  s_add_u32 m0, s77, 0xc000
  s_nop 0
  buffer_load_dwordx4 v3, s[12:15], s39 offen offset:0 sc1 lds
  buffer_load_dwordx4 v3, s[12:15], s39 offen offset:1024 sc1 lds
  buffer_load_dwordx4 v3, s[12:15], s39 offen offset:2048 sc1 lds
  buffer_load_dwordx4 v3, s[12:15], s39 offen offset:3072 sc1 lds
  s_add_u32 s39, s38, 0x4000
  s_cmp_eq_u32 s39, s3
  s_cselect_b32 s39, s76, s39
  s_add_u32 m0, s77, 0x8000
  s_nop 0
  buffer_load_dwordx4 v3, s[8:11], s39 offen offset:0 sc1 lds
  buffer_load_dwordx4 v3, s[8:11], s39 offen offset:1024 sc1 lds
  buffer_load_dwordx4 v3, s[8:11], s39 offen offset:2048 sc1 lds
  buffer_load_dwordx4 v3, s[8:11], s39 offen offset:3072 sc1 lds
  s_xor_b32 s77, s77, 0x10000
Lk_I1:
  s_mov_b32 s37, 1
  s_sub_u32 s35, s35, 1
  s_cbranch_scc1 Lk_epi
  s_waitcnt vmcnt(16) lgkmcnt(0)
  s_barrier
  ds_read_b128 a[64:67], v116 offset:32768
  ds_read_b128 a[68:71], v116 offset:33792
  ds_read_b128 a[72:75], v116 offset:34816
  ds_read_b128 a[76:79], v116 offset:35840
  ds_read_b128 a[80:83], v116 offset:36864
  ds_read_b128 a[84:87], v116 offset:37888
  ds_read_b128 a[88:91], v116 offset:38912
  ds_read_b128 a[92:95], v116 offset:39936
  ds_read_b128 a[96:99], v116 offset:40960
  ds_read_b128 a[100:103], v116 offset:41984
  ds_read_b128 a[104:107], v116 offset:43008
  ds_read_b128 a[108:111], v116 offset:44032
  ds_read_b128 a[112:115], v116 offset:45056
  ds_read_b128 a[116:119], v116 offset:46080
  ds_read_b128 a[120:123], v116 offset:47104
  ds_read_b128 a[124:127], v116 offset:48128
  v_xor_b32 v116, 0x10000, v116
  s_add_u32 m0, s77, 0x4000
  s_nop 0
  buffer_load_dwordx4 v3, s[12:15], s38 offen offset:0 sc1 lds
  buffer_load_dwordx4 v3, s[12:15], s38 offen offset:1024 sc1 lds
  buffer_load_dwordx4 v3, s[12:15], s38 offen offset:2048 sc1 lds
  buffer_load_dwordx4 v3, s[12:15], s38 offen offset:3072 sc1 lds
  s_add_u32 s38, s39, 0x4000
  s_cmp_eq_u32 s38, s3
  s_cselect_b32 s38, s76, s38
  s_mov_b32 m0, s77
  s_nop 0
  buffer_load_dwordx4 v3, s[8:11], s38 offen offset:0 sc1 lds
  buffer_load_dwordx4 v3, s[8:11], s38 offen offset:1024 sc1 lds
  buffer_load_dwordx4 v3, s[8:11], s38 offen offset:2048 sc1 lds
  buffer_load_dwordx4 v3, s[8:11], s38 offen offset:3072 sc1 lds
  s_branch Lk_I0
Lk_epi:
  v_mov_b32 v120, v88
  v_mov_b32 v121, v92
  s_nop 0
  v_permlane32_swap_b32 v88, v120
  v_permlane32_swap_b32 v92, v121
  v_add_f32 v88, v88, v120
  v_add_f32 v92, v92, v121
  v_mov_b32 v120, v88
  v_mov_b32 v121, v92
  s_nop 0
  v_permlane16_swap_b32 v88, v120
  v_permlane16_swap_b32 v92, v121
  v_add_f32 v88, v88, v120
  v_add_f32 v92, v92, v121
  s_cmp_eq_u32 s99, 0
  s_cbranch_scc1 Lk_final81
  v_rcp_f32 v104, v88
  v_rcp_f32 v106, v92
  v_mul_f32 v104, v104, v124
  v_mul_f32 v106, v106, v125
  v_mov_b32 v105, v104
  v_mov_b32 v107, v106
  v_pk_mul_f32 v[128:129], v[128:129], v[104:105]
  v_pk_mul_f32 v[130:131], v[130:131], v[104:105]
  v_pk_mul_f32 v[136:137], v[136:137], v[104:105]
  v_pk_mul_f32 v[138:139], v[138:139], v[104:105]
  v_cvt_pk_bf16_f32 v128, v128, v129
  v_cvt_pk_bf16_f32 v129, v130, v131
  v_cvt_pk_bf16_f32 v130, v136, v137
  v_cvt_pk_bf16_f32 v131, v138, v139
  s_waitcnt vmcnt(31)
  v_accvgpr_write_b32 a192, v128
  v_accvgpr_write_b32 a193, v129
  v_accvgpr_write_b32 a194, v130
  v_accvgpr_write_b32 a195, v131
  buffer_load_dwordx4 a[32:35], v2, s[28:31], s54 offen offset:0 sc1
  v_pk_mul_f32 v[132:133], v[132:133], v[106:107]
  v_pk_mul_f32 v[134:135], v[134:135], v[106:107]
  v_pk_mul_f32 v[140:141], v[140:141], v[106:107]
  v_pk_mul_f32 v[142:143], v[142:143], v[106:107]
  v_cvt_pk_bf16_f32 v132, v132, v133
  v_cvt_pk_bf16_f32 v133, v134, v135
  v_cvt_pk_bf16_f32 v134, v140, v141
  v_cvt_pk_bf16_f32 v135, v142, v143
  s_waitcnt vmcnt(31)
  v_accvgpr_write_b32 a196, v132
  v_accvgpr_write_b32 a197, v133
  v_accvgpr_write_b32 a198, v134
  v_accvgpr_write_b32 a199, v135
  buffer_load_dwordx4 a[36:39], v2, s[28:31], s54 offen offset:1024 sc1
  v_pk_mul_f32 v[144:145], v[144:145], v[104:105]
  v_pk_mul_f32 v[146:147], v[146:147], v[104:105]
  v_pk_mul_f32 v[152:153], v[152:153], v[104:105]
  v_pk_mul_f32 v[154:155], v[154:155], v[104:105]
  v_cvt_pk_bf16_f32 v144, v144, v145
  v_cvt_pk_bf16_f32 v145, v146, v147
  v_cvt_pk_bf16_f32 v146, v152, v153
  v_cvt_pk_bf16_f32 v147, v154, v155
  s_waitcnt vmcnt(31)
  v_accvgpr_write_b32 a200, v144
  v_accvgpr_write_b32 a201, v145
  v_accvgpr_write_b32 a202, v146
  v_accvgpr_write_b32 a203, v147
  buffer_load_dwordx4 a[40:43], v2, s[28:31], s54 offen offset:2048 sc1
  v_pk_mul_f32 v[148:149], v[148:149], v[106:107]
  v_pk_mul_f32 v[150:151], v[150:151], v[106:107]
  v_pk_mul_f32 v[156:157], v[156:157], v[106:107]
  v_pk_mul_f32 v[158:159], v[158:159], v[106:107]
  v_cvt_pk_bf16_f32 v148, v148, v149
  v_cvt_pk_bf16_f32 v149, v150, v151
  v_cvt_pk_bf16_f32 v150, v156, v157
  v_cvt_pk_bf16_f32 v151, v158, v159
  s_waitcnt vmcnt(31)
  v_accvgpr_write_b32 a204, v148
  v_accvgpr_write_b32 a205, v149
  v_accvgpr_write_b32 a206, v150
  v_accvgpr_write_b32 a207, v151
  buffer_load_dwordx4 a[44:47], v2, s[28:31], s54 offen offset:3072 sc1
  v_pk_mul_f32 v[160:161], v[160:161], v[104:105]
  v_pk_mul_f32 v[162:163], v[162:163], v[104:105]
  v_pk_mul_f32 v[168:169], v[168:169], v[104:105]
  v_pk_mul_f32 v[170:171], v[170:171], v[104:105]
  v_cvt_pk_bf16_f32 v160, v160, v161
  v_cvt_pk_bf16_f32 v161, v162, v163
  v_cvt_pk_bf16_f32 v162, v168, v169
  v_cvt_pk_bf16_f32 v163, v170, v171
  s_waitcnt vmcnt(31)
  v_accvgpr_write_b32 a208, v160
  v_accvgpr_write_b32 a209, v161
  v_accvgpr_write_b32 a210, v162
  v_accvgpr_write_b32 a211, v163
  s_add_u32 s54, s54, 0x1000
  buffer_load_dwordx4 a[48:51], v2, s[28:31], s54 offen offset:0 sc1
  v_pk_mul_f32 v[164:165], v[164:165], v[106:107]
  v_pk_mul_f32 v[166:167], v[166:167], v[106:107]
  v_pk_mul_f32 v[172:173], v[172:173], v[106:107]
  v_pk_mul_f32 v[174:175], v[174:175], v[106:107]
  v_cvt_pk_bf16_f32 v164, v164, v165
  v_cvt_pk_bf16_f32 v165, v166, v167
  v_cvt_pk_bf16_f32 v166, v172, v173
  v_cvt_pk_bf16_f32 v167, v174, v175
  s_waitcnt vmcnt(31)
  v_accvgpr_write_b32 a212, v164
  v_accvgpr_write_b32 a213, v165
  v_accvgpr_write_b32 a214, v166
  v_accvgpr_write_b32 a215, v167
  buffer_load_dwordx4 a[52:55], v2, s[28:31], s54 offen offset:1024 sc1
  v_pk_mul_f32 v[176:177], v[176:177], v[104:105]
  v_pk_mul_f32 v[178:179], v[178:179], v[104:105]
  v_pk_mul_f32 v[184:185], v[184:185], v[104:105]
  v_pk_mul_f32 v[186:187], v[186:187], v[104:105]
  v_cvt_pk_bf16_f32 v176, v176, v177
  v_cvt_pk_bf16_f32 v177, v178, v179
  v_cvt_pk_bf16_f32 v178, v184, v185
  v_cvt_pk_bf16_f32 v179, v186, v187
  s_waitcnt vmcnt(31)
  v_accvgpr_write_b32 a216, v176
  v_accvgpr_write_b32 a217, v177
  v_accvgpr_write_b32 a218, v178
  v_accvgpr_write_b32 a219, v179
  buffer_load_dwordx4 a[56:59], v2, s[28:31], s54 offen offset:2048 sc1
  v_pk_mul_f32 v[180:181], v[180:181], v[106:107]
  v_pk_mul_f32 v[182:183], v[182:183], v[106:107]
  v_pk_mul_f32 v[188:189], v[188:189], v[106:107]
  v_pk_mul_f32 v[190:191], v[190:191], v[106:107]
  v_cvt_pk_bf16_f32 v180, v180, v181
  v_cvt_pk_bf16_f32 v181, v182, v183
  v_cvt_pk_bf16_f32 v182, v188, v189
  v_cvt_pk_bf16_f32 v183, v190, v191
  s_waitcnt vmcnt(31)
  v_accvgpr_write_b32 a220, v180
  v_accvgpr_write_b32 a221, v181
  v_accvgpr_write_b32 a222, v182
  v_accvgpr_write_b32 a223, v183
  buffer_load_dwordx4 a[60:63], v2, s[28:31], s54 offen offset:3072 sc1
  v_pk_mul_f32 v[192:193], v[192:193], v[104:105]
  v_pk_mul_f32 v[194:195], v[194:195], v[104:105]
  v_pk_mul_f32 v[200:201], v[200:201], v[104:105]
  v_pk_mul_f32 v[202:203], v[202:203], v[104:105]
  v_cvt_pk_bf16_f32 v192, v192, v193
  v_cvt_pk_bf16_f32 v193, v194, v195
  v_cvt_pk_bf16_f32 v194, v200, v201
  v_cvt_pk_bf16_f32 v195, v202, v203
  v_accvgpr_write_b32 a224, v192
  v_accvgpr_write_b32 a225, v193
  v_accvgpr_write_b32 a226, v194
  v_accvgpr_write_b32 a227, v195
  v_pk_mul_f32 v[196:197], v[196:197], v[106:107]
  v_pk_mul_f32 v[198:199], v[198:199], v[106:107]
  v_pk_mul_f32 v[204:205], v[204:205], v[106:107]
  v_pk_mul_f32 v[206:207], v[206:207], v[106:107]
  v_cvt_pk_bf16_f32 v196, v196, v197
  v_cvt_pk_bf16_f32 v197, v198, v199
  v_cvt_pk_bf16_f32 v198, v204, v205
  v_cvt_pk_bf16_f32 v199, v206, v207
  v_accvgpr_write_b32 a228, v196
  v_accvgpr_write_b32 a229, v197
  v_accvgpr_write_b32 a230, v198
  v_accvgpr_write_b32 a231, v199
  v_pk_mul_f32 v[208:209], v[208:209], v[104:105]
  v_pk_mul_f32 v[210:211], v[210:211], v[104:105]
  v_pk_mul_f32 v[216:217], v[216:217], v[104:105]
  v_pk_mul_f32 v[218:219], v[218:219], v[104:105]
  v_cvt_pk_bf16_f32 v208, v208, v209
  v_cvt_pk_bf16_f32 v209, v210, v211
  v_cvt_pk_bf16_f32 v210, v216, v217
  v_cvt_pk_bf16_f32 v211, v218, v219
  v_accvgpr_write_b32 a232, v208
  v_accvgpr_write_b32 a233, v209
  v_accvgpr_write_b32 a234, v210
  v_accvgpr_write_b32 a235, v211
  v_pk_mul_f32 v[212:213], v[212:213], v[106:107]
  v_pk_mul_f32 v[214:215], v[214:215], v[106:107]
  v_pk_mul_f32 v[220:221], v[220:221], v[106:107]
  v_pk_mul_f32 v[222:223], v[222:223], v[106:107]
  v_cvt_pk_bf16_f32 v212, v212, v213
  v_cvt_pk_bf16_f32 v213, v214, v215
  v_cvt_pk_bf16_f32 v214, v220, v221
  v_cvt_pk_bf16_f32 v215, v222, v223
  v_accvgpr_write_b32 a236, v212
  v_accvgpr_write_b32 a237, v213
  v_accvgpr_write_b32 a238, v214
  v_accvgpr_write_b32 a239, v215
  v_pk_mul_f32 v[224:225], v[224:225], v[104:105]
  v_pk_mul_f32 v[226:227], v[226:227], v[104:105]
  v_pk_mul_f32 v[232:233], v[232:233], v[104:105]
  v_pk_mul_f32 v[234:235], v[234:235], v[104:105]
  v_cvt_pk_bf16_f32 v224, v224, v225
  v_cvt_pk_bf16_f32 v225, v226, v227
  v_cvt_pk_bf16_f32 v226, v232, v233
  v_cvt_pk_bf16_f32 v227, v234, v235
  v_accvgpr_write_b32 a240, v224
  v_accvgpr_write_b32 a241, v225
  v_accvgpr_write_b32 a242, v226
  v_accvgpr_write_b32 a243, v227
  v_pk_mul_f32 v[228:229], v[228:229], v[106:107]
  v_pk_mul_f32 v[230:231], v[230:231], v[106:107]
  v_pk_mul_f32 v[236:237], v[236:237], v[106:107]
  v_pk_mul_f32 v[238:239], v[238:239], v[106:107]
  v_cvt_pk_bf16_f32 v228, v228, v229
  v_cvt_pk_bf16_f32 v229, v230, v231
  v_cvt_pk_bf16_f32 v230, v236, v237
  v_cvt_pk_bf16_f32 v231, v238, v239
  v_accvgpr_write_b32 a244, v228
  v_accvgpr_write_b32 a245, v229
  v_accvgpr_write_b32 a246, v230
  v_accvgpr_write_b32 a247, v231
  v_pk_mul_f32 v[240:241], v[240:241], v[104:105]
  v_pk_mul_f32 v[242:243], v[242:243], v[104:105]
  v_pk_mul_f32 v[248:249], v[248:249], v[104:105]
  v_pk_mul_f32 v[250:251], v[250:251], v[104:105]
  v_cvt_pk_bf16_f32 v240, v240, v241
  v_cvt_pk_bf16_f32 v241, v242, v243
  v_cvt_pk_bf16_f32 v242, v248, v249
  v_cvt_pk_bf16_f32 v243, v250, v251
  v_accvgpr_write_b32 a248, v240
  v_accvgpr_write_b32 a249, v241
  v_accvgpr_write_b32 a250, v242
  v_accvgpr_write_b32 a251, v243
  v_pk_mul_f32 v[244:245], v[244:245], v[106:107]
  v_pk_mul_f32 v[246:247], v[246:247], v[106:107]
  v_pk_mul_f32 v[252:253], v[252:253], v[106:107]
  v_pk_mul_f32 v[254:255], v[254:255], v[106:107]
  v_cvt_pk_bf16_f32 v244, v244, v245
  v_cvt_pk_bf16_f32 v245, v246, v247
  v_cvt_pk_bf16_f32 v246, v252, v253
  v_cvt_pk_bf16_f32 v247, v254, v255
  v_accvgpr_write_b32 a252, v244
  v_accvgpr_write_b32 a253, v245
  v_accvgpr_write_b32 a254, v246
  v_accvgpr_write_b32 a255, v247
  s_xor_b32 s53, s53, 1
  s_mov_b32 s36, 2
  s_lshl_b32 s3, s44, 2
  s_sub_u32 s3, 64, s3
  s_sub_u32 s101, s3, s72
  s_lshl_b32 s3, s3, 14
  s_lshl_b32 s40, s50, 20
  s_add_u32 s3, s3, s40
  s_mov_b32 s99, 0
  s_sub_u32 s76, s10, 245760
  v_mov_b32 v88, 0
  v_mov_b32 v92, 0
  v_mov_b64 v[52:53], 0
  v_mov_b64 v[54:55], 0
  v_mov_b64 v[56:57], 0
  v_mov_b64 v[58:59], 0
  v_mov_b64 v[60:61], 0
  v_mov_b64 v[62:63], 0
  v_mov_b64 v[64:65], 0
  v_mov_b64 v[66:67], 0
  v_mov_b32 v112, 0
  v_mov_b32 v114, 0
  s_sub_u32 s35, 3, s19
  s_mul_i32 s35, s35, s98
  s_sub_u32 s33, s101, s35
  s_sub_u32 s33, s33, 1
  s_waitcnt vmcnt(0)
  s_cmp_eq_u32 s37, 0
  s_cbranch_scc1 Lk_P0
  s_branch Lk_P1
Lk_final81:
  s_cmp_lg_u32 s97, 1
  s_cbranch_scc1 Lk_npub82
  s_lshl_b32 s40, s50, 3
  s_add_u32 s40, s40, s16
  s_mul_i32 s42, s40, 73728
  s_add_u32 s42, s42, 0x5000000
  s_lshl_b32 s41, s19, 14
  s_add_u32 s43, s42, s41
  s_lshl_b32 s41, s19, 10
  s_add_u32 s42, s42, s41
  s_add_u32 s42, s42, 0x10000
  v_rcp_f32 v104, v88
  v_rcp_f32 v106, v92
  v_mov_b32 v113, v88
  v_mov_b32 v115, v92
  v_mov_b32 v105, v104
  v_mov_b32 v107, v106
  v_pk_mul_f32 v[128:129], v[128:129], v[104:105]
  v_pk_mul_f32 v[130:131], v[130:131], v[104:105]
  v_pk_mul_f32 v[136:137], v[136:137], v[104:105]
  v_pk_mul_f32 v[138:139], v[138:139], v[104:105]
  v_cvt_pk_bf16_f32 v128, v128, v129
  v_cvt_pk_bf16_f32 v129, v130, v131
  v_cvt_pk_bf16_f32 v130, v136, v137
  v_cvt_pk_bf16_f32 v131, v138, v139
  v_pk_mul_f32 v[132:133], v[132:133], v[106:107]
  v_pk_mul_f32 v[134:135], v[134:135], v[106:107]
  v_pk_mul_f32 v[140:141], v[140:141], v[106:107]
  v_pk_mul_f32 v[142:143], v[142:143], v[106:107]
  v_cvt_pk_bf16_f32 v132, v132, v133
  v_cvt_pk_bf16_f32 v133, v134, v135
  v_cvt_pk_bf16_f32 v134, v140, v141
  v_cvt_pk_bf16_f32 v135, v142, v143
  s_add_u32 s41, s43, 0x0
  s_add_u32 s32, s43, 0x2000
  buffer_store_dwordx4 v[128:131], v2, s[28:31], s41 offen offset:0 sc1
  v_pk_mul_f32 v[144:145], v[144:145], v[104:105]
  v_pk_mul_f32 v[146:147], v[146:147], v[104:105]
  v_pk_mul_f32 v[152:153], v[152:153], v[104:105]
  v_pk_mul_f32 v[154:155], v[154:155], v[104:105]
  v_cvt_pk_bf16_f32 v144, v144, v145
  v_cvt_pk_bf16_f32 v145, v146, v147
  v_cvt_pk_bf16_f32 v146, v152, v153
  v_cvt_pk_bf16_f32 v147, v154, v155
  buffer_store_dwordx4 v[132:135], v2, s[28:31], s32 offen offset:0 sc1
  v_pk_mul_f32 v[148:149], v[148:149], v[106:107]
  v_pk_mul_f32 v[150:151], v[150:151], v[106:107]
  v_pk_mul_f32 v[156:157], v[156:157], v[106:107]
  v_pk_mul_f32 v[158:159], v[158:159], v[106:107]
  v_cvt_pk_bf16_f32 v148, v148, v149
  v_cvt_pk_bf16_f32 v149, v150, v151
  v_cvt_pk_bf16_f32 v150, v156, v157
  v_cvt_pk_bf16_f32 v151, v158, v159
  buffer_store_dwordx4 v[144:147], v2, s[28:31], s41 offen offset:1024 sc1
  v_pk_mul_f32 v[160:161], v[160:161], v[104:105]
  v_pk_mul_f32 v[162:163], v[162:163], v[104:105]
  v_pk_mul_f32 v[168:169], v[168:169], v[104:105]
  v_pk_mul_f32 v[170:171], v[170:171], v[104:105]
  v_cvt_pk_bf16_f32 v160, v160, v161
  v_cvt_pk_bf16_f32 v161, v162, v163
  v_cvt_pk_bf16_f32 v162, v168, v169
  v_cvt_pk_bf16_f32 v163, v170, v171
  buffer_store_dwordx4 v[148:151], v2, s[28:31], s32 offen offset:1024 sc1
  v_pk_mul_f32 v[164:165], v[164:165], v[106:107]
  v_pk_mul_f32 v[166:167], v[166:167], v[106:107]
  v_pk_mul_f32 v[172:173], v[172:173], v[106:107]
  v_pk_mul_f32 v[174:175], v[174:175], v[106:107]
  v_cvt_pk_bf16_f32 v164, v164, v165
  v_cvt_pk_bf16_f32 v165, v166, v167
  v_cvt_pk_bf16_f32 v166, v172, v173
  v_cvt_pk_bf16_f32 v167, v174, v175
  buffer_store_dwordx4 v[160:163], v2, s[28:31], s41 offen offset:2048 sc1
  v_pk_mul_f32 v[176:177], v[176:177], v[104:105]
  v_pk_mul_f32 v[178:179], v[178:179], v[104:105]
  v_pk_mul_f32 v[184:185], v[184:185], v[104:105]
  v_pk_mul_f32 v[186:187], v[186:187], v[104:105]
  v_cvt_pk_bf16_f32 v176, v176, v177
  v_cvt_pk_bf16_f32 v177, v178, v179
  v_cvt_pk_bf16_f32 v178, v184, v185
  v_cvt_pk_bf16_f32 v179, v186, v187
  buffer_store_dwordx4 v[164:167], v2, s[28:31], s32 offen offset:2048 sc1
  v_pk_mul_f32 v[180:181], v[180:181], v[106:107]
  v_pk_mul_f32 v[182:183], v[182:183], v[106:107]
  v_pk_mul_f32 v[188:189], v[188:189], v[106:107]
  v_pk_mul_f32 v[190:191], v[190:191], v[106:107]
  v_cvt_pk_bf16_f32 v180, v180, v181
  v_cvt_pk_bf16_f32 v181, v182, v183
  v_cvt_pk_bf16_f32 v182, v188, v189
  v_cvt_pk_bf16_f32 v183, v190, v191
  buffer_store_dwordx4 v[176:179], v2, s[28:31], s41 offen offset:3072 sc1
  v_pk_mul_f32 v[192:193], v[192:193], v[104:105]
  v_pk_mul_f32 v[194:195], v[194:195], v[104:105]
  v_pk_mul_f32 v[200:201], v[200:201], v[104:105]
  v_pk_mul_f32 v[202:203], v[202:203], v[104:105]
  v_cvt_pk_bf16_f32 v192, v192, v193
  v_cvt_pk_bf16_f32 v193, v194, v195
  v_cvt_pk_bf16_f32 v194, v200, v201
  v_cvt_pk_bf16_f32 v195, v202, v203
  buffer_store_dwordx4 v[180:183], v2, s[28:31], s32 offen offset:3072 sc1
  v_pk_mul_f32 v[196:197], v[196:197], v[106:107]
  v_pk_mul_f32 v[198:199], v[198:199], v[106:107]
  v_pk_mul_f32 v[204:205], v[204:205], v[106:107]
  v_pk_mul_f32 v[206:207], v[206:207], v[106:107]
  v_cvt_pk_bf16_f32 v196, v196, v197
  v_cvt_pk_bf16_f32 v197, v198, v199
  v_cvt_pk_bf16_f32 v198, v204, v205
  v_cvt_pk_bf16_f32 v199, v206, v207
  s_add_u32 s41, s43, 0x1000
  s_add_u32 s32, s43, 0x3000
  buffer_store_dwordx4 v[192:195], v2, s[28:31], s41 offen offset:0 sc1
  v_pk_mul_f32 v[208:209], v[208:209], v[104:105]
  v_pk_mul_f32 v[210:211], v[210:211], v[104:105]
  v_pk_mul_f32 v[216:217], v[216:217], v[104:105]
  v_pk_mul_f32 v[218:219], v[218:219], v[104:105]
  v_cvt_pk_bf16_f32 v208, v208, v209
  v_cvt_pk_bf16_f32 v209, v210, v211
  v_cvt_pk_bf16_f32 v210, v216, v217
  v_cvt_pk_bf16_f32 v211, v218, v219
  buffer_store_dwordx4 v[196:199], v2, s[28:31], s32 offen offset:0 sc1
  v_pk_mul_f32 v[212:213], v[212:213], v[106:107]
  v_pk_mul_f32 v[214:215], v[214:215], v[106:107]
  v_pk_mul_f32 v[220:221], v[220:221], v[106:107]
  v_pk_mul_f32 v[222:223], v[222:223], v[106:107]
  v_cvt_pk_bf16_f32 v212, v212, v213
  v_cvt_pk_bf16_f32 v213, v214, v215
  v_cvt_pk_bf16_f32 v214, v220, v221
  v_cvt_pk_bf16_f32 v215, v222, v223
  buffer_store_dwordx4 v[208:211], v2, s[28:31], s41 offen offset:1024 sc1
  v_pk_mul_f32 v[224:225], v[224:225], v[104:105]
  v_pk_mul_f32 v[226:227], v[226:227], v[104:105]
  v_pk_mul_f32 v[232:233], v[232:233], v[104:105]
  v_pk_mul_f32 v[234:235], v[234:235], v[104:105]
  v_cvt_pk_bf16_f32 v224, v224, v225
  v_cvt_pk_bf16_f32 v225, v226, v227
  v_cvt_pk_bf16_f32 v226, v232, v233
  v_cvt_pk_bf16_f32 v227, v234, v235
  buffer_store_dwordx4 v[212:215], v2, s[28:31], s32 offen offset:1024 sc1
  v_pk_mul_f32 v[228:229], v[228:229], v[106:107]
  v_pk_mul_f32 v[230:231], v[230:231], v[106:107]
  v_pk_mul_f32 v[236:237], v[236:237], v[106:107]
  v_pk_mul_f32 v[238:239], v[238:239], v[106:107]
  v_cvt_pk_bf16_f32 v228, v228, v229
  v_cvt_pk_bf16_f32 v229, v230, v231
  v_cvt_pk_bf16_f32 v230, v236, v237
  v_cvt_pk_bf16_f32 v231, v238, v239
  buffer_store_dwordx4 v[224:227], v2, s[28:31], s41 offen offset:2048 sc1
  v_pk_mul_f32 v[240:241], v[240:241], v[104:105]
  v_pk_mul_f32 v[242:243], v[242:243], v[104:105]
  v_pk_mul_f32 v[248:249], v[248:249], v[104:105]
  v_pk_mul_f32 v[250:251], v[250:251], v[104:105]
  v_cvt_pk_bf16_f32 v240, v240, v241
  v_cvt_pk_bf16_f32 v241, v242, v243
  v_cvt_pk_bf16_f32 v242, v248, v249
  v_cvt_pk_bf16_f32 v243, v250, v251
  buffer_store_dwordx4 v[228:231], v2, s[28:31], s32 offen offset:2048 sc1
  v_pk_mul_f32 v[244:245], v[244:245], v[106:107]
  v_pk_mul_f32 v[246:247], v[246:247], v[106:107]
  v_pk_mul_f32 v[252:253], v[252:253], v[106:107]
  v_pk_mul_f32 v[254:255], v[254:255], v[106:107]
  v_cvt_pk_bf16_f32 v244, v244, v245
  v_cvt_pk_bf16_f32 v245, v246, v247
  v_cvt_pk_bf16_f32 v246, v252, v253
  v_cvt_pk_bf16_f32 v247, v254, v255
  buffer_store_dwordx4 v[240:243], v2, s[28:31], s41 offen offset:3072 sc1
  buffer_store_dwordx4 v[244:247], v2, s[28:31], s32 offen offset:3072 sc1
  buffer_store_dwordx4 v[112:115], v2, s[28:31], s42 offen sc1
Lk_npub82:
  v_and_b32 v120, 0x30, v1
  s_lshl_b32 s41, s19, 10
  s_add_u32 s41, s41, 0x27000
  v_add_u32 v120, s41, v120
  s_waitcnt vmcnt(16)
  ds_read_b128 v[4:7], v120 offset:0
  ds_read_b128 v[8:11], v120 offset:128
  ds_read_b128 v[12:15], v120 offset:256
  ds_read_b128 v[16:19], v120 offset:384
  ds_read_b128 v[20:23], v120 offset:512
  ds_read_b128 v[24:27], v120 offset:640
  ds_read_b128 v[28:31], v120 offset:768
  v_rcp_f32 v122, v88
  v_rcp_f32 v123, v92
  s_add_u32 s54, s54, 0x1000
  s_add_u32 s55, s55, 0x1000
  buffer_load_dwordx4 a[32:35], v2, s[28:31], s54 offen offset:0 sc1
  buffer_load_dwordx4 a[36:39], v2, s[28:31], s55 offen offset:0 sc1
  buffer_load_dwordx4 a[40:43], v2, s[28:31], s54 offen offset:1024 sc1
  buffer_load_dwordx4 a[44:47], v2, s[28:31], s55 offen offset:1024 sc1
  v_mul_f32 v122, v122, v124
  v_mul_f32 v123, v123, v125
  v_cmp_gt_u32 vcc, 48, v1
  s_waitcnt vmcnt(12)
  s_nop 0
  v_cndmask_b32 v72, 0, v72, vcc
  v_cndmask_b32 v73, 0, v73, vcc
  v_cndmask_b32 v74, 0, v74, vcc
  v_cndmask_b32 v75, 0, v75, vcc
  v_pk_add_f32 v[68:69], v[68:69], v[72:73]
  v_pk_add_f32 v[70:71], v[70:71], v[74:75]
  v_mov_b32 v72, v68
  v_mov_b32 v73, v69
  v_mov_b32 v74, v70
  v_mov_b32 v75, v71
  v_permlane32_swap_b32 v68, v72
  v_permlane32_swap_b32 v69, v73
  v_permlane32_swap_b32 v70, v74
  v_permlane32_swap_b32 v71, v75
  v_add_f32 v68, v68, v72
  v_add_f32 v69, v69, v73
  v_add_f32 v70, v70, v74
  v_add_f32 v71, v71, v75
  v_mov_b32 v72, v68
  v_mov_b32 v73, v69
  v_mov_b32 v74, v70
  v_mov_b32 v75, v71
  v_permlane16_swap_b32 v68, v72
  v_permlane16_swap_b32 v69, v73
  v_permlane16_swap_b32 v70, v74
  v_permlane16_swap_b32 v71, v75
  v_add_f32 v68, v68, v72
  v_add_f32 v69, v69, v73
  v_add_f32 v70, v70, v74
  v_add_f32 v71, v71, v75
  s_mov_b32 s40, 0xbb124925
  v_mul_f32 v96, s40, v68
  v_mul_f32 v97, s40, v68
  v_mul_f32 v98, s40, v70
  v_mul_f32 v99, s40, v70
  s_waitcnt lgkmcnt(6)
  v_pk_mul_f32 v[32:33], v[4:5], v[98:99]
  v_pk_mul_f32 v[34:35], v[6:7], v[98:99]
  v_pk_mul_f32 v[4:5], v[4:5], v[96:97]
  v_pk_mul_f32 v[6:7], v[6:7], v[96:97]
  s_waitcnt lgkmcnt(5)
  v_pk_mul_f32 v[36:37], v[8:9], v[98:99]
  v_pk_mul_f32 v[38:39], v[10:11], v[98:99]
  v_pk_mul_f32 v[8:9], v[8:9], v[96:97]
  v_pk_mul_f32 v[10:11], v[10:11], v[96:97]
  s_waitcnt lgkmcnt(4)
  v_pk_mul_f32 v[40:41], v[12:13], v[98:99]
  v_pk_mul_f32 v[42:43], v[14:15], v[98:99]
  v_pk_mul_f32 v[12:13], v[12:13], v[96:97]
  v_pk_mul_f32 v[14:15], v[14:15], v[96:97]
  s_waitcnt lgkmcnt(3)
  v_pk_mul_f32 v[44:45], v[16:17], v[98:99]
  v_pk_mul_f32 v[46:47], v[18:19], v[98:99]
  v_pk_mul_f32 v[16:17], v[16:17], v[96:97]
  v_pk_mul_f32 v[18:19], v[18:19], v[96:97]
  s_waitcnt lgkmcnt(2)
  v_pk_mul_f32 v[48:49], v[20:21], v[98:99]
  v_pk_mul_f32 v[50:51], v[22:23], v[98:99]
  v_pk_mul_f32 v[20:21], v[20:21], v[96:97]
  v_pk_mul_f32 v[22:23], v[22:23], v[96:97]
  s_waitcnt lgkmcnt(1)
  v_pk_mul_f32 v[52:53], v[24:25], v[98:99]
  v_pk_mul_f32 v[54:55], v[26:27], v[98:99]
  v_pk_mul_f32 v[24:25], v[24:25], v[96:97]
  v_pk_mul_f32 v[26:27], v[26:27], v[96:97]
  s_waitcnt lgkmcnt(0)
  v_pk_mul_f32 v[56:57], v[28:29], v[98:99]
  v_pk_mul_f32 v[58:59], v[30:31], v[98:99]
  v_pk_mul_f32 v[28:29], v[28:29], v[96:97]
  v_pk_mul_f32 v[30:31], v[30:31], v[96:97]
  s_mul_i32 s66, s44, 917504
  s_lshr_b32 s41, s17, 1
  s_lshl_b32 s41, s41, 13
  s_add_u32 s66, s66, s41
  s_lshl_b32 s41, s19, 11
  s_add_u32 s66, s66, s41
  s_add_u32 s66, s66, 0x9000000
  s_and_b32 s41, s17, 1
  s_mul_i32 s41, s41, 458752
  s_sub_u32 s67, 458752, s41
  s_add_u32 s67, s67, s66
  s_add_u32 s66, s66, s41
  s_mov_b32 s64, s67
  s_mov_b32 s69, 0x8000
  s_add_u32 s65, s44, 192
  s_lshl_b32 s65, s65, 7
  s_lshl_b32 s41, s17, 2
  s_add_u32 s65, s65, s41
  s_xor_b32 s68, s65, 4
  s_load_dwordx2 s[4:5], s[0:1], 96
  s_waitcnt lgkmcnt(0)
  s_cmp_eq_u32 s97, 1
  s_cbranch_scc1 Lk_th85
  s_cmp_eq_u32 s97, 2
  s_cbranch_scc1 Lk_th86
  s_waitcnt vmcnt(16) lgkmcnt(0)
  s_barrier
  s_waitcnt vmcnt(11)
  v_mfma_f32_16x16x32_bf16 v[4:7], a[64:67], a[0:3], v[4:7]
  ds_read_b128 a[128:131], v116 offset:16384
  v_mul_f32 v128, v128, v122
  s_waitcnt vmcnt(10)
  v_mfma_f32_16x16x32_bf16 v[32:35], a[64:67], a[4:7], v[32:35]
  s_add_u32 m0, s77, 0xc000
  ds_read_b128 a[132:135], v116 offset:17408
  v_mul_f32 v129, v129, v122
  v_mfma_f32_16x16x32_bf16 v[8:11], a[68:71], a[0:3], v[8:11]
  buffer_load_dwordx4 v3, s[12:15], s39 offen offset:0 sc1 lds
  v_mul_f32 v130, v130, v122
  v_mfma_f32_16x16x32_bf16 v[36:39], a[68:71], a[4:7], v[36:39]
  ds_read_b128 a[136:139], v116 offset:18432
  v_mul_f32 v131, v131, v122
  v_mfma_f32_16x16x32_bf16 v[12:15], a[72:75], a[0:3], v[12:15]
  ds_read_b128 a[140:143], v116 offset:19456
  v_mul_f32 v136, v136, v122
  v_mfma_f32_16x16x32_bf16 v[40:43], a[72:75], a[4:7], v[40:43]
  buffer_load_dwordx4 a[48:51], v2, s[28:31], s54 offen offset:2048 sc1
  v_mul_f32 v137, v137, v122
  v_mfma_f32_16x16x32_bf16 v[16:19], a[76:79], a[0:3], v[16:19]
  ds_read_b128 a[144:147], v116 offset:20480
  v_mul_f32 v138, v138, v122
  v_mfma_f32_16x16x32_bf16 v[44:47], a[76:79], a[4:7], v[44:47]
  ds_read_b128 a[148:151], v116 offset:21504
  v_mul_f32 v139, v139, v122
  v_mfma_f32_16x16x32_bf16 v[20:23], a[80:83], a[0:3], v[20:23]
  buffer_load_dwordx4 a[52:55], v2, s[28:31], s55 offen offset:2048 sc1
  v_cvt_pk_bf16_f32 v128, v128, v129
  v_mfma_f32_16x16x32_bf16 v[48:51], a[80:83], a[4:7], v[48:51]
  buffer_load_dwordx4 v3, s[12:15], s39 offen offset:1024 sc1 lds
  v_cvt_pk_bf16_f32 v129, v130, v131
  v_mfma_f32_16x16x32_bf16 v[24:27], a[84:87], a[0:3], v[24:27]
  ds_read_b128 a[152:155], v116 offset:22528
  v_cvt_pk_bf16_f32 v130, v136, v137
  v_mfma_f32_16x16x32_bf16 v[52:55], a[84:87], a[4:7], v[52:55]
  ds_read_b128 a[156:159], v116 offset:23552
  v_cvt_pk_bf16_f32 v131, v138, v139
  v_mfma_f32_16x16x32_bf16 v[28:31], a[88:91], a[0:3], v[28:31]
  ds_read_b128 a[160:163], v116 offset:24576
  v_mul_f32 v132, v132, v123
  v_mfma_f32_16x16x32_bf16 v[56:59], a[88:91], a[4:7], v[56:59]
  buffer_load_dwordx4 a[56:59], v2, s[28:31], s54 offen offset:3072 sc1
  v_mul_f32 v133, v133, v123
  s_waitcnt vmcnt(14)
  v_mfma_f32_16x16x32_bf16 v[4:7], a[92:95], a[8:11], v[4:7]
  ds_read_b128 a[164:167], v116 offset:25600
  v_mul_f32 v134, v134, v123
  s_waitcnt vmcnt(13)
  v_mfma_f32_16x16x32_bf16 v[32:35], a[92:95], a[12:15], v[32:35]
  ds_read_b128 a[168:171], v116 offset:26624
  v_mul_f32 v135, v135, v123
  v_mfma_f32_16x16x32_bf16 v[8:11], a[96:99], a[8:11], v[8:11]
  buffer_load_dwordx4 v3, s[12:15], s39 offen offset:2048 sc1 lds
  v_mul_f32 v140, v140, v123
  v_mfma_f32_16x16x32_bf16 v[36:39], a[96:99], a[12:15], v[36:39]
  ds_read_b128 a[172:175], v116 offset:27648
  v_mul_f32 v141, v141, v123
  v_mfma_f32_16x16x32_bf16 v[12:15], a[100:103], a[8:11], v[12:15]
  ds_read_b128 a[176:179], v116 offset:28672
  v_mul_f32 v142, v142, v123
  v_mfma_f32_16x16x32_bf16 v[40:43], a[100:103], a[12:15], v[40:43]
  buffer_load_dwordx4 a[60:63], v2, s[28:31], s55 offen offset:3072 sc1
  v_mul_f32 v143, v143, v123
  v_mfma_f32_16x16x32_bf16 v[16:19], a[104:107], a[8:11], v[16:19]
  ds_read_b128 a[180:183], v116 offset:29696
  v_cvt_pk_bf16_f32 v132, v132, v133
  v_mfma_f32_16x16x32_bf16 v[44:47], a[104:107], a[12:15], v[44:47]
  ds_read_b128 a[184:187], v116 offset:30720
  v_cvt_pk_bf16_f32 v133, v134, v135
  v_mfma_f32_16x16x32_bf16 v[20:23], a[108:111], a[8:11], v[20:23]
  v_cvt_pk_bf16_f32 v134, v140, v141
  v_mul_f32 v100, v96, v96
  v_mfma_f32_16x16x32_bf16 v[48:51], a[108:111], a[12:15], v[48:51]
  buffer_load_dwordx4 v3, s[12:15], s39 offen offset:3072 sc1 lds
  v_cvt_pk_bf16_f32 v135, v142, v143
  v_mfma_f32_16x16x32_bf16 v[24:27], a[112:115], a[8:11], v[24:27]
  s_add_u32 s39, s38, 0x4000
  ds_read_b128 a[188:191], v116 offset:31744
  v_mul_f32 v144, v144, v122
  v_mfma_f32_16x16x32_bf16 v[52:55], a[112:115], a[12:15], v[52:55]
  s_cmp_eq_u32 s39, s3
  s_cselect_b32 s39, s76, s39
  s_add_u32 m0, s77, 0x8000
  v_mfma_f32_16x16x32_bf16 v[28:31], a[116:119], a[8:11], v[28:31]
  v_mul_f32 v145, v145, v122
  v_fma_f32 v100, -v69, s40, -v100
  v_mfma_f32_16x16x32_bf16 v[56:59], a[116:119], a[12:15], v[56:59]
  v_mul_f32 v146, v146, v122
  v_max_f32 v100, 0, v100
  s_waitcnt vmcnt(15)
  v_mfma_f32_16x16x32_bf16 v[4:7], a[120:123], a[16:19], v[4:7]
  v_mul_f32 v147, v147, v122
  v_add_f32 v100, 0x3727c5ac, v100
  s_waitcnt vmcnt(14)
  v_mfma_f32_16x16x32_bf16 v[32:35], a[120:123], a[20:23], v[32:35]
  v_rsq_f32 v100, v100
  v_mfma_f32_16x16x32_bf16 v[8:11], a[124:127], a[16:19], v[8:11]
  v_mul_f32 v152, v152, v122
  v_sub_f32 v101, 1.0, v124
  v_mfma_f32_16x16x32_bf16 v[36:39], a[124:127], a[20:23], v[36:39]
  v_mul_f32 v153, v153, v122
  v_mul_f32 v72, 0xc0135761, v100
  s_waitcnt lgkmcnt(0)
  v_mfma_f32_16x16x32_bf16 v[12:15], a[128:131], a[16:19], v[12:15]
  s_add_u32 s54, s54, 0x1000
  s_add_u32 s55, s55, 0x1000
  ds_read_b128 a[64:67], v116 offset:0
  v_mfma_f32_16x16x32_bf16 v[40:43], a[128:131], a[20:23], v[40:43]
  ds_read_b128 a[68:71], v116 offset:1024
  v_mul_f32 v154, v154, v122
  v_mfma_f32_16x16x32_bf16 v[16:19], a[132:135], a[16:19], v[16:19]
  buffer_load_dwordx4 v3, s[8:11], s39 offen offset:0 sc1 lds
  v_mul_f32 v155, v155, v122
  v_mfma_f32_16x16x32_bf16 v[44:47], a[132:135], a[20:23], v[44:47]
  ds_read_b128 a[72:75], v116 offset:2048
  v_cvt_pk_bf16_f32 v144, v144, v145
  v_mfma_f32_16x16x32_bf16 v[20:23], a[136:139], a[16:19], v[20:23]
  ds_read_b128 a[76:79], v116 offset:3072
  v_cvt_pk_bf16_f32 v145, v146, v147
  v_mfma_f32_16x16x32_bf16 v[48:51], a[136:139], a[20:23], v[48:51]
  buffer_load_dwordx4 a[192:195], v2, s[28:31], s54 offen offset:0 sc1
  v_cvt_pk_bf16_f32 v146, v152, v153
  v_mfma_f32_16x16x32_bf16 v[24:27], a[140:143], a[16:19], v[24:27]
  ds_read_b128 a[80:83], v116 offset:4096
  v_cvt_pk_bf16_f32 v147, v154, v155
  v_mfma_f32_16x16x32_bf16 v[52:55], a[140:143], a[20:23], v[52:55]
  ds_read_b128 a[84:87], v116 offset:5120
  v_mul_f32 v148, v148, v123
  v_mfma_f32_16x16x32_bf16 v[28:31], a[144:147], a[16:19], v[28:31]
  buffer_load_dwordx4 a[196:199], v2, s[28:31], s55 offen offset:0 sc1
  v_mul_f32 v149, v149, v123
  v_mfma_f32_16x16x32_bf16 v[56:59], a[144:147], a[20:23], v[56:59]
  buffer_load_dwordx4 v3, s[8:11], s39 offen offset:1024 sc1 lds
  v_mul_f32 v150, v150, v123
  s_waitcnt vmcnt(17)
  v_mfma_f32_16x16x32_bf16 v[4:7], a[148:151], a[24:27], v[4:7]
  ds_read_b128 a[88:91], v116 offset:6144
  v_mul_f32 v151, v151, v123
  s_waitcnt vmcnt(16)
  v_mfma_f32_16x16x32_bf16 v[32:35], a[148:151], a[28:31], v[32:35]
  ds_read_b128 a[92:95], v116 offset:7168
  v_mul_f32 v156, v156, v123
  v_mfma_f32_16x16x32_bf16 v[8:11], a[152:155], a[24:27], v[8:11]
  ds_read_b128 a[96:99], v116 offset:8192
  v_mul_f32 v157, v157, v123
  v_mfma_f32_16x16x32_bf16 v[36:39], a[152:155], a[28:31], v[36:39]
  buffer_load_dwordx4 a[200:203], v2, s[28:31], s54 offen offset:1024 sc1
  v_mul_f32 v158, v158, v123
  v_mfma_f32_16x16x32_bf16 v[12:15], a[156:159], a[24:27], v[12:15]
  ds_read_b128 a[100:103], v116 offset:9216
  v_mul_f32 v159, v159, v123
  v_mfma_f32_16x16x32_bf16 v[40:43], a[156:159], a[28:31], v[40:43]
  ds_read_b128 a[104:107], v116 offset:10240
  v_cvt_pk_bf16_f32 v148, v148, v149
  v_mfma_f32_16x16x32_bf16 v[16:19], a[160:163], a[24:27], v[16:19]
  buffer_load_dwordx4 v3, s[8:11], s39 offen offset:2048 sc1 lds
  v_cvt_pk_bf16_f32 v149, v150, v151
  v_mfma_f32_16x16x32_bf16 v[44:47], a[160:163], a[28:31], v[44:47]
  ds_read_b128 a[108:111], v116 offset:11264
  v_cvt_pk_bf16_f32 v150, v156, v157
  v_mfma_f32_16x16x32_bf16 v[20:23], a[164:167], a[24:27], v[20:23]
  ds_read_b128 a[112:115], v116 offset:12288
  v_cvt_pk_bf16_f32 v151, v158, v159
  v_mfma_f32_16x16x32_bf16 v[48:51], a[164:167], a[28:31], v[48:51]
  buffer_load_dwordx4 a[204:207], v2, s[28:31], s55 offen offset:1024 sc1
  v_mul_f32 v160, v160, v122
  v_mfma_f32_16x16x32_bf16 v[24:27], a[168:171], a[24:27], v[24:27]
  ds_read_b128 a[116:119], v116 offset:13312
  v_mul_f32 v161, v161, v122
  v_mfma_f32_16x16x32_bf16 v[52:55], a[168:171], a[28:31], v[52:55]
  ds_read_b128 a[120:123], v116 offset:14336
  v_mul_f32 v162, v162, v122
  v_mfma_f32_16x16x32_bf16 v[28:31], a[172:175], a[24:27], v[28:31]
  buffer_load_dwordx4 a[208:211], v2, s[28:31], s54 offen offset:2048 sc1
  v_mul_f32 v163, v163, v122
  v_mfma_f32_16x16x32_bf16 v[56:59], a[172:175], a[28:31], v[56:59]
  buffer_load_dwordx4 v3, s[8:11], s39 offen offset:3072 sc1 lds
  v_mul_f32 v168, v168, v122
  s_waitcnt vmcnt(20)
  v_mfma_f32_16x16x32_bf16 v[4:7], a[176:179], a[32:35], v[4:7]
  s_xor_b32 s77, s77, 0x10000
  ds_read_b128 a[124:127], v116 offset:15360
  v_mul_f32 v169, v169, v122
  s_waitcnt vmcnt(19)
  v_mfma_f32_16x16x32_bf16 v[32:35], a[176:179], a[36:39], v[32:35]
  buffer_load_dwordx4 a[212:215], v2, s[28:31], s55 offen offset:2048 sc1
  v_mul_f32 v170, v170, v122
  v_mfma_f32_16x16x32_bf16 v[8:11], a[180:183], a[32:35], v[8:11]
  v_mul_f32 v171, v171, v122
  v_mul_f32 v101, v101, v100
  v_mfma_f32_16x16x32_bf16 v[36:39], a[180:183], a[36:39], v[36:39]
  buffer_load_dwordx4 a[216:219], v2, s[28:31], s54 offen offset:3072 sc1
  v_cvt_pk_bf16_f32 v160, v160, v161
  v_mfma_f32_16x16x32_bf16 v[12:15], a[184:187], a[32:35], v[12:15]
  v_rcp_f32 v101, v101
  v_mfma_f32_16x16x32_bf16 v[40:43], a[184:187], a[36:39], v[40:43]
  buffer_load_dwordx4 a[220:223], v2, s[28:31], s55 offen offset:3072 sc1
  v_cvt_pk_bf16_f32 v161, v162, v163
  v_mfma_f32_16x16x32_bf16 v[16:19], a[188:191], a[32:35], v[16:19]
  s_add_u32 s54, s54, 0x1000
  s_add_u32 s55, s55, 0x1000
  v_cvt_pk_bf16_f32 v162, v168, v169
  v_mfma_f32_16x16x32_bf16 v[44:47], a[188:191], a[36:39], v[44:47]
  buffer_load_dwordx4 a[224:227], v2, s[28:31], s54 offen offset:0 sc1
  v_cvt_pk_bf16_f32 v163, v170, v171
  s_waitcnt vmcnt(16) lgkmcnt(0)
  s_barrier
  v_mfma_f32_16x16x32_bf16 v[20:23], a[64:67], a[32:35], v[20:23]
  ds_read_b128 a[128:131], v116 offset:49152
  v_mul_f32 v164, v164, v123
  v_mfma_f32_16x16x32_bf16 v[48:51], a[64:67], a[36:39], v[48:51]
  s_add_u32 m0, s77, 0x4000
  ds_read_b128 a[132:135], v116 offset:50176
  v_mul_f32 v165, v165, v123
  v_mfma_f32_16x16x32_bf16 v[24:27], a[68:71], a[32:35], v[24:27]
  buffer_load_dwordx4 v3, s[12:15], s38 offen offset:0 sc1 lds
  v_mul_f32 v166, v166, v123
  v_mfma_f32_16x16x32_bf16 v[52:55], a[68:71], a[36:39], v[52:55]
  ds_read_b128 a[136:139], v116 offset:51200
  v_mul_f32 v167, v167, v123
  v_mfma_f32_16x16x32_bf16 v[28:31], a[72:75], a[32:35], v[28:31]
  ds_read_b128 a[140:143], v116 offset:52224
  v_mul_f32 v172, v172, v123
  v_mfma_f32_16x16x32_bf16 v[56:59], a[72:75], a[36:39], v[56:59]
  buffer_load_dwordx4 a[228:231], v2, s[28:31], s55 offen offset:0 sc1
  v_mul_f32 v173, v173, v123
  v_mfma_f32_16x16x32_bf16 v[4:7], a[76:79], a[40:43], v[4:7]
  ds_read_b128 a[144:147], v116 offset:53248
  v_mul_f32 v174, v174, v123
  v_mfma_f32_16x16x32_bf16 v[32:35], a[76:79], a[44:47], v[32:35]
  ds_read_b128 a[148:151], v116 offset:54272
  v_mul_f32 v175, v175, v123
  v_mfma_f32_16x16x32_bf16 v[8:11], a[80:83], a[40:43], v[8:11]
  buffer_load_dwordx4 a[232:235], v2, s[28:31], s54 offen offset:1024 sc1
  v_cvt_pk_bf16_f32 v164, v164, v165
  v_mfma_f32_16x16x32_bf16 v[36:39], a[80:83], a[44:47], v[36:39]
  buffer_load_dwordx4 v3, s[12:15], s38 offen offset:1024 sc1 lds
  v_cvt_pk_bf16_f32 v165, v166, v167
  v_mfma_f32_16x16x32_bf16 v[12:15], a[84:87], a[40:43], v[12:15]
  ds_read_b128 a[152:155], v116 offset:55296
  v_cvt_pk_bf16_f32 v166, v172, v173
  v_mfma_f32_16x16x32_bf16 v[40:43], a[84:87], a[44:47], v[40:43]
  ds_read_b128 a[156:159], v116 offset:56320
  v_cvt_pk_bf16_f32 v167, v174, v175
  v_mfma_f32_16x16x32_bf16 v[16:19], a[88:91], a[40:43], v[16:19]
  ds_read_b128 a[160:163], v116 offset:57344
  v_mul_f32 v176, v176, v122
  v_mfma_f32_16x16x32_bf16 v[44:47], a[88:91], a[44:47], v[44:47]
  buffer_load_dwordx4 a[236:239], v2, s[28:31], s55 offen offset:1024 sc1
  v_mul_f32 v177, v177, v122
  v_mfma_f32_16x16x32_bf16 v[20:23], a[92:95], a[40:43], v[20:23]
  ds_read_b128 a[164:167], v116 offset:58368
  v_mul_f32 v178, v178, v122
  v_mfma_f32_16x16x32_bf16 v[48:51], a[92:95], a[44:47], v[48:51]
  ds_read_b128 a[168:171], v116 offset:59392
  v_mul_f32 v179, v179, v122
  v_mfma_f32_16x16x32_bf16 v[24:27], a[96:99], a[40:43], v[24:27]
  buffer_load_dwordx4 v3, s[12:15], s38 offen offset:2048 sc1 lds
  v_mul_f32 v184, v184, v122
  v_mfma_f32_16x16x32_bf16 v[52:55], a[96:99], a[44:47], v[52:55]
  ds_read_b128 a[172:175], v116 offset:60416
  v_mul_f32 v185, v185, v122
  v_mfma_f32_16x16x32_bf16 v[28:31], a[100:103], a[40:43], v[28:31]
  ds_read_b128 a[176:179], v116 offset:61440
  v_mul_f32 v186, v186, v122
  v_mfma_f32_16x16x32_bf16 v[56:59], a[100:103], a[44:47], v[56:59]
  v_mul_f32 v187, v187, v122
  v_mul_f32 v76, v100, v100
  v_mfma_f32_16x16x32_bf16 v[4:7], a[104:107], a[48:51], v[4:7]
  ds_read_b128 a[180:183], v116 offset:62464
  v_cvt_pk_bf16_f32 v176, v176, v177
  v_mfma_f32_16x16x32_bf16 v[32:35], a[104:107], a[52:55], v[32:35]
  ds_read_b128 a[184:187], v116 offset:63488
  v_cvt_pk_bf16_f32 v177, v178, v179
  v_mfma_f32_16x16x32_bf16 v[8:11], a[108:111], a[48:51], v[8:11]
  v_cvt_pk_bf16_f32 v178, v184, v185
  v_min_f32 v80, 0x7149f2ca, v101
  v_mfma_f32_16x16x32_bf16 v[36:39], a[108:111], a[52:55], v[36:39]
  buffer_load_dwordx4 v3, s[12:15], s38 offen offset:3072 sc1 lds
  v_cvt_pk_bf16_f32 v179, v186, v187
  v_mfma_f32_16x16x32_bf16 v[12:15], a[112:115], a[48:51], v[12:15]
  s_add_u32 s38, s39, 0x4000
  ds_read_b128 a[188:191], v116 offset:64512
  v_mul_f32 v180, v180, v123
  v_mfma_f32_16x16x32_bf16 v[40:43], a[112:115], a[52:55], v[40:43]
  s_cmp_eq_u32 s38, s3
  s_cselect_b32 s38, s76, s38
  s_mov_b32 m0, s77
  v_mfma_f32_16x16x32_bf16 v[16:19], a[116:119], a[48:51], v[16:19]
  v_mul_f32 v181, v181, v123
  v_mul_f32 v76, v76, v100
  v_mfma_f32_16x16x32_bf16 v[44:47], a[116:119], a[52:55], v[44:47]
  v_mul_f32 v182, v182, v123
  v_mul_f32 v76, 0xbdd2d3e8, v76
  v_mfma_f32_16x16x32_bf16 v[20:23], a[120:123], a[48:51], v[20:23]
  v_mul_f32 v183, v183, v123
  v_mov_b32 v73, v72
  v_mfma_f32_16x16x32_bf16 v[48:51], a[120:123], a[52:55], v[48:51]
  v_mul_f32 v188, v188, v123
  v_mov_b32 v77, v76
  v_mfma_f32_16x16x32_bf16 v[24:27], a[124:127], a[48:51], v[24:27]
  v_mul_f32 v189, v189, v123
  v_mov_b32 v81, v80
  v_mfma_f32_16x16x32_bf16 v[52:55], a[124:127], a[52:55], v[52:55]
  v_mul_f32 v190, v190, v123
  v_mul_f32 v102, v98, v98
  s_waitcnt lgkmcnt(0)
  v_mfma_f32_16x16x32_bf16 v[28:31], a[128:131], a[48:51], v[28:31]
  ds_read_b128 a[64:67], v116 offset:32768
  v_mul_f32 v191, v191, v123
  v_mfma_f32_16x16x32_bf16 v[56:59], a[128:131], a[52:55], v[56:59]
  ds_read_b128 a[68:71], v116 offset:33792
  v_cvt_pk_bf16_f32 v180, v180, v181
  v_mfma_f32_16x16x32_bf16 v[4:7], a[132:135], a[56:59], v[4:7]
  buffer_load_dwordx4 v3, s[8:11], s38 offen offset:0 sc1 lds
  v_cvt_pk_bf16_f32 v181, v182, v183
  s_waitcnt vmcnt(22)
  v_mfma_f32_16x16x32_bf16 v[32:35], a[132:135], a[60:63], v[32:35]
  ds_read_b128 a[72:75], v116 offset:34816
  v_cvt_pk_bf16_f32 v182, v188, v189
  v_mfma_f32_16x16x32_bf16 v[8:11], a[136:139], a[56:59], v[8:11]
  ds_read_b128 a[76:79], v116 offset:35840
  v_cvt_pk_bf16_f32 v183, v190, v191
  v_mfma_f32_16x16x32_bf16 v[36:39], a[136:139], a[60:63], v[36:39]
  v_mul_f32 v192, v192, v122
  v_fma_f32 v102, -v71, s40, -v102
  v_mfma_f32_16x16x32_bf16 v[12:15], a[140:143], a[56:59], v[12:15]
  ds_read_b128 a[80:83], v116 offset:36864
  v_mul_f32 v193, v193, v122
  v_mfma_f32_16x16x32_bf16 v[40:43], a[140:143], a[60:63], v[40:43]
  ds_read_b128 a[84:87], v116 offset:37888
  v_mul_f32 v194, v194, v122
  v_mfma_f32_16x16x32_bf16 v[16:19], a[144:147], a[56:59], v[16:19]
  v_mul_f32 v195, v195, v122
  v_max_f32 v102, 0, v102
  v_mfma_f32_16x16x32_bf16 v[44:47], a[144:147], a[60:63], v[44:47]
  buffer_load_dwordx4 v3, s[8:11], s38 offen offset:1024 sc1 lds
  v_mul_f32 v200, v200, v122
  v_mfma_f32_16x16x32_bf16 v[20:23], a[148:151], a[56:59], v[20:23]
  ds_read_b128 a[88:91], v116 offset:38912
  v_mul_f32 v201, v201, v122
  v_mfma_f32_16x16x32_bf16 v[48:51], a[148:151], a[60:63], v[48:51]
  ds_read_b128 a[92:95], v116 offset:39936
  v_mul_f32 v202, v202, v122
  v_mfma_f32_16x16x32_bf16 v[24:27], a[152:155], a[56:59], v[24:27]
  ds_read_b128 a[96:99], v116 offset:40960
  v_mul_f32 v203, v203, v122
  v_mfma_f32_16x16x32_bf16 v[52:55], a[152:155], a[60:63], v[52:55]
  v_cvt_pk_bf16_f32 v192, v192, v193
  v_add_f32 v102, 0x3727c5ac, v102
  v_mfma_f32_16x16x32_bf16 v[28:31], a[156:159], a[56:59], v[28:31]
  ds_read_b128 a[100:103], v116 offset:41984
  v_cvt_pk_bf16_f32 v193, v194, v195
  v_mfma_f32_16x16x32_bf16 v[56:59], a[156:159], a[60:63], v[56:59]
  ds_read_b128 a[104:107], v116 offset:43008
  v_cvt_pk_bf16_f32 v194, v200, v201
  s_waitcnt vmcnt(20)
  v_mfma_f32_16x16x32_bf16 v[4:7], a[160:163], a[192:195], v[4:7]
  buffer_load_dwordx4 v3, s[8:11], s38 offen offset:2048 sc1 lds
  v_cvt_pk_bf16_f32 v195, v202, v203
  s_waitcnt vmcnt(20)
  v_mfma_f32_16x16x32_bf16 v[32:35], a[160:163], a[196:199], v[32:35]
  ds_read_b128 a[108:111], v116 offset:44032
  v_mul_f32 v196, v196, v123
  v_mfma_f32_16x16x32_bf16 v[8:11], a[164:167], a[192:195], v[8:11]
  ds_read_b128 a[112:115], v116 offset:45056
  v_mul_f32 v197, v197, v123
  v_mfma_f32_16x16x32_bf16 v[36:39], a[164:167], a[196:199], v[36:39]
  v_rsq_f32 v102, v102
  v_mfma_f32_16x16x32_bf16 v[12:15], a[168:171], a[192:195], v[12:15]
  ds_read_b128 a[116:119], v116 offset:46080
  v_mul_f32 v198, v198, v123
  v_mfma_f32_16x16x32_bf16 v[40:43], a[168:171], a[196:199], v[40:43]
  ds_read_b128 a[120:123], v116 offset:47104
  v_mul_f32 v199, v199, v123
  v_mfma_f32_16x16x32_bf16 v[16:19], a[172:175], a[192:195], v[16:19]
  v_mul_f32 v204, v204, v123
  v_sub_f32 v103, 1.0, v125
  v_mfma_f32_16x16x32_bf16 v[44:47], a[172:175], a[196:199], v[44:47]
  buffer_load_dwordx4 v3, s[8:11], s38 offen offset:3072 sc1 lds
  v_mul_f32 v205, v205, v123
  v_mfma_f32_16x16x32_bf16 v[20:23], a[176:179], a[192:195], v[20:23]
  ds_read_b128 a[124:127], v116 offset:48128
  v_mul_f32 v206, v206, v123
  v_mfma_f32_16x16x32_bf16 v[48:51], a[176:179], a[196:199], v[48:51]
  v_xor_b32 v116, 0x10000, v116
  v_mul_f32 v207, v207, v123
  v_mfma_f32_16x16x32_bf16 v[24:27], a[180:183], a[192:195], v[24:27]
  v_cvt_pk_bf16_f32 v196, v196, v197
  v_mul_f32 v74, 0xc0135761, v102
  v_mfma_f32_16x16x32_bf16 v[52:55], a[180:183], a[196:199], v[52:55]
  v_cvt_pk_bf16_f32 v197, v198, v199
  v_mul_f32 v103, v103, v102
  v_mfma_f32_16x16x32_bf16 v[28:31], a[184:187], a[192:195], v[28:31]
  v_rcp_f32 v103, v103
  v_mfma_f32_16x16x32_bf16 v[56:59], a[184:187], a[196:199], v[56:59]
  v_cvt_pk_bf16_f32 v198, v204, v205
  v_mul_f32 v78, v102, v102
  s_waitcnt vmcnt(19)
  v_mfma_f32_16x16x32_bf16 v[4:7], a[188:191], a[200:203], v[4:7]
  v_cvt_pk_bf16_f32 v199, v206, v207
  v_min_f32 v82, 0x7149f2ca, v103
  s_waitcnt vmcnt(17)
  v_mfma_f32_16x16x32_bf16 v[32:35], a[188:191], a[204:207], v[32:35]
  v_mul_f32 v208, v208, v122
  v_mul_f32 v78, v78, v102
  s_waitcnt vmcnt(16) lgkmcnt(0)
  s_barrier
  v_mfma_f32_16x16x32_bf16 v[8:11], a[64:67], a[200:203], v[8:11]
  ds_read_b128 a[128:131], v116 offset:16384
  v_mul_f32 v209, v209, v122
  v_mfma_f32_16x16x32_bf16 v[36:39], a[64:67], a[204:207], v[36:39]
  s_add_u32 m0, s77, 0xc000
  ds_read_b128 a[132:135], v116 offset:17408
  v_mul_f32 v210, v210, v122
  v_mfma_f32_16x16x32_bf16 v[12:15], a[68:71], a[200:203], v[12:15]
  buffer_load_dwordx4 v3, s[12:15], s39 offen offset:0 sc1 lds
  v_mul_f32 v211, v211, v122
  v_mfma_f32_16x16x32_bf16 v[40:43], a[68:71], a[204:207], v[40:43]
  ds_read_b128 a[136:139], v116 offset:18432
  v_mul_f32 v216, v216, v122
  v_mfma_f32_16x16x32_bf16 v[16:19], a[72:75], a[200:203], v[16:19]
  ds_read_b128 a[140:143], v116 offset:19456
  v_mul_f32 v217, v217, v122
  v_mfma_f32_16x16x32_bf16 v[44:47], a[72:75], a[204:207], v[44:47]
  v_mul_f32 v218, v218, v122
  v_mul_f32 v78, 0xbdd2d3e8, v78
  v_mfma_f32_16x16x32_bf16 v[20:23], a[76:79], a[200:203], v[20:23]
  ds_read_b128 a[144:147], v116 offset:20480
  v_mul_f32 v219, v219, v122
  v_mfma_f32_16x16x32_bf16 v[48:51], a[76:79], a[204:207], v[48:51]
  ds_read_b128 a[148:151], v116 offset:21504
  v_cvt_pk_bf16_f32 v208, v208, v209
  v_mfma_f32_16x16x32_bf16 v[24:27], a[80:83], a[200:203], v[24:27]
  v_cvt_pk_bf16_f32 v209, v210, v211
  v_mov_b32 v75, v74
  v_mfma_f32_16x16x32_bf16 v[52:55], a[80:83], a[204:207], v[52:55]
  buffer_load_dwordx4 v3, s[12:15], s39 offen offset:1024 sc1 lds
  v_cvt_pk_bf16_f32 v210, v216, v217
  v_mfma_f32_16x16x32_bf16 v[28:31], a[84:87], a[200:203], v[28:31]
  ds_read_b128 a[152:155], v116 offset:22528
  v_cvt_pk_bf16_f32 v211, v218, v219
  v_mfma_f32_16x16x32_bf16 v[56:59], a[84:87], a[204:207], v[56:59]
  ds_read_b128 a[156:159], v116 offset:23552
  v_mul_f32 v212, v212, v123
  v_mfma_f32_16x16x32_bf16 v[4:7], a[88:91], a[208:211], v[4:7]
  ds_read_b128 a[160:163], v116 offset:24576
  v_mul_f32 v213, v213, v123
  s_waitcnt vmcnt(16)
  v_mfma_f32_16x16x32_bf16 v[32:35], a[88:91], a[212:215], v[32:35]
  v_mul_f32 v214, v214, v123
  v_mov_b32 v79, v78
  v_mfma_f32_16x16x32_bf16 v[8:11], a[92:95], a[208:211], v[8:11]
  ds_read_b128 a[164:167], v116 offset:25600
  v_mul_f32 v215, v215, v123
  v_mfma_f32_16x16x32_bf16 v[36:39], a[92:95], a[212:215], v[36:39]
  ds_read_b128 a[168:171], v116 offset:26624
  v_mul_f32 v220, v220, v123
  v_mfma_f32_16x16x32_bf16 v[12:15], a[96:99], a[208:211], v[12:15]
  buffer_load_dwordx4 v3, s[12:15], s39 offen offset:2048 sc1 lds
  v_mul_f32 v221, v221, v123
  v_mfma_f32_16x16x32_bf16 v[40:43], a[96:99], a[212:215], v[40:43]
  ds_read_b128 a[172:175], v116 offset:27648
  v_mul_f32 v222, v222, v123
  v_mfma_f32_16x16x32_bf16 v[16:19], a[100:103], a[208:211], v[16:19]
  ds_read_b128 a[176:179], v116 offset:28672
  v_mul_f32 v223, v223, v123
  v_mfma_f32_16x16x32_bf16 v[44:47], a[100:103], a[212:215], v[44:47]
  v_cvt_pk_bf16_f32 v212, v212, v213
  v_mov_b32 v83, v82
  v_mfma_f32_16x16x32_bf16 v[20:23], a[104:107], a[208:211], v[20:23]
  ds_read_b128 a[180:183], v116 offset:29696
  v_cvt_pk_bf16_f32 v213, v214, v215
  v_mfma_f32_16x16x32_bf16 v[48:51], a[104:107], a[212:215], v[48:51]
  ds_read_b128 a[184:187], v116 offset:30720
  v_cvt_pk_bf16_f32 v214, v220, v221
  v_mfma_f32_16x16x32_bf16 v[24:27], a[108:111], a[208:211], v[24:27]
  v_cvt_pk_bf16_f32 v215, v222, v223
  v_mul_f32 v224, v224, v122
  v_mfma_f32_16x16x32_bf16 v[52:55], a[108:111], a[212:215], v[52:55]
  buffer_load_dwordx4 v3, s[12:15], s39 offen offset:3072 sc1 lds
  v_mul_f32 v225, v225, v122
  v_mfma_f32_16x16x32_bf16 v[28:31], a[112:115], a[208:211], v[28:31]
  s_add_u32 s39, s38, 0x4000
  ds_read_b128 a[188:191], v116 offset:31744
  v_mul_f32 v226, v226, v122
  v_mfma_f32_16x16x32_bf16 v[56:59], a[112:115], a[212:215], v[56:59]
  s_cmp_eq_u32 s39, s3
  s_cselect_b32 s39, s76, s39
  s_add_u32 m0, s77, 0x8000
  s_waitcnt vmcnt(17)
  v_mfma_f32_16x16x32_bf16 v[4:7], a[116:119], a[216:219], v[4:7]
  v_mul_f32 v227, v227, v122
  v_mul_f32 v232, v232, v122
  s_waitcnt vmcnt(16)
  v_mfma_f32_16x16x32_bf16 v[32:35], a[116:119], a[220:223], v[32:35]
  v_mul_f32 v233, v233, v122
  v_mul_f32 v234, v234, v122
  v_mfma_f32_16x16x32_bf16 v[8:11], a[120:123], a[216:219], v[8:11]
  v_mul_f32 v235, v235, v122
  v_cvt_pk_bf16_f32 v224, v224, v225
  v_mfma_f32_16x16x32_bf16 v[36:39], a[120:123], a[220:223], v[36:39]
  v_cvt_pk_bf16_f32 v225, v226, v227
  v_cvt_pk_bf16_f32 v226, v232, v233
  v_mfma_f32_16x16x32_bf16 v[12:15], a[124:127], a[216:219], v[12:15]
  v_cvt_pk_bf16_f32 v227, v234, v235
  v_mul_f32 v228, v228, v123
  v_mfma_f32_16x16x32_bf16 v[40:43], a[124:127], a[220:223], v[40:43]
  v_mul_f32 v229, v229, v123
  v_mul_f32 v230, v230, v123
  s_waitcnt lgkmcnt(0)
  v_mfma_f32_16x16x32_bf16 v[16:19], a[128:131], a[216:219], v[16:19]
  ds_read_b128 a[64:67], v116 offset:0
  v_mul_f32 v231, v231, v123
  v_mfma_f32_16x16x32_bf16 v[44:47], a[128:131], a[220:223], v[44:47]
  ds_read_b128 a[68:71], v116 offset:1024
  v_mul_f32 v236, v236, v123
  v_mfma_f32_16x16x32_bf16 v[20:23], a[132:135], a[216:219], v[20:23]
  buffer_load_dwordx4 v3, s[8:11], s39 offen offset:0 sc1 lds
  v_mul_f32 v237, v237, v123
  v_mfma_f32_16x16x32_bf16 v[48:51], a[132:135], a[220:223], v[48:51]
  ds_read_b128 a[72:75], v116 offset:2048
  v_mul_f32 v238, v238, v123
  v_mfma_f32_16x16x32_bf16 v[24:27], a[136:139], a[216:219], v[24:27]
  ds_read_b128 a[76:79], v116 offset:3072
  v_mul_f32 v239, v239, v123
  v_mfma_f32_16x16x32_bf16 v[52:55], a[136:139], a[220:223], v[52:55]
  v_cvt_pk_bf16_f32 v228, v228, v229
  v_cvt_pk_bf16_f32 v229, v230, v231
  v_mfma_f32_16x16x32_bf16 v[28:31], a[140:143], a[216:219], v[28:31]
  ds_read_b128 a[80:83], v116 offset:4096
  v_cvt_pk_bf16_f32 v230, v236, v237
  v_mfma_f32_16x16x32_bf16 v[56:59], a[140:143], a[220:223], v[56:59]
  ds_read_b128 a[84:87], v116 offset:5120
  v_cvt_pk_bf16_f32 v231, v238, v239
  s_waitcnt vmcnt(16)
  v_mfma_f32_16x16x32_bf16 v[4:7], a[144:147], a[224:227], v[4:7]
  v_mul_f32 v240, v240, v122
  v_mul_f32 v241, v241, v122
  s_waitcnt vmcnt(14)
  v_mfma_f32_16x16x32_bf16 v[32:35], a[144:147], a[228:231], v[32:35]
  buffer_load_dwordx4 v3, s[8:11], s39 offen offset:1024 sc1 lds
  v_mul_f32 v242, v242, v122
  v_mfma_f32_16x16x32_bf16 v[8:11], a[148:151], a[224:227], v[8:11]
  ds_read_b128 a[88:91], v116 offset:6144
  v_mul_f32 v243, v243, v122
  v_mfma_f32_16x16x32_bf16 v[36:39], a[148:151], a[228:231], v[36:39]
  ds_read_b128 a[92:95], v116 offset:7168
  v_mul_f32 v248, v248, v122
  v_mfma_f32_16x16x32_bf16 v[12:15], a[152:155], a[224:227], v[12:15]
  ds_read_b128 a[96:99], v116 offset:8192
  v_mul_f32 v249, v249, v122
  v_mfma_f32_16x16x32_bf16 v[40:43], a[152:155], a[228:231], v[40:43]
  v_mul_f32 v250, v250, v122
  v_mul_f32 v251, v251, v122
  v_mfma_f32_16x16x32_bf16 v[16:19], a[156:159], a[224:227], v[16:19]
  ds_read_b128 a[100:103], v116 offset:9216
  v_cvt_pk_bf16_f32 v240, v240, v241
  v_mfma_f32_16x16x32_bf16 v[44:47], a[156:159], a[228:231], v[44:47]
  ds_read_b128 a[104:107], v116 offset:10240
  v_cvt_pk_bf16_f32 v241, v242, v243
  v_mfma_f32_16x16x32_bf16 v[20:23], a[160:163], a[224:227], v[20:23]
  buffer_load_dwordx4 v3, s[8:11], s39 offen offset:2048 sc1 lds
  v_cvt_pk_bf16_f32 v242, v248, v249
  v_mfma_f32_16x16x32_bf16 v[48:51], a[160:163], a[228:231], v[48:51]
  ds_read_b128 a[108:111], v116 offset:11264
  v_cvt_pk_bf16_f32 v243, v250, v251
  v_mfma_f32_16x16x32_bf16 v[24:27], a[164:167], a[224:227], v[24:27]
  ds_read_b128 a[112:115], v116 offset:12288
  v_mul_f32 v244, v244, v123
  v_mfma_f32_16x16x32_bf16 v[52:55], a[164:167], a[228:231], v[52:55]
  v_mul_f32 v245, v245, v123
  v_mul_f32 v246, v246, v123
  v_mfma_f32_16x16x32_bf16 v[28:31], a[168:171], a[224:227], v[28:31]
  ds_read_b128 a[116:119], v116 offset:13312
  v_mul_f32 v247, v247, v123
  v_mfma_f32_16x16x32_bf16 v[56:59], a[168:171], a[228:231], v[56:59]
  ds_read_b128 a[120:123], v116 offset:14336
  v_mul_f32 v252, v252, v123
  s_waitcnt vmcnt(15)
  v_mfma_f32_16x16x32_bf16 v[4:7], a[172:175], a[232:235], v[4:7]
  v_mul_f32 v253, v253, v123
  v_mul_f32 v254, v254, v123
  s_waitcnt vmcnt(13)
  v_mfma_f32_16x16x32_bf16 v[32:35], a[172:175], a[236:239], v[32:35]
  buffer_load_dwordx4 v3, s[8:11], s39 offen offset:3072 sc1 lds
  v_mul_f32 v255, v255, v123
  v_mfma_f32_16x16x32_bf16 v[8:11], a[176:179], a[232:235], v[8:11]
  s_xor_b32 s77, s77, 0x10000
  ds_read_b128 a[124:127], v116 offset:15360
  v_cvt_pk_bf16_f32 v244, v244, v245
  v_mfma_f32_16x16x32_bf16 v[36:39], a[176:179], a[236:239], v[36:39]
  v_cvt_pk_bf16_f32 v245, v246, v247
  v_cvt_pk_bf16_f32 v246, v252, v253
  v_mfma_f32_16x16x32_bf16 v[12:15], a[180:183], a[232:235], v[12:15]
  v_cvt_pk_bf16_f32 v247, v254, v255
  v_mfma_f32_16x16x32_bf16 v[40:43], a[180:183], a[236:239], v[40:43]
  v_mfma_f32_16x16x32_bf16 v[16:19], a[184:187], a[232:235], v[16:19]
  v_mfma_f32_16x16x32_bf16 v[44:47], a[184:187], a[236:239], v[44:47]
  v_mfma_f32_16x16x32_bf16 v[20:23], a[188:191], a[232:235], v[20:23]
  v_mfma_f32_16x16x32_bf16 v[48:51], a[188:191], a[236:239], v[48:51]
  s_branch Lk_tj87
Lk_th85:
  s_waitcnt vmcnt(0) lgkmcnt(0)
  s_barrier
  s_lshl_b32 s41, s50, 3
  s_add_u32 s41, s41, s16
  s_add_u32 s41, s41, 48
  s_lshl_b32 s41, s41, 7
  s_cmp_lg_u32 s19, 0
  s_cbranch_scc1 Lk_sig88
  v_mov_b32 v120, 1
  s_mov_b64 exec, 1
  buffer_atomic_add v120, off, s[20:23], s41 sc1
  s_mov_b64 exec, -1
Lk_sig88:
  v_mfma_f32_16x16x32_bf16 v[4:7], a[64:67], a[0:3], v[4:7]
  ds_read_b128 a[128:131], v116 offset:16384
  v_accvgpr_read_b32 v128, a192
  v_mfma_f32_16x16x32_bf16 v[32:35], a[64:67], a[4:7], v[32:35]
  s_add_u32 m0, s77, 0xc000
  ds_read_b128 a[132:135], v116 offset:17408
  v_accvgpr_read_b32 v129, a193
  v_mfma_f32_16x16x32_bf16 v[8:11], a[68:71], a[0:3], v[8:11]
  buffer_load_dwordx4 v3, s[12:15], s39 offen offset:0 sc1 lds
  v_accvgpr_read_b32 v130, a194
  v_mfma_f32_16x16x32_bf16 v[36:39], a[68:71], a[4:7], v[36:39]
  ds_read_b128 a[136:139], v116 offset:18432
  v_accvgpr_read_b32 v131, a195
  v_mfma_f32_16x16x32_bf16 v[12:15], a[72:75], a[0:3], v[12:15]
  ds_read_b128 a[140:143], v116 offset:19456
  v_accvgpr_read_b32 v132, a196
  v_mfma_f32_16x16x32_bf16 v[40:43], a[72:75], a[4:7], v[40:43]
  buffer_load_dwordx4 a[48:51], v2, s[28:31], s54 offen offset:2048 sc1
  v_accvgpr_read_b32 v133, a197
  v_mfma_f32_16x16x32_bf16 v[16:19], a[76:79], a[0:3], v[16:19]
  ds_read_b128 a[144:147], v116 offset:20480
  v_accvgpr_read_b32 v134, a198
  v_mfma_f32_16x16x32_bf16 v[44:47], a[76:79], a[4:7], v[44:47]
  ds_read_b128 a[148:151], v116 offset:21504
  v_accvgpr_read_b32 v135, a199
  v_mfma_f32_16x16x32_bf16 v[20:23], a[80:83], a[0:3], v[20:23]
  buffer_load_dwordx4 a[52:55], v2, s[28:31], s55 offen offset:2048 sc1
  v_accvgpr_read_b32 v144, a200
  v_mfma_f32_16x16x32_bf16 v[48:51], a[80:83], a[4:7], v[48:51]
  buffer_load_dwordx4 v3, s[12:15], s39 offen offset:1024 sc1 lds
  v_accvgpr_read_b32 v145, a201
  v_mfma_f32_16x16x32_bf16 v[24:27], a[84:87], a[0:3], v[24:27]
  ds_read_b128 a[152:155], v116 offset:22528
  v_accvgpr_read_b32 v146, a202
  v_mfma_f32_16x16x32_bf16 v[52:55], a[84:87], a[4:7], v[52:55]
  ds_read_b128 a[156:159], v116 offset:23552
  v_accvgpr_read_b32 v147, a203
  v_mfma_f32_16x16x32_bf16 v[28:31], a[88:91], a[0:3], v[28:31]
  ds_read_b128 a[160:163], v116 offset:24576
  v_accvgpr_read_b32 v148, a204
  v_mfma_f32_16x16x32_bf16 v[56:59], a[88:91], a[4:7], v[56:59]
  buffer_load_dwordx4 a[56:59], v2, s[28:31], s54 offen offset:3072 sc1
  v_accvgpr_read_b32 v149, a205
  v_mfma_f32_16x16x32_bf16 v[4:7], a[92:95], a[8:11], v[4:7]
  ds_read_b128 a[164:167], v116 offset:25600
  v_accvgpr_read_b32 v150, a206
  v_mfma_f32_16x16x32_bf16 v[32:35], a[92:95], a[12:15], v[32:35]
  ds_read_b128 a[168:171], v116 offset:26624
  v_accvgpr_read_b32 v151, a207
  v_mfma_f32_16x16x32_bf16 v[8:11], a[96:99], a[8:11], v[8:11]
  buffer_load_dwordx4 v3, s[12:15], s39 offen offset:2048 sc1 lds
  v_accvgpr_read_b32 v160, a208
  v_mfma_f32_16x16x32_bf16 v[36:39], a[96:99], a[12:15], v[36:39]
  ds_read_b128 a[172:175], v116 offset:27648
  v_accvgpr_read_b32 v161, a209
  v_mfma_f32_16x16x32_bf16 v[12:15], a[100:103], a[8:11], v[12:15]
  ds_read_b128 a[176:179], v116 offset:28672
  v_accvgpr_read_b32 v162, a210
  v_mfma_f32_16x16x32_bf16 v[40:43], a[100:103], a[12:15], v[40:43]
  buffer_load_dwordx4 a[60:63], v2, s[28:31], s55 offen offset:3072 sc1
  v_accvgpr_read_b32 v163, a211
  v_mfma_f32_16x16x32_bf16 v[16:19], a[104:107], a[8:11], v[16:19]
  ds_read_b128 a[180:183], v116 offset:29696
  v_accvgpr_read_b32 v164, a212
  v_mfma_f32_16x16x32_bf16 v[44:47], a[104:107], a[12:15], v[44:47]
  ds_read_b128 a[184:187], v116 offset:30720
  v_accvgpr_read_b32 v165, a213
  v_mfma_f32_16x16x32_bf16 v[20:23], a[108:111], a[8:11], v[20:23]
  v_accvgpr_read_b32 v166, a214
  v_accvgpr_read_b32 v167, a215
  v_mfma_f32_16x16x32_bf16 v[48:51], a[108:111], a[12:15], v[48:51]
  buffer_load_dwordx4 v3, s[12:15], s39 offen offset:3072 sc1 lds
  v_accvgpr_read_b32 v176, a216
  v_mfma_f32_16x16x32_bf16 v[24:27], a[112:115], a[8:11], v[24:27]
  s_add_u32 s39, s38, 0x4000
  ds_read_b128 a[188:191], v116 offset:31744
  v_accvgpr_read_b32 v177, a217
  v_mfma_f32_16x16x32_bf16 v[52:55], a[112:115], a[12:15], v[52:55]
  s_cmp_eq_u32 s39, s3
  s_cselect_b32 s39, s76, s39
  s_add_u32 m0, s77, 0x8000
  v_mfma_f32_16x16x32_bf16 v[28:31], a[116:119], a[8:11], v[28:31]
  v_accvgpr_read_b32 v178, a218
  v_accvgpr_read_b32 v179, a219
  v_mfma_f32_16x16x32_bf16 v[56:59], a[116:119], a[12:15], v[56:59]
  v_accvgpr_read_b32 v180, a220
  v_accvgpr_read_b32 v181, a221
  v_mfma_f32_16x16x32_bf16 v[4:7], a[120:123], a[16:19], v[4:7]
  v_accvgpr_read_b32 v182, a222
  v_accvgpr_read_b32 v183, a223
  v_mfma_f32_16x16x32_bf16 v[32:35], a[120:123], a[20:23], v[32:35]
  v_accvgpr_read_b32 v192, a224
  v_accvgpr_read_b32 v193, a225
  v_mfma_f32_16x16x32_bf16 v[8:11], a[124:127], a[16:19], v[8:11]
  v_accvgpr_read_b32 v194, a226
  v_accvgpr_read_b32 v195, a227
  v_mfma_f32_16x16x32_bf16 v[36:39], a[124:127], a[20:23], v[36:39]
  v_accvgpr_read_b32 v196, a228
  v_accvgpr_read_b32 v197, a229
  s_waitcnt lgkmcnt(0)
  v_mfma_f32_16x16x32_bf16 v[12:15], a[128:131], a[16:19], v[12:15]
  ds_read_b128 a[64:67], v116 offset:0
  v_accvgpr_read_b32 v198, a230
  v_mfma_f32_16x16x32_bf16 v[40:43], a[128:131], a[20:23], v[40:43]
  ds_read_b128 a[68:71], v116 offset:1024
  v_accvgpr_read_b32 v199, a231
  v_mfma_f32_16x16x32_bf16 v[16:19], a[132:135], a[16:19], v[16:19]
  buffer_load_dwordx4 v3, s[8:11], s39 offen offset:0 sc1 lds
  v_accvgpr_read_b32 v208, a232
  v_mfma_f32_16x16x32_bf16 v[44:47], a[132:135], a[20:23], v[44:47]
  ds_read_b128 a[72:75], v116 offset:2048
  v_accvgpr_read_b32 v209, a233
  v_mfma_f32_16x16x32_bf16 v[20:23], a[136:139], a[16:19], v[20:23]
  ds_read_b128 a[76:79], v116 offset:3072
  v_accvgpr_read_b32 v210, a234
  v_mfma_f32_16x16x32_bf16 v[48:51], a[136:139], a[20:23], v[48:51]
  v_accvgpr_read_b32 v211, a235
  v_accvgpr_read_b32 v212, a236
  v_mfma_f32_16x16x32_bf16 v[24:27], a[140:143], a[16:19], v[24:27]
  ds_read_b128 a[80:83], v116 offset:4096
  v_accvgpr_read_b32 v213, a237
  v_mfma_f32_16x16x32_bf16 v[52:55], a[140:143], a[20:23], v[52:55]
  ds_read_b128 a[84:87], v116 offset:5120
  v_accvgpr_read_b32 v214, a238
  v_mfma_f32_16x16x32_bf16 v[28:31], a[144:147], a[16:19], v[28:31]
  v_accvgpr_read_b32 v215, a239
  v_accvgpr_read_b32 v224, a240
  v_mfma_f32_16x16x32_bf16 v[56:59], a[144:147], a[20:23], v[56:59]
  buffer_load_dwordx4 v3, s[8:11], s39 offen offset:1024 sc1 lds
  v_accvgpr_read_b32 v225, a241
  v_mfma_f32_16x16x32_bf16 v[4:7], a[148:151], a[24:27], v[4:7]
  ds_read_b128 a[88:91], v116 offset:6144
  v_accvgpr_read_b32 v226, a242
  v_mfma_f32_16x16x32_bf16 v[32:35], a[148:151], a[28:31], v[32:35]
  ds_read_b128 a[92:95], v116 offset:7168
  v_accvgpr_read_b32 v227, a243
  v_mfma_f32_16x16x32_bf16 v[8:11], a[152:155], a[24:27], v[8:11]
  ds_read_b128 a[96:99], v116 offset:8192
  v_accvgpr_read_b32 v228, a244
  v_mfma_f32_16x16x32_bf16 v[36:39], a[152:155], a[28:31], v[36:39]
  v_accvgpr_read_b32 v229, a245
  v_accvgpr_read_b32 v230, a246
  v_mfma_f32_16x16x32_bf16 v[12:15], a[156:159], a[24:27], v[12:15]
  ds_read_b128 a[100:103], v116 offset:9216
  v_accvgpr_read_b32 v231, a247
  v_mfma_f32_16x16x32_bf16 v[40:43], a[156:159], a[28:31], v[40:43]
  ds_read_b128 a[104:107], v116 offset:10240
  v_accvgpr_read_b32 v240, a248
  v_mfma_f32_16x16x32_bf16 v[16:19], a[160:163], a[24:27], v[16:19]
  buffer_load_dwordx4 v3, s[8:11], s39 offen offset:2048 sc1 lds
  v_accvgpr_read_b32 v241, a249
  v_mfma_f32_16x16x32_bf16 v[44:47], a[160:163], a[28:31], v[44:47]
  ds_read_b128 a[108:111], v116 offset:11264
  v_accvgpr_read_b32 v242, a250
  v_mfma_f32_16x16x32_bf16 v[20:23], a[164:167], a[24:27], v[20:23]
  ds_read_b128 a[112:115], v116 offset:12288
  v_accvgpr_read_b32 v243, a251
  v_mfma_f32_16x16x32_bf16 v[48:51], a[164:167], a[28:31], v[48:51]
  v_accvgpr_read_b32 v244, a252
  v_accvgpr_read_b32 v245, a253
  v_mfma_f32_16x16x32_bf16 v[24:27], a[168:171], a[24:27], v[24:27]
  ds_read_b128 a[116:119], v116 offset:13312
  v_accvgpr_read_b32 v246, a254
  v_mfma_f32_16x16x32_bf16 v[52:55], a[168:171], a[28:31], v[52:55]
  ds_read_b128 a[120:123], v116 offset:14336
  v_accvgpr_read_b32 v247, a255
  v_mfma_f32_16x16x32_bf16 v[28:31], a[172:175], a[24:27], v[28:31]
  v_mfma_f32_16x16x32_bf16 v[56:59], a[172:175], a[28:31], v[56:59]
  buffer_load_dwordx4 v3, s[8:11], s39 offen offset:3072 sc1 lds
  v_mfma_f32_16x16x32_bf16 v[4:7], a[176:179], a[32:35], v[4:7]
  s_xor_b32 s77, s77, 0x10000
  ds_read_b128 a[124:127], v116 offset:15360
  v_mfma_f32_16x16x32_bf16 v[32:35], a[176:179], a[36:39], v[32:35]
  v_mfma_f32_16x16x32_bf16 v[8:11], a[180:183], a[32:35], v[8:11]
  v_mfma_f32_16x16x32_bf16 v[36:39], a[180:183], a[36:39], v[36:39]
  v_mfma_f32_16x16x32_bf16 v[12:15], a[184:187], a[32:35], v[12:15]
  v_mfma_f32_16x16x32_bf16 v[40:43], a[184:187], a[36:39], v[40:43]
  v_mfma_f32_16x16x32_bf16 v[16:19], a[188:191], a[32:35], v[16:19]
  v_mfma_f32_16x16x32_bf16 v[44:47], a[188:191], a[36:39], v[44:47]
  s_waitcnt vmcnt(16) lgkmcnt(0)
  s_barrier
  v_mfma_f32_16x16x32_bf16 v[20:23], a[64:67], a[32:35], v[20:23]
  s_add_u32 s54, s54, 0x1000
  s_add_u32 s55, s55, 0x1000
  ds_read_b128 a[128:131], v116 offset:49152
  v_mfma_f32_16x16x32_bf16 v[48:51], a[64:67], a[36:39], v[48:51]
  s_add_u32 m0, s77, 0x4000
  ds_read_b128 a[132:135], v116 offset:50176
  v_mul_f32 v100, v96, v96
  v_mfma_f32_16x16x32_bf16 v[24:27], a[68:71], a[32:35], v[24:27]
  buffer_load_dwordx4 v3, s[12:15], s38 offen offset:0 sc1 lds
  v_fma_f32 v100, -v69, s40, -v100
  v_mfma_f32_16x16x32_bf16 v[52:55], a[68:71], a[36:39], v[52:55]
  ds_read_b128 a[136:139], v116 offset:51200
  v_max_f32 v100, 0, v100
  v_mfma_f32_16x16x32_bf16 v[28:31], a[72:75], a[32:35], v[28:31]
  ds_read_b128 a[140:143], v116 offset:52224
  v_add_f32 v100, 0x3727c5ac, v100
  v_mfma_f32_16x16x32_bf16 v[56:59], a[72:75], a[36:39], v[56:59]
  buffer_load_dwordx4 a[192:195], v2, s[28:31], s54 offen offset:0 sc1
  v_mfma_f32_16x16x32_bf16 v[4:7], a[76:79], a[40:43], v[4:7]
  ds_read_b128 a[144:147], v116 offset:53248
  v_mfma_f32_16x16x32_bf16 v[32:35], a[76:79], a[44:47], v[32:35]
  ds_read_b128 a[148:151], v116 offset:54272
  v_mfma_f32_16x16x32_bf16 v[8:11], a[80:83], a[40:43], v[8:11]
  buffer_load_dwordx4 a[196:199], v2, s[28:31], s55 offen offset:0 sc1
  v_mfma_f32_16x16x32_bf16 v[36:39], a[80:83], a[44:47], v[36:39]
  buffer_load_dwordx4 v3, s[12:15], s38 offen offset:1024 sc1 lds
  v_mfma_f32_16x16x32_bf16 v[12:15], a[84:87], a[40:43], v[12:15]
  ds_read_b128 a[152:155], v116 offset:55296
  v_mfma_f32_16x16x32_bf16 v[40:43], a[84:87], a[44:47], v[40:43]
  ds_read_b128 a[156:159], v116 offset:56320
  v_mfma_f32_16x16x32_bf16 v[16:19], a[88:91], a[40:43], v[16:19]
  ds_read_b128 a[160:163], v116 offset:57344
  v_mfma_f32_16x16x32_bf16 v[44:47], a[88:91], a[44:47], v[44:47]
  buffer_load_dwordx4 a[200:203], v2, s[28:31], s54 offen offset:1024 sc1
  v_mfma_f32_16x16x32_bf16 v[20:23], a[92:95], a[40:43], v[20:23]
  ds_read_b128 a[164:167], v116 offset:58368
  v_mfma_f32_16x16x32_bf16 v[48:51], a[92:95], a[44:47], v[48:51]
  ds_read_b128 a[168:171], v116 offset:59392
  v_mfma_f32_16x16x32_bf16 v[24:27], a[96:99], a[40:43], v[24:27]
  buffer_load_dwordx4 v3, s[12:15], s38 offen offset:2048 sc1 lds
  v_mfma_f32_16x16x32_bf16 v[52:55], a[96:99], a[44:47], v[52:55]
  ds_read_b128 a[172:175], v116 offset:60416
  v_mfma_f32_16x16x32_bf16 v[28:31], a[100:103], a[40:43], v[28:31]
  ds_read_b128 a[176:179], v116 offset:61440
  v_mfma_f32_16x16x32_bf16 v[56:59], a[100:103], a[44:47], v[56:59]
  buffer_load_dwordx4 a[204:207], v2, s[28:31], s55 offen offset:1024 sc1
  s_waitcnt vmcnt(17)
  v_mfma_f32_16x16x32_bf16 v[4:7], a[104:107], a[48:51], v[4:7]
  ds_read_b128 a[180:183], v116 offset:62464
  s_waitcnt vmcnt(16)
  v_mfma_f32_16x16x32_bf16 v[32:35], a[104:107], a[52:55], v[32:35]
  ds_read_b128 a[184:187], v116 offset:63488
  v_mfma_f32_16x16x32_bf16 v[8:11], a[108:111], a[48:51], v[8:11]
  buffer_load_dwordx4 a[208:211], v2, s[28:31], s54 offen offset:2048 sc1
  v_mfma_f32_16x16x32_bf16 v[36:39], a[108:111], a[52:55], v[36:39]
  buffer_load_dwordx4 v3, s[12:15], s38 offen offset:3072 sc1 lds
  v_mfma_f32_16x16x32_bf16 v[12:15], a[112:115], a[48:51], v[12:15]
  s_add_u32 s38, s39, 0x4000
  ds_read_b128 a[188:191], v116 offset:64512
  v_mfma_f32_16x16x32_bf16 v[40:43], a[112:115], a[52:55], v[40:43]
  s_cmp_eq_u32 s38, s3
  s_cselect_b32 s38, s76, s38
  buffer_load_dwordx4 a[212:215], v2, s[28:31], s55 offen offset:2048 sc1
  v_mfma_f32_16x16x32_bf16 v[16:19], a[116:119], a[48:51], v[16:19]
  v_rsq_f32 v100, v100
  v_mfma_f32_16x16x32_bf16 v[44:47], a[116:119], a[52:55], v[44:47]
  s_mov_b32 m0, s77
  buffer_load_dwordx4 a[216:219], v2, s[28:31], s54 offen offset:3072 sc1
  v_sub_f32 v101, 1.0, v124
  v_mfma_f32_16x16x32_bf16 v[20:23], a[120:123], a[48:51], v[20:23]
  v_mul_f32 v72, 0xc0135761, v100
  v_mul_f32 v101, v101, v100
  v_mfma_f32_16x16x32_bf16 v[48:51], a[120:123], a[52:55], v[48:51]
  buffer_load_dwordx4 a[220:223], v2, s[28:31], s55 offen offset:3072 sc1
  v_mfma_f32_16x16x32_bf16 v[24:27], a[124:127], a[48:51], v[24:27]
  v_rcp_f32 v101, v101
  v_mfma_f32_16x16x32_bf16 v[52:55], a[124:127], a[52:55], v[52:55]
  s_add_u32 s54, s54, 0x1000
  s_add_u32 s55, s55, 0x1000
  buffer_load_dwordx4 a[224:227], v2, s[28:31], s54 offen offset:0 sc1
  s_waitcnt lgkmcnt(0)
  v_mfma_f32_16x16x32_bf16 v[28:31], a[128:131], a[48:51], v[28:31]
  ds_read_b128 a[64:67], v116 offset:32768
  v_mul_f32 v76, v100, v100
  v_mfma_f32_16x16x32_bf16 v[56:59], a[128:131], a[52:55], v[56:59]
  ds_read_b128 a[68:71], v116 offset:33792
  v_min_f32 v80, 0x7149f2ca, v101
  s_waitcnt vmcnt(20)
  v_mfma_f32_16x16x32_bf16 v[4:7], a[132:135], a[56:59], v[4:7]
  buffer_load_dwordx4 v3, s[8:11], s38 offen offset:0 sc1 lds
  v_mul_f32 v76, v76, v100
  s_waitcnt vmcnt(19)
  v_mfma_f32_16x16x32_bf16 v[32:35], a[132:135], a[60:63], v[32:35]
  ds_read_b128 a[72:75], v116 offset:34816
  v_mul_f32 v76, 0xbdd2d3e8, v76
  v_mfma_f32_16x16x32_bf16 v[8:11], a[136:139], a[56:59], v[8:11]
  ds_read_b128 a[76:79], v116 offset:35840
  v_mov_b32 v73, v72
  v_mfma_f32_16x16x32_bf16 v[36:39], a[136:139], a[60:63], v[36:39]
  buffer_load_dwordx4 a[228:231], v2, s[28:31], s55 offen offset:0 sc1
  v_mov_b32 v77, v76
  v_mfma_f32_16x16x32_bf16 v[12:15], a[140:143], a[56:59], v[12:15]
  ds_read_b128 a[80:83], v116 offset:36864
  v_mov_b32 v81, v80
  v_mfma_f32_16x16x32_bf16 v[40:43], a[140:143], a[60:63], v[40:43]
  ds_read_b128 a[84:87], v116 offset:37888
  v_mul_f32 v102, v98, v98
  v_mfma_f32_16x16x32_bf16 v[16:19], a[144:147], a[56:59], v[16:19]
  buffer_load_dwordx4 a[232:235], v2, s[28:31], s54 offen offset:1024 sc1
  v_fma_f32 v102, -v71, s40, -v102
  v_mfma_f32_16x16x32_bf16 v[44:47], a[144:147], a[60:63], v[44:47]
  buffer_load_dwordx4 v3, s[8:11], s38 offen offset:1024 sc1 lds
  v_max_f32 v102, 0, v102
  v_mfma_f32_16x16x32_bf16 v[20:23], a[148:151], a[56:59], v[20:23]
  ds_read_b128 a[88:91], v116 offset:38912
  v_add_f32 v102, 0x3727c5ac, v102
  v_mfma_f32_16x16x32_bf16 v[48:51], a[148:151], a[60:63], v[48:51]
  ds_read_b128 a[92:95], v116 offset:39936
  v_mfma_f32_16x16x32_bf16 v[24:27], a[152:155], a[56:59], v[24:27]
  ds_read_b128 a[96:99], v116 offset:40960
  v_mfma_f32_16x16x32_bf16 v[52:55], a[152:155], a[60:63], v[52:55]
  buffer_load_dwordx4 a[236:239], v2, s[28:31], s55 offen offset:1024 sc1
  v_mfma_f32_16x16x32_bf16 v[28:31], a[156:159], a[56:59], v[28:31]
  ds_read_b128 a[100:103], v116 offset:41984
  v_mfma_f32_16x16x32_bf16 v[56:59], a[156:159], a[60:63], v[56:59]
  ds_read_b128 a[104:107], v116 offset:43008
  s_waitcnt vmcnt(16)
  v_mfma_f32_16x16x32_bf16 v[4:7], a[160:163], a[192:195], v[4:7]
  buffer_load_dwordx4 v3, s[8:11], s38 offen offset:2048 sc1 lds
  s_waitcnt vmcnt(16)
  v_mfma_f32_16x16x32_bf16 v[32:35], a[160:163], a[196:199], v[32:35]
  ds_read_b128 a[108:111], v116 offset:44032
  v_mfma_f32_16x16x32_bf16 v[8:11], a[164:167], a[192:195], v[8:11]
  ds_read_b128 a[112:115], v116 offset:45056
  v_mfma_f32_16x16x32_bf16 v[36:39], a[164:167], a[196:199], v[36:39]
  v_rsq_f32 v102, v102
  v_mfma_f32_16x16x32_bf16 v[12:15], a[168:171], a[192:195], v[12:15]
  ds_read_b128 a[116:119], v116 offset:46080
  v_sub_f32 v103, 1.0, v125
  v_mfma_f32_16x16x32_bf16 v[40:43], a[168:171], a[196:199], v[40:43]
  ds_read_b128 a[120:123], v116 offset:47104
  v_mul_f32 v74, 0xc0135761, v102
  v_mfma_f32_16x16x32_bf16 v[16:19], a[172:175], a[192:195], v[16:19]
  v_mul_f32 v103, v103, v102
  v_mfma_f32_16x16x32_bf16 v[44:47], a[172:175], a[196:199], v[44:47]
  buffer_load_dwordx4 v3, s[8:11], s38 offen offset:3072 sc1 lds
  v_mfma_f32_16x16x32_bf16 v[20:23], a[176:179], a[192:195], v[20:23]
  ds_read_b128 a[124:127], v116 offset:48128
  v_mfma_f32_16x16x32_bf16 v[48:51], a[176:179], a[196:199], v[48:51]
  v_rcp_f32 v103, v103
  v_mfma_f32_16x16x32_bf16 v[24:27], a[180:183], a[192:195], v[24:27]
  v_xor_b32 v116, 0x10000, v116
  v_mul_f32 v78, v102, v102
  v_mfma_f32_16x16x32_bf16 v[52:55], a[180:183], a[196:199], v[52:55]
  v_min_f32 v82, 0x7149f2ca, v103
  v_mul_f32 v78, v78, v102
  v_mfma_f32_16x16x32_bf16 v[28:31], a[184:187], a[192:195], v[28:31]
  v_mul_f32 v78, 0xbdd2d3e8, v78
  v_mov_b32 v75, v74
  v_mfma_f32_16x16x32_bf16 v[56:59], a[184:187], a[196:199], v[56:59]
  v_mov_b32 v79, v78
  v_mov_b32 v83, v82
  s_waitcnt vmcnt(15)
  v_mfma_f32_16x16x32_bf16 v[4:7], a[188:191], a[200:203], v[4:7]
  s_waitcnt vmcnt(13)
  v_mfma_f32_16x16x32_bf16 v[32:35], a[188:191], a[204:207], v[32:35]
  s_waitcnt vmcnt(16) lgkmcnt(0)
  s_barrier
  v_mfma_f32_16x16x32_bf16 v[8:11], a[64:67], a[200:203], v[8:11]
  ds_read_b128 a[128:131], v116 offset:16384
  v_mfma_f32_16x16x32_bf16 v[36:39], a[64:67], a[204:207], v[36:39]
  s_add_u32 m0, s77, 0xc000
  ds_read_b128 a[132:135], v116 offset:17408
  v_mfma_f32_16x16x32_bf16 v[12:15], a[68:71], a[200:203], v[12:15]
  buffer_load_dwordx4 v3, s[12:15], s39 offen offset:0 sc1 lds
  v_mfma_f32_16x16x32_bf16 v[40:43], a[68:71], a[204:207], v[40:43]
  ds_read_b128 a[136:139], v116 offset:18432
  v_mfma_f32_16x16x32_bf16 v[16:19], a[72:75], a[200:203], v[16:19]
  ds_read_b128 a[140:143], v116 offset:19456
  v_mfma_f32_16x16x32_bf16 v[44:47], a[72:75], a[204:207], v[44:47]
  v_mfma_f32_16x16x32_bf16 v[20:23], a[76:79], a[200:203], v[20:23]
  ds_read_b128 a[144:147], v116 offset:20480
  v_mfma_f32_16x16x32_bf16 v[48:51], a[76:79], a[204:207], v[48:51]
  ds_read_b128 a[148:151], v116 offset:21504
  v_mfma_f32_16x16x32_bf16 v[24:27], a[80:83], a[200:203], v[24:27]
  v_mfma_f32_16x16x32_bf16 v[52:55], a[80:83], a[204:207], v[52:55]
  buffer_load_dwordx4 v3, s[12:15], s39 offen offset:1024 sc1 lds
  v_mfma_f32_16x16x32_bf16 v[28:31], a[84:87], a[200:203], v[28:31]
  ds_read_b128 a[152:155], v116 offset:22528
  v_mfma_f32_16x16x32_bf16 v[56:59], a[84:87], a[204:207], v[56:59]
  ds_read_b128 a[156:159], v116 offset:23552
  s_waitcnt vmcnt(14)
  v_mfma_f32_16x16x32_bf16 v[4:7], a[88:91], a[208:211], v[4:7]
  ds_read_b128 a[160:163], v116 offset:24576
  s_waitcnt vmcnt(12)
  v_mfma_f32_16x16x32_bf16 v[32:35], a[88:91], a[212:215], v[32:35]
  v_mfma_f32_16x16x32_bf16 v[8:11], a[92:95], a[208:211], v[8:11]
  ds_read_b128 a[164:167], v116 offset:25600
  v_mfma_f32_16x16x32_bf16 v[36:39], a[92:95], a[212:215], v[36:39]
  ds_read_b128 a[168:171], v116 offset:26624
  v_mfma_f32_16x16x32_bf16 v[12:15], a[96:99], a[208:211], v[12:15]
  buffer_load_dwordx4 v3, s[12:15], s39 offen offset:2048 sc1 lds
  v_mfma_f32_16x16x32_bf16 v[40:43], a[96:99], a[212:215], v[40:43]
  ds_read_b128 a[172:175], v116 offset:27648
  v_mfma_f32_16x16x32_bf16 v[16:19], a[100:103], a[208:211], v[16:19]
  ds_read_b128 a[176:179], v116 offset:28672
  v_mfma_f32_16x16x32_bf16 v[44:47], a[100:103], a[212:215], v[44:47]
  v_mfma_f32_16x16x32_bf16 v[20:23], a[104:107], a[208:211], v[20:23]
  ds_read_b128 a[180:183], v116 offset:29696
  v_mfma_f32_16x16x32_bf16 v[48:51], a[104:107], a[212:215], v[48:51]
  ds_read_b128 a[184:187], v116 offset:30720
  v_mfma_f32_16x16x32_bf16 v[24:27], a[108:111], a[208:211], v[24:27]
  v_mfma_f32_16x16x32_bf16 v[52:55], a[108:111], a[212:215], v[52:55]
  buffer_load_dwordx4 v3, s[12:15], s39 offen offset:3072 sc1 lds
  v_mfma_f32_16x16x32_bf16 v[28:31], a[112:115], a[208:211], v[28:31]
  s_add_u32 s39, s38, 0x4000
  ds_read_b128 a[188:191], v116 offset:31744
  v_mfma_f32_16x16x32_bf16 v[56:59], a[112:115], a[212:215], v[56:59]
  s_cmp_eq_u32 s39, s3
  s_cselect_b32 s39, s76, s39
  s_add_u32 m0, s77, 0x8000
  s_waitcnt vmcnt(13)
  v_mfma_f32_16x16x32_bf16 v[4:7], a[116:119], a[216:219], v[4:7]
  s_waitcnt vmcnt(12)
  v_mfma_f32_16x16x32_bf16 v[32:35], a[116:119], a[220:223], v[32:35]
  v_mfma_f32_16x16x32_bf16 v[8:11], a[120:123], a[216:219], v[8:11]
  v_mfma_f32_16x16x32_bf16 v[36:39], a[120:123], a[220:223], v[36:39]
  v_mfma_f32_16x16x32_bf16 v[12:15], a[124:127], a[216:219], v[12:15]
  v_mfma_f32_16x16x32_bf16 v[40:43], a[124:127], a[220:223], v[40:43]
  s_waitcnt lgkmcnt(0)
  v_mfma_f32_16x16x32_bf16 v[16:19], a[128:131], a[216:219], v[16:19]
  ds_read_b128 a[64:67], v116 offset:0
  v_mfma_f32_16x16x32_bf16 v[44:47], a[128:131], a[220:223], v[44:47]
  ds_read_b128 a[68:71], v116 offset:1024
  v_mfma_f32_16x16x32_bf16 v[20:23], a[132:135], a[216:219], v[20:23]
  buffer_load_dwordx4 v3, s[8:11], s39 offen offset:0 sc1 lds
  v_mfma_f32_16x16x32_bf16 v[48:51], a[132:135], a[220:223], v[48:51]
  ds_read_b128 a[72:75], v116 offset:2048
  v_mfma_f32_16x16x32_bf16 v[24:27], a[136:139], a[216:219], v[24:27]
  ds_read_b128 a[76:79], v116 offset:3072
  v_mfma_f32_16x16x32_bf16 v[52:55], a[136:139], a[220:223], v[52:55]
  v_mfma_f32_16x16x32_bf16 v[28:31], a[140:143], a[216:219], v[28:31]
  ds_read_b128 a[80:83], v116 offset:4096
  v_mfma_f32_16x16x32_bf16 v[56:59], a[140:143], a[220:223], v[56:59]
  ds_read_b128 a[84:87], v116 offset:5120
  s_waitcnt vmcnt(12)
  v_mfma_f32_16x16x32_bf16 v[4:7], a[144:147], a[224:227], v[4:7]
  s_waitcnt vmcnt(10)
  v_mfma_f32_16x16x32_bf16 v[32:35], a[144:147], a[228:231], v[32:35]
  buffer_load_dwordx4 v3, s[8:11], s39 offen offset:1024 sc1 lds
  v_mfma_f32_16x16x32_bf16 v[8:11], a[148:151], a[224:227], v[8:11]
  ds_read_b128 a[88:91], v116 offset:6144
  v_mfma_f32_16x16x32_bf16 v[36:39], a[148:151], a[228:231], v[36:39]
  ds_read_b128 a[92:95], v116 offset:7168
  v_mfma_f32_16x16x32_bf16 v[12:15], a[152:155], a[224:227], v[12:15]
  ds_read_b128 a[96:99], v116 offset:8192
  v_mfma_f32_16x16x32_bf16 v[40:43], a[152:155], a[228:231], v[40:43]
  v_mfma_f32_16x16x32_bf16 v[16:19], a[156:159], a[224:227], v[16:19]
  ds_read_b128 a[100:103], v116 offset:9216
  v_mfma_f32_16x16x32_bf16 v[44:47], a[156:159], a[228:231], v[44:47]
  ds_read_b128 a[104:107], v116 offset:10240
  v_mfma_f32_16x16x32_bf16 v[20:23], a[160:163], a[224:227], v[20:23]
  buffer_load_dwordx4 v3, s[8:11], s39 offen offset:2048 sc1 lds
  v_mfma_f32_16x16x32_bf16 v[48:51], a[160:163], a[228:231], v[48:51]
  ds_read_b128 a[108:111], v116 offset:11264
  v_mfma_f32_16x16x32_bf16 v[24:27], a[164:167], a[224:227], v[24:27]
  ds_read_b128 a[112:115], v116 offset:12288
  v_mfma_f32_16x16x32_bf16 v[52:55], a[164:167], a[228:231], v[52:55]
  v_mfma_f32_16x16x32_bf16 v[28:31], a[168:171], a[224:227], v[28:31]
  ds_read_b128 a[116:119], v116 offset:13312
  v_mfma_f32_16x16x32_bf16 v[56:59], a[168:171], a[228:231], v[56:59]
  ds_read_b128 a[120:123], v116 offset:14336
  s_waitcnt vmcnt(11)
  v_mfma_f32_16x16x32_bf16 v[4:7], a[172:175], a[232:235], v[4:7]
  s_waitcnt vmcnt(9)
  v_mfma_f32_16x16x32_bf16 v[32:35], a[172:175], a[236:239], v[32:35]
  buffer_load_dwordx4 v3, s[8:11], s39 offen offset:3072 sc1 lds
  v_mfma_f32_16x16x32_bf16 v[8:11], a[176:179], a[232:235], v[8:11]
  s_xor_b32 s77, s77, 0x10000
  ds_read_b128 a[124:127], v116 offset:15360
  v_mfma_f32_16x16x32_bf16 v[36:39], a[176:179], a[236:239], v[36:39]
  v_mfma_f32_16x16x32_bf16 v[12:15], a[180:183], a[232:235], v[12:15]
  v_mfma_f32_16x16x32_bf16 v[40:43], a[180:183], a[236:239], v[40:43]
  v_mfma_f32_16x16x32_bf16 v[16:19], a[184:187], a[232:235], v[16:19]
  v_mfma_f32_16x16x32_bf16 v[44:47], a[184:187], a[236:239], v[44:47]
  v_mfma_f32_16x16x32_bf16 v[20:23], a[188:191], a[232:235], v[20:23]
  v_mfma_f32_16x16x32_bf16 v[48:51], a[188:191], a[236:239], v[48:51]
  s_branch Lk_tj87
Lk_th86:
  s_mov_b32 s32, s40
  s_lshl_b32 s40, s50, 3
  s_add_u32 s40, s40, s16
  s_mul_i32 s42, s40, 73728
  s_add_u32 s42, s42, 0x5000000
  s_lshl_b32 s41, s19, 14
  s_add_u32 s43, s42, s41
  s_lshl_b32 s41, s19, 10
  s_add_u32 s42, s42, s41
  s_add_u32 s42, s42, 0x10000
  s_add_u32 s40, s40, 48
  s_lshl_b32 s40, s40, 7
  v_mov_b32 v120, s40
  v_mov_b32 v121, 1
  s_mov_b32 s40, s32
  s_mov_b32 s32, s43
  s_waitcnt vmcnt(16) lgkmcnt(0)
  s_barrier
  s_waitcnt vmcnt(11)
  v_mfma_f32_16x16x32_bf16 v[4:7], a[64:67], a[0:3], v[4:7]
  ds_read_b128 a[128:131], v116 offset:16384
  v_mul_f32 v100, v96, v96
  s_waitcnt vmcnt(10)
  v_mfma_f32_16x16x32_bf16 v[32:35], a[64:67], a[4:7], v[32:35]
  s_add_u32 m0, s77, 0xc000
  ds_read_b128 a[132:135], v116 offset:17408
  v_fma_f32 v100, -v69, s40, -v100
  v_mfma_f32_16x16x32_bf16 v[8:11], a[68:71], a[0:3], v[8:11]
  buffer_load_dwordx4 v3, s[12:15], s39 offen offset:0 sc1 lds
  v_max_f32 v100, 0, v100
  v_mfma_f32_16x16x32_bf16 v[36:39], a[68:71], a[4:7], v[36:39]
  ds_read_b128 a[136:139], v116 offset:18432
  v_add_f32 v100, 0x3727c5ac, v100
  v_mfma_f32_16x16x32_bf16 v[12:15], a[72:75], a[0:3], v[12:15]
  ds_read_b128 a[140:143], v116 offset:19456
  v_mfma_f32_16x16x32_bf16 v[40:43], a[72:75], a[4:7], v[40:43]
  buffer_load_dwordx4 a[48:51], v2, s[28:31], s54 offen offset:2048 sc1
  v_mfma_f32_16x16x32_bf16 v[16:19], a[76:79], a[0:3], v[16:19]
  ds_read_b128 a[144:147], v116 offset:20480
  v_mfma_f32_16x16x32_bf16 v[44:47], a[76:79], a[4:7], v[44:47]
  ds_read_b128 a[148:151], v116 offset:21504
  v_mfma_f32_16x16x32_bf16 v[20:23], a[80:83], a[0:3], v[20:23]
  buffer_load_dwordx4 a[52:55], v2, s[28:31], s55 offen offset:2048 sc1
  v_mfma_f32_16x16x32_bf16 v[48:51], a[80:83], a[4:7], v[48:51]
  buffer_load_dwordx4 v3, s[12:15], s39 offen offset:1024 sc1 lds
  v_mfma_f32_16x16x32_bf16 v[24:27], a[84:87], a[0:3], v[24:27]
  ds_read_b128 a[152:155], v116 offset:22528
  v_mfma_f32_16x16x32_bf16 v[52:55], a[84:87], a[4:7], v[52:55]
  ds_read_b128 a[156:159], v116 offset:23552
  v_mfma_f32_16x16x32_bf16 v[28:31], a[88:91], a[0:3], v[28:31]
  ds_read_b128 a[160:163], v116 offset:24576
  v_mfma_f32_16x16x32_bf16 v[56:59], a[88:91], a[4:7], v[56:59]
  buffer_load_dwordx4 a[56:59], v2, s[28:31], s54 offen offset:3072 sc1
  s_waitcnt vmcnt(14)
  v_mfma_f32_16x16x32_bf16 v[4:7], a[92:95], a[8:11], v[4:7]
  ds_read_b128 a[164:167], v116 offset:25600
  s_waitcnt vmcnt(13)
  v_mfma_f32_16x16x32_bf16 v[32:35], a[92:95], a[12:15], v[32:35]
  ds_read_b128 a[168:171], v116 offset:26624
  v_mfma_f32_16x16x32_bf16 v[8:11], a[96:99], a[8:11], v[8:11]
  buffer_load_dwordx4 v3, s[12:15], s39 offen offset:2048 sc1 lds
  v_mfma_f32_16x16x32_bf16 v[36:39], a[96:99], a[12:15], v[36:39]
  ds_read_b128 a[172:175], v116 offset:27648
  v_mfma_f32_16x16x32_bf16 v[12:15], a[100:103], a[8:11], v[12:15]
  ds_read_b128 a[176:179], v116 offset:28672
  v_mfma_f32_16x16x32_bf16 v[40:43], a[100:103], a[12:15], v[40:43]
  buffer_load_dwordx4 a[60:63], v2, s[28:31], s55 offen offset:3072 sc1
  v_mfma_f32_16x16x32_bf16 v[16:19], a[104:107], a[8:11], v[16:19]
  ds_read_b128 a[180:183], v116 offset:29696
  v_mfma_f32_16x16x32_bf16 v[44:47], a[104:107], a[12:15], v[44:47]
  ds_read_b128 a[184:187], v116 offset:30720
  v_mfma_f32_16x16x32_bf16 v[20:23], a[108:111], a[8:11], v[20:23]
  v_rsq_f32 v100, v100
  v_mfma_f32_16x16x32_bf16 v[48:51], a[108:111], a[12:15], v[48:51]
  buffer_load_dwordx4 v3, s[12:15], s39 offen offset:3072 sc1 lds
  v_sub_f32 v101, 1.0, v124
  v_mfma_f32_16x16x32_bf16 v[24:27], a[112:115], a[8:11], v[24:27]
  s_add_u32 s39, s38, 0x4000
  ds_read_b128 a[188:191], v116 offset:31744
  v_mul_f32 v72, 0xc0135761, v100
  v_mfma_f32_16x16x32_bf16 v[52:55], a[112:115], a[12:15], v[52:55]
  s_cmp_eq_u32 s39, s3
  s_cselect_b32 s39, s76, s39
  s_add_u32 m0, s77, 0x8000
  v_mfma_f32_16x16x32_bf16 v[28:31], a[116:119], a[8:11], v[28:31]
  v_mul_f32 v101, v101, v100
  v_mfma_f32_16x16x32_bf16 v[56:59], a[116:119], a[12:15], v[56:59]
  v_rcp_f32 v101, v101
  s_waitcnt vmcnt(15)
  v_mfma_f32_16x16x32_bf16 v[4:7], a[120:123], a[16:19], v[4:7]
  v_mul_f32 v76, v100, v100
  v_min_f32 v80, 0x7149f2ca, v101
  s_waitcnt vmcnt(14)
  v_mfma_f32_16x16x32_bf16 v[32:35], a[120:123], a[20:23], v[32:35]
  v_mul_f32 v76, v76, v100
  v_mul_f32 v76, 0xbdd2d3e8, v76
  v_mfma_f32_16x16x32_bf16 v[8:11], a[124:127], a[16:19], v[8:11]
  v_mov_b32 v73, v72
  v_mov_b32 v77, v76
  v_mfma_f32_16x16x32_bf16 v[36:39], a[124:127], a[20:23], v[36:39]
  v_mov_b32 v81, v80
  v_mul_f32 v102, v98, v98
  s_waitcnt lgkmcnt(0)
  v_mfma_f32_16x16x32_bf16 v[12:15], a[128:131], a[16:19], v[12:15]
  s_add_u32 s54, s54, 0x1000
  s_add_u32 s55, s55, 0x1000
  ds_read_b128 a[64:67], v116 offset:0
  v_mfma_f32_16x16x32_bf16 v[40:43], a[128:131], a[20:23], v[40:43]
  ds_read_b128 a[68:71], v116 offset:1024
  v_fma_f32 v102, -v71, s40, -v102
  v_mfma_f32_16x16x32_bf16 v[16:19], a[132:135], a[16:19], v[16:19]
  buffer_load_dwordx4 v3, s[8:11], s39 offen offset:0 sc1 lds
  v_max_f32 v102, 0, v102
  v_mfma_f32_16x16x32_bf16 v[44:47], a[132:135], a[20:23], v[44:47]
  ds_read_b128 a[72:75], v116 offset:2048
  v_add_f32 v102, 0x3727c5ac, v102
  v_mfma_f32_16x16x32_bf16 v[20:23], a[136:139], a[16:19], v[20:23]
  ds_read_b128 a[76:79], v116 offset:3072
  v_mfma_f32_16x16x32_bf16 v[48:51], a[136:139], a[20:23], v[48:51]
  buffer_load_dwordx4 a[192:195], v2, s[28:31], s54 offen offset:0 sc1
  v_mfma_f32_16x16x32_bf16 v[24:27], a[140:143], a[16:19], v[24:27]
  ds_read_b128 a[80:83], v116 offset:4096
  v_mfma_f32_16x16x32_bf16 v[52:55], a[140:143], a[20:23], v[52:55]
  ds_read_b128 a[84:87], v116 offset:5120
  v_mfma_f32_16x16x32_bf16 v[28:31], a[144:147], a[16:19], v[28:31]
  buffer_load_dwordx4 a[196:199], v2, s[28:31], s55 offen offset:0 sc1
  v_mfma_f32_16x16x32_bf16 v[56:59], a[144:147], a[20:23], v[56:59]
  buffer_load_dwordx4 v3, s[8:11], s39 offen offset:1024 sc1 lds
  s_waitcnt vmcnt(17)
  v_mfma_f32_16x16x32_bf16 v[4:7], a[148:151], a[24:27], v[4:7]
  ds_read_b128 a[88:91], v116 offset:6144
  s_waitcnt vmcnt(16)
  v_mfma_f32_16x16x32_bf16 v[32:35], a[148:151], a[28:31], v[32:35]
  ds_read_b128 a[92:95], v116 offset:7168
  v_mfma_f32_16x16x32_bf16 v[8:11], a[152:155], a[24:27], v[8:11]
  ds_read_b128 a[96:99], v116 offset:8192
  v_mfma_f32_16x16x32_bf16 v[36:39], a[152:155], a[28:31], v[36:39]
  buffer_load_dwordx4 a[200:203], v2, s[28:31], s54 offen offset:1024 sc1
  v_mfma_f32_16x16x32_bf16 v[12:15], a[156:159], a[24:27], v[12:15]
  ds_read_b128 a[100:103], v116 offset:9216
  v_mfma_f32_16x16x32_bf16 v[40:43], a[156:159], a[28:31], v[40:43]
  ds_read_b128 a[104:107], v116 offset:10240
  v_mfma_f32_16x16x32_bf16 v[16:19], a[160:163], a[24:27], v[16:19]
  buffer_load_dwordx4 v3, s[8:11], s39 offen offset:2048 sc1 lds
  v_mfma_f32_16x16x32_bf16 v[44:47], a[160:163], a[28:31], v[44:47]
  ds_read_b128 a[108:111], v116 offset:11264
  v_mfma_f32_16x16x32_bf16 v[20:23], a[164:167], a[24:27], v[20:23]
  ds_read_b128 a[112:115], v116 offset:12288
  v_mfma_f32_16x16x32_bf16 v[48:51], a[164:167], a[28:31], v[48:51]
  buffer_load_dwordx4 a[204:207], v2, s[28:31], s55 offen offset:1024 sc1
  v_mfma_f32_16x16x32_bf16 v[24:27], a[168:171], a[24:27], v[24:27]
  ds_read_b128 a[116:119], v116 offset:13312
  v_mfma_f32_16x16x32_bf16 v[52:55], a[168:171], a[28:31], v[52:55]
  ds_read_b128 a[120:123], v116 offset:14336
  v_mfma_f32_16x16x32_bf16 v[28:31], a[172:175], a[24:27], v[28:31]
  buffer_load_dwordx4 a[208:211], v2, s[28:31], s54 offen offset:2048 sc1
  v_mfma_f32_16x16x32_bf16 v[56:59], a[172:175], a[28:31], v[56:59]
  buffer_load_dwordx4 v3, s[8:11], s39 offen offset:3072 sc1 lds
  s_waitcnt vmcnt(20)
  v_mfma_f32_16x16x32_bf16 v[4:7], a[176:179], a[32:35], v[4:7]
  s_xor_b32 s77, s77, 0x10000
  ds_read_b128 a[124:127], v116 offset:15360
  s_waitcnt vmcnt(19)
  v_mfma_f32_16x16x32_bf16 v[32:35], a[176:179], a[36:39], v[32:35]
  buffer_load_dwordx4 a[212:215], v2, s[28:31], s55 offen offset:2048 sc1
  v_mfma_f32_16x16x32_bf16 v[8:11], a[180:183], a[32:35], v[8:11]
  v_rsq_f32 v102, v102
  v_mfma_f32_16x16x32_bf16 v[36:39], a[180:183], a[36:39], v[36:39]
  buffer_load_dwordx4 a[216:219], v2, s[28:31], s54 offen offset:3072 sc1
  v_sub_f32 v103, 1.0, v125
  v_mfma_f32_16x16x32_bf16 v[12:15], a[184:187], a[32:35], v[12:15]
  v_mul_f32 v74, 0xc0135761, v102
  v_mul_f32 v103, v103, v102
  v_mfma_f32_16x16x32_bf16 v[40:43], a[184:187], a[36:39], v[40:43]
  buffer_load_dwordx4 a[220:223], v2, s[28:31], s55 offen offset:3072 sc1
  v_mfma_f32_16x16x32_bf16 v[16:19], a[188:191], a[32:35], v[16:19]
  v_rcp_f32 v103, v103
  v_mfma_f32_16x16x32_bf16 v[44:47], a[188:191], a[36:39], v[44:47]
  s_add_u32 s54, s54, 0x1000
  s_add_u32 s55, s55, 0x1000
  buffer_load_dwordx4 a[224:227], v2, s[28:31], s54 offen offset:0 sc1
  s_waitcnt vmcnt(16) lgkmcnt(0)
  s_barrier
  v_mfma_f32_16x16x32_bf16 v[20:23], a[64:67], a[32:35], v[20:23]
  ds_read_b128 a[128:131], v116 offset:49152
  v_mul_f32 v78, v102, v102
  v_mfma_f32_16x16x32_bf16 v[48:51], a[64:67], a[36:39], v[48:51]
  s_add_u32 m0, s77, 0x4000
  ds_read_b128 a[132:135], v116 offset:50176
  v_min_f32 v82, 0x7149f2ca, v103
  v_mfma_f32_16x16x32_bf16 v[24:27], a[68:71], a[32:35], v[24:27]
  buffer_load_dwordx4 v3, s[12:15], s38 offen offset:0 sc1 lds
  v_mul_f32 v78, v78, v102
  v_mfma_f32_16x16x32_bf16 v[52:55], a[68:71], a[36:39], v[52:55]
  ds_read_b128 a[136:139], v116 offset:51200
  v_mul_f32 v78, 0xbdd2d3e8, v78
  v_mfma_f32_16x16x32_bf16 v[28:31], a[72:75], a[32:35], v[28:31]
  ds_read_b128 a[140:143], v116 offset:52224
  v_mov_b32 v75, v74
  v_mfma_f32_16x16x32_bf16 v[56:59], a[72:75], a[36:39], v[56:59]
  buffer_load_dwordx4 a[228:231], v2, s[28:31], s55 offen offset:0 sc1
  v_mov_b32 v79, v78
  v_mfma_f32_16x16x32_bf16 v[4:7], a[76:79], a[40:43], v[4:7]
  ds_read_b128 a[144:147], v116 offset:53248
  v_mov_b32 v83, v82
  v_mfma_f32_16x16x32_bf16 v[32:35], a[76:79], a[44:47], v[32:35]
  ds_read_b128 a[148:151], v116 offset:54272
  v_mfma_f32_16x16x32_bf16 v[8:11], a[80:83], a[40:43], v[8:11]
  buffer_load_dwordx4 a[232:235], v2, s[28:31], s54 offen offset:1024 sc1
  v_mfma_f32_16x16x32_bf16 v[36:39], a[80:83], a[44:47], v[36:39]
  buffer_load_dwordx4 v3, s[12:15], s38 offen offset:1024 sc1 lds
  v_mfma_f32_16x16x32_bf16 v[12:15], a[84:87], a[40:43], v[12:15]
  ds_read_b128 a[152:155], v116 offset:55296
  v_mfma_f32_16x16x32_bf16 v[40:43], a[84:87], a[44:47], v[40:43]
  ds_read_b128 a[156:159], v116 offset:56320
  v_mfma_f32_16x16x32_bf16 v[16:19], a[88:91], a[40:43], v[16:19]
  ds_read_b128 a[160:163], v116 offset:57344
  v_mfma_f32_16x16x32_bf16 v[44:47], a[88:91], a[44:47], v[44:47]
  buffer_load_dwordx4 a[236:239], v2, s[28:31], s55 offen offset:1024 sc1
  v_mfma_f32_16x16x32_bf16 v[20:23], a[92:95], a[40:43], v[20:23]
  ds_read_b128 a[164:167], v116 offset:58368
  v_mfma_f32_16x16x32_bf16 v[48:51], a[92:95], a[44:47], v[48:51]
  ds_read_b128 a[168:171], v116 offset:59392
  v_mfma_f32_16x16x32_bf16 v[24:27], a[96:99], a[40:43], v[24:27]
  buffer_load_dwordx4 v3, s[12:15], s38 offen offset:2048 sc1 lds
  v_mfma_f32_16x16x32_bf16 v[52:55], a[96:99], a[44:47], v[52:55]
  ds_read_b128 a[172:175], v116 offset:60416
  v_mfma_f32_16x16x32_bf16 v[28:31], a[100:103], a[40:43], v[28:31]
  ds_read_b128 a[176:179], v116 offset:61440
  v_mfma_f32_16x16x32_bf16 v[56:59], a[100:103], a[44:47], v[56:59]
  v_mfma_f32_16x16x32_bf16 v[4:7], a[104:107], a[48:51], v[4:7]
  ds_read_b128 a[180:183], v116 offset:62464
  v_mfma_f32_16x16x32_bf16 v[32:35], a[104:107], a[52:55], v[32:35]
  ds_read_b128 a[184:187], v116 offset:63488
  v_mfma_f32_16x16x32_bf16 v[8:11], a[108:111], a[48:51], v[8:11]
  v_mfma_f32_16x16x32_bf16 v[36:39], a[108:111], a[52:55], v[36:39]
  buffer_load_dwordx4 v3, s[12:15], s38 offen offset:3072 sc1 lds
  v_mfma_f32_16x16x32_bf16 v[12:15], a[112:115], a[48:51], v[12:15]
  s_add_u32 s38, s39, 0x4000
  ds_read_b128 a[188:191], v116 offset:64512
  v_mfma_f32_16x16x32_bf16 v[40:43], a[112:115], a[52:55], v[40:43]
  s_cmp_eq_u32 s38, s3
  s_cselect_b32 s38, s76, s38
  s_mov_b32 m0, s77
  v_mfma_f32_16x16x32_bf16 v[16:19], a[116:119], a[48:51], v[16:19]
  v_mfma_f32_16x16x32_bf16 v[44:47], a[116:119], a[52:55], v[44:47]
  v_mfma_f32_16x16x32_bf16 v[20:23], a[120:123], a[48:51], v[20:23]
  v_mfma_f32_16x16x32_bf16 v[48:51], a[120:123], a[52:55], v[48:51]
  v_mfma_f32_16x16x32_bf16 v[24:27], a[124:127], a[48:51], v[24:27]
  v_mfma_f32_16x16x32_bf16 v[52:55], a[124:127], a[52:55], v[52:55]
  s_waitcnt lgkmcnt(0)
  v_mfma_f32_16x16x32_bf16 v[28:31], a[128:131], a[48:51], v[28:31]
  ds_read_b128 a[64:67], v116 offset:32768
  v_mfma_f32_16x16x32_bf16 v[56:59], a[128:131], a[52:55], v[56:59]
  ds_read_b128 a[68:71], v116 offset:33792
  v_mfma_f32_16x16x32_bf16 v[4:7], a[132:135], a[56:59], v[4:7]
  buffer_load_dwordx4 v3, s[8:11], s38 offen offset:0 sc1 lds
  s_waitcnt vmcnt(22)
  v_mfma_f32_16x16x32_bf16 v[32:35], a[132:135], a[60:63], v[32:35]
  ds_read_b128 a[72:75], v116 offset:34816
  v_mfma_f32_16x16x32_bf16 v[8:11], a[136:139], a[56:59], v[8:11]
  ds_read_b128 a[76:79], v116 offset:35840
  v_mfma_f32_16x16x32_bf16 v[36:39], a[136:139], a[60:63], v[36:39]
  v_mfma_f32_16x16x32_bf16 v[12:15], a[140:143], a[56:59], v[12:15]
  ds_read_b128 a[80:83], v116 offset:36864
  v_mfma_f32_16x16x32_bf16 v[40:43], a[140:143], a[60:63], v[40:43]
  ds_read_b128 a[84:87], v116 offset:37888
  v_mfma_f32_16x16x32_bf16 v[16:19], a[144:147], a[56:59], v[16:19]
  v_mfma_f32_16x16x32_bf16 v[44:47], a[144:147], a[60:63], v[44:47]
  buffer_load_dwordx4 v3, s[8:11], s38 offen offset:1024 sc1 lds
  v_mfma_f32_16x16x32_bf16 v[20:23], a[148:151], a[56:59], v[20:23]
  ds_read_b128 a[88:91], v116 offset:38912
  v_mfma_f32_16x16x32_bf16 v[48:51], a[148:151], a[60:63], v[48:51]
  ds_read_b128 a[92:95], v116 offset:39936
  v_mfma_f32_16x16x32_bf16 v[24:27], a[152:155], a[56:59], v[24:27]
  ds_read_b128 a[96:99], v116 offset:40960
  v_mfma_f32_16x16x32_bf16 v[52:55], a[152:155], a[60:63], v[52:55]
  v_mfma_f32_16x16x32_bf16 v[28:31], a[156:159], a[56:59], v[28:31]
  ds_read_b128 a[100:103], v116 offset:41984
  v_mfma_f32_16x16x32_bf16 v[56:59], a[156:159], a[60:63], v[56:59]
  ds_read_b128 a[104:107], v116 offset:43008
  s_waitcnt vmcnt(20)
  v_mfma_f32_16x16x32_bf16 v[4:7], a[160:163], a[192:195], v[4:7]
  buffer_load_dwordx4 v3, s[8:11], s38 offen offset:2048 sc1 lds
  s_waitcnt vmcnt(20)
  v_mfma_f32_16x16x32_bf16 v[32:35], a[160:163], a[196:199], v[32:35]
  ds_read_b128 a[108:111], v116 offset:44032
  v_mfma_f32_16x16x32_bf16 v[8:11], a[164:167], a[192:195], v[8:11]
  ds_read_b128 a[112:115], v116 offset:45056
  v_mfma_f32_16x16x32_bf16 v[36:39], a[164:167], a[196:199], v[36:39]
  v_mfma_f32_16x16x32_bf16 v[12:15], a[168:171], a[192:195], v[12:15]
  ds_read_b128 a[116:119], v116 offset:46080
  v_mfma_f32_16x16x32_bf16 v[40:43], a[168:171], a[196:199], v[40:43]
  ds_read_b128 a[120:123], v116 offset:47104
  v_mfma_f32_16x16x32_bf16 v[16:19], a[172:175], a[192:195], v[16:19]
  v_mfma_f32_16x16x32_bf16 v[44:47], a[172:175], a[196:199], v[44:47]
  buffer_load_dwordx4 v3, s[8:11], s38 offen offset:3072 sc1 lds
  v_mfma_f32_16x16x32_bf16 v[20:23], a[176:179], a[192:195], v[20:23]
  ds_read_b128 a[124:127], v116 offset:48128
  v_mfma_f32_16x16x32_bf16 v[48:51], a[176:179], a[196:199], v[48:51]
  v_xor_b32 v116, 0x10000, v116
  v_mfma_f32_16x16x32_bf16 v[24:27], a[180:183], a[192:195], v[24:27]
  v_mfma_f32_16x16x32_bf16 v[52:55], a[180:183], a[196:199], v[52:55]
  v_mfma_f32_16x16x32_bf16 v[28:31], a[184:187], a[192:195], v[28:31]
  v_mfma_f32_16x16x32_bf16 v[56:59], a[184:187], a[196:199], v[56:59]
  s_waitcnt vmcnt(19)
  v_mfma_f32_16x16x32_bf16 v[4:7], a[188:191], a[200:203], v[4:7]
  s_waitcnt vmcnt(17)
  v_mfma_f32_16x16x32_bf16 v[32:35], a[188:191], a[204:207], v[32:35]
  s_waitcnt vmcnt(16) lgkmcnt(0)
  s_barrier
  v_mfma_f32_16x16x32_bf16 v[8:11], a[64:67], a[200:203], v[8:11]
  ds_read_b128 a[128:131], v116 offset:16384
  v_mfma_f32_16x16x32_bf16 v[36:39], a[64:67], a[204:207], v[36:39]
  s_add_u32 m0, s77, 0xc000
  ds_read_b128 a[132:135], v116 offset:17408
  v_mfma_f32_16x16x32_bf16 v[12:15], a[68:71], a[200:203], v[12:15]
  buffer_load_dwordx4 v3, s[12:15], s39 offen offset:0 sc1 lds
  v_mfma_f32_16x16x32_bf16 v[40:43], a[68:71], a[204:207], v[40:43]
  ds_read_b128 a[136:139], v116 offset:18432
  v_mfma_f32_16x16x32_bf16 v[16:19], a[72:75], a[200:203], v[16:19]
  ds_read_b128 a[140:143], v116 offset:19456
  v_mfma_f32_16x16x32_bf16 v[44:47], a[72:75], a[204:207], v[44:47]
  v_mfma_f32_16x16x32_bf16 v[20:23], a[76:79], a[200:203], v[20:23]
  ds_read_b128 a[144:147], v116 offset:20480
  v_mfma_f32_16x16x32_bf16 v[48:51], a[76:79], a[204:207], v[48:51]
  ds_read_b128 a[148:151], v116 offset:21504
  v_mfma_f32_16x16x32_bf16 v[24:27], a[80:83], a[200:203], v[24:27]
  v_mfma_f32_16x16x32_bf16 v[52:55], a[80:83], a[204:207], v[52:55]
  buffer_load_dwordx4 v3, s[12:15], s39 offen offset:1024 sc1 lds
  v_mfma_f32_16x16x32_bf16 v[28:31], a[84:87], a[200:203], v[28:31]
  ds_read_b128 a[152:155], v116 offset:22528
  v_mfma_f32_16x16x32_bf16 v[56:59], a[84:87], a[204:207], v[56:59]
  ds_read_b128 a[156:159], v116 offset:23552
  v_mfma_f32_16x16x32_bf16 v[4:7], a[88:91], a[208:211], v[4:7]
  ds_read_b128 a[160:163], v116 offset:24576
  s_waitcnt vmcnt(16)
  v_mfma_f32_16x16x32_bf16 v[32:35], a[88:91], a[212:215], v[32:35]
  v_mfma_f32_16x16x32_bf16 v[8:11], a[92:95], a[208:211], v[8:11]
  ds_read_b128 a[164:167], v116 offset:25600
  v_mfma_f32_16x16x32_bf16 v[36:39], a[92:95], a[212:215], v[36:39]
  ds_read_b128 a[168:171], v116 offset:26624
  v_mfma_f32_16x16x32_bf16 v[12:15], a[96:99], a[208:211], v[12:15]
  buffer_load_dwordx4 v3, s[12:15], s39 offen offset:2048 sc1 lds
  v_mfma_f32_16x16x32_bf16 v[40:43], a[96:99], a[212:215], v[40:43]
  ds_read_b128 a[172:175], v116 offset:27648
  v_mfma_f32_16x16x32_bf16 v[16:19], a[100:103], a[208:211], v[16:19]
  ds_read_b128 a[176:179], v116 offset:28672
  v_mfma_f32_16x16x32_bf16 v[44:47], a[100:103], a[212:215], v[44:47]
  v_mfma_f32_16x16x32_bf16 v[20:23], a[104:107], a[208:211], v[20:23]
  ds_read_b128 a[180:183], v116 offset:29696
  v_mfma_f32_16x16x32_bf16 v[48:51], a[104:107], a[212:215], v[48:51]
  ds_read_b128 a[184:187], v116 offset:30720
  v_mfma_f32_16x16x32_bf16 v[24:27], a[108:111], a[208:211], v[24:27]
  v_mfma_f32_16x16x32_bf16 v[52:55], a[108:111], a[212:215], v[52:55]
  buffer_load_dwordx4 v3, s[12:15], s39 offen offset:3072 sc1 lds
  v_mfma_f32_16x16x32_bf16 v[28:31], a[112:115], a[208:211], v[28:31]
  s_add_u32 s39, s38, 0x4000
  ds_read_b128 a[188:191], v116 offset:31744
  v_mfma_f32_16x16x32_bf16 v[56:59], a[112:115], a[212:215], v[56:59]
  s_cmp_eq_u32 s39, s3
  s_cselect_b32 s39, s76, s39
  s_add_u32 m0, s77, 0x8000
  s_waitcnt vmcnt(17)
  v_mfma_f32_16x16x32_bf16 v[4:7], a[116:119], a[216:219], v[4:7]
  s_waitcnt vmcnt(16)
  v_mfma_f32_16x16x32_bf16 v[32:35], a[116:119], a[220:223], v[32:35]
  v_mfma_f32_16x16x32_bf16 v[8:11], a[120:123], a[216:219], v[8:11]
  v_mfma_f32_16x16x32_bf16 v[36:39], a[120:123], a[220:223], v[36:39]
  v_mfma_f32_16x16x32_bf16 v[12:15], a[124:127], a[216:219], v[12:15]
  v_mfma_f32_16x16x32_bf16 v[40:43], a[124:127], a[220:223], v[40:43]
  s_waitcnt lgkmcnt(0)
  v_mfma_f32_16x16x32_bf16 v[16:19], a[128:131], a[216:219], v[16:19]
  ds_read_b128 a[64:67], v116 offset:0
  v_mfma_f32_16x16x32_bf16 v[44:47], a[128:131], a[220:223], v[44:47]
  ds_read_b128 a[68:71], v116 offset:1024
  v_mfma_f32_16x16x32_bf16 v[20:23], a[132:135], a[216:219], v[20:23]
  buffer_load_dwordx4 v3, s[8:11], s39 offen offset:0 sc1 lds
  v_mfma_f32_16x16x32_bf16 v[48:51], a[132:135], a[220:223], v[48:51]
  ds_read_b128 a[72:75], v116 offset:2048
  v_mfma_f32_16x16x32_bf16 v[24:27], a[136:139], a[216:219], v[24:27]
  ds_read_b128 a[76:79], v116 offset:3072
  v_mfma_f32_16x16x32_bf16 v[52:55], a[136:139], a[220:223], v[52:55]
  buffer_load_dword v122, v120, s[20:23], 0 offen sc1
  v_mfma_f32_16x16x32_bf16 v[28:31], a[140:143], a[216:219], v[28:31]
  ds_read_b128 a[80:83], v116 offset:4096
  v_mfma_f32_16x16x32_bf16 v[56:59], a[140:143], a[220:223], v[56:59]
  ds_read_b128 a[84:87], v116 offset:5120
  s_waitcnt vmcnt(17)
  v_mfma_f32_16x16x32_bf16 v[4:7], a[144:147], a[224:227], v[4:7]
  s_waitcnt vmcnt(15)
  v_mfma_f32_16x16x32_bf16 v[32:35], a[144:147], a[228:231], v[32:35]
  buffer_load_dwordx4 v3, s[8:11], s39 offen offset:1024 sc1 lds
  v_mfma_f32_16x16x32_bf16 v[8:11], a[148:151], a[224:227], v[8:11]
  ds_read_b128 a[88:91], v116 offset:6144
  v_mfma_f32_16x16x32_bf16 v[36:39], a[148:151], a[228:231], v[36:39]
  ds_read_b128 a[92:95], v116 offset:7168
  v_mfma_f32_16x16x32_bf16 v[12:15], a[152:155], a[224:227], v[12:15]
  ds_read_b128 a[96:99], v116 offset:8192
  v_mfma_f32_16x16x32_bf16 v[40:43], a[152:155], a[228:231], v[40:43]
  v_mfma_f32_16x16x32_bf16 v[16:19], a[156:159], a[224:227], v[16:19]
  ds_read_b128 a[100:103], v116 offset:9216
  v_mfma_f32_16x16x32_bf16 v[44:47], a[156:159], a[228:231], v[44:47]
  ds_read_b128 a[104:107], v116 offset:10240
  v_mfma_f32_16x16x32_bf16 v[20:23], a[160:163], a[224:227], v[20:23]
  buffer_load_dwordx4 v3, s[8:11], s39 offen offset:2048 sc1 lds
  v_mfma_f32_16x16x32_bf16 v[48:51], a[160:163], a[228:231], v[48:51]
  ds_read_b128 a[108:111], v116 offset:11264
  v_mfma_f32_16x16x32_bf16 v[24:27], a[164:167], a[224:227], v[24:27]
  ds_read_b128 a[112:115], v116 offset:12288
  v_mfma_f32_16x16x32_bf16 v[52:55], a[164:167], a[228:231], v[52:55]
  v_mfma_f32_16x16x32_bf16 v[28:31], a[168:171], a[224:227], v[28:31]
  ds_read_b128 a[116:119], v116 offset:13312
  v_mfma_f32_16x16x32_bf16 v[56:59], a[168:171], a[228:231], v[56:59]
  ds_read_b128 a[120:123], v116 offset:14336
  s_waitcnt vmcnt(16)
  v_mfma_f32_16x16x32_bf16 v[4:7], a[172:175], a[232:235], v[4:7]
  s_waitcnt vmcnt(14)
  v_mfma_f32_16x16x32_bf16 v[32:35], a[172:175], a[236:239], v[32:35]
  buffer_load_dwordx4 v3, s[8:11], s39 offen offset:3072 sc1 lds
  v_mfma_f32_16x16x32_bf16 v[8:11], a[176:179], a[232:235], v[8:11]
  s_xor_b32 s77, s77, 0x10000
  ds_read_b128 a[124:127], v116 offset:15360
  v_mfma_f32_16x16x32_bf16 v[36:39], a[176:179], a[236:239], v[36:39]
  v_mfma_f32_16x16x32_bf16 v[12:15], a[180:183], a[232:235], v[12:15]
  v_mfma_f32_16x16x32_bf16 v[40:43], a[180:183], a[236:239], v[40:43]
  v_mfma_f32_16x16x32_bf16 v[16:19], a[184:187], a[232:235], v[16:19]
  v_mfma_f32_16x16x32_bf16 v[44:47], a[184:187], a[236:239], v[44:47]
  v_mfma_f32_16x16x32_bf16 v[20:23], a[188:191], a[232:235], v[20:23]
  v_mfma_f32_16x16x32_bf16 v[48:51], a[188:191], a[236:239], v[48:51]
Lk_tj87:
  s_waitcnt lgkmcnt(0)
  v_mfma_f32_16x16x32_bf16 v[24:27], a[64:67], a[232:235], v[24:27]
  v_mfma_f32_16x16x32_bf16 v[52:55], a[64:67], a[236:239], v[52:55]
  v_mfma_f32_16x16x32_bf16 v[28:31], a[68:71], a[232:235], v[28:31]
  v_mfma_f32_16x16x32_bf16 v[56:59], a[68:71], a[236:239], v[56:59]
  s_cmp_eq_u32 s97, 2
  s_cbranch_scc1 Lk_g89
  v_pk_mul_f32 v[96:97], v[4:5], v[4:5]
  v_pk_mul_f32 v[98:99], v[6:7], v[6:7]
  v_pk_mul_f32 v[100:101], v[32:33], v[32:33]
  v_pk_mul_f32 v[102:103], v[34:35], v[34:35]
  v_pk_mul_f32 v[104:105], v[8:9], v[8:9]
  v_pk_mul_f32 v[106:107], v[10:11], v[10:11]
  v_pk_mul_f32 v[108:109], v[36:37], v[36:37]
  v_pk_mul_f32 v[110:111], v[38:39], v[38:39]
  v_pk_fma_f32 v[96:97], v[96:97], v[76:77], v[72:73]
  v_pk_fma_f32 v[98:99], v[98:99], v[76:77], v[72:73]
  v_pk_fma_f32 v[100:101], v[100:101], v[78:79], v[74:75]
  v_pk_fma_f32 v[102:103], v[102:103], v[78:79], v[74:75]
  v_pk_fma_f32 v[104:105], v[104:105], v[76:77], v[72:73]
  v_pk_fma_f32 v[106:107], v[106:107], v[76:77], v[72:73]
  v_pk_fma_f32 v[108:109], v[108:109], v[78:79], v[74:75]
  v_pk_fma_f32 v[110:111], v[110:111], v[78:79], v[74:75]
  v_pk_mul_f32 v[96:97], v[96:97], v[4:5]
  v_pk_mul_f32 v[98:99], v[98:99], v[6:7]
  v_pk_mul_f32 v[100:101], v[100:101], v[32:33]
  v_pk_mul_f32 v[102:103], v[102:103], v[34:35]
  v_pk_mul_f32 v[104:105], v[104:105], v[8:9]
  v_pk_mul_f32 v[106:107], v[106:107], v[10:11]
  v_pk_mul_f32 v[108:109], v[108:109], v[36:37]
  v_pk_mul_f32 v[110:111], v[110:111], v[38:39]
  v_exp_f32 v96, v96
  v_exp_f32 v97, v97
  v_exp_f32 v98, v98
  v_exp_f32 v99, v99
  v_exp_f32 v100, v100
  v_exp_f32 v101, v101
  v_exp_f32 v102, v102
  v_exp_f32 v103, v103
  v_exp_f32 v104, v104
  v_exp_f32 v105, v105
  v_exp_f32 v106, v106
  v_exp_f32 v107, v107
  v_exp_f32 v108, v108
  v_exp_f32 v109, v109
  v_exp_f32 v110, v110
  v_exp_f32 v111, v111
  v_pk_fma_f32 v[96:97], v[96:97], v[80:81], v[80:81]
  v_pk_fma_f32 v[98:99], v[98:99], v[80:81], v[80:81]
  v_pk_fma_f32 v[100:101], v[100:101], v[82:83], v[82:83]
  v_pk_fma_f32 v[102:103], v[102:103], v[82:83], v[82:83]
  v_pk_fma_f32 v[104:105], v[104:105], v[80:81], v[80:81]
  v_pk_fma_f32 v[106:107], v[106:107], v[80:81], v[80:81]
  v_pk_fma_f32 v[108:109], v[108:109], v[82:83], v[82:83]
  v_pk_fma_f32 v[110:111], v[110:111], v[82:83], v[82:83]
  v_rcp_f32 v96, v96
  v_rcp_f32 v97, v97
  v_rcp_f32 v98, v98
  v_rcp_f32 v99, v99
  v_rcp_f32 v100, v100
  v_rcp_f32 v101, v101
  v_rcp_f32 v102, v102
  v_rcp_f32 v103, v103
  v_rcp_f32 v104, v104
  v_rcp_f32 v105, v105
  v_rcp_f32 v106, v106
  v_rcp_f32 v107, v107
  v_rcp_f32 v108, v108
  v_rcp_f32 v109, v109
  v_rcp_f32 v110, v110
  v_rcp_f32 v111, v111
  v_pk_mul_f32 v[4:5], v[4:5], v[96:97]
  v_pk_mul_f32 v[6:7], v[6:7], v[98:99]
  v_pk_mul_f32 v[32:33], v[32:33], v[100:101]
  v_pk_mul_f32 v[34:35], v[34:35], v[102:103]
  v_pk_mul_f32 v[8:9], v[8:9], v[104:105]
  v_pk_mul_f32 v[10:11], v[10:11], v[106:107]
  v_pk_mul_f32 v[36:37], v[36:37], v[108:109]
  v_pk_mul_f32 v[38:39], v[38:39], v[110:111]
  v_cvt_pk_bf16_f32 v4, v4, v5
  v_cvt_pk_bf16_f32 v5, v6, v7
  v_cvt_pk_bf16_f32 v32, v32, v33
  v_cvt_pk_bf16_f32 v33, v34, v35
  v_cvt_pk_bf16_f32 v6, v8, v9
  v_cvt_pk_bf16_f32 v7, v10, v11
  v_cvt_pk_bf16_f32 v34, v36, v37
  v_cvt_pk_bf16_f32 v35, v38, v39
  v_pk_mul_f32 v[96:97], v[12:13], v[12:13]
  v_pk_mul_f32 v[98:99], v[14:15], v[14:15]
  v_pk_mul_f32 v[100:101], v[40:41], v[40:41]
  v_pk_mul_f32 v[102:103], v[42:43], v[42:43]
  v_pk_mul_f32 v[104:105], v[16:17], v[16:17]
  v_pk_mul_f32 v[106:107], v[18:19], v[18:19]
  v_pk_mul_f32 v[108:109], v[44:45], v[44:45]
  v_pk_mul_f32 v[110:111], v[46:47], v[46:47]
  v_pk_fma_f32 v[96:97], v[96:97], v[76:77], v[72:73]
  v_pk_fma_f32 v[98:99], v[98:99], v[76:77], v[72:73]
  v_pk_fma_f32 v[100:101], v[100:101], v[78:79], v[74:75]
  v_pk_fma_f32 v[102:103], v[102:103], v[78:79], v[74:75]
  v_pk_fma_f32 v[104:105], v[104:105], v[76:77], v[72:73]
  v_pk_fma_f32 v[106:107], v[106:107], v[76:77], v[72:73]
  v_pk_fma_f32 v[108:109], v[108:109], v[78:79], v[74:75]
  v_pk_fma_f32 v[110:111], v[110:111], v[78:79], v[74:75]
  v_pk_mul_f32 v[96:97], v[96:97], v[12:13]
  v_pk_mul_f32 v[98:99], v[98:99], v[14:15]
  v_pk_mul_f32 v[100:101], v[100:101], v[40:41]
  v_pk_mul_f32 v[102:103], v[102:103], v[42:43]
  v_pk_mul_f32 v[104:105], v[104:105], v[16:17]
  v_pk_mul_f32 v[106:107], v[106:107], v[18:19]
  v_pk_mul_f32 v[108:109], v[108:109], v[44:45]
  v_pk_mul_f32 v[110:111], v[110:111], v[46:47]
  v_exp_f32 v96, v96
  v_exp_f32 v97, v97
  v_exp_f32 v98, v98
  v_exp_f32 v99, v99
  v_exp_f32 v100, v100
  v_exp_f32 v101, v101
  v_exp_f32 v102, v102
  v_exp_f32 v103, v103
  v_exp_f32 v104, v104
  v_exp_f32 v105, v105
  v_exp_f32 v106, v106
  v_exp_f32 v107, v107
  v_exp_f32 v108, v108
  v_exp_f32 v109, v109
  v_exp_f32 v110, v110
  v_exp_f32 v111, v111
  v_pk_fma_f32 v[96:97], v[96:97], v[80:81], v[80:81]
  v_pk_fma_f32 v[98:99], v[98:99], v[80:81], v[80:81]
  v_pk_fma_f32 v[100:101], v[100:101], v[82:83], v[82:83]
  v_pk_fma_f32 v[102:103], v[102:103], v[82:83], v[82:83]
  v_pk_fma_f32 v[104:105], v[104:105], v[80:81], v[80:81]
  v_pk_fma_f32 v[106:107], v[106:107], v[80:81], v[80:81]
  v_pk_fma_f32 v[108:109], v[108:109], v[82:83], v[82:83]
  v_pk_fma_f32 v[110:111], v[110:111], v[82:83], v[82:83]
  v_rcp_f32 v96, v96
  v_rcp_f32 v97, v97
  v_rcp_f32 v98, v98
  v_rcp_f32 v99, v99
  v_rcp_f32 v100, v100
  v_rcp_f32 v101, v101
  v_rcp_f32 v102, v102
  v_rcp_f32 v103, v103
  v_rcp_f32 v104, v104
  v_rcp_f32 v105, v105
  v_rcp_f32 v106, v106
  v_rcp_f32 v107, v107
  v_rcp_f32 v108, v108
  v_rcp_f32 v109, v109
  v_rcp_f32 v110, v110
  v_rcp_f32 v111, v111
  v_pk_mul_f32 v[12:13], v[12:13], v[96:97]
  v_pk_mul_f32 v[14:15], v[14:15], v[98:99]
  v_pk_mul_f32 v[40:41], v[40:41], v[100:101]
  v_pk_mul_f32 v[42:43], v[42:43], v[102:103]
  v_pk_mul_f32 v[16:17], v[16:17], v[104:105]
  v_pk_mul_f32 v[18:19], v[18:19], v[106:107]
  v_pk_mul_f32 v[44:45], v[44:45], v[108:109]
  v_pk_mul_f32 v[46:47], v[46:47], v[110:111]
  v_cvt_pk_bf16_f32 v12, v12, v13
  v_cvt_pk_bf16_f32 v13, v14, v15
  v_cvt_pk_bf16_f32 v40, v40, v41
  v_cvt_pk_bf16_f32 v41, v42, v43
  v_cvt_pk_bf16_f32 v14, v16, v17
  v_cvt_pk_bf16_f32 v15, v18, v19
  v_cvt_pk_bf16_f32 v42, v44, v45
  v_cvt_pk_bf16_f32 v43, v46, v47
  v_pk_mul_f32 v[96:97], v[20:21], v[20:21]
  v_pk_mul_f32 v[98:99], v[22:23], v[22:23]
  v_pk_mul_f32 v[100:101], v[48:49], v[48:49]
  v_pk_mul_f32 v[102:103], v[50:51], v[50:51]
  v_pk_mul_f32 v[104:105], v[24:25], v[24:25]
  v_pk_mul_f32 v[106:107], v[26:27], v[26:27]
  v_pk_mul_f32 v[108:109], v[52:53], v[52:53]
  v_pk_mul_f32 v[110:111], v[54:55], v[54:55]
  v_pk_fma_f32 v[96:97], v[96:97], v[76:77], v[72:73]
  v_pk_fma_f32 v[98:99], v[98:99], v[76:77], v[72:73]
  v_pk_fma_f32 v[100:101], v[100:101], v[78:79], v[74:75]
  v_pk_fma_f32 v[102:103], v[102:103], v[78:79], v[74:75]
  v_pk_fma_f32 v[104:105], v[104:105], v[76:77], v[72:73]
  v_pk_fma_f32 v[106:107], v[106:107], v[76:77], v[72:73]
  v_pk_fma_f32 v[108:109], v[108:109], v[78:79], v[74:75]
  v_pk_fma_f32 v[110:111], v[110:111], v[78:79], v[74:75]
  v_pk_mul_f32 v[96:97], v[96:97], v[20:21]
  v_pk_mul_f32 v[98:99], v[98:99], v[22:23]
  v_pk_mul_f32 v[100:101], v[100:101], v[48:49]
  v_pk_mul_f32 v[102:103], v[102:103], v[50:51]
  v_pk_mul_f32 v[104:105], v[104:105], v[24:25]
  v_pk_mul_f32 v[106:107], v[106:107], v[26:27]
  v_pk_mul_f32 v[108:109], v[108:109], v[52:53]
  v_pk_mul_f32 v[110:111], v[110:111], v[54:55]
  v_exp_f32 v96, v96
  v_exp_f32 v97, v97
  v_exp_f32 v98, v98
  v_exp_f32 v99, v99
  v_exp_f32 v100, v100
  v_exp_f32 v101, v101
  v_exp_f32 v102, v102
  v_exp_f32 v103, v103
  v_exp_f32 v104, v104
  v_exp_f32 v105, v105
  v_exp_f32 v106, v106
  v_exp_f32 v107, v107
  v_exp_f32 v108, v108
  v_exp_f32 v109, v109
  v_exp_f32 v110, v110
  v_exp_f32 v111, v111
  v_pk_fma_f32 v[96:97], v[96:97], v[80:81], v[80:81]
  v_pk_fma_f32 v[98:99], v[98:99], v[80:81], v[80:81]
  v_pk_fma_f32 v[100:101], v[100:101], v[82:83], v[82:83]
  v_pk_fma_f32 v[102:103], v[102:103], v[82:83], v[82:83]
  v_pk_fma_f32 v[104:105], v[104:105], v[80:81], v[80:81]
  v_pk_fma_f32 v[106:107], v[106:107], v[80:81], v[80:81]
  v_pk_fma_f32 v[108:109], v[108:109], v[82:83], v[82:83]
  v_pk_fma_f32 v[110:111], v[110:111], v[82:83], v[82:83]
  v_rcp_f32 v96, v96
  v_rcp_f32 v97, v97
  v_rcp_f32 v98, v98
  v_rcp_f32 v99, v99
  v_rcp_f32 v100, v100
  v_rcp_f32 v101, v101
  v_rcp_f32 v102, v102
  v_rcp_f32 v103, v103
  v_rcp_f32 v104, v104
  v_rcp_f32 v105, v105
  v_rcp_f32 v106, v106
  v_rcp_f32 v107, v107
  v_rcp_f32 v108, v108
  v_rcp_f32 v109, v109
  v_rcp_f32 v110, v110
  v_rcp_f32 v111, v111
  v_pk_mul_f32 v[20:21], v[20:21], v[96:97]
  v_pk_mul_f32 v[22:23], v[22:23], v[98:99]
  v_pk_mul_f32 v[48:49], v[48:49], v[100:101]
  v_pk_mul_f32 v[50:51], v[50:51], v[102:103]
  v_pk_mul_f32 v[24:25], v[24:25], v[104:105]
  v_pk_mul_f32 v[26:27], v[26:27], v[106:107]
  v_pk_mul_f32 v[52:53], v[52:53], v[108:109]
  v_pk_mul_f32 v[54:55], v[54:55], v[110:111]
  v_cvt_pk_bf16_f32 v20, v20, v21
  v_cvt_pk_bf16_f32 v21, v22, v23
  v_cvt_pk_bf16_f32 v48, v48, v49
  v_cvt_pk_bf16_f32 v49, v50, v51
  v_cvt_pk_bf16_f32 v22, v24, v25
  v_cvt_pk_bf16_f32 v23, v26, v27
  v_cvt_pk_bf16_f32 v50, v52, v53
  v_cvt_pk_bf16_f32 v51, v54, v55
  v_pk_mul_f32 v[96:97], v[28:29], v[28:29]
  v_pk_mul_f32 v[98:99], v[30:31], v[30:31]
  v_pk_mul_f32 v[100:101], v[56:57], v[56:57]
  v_pk_mul_f32 v[102:103], v[58:59], v[58:59]
  v_pk_fma_f32 v[96:97], v[96:97], v[76:77], v[72:73]
  v_pk_fma_f32 v[98:99], v[98:99], v[76:77], v[72:73]
  v_pk_fma_f32 v[100:101], v[100:101], v[78:79], v[74:75]
  v_pk_fma_f32 v[102:103], v[102:103], v[78:79], v[74:75]
  v_pk_mul_f32 v[96:97], v[96:97], v[28:29]
  v_pk_mul_f32 v[98:99], v[98:99], v[30:31]
  v_pk_mul_f32 v[100:101], v[100:101], v[56:57]
  v_pk_mul_f32 v[102:103], v[102:103], v[58:59]
  v_exp_f32 v96, v96
  v_exp_f32 v97, v97
  v_exp_f32 v98, v98
  v_exp_f32 v99, v99
  v_exp_f32 v100, v100
  v_exp_f32 v101, v101
  v_exp_f32 v102, v102
  v_exp_f32 v103, v103
  v_pk_fma_f32 v[96:97], v[96:97], v[80:81], v[80:81]
  v_pk_fma_f32 v[98:99], v[98:99], v[80:81], v[80:81]
  v_pk_fma_f32 v[100:101], v[100:101], v[82:83], v[82:83]
  v_pk_fma_f32 v[102:103], v[102:103], v[82:83], v[82:83]
  v_rcp_f32 v96, v96
  v_rcp_f32 v97, v97
  v_rcp_f32 v98, v98
  v_rcp_f32 v99, v99
  v_rcp_f32 v100, v100
  v_rcp_f32 v101, v101
  v_rcp_f32 v102, v102
  v_rcp_f32 v103, v103
  v_pk_mul_f32 v[28:29], v[28:29], v[96:97]
  v_pk_mul_f32 v[30:31], v[30:31], v[98:99]
  v_pk_mul_f32 v[56:57], v[56:57], v[100:101]
  v_pk_mul_f32 v[58:59], v[58:59], v[102:103]
  v_cvt_pk_bf16_f32 v28, v28, v29
  v_cvt_pk_bf16_f32 v29, v30, v31
  v_cvt_pk_bf16_f32 v56, v56, v57
  v_cvt_pk_bf16_f32 v57, v58, v59
  v_mov_b64 v[30:31], 0
  v_mov_b64 v[58:59], 0
  s_branch Lk_g90
Lk_g89:
  s_waitcnt vmcnt(3)
  v_cmp_lt_u32 vcc, v122, v121
  s_nop 4
  s_cbranch_vccz Lk_go92
  s_mov_b32 s43, 0
Lk_poll91:
  s_sleep 3
  buffer_load_dword v122, v120, s[20:23], 0 offen offset:0 sc1
  s_waitcnt vmcnt(0)
  v_cmp_lt_u32 vcc, v122, v121
  s_nop 4
  s_cbranch_vccz Lk_go92
  s_add_u32 s43, s43, 1
  s_cmp_lt_u32 s43, 0x40000
  s_cbranch_scc1 Lk_poll91
Lk_go92:
  buffer_load_dwordx4 v[84:87], v2, s[28:31], s42 offen sc1
  s_add_u32 s41, s32, 0x0
  buffer_load_dwordx4 a[0:3], v2, s[28:31], s41 offen offset:0 sc1
  buffer_load_dwordx4 a[4:7], v2, s[28:31], s41 offen offset:1024 sc1
  v_pk_mul_f32 v[96:97], v[4:5], v[4:5]
  v_pk_mul_f32 v[98:99], v[6:7], v[6:7]
  v_pk_mul_f32 v[100:101], v[32:33], v[32:33]
  v_pk_mul_f32 v[102:103], v[34:35], v[34:35]
  v_pk_mul_f32 v[104:105], v[8:9], v[8:9]
  v_pk_mul_f32 v[106:107], v[10:11], v[10:11]
  v_pk_mul_f32 v[108:109], v[36:37], v[36:37]
  v_pk_mul_f32 v[110:111], v[38:39], v[38:39]
  v_pk_fma_f32 v[96:97], v[96:97], v[76:77], v[72:73]
  v_pk_fma_f32 v[98:99], v[98:99], v[76:77], v[72:73]
  buffer_load_dwordx4 a[8:11], v2, s[28:31], s41 offen offset:2048 sc1
  v_pk_fma_f32 v[100:101], v[100:101], v[78:79], v[74:75]
  v_pk_fma_f32 v[102:103], v[102:103], v[78:79], v[74:75]
  v_pk_fma_f32 v[104:105], v[104:105], v[76:77], v[72:73]
  v_pk_fma_f32 v[106:107], v[106:107], v[76:77], v[72:73]
  v_pk_fma_f32 v[108:109], v[108:109], v[78:79], v[74:75]
  v_pk_fma_f32 v[110:111], v[110:111], v[78:79], v[74:75]
  v_pk_mul_f32 v[96:97], v[96:97], v[4:5]
  v_pk_mul_f32 v[98:99], v[98:99], v[6:7]
  v_pk_mul_f32 v[100:101], v[100:101], v[32:33]
  v_pk_mul_f32 v[102:103], v[102:103], v[34:35]
  buffer_load_dwordx4 a[12:15], v2, s[28:31], s41 offen offset:3072 sc1
  v_pk_mul_f32 v[104:105], v[104:105], v[8:9]
  v_pk_mul_f32 v[106:107], v[106:107], v[10:11]
  v_pk_mul_f32 v[108:109], v[108:109], v[36:37]
  v_pk_mul_f32 v[110:111], v[110:111], v[38:39]
  v_exp_f32 v96, v96
  v_exp_f32 v97, v97
  v_exp_f32 v98, v98
  v_exp_f32 v99, v99
  v_exp_f32 v100, v100
  v_exp_f32 v101, v101
  s_add_u32 s41, s32, 0x1000
  buffer_load_dwordx4 a[16:19], v2, s[28:31], s41 offen offset:0 sc1
  v_exp_f32 v102, v102
  v_exp_f32 v103, v103
  v_exp_f32 v104, v104
  v_exp_f32 v105, v105
  v_exp_f32 v106, v106
  v_exp_f32 v107, v107
  v_exp_f32 v108, v108
  v_exp_f32 v109, v109
  v_exp_f32 v110, v110
  v_exp_f32 v111, v111
  buffer_load_dwordx4 a[20:23], v2, s[28:31], s41 offen offset:1024 sc1
  v_pk_fma_f32 v[96:97], v[96:97], v[80:81], v[80:81]
  v_pk_fma_f32 v[98:99], v[98:99], v[80:81], v[80:81]
  v_pk_fma_f32 v[100:101], v[100:101], v[82:83], v[82:83]
  v_pk_fma_f32 v[102:103], v[102:103], v[82:83], v[82:83]
  v_pk_fma_f32 v[104:105], v[104:105], v[80:81], v[80:81]
  v_pk_fma_f32 v[106:107], v[106:107], v[80:81], v[80:81]
  v_pk_fma_f32 v[108:109], v[108:109], v[82:83], v[82:83]
  v_pk_fma_f32 v[110:111], v[110:111], v[82:83], v[82:83]
  v_rcp_f32 v96, v96
  v_rcp_f32 v97, v97
  buffer_load_dwordx4 a[24:27], v2, s[28:31], s41 offen offset:2048 sc1
  v_rcp_f32 v98, v98
  v_rcp_f32 v99, v99
  v_rcp_f32 v100, v100
  v_rcp_f32 v101, v101
  v_rcp_f32 v102, v102
  v_rcp_f32 v103, v103
  v_rcp_f32 v104, v104
  v_rcp_f32 v105, v105
  v_rcp_f32 v106, v106
  v_rcp_f32 v107, v107
  buffer_load_dwordx4 a[28:31], v2, s[28:31], s41 offen offset:3072 sc1
  v_rcp_f32 v108, v108
  v_rcp_f32 v109, v109
  v_rcp_f32 v110, v110
  v_rcp_f32 v111, v111
  v_pk_mul_f32 v[4:5], v[4:5], v[96:97]
  v_pk_mul_f32 v[6:7], v[6:7], v[98:99]
  v_pk_mul_f32 v[32:33], v[32:33], v[100:101]
  v_pk_mul_f32 v[34:35], v[34:35], v[102:103]
  v_pk_mul_f32 v[8:9], v[8:9], v[104:105]
  v_pk_mul_f32 v[10:11], v[10:11], v[106:107]
  s_add_u32 s41, s32, 0x2000
  buffer_load_dwordx4 a[32:35], v2, s[28:31], s41 offen offset:0 sc1
  v_pk_mul_f32 v[36:37], v[36:37], v[108:109]
  v_pk_mul_f32 v[38:39], v[38:39], v[110:111]
  v_cvt_pk_bf16_f32 v4, v4, v5
  v_cvt_pk_bf16_f32 v5, v6, v7
  v_cvt_pk_bf16_f32 v32, v32, v33
  v_cvt_pk_bf16_f32 v33, v34, v35
  v_cvt_pk_bf16_f32 v6, v8, v9
  v_cvt_pk_bf16_f32 v7, v10, v11
  v_cvt_pk_bf16_f32 v34, v36, v37
  v_cvt_pk_bf16_f32 v35, v38, v39
  buffer_load_dwordx4 a[36:39], v2, s[28:31], s41 offen offset:1024 sc1
  v_pk_mul_f32 v[96:97], v[12:13], v[12:13]
  v_pk_mul_f32 v[98:99], v[14:15], v[14:15]
  v_pk_mul_f32 v[100:101], v[40:41], v[40:41]
  v_pk_mul_f32 v[102:103], v[42:43], v[42:43]
  v_pk_mul_f32 v[104:105], v[16:17], v[16:17]
  v_pk_mul_f32 v[106:107], v[18:19], v[18:19]
  v_pk_mul_f32 v[108:109], v[44:45], v[44:45]
  v_pk_mul_f32 v[110:111], v[46:47], v[46:47]
  v_pk_fma_f32 v[96:97], v[96:97], v[76:77], v[72:73]
  v_pk_fma_f32 v[98:99], v[98:99], v[76:77], v[72:73]
  buffer_load_dwordx4 a[40:43], v2, s[28:31], s41 offen offset:2048 sc1
  v_pk_fma_f32 v[100:101], v[100:101], v[78:79], v[74:75]
  v_pk_fma_f32 v[102:103], v[102:103], v[78:79], v[74:75]
  v_pk_fma_f32 v[104:105], v[104:105], v[76:77], v[72:73]
  v_pk_fma_f32 v[106:107], v[106:107], v[76:77], v[72:73]
  v_pk_fma_f32 v[108:109], v[108:109], v[78:79], v[74:75]
  v_pk_fma_f32 v[110:111], v[110:111], v[78:79], v[74:75]
  v_pk_mul_f32 v[96:97], v[96:97], v[12:13]
  v_pk_mul_f32 v[98:99], v[98:99], v[14:15]
  v_pk_mul_f32 v[100:101], v[100:101], v[40:41]
  v_pk_mul_f32 v[102:103], v[102:103], v[42:43]
  buffer_load_dwordx4 a[44:47], v2, s[28:31], s41 offen offset:3072 sc1
  v_pk_mul_f32 v[104:105], v[104:105], v[16:17]
  v_pk_mul_f32 v[106:107], v[106:107], v[18:19]
  v_pk_mul_f32 v[108:109], v[108:109], v[44:45]
  v_pk_mul_f32 v[110:111], v[110:111], v[46:47]
  v_exp_f32 v96, v96
  v_exp_f32 v97, v97
  v_exp_f32 v98, v98
  v_exp_f32 v99, v99
  v_exp_f32 v100, v100
  v_exp_f32 v101, v101
  s_add_u32 s41, s32, 0x3000
  buffer_load_dwordx4 a[48:51], v2, s[28:31], s41 offen offset:0 sc1
  v_exp_f32 v102, v102
  v_exp_f32 v103, v103
  v_exp_f32 v104, v104
  v_exp_f32 v105, v105
  v_exp_f32 v106, v106
  v_exp_f32 v107, v107
  v_exp_f32 v108, v108
  v_exp_f32 v109, v109
  v_exp_f32 v110, v110
  v_exp_f32 v111, v111
  buffer_load_dwordx4 a[52:55], v2, s[28:31], s41 offen offset:1024 sc1
  v_pk_fma_f32 v[96:97], v[96:97], v[80:81], v[80:81]
  v_pk_fma_f32 v[98:99], v[98:99], v[80:81], v[80:81]
  v_pk_fma_f32 v[100:101], v[100:101], v[82:83], v[82:83]
  v_pk_fma_f32 v[102:103], v[102:103], v[82:83], v[82:83]
  v_pk_fma_f32 v[104:105], v[104:105], v[80:81], v[80:81]
  v_pk_fma_f32 v[106:107], v[106:107], v[80:81], v[80:81]
  v_pk_fma_f32 v[108:109], v[108:109], v[82:83], v[82:83]
  v_pk_fma_f32 v[110:111], v[110:111], v[82:83], v[82:83]
  v_rcp_f32 v96, v96
  v_rcp_f32 v97, v97
  buffer_load_dwordx4 a[56:59], v2, s[28:31], s41 offen offset:2048 sc1
  v_rcp_f32 v98, v98
  v_rcp_f32 v99, v99
  v_rcp_f32 v100, v100
  v_rcp_f32 v101, v101
  v_rcp_f32 v102, v102
  v_rcp_f32 v103, v103
  v_rcp_f32 v104, v104
  v_rcp_f32 v105, v105
  v_rcp_f32 v106, v106
  v_rcp_f32 v107, v107
  buffer_load_dwordx4 a[60:63], v2, s[28:31], s41 offen offset:3072 sc1
  v_rcp_f32 v108, v108
  v_rcp_f32 v109, v109
  v_rcp_f32 v110, v110
  v_rcp_f32 v111, v111
  v_pk_mul_f32 v[12:13], v[12:13], v[96:97]
  v_pk_mul_f32 v[14:15], v[14:15], v[98:99]
  v_pk_mul_f32 v[40:41], v[40:41], v[100:101]
  v_pk_mul_f32 v[42:43], v[42:43], v[102:103]
  v_pk_mul_f32 v[16:17], v[16:17], v[104:105]
  v_pk_mul_f32 v[18:19], v[18:19], v[106:107]
  v_pk_mul_f32 v[44:45], v[44:45], v[108:109]
  v_pk_mul_f32 v[46:47], v[46:47], v[110:111]
  v_cvt_pk_bf16_f32 v12, v12, v13
  v_cvt_pk_bf16_f32 v13, v14, v15
  v_cvt_pk_bf16_f32 v40, v40, v41
  v_cvt_pk_bf16_f32 v41, v42, v43
  v_cvt_pk_bf16_f32 v14, v16, v17
  v_cvt_pk_bf16_f32 v15, v18, v19
  v_cvt_pk_bf16_f32 v42, v44, v45
  v_cvt_pk_bf16_f32 v43, v46, v47
  v_pk_mul_f32 v[96:97], v[20:21], v[20:21]
  v_pk_mul_f32 v[98:99], v[22:23], v[22:23]
  v_pk_mul_f32 v[100:101], v[48:49], v[48:49]
  v_pk_mul_f32 v[102:103], v[50:51], v[50:51]
  v_pk_mul_f32 v[104:105], v[24:25], v[24:25]
  v_pk_mul_f32 v[106:107], v[26:27], v[26:27]
  v_pk_mul_f32 v[108:109], v[52:53], v[52:53]
  v_pk_mul_f32 v[110:111], v[54:55], v[54:55]
  v_pk_fma_f32 v[96:97], v[96:97], v[76:77], v[72:73]
  v_pk_fma_f32 v[98:99], v[98:99], v[76:77], v[72:73]
  v_pk_fma_f32 v[100:101], v[100:101], v[78:79], v[74:75]
  v_pk_fma_f32 v[102:103], v[102:103], v[78:79], v[74:75]
  v_pk_fma_f32 v[104:105], v[104:105], v[76:77], v[72:73]
  v_pk_fma_f32 v[106:107], v[106:107], v[76:77], v[72:73]
  v_pk_fma_f32 v[108:109], v[108:109], v[78:79], v[74:75]
  v_pk_fma_f32 v[110:111], v[110:111], v[78:79], v[74:75]
  v_pk_mul_f32 v[96:97], v[96:97], v[20:21]
  v_pk_mul_f32 v[98:99], v[98:99], v[22:23]
  v_pk_mul_f32 v[100:101], v[100:101], v[48:49]
  v_pk_mul_f32 v[102:103], v[102:103], v[50:51]
  v_pk_mul_f32 v[104:105], v[104:105], v[24:25]
  v_pk_mul_f32 v[106:107], v[106:107], v[26:27]
  v_pk_mul_f32 v[108:109], v[108:109], v[52:53]
  v_pk_mul_f32 v[110:111], v[110:111], v[54:55]
  v_exp_f32 v96, v96
  v_exp_f32 v97, v97
  v_exp_f32 v98, v98
  v_exp_f32 v99, v99
  v_exp_f32 v100, v100
  v_exp_f32 v101, v101
  v_exp_f32 v102, v102
  v_exp_f32 v103, v103
  v_exp_f32 v104, v104
  v_exp_f32 v105, v105
  v_exp_f32 v106, v106
  v_exp_f32 v107, v107
  v_exp_f32 v108, v108
  v_exp_f32 v109, v109
  v_exp_f32 v110, v110
  v_exp_f32 v111, v111
  v_pk_fma_f32 v[96:97], v[96:97], v[80:81], v[80:81]
  v_pk_fma_f32 v[98:99], v[98:99], v[80:81], v[80:81]
  v_pk_fma_f32 v[100:101], v[100:101], v[82:83], v[82:83]
  v_pk_fma_f32 v[102:103], v[102:103], v[82:83], v[82:83]
  v_pk_fma_f32 v[104:105], v[104:105], v[80:81], v[80:81]
  v_pk_fma_f32 v[106:107], v[106:107], v[80:81], v[80:81]
  v_pk_fma_f32 v[108:109], v[108:109], v[82:83], v[82:83]
  v_pk_fma_f32 v[110:111], v[110:111], v[82:83], v[82:83]
  v_rcp_f32 v96, v96
  v_rcp_f32 v97, v97
  v_rcp_f32 v98, v98
  v_rcp_f32 v99, v99
  v_rcp_f32 v100, v100
  v_rcp_f32 v101, v101
  v_rcp_f32 v102, v102
  v_rcp_f32 v103, v103
  v_rcp_f32 v104, v104
  v_rcp_f32 v105, v105
  v_rcp_f32 v106, v106
  v_rcp_f32 v107, v107
  v_rcp_f32 v108, v108
  v_rcp_f32 v109, v109
  v_rcp_f32 v110, v110
  v_rcp_f32 v111, v111
  v_pk_mul_f32 v[20:21], v[20:21], v[96:97]
  v_pk_mul_f32 v[22:23], v[22:23], v[98:99]
  v_pk_mul_f32 v[48:49], v[48:49], v[100:101]
  v_pk_mul_f32 v[50:51], v[50:51], v[102:103]
  v_pk_mul_f32 v[24:25], v[24:25], v[104:105]
  v_pk_mul_f32 v[26:27], v[26:27], v[106:107]
  v_pk_mul_f32 v[52:53], v[52:53], v[108:109]
  v_pk_mul_f32 v[54:55], v[54:55], v[110:111]
  v_cvt_pk_bf16_f32 v20, v20, v21
  v_cvt_pk_bf16_f32 v21, v22, v23
  v_cvt_pk_bf16_f32 v48, v48, v49
  v_cvt_pk_bf16_f32 v49, v50, v51
  v_cvt_pk_bf16_f32 v22, v24, v25
  v_cvt_pk_bf16_f32 v23, v26, v27
  v_cvt_pk_bf16_f32 v50, v52, v53
  v_cvt_pk_bf16_f32 v51, v54, v55
  v_pk_mul_f32 v[96:97], v[28:29], v[28:29]
  v_pk_mul_f32 v[98:99], v[30:31], v[30:31]
  v_pk_mul_f32 v[100:101], v[56:57], v[56:57]
  v_pk_mul_f32 v[102:103], v[58:59], v[58:59]
  v_pk_fma_f32 v[96:97], v[96:97], v[76:77], v[72:73]
  v_pk_fma_f32 v[98:99], v[98:99], v[76:77], v[72:73]
  v_pk_fma_f32 v[100:101], v[100:101], v[78:79], v[74:75]
  v_pk_fma_f32 v[102:103], v[102:103], v[78:79], v[74:75]
  v_pk_mul_f32 v[96:97], v[96:97], v[28:29]
  v_pk_mul_f32 v[98:99], v[98:99], v[30:31]
  v_pk_mul_f32 v[100:101], v[100:101], v[56:57]
  v_pk_mul_f32 v[102:103], v[102:103], v[58:59]
  v_exp_f32 v96, v96
  v_exp_f32 v97, v97
  v_exp_f32 v98, v98
  v_exp_f32 v99, v99
  v_exp_f32 v100, v100
  v_exp_f32 v101, v101
  v_exp_f32 v102, v102
  v_exp_f32 v103, v103
  v_pk_fma_f32 v[96:97], v[96:97], v[80:81], v[80:81]
  v_pk_fma_f32 v[98:99], v[98:99], v[80:81], v[80:81]
  v_pk_fma_f32 v[100:101], v[100:101], v[82:83], v[82:83]
  v_pk_fma_f32 v[102:103], v[102:103], v[82:83], v[82:83]
  v_rcp_f32 v96, v96
  v_rcp_f32 v97, v97
  v_rcp_f32 v98, v98
  v_rcp_f32 v99, v99
  v_rcp_f32 v100, v100
  v_rcp_f32 v101, v101
  v_rcp_f32 v102, v102
  v_rcp_f32 v103, v103
  v_pk_mul_f32 v[28:29], v[28:29], v[96:97]
  v_pk_mul_f32 v[30:31], v[30:31], v[98:99]
  v_pk_mul_f32 v[56:57], v[56:57], v[100:101]
  v_pk_mul_f32 v[58:59], v[58:59], v[102:103]
  v_cvt_pk_bf16_f32 v28, v28, v29
  v_cvt_pk_bf16_f32 v29, v30, v31
  v_cvt_pk_bf16_f32 v56, v56, v57
  v_cvt_pk_bf16_f32 v57, v58, v59
  v_mov_b64 v[30:31], 0
  v_mov_b64 v[58:59], 0
  s_waitcnt vmcnt(16)
  v_sub_f32 v84, v112, v84
  v_sub_f32 v86, v114, v86
  v_max_f32 v120, v84, v86
  v_cmp_lt_f32 vcc, 0x42700000, v120
  s_nop 4
  s_cbranch_vccnz Lk_fix83
Lk_fr84:
  v_exp_f32 v84, v84
  v_exp_f32 v86, v86
  v_mul_f32 v84, v84, v85
  v_mul_f32 v86, v86, v87
  v_add_f32 v88, v88, v84
  v_add_f32 v92, v92, v86
  v_rcp_f32 v68, v88
  v_rcp_f32 v70, v92
  v_mul_f32 v68, v68, v124
  v_mul_f32 v70, v70, v125
  v_mul_f32 v84, v84, v68
  v_mul_f32 v86, v86, v70
  v_mov_b32 v69, v68
  v_mov_b32 v85, v84
  v_mov_b32 v71, v70
  v_mov_b32 v87, v86
  v_pk_mul_f32 v[128:129], v[128:129], v[68:69]
  v_pk_mul_f32 v[130:131], v[130:131], v[68:69]
  v_pk_mul_f32 v[132:133], v[132:133], v[70:71]
  v_pk_mul_f32 v[134:135], v[134:135], v[70:71]
  v_pk_mul_f32 v[136:137], v[136:137], v[68:69]
  v_pk_mul_f32 v[138:139], v[138:139], v[68:69]
  v_pk_mul_f32 v[140:141], v[140:141], v[70:71]
  v_pk_mul_f32 v[142:143], v[142:143], v[70:71]
  v_pk_mul_f32 v[144:145], v[144:145], v[68:69]
  v_pk_mul_f32 v[146:147], v[146:147], v[68:69]
  v_pk_mul_f32 v[148:149], v[148:149], v[70:71]
  v_pk_mul_f32 v[150:151], v[150:151], v[70:71]
  v_pk_mul_f32 v[152:153], v[152:153], v[68:69]
  v_pk_mul_f32 v[154:155], v[154:155], v[68:69]
  v_pk_mul_f32 v[156:157], v[156:157], v[70:71]
  v_pk_mul_f32 v[158:159], v[158:159], v[70:71]
  v_pk_mul_f32 v[160:161], v[160:161], v[68:69]
  v_pk_mul_f32 v[162:163], v[162:163], v[68:69]
  v_pk_mul_f32 v[164:165], v[164:165], v[70:71]
  v_pk_mul_f32 v[166:167], v[166:167], v[70:71]
  v_pk_mul_f32 v[168:169], v[168:169], v[68:69]
  v_pk_mul_f32 v[170:171], v[170:171], v[68:69]
  v_pk_mul_f32 v[172:173], v[172:173], v[70:71]
  v_pk_mul_f32 v[174:175], v[174:175], v[70:71]
  v_pk_mul_f32 v[176:177], v[176:177], v[68:69]
  v_pk_mul_f32 v[178:179], v[178:179], v[68:69]
  v_pk_mul_f32 v[180:181], v[180:181], v[70:71]
  v_pk_mul_f32 v[182:183], v[182:183], v[70:71]
  v_pk_mul_f32 v[184:185], v[184:185], v[68:69]
  v_pk_mul_f32 v[186:187], v[186:187], v[68:69]
  v_pk_mul_f32 v[188:189], v[188:189], v[70:71]
  v_pk_mul_f32 v[190:191], v[190:191], v[70:71]
  v_pk_mul_f32 v[192:193], v[192:193], v[68:69]
  v_pk_mul_f32 v[194:195], v[194:195], v[68:69]
  v_pk_mul_f32 v[196:197], v[196:197], v[70:71]
  v_pk_mul_f32 v[198:199], v[198:199], v[70:71]
  v_pk_mul_f32 v[200:201], v[200:201], v[68:69]
  v_pk_mul_f32 v[202:203], v[202:203], v[68:69]
  v_pk_mul_f32 v[204:205], v[204:205], v[70:71]
  v_pk_mul_f32 v[206:207], v[206:207], v[70:71]
  v_pk_mul_f32 v[208:209], v[208:209], v[68:69]
  v_pk_mul_f32 v[210:211], v[210:211], v[68:69]
  v_pk_mul_f32 v[212:213], v[212:213], v[70:71]
  v_pk_mul_f32 v[214:215], v[214:215], v[70:71]
  v_pk_mul_f32 v[216:217], v[216:217], v[68:69]
  v_pk_mul_f32 v[218:219], v[218:219], v[68:69]
  v_pk_mul_f32 v[220:221], v[220:221], v[70:71]
  v_pk_mul_f32 v[222:223], v[222:223], v[70:71]
  v_pk_mul_f32 v[224:225], v[224:225], v[68:69]
  v_pk_mul_f32 v[226:227], v[226:227], v[68:69]
  v_pk_mul_f32 v[228:229], v[228:229], v[70:71]
  v_pk_mul_f32 v[230:231], v[230:231], v[70:71]
  v_pk_mul_f32 v[232:233], v[232:233], v[68:69]
  v_pk_mul_f32 v[234:235], v[234:235], v[68:69]
  v_pk_mul_f32 v[236:237], v[236:237], v[70:71]
  v_pk_mul_f32 v[238:239], v[238:239], v[70:71]
  v_pk_mul_f32 v[240:241], v[240:241], v[68:69]
  v_pk_mul_f32 v[242:243], v[242:243], v[68:69]
  v_pk_mul_f32 v[244:245], v[244:245], v[70:71]
  v_pk_mul_f32 v[246:247], v[246:247], v[70:71]
  v_pk_mul_f32 v[248:249], v[248:249], v[68:69]
  v_pk_mul_f32 v[250:251], v[250:251], v[68:69]
  v_pk_mul_f32 v[252:253], v[252:253], v[70:71]
  v_pk_mul_f32 v[254:255], v[254:255], v[70:71]
  s_waitcnt vmcnt(15)
  v_accvgpr_read_b32 v104, a0
  v_accvgpr_read_b32 v105, a1
  v_accvgpr_read_b32 v106, a2
  v_accvgpr_read_b32 v107, a3
  v_lshlrev_b32 v96, 16, v104
  v_and_b32 v97, 0xffff0000, v104
  v_lshlrev_b32 v98, 16, v105
  v_and_b32 v99, 0xffff0000, v105
  v_lshlrev_b32 v100, 16, v106
  v_and_b32 v101, 0xffff0000, v106
  v_lshlrev_b32 v102, 16, v107
  v_and_b32 v103, 0xffff0000, v107
  v_pk_fma_f32 v[128:129], v[96:97], v[84:85], v[128:129]
  v_pk_fma_f32 v[130:131], v[98:99], v[84:85], v[130:131]
  v_pk_fma_f32 v[136:137], v[100:101], v[84:85], v[136:137]
  v_pk_fma_f32 v[138:139], v[102:103], v[84:85], v[138:139]
  v_cvt_pk_bf16_f32 v128, v128, v129
  v_cvt_pk_bf16_f32 v129, v130, v131
  v_cvt_pk_bf16_f32 v130, v136, v137
  v_cvt_pk_bf16_f32 v131, v138, v139
  s_waitcnt vmcnt(14)
  v_accvgpr_read_b32 v104, a4
  v_accvgpr_read_b32 v105, a5
  v_accvgpr_read_b32 v106, a6
  v_accvgpr_read_b32 v107, a7
  v_lshlrev_b32 v96, 16, v104
  v_and_b32 v97, 0xffff0000, v104
  v_lshlrev_b32 v98, 16, v105
  v_and_b32 v99, 0xffff0000, v105
  v_lshlrev_b32 v100, 16, v106
  v_and_b32 v101, 0xffff0000, v106
  v_lshlrev_b32 v102, 16, v107
  v_and_b32 v103, 0xffff0000, v107
  v_pk_fma_f32 v[144:145], v[96:97], v[84:85], v[144:145]
  v_pk_fma_f32 v[146:147], v[98:99], v[84:85], v[146:147]
  v_pk_fma_f32 v[152:153], v[100:101], v[84:85], v[152:153]
  v_pk_fma_f32 v[154:155], v[102:103], v[84:85], v[154:155]
  v_cvt_pk_bf16_f32 v144, v144, v145
  v_cvt_pk_bf16_f32 v145, v146, v147
  v_cvt_pk_bf16_f32 v146, v152, v153
  v_cvt_pk_bf16_f32 v147, v154, v155
  s_waitcnt vmcnt(13)
  v_accvgpr_read_b32 v104, a8
  v_accvgpr_read_b32 v105, a9
  v_accvgpr_read_b32 v106, a10
  v_accvgpr_read_b32 v107, a11
  v_lshlrev_b32 v96, 16, v104
  v_and_b32 v97, 0xffff0000, v104
  v_lshlrev_b32 v98, 16, v105
  v_and_b32 v99, 0xffff0000, v105
  v_lshlrev_b32 v100, 16, v106
  v_and_b32 v101, 0xffff0000, v106
  v_lshlrev_b32 v102, 16, v107
  v_and_b32 v103, 0xffff0000, v107
  v_pk_fma_f32 v[160:161], v[96:97], v[84:85], v[160:161]
  v_pk_fma_f32 v[162:163], v[98:99], v[84:85], v[162:163]
  v_pk_fma_f32 v[168:169], v[100:101], v[84:85], v[168:169]
  v_pk_fma_f32 v[170:171], v[102:103], v[84:85], v[170:171]
  v_cvt_pk_bf16_f32 v160, v160, v161
  v_cvt_pk_bf16_f32 v161, v162, v163
  v_cvt_pk_bf16_f32 v162, v168, v169
  v_cvt_pk_bf16_f32 v163, v170, v171
  s_waitcnt vmcnt(12)
  v_accvgpr_read_b32 v104, a12
  v_accvgpr_read_b32 v105, a13
  v_accvgpr_read_b32 v106, a14
  v_accvgpr_read_b32 v107, a15
  v_lshlrev_b32 v96, 16, v104
  v_and_b32 v97, 0xffff0000, v104
  v_lshlrev_b32 v98, 16, v105
  v_and_b32 v99, 0xffff0000, v105
  v_lshlrev_b32 v100, 16, v106
  v_and_b32 v101, 0xffff0000, v106
  v_lshlrev_b32 v102, 16, v107
  v_and_b32 v103, 0xffff0000, v107
  v_pk_fma_f32 v[176:177], v[96:97], v[84:85], v[176:177]
  v_pk_fma_f32 v[178:179], v[98:99], v[84:85], v[178:179]
  v_pk_fma_f32 v[184:185], v[100:101], v[84:85], v[184:185]
  v_pk_fma_f32 v[186:187], v[102:103], v[84:85], v[186:187]
  v_cvt_pk_bf16_f32 v176, v176, v177
  v_cvt_pk_bf16_f32 v177, v178, v179
  v_cvt_pk_bf16_f32 v178, v184, v185
  v_cvt_pk_bf16_f32 v179, v186, v187
  s_waitcnt vmcnt(11)
  v_accvgpr_read_b32 v104, a16
  v_accvgpr_read_b32 v105, a17
  v_accvgpr_read_b32 v106, a18
  v_accvgpr_read_b32 v107, a19
  v_lshlrev_b32 v96, 16, v104
  v_and_b32 v97, 0xffff0000, v104
  v_lshlrev_b32 v98, 16, v105
  v_and_b32 v99, 0xffff0000, v105
  v_lshlrev_b32 v100, 16, v106
  v_and_b32 v101, 0xffff0000, v106
  v_lshlrev_b32 v102, 16, v107
  v_and_b32 v103, 0xffff0000, v107
  v_pk_fma_f32 v[192:193], v[96:97], v[84:85], v[192:193]
  v_pk_fma_f32 v[194:195], v[98:99], v[84:85], v[194:195]
  v_pk_fma_f32 v[200:201], v[100:101], v[84:85], v[200:201]
  v_pk_fma_f32 v[202:203], v[102:103], v[84:85], v[202:203]
  v_cvt_pk_bf16_f32 v192, v192, v193
  v_cvt_pk_bf16_f32 v193, v194, v195
  v_cvt_pk_bf16_f32 v194, v200, v201
  v_cvt_pk_bf16_f32 v195, v202, v203
  s_waitcnt vmcnt(10)
  v_accvgpr_read_b32 v104, a20
  v_accvgpr_read_b32 v105, a21
  v_accvgpr_read_b32 v106, a22
  v_accvgpr_read_b32 v107, a23
  v_lshlrev_b32 v96, 16, v104
  v_and_b32 v97, 0xffff0000, v104
  v_lshlrev_b32 v98, 16, v105
  v_and_b32 v99, 0xffff0000, v105
  v_lshlrev_b32 v100, 16, v106
  v_and_b32 v101, 0xffff0000, v106
  v_lshlrev_b32 v102, 16, v107
  v_and_b32 v103, 0xffff0000, v107
  v_pk_fma_f32 v[208:209], v[96:97], v[84:85], v[208:209]
  v_pk_fma_f32 v[210:211], v[98:99], v[84:85], v[210:211]
  v_pk_fma_f32 v[216:217], v[100:101], v[84:85], v[216:217]
  v_pk_fma_f32 v[218:219], v[102:103], v[84:85], v[218:219]
  v_cvt_pk_bf16_f32 v208, v208, v209
  v_cvt_pk_bf16_f32 v209, v210, v211
  v_cvt_pk_bf16_f32 v210, v216, v217
  v_cvt_pk_bf16_f32 v211, v218, v219
  s_waitcnt vmcnt(9)
  v_accvgpr_read_b32 v104, a24
  v_accvgpr_read_b32 v105, a25
  v_accvgpr_read_b32 v106, a26
  v_accvgpr_read_b32 v107, a27
  v_lshlrev_b32 v96, 16, v104
  v_and_b32 v97, 0xffff0000, v104
  v_lshlrev_b32 v98, 16, v105
  v_and_b32 v99, 0xffff0000, v105
  v_lshlrev_b32 v100, 16, v106
  v_and_b32 v101, 0xffff0000, v106
  v_lshlrev_b32 v102, 16, v107
  v_and_b32 v103, 0xffff0000, v107
  v_pk_fma_f32 v[224:225], v[96:97], v[84:85], v[224:225]
  v_pk_fma_f32 v[226:227], v[98:99], v[84:85], v[226:227]
  v_pk_fma_f32 v[232:233], v[100:101], v[84:85], v[232:233]
  v_pk_fma_f32 v[234:235], v[102:103], v[84:85], v[234:235]
  v_cvt_pk_bf16_f32 v224, v224, v225
  v_cvt_pk_bf16_f32 v225, v226, v227
  v_cvt_pk_bf16_f32 v226, v232, v233
  v_cvt_pk_bf16_f32 v227, v234, v235
  s_waitcnt vmcnt(8)
  v_accvgpr_read_b32 v104, a28
  v_accvgpr_read_b32 v105, a29
  v_accvgpr_read_b32 v106, a30
  v_accvgpr_read_b32 v107, a31
  v_lshlrev_b32 v96, 16, v104
  v_and_b32 v97, 0xffff0000, v104
  v_lshlrev_b32 v98, 16, v105
  v_and_b32 v99, 0xffff0000, v105
  v_lshlrev_b32 v100, 16, v106
  v_and_b32 v101, 0xffff0000, v106
  v_lshlrev_b32 v102, 16, v107
  v_and_b32 v103, 0xffff0000, v107
  v_pk_fma_f32 v[240:241], v[96:97], v[84:85], v[240:241]
  v_pk_fma_f32 v[242:243], v[98:99], v[84:85], v[242:243]
  v_pk_fma_f32 v[248:249], v[100:101], v[84:85], v[248:249]
  v_pk_fma_f32 v[250:251], v[102:103], v[84:85], v[250:251]
  v_cvt_pk_bf16_f32 v240, v240, v241
  v_cvt_pk_bf16_f32 v241, v242, v243
  v_cvt_pk_bf16_f32 v242, v248, v249
  v_cvt_pk_bf16_f32 v243, v250, v251
  s_waitcnt vmcnt(7)
  v_accvgpr_read_b32 v104, a32
  v_accvgpr_read_b32 v105, a33
  v_accvgpr_read_b32 v106, a34
  v_accvgpr_read_b32 v107, a35
  v_lshlrev_b32 v96, 16, v104
  v_and_b32 v97, 0xffff0000, v104
  v_lshlrev_b32 v98, 16, v105
  v_and_b32 v99, 0xffff0000, v105
  v_lshlrev_b32 v100, 16, v106
  v_and_b32 v101, 0xffff0000, v106
  v_lshlrev_b32 v102, 16, v107
  v_and_b32 v103, 0xffff0000, v107
  v_pk_fma_f32 v[132:133], v[96:97], v[86:87], v[132:133]
  v_pk_fma_f32 v[134:135], v[98:99], v[86:87], v[134:135]
  v_pk_fma_f32 v[140:141], v[100:101], v[86:87], v[140:141]
  v_pk_fma_f32 v[142:143], v[102:103], v[86:87], v[142:143]
  v_cvt_pk_bf16_f32 v132, v132, v133
  v_cvt_pk_bf16_f32 v133, v134, v135
  v_cvt_pk_bf16_f32 v134, v140, v141
  v_cvt_pk_bf16_f32 v135, v142, v143
  s_waitcnt vmcnt(6)
  v_accvgpr_read_b32 v104, a36
  v_accvgpr_read_b32 v105, a37
  v_accvgpr_read_b32 v106, a38
  v_accvgpr_read_b32 v107, a39
  v_lshlrev_b32 v96, 16, v104
  v_and_b32 v97, 0xffff0000, v104
  v_lshlrev_b32 v98, 16, v105
  v_and_b32 v99, 0xffff0000, v105
  v_lshlrev_b32 v100, 16, v106
  v_and_b32 v101, 0xffff0000, v106
  v_lshlrev_b32 v102, 16, v107
  v_and_b32 v103, 0xffff0000, v107
  v_pk_fma_f32 v[148:149], v[96:97], v[86:87], v[148:149]
  v_pk_fma_f32 v[150:151], v[98:99], v[86:87], v[150:151]
  v_pk_fma_f32 v[156:157], v[100:101], v[86:87], v[156:157]
  v_pk_fma_f32 v[158:159], v[102:103], v[86:87], v[158:159]
  v_cvt_pk_bf16_f32 v148, v148, v149
  v_cvt_pk_bf16_f32 v149, v150, v151
  v_cvt_pk_bf16_f32 v150, v156, v157
  v_cvt_pk_bf16_f32 v151, v158, v159
  s_waitcnt vmcnt(5)
  v_accvgpr_read_b32 v104, a40
  v_accvgpr_read_b32 v105, a41
  v_accvgpr_read_b32 v106, a42
  v_accvgpr_read_b32 v107, a43
  v_lshlrev_b32 v96, 16, v104
  v_and_b32 v97, 0xffff0000, v104
  v_lshlrev_b32 v98, 16, v105
  v_and_b32 v99, 0xffff0000, v105
  v_lshlrev_b32 v100, 16, v106
  v_and_b32 v101, 0xffff0000, v106
  v_lshlrev_b32 v102, 16, v107
  v_and_b32 v103, 0xffff0000, v107
  v_pk_fma_f32 v[164:165], v[96:97], v[86:87], v[164:165]
  v_pk_fma_f32 v[166:167], v[98:99], v[86:87], v[166:167]
  v_pk_fma_f32 v[172:173], v[100:101], v[86:87], v[172:173]
  v_pk_fma_f32 v[174:175], v[102:103], v[86:87], v[174:175]
  v_cvt_pk_bf16_f32 v164, v164, v165
  v_cvt_pk_bf16_f32 v165, v166, v167
  v_cvt_pk_bf16_f32 v166, v172, v173
  v_cvt_pk_bf16_f32 v167, v174, v175
  s_waitcnt vmcnt(4)
  v_accvgpr_read_b32 v104, a44
  v_accvgpr_read_b32 v105, a45
  v_accvgpr_read_b32 v106, a46
  v_accvgpr_read_b32 v107, a47
  v_lshlrev_b32 v96, 16, v104
  v_and_b32 v97, 0xffff0000, v104
  v_lshlrev_b32 v98, 16, v105
  v_and_b32 v99, 0xffff0000, v105
  v_lshlrev_b32 v100, 16, v106
  v_and_b32 v101, 0xffff0000, v106
  v_lshlrev_b32 v102, 16, v107
  v_and_b32 v103, 0xffff0000, v107
  v_pk_fma_f32 v[180:181], v[96:97], v[86:87], v[180:181]
  v_pk_fma_f32 v[182:183], v[98:99], v[86:87], v[182:183]
  v_pk_fma_f32 v[188:189], v[100:101], v[86:87], v[188:189]
  v_pk_fma_f32 v[190:191], v[102:103], v[86:87], v[190:191]
  v_cvt_pk_bf16_f32 v180, v180, v181
  v_cvt_pk_bf16_f32 v181, v182, v183
  v_cvt_pk_bf16_f32 v182, v188, v189
  v_cvt_pk_bf16_f32 v183, v190, v191
  s_waitcnt vmcnt(3)
  v_accvgpr_read_b32 v104, a48
  v_accvgpr_read_b32 v105, a49
  v_accvgpr_read_b32 v106, a50
  v_accvgpr_read_b32 v107, a51
  v_lshlrev_b32 v96, 16, v104
  v_and_b32 v97, 0xffff0000, v104
  v_lshlrev_b32 v98, 16, v105
  v_and_b32 v99, 0xffff0000, v105
  v_lshlrev_b32 v100, 16, v106
  v_and_b32 v101, 0xffff0000, v106
  v_lshlrev_b32 v102, 16, v107
  v_and_b32 v103, 0xffff0000, v107
  v_pk_fma_f32 v[196:197], v[96:97], v[86:87], v[196:197]
  v_pk_fma_f32 v[198:199], v[98:99], v[86:87], v[198:199]
  v_pk_fma_f32 v[204:205], v[100:101], v[86:87], v[204:205]
  v_pk_fma_f32 v[206:207], v[102:103], v[86:87], v[206:207]
  v_cvt_pk_bf16_f32 v196, v196, v197
  v_cvt_pk_bf16_f32 v197, v198, v199
  v_cvt_pk_bf16_f32 v198, v204, v205
  v_cvt_pk_bf16_f32 v199, v206, v207
  s_waitcnt vmcnt(2)
  v_accvgpr_read_b32 v104, a52
  v_accvgpr_read_b32 v105, a53
  v_accvgpr_read_b32 v106, a54
  v_accvgpr_read_b32 v107, a55
  v_lshlrev_b32 v96, 16, v104
  v_and_b32 v97, 0xffff0000, v104
  v_lshlrev_b32 v98, 16, v105
  v_and_b32 v99, 0xffff0000, v105
  v_lshlrev_b32 v100, 16, v106
  v_and_b32 v101, 0xffff0000, v106
  v_lshlrev_b32 v102, 16, v107
  v_and_b32 v103, 0xffff0000, v107
  v_pk_fma_f32 v[212:213], v[96:97], v[86:87], v[212:213]
  v_pk_fma_f32 v[214:215], v[98:99], v[86:87], v[214:215]
  v_pk_fma_f32 v[220:221], v[100:101], v[86:87], v[220:221]
  v_pk_fma_f32 v[222:223], v[102:103], v[86:87], v[222:223]
  v_cvt_pk_bf16_f32 v212, v212, v213
  v_cvt_pk_bf16_f32 v213, v214, v215
  v_cvt_pk_bf16_f32 v214, v220, v221
  v_cvt_pk_bf16_f32 v215, v222, v223
  s_waitcnt vmcnt(1)
  v_accvgpr_read_b32 v104, a56
  v_accvgpr_read_b32 v105, a57
  v_accvgpr_read_b32 v106, a58
  v_accvgpr_read_b32 v107, a59
  v_lshlrev_b32 v96, 16, v104
  v_and_b32 v97, 0xffff0000, v104
  v_lshlrev_b32 v98, 16, v105
  v_and_b32 v99, 0xffff0000, v105
  v_lshlrev_b32 v100, 16, v106
  v_and_b32 v101, 0xffff0000, v106
  v_lshlrev_b32 v102, 16, v107
  v_and_b32 v103, 0xffff0000, v107
  v_pk_fma_f32 v[228:229], v[96:97], v[86:87], v[228:229]
  v_pk_fma_f32 v[230:231], v[98:99], v[86:87], v[230:231]
  v_pk_fma_f32 v[236:237], v[100:101], v[86:87], v[236:237]
  v_pk_fma_f32 v[238:239], v[102:103], v[86:87], v[238:239]
  v_cvt_pk_bf16_f32 v228, v228, v229
  v_cvt_pk_bf16_f32 v229, v230, v231
  v_cvt_pk_bf16_f32 v230, v236, v237
  v_cvt_pk_bf16_f32 v231, v238, v239
  s_waitcnt vmcnt(0)
  v_accvgpr_read_b32 v104, a60
  v_accvgpr_read_b32 v105, a61
  v_accvgpr_read_b32 v106, a62
  v_accvgpr_read_b32 v107, a63
  v_lshlrev_b32 v96, 16, v104
  v_and_b32 v97, 0xffff0000, v104
  v_lshlrev_b32 v98, 16, v105
  v_and_b32 v99, 0xffff0000, v105
  v_lshlrev_b32 v100, 16, v106
  v_and_b32 v101, 0xffff0000, v106
  v_lshlrev_b32 v102, 16, v107
  v_and_b32 v103, 0xffff0000, v107
  v_pk_fma_f32 v[244:245], v[96:97], v[86:87], v[244:245]
  v_pk_fma_f32 v[246:247], v[98:99], v[86:87], v[246:247]
  v_pk_fma_f32 v[252:253], v[100:101], v[86:87], v[252:253]
  v_pk_fma_f32 v[254:255], v[102:103], v[86:87], v[254:255]
  v_cvt_pk_bf16_f32 v244, v244, v245
  v_cvt_pk_bf16_f32 v245, v246, v247
  v_cvt_pk_bf16_f32 v246, v252, v253
  v_cvt_pk_bf16_f32 v247, v254, v255
Lk_g90:
  s_waitcnt lgkmcnt(0)
  s_barrier
  v_mfma_f32_16x16x32_bf16 v[136:139], a[72:75], v[128:131], 0
  ds_read_b128 a[128:131], v116 offset:49152
  v_mfma_f32_16x16x32_bf16 v[136:139], a[80:83], v[144:147], v[136:139]
  s_add_u32 m0, s77, 0x4000
  ds_read_b128 a[132:135], v116 offset:50176
  v_mfma_f32_16x16x32_bf16 v[136:139], a[88:91], v[160:163], v[136:139]
  buffer_load_dwordx4 v3, s[12:15], s38 offen offset:0 sc1 lds
  v_mfma_f32_16x16x32_bf16 v[136:139], a[96:99], v[176:179], v[136:139]
  ds_read_b128 a[136:139], v116 offset:51200
  v_mfma_f32_16x16x32_bf16 v[136:139], a[104:107], v[192:195], v[136:139]
  ds_read_b128 a[140:143], v116 offset:52224
  v_mfma_f32_16x16x32_bf16 v[136:139], a[112:115], v[208:211], v[136:139]
  ds_read_b128 a[144:147], v116 offset:53248
  v_mfma_f32_16x16x32_bf16 v[136:139], a[120:123], v[224:227], v[136:139]
  ds_read_b128 a[148:151], v116 offset:54272
  v_mfma_f32_16x16x32_bf16 v[140:143], a[72:75], v[132:135], 0
  ds_read_b128 a[152:155], v116 offset:55296
  v_mfma_f32_16x16x32_bf16 v[140:143], a[80:83], v[148:151], v[140:143]
  buffer_load_dwordx4 v3, s[12:15], s38 offen offset:1024 sc1 lds
  v_mfma_f32_16x16x32_bf16 v[140:143], a[88:91], v[164:167], v[140:143]
  ds_read_b128 a[156:159], v116 offset:56320
  v_mfma_f32_16x16x32_bf16 v[140:143], a[96:99], v[180:183], v[140:143]
  ds_read_b128 a[160:163], v116 offset:57344
  v_mfma_f32_16x16x32_bf16 v[140:143], a[104:107], v[196:199], v[140:143]
  ds_read_b128 a[164:167], v116 offset:58368
  v_mfma_f32_16x16x32_bf16 v[140:143], a[112:115], v[212:215], v[140:143]
  ds_read_b128 a[168:171], v116 offset:59392
  v_mfma_f32_16x16x32_bf16 v[140:143], a[120:123], v[228:231], v[140:143]
  v_mfma_f32_16x16x32_bf16 v[152:155], a[76:79], v[128:131], 0
  buffer_load_dwordx4 v3, s[12:15], s38 offen offset:2048 sc1 lds
  v_mfma_f32_16x16x32_bf16 v[152:155], a[84:87], v[144:147], v[152:155]
  ds_read_b128 a[172:175], v116 offset:60416
  v_mfma_f32_16x16x32_bf16 v[152:155], a[92:95], v[160:163], v[152:155]
  ds_read_b128 a[176:179], v116 offset:61440
  v_mfma_f32_16x16x32_bf16 v[152:155], a[100:103], v[176:179], v[152:155]
  ds_read_b128 a[180:183], v116 offset:62464
  v_mfma_f32_16x16x32_bf16 v[152:155], a[108:111], v[192:195], v[152:155]
  ds_read_b128 a[184:187], v116 offset:63488
  v_mfma_f32_16x16x32_bf16 v[152:155], a[116:119], v[208:211], v[152:155]
  ds_read_b128 a[188:191], v116 offset:64512
  v_mfma_f32_16x16x32_bf16 v[152:155], a[124:127], v[224:227], v[152:155]
  buffer_load_dwordx4 v3, s[12:15], s38 offen offset:3072 sc1 lds
  v_mfma_f32_16x16x32_bf16 v[156:159], a[76:79], v[132:135], 0
  s_add_u32 s38, s39, 0x4000
  s_cmp_eq_u32 s38, s3
  s_cselect_b32 s38, s76, s38
  v_mfma_f32_16x16x32_bf16 v[156:159], a[84:87], v[148:151], v[156:159]
  s_mov_b32 m0, s77
  v_mfma_f32_16x16x32_bf16 v[156:159], a[92:95], v[164:167], v[156:159]
  v_mfma_f32_16x16x32_bf16 v[156:159], a[100:103], v[180:183], v[156:159]
  v_mfma_f32_16x16x32_bf16 v[156:159], a[108:111], v[196:199], v[156:159]
  v_mfma_f32_16x16x32_bf16 v[156:159], a[116:119], v[212:215], v[156:159]
  v_mfma_f32_16x16x32_bf16 v[156:159], a[124:127], v[228:231], v[156:159]
  s_waitcnt lgkmcnt(0)
  v_mfma_f32_16x16x32_bf16 v[136:139], a[128:131], v[240:243], v[136:139]
  ds_read_b128 a[64:67], v116 offset:32768
  v_mfma_f32_16x16x32_bf16 v[136:139], a[136:139], v[4:7], v[136:139]
  ds_read_b128 a[68:71], v116 offset:33792
  v_mfma_f32_16x16x32_bf16 v[136:139], a[144:147], v[12:15], v[136:139]
  buffer_load_dwordx4 v3, s[8:11], s38 offen offset:0 sc1 lds
  v_mfma_f32_16x16x32_bf16 v[136:139], a[152:155], v[20:23], v[136:139]
  ds_read_b128 a[72:75], v116 offset:34816
  v_mfma_f32_16x16x32_bf16 v[136:139], a[160:163], v[28:31], v[136:139]
  ds_read_b128 a[76:79], v116 offset:35840
  v_mfma_f32_16x16x32_bf16 v[140:143], a[128:131], v[244:247], v[140:143]
  v_mfma_f32_16x16x32_bf16 v[140:143], a[136:139], v[32:35], v[140:143]
  ds_read_b128 a[80:83], v116 offset:36864
  v_mfma_f32_16x16x32_bf16 v[140:143], a[144:147], v[40:43], v[140:143]
  ds_read_b128 a[84:87], v116 offset:37888
  v_mfma_f32_16x16x32_bf16 v[140:143], a[152:155], v[48:51], v[140:143]
  v_mfma_f32_16x16x32_bf16 v[140:143], a[160:163], v[56:59], v[140:143]
  buffer_load_dwordx4 v3, s[8:11], s38 offen offset:1024 sc1 lds
  v_mfma_f32_16x16x32_bf16 v[152:155], a[132:135], v[240:243], v[152:155]
  ds_read_b128 a[88:91], v116 offset:38912
  v_mfma_f32_16x16x32_bf16 v[152:155], a[140:143], v[4:7], v[152:155]
  ds_read_b128 a[92:95], v116 offset:39936
  v_mfma_f32_16x16x32_bf16 v[152:155], a[148:151], v[12:15], v[152:155]
  ds_read_b128 a[96:99], v116 offset:40960
  v_mfma_f32_16x16x32_bf16 v[152:155], a[156:159], v[20:23], v[152:155]
  v_mfma_f32_16x16x32_bf16 v[152:155], a[164:167], v[28:31], v[152:155]
  ds_read_b128 a[100:103], v116 offset:41984
  v_mfma_f32_16x16x32_bf16 v[156:159], a[132:135], v[244:247], v[156:159]
  ds_read_b128 a[104:107], v116 offset:43008
  v_mfma_f32_16x16x32_bf16 v[156:159], a[140:143], v[32:35], v[156:159]
  buffer_load_dwordx4 v3, s[8:11], s38 offen offset:2048 sc1 lds
  v_mfma_f32_16x16x32_bf16 v[156:159], a[148:151], v[40:43], v[156:159]
  ds_read_b128 a[108:111], v116 offset:44032
  v_mfma_f32_16x16x32_bf16 v[156:159], a[156:159], v[48:51], v[156:159]
  ds_read_b128 a[112:115], v116 offset:45056
  v_mfma_f32_16x16x32_bf16 v[156:159], a[164:167], v[56:59], v[156:159]
  v_mfma_f32_16x16x32_bf16 v[168:171], a[168:171], v[128:131], 0
  ds_read_b128 a[116:119], v116 offset:46080
  v_mfma_f32_16x16x32_bf16 v[168:171], a[176:179], v[144:147], v[168:171]
  ds_read_b128 a[120:123], v116 offset:47104
  v_mfma_f32_16x16x32_bf16 v[168:171], a[184:187], v[160:163], v[168:171]
  v_mfma_f32_16x16x32_bf16 v[172:175], a[168:171], v[132:135], 0
  buffer_load_dwordx4 v3, s[8:11], s38 offen offset:3072 sc1 lds
  v_mfma_f32_16x16x32_bf16 v[172:175], a[176:179], v[148:151], v[172:175]
  ds_read_b128 a[124:127], v116 offset:48128
  v_cvt_pk_bf16_f32 v136, v136, v137
  v_mfma_f32_16x16x32_bf16 v[172:175], a[184:187], v[164:167], v[172:175]
  v_cvt_pk_bf16_f32 v137, v138, v139
  v_xor_b32 v116, 0x10000, v116
  v_mfma_f32_16x16x32_bf16 v[184:187], a[172:175], v[128:131], 0
  v_cvt_pk_bf16_f32 v138, v152, v153
  v_cvt_pk_bf16_f32 v139, v154, v155
  v_mfma_f32_16x16x32_bf16 v[184:187], a[180:183], v[144:147], v[184:187]
  v_and_b32 v136, -2, v136
  v_mfma_f32_16x16x32_bf16 v[184:187], a[188:191], v[160:163], v[184:187]
  buffer_store_dwordx4 v[136:139], v2, s[28:31], s66 offen offset:0 sc1
  v_mfma_f32_16x16x32_bf16 v[188:191], a[172:175], v[132:135], 0
  v_mfma_f32_16x16x32_bf16 v[188:191], a[180:183], v[148:151], v[188:191]
  v_mfma_f32_16x16x32_bf16 v[188:191], a[188:191], v[164:167], v[188:191]
  s_waitcnt vmcnt(17)
  s_waitcnt lgkmcnt(0)
  s_barrier
  v_mfma_f32_16x16x32_bf16 v[168:171], a[64:67], v[176:179], v[168:171]
  ds_read_b128 a[128:131], v116 offset:16384
  v_mfma_f32_16x16x32_bf16 v[168:171], a[72:75], v[192:195], v[168:171]
  s_add_u32 m0, s77, 0xc000
  ds_read_b128 a[132:135], v116 offset:17408
  v_mfma_f32_16x16x32_bf16 v[168:171], a[80:83], v[208:211], v[168:171]
  buffer_load_dwordx4 v3, s[12:15], s39 offen offset:0 sc1 lds
  v_mfma_f32_16x16x32_bf16 v[168:171], a[88:91], v[224:227], v[168:171]
  ds_read_b128 a[136:139], v116 offset:18432
  v_mfma_f32_16x16x32_bf16 v[168:171], a[96:99], v[240:243], v[168:171]
  ds_read_b128 a[140:143], v116 offset:19456
  v_mfma_f32_16x16x32_bf16 v[168:171], a[104:107], v[4:7], v[168:171]
  v_mfma_f32_16x16x32_bf16 v[168:171], a[112:115], v[12:15], v[168:171]
  ds_read_b128 a[144:147], v116 offset:20480
  v_mfma_f32_16x16x32_bf16 v[168:171], a[120:123], v[20:23], v[168:171]
  ds_read_b128 a[148:151], v116 offset:21504
  v_mfma_f32_16x16x32_bf16 v[172:175], a[64:67], v[180:183], v[172:175]
  v_mfma_f32_16x16x32_bf16 v[172:175], a[72:75], v[196:199], v[172:175]
  buffer_load_dwordx4 v3, s[12:15], s39 offen offset:1024 sc1 lds
  v_mfma_f32_16x16x32_bf16 v[172:175], a[80:83], v[212:215], v[172:175]
  ds_read_b128 a[152:155], v116 offset:22528
  v_mfma_f32_16x16x32_bf16 v[172:175], a[88:91], v[228:231], v[172:175]
  ds_read_b128 a[156:159], v116 offset:23552
  v_mfma_f32_16x16x32_bf16 v[172:175], a[96:99], v[244:247], v[172:175]
  ds_read_b128 a[160:163], v116 offset:24576
  v_mfma_f32_16x16x32_bf16 v[172:175], a[104:107], v[32:35], v[172:175]
  v_mfma_f32_16x16x32_bf16 v[172:175], a[112:115], v[40:43], v[172:175]
  ds_read_b128 a[164:167], v116 offset:25600
  v_mfma_f32_16x16x32_bf16 v[172:175], a[120:123], v[48:51], v[172:175]
  ds_read_b128 a[168:171], v116 offset:26624
  v_mfma_f32_16x16x32_bf16 v[184:187], a[68:71], v[176:179], v[184:187]
  buffer_load_dwordx4 v3, s[12:15], s39 offen offset:2048 sc1 lds
  v_cvt_pk_bf16_f32 v140, v140, v141
  v_mfma_f32_16x16x32_bf16 v[184:187], a[76:79], v[192:195], v[184:187]
  ds_read_b128 a[172:175], v116 offset:27648
  v_cvt_pk_bf16_f32 v141, v142, v143
  v_mfma_f32_16x16x32_bf16 v[184:187], a[84:87], v[208:211], v[184:187]
  ds_read_b128 a[176:179], v116 offset:28672
  v_cvt_pk_bf16_f32 v142, v156, v157
  v_mfma_f32_16x16x32_bf16 v[184:187], a[92:95], v[224:227], v[184:187]
  v_cvt_pk_bf16_f32 v143, v158, v159
  v_and_b32 v140, -2, v140
  v_mfma_f32_16x16x32_bf16 v[184:187], a[100:103], v[240:243], v[184:187]
  buffer_store_dwordx4 v[140:143], v2, s[28:31], s66 offen offset:1024 sc1
  v_mfma_f32_16x16x32_bf16 v[184:187], a[108:111], v[4:7], v[184:187]
  ds_read_b128 a[180:183], v116 offset:29696
  v_mfma_f32_16x16x32_bf16 v[184:187], a[116:119], v[12:15], v[184:187]
  ds_read_b128 a[184:187], v116 offset:30720
  v_mfma_f32_16x16x32_bf16 v[184:187], a[124:127], v[20:23], v[184:187]
  buffer_load_dwordx4 v3, s[12:15], s39 offen offset:3072 sc1 lds
  v_mfma_f32_16x16x32_bf16 v[188:191], a[68:71], v[180:183], v[188:191]
  s_add_u32 s39, s38, 0x4000
  ds_read_b128 a[188:191], v116 offset:31744
  v_mfma_f32_16x16x32_bf16 v[188:191], a[76:79], v[196:199], v[188:191]
  s_cmp_eq_u32 s39, s3
  s_cselect_b32 s39, s76, s39
  s_add_u32 m0, s77, 0x8000
  v_mfma_f32_16x16x32_bf16 v[188:191], a[84:87], v[212:215], v[188:191]
  v_mfma_f32_16x16x32_bf16 v[188:191], a[92:95], v[228:231], v[188:191]
  v_mfma_f32_16x16x32_bf16 v[188:191], a[100:103], v[244:247], v[188:191]
  v_mfma_f32_16x16x32_bf16 v[188:191], a[108:111], v[32:35], v[188:191]
  v_mfma_f32_16x16x32_bf16 v[188:191], a[116:119], v[40:43], v[188:191]
  v_mfma_f32_16x16x32_bf16 v[188:191], a[124:127], v[48:51], v[188:191]
  s_waitcnt lgkmcnt(0)
  v_mfma_f32_16x16x32_bf16 v[168:171], a[128:131], v[28:31], v[168:171]
  ds_read_b128 a[64:67], v116 offset:0
  v_mfma_f32_16x16x32_bf16 v[172:175], a[128:131], v[56:59], v[172:175]
  ds_read_b128 a[68:71], v116 offset:1024
  v_mfma_f32_16x16x32_bf16 v[184:187], a[132:135], v[28:31], v[184:187]
  buffer_load_dwordx4 v3, s[8:11], s39 offen offset:0 sc1 lds
  v_mfma_f32_16x16x32_bf16 v[188:191], a[132:135], v[56:59], v[188:191]
  ds_read_b128 a[72:75], v116 offset:2048
  v_mfma_f32_16x16x32_bf16 v[200:203], a[136:139], v[128:131], 0
  ds_read_b128 a[76:79], v116 offset:3072
  v_mfma_f32_16x16x32_bf16 v[200:203], a[144:147], v[144:147], v[200:203]
  v_mfma_f32_16x16x32_bf16 v[200:203], a[152:155], v[160:163], v[200:203]
  ds_read_b128 a[80:83], v116 offset:4096
  v_mfma_f32_16x16x32_bf16 v[200:203], a[160:163], v[176:179], v[200:203]
  ds_read_b128 a[84:87], v116 offset:5120
  v_mfma_f32_16x16x32_bf16 v[200:203], a[168:171], v[192:195], v[200:203]
  v_cvt_pk_bf16_f32 v168, v168, v169
  v_cvt_pk_bf16_f32 v169, v170, v171
  v_mfma_f32_16x16x32_bf16 v[200:203], a[176:179], v[208:211], v[200:203]
  buffer_load_dwordx4 v3, s[8:11], s39 offen offset:1024 sc1 lds
  v_cvt_pk_bf16_f32 v170, v184, v185
  v_mfma_f32_16x16x32_bf16 v[200:203], a[184:187], v[224:227], v[200:203]
  ds_read_b128 a[88:91], v116 offset:6144
  v_cvt_pk_bf16_f32 v171, v186, v187
  v_mfma_f32_16x16x32_bf16 v[204:207], a[136:139], v[132:135], 0
  ds_read_b128 a[92:95], v116 offset:7168
  v_and_b32 v168, -2, v168
  v_mfma_f32_16x16x32_bf16 v[204:207], a[144:147], v[148:151], v[204:207]
  s_add_u32 s66, s66, 0x10000
  ds_read_b128 a[96:99], v116 offset:8192
  v_mfma_f32_16x16x32_bf16 v[204:207], a[152:155], v[164:167], v[204:207]
  buffer_store_dwordx4 v[168:171], v2, s[28:31], s66 offen offset:0 sc1
  v_mfma_f32_16x16x32_bf16 v[204:207], a[160:163], v[180:183], v[204:207]
  ds_read_b128 a[100:103], v116 offset:9216
  v_mfma_f32_16x16x32_bf16 v[204:207], a[168:171], v[196:199], v[204:207]
  ds_read_b128 a[104:107], v116 offset:10240
  v_mfma_f32_16x16x32_bf16 v[204:207], a[176:179], v[212:215], v[204:207]
  buffer_load_dwordx4 v3, s[8:11], s39 offen offset:2048 sc1 lds
  v_mfma_f32_16x16x32_bf16 v[204:207], a[184:187], v[228:231], v[204:207]
  ds_read_b128 a[108:111], v116 offset:11264
  v_mfma_f32_16x16x32_bf16 v[216:219], a[140:143], v[128:131], 0
  ds_read_b128 a[112:115], v116 offset:12288
  v_mfma_f32_16x16x32_bf16 v[216:219], a[148:151], v[144:147], v[216:219]
  v_mfma_f32_16x16x32_bf16 v[216:219], a[156:159], v[160:163], v[216:219]
  ds_read_b128 a[116:119], v116 offset:13312
  v_mfma_f32_16x16x32_bf16 v[216:219], a[164:167], v[176:179], v[216:219]
  ds_read_b128 a[120:123], v116 offset:14336
  v_mfma_f32_16x16x32_bf16 v[216:219], a[172:175], v[192:195], v[216:219]
  v_mfma_f32_16x16x32_bf16 v[216:219], a[180:183], v[208:211], v[216:219]
  buffer_load_dwordx4 v3, s[8:11], s39 offen offset:3072 sc1 lds
  v_mfma_f32_16x16x32_bf16 v[216:219], a[188:191], v[224:227], v[216:219]
  s_xor_b32 s77, s77, 0x10000
  ds_read_b128 a[124:127], v116 offset:15360
  v_mfma_f32_16x16x32_bf16 v[220:223], a[140:143], v[132:135], 0
  v_mfma_f32_16x16x32_bf16 v[220:223], a[148:151], v[148:151], v[220:223]
  v_mfma_f32_16x16x32_bf16 v[220:223], a[156:159], v[164:167], v[220:223]
  v_mfma_f32_16x16x32_bf16 v[220:223], a[164:167], v[180:183], v[220:223]
  v_mfma_f32_16x16x32_bf16 v[220:223], a[172:175], v[196:199], v[220:223]
  v_mfma_f32_16x16x32_bf16 v[220:223], a[180:183], v[212:215], v[220:223]
  v_mfma_f32_16x16x32_bf16 v[220:223], a[188:191], v[228:231], v[220:223]
  s_waitcnt vmcnt(19)
  s_waitcnt lgkmcnt(0)
  s_barrier
  v_mfma_f32_16x16x32_bf16 v[200:203], a[64:67], v[240:243], v[200:203]
  ds_read_b128 a[128:131], v116 offset:49152
  v_cvt_pk_bf16_f32 v172, v172, v173
  v_mfma_f32_16x16x32_bf16 v[200:203], a[72:75], v[4:7], v[200:203]
  s_add_u32 m0, s77, 0x4000
  ds_read_b128 a[132:135], v116 offset:50176
  v_cvt_pk_bf16_f32 v173, v174, v175
  v_mfma_f32_16x16x32_bf16 v[200:203], a[80:83], v[12:15], v[200:203]
  buffer_load_dwordx4 v3, s[12:15], s38 offen offset:0 sc1 lds
  v_cvt_pk_bf16_f32 v174, v188, v189
  v_mfma_f32_16x16x32_bf16 v[200:203], a[88:91], v[20:23], v[200:203]
  ds_read_b128 a[136:139], v116 offset:51200
  v_cvt_pk_bf16_f32 v175, v190, v191
  v_mfma_f32_16x16x32_bf16 v[200:203], a[96:99], v[28:31], v[200:203]
  ds_read_b128 a[140:143], v116 offset:52224
  v_and_b32 v172, -2, v172
  v_mfma_f32_16x16x32_bf16 v[204:207], a[64:67], v[244:247], v[204:207]
  buffer_store_dwordx4 v[172:175], v2, s[28:31], s66 offen offset:1024 sc1
  v_mfma_f32_16x16x32_bf16 v[204:207], a[72:75], v[32:35], v[204:207]
  ds_read_b128 a[144:147], v116 offset:53248
  v_mfma_f32_16x16x32_bf16 v[204:207], a[80:83], v[40:43], v[204:207]
  ds_read_b128 a[148:151], v116 offset:54272
  v_mfma_f32_16x16x32_bf16 v[204:207], a[88:91], v[48:51], v[204:207]
  v_mfma_f32_16x16x32_bf16 v[204:207], a[96:99], v[56:59], v[204:207]
  buffer_load_dwordx4 v3, s[12:15], s38 offen offset:1024 sc1 lds
  v_mfma_f32_16x16x32_bf16 v[216:219], a[68:71], v[240:243], v[216:219]
  ds_read_b128 a[152:155], v116 offset:55296
  v_mfma_f32_16x16x32_bf16 v[216:219], a[76:79], v[4:7], v[216:219]
  ds_read_b128 a[156:159], v116 offset:56320
  v_mfma_f32_16x16x32_bf16 v[216:219], a[84:87], v[12:15], v[216:219]
  ds_read_b128 a[160:163], v116 offset:57344
  v_mfma_f32_16x16x32_bf16 v[216:219], a[92:95], v[20:23], v[216:219]
  v_mfma_f32_16x16x32_bf16 v[216:219], a[100:103], v[28:31], v[216:219]
  ds_read_b128 a[164:167], v116 offset:58368
  v_mfma_f32_16x16x32_bf16 v[220:223], a[68:71], v[244:247], v[220:223]
  ds_read_b128 a[168:171], v116 offset:59392
  v_mfma_f32_16x16x32_bf16 v[220:223], a[76:79], v[32:35], v[220:223]
  buffer_load_dwordx4 v3, s[12:15], s38 offen offset:2048 sc1 lds
  v_mfma_f32_16x16x32_bf16 v[220:223], a[84:87], v[40:43], v[220:223]
  ds_read_b128 a[172:175], v116 offset:60416
  v_mfma_f32_16x16x32_bf16 v[220:223], a[92:95], v[48:51], v[220:223]
  ds_read_b128 a[176:179], v116 offset:61440
  v_mfma_f32_16x16x32_bf16 v[220:223], a[100:103], v[56:59], v[220:223]
  v_mfma_f32_16x16x32_bf16 v[232:235], a[104:107], v[128:131], 0
  ds_read_b128 a[180:183], v116 offset:62464
  v_mfma_f32_16x16x32_bf16 v[232:235], a[112:115], v[144:147], v[232:235]
  ds_read_b128 a[184:187], v116 offset:63488
  v_mfma_f32_16x16x32_bf16 v[232:235], a[120:123], v[160:163], v[232:235]
  v_mfma_f32_16x16x32_bf16 v[236:239], a[104:107], v[132:135], 0
  buffer_load_dwordx4 v3, s[12:15], s38 offen offset:3072 sc1 lds
  v_mfma_f32_16x16x32_bf16 v[236:239], a[112:115], v[148:151], v[236:239]
  s_add_u32 s38, s39, 0x4000
  ds_read_b128 a[188:191], v116 offset:64512
  v_cvt_pk_bf16_f32 v200, v200, v201
  v_mfma_f32_16x16x32_bf16 v[236:239], a[120:123], v[164:167], v[236:239]
  s_cmp_eq_u32 s38, s3
  s_cselect_b32 s38, s76, s38
  s_mov_b32 m0, s77
  v_mfma_f32_16x16x32_bf16 v[248:251], a[108:111], v[128:131], 0
  v_cvt_pk_bf16_f32 v201, v202, v203
  v_cvt_pk_bf16_f32 v202, v216, v217
  v_mfma_f32_16x16x32_bf16 v[248:251], a[116:119], v[144:147], v[248:251]
  v_cvt_pk_bf16_f32 v203, v218, v219
  v_and_b32 v200, -2, v200
  v_mfma_f32_16x16x32_bf16 v[248:251], a[124:127], v[160:163], v[248:251]
  s_add_u32 s66, s66, 0x10000
  buffer_store_dwordx4 v[200:203], v2, s[28:31], s66 offen offset:0 sc1
  v_mfma_f32_16x16x32_bf16 v[252:255], a[108:111], v[132:135], 0
  v_mfma_f32_16x16x32_bf16 v[252:255], a[116:119], v[148:151], v[252:255]
  v_mfma_f32_16x16x32_bf16 v[252:255], a[124:127], v[164:167], v[252:255]
  s_waitcnt lgkmcnt(0)
  v_mfma_f32_16x16x32_bf16 v[232:235], a[128:131], v[176:179], v[232:235]
  ds_read_b128 a[64:67], v116 offset:32768
  v_mfma_f32_16x16x32_bf16 v[232:235], a[136:139], v[192:195], v[232:235]
  ds_read_b128 a[68:71], v116 offset:33792
  v_mfma_f32_16x16x32_bf16 v[232:235], a[144:147], v[208:211], v[232:235]
  buffer_load_dwordx4 v3, s[8:11], s38 offen offset:0 sc1 lds
  v_mfma_f32_16x16x32_bf16 v[232:235], a[152:155], v[224:227], v[232:235]
  ds_read_b128 a[72:75], v116 offset:34816
  v_mfma_f32_16x16x32_bf16 v[232:235], a[160:163], v[240:243], v[232:235]
  ds_read_b128 a[76:79], v116 offset:35840
  v_mfma_f32_16x16x32_bf16 v[232:235], a[168:171], v[4:7], v[232:235]
  v_mfma_f32_16x16x32_bf16 v[232:235], a[176:179], v[12:15], v[232:235]
  ds_read_b128 a[80:83], v116 offset:36864
  v_mfma_f32_16x16x32_bf16 v[232:235], a[184:187], v[20:23], v[232:235]
  ds_read_b128 a[84:87], v116 offset:37888
  v_mfma_f32_16x16x32_bf16 v[236:239], a[128:131], v[180:183], v[236:239]
  v_mfma_f32_16x16x32_bf16 v[236:239], a[136:139], v[196:199], v[236:239]
  buffer_load_dwordx4 v3, s[8:11], s38 offen offset:1024 sc1 lds
  v_mfma_f32_16x16x32_bf16 v[236:239], a[144:147], v[212:215], v[236:239]
  ds_read_b128 a[88:91], v116 offset:38912
  v_mfma_f32_16x16x32_bf16 v[236:239], a[152:155], v[228:231], v[236:239]
  ds_read_b128 a[92:95], v116 offset:39936
  v_mfma_f32_16x16x32_bf16 v[236:239], a[160:163], v[244:247], v[236:239]
  ds_read_b128 a[96:99], v116 offset:40960
  v_mfma_f32_16x16x32_bf16 v[236:239], a[168:171], v[32:35], v[236:239]
  v_mfma_f32_16x16x32_bf16 v[236:239], a[176:179], v[40:43], v[236:239]
  ds_read_b128 a[100:103], v116 offset:41984
  v_mfma_f32_16x16x32_bf16 v[236:239], a[184:187], v[48:51], v[236:239]
  ds_read_b128 a[104:107], v116 offset:43008
  v_mfma_f32_16x16x32_bf16 v[248:251], a[132:135], v[176:179], v[248:251]
  buffer_load_dwordx4 v3, s[8:11], s38 offen offset:2048 sc1 lds
  v_cvt_pk_bf16_f32 v204, v204, v205
  v_mfma_f32_16x16x32_bf16 v[248:251], a[140:143], v[192:195], v[248:251]
  ds_read_b128 a[108:111], v116 offset:44032
  v_cvt_pk_bf16_f32 v205, v206, v207
  v_mfma_f32_16x16x32_bf16 v[248:251], a[148:151], v[208:211], v[248:251]
  ds_read_b128 a[112:115], v116 offset:45056
  v_cvt_pk_bf16_f32 v206, v220, v221
  v_mfma_f32_16x16x32_bf16 v[248:251], a[156:159], v[224:227], v[248:251]
  v_cvt_pk_bf16_f32 v207, v222, v223
  v_and_b32 v204, -2, v204
  v_mfma_f32_16x16x32_bf16 v[248:251], a[164:167], v[240:243], v[248:251]
  buffer_store_dwordx4 v[204:207], v2, s[28:31], s66 offen offset:1024 sc1
  v_mfma_f32_16x16x32_bf16 v[248:251], a[172:175], v[4:7], v[248:251]
  ds_read_b128 a[116:119], v116 offset:46080
  v_mfma_f32_16x16x32_bf16 v[248:251], a[180:183], v[12:15], v[248:251]
  ds_read_b128 a[120:123], v116 offset:47104
  v_mfma_f32_16x16x32_bf16 v[248:251], a[188:191], v[20:23], v[248:251]
  buffer_load_dwordx4 v3, s[8:11], s38 offen offset:3072 sc1 lds
  v_mfma_f32_16x16x32_bf16 v[252:255], a[132:135], v[180:183], v[252:255]
  ds_read_b128 a[124:127], v116 offset:48128
  v_mfma_f32_16x16x32_bf16 v[252:255], a[140:143], v[196:199], v[252:255]
  v_xor_b32 v116, 0x10000, v116
  v_mfma_f32_16x16x32_bf16 v[252:255], a[148:151], v[212:215], v[252:255]
  v_mfma_f32_16x16x32_bf16 v[252:255], a[156:159], v[228:231], v[252:255]
  v_mfma_f32_16x16x32_bf16 v[252:255], a[164:167], v[244:247], v[252:255]
  v_mfma_f32_16x16x32_bf16 v[252:255], a[172:175], v[32:35], v[252:255]
  v_mfma_f32_16x16x32_bf16 v[252:255], a[180:183], v[40:43], v[252:255]
  v_mfma_f32_16x16x32_bf16 v[252:255], a[188:191], v[48:51], v[252:255]
  s_waitcnt vmcnt(22)
  s_waitcnt lgkmcnt(0)
  s_barrier
  v_mfma_f32_16x16x32_bf16 v[232:235], a[64:67], v[28:31], v[232:235]
  ds_read_b128 a[128:131], v116 offset:16384
  v_mfma_f32_16x16x32_bf16 v[236:239], a[64:67], v[56:59], v[236:239]
  s_add_u32 m0, s77, 0xc000
  ds_read_b128 a[132:135], v116 offset:17408
  v_mfma_f32_16x16x32_bf16 v[248:251], a[68:71], v[28:31], v[248:251]
  buffer_load_dwordx4 v3, s[12:15], s39 offen offset:0 sc1 lds
  v_mfma_f32_16x16x32_bf16 v[252:255], a[68:71], v[56:59], v[252:255]
  ds_read_b128 a[136:139], v116 offset:18432
  v_mfma_f32_16x16x32_bf16 v[8:11], a[72:75], v[128:131], 0
  ds_read_b128 a[140:143], v116 offset:19456
  v_mfma_f32_16x16x32_bf16 v[8:11], a[80:83], v[144:147], v[8:11]
  v_mfma_f32_16x16x32_bf16 v[8:11], a[88:91], v[160:163], v[8:11]
  ds_read_b128 a[144:147], v116 offset:20480
  v_mfma_f32_16x16x32_bf16 v[8:11], a[96:99], v[176:179], v[8:11]
  ds_read_b128 a[148:151], v116 offset:21504
  v_mfma_f32_16x16x32_bf16 v[8:11], a[104:107], v[192:195], v[8:11]
  v_cvt_pk_bf16_f32 v232, v232, v233
  v_cvt_pk_bf16_f32 v233, v234, v235
  v_mfma_f32_16x16x32_bf16 v[8:11], a[112:115], v[208:211], v[8:11]
  buffer_load_dwordx4 v3, s[12:15], s39 offen offset:1024 sc1 lds
  v_cvt_pk_bf16_f32 v234, v248, v249
  v_mfma_f32_16x16x32_bf16 v[8:11], a[120:123], v[224:227], v[8:11]
  ds_read_b128 a[152:155], v116 offset:22528
  v_cvt_pk_bf16_f32 v235, v250, v251
  v_mfma_f32_16x16x32_bf16 v[16:19], a[72:75], v[132:135], 0
  ds_read_b128 a[156:159], v116 offset:23552
  v_and_b32 v232, -2, v232
  v_mfma_f32_16x16x32_bf16 v[16:19], a[80:83], v[148:151], v[16:19]
  s_add_u32 s66, s66, 0x10000
  ds_read_b128 a[160:163], v116 offset:24576
  v_mfma_f32_16x16x32_bf16 v[16:19], a[88:91], v[164:167], v[16:19]
  buffer_store_dwordx4 v[232:235], v2, s[28:31], s66 offen offset:0 sc1
  v_mfma_f32_16x16x32_bf16 v[16:19], a[96:99], v[180:183], v[16:19]
  ds_read_b128 a[164:167], v116 offset:25600
  v_mfma_f32_16x16x32_bf16 v[16:19], a[104:107], v[196:199], v[16:19]
  ds_read_b128 a[168:171], v116 offset:26624
  v_mfma_f32_16x16x32_bf16 v[16:19], a[112:115], v[212:215], v[16:19]
  buffer_load_dwordx4 v3, s[12:15], s39 offen offset:2048 sc1 lds
  v_mfma_f32_16x16x32_bf16 v[16:19], a[120:123], v[228:231], v[16:19]
  ds_read_b128 a[172:175], v116 offset:27648
  v_mfma_f32_16x16x32_bf16 v[24:27], a[76:79], v[128:131], 0
  ds_read_b128 a[176:179], v116 offset:28672
  v_mfma_f32_16x16x32_bf16 v[24:27], a[84:87], v[144:147], v[24:27]
  v_mfma_f32_16x16x32_bf16 v[24:27], a[92:95], v[160:163], v[24:27]
  ds_read_b128 a[180:183], v116 offset:29696
  v_mfma_f32_16x16x32_bf16 v[24:27], a[100:103], v[176:179], v[24:27]
  ds_read_b128 a[184:187], v116 offset:30720
  v_mfma_f32_16x16x32_bf16 v[24:27], a[108:111], v[192:195], v[24:27]
  v_mfma_f32_16x16x32_bf16 v[24:27], a[116:119], v[208:211], v[24:27]
  buffer_load_dwordx4 v3, s[12:15], s39 offen offset:3072 sc1 lds
  v_mfma_f32_16x16x32_bf16 v[24:27], a[124:127], v[224:227], v[24:27]
  s_add_u32 s39, s38, 0x4000
  ds_read_b128 a[188:191], v116 offset:31744
  v_mfma_f32_16x16x32_bf16 v[36:39], a[76:79], v[132:135], 0
  s_cmp_eq_u32 s39, s3
  s_cselect_b32 s39, s76, s39
  s_add_u32 m0, s77, 0x8000
  v_mfma_f32_16x16x32_bf16 v[36:39], a[84:87], v[148:151], v[36:39]
  v_mfma_f32_16x16x32_bf16 v[36:39], a[92:95], v[164:167], v[36:39]
  v_mfma_f32_16x16x32_bf16 v[36:39], a[100:103], v[180:183], v[36:39]
  v_mfma_f32_16x16x32_bf16 v[36:39], a[108:111], v[196:199], v[36:39]
  v_mfma_f32_16x16x32_bf16 v[36:39], a[116:119], v[212:215], v[36:39]
  v_mfma_f32_16x16x32_bf16 v[36:39], a[124:127], v[228:231], v[36:39]
  s_waitcnt lgkmcnt(0)
  v_mfma_f32_16x16x32_bf16 v[8:11], a[128:131], v[240:243], v[8:11]
  ds_read_b128 a[64:67], v116 offset:0
  v_cvt_pk_bf16_f32 v236, v236, v237
  v_mfma_f32_16x16x32_bf16 v[8:11], a[136:139], v[4:7], v[8:11]
  ds_read_b128 a[68:71], v116 offset:1024
  v_cvt_pk_bf16_f32 v237, v238, v239
  v_mfma_f32_16x16x32_bf16 v[8:11], a[144:147], v[12:15], v[8:11]
  buffer_load_dwordx4 v3, s[8:11], s39 offen offset:0 sc1 lds
  v_cvt_pk_bf16_f32 v238, v252, v253
  v_mfma_f32_16x16x32_bf16 v[8:11], a[152:155], v[20:23], v[8:11]
  ds_read_b128 a[72:75], v116 offset:2048
  v_cvt_pk_bf16_f32 v239, v254, v255
  v_mfma_f32_16x16x32_bf16 v[8:11], a[160:163], v[28:31], v[8:11]
  ds_read_b128 a[76:79], v116 offset:3072
  v_and_b32 v236, -2, v236
  v_mfma_f32_16x16x32_bf16 v[16:19], a[128:131], v[244:247], v[16:19]
  buffer_store_dwordx4 v[236:239], v2, s[28:31], s66 offen offset:1024 sc1
  v_mfma_f32_16x16x32_bf16 v[16:19], a[136:139], v[32:35], v[16:19]
  ds_read_b128 a[80:83], v116 offset:4096
  v_mfma_f32_16x16x32_bf16 v[16:19], a[144:147], v[40:43], v[16:19]
  ds_read_b128 a[84:87], v116 offset:5120
  v_mfma_f32_16x16x32_bf16 v[16:19], a[152:155], v[48:51], v[16:19]
  v_mfma_f32_16x16x32_bf16 v[16:19], a[160:163], v[56:59], v[16:19]
  buffer_load_dwordx4 v3, s[8:11], s39 offen offset:1024 sc1 lds
  v_mfma_f32_16x16x32_bf16 v[24:27], a[132:135], v[240:243], v[24:27]
  ds_read_b128 a[88:91], v116 offset:6144
  v_mfma_f32_16x16x32_bf16 v[24:27], a[140:143], v[4:7], v[24:27]
  ds_read_b128 a[92:95], v116 offset:7168
  v_mfma_f32_16x16x32_bf16 v[24:27], a[148:151], v[12:15], v[24:27]
  ds_read_b128 a[96:99], v116 offset:8192
  v_mfma_f32_16x16x32_bf16 v[24:27], a[156:159], v[20:23], v[24:27]
  v_mfma_f32_16x16x32_bf16 v[24:27], a[164:167], v[28:31], v[24:27]
  ds_read_b128 a[100:103], v116 offset:9216
  v_mfma_f32_16x16x32_bf16 v[36:39], a[132:135], v[244:247], v[36:39]
  ds_read_b128 a[104:107], v116 offset:10240
  v_mfma_f32_16x16x32_bf16 v[36:39], a[140:143], v[32:35], v[36:39]
  buffer_load_dwordx4 v3, s[8:11], s39 offen offset:2048 sc1 lds
  v_mfma_f32_16x16x32_bf16 v[36:39], a[148:151], v[40:43], v[36:39]
  ds_read_b128 a[108:111], v116 offset:11264
  v_mfma_f32_16x16x32_bf16 v[36:39], a[156:159], v[48:51], v[36:39]
  ds_read_b128 a[112:115], v116 offset:12288
  v_mfma_f32_16x16x32_bf16 v[36:39], a[164:167], v[56:59], v[36:39]
  v_mfma_f32_16x16x32_bf16 v[44:47], a[168:171], v[128:131], 0
  ds_read_b128 a[116:119], v116 offset:13312
  v_mfma_f32_16x16x32_bf16 v[44:47], a[176:179], v[144:147], v[44:47]
  ds_read_b128 a[120:123], v116 offset:14336
  v_mfma_f32_16x16x32_bf16 v[44:47], a[184:187], v[160:163], v[44:47]
  v_mfma_f32_16x16x32_bf16 v[52:55], a[168:171], v[132:135], 0
  buffer_load_dwordx4 v3, s[8:11], s39 offen offset:3072 sc1 lds
  v_mfma_f32_16x16x32_bf16 v[52:55], a[176:179], v[148:151], v[52:55]
  s_xor_b32 s77, s77, 0x10000
  ds_read_b128 a[124:127], v116 offset:15360
  v_cvt_pk_bf16_f32 v8, v8, v9
  v_mfma_f32_16x16x32_bf16 v[52:55], a[184:187], v[164:167], v[52:55]
  v_cvt_pk_bf16_f32 v9, v10, v11
  v_cvt_pk_bf16_f32 v10, v24, v25
  v_mfma_f32_16x16x32_bf16 v[60:63], a[172:175], v[128:131], 0
  v_cvt_pk_bf16_f32 v11, v26, v27
  v_and_b32 v8, -2, v8
  v_mfma_f32_16x16x32_bf16 v[60:63], a[180:183], v[144:147], v[60:63]
  s_add_u32 s66, s66, 0x10000
  buffer_store_dwordx4 v[8:11], v2, s[28:31], s66 offen offset:0 sc1
  v_mfma_f32_16x16x32_bf16 v[60:63], a[188:191], v[160:163], v[60:63]
  v_mfma_f32_16x16x32_bf16 v[64:67], a[172:175], v[132:135], 0
  v_mfma_f32_16x16x32_bf16 v[64:67], a[180:183], v[148:151], v[64:67]
  v_mfma_f32_16x16x32_bf16 v[64:67], a[188:191], v[164:167], v[64:67]
  s_waitcnt vmcnt(22)
  s_waitcnt lgkmcnt(0)
  s_waitcnt vmcnt(4)
  s_barrier
  s_cmp_lg_u32 s19, 0
  s_cbranch_scc1 Lk_sig93
  v_mov_b32 v120, 1
  s_mov_b64 exec, 1
  buffer_store_dword v120, off, s[20:23], s65 offset:64 sc1
  s_mov_b64 exec, -1
Lk_sig93:
  v_mfma_f32_16x16x32_bf16 v[44:47], a[64:67], v[176:179], v[44:47]
  ds_read_b128 a[128:131], v116 offset:49152
  v_mfma_f32_16x16x32_bf16 v[44:47], a[72:75], v[192:195], v[44:47]
  s_add_u32 m0, s77, 0x4000
  ds_read_b128 a[132:135], v116 offset:50176
  v_mfma_f32_16x16x32_bf16 v[44:47], a[80:83], v[208:211], v[44:47]
  buffer_load_dwordx4 v3, s[12:15], s38 offen offset:0 sc1 lds
  v_mfma_f32_16x16x32_bf16 v[44:47], a[88:91], v[224:227], v[44:47]
  ds_read_b128 a[136:139], v116 offset:51200
  v_mfma_f32_16x16x32_bf16 v[44:47], a[96:99], v[240:243], v[44:47]
  ds_read_b128 a[140:143], v116 offset:52224
  v_mfma_f32_16x16x32_bf16 v[44:47], a[104:107], v[4:7], v[44:47]
  v_mfma_f32_16x16x32_bf16 v[44:47], a[112:115], v[12:15], v[44:47]
  ds_read_b128 a[144:147], v116 offset:53248
  v_mfma_f32_16x16x32_bf16 v[44:47], a[120:123], v[20:23], v[44:47]
  ds_read_b128 a[148:151], v116 offset:54272
  v_mfma_f32_16x16x32_bf16 v[52:55], a[64:67], v[180:183], v[52:55]
  v_mfma_f32_16x16x32_bf16 v[52:55], a[72:75], v[196:199], v[52:55]
  buffer_load_dwordx4 v3, s[12:15], s38 offen offset:1024 sc1 lds
  v_mfma_f32_16x16x32_bf16 v[52:55], a[80:83], v[212:215], v[52:55]
  ds_read_b128 a[152:155], v116 offset:55296
  v_mfma_f32_16x16x32_bf16 v[52:55], a[88:91], v[228:231], v[52:55]
  ds_read_b128 a[156:159], v116 offset:56320
  v_mfma_f32_16x16x32_bf16 v[52:55], a[96:99], v[244:247], v[52:55]
  ds_read_b128 a[160:163], v116 offset:57344
  v_mfma_f32_16x16x32_bf16 v[52:55], a[104:107], v[32:35], v[52:55]
  v_mfma_f32_16x16x32_bf16 v[52:55], a[112:115], v[40:43], v[52:55]
  ds_read_b128 a[164:167], v116 offset:58368
  v_mfma_f32_16x16x32_bf16 v[52:55], a[120:123], v[48:51], v[52:55]
  ds_read_b128 a[168:171], v116 offset:59392
  v_mfma_f32_16x16x32_bf16 v[60:63], a[68:71], v[176:179], v[60:63]
  buffer_load_dwordx4 v3, s[12:15], s38 offen offset:2048 sc1 lds
  v_cvt_pk_bf16_f32 v16, v16, v17
  v_mfma_f32_16x16x32_bf16 v[60:63], a[76:79], v[192:195], v[60:63]
  ds_read_b128 a[172:175], v116 offset:60416
  v_cvt_pk_bf16_f32 v17, v18, v19
  v_mfma_f32_16x16x32_bf16 v[60:63], a[84:87], v[208:211], v[60:63]
  ds_read_b128 a[176:179], v116 offset:61440
  v_cvt_pk_bf16_f32 v18, v36, v37
  v_mfma_f32_16x16x32_bf16 v[60:63], a[92:95], v[224:227], v[60:63]
  v_cvt_pk_bf16_f32 v19, v38, v39
  v_and_b32 v16, -2, v16
  v_mfma_f32_16x16x32_bf16 v[60:63], a[100:103], v[240:243], v[60:63]
  buffer_store_dwordx4 v[16:19], v2, s[28:31], s66 offen offset:1024 sc1
  v_mfma_f32_16x16x32_bf16 v[60:63], a[108:111], v[4:7], v[60:63]
  ds_read_b128 a[180:183], v116 offset:62464
  v_mfma_f32_16x16x32_bf16 v[60:63], a[116:119], v[12:15], v[60:63]
  ds_read_b128 a[184:187], v116 offset:63488
  v_mfma_f32_16x16x32_bf16 v[60:63], a[124:127], v[20:23], v[60:63]
  buffer_load_dwordx4 v3, s[12:15], s38 offen offset:3072 sc1 lds
  v_mfma_f32_16x16x32_bf16 v[64:67], a[68:71], v[180:183], v[64:67]
  s_add_u32 s38, s39, 0x4000
  ds_read_b128 a[188:191], v116 offset:64512
  v_mfma_f32_16x16x32_bf16 v[64:67], a[76:79], v[196:199], v[64:67]
  s_cmp_eq_u32 s38, s3
  s_cselect_b32 s38, s76, s38
  s_mov_b32 m0, s77
  v_mfma_f32_16x16x32_bf16 v[64:67], a[84:87], v[212:215], v[64:67]
  v_mfma_f32_16x16x32_bf16 v[64:67], a[92:95], v[228:231], v[64:67]
  v_mfma_f32_16x16x32_bf16 v[64:67], a[100:103], v[244:247], v[64:67]
  v_mfma_f32_16x16x32_bf16 v[64:67], a[108:111], v[32:35], v[64:67]
  v_mfma_f32_16x16x32_bf16 v[64:67], a[116:119], v[40:43], v[64:67]
  v_mfma_f32_16x16x32_bf16 v[64:67], a[124:127], v[48:51], v[64:67]
  s_waitcnt lgkmcnt(0)
  v_mfma_f32_16x16x32_bf16 v[44:47], a[128:131], v[28:31], v[44:47]
  ds_read_b128 a[64:67], v116 offset:32768
  v_mfma_f32_16x16x32_bf16 v[52:55], a[128:131], v[56:59], v[52:55]
  ds_read_b128 a[68:71], v116 offset:33792
  v_mfma_f32_16x16x32_bf16 v[60:63], a[132:135], v[28:31], v[60:63]
  buffer_load_dwordx4 v3, s[8:11], s38 offen offset:0 sc1 lds
  v_mfma_f32_16x16x32_bf16 v[64:67], a[132:135], v[56:59], v[64:67]
  ds_read_b128 a[72:75], v116 offset:34816
  v_mfma_f32_16x16x32_bf16 v[136:139], a[136:139], v[128:131], 0
  ds_read_b128 a[76:79], v116 offset:35840
  v_mfma_f32_16x16x32_bf16 v[136:139], a[144:147], v[144:147], v[136:139]
  v_mfma_f32_16x16x32_bf16 v[136:139], a[152:155], v[160:163], v[136:139]
  ds_read_b128 a[80:83], v116 offset:36864
  v_mfma_f32_16x16x32_bf16 v[136:139], a[160:163], v[176:179], v[136:139]
  ds_read_b128 a[84:87], v116 offset:37888
  v_mfma_f32_16x16x32_bf16 v[136:139], a[168:171], v[192:195], v[136:139]
  v_cvt_pk_bf16_f32 v44, v44, v45
  v_cvt_pk_bf16_f32 v45, v46, v47
  v_mfma_f32_16x16x32_bf16 v[136:139], a[176:179], v[208:211], v[136:139]
  buffer_load_dwordx4 v3, s[8:11], s38 offen offset:1024 sc1 lds
  v_cvt_pk_bf16_f32 v46, v60, v61
  v_mfma_f32_16x16x32_bf16 v[136:139], a[184:187], v[224:227], v[136:139]
  ds_read_b128 a[88:91], v116 offset:38912
  v_cvt_pk_bf16_f32 v47, v62, v63
  v_mfma_f32_16x16x32_bf16 v[140:143], a[136:139], v[132:135], 0
  ds_read_b128 a[92:95], v116 offset:39936
  v_and_b32 v44, -2, v44
  v_mfma_f32_16x16x32_bf16 v[140:143], a[144:147], v[148:151], v[140:143]
  s_add_u32 s66, s66, 0x10000
  ds_read_b128 a[96:99], v116 offset:40960
  v_mfma_f32_16x16x32_bf16 v[140:143], a[152:155], v[164:167], v[140:143]
  buffer_store_dwordx4 v[44:47], v2, s[28:31], s66 offen offset:0 sc1
  v_mfma_f32_16x16x32_bf16 v[140:143], a[160:163], v[180:183], v[140:143]
  ds_read_b128 a[100:103], v116 offset:41984
  v_mfma_f32_16x16x32_bf16 v[140:143], a[168:171], v[196:199], v[140:143]
  ds_read_b128 a[104:107], v116 offset:43008
  v_mfma_f32_16x16x32_bf16 v[140:143], a[176:179], v[212:215], v[140:143]
  buffer_load_dwordx4 v3, s[8:11], s38 offen offset:2048 sc1 lds
  v_mfma_f32_16x16x32_bf16 v[140:143], a[184:187], v[228:231], v[140:143]
  ds_read_b128 a[108:111], v116 offset:44032
  v_mfma_f32_16x16x32_bf16 v[152:155], a[140:143], v[128:131], 0
  ds_read_b128 a[112:115], v116 offset:45056
  v_mfma_f32_16x16x32_bf16 v[152:155], a[148:151], v[144:147], v[152:155]
  v_mfma_f32_16x16x32_bf16 v[152:155], a[156:159], v[160:163], v[152:155]
  ds_read_b128 a[116:119], v116 offset:46080
  v_mfma_f32_16x16x32_bf16 v[152:155], a[164:167], v[176:179], v[152:155]
  ds_read_b128 a[120:123], v116 offset:47104
  v_mfma_f32_16x16x32_bf16 v[152:155], a[172:175], v[192:195], v[152:155]
  v_mfma_f32_16x16x32_bf16 v[152:155], a[180:183], v[208:211], v[152:155]
  buffer_load_dwordx4 v3, s[8:11], s38 offen offset:3072 sc1 lds
  v_mfma_f32_16x16x32_bf16 v[152:155], a[188:191], v[224:227], v[152:155]
  ds_read_b128 a[124:127], v116 offset:48128
  v_mfma_f32_16x16x32_bf16 v[156:159], a[140:143], v[132:135], 0
  v_xor_b32 v116, 0x10000, v116
  v_mfma_f32_16x16x32_bf16 v[156:159], a[148:151], v[148:151], v[156:159]
  v_mfma_f32_16x16x32_bf16 v[156:159], a[156:159], v[164:167], v[156:159]
  v_mfma_f32_16x16x32_bf16 v[156:159], a[164:167], v[180:183], v[156:159]
  v_mfma_f32_16x16x32_bf16 v[156:159], a[172:175], v[196:199], v[156:159]
  v_mfma_f32_16x16x32_bf16 v[156:159], a[180:183], v[212:215], v[156:159]
  v_mfma_f32_16x16x32_bf16 v[156:159], a[188:191], v[228:231], v[156:159]
  s_waitcnt lgkmcnt(0)
  s_barrier
  v_mfma_f32_16x16x32_bf16 v[136:139], a[64:67], v[240:243], v[136:139]
  ds_read_b128 a[128:131], v116 offset:16384
  v_cvt_pk_bf16_f32 v52, v52, v53
  v_mfma_f32_16x16x32_bf16 v[136:139], a[72:75], v[4:7], v[136:139]
  s_add_u32 m0, s77, 0xc000
  ds_read_b128 a[132:135], v116 offset:17408
  v_cvt_pk_bf16_f32 v53, v54, v55
  v_mfma_f32_16x16x32_bf16 v[136:139], a[80:83], v[12:15], v[136:139]
  buffer_load_dwordx4 v3, s[12:15], s39 offen offset:0 sc1 lds
  v_cvt_pk_bf16_f32 v54, v64, v65
  v_mfma_f32_16x16x32_bf16 v[136:139], a[88:91], v[20:23], v[136:139]
  ds_read_b128 a[136:139], v116 offset:18432
  v_cvt_pk_bf16_f32 v55, v66, v67
  v_mfma_f32_16x16x32_bf16 v[136:139], a[96:99], v[28:31], v[136:139]
  ds_read_b128 a[140:143], v116 offset:19456
  v_and_b32 v52, -2, v52
  v_mfma_f32_16x16x32_bf16 v[140:143], a[64:67], v[244:247], v[140:143]
  buffer_store_dwordx4 v[52:55], v2, s[28:31], s66 offen offset:1024 sc1
  v_mfma_f32_16x16x32_bf16 v[140:143], a[72:75], v[32:35], v[140:143]
  ds_read_b128 a[144:147], v116 offset:20480
  v_mfma_f32_16x16x32_bf16 v[140:143], a[80:83], v[40:43], v[140:143]
  ds_read_b128 a[148:151], v116 offset:21504
  v_mfma_f32_16x16x32_bf16 v[140:143], a[88:91], v[48:51], v[140:143]
  v_mfma_f32_16x16x32_bf16 v[140:143], a[96:99], v[56:59], v[140:143]
  buffer_load_dwordx4 v3, s[12:15], s39 offen offset:1024 sc1 lds
  v_mfma_f32_16x16x32_bf16 v[152:155], a[68:71], v[240:243], v[152:155]
  ds_read_b128 a[152:155], v116 offset:22528
  v_mfma_f32_16x16x32_bf16 v[152:155], a[76:79], v[4:7], v[152:155]
  ds_read_b128 a[156:159], v116 offset:23552
  v_mfma_f32_16x16x32_bf16 v[152:155], a[84:87], v[12:15], v[152:155]
  ds_read_b128 a[160:163], v116 offset:24576
  v_mfma_f32_16x16x32_bf16 v[152:155], a[92:95], v[20:23], v[152:155]
  v_mfma_f32_16x16x32_bf16 v[152:155], a[100:103], v[28:31], v[152:155]
  ds_read_b128 a[164:167], v116 offset:25600
  v_mfma_f32_16x16x32_bf16 v[156:159], a[68:71], v[244:247], v[156:159]
  ds_read_b128 a[168:171], v116 offset:26624
  v_mfma_f32_16x16x32_bf16 v[156:159], a[76:79], v[32:35], v[156:159]
  buffer_load_dwordx4 v3, s[12:15], s39 offen offset:2048 sc1 lds
  v_mfma_f32_16x16x32_bf16 v[156:159], a[84:87], v[40:43], v[156:159]
  ds_read_b128 a[172:175], v116 offset:27648
  v_mfma_f32_16x16x32_bf16 v[156:159], a[92:95], v[48:51], v[156:159]
  ds_read_b128 a[176:179], v116 offset:28672
  v_mfma_f32_16x16x32_bf16 v[156:159], a[100:103], v[56:59], v[156:159]
  v_mfma_f32_16x16x32_bf16 v[168:171], a[104:107], v[128:131], 0
  ds_read_b128 a[180:183], v116 offset:29696
  v_mfma_f32_16x16x32_bf16 v[168:171], a[112:115], v[144:147], v[168:171]
  ds_read_b128 a[184:187], v116 offset:30720
  v_mfma_f32_16x16x32_bf16 v[168:171], a[120:123], v[160:163], v[168:171]
  v_mfma_f32_16x16x32_bf16 v[172:175], a[104:107], v[132:135], 0
  buffer_load_dwordx4 v3, s[12:15], s39 offen offset:3072 sc1 lds
  v_mfma_f32_16x16x32_bf16 v[172:175], a[112:115], v[148:151], v[172:175]
  s_add_u32 s39, s38, 0x4000
  ds_read_b128 a[188:191], v116 offset:31744
  v_cvt_pk_bf16_f32 v136, v136, v137
  v_mfma_f32_16x16x32_bf16 v[172:175], a[120:123], v[164:167], v[172:175]
  s_cmp_eq_u32 s39, s3
  s_cselect_b32 s39, s76, s39
  s_add_u32 m0, s77, 0x8000
  v_mfma_f32_16x16x32_bf16 v[184:187], a[108:111], v[128:131], 0
  v_cvt_pk_bf16_f32 v137, v138, v139
  v_cvt_pk_bf16_f32 v138, v152, v153
  v_mfma_f32_16x16x32_bf16 v[184:187], a[116:119], v[144:147], v[184:187]
  v_cvt_pk_bf16_f32 v139, v154, v155
  v_and_b32 v136, -2, v136
  v_mfma_f32_16x16x32_bf16 v[184:187], a[124:127], v[160:163], v[184:187]
  s_add_u32 s66, s66, 0x10000
  buffer_store_dwordx4 v[136:139], v2, s[28:31], s66 offen offset:0 sc1
  v_mfma_f32_16x16x32_bf16 v[188:191], a[108:111], v[132:135], 0
  v_mfma_f32_16x16x32_bf16 v[188:191], a[116:119], v[148:151], v[188:191]
  v_mfma_f32_16x16x32_bf16 v[188:191], a[124:127], v[164:167], v[188:191]
  s_waitcnt lgkmcnt(0)
  v_mfma_f32_16x16x32_bf16 v[168:171], a[128:131], v[176:179], v[168:171]
  ds_read_b128 a[64:67], v116 offset:0
  v_mfma_f32_16x16x32_bf16 v[168:171], a[136:139], v[192:195], v[168:171]
  ds_read_b128 a[68:71], v116 offset:1024
  v_mfma_f32_16x16x32_bf16 v[168:171], a[144:147], v[208:211], v[168:171]
  buffer_load_dwordx4 v3, s[8:11], s39 offen offset:0 sc1 lds
  v_mfma_f32_16x16x32_bf16 v[168:171], a[152:155], v[224:227], v[168:171]
  ds_read_b128 a[72:75], v116 offset:2048
  v_mfma_f32_16x16x32_bf16 v[168:171], a[160:163], v[240:243], v[168:171]
  ds_read_b128 a[76:79], v116 offset:3072
  v_mfma_f32_16x16x32_bf16 v[168:171], a[168:171], v[4:7], v[168:171]
  buffer_load_dword v122, off, s[20:23], s68 offset:64 sc1
  v_mfma_f32_16x16x32_bf16 v[168:171], a[176:179], v[12:15], v[168:171]
  ds_read_b128 a[80:83], v116 offset:4096
  v_mfma_f32_16x16x32_bf16 v[168:171], a[184:187], v[20:23], v[168:171]
  ds_read_b128 a[84:87], v116 offset:5120
  v_mfma_f32_16x16x32_bf16 v[172:175], a[128:131], v[180:183], v[172:175]
  v_mfma_f32_16x16x32_bf16 v[172:175], a[136:139], v[196:199], v[172:175]
  buffer_load_dwordx4 v3, s[8:11], s39 offen offset:1024 sc1 lds
  v_mfma_f32_16x16x32_bf16 v[172:175], a[144:147], v[212:215], v[172:175]
  ds_read_b128 a[88:91], v116 offset:6144
  v_mfma_f32_16x16x32_bf16 v[172:175], a[152:155], v[228:231], v[172:175]
  ds_read_b128 a[92:95], v116 offset:7168
  v_mfma_f32_16x16x32_bf16 v[172:175], a[160:163], v[244:247], v[172:175]
  ds_read_b128 a[96:99], v116 offset:8192
  v_mfma_f32_16x16x32_bf16 v[172:175], a[168:171], v[32:35], v[172:175]
  v_mfma_f32_16x16x32_bf16 v[172:175], a[176:179], v[40:43], v[172:175]
  ds_read_b128 a[100:103], v116 offset:9216
  v_mfma_f32_16x16x32_bf16 v[172:175], a[184:187], v[48:51], v[172:175]
  ds_read_b128 a[104:107], v116 offset:10240
  v_mfma_f32_16x16x32_bf16 v[184:187], a[132:135], v[176:179], v[184:187]
  buffer_load_dwordx4 v3, s[8:11], s39 offen offset:2048 sc1 lds
  v_cvt_pk_bf16_f32 v140, v140, v141
  v_mfma_f32_16x16x32_bf16 v[184:187], a[140:143], v[192:195], v[184:187]
  ds_read_b128 a[108:111], v116 offset:11264
  v_cvt_pk_bf16_f32 v141, v142, v143
  v_mfma_f32_16x16x32_bf16 v[184:187], a[148:151], v[208:211], v[184:187]
  ds_read_b128 a[112:115], v116 offset:12288
  v_cvt_pk_bf16_f32 v142, v156, v157
  v_mfma_f32_16x16x32_bf16 v[184:187], a[156:159], v[224:227], v[184:187]
  v_cvt_pk_bf16_f32 v143, v158, v159
  v_and_b32 v140, -2, v140
  v_mfma_f32_16x16x32_bf16 v[184:187], a[164:167], v[240:243], v[184:187]
  buffer_store_dwordx4 v[140:143], v2, s[28:31], s66 offen offset:1024 sc1
  v_mfma_f32_16x16x32_bf16 v[184:187], a[172:175], v[4:7], v[184:187]
  ds_read_b128 a[116:119], v116 offset:13312
  v_mfma_f32_16x16x32_bf16 v[184:187], a[180:183], v[12:15], v[184:187]
  ds_read_b128 a[120:123], v116 offset:14336
  v_mfma_f32_16x16x32_bf16 v[184:187], a[188:191], v[20:23], v[184:187]
  buffer_load_dwordx4 v3, s[8:11], s39 offen offset:3072 sc1 lds
  v_mfma_f32_16x16x32_bf16 v[188:191], a[132:135], v[180:183], v[188:191]
  s_xor_b32 s77, s77, 0x10000
  ds_read_b128 a[124:127], v116 offset:15360
  v_mfma_f32_16x16x32_bf16 v[188:191], a[140:143], v[196:199], v[188:191]
  v_mfma_f32_16x16x32_bf16 v[188:191], a[148:151], v[212:215], v[188:191]
  v_mfma_f32_16x16x32_bf16 v[188:191], a[156:159], v[228:231], v[188:191]
  v_mfma_f32_16x16x32_bf16 v[188:191], a[164:167], v[244:247], v[188:191]
  v_mfma_f32_16x16x32_bf16 v[188:191], a[172:175], v[32:35], v[188:191]
  v_mfma_f32_16x16x32_bf16 v[188:191], a[180:183], v[40:43], v[188:191]
  v_mfma_f32_16x16x32_bf16 v[188:191], a[188:191], v[48:51], v[188:191]
  s_waitcnt vmcnt(23)
  s_waitcnt lgkmcnt(0)
  s_waitcnt vmcnt(1)
  v_mov_b32 v120, s68
  v_mov_b32 v121, 1
  v_cmp_lt_u32 vcc, v122, v121
  s_nop 4
  s_cbranch_vccz Lk_go95
  s_mov_b32 s43, 0
Lk_poll94:
  s_sleep 3
  buffer_load_dword v122, v120, s[20:23], 0 offen offset:64 sc1
  s_waitcnt vmcnt(0)
  v_cmp_lt_u32 vcc, v122, v121
  s_nop 4
  s_cbranch_vccz Lk_go95
  s_add_u32 s43, s43, 1
  s_cmp_lt_u32 s43, 0x40000
  s_cbranch_scc1 Lk_poll94
Lk_go95:
  s_barrier
  s_cmp_lg_u32 s19, 0
  s_cbranch_scc1 Lk_sig96
  v_mov_b32 v120, 2
  s_mov_b64 exec, 1
  buffer_store_dword v120, off, s[20:23], s65 offset:64 sc1
  s_mov_b64 exec, -1
Lk_sig96:
  v_mfma_f32_16x16x32_bf16 v[168:171], a[64:67], v[28:31], v[168:171]
  ds_read_b128 a[128:131], v116 offset:49152
  v_mfma_f32_16x16x32_bf16 v[172:175], a[64:67], v[56:59], v[172:175]
  s_add_u32 m0, s77, 0x4000
  ds_read_b128 a[132:135], v116 offset:50176
  v_mfma_f32_16x16x32_bf16 v[184:187], a[68:71], v[28:31], v[184:187]
  buffer_load_dwordx4 v3, s[12:15], s38 offen offset:0 sc1 lds
  v_mfma_f32_16x16x32_bf16 v[188:191], a[68:71], v[56:59], v[188:191]
  ds_read_b128 a[136:139], v116 offset:51200
  v_mfma_f32_16x16x32_bf16 v[200:203], a[72:75], v[128:131], 0
  ds_read_b128 a[140:143], v116 offset:52224
  v_mfma_f32_16x16x32_bf16 v[200:203], a[80:83], v[144:147], v[200:203]
  buffer_load_dwordx4 a[0:3], v2, s[28:31], s64 offen offset:0 sc1
  v_mfma_f32_16x16x32_bf16 v[200:203], a[88:91], v[160:163], v[200:203]
  ds_read_b128 a[144:147], v116 offset:53248
  v_mfma_f32_16x16x32_bf16 v[200:203], a[96:99], v[176:179], v[200:203]
  ds_read_b128 a[148:151], v116 offset:54272
  v_mfma_f32_16x16x32_bf16 v[200:203], a[104:107], v[192:195], v[200:203]
  buffer_load_dwordx4 a[4:7], v2, s[28:31], s64 offen offset:1024 sc1
  v_mfma_f32_16x16x32_bf16 v[200:203], a[112:115], v[208:211], v[200:203]
  s_add_u32 s64, s64, 0x10000
  buffer_load_dwordx4 v3, s[12:15], s38 offen offset:1024 sc1 lds
  v_mfma_f32_16x16x32_bf16 v[200:203], a[120:123], v[224:227], v[200:203]
  ds_read_b128 a[152:155], v116 offset:55296
  v_mfma_f32_16x16x32_bf16 v[204:207], a[72:75], v[132:135], 0
  ds_read_b128 a[156:159], v116 offset:56320
  v_mfma_f32_16x16x32_bf16 v[204:207], a[80:83], v[148:151], v[204:207]
  ds_read_b128 a[160:163], v116 offset:57344
  v_mfma_f32_16x16x32_bf16 v[204:207], a[88:91], v[164:167], v[204:207]
  buffer_load_dwordx4 a[8:11], v2, s[28:31], s64 offen offset:0 sc1
  v_mfma_f32_16x16x32_bf16 v[204:207], a[96:99], v[180:183], v[204:207]
  ds_read_b128 a[164:167], v116 offset:58368
  v_mfma_f32_16x16x32_bf16 v[204:207], a[104:107], v[196:199], v[204:207]
  ds_read_b128 a[168:171], v116 offset:59392
  v_mfma_f32_16x16x32_bf16 v[204:207], a[112:115], v[212:215], v[204:207]
  buffer_load_dwordx4 v3, s[12:15], s38 offen offset:2048 sc1 lds
  v_mfma_f32_16x16x32_bf16 v[204:207], a[120:123], v[228:231], v[204:207]
  ds_read_b128 a[172:175], v116 offset:60416
  v_mfma_f32_16x16x32_bf16 v[216:219], a[76:79], v[128:131], 0
  ds_read_b128 a[176:179], v116 offset:61440
  v_mfma_f32_16x16x32_bf16 v[216:219], a[84:87], v[144:147], v[216:219]
  buffer_load_dwordx4 a[12:15], v2, s[28:31], s64 offen offset:1024 sc1
  v_mfma_f32_16x16x32_bf16 v[216:219], a[92:95], v[160:163], v[216:219]
  s_add_u32 s64, s64, 0x10000
  ds_read_b128 a[180:183], v116 offset:62464
  v_mfma_f32_16x16x32_bf16 v[216:219], a[100:103], v[176:179], v[216:219]
  ds_read_b128 a[184:187], v116 offset:63488
  v_mfma_f32_16x16x32_bf16 v[216:219], a[108:111], v[192:195], v[216:219]
  buffer_load_dwordx4 a[16:19], v2, s[28:31], s64 offen offset:0 sc1
  v_mfma_f32_16x16x32_bf16 v[216:219], a[116:119], v[208:211], v[216:219]
  buffer_load_dwordx4 v3, s[12:15], s38 offen offset:3072 sc1 lds
  v_mfma_f32_16x16x32_bf16 v[216:219], a[124:127], v[224:227], v[216:219]
  s_add_u32 s38, s39, 0x4000
  ds_read_b128 a[188:191], v116 offset:64512
  v_mfma_f32_16x16x32_bf16 v[220:223], a[76:79], v[132:135], 0
  s_cmp_eq_u32 s38, s3
  s_cselect_b32 s38, s76, s38
  buffer_load_dwordx4 a[20:23], v2, s[28:31], s64 offen offset:1024 sc1
  v_mfma_f32_16x16x32_bf16 v[220:223], a[84:87], v[148:151], v[220:223]
  s_mov_b32 m0, s77
  s_add_u32 s64, s64, 0x10000
  v_mfma_f32_16x16x32_bf16 v[220:223], a[92:95], v[164:167], v[220:223]
  buffer_load_dwordx4 a[24:27], v2, s[28:31], s64 offen offset:0 sc1
  v_mfma_f32_16x16x32_bf16 v[220:223], a[100:103], v[180:183], v[220:223]
  v_mfma_f32_16x16x32_bf16 v[220:223], a[108:111], v[196:199], v[220:223]
  buffer_load_dwordx4 a[28:31], v2, s[28:31], s64 offen offset:1024 sc1
  v_mfma_f32_16x16x32_bf16 v[220:223], a[116:119], v[212:215], v[220:223]
  s_add_u32 s64, s64, 0x10000
  v_mfma_f32_16x16x32_bf16 v[220:223], a[124:127], v[228:231], v[220:223]
  s_waitcnt lgkmcnt(0)
  v_mfma_f32_16x16x32_bf16 v[200:203], a[128:131], v[240:243], v[200:203]
  ds_read_b128 a[64:67], v116 offset:32768
  v_mfma_f32_16x16x32_bf16 v[200:203], a[136:139], v[4:7], v[200:203]
  ds_read_b128 a[68:71], v116 offset:33792
  v_mfma_f32_16x16x32_bf16 v[200:203], a[144:147], v[12:15], v[200:203]
  buffer_load_dwordx4 v3, s[8:11], s38 offen offset:0 sc1 lds
  v_mfma_f32_16x16x32_bf16 v[200:203], a[152:155], v[20:23], v[200:203]
  ds_read_b128 a[72:75], v116 offset:34816
  v_mfma_f32_16x16x32_bf16 v[200:203], a[160:163], v[28:31], v[200:203]
  ds_read_b128 a[76:79], v116 offset:35840
  v_mfma_f32_16x16x32_bf16 v[204:207], a[128:131], v[244:247], v[204:207]
  v_mfma_f32_16x16x32_bf16 v[204:207], a[136:139], v[32:35], v[204:207]
  ds_read_b128 a[80:83], v116 offset:36864
  v_mfma_f32_16x16x32_bf16 v[204:207], a[144:147], v[40:43], v[204:207]
  ds_read_b128 a[84:87], v116 offset:37888
  v_mfma_f32_16x16x32_bf16 v[204:207], a[152:155], v[48:51], v[204:207]
  v_mfma_f32_16x16x32_bf16 v[204:207], a[160:163], v[56:59], v[204:207]
  buffer_load_dwordx4 v3, s[8:11], s38 offen offset:1024 sc1 lds
  v_mfma_f32_16x16x32_bf16 v[216:219], a[132:135], v[240:243], v[216:219]
  ds_read_b128 a[88:91], v116 offset:38912
  v_mfma_f32_16x16x32_bf16 v[216:219], a[140:143], v[4:7], v[216:219]
  ds_read_b128 a[92:95], v116 offset:39936
  v_mfma_f32_16x16x32_bf16 v[216:219], a[148:151], v[12:15], v[216:219]
  ds_read_b128 a[96:99], v116 offset:40960
  v_mfma_f32_16x16x32_bf16 v[216:219], a[156:159], v[20:23], v[216:219]
  v_mfma_f32_16x16x32_bf16 v[216:219], a[164:167], v[28:31], v[216:219]
  ds_read_b128 a[100:103], v116 offset:41984
  v_mfma_f32_16x16x32_bf16 v[220:223], a[132:135], v[244:247], v[220:223]
  ds_read_b128 a[104:107], v116 offset:43008
  v_mfma_f32_16x16x32_bf16 v[220:223], a[140:143], v[32:35], v[220:223]
  buffer_load_dwordx4 v3, s[8:11], s38 offen offset:2048 sc1 lds
  v_mfma_f32_16x16x32_bf16 v[220:223], a[148:151], v[40:43], v[220:223]
  ds_read_b128 a[108:111], v116 offset:44032
  v_mfma_f32_16x16x32_bf16 v[220:223], a[156:159], v[48:51], v[220:223]
  ds_read_b128 a[112:115], v116 offset:45056
  v_mfma_f32_16x16x32_bf16 v[220:223], a[164:167], v[56:59], v[220:223]
  v_mfma_f32_16x16x32_bf16 v[232:235], a[168:171], v[128:131], 0
  ds_read_b128 a[116:119], v116 offset:46080
  v_mfma_f32_16x16x32_bf16 v[232:235], a[176:179], v[144:147], v[232:235]
  ds_read_b128 a[120:123], v116 offset:47104
  v_mfma_f32_16x16x32_bf16 v[232:235], a[184:187], v[160:163], v[232:235]
  v_mfma_f32_16x16x32_bf16 v[236:239], a[168:171], v[132:135], 0
  buffer_load_dwordx4 v3, s[8:11], s38 offen offset:3072 sc1 lds
  v_mfma_f32_16x16x32_bf16 v[236:239], a[176:179], v[148:151], v[236:239]
  ds_read_b128 a[124:127], v116 offset:48128
  s_waitcnt vmcnt(14)
  v_accvgpr_read_b32 v104, a0
  v_mfma_f32_16x16x32_bf16 v[236:239], a[184:187], v[164:167], v[236:239]
  v_accvgpr_read_b32 v105, a1
  v_xor_b32 v116, 0x10000, v116
  v_mfma_f32_16x16x32_bf16 v[248:251], a[172:175], v[128:131], 0
  v_accvgpr_read_b32 v106, a2
  v_accvgpr_read_b32 v107, a3
  v_mfma_f32_16x16x32_bf16 v[248:251], a[180:183], v[144:147], v[248:251]
  v_lshl_or_b32 v96, v104, 16, s69
  v_and_b32 v97, 0xffff0000, v104
  v_mfma_f32_16x16x32_bf16 v[248:251], a[188:191], v[160:163], v[248:251]
  v_lshlrev_b32 v98, 16, v105
  v_and_b32 v99, 0xffff0000, v105
  v_mfma_f32_16x16x32_bf16 v[252:255], a[172:175], v[132:135], 0
  v_lshlrev_b32 v100, 16, v106
  v_and_b32 v101, 0xffff0000, v106
  v_mfma_f32_16x16x32_bf16 v[252:255], a[180:183], v[148:151], v[252:255]
  v_lshlrev_b32 v102, 16, v107
  v_and_b32 v103, 0xffff0000, v107
  v_mfma_f32_16x16x32_bf16 v[252:255], a[188:191], v[164:167], v[252:255]
  v_add_f32 v168, v168, v96
  v_add_f32 v169, v169, v97
  s_waitcnt lgkmcnt(0)
  s_barrier
  v_mfma_f32_16x16x32_bf16 v[232:235], a[64:67], v[176:179], v[232:235]
  ds_read_b128 a[128:131], v116 offset:16384
  v_add_f32 v170, v170, v98
  v_mfma_f32_16x16x32_bf16 v[232:235], a[72:75], v[192:195], v[232:235]
  s_add_u32 m0, s77, 0xc000
  ds_read_b128 a[132:135], v116 offset:17408
  v_add_f32 v171, v171, v99
  v_mfma_f32_16x16x32_bf16 v[232:235], a[80:83], v[208:211], v[232:235]
  buffer_load_dwordx4 v3, s[12:15], s39 offen offset:0 sc1 lds
  v_add_f32 v184, v184, v100
  v_mfma_f32_16x16x32_bf16 v[232:235], a[88:91], v[224:227], v[232:235]
  ds_read_b128 a[136:139], v116 offset:18432
  v_add_f32 v185, v185, v101
  v_mfma_f32_16x16x32_bf16 v[232:235], a[96:99], v[240:243], v[232:235]
  ds_read_b128 a[140:143], v116 offset:19456
  v_add_f32 v186, v186, v102
  v_mfma_f32_16x16x32_bf16 v[232:235], a[104:107], v[4:7], v[232:235]
  v_add_f32 v187, v187, v103
  v_cvt_pk_bf16_f32 v168, v168, v169
  v_mfma_f32_16x16x32_bf16 v[232:235], a[112:115], v[12:15], v[232:235]
  ds_read_b128 a[144:147], v116 offset:20480
  v_cvt_pk_bf16_f32 v169, v170, v171
  v_mfma_f32_16x16x32_bf16 v[232:235], a[120:123], v[20:23], v[232:235]
  ds_read_b128 a[148:151], v116 offset:21504
  v_cvt_pk_bf16_f32 v170, v184, v185
  v_mfma_f32_16x16x32_bf16 v[236:239], a[64:67], v[180:183], v[236:239]
  v_cvt_pk_bf16_f32 v171, v186, v187
  v_or_b32 v168, 1, v168
  v_mfma_f32_16x16x32_bf16 v[236:239], a[72:75], v[196:199], v[236:239]
  s_mov_b32 s66, s67
  buffer_load_dwordx4 v3, s[12:15], s39 offen offset:1024 sc1 lds
  v_mfma_f32_16x16x32_bf16 v[236:239], a[80:83], v[212:215], v[236:239]
  buffer_store_dwordx4 v[168:171], v2, s[28:31], s66 offen offset:0 sc1
  s_waitcnt vmcnt(16)
  v_accvgpr_read_b32 v104, a4
  v_mfma_f32_16x16x32_bf16 v[236:239], a[88:91], v[228:231], v[236:239]
  ds_read_b128 a[152:155], v116 offset:22528
  v_accvgpr_read_b32 v105, a5
  v_mfma_f32_16x16x32_bf16 v[236:239], a[96:99], v[244:247], v[236:239]
  ds_read_b128 a[156:159], v116 offset:23552
  v_accvgpr_read_b32 v106, a6
  v_mfma_f32_16x16x32_bf16 v[236:239], a[104:107], v[32:35], v[236:239]
  ds_read_b128 a[160:163], v116 offset:24576
  v_accvgpr_read_b32 v107, a7
  v_mfma_f32_16x16x32_bf16 v[236:239], a[112:115], v[40:43], v[236:239]
  v_lshl_or_b32 v96, v104, 16, s69
  v_and_b32 v97, 0xffff0000, v104
  v_mfma_f32_16x16x32_bf16 v[236:239], a[120:123], v[48:51], v[236:239]
  ds_read_b128 a[164:167], v116 offset:25600
  v_lshlrev_b32 v98, 16, v105
  v_mfma_f32_16x16x32_bf16 v[248:251], a[68:71], v[176:179], v[248:251]
  buffer_load_dwordx4 v3, s[12:15], s39 offen offset:2048 sc1 lds
  v_and_b32 v99, 0xffff0000, v105
  v_mfma_f32_16x16x32_bf16 v[248:251], a[76:79], v[192:195], v[248:251]
  ds_read_b128 a[168:171], v116 offset:26624
  v_lshlrev_b32 v100, 16, v106
  v_mfma_f32_16x16x32_bf16 v[248:251], a[84:87], v[208:211], v[248:251]
  ds_read_b128 a[172:175], v116 offset:27648
  v_and_b32 v101, 0xffff0000, v106
  v_mfma_f32_16x16x32_bf16 v[248:251], a[92:95], v[224:227], v[248:251]
  ds_read_b128 a[176:179], v116 offset:28672
  v_lshlrev_b32 v102, 16, v107
  v_mfma_f32_16x16x32_bf16 v[248:251], a[100:103], v[240:243], v[248:251]
  v_and_b32 v103, 0xffff0000, v107
  v_add_f32 v172, v172, v96
  v_mfma_f32_16x16x32_bf16 v[248:251], a[108:111], v[4:7], v[248:251]
  ds_read_b128 a[180:183], v116 offset:29696
  v_add_f32 v173, v173, v97
  v_mfma_f32_16x16x32_bf16 v[248:251], a[116:119], v[12:15], v[248:251]
  ds_read_b128 a[184:187], v116 offset:30720
  v_add_f32 v174, v174, v98
  v_mfma_f32_16x16x32_bf16 v[248:251], a[124:127], v[20:23], v[248:251]
  buffer_load_dwordx4 v3, s[12:15], s39 offen offset:3072 sc1 lds
  v_add_f32 v175, v175, v99
  v_mfma_f32_16x16x32_bf16 v[252:255], a[68:71], v[180:183], v[252:255]
  s_add_u32 s39, s38, 0x4000
  ds_read_b128 a[188:191], v116 offset:31744
  v_add_f32 v188, v188, v100
  v_mfma_f32_16x16x32_bf16 v[252:255], a[76:79], v[196:199], v[252:255]
  s_cmp_eq_u32 s39, s3
  s_cselect_b32 s39, s76, s39
  s_add_u32 m0, s77, 0x8000
  v_mfma_f32_16x16x32_bf16 v[252:255], a[84:87], v[212:215], v[252:255]
  v_add_f32 v189, v189, v101
  v_add_f32 v190, v190, v102
  v_mfma_f32_16x16x32_bf16 v[252:255], a[92:95], v[228:231], v[252:255]
  v_add_f32 v191, v191, v103
  v_cvt_pk_bf16_f32 v172, v172, v173
  v_mfma_f32_16x16x32_bf16 v[252:255], a[100:103], v[244:247], v[252:255]
  v_cvt_pk_bf16_f32 v173, v174, v175
  v_cvt_pk_bf16_f32 v174, v188, v189
  v_mfma_f32_16x16x32_bf16 v[252:255], a[108:111], v[32:35], v[252:255]
  v_cvt_pk_bf16_f32 v175, v190, v191
  v_or_b32 v172, 1, v172
  v_mfma_f32_16x16x32_bf16 v[252:255], a[116:119], v[40:43], v[252:255]
  buffer_store_dwordx4 v[172:175], v2, s[28:31], s66 offen offset:1024 sc1
  s_waitcnt vmcnt(17)
  v_accvgpr_read_b32 v104, a8
  v_mfma_f32_16x16x32_bf16 v[252:255], a[124:127], v[48:51], v[252:255]
  v_accvgpr_read_b32 v105, a9
  v_accvgpr_read_b32 v106, a10
  s_waitcnt lgkmcnt(0)
  v_mfma_f32_16x16x32_bf16 v[232:235], a[128:131], v[28:31], v[232:235]
  ds_read_b128 a[64:67], v116 offset:0
  v_accvgpr_read_b32 v107, a11
  v_mfma_f32_16x16x32_bf16 v[236:239], a[128:131], v[56:59], v[236:239]
  ds_read_b128 a[68:71], v116 offset:1024
  v_lshl_or_b32 v96, v104, 16, s69
  v_mfma_f32_16x16x32_bf16 v[248:251], a[132:135], v[28:31], v[248:251]
  buffer_load_dwordx4 v3, s[8:11], s39 offen offset:0 sc1 lds
  v_and_b32 v97, 0xffff0000, v104
  v_mfma_f32_16x16x32_bf16 v[252:255], a[132:135], v[56:59], v[252:255]
  ds_read_b128 a[72:75], v116 offset:2048
  v_lshlrev_b32 v98, 16, v105
  v_mfma_f32_16x16x32_bf16 v[8:11], a[136:139], v[128:131], 0
  ds_read_b128 a[76:79], v116 offset:3072
  v_and_b32 v99, 0xffff0000, v105
  v_mfma_f32_16x16x32_bf16 v[8:11], a[144:147], v[144:147], v[8:11]
  buffer_load_dword v122, off, s[20:23], s68 offset:64 sc1
  v_lshlrev_b32 v100, 16, v106
  v_mfma_f32_16x16x32_bf16 v[8:11], a[152:155], v[160:163], v[8:11]
  ds_read_b128 a[80:83], v116 offset:4096
  v_and_b32 v101, 0xffff0000, v106
  v_mfma_f32_16x16x32_bf16 v[8:11], a[160:163], v[176:179], v[8:11]
  ds_read_b128 a[84:87], v116 offset:5120
  v_lshlrev_b32 v102, 16, v107
  v_mfma_f32_16x16x32_bf16 v[8:11], a[168:171], v[192:195], v[8:11]
  v_and_b32 v103, 0xffff0000, v107
  v_add_f32 v200, v200, v96
  v_mfma_f32_16x16x32_bf16 v[8:11], a[176:179], v[208:211], v[8:11]
  buffer_load_dwordx4 v3, s[8:11], s39 offen offset:1024 sc1 lds
  v_add_f32 v201, v201, v97
  v_mfma_f32_16x16x32_bf16 v[8:11], a[184:187], v[224:227], v[8:11]
  ds_read_b128 a[88:91], v116 offset:6144
  v_add_f32 v202, v202, v98
  v_mfma_f32_16x16x32_bf16 v[16:19], a[136:139], v[132:135], 0
  ds_read_b128 a[92:95], v116 offset:7168
  v_add_f32 v203, v203, v99
  v_mfma_f32_16x16x32_bf16 v[16:19], a[144:147], v[148:151], v[16:19]
  ds_read_b128 a[96:99], v116 offset:8192
  v_add_f32 v216, v216, v100
  v_mfma_f32_16x16x32_bf16 v[16:19], a[152:155], v[164:167], v[16:19]
  v_add_f32 v217, v217, v101
  v_add_f32 v218, v218, v102
  v_mfma_f32_16x16x32_bf16 v[16:19], a[160:163], v[180:183], v[16:19]
  ds_read_b128 a[100:103], v116 offset:9216
  v_add_f32 v219, v219, v103
  v_mfma_f32_16x16x32_bf16 v[16:19], a[168:171], v[196:199], v[16:19]
  ds_read_b128 a[104:107], v116 offset:10240
  v_cvt_pk_bf16_f32 v200, v200, v201
  v_mfma_f32_16x16x32_bf16 v[16:19], a[176:179], v[212:215], v[16:19]
  buffer_load_dwordx4 v3, s[8:11], s39 offen offset:2048 sc1 lds
  v_cvt_pk_bf16_f32 v201, v202, v203
  v_mfma_f32_16x16x32_bf16 v[16:19], a[184:187], v[228:231], v[16:19]
  ds_read_b128 a[108:111], v116 offset:11264
  v_cvt_pk_bf16_f32 v202, v216, v217
  v_mfma_f32_16x16x32_bf16 v[24:27], a[140:143], v[128:131], 0
  ds_read_b128 a[112:115], v116 offset:12288
  v_cvt_pk_bf16_f32 v203, v218, v219
  v_mfma_f32_16x16x32_bf16 v[24:27], a[148:151], v[144:147], v[24:27]
  v_or_b32 v200, 1, v200
  v_mfma_f32_16x16x32_bf16 v[24:27], a[156:159], v[160:163], v[24:27]
  s_add_u32 s66, s66, 0x10000
  ds_read_b128 a[116:119], v116 offset:13312
  v_mfma_f32_16x16x32_bf16 v[24:27], a[164:167], v[176:179], v[24:27]
  buffer_store_dwordx4 v[200:203], v2, s[28:31], s66 offen offset:0 sc1
  s_waitcnt vmcnt(20)
  v_accvgpr_read_b32 v104, a12
  v_mfma_f32_16x16x32_bf16 v[24:27], a[172:175], v[192:195], v[24:27]
  ds_read_b128 a[120:123], v116 offset:14336
  v_accvgpr_read_b32 v105, a13
  v_mfma_f32_16x16x32_bf16 v[24:27], a[180:183], v[208:211], v[24:27]
  buffer_load_dwordx4 v3, s[8:11], s39 offen offset:3072 sc1 lds
  v_accvgpr_read_b32 v106, a14
  v_mfma_f32_16x16x32_bf16 v[24:27], a[188:191], v[224:227], v[24:27]
  s_xor_b32 s77, s77, 0x10000
  ds_read_b128 a[124:127], v116 offset:15360
  v_accvgpr_read_b32 v107, a15
  v_mfma_f32_16x16x32_bf16 v[36:39], a[140:143], v[132:135], 0
  v_lshl_or_b32 v96, v104, 16, s69
  v_and_b32 v97, 0xffff0000, v104
  v_mfma_f32_16x16x32_bf16 v[36:39], a[148:151], v[148:151], v[36:39]
  v_lshlrev_b32 v98, 16, v105
  v_and_b32 v99, 0xffff0000, v105
  v_mfma_f32_16x16x32_bf16 v[36:39], a[156:159], v[164:167], v[36:39]
  v_lshlrev_b32 v100, 16, v106
  v_and_b32 v101, 0xffff0000, v106
  v_mfma_f32_16x16x32_bf16 v[36:39], a[164:167], v[180:183], v[36:39]
  v_lshlrev_b32 v102, 16, v107
  v_and_b32 v103, 0xffff0000, v107
  v_mfma_f32_16x16x32_bf16 v[36:39], a[172:175], v[196:199], v[36:39]
  v_add_f32 v204, v204, v96
  v_add_f32 v205, v205, v97
  v_mfma_f32_16x16x32_bf16 v[36:39], a[180:183], v[212:215], v[36:39]
  v_add_f32 v206, v206, v98
  v_add_f32 v207, v207, v99
  v_mfma_f32_16x16x32_bf16 v[36:39], a[188:191], v[228:231], v[36:39]
  v_add_f32 v220, v220, v100
  v_add_f32 v221, v221, v101
  s_waitcnt lgkmcnt(0)
  v_mov_b32 v120, s68
  v_mov_b32 v121, 2
  s_waitcnt vmcnt(4)
  v_cmp_lt_u32 vcc, v122, v121
  s_nop 4
  s_cbranch_vccz Lk_go98
  s_mov_b32 s43, 0
Lk_poll97:
  s_sleep 3
  buffer_load_dword v122, v120, s[20:23], 0 offen offset:64 sc1
  s_waitcnt vmcnt(0)
  v_cmp_lt_u32 vcc, v122, v121
  s_nop 4
  s_cbranch_vccz Lk_go98
  s_add_u32 s43, s43, 1
  s_cmp_lt_u32 s43, 0x40000
  s_cbranch_scc1 Lk_poll97
Lk_go98:
  s_barrier
  v_mfma_f32_16x16x32_bf16 v[8:11], a[64:67], v[240:243], v[8:11]
  ds_read_b128 a[128:131], v116 offset:49152
  v_add_f32 v222, v222, v102
  v_mfma_f32_16x16x32_bf16 v[8:11], a[72:75], v[4:7], v[8:11]
  ds_read_b128 a[132:135], v116 offset:50176
  v_add_f32 v223, v223, v103
  v_mfma_f32_16x16x32_bf16 v[8:11], a[80:83], v[12:15], v[8:11]
  buffer_load_dwordx4 a[32:35], v2, s[28:31], s64 offen offset:0 sc1
  v_cvt_pk_bf16_f32 v204, v204, v205
  v_mfma_f32_16x16x32_bf16 v[8:11], a[88:91], v[20:23], v[8:11]
  ds_read_b128 a[136:139], v116 offset:51200
  v_cvt_pk_bf16_f32 v205, v206, v207
  v_mfma_f32_16x16x32_bf16 v[8:11], a[96:99], v[28:31], v[8:11]
  ds_read_b128 a[140:143], v116 offset:52224
  v_cvt_pk_bf16_f32 v206, v220, v221
  v_mfma_f32_16x16x32_bf16 v[16:19], a[64:67], v[244:247], v[16:19]
  buffer_load_dwordx4 a[36:39], v2, s[28:31], s64 offen offset:1024 sc1
  v_cvt_pk_bf16_f32 v207, v222, v223
  v_mfma_f32_16x16x32_bf16 v[16:19], a[72:75], v[32:35], v[16:19]
  s_add_u32 s64, s64, 0x10000
  ds_read_b128 a[144:147], v116 offset:53248
  v_or_b32 v204, 1, v204
  v_mfma_f32_16x16x32_bf16 v[16:19], a[80:83], v[40:43], v[16:19]
  buffer_store_dwordx4 v[204:207], v2, s[28:31], s66 offen offset:1024 sc1
  v_accvgpr_read_b32 v104, a16
  v_mfma_f32_16x16x32_bf16 v[16:19], a[88:91], v[48:51], v[16:19]
  ds_read_b128 a[148:151], v116 offset:54272
  v_accvgpr_read_b32 v105, a17
  v_mfma_f32_16x16x32_bf16 v[16:19], a[96:99], v[56:59], v[16:19]
  ds_read_b128 a[152:155], v116 offset:55296
  v_accvgpr_read_b32 v106, a18
  v_mfma_f32_16x16x32_bf16 v[24:27], a[68:71], v[240:243], v[24:27]
  ds_read_b128 a[156:159], v116 offset:56320
  v_accvgpr_read_b32 v107, a19
  v_mfma_f32_16x16x32_bf16 v[24:27], a[76:79], v[4:7], v[24:27]
  buffer_load_dwordx4 a[40:43], v2, s[28:31], s64 offen offset:0 sc1
  v_lshl_or_b32 v96, v104, 16, s69
  v_mfma_f32_16x16x32_bf16 v[24:27], a[84:87], v[12:15], v[24:27]
  ds_read_b128 a[160:163], v116 offset:57344
  v_and_b32 v97, 0xffff0000, v104
  v_mfma_f32_16x16x32_bf16 v[24:27], a[92:95], v[20:23], v[24:27]
  ds_read_b128 a[164:167], v116 offset:58368
  v_lshlrev_b32 v98, 16, v105
  v_mfma_f32_16x16x32_bf16 v[24:27], a[100:103], v[28:31], v[24:27]
  buffer_load_dwordx4 a[44:47], v2, s[28:31], s64 offen offset:1024 sc1
  v_and_b32 v99, 0xffff0000, v105
  v_mfma_f32_16x16x32_bf16 v[36:39], a[68:71], v[244:247], v[36:39]
  s_add_u32 s64, s64, 0x10000
  ds_read_b128 a[168:171], v116 offset:59392
  v_lshlrev_b32 v100, 16, v106
  v_mfma_f32_16x16x32_bf16 v[36:39], a[76:79], v[32:35], v[36:39]
  ds_read_b128 a[172:175], v116 offset:60416
  v_and_b32 v101, 0xffff0000, v106
  v_mfma_f32_16x16x32_bf16 v[36:39], a[84:87], v[40:43], v[36:39]
  buffer_load_dwordx4 a[48:51], v2, s[28:31], s64 offen offset:0 sc1
  v_lshlrev_b32 v102, 16, v107
  v_mfma_f32_16x16x32_bf16 v[36:39], a[92:95], v[48:51], v[36:39]
  ds_read_b128 a[176:179], v116 offset:61440
  v_and_b32 v103, 0xffff0000, v107
  v_mfma_f32_16x16x32_bf16 v[36:39], a[100:103], v[56:59], v[36:39]
  ds_read_b128 a[180:183], v116 offset:62464
  v_add_f32 v232, v232, v96
  v_mfma_f32_16x16x32_bf16 v[44:47], a[104:107], v[128:131], 0
  buffer_load_dwordx4 a[52:55], v2, s[28:31], s64 offen offset:1024 sc1
  v_add_f32 v233, v233, v97
  v_mfma_f32_16x16x32_bf16 v[44:47], a[112:115], v[144:147], v[44:47]
  s_add_u32 s64, s64, 0x10000
  ds_read_b128 a[184:187], v116 offset:63488
  v_add_f32 v234, v234, v98
  v_mfma_f32_16x16x32_bf16 v[44:47], a[120:123], v[160:163], v[44:47]
  ds_read_b128 a[188:191], v116 offset:64512
  v_add_f32 v235, v235, v99
  v_mfma_f32_16x16x32_bf16 v[52:55], a[104:107], v[132:135], 0
  v_add_f32 v248, v248, v100
  v_add_f32 v249, v249, v101
  v_mfma_f32_16x16x32_bf16 v[52:55], a[112:115], v[148:151], v[52:55]
  v_add_f32 v250, v250, v102
  v_add_f32 v251, v251, v103
  v_mfma_f32_16x16x32_bf16 v[52:55], a[120:123], v[164:167], v[52:55]
  v_cvt_pk_bf16_f32 v232, v232, v233
  v_cvt_pk_bf16_f32 v233, v234, v235
  v_mfma_f32_16x16x32_bf16 v[60:63], a[108:111], v[128:131], 0
  v_cvt_pk_bf16_f32 v234, v248, v249
  v_cvt_pk_bf16_f32 v235, v250, v251
  v_mfma_f32_16x16x32_bf16 v[60:63], a[116:119], v[144:147], v[60:63]
  v_or_b32 v232, 1, v232
  v_mfma_f32_16x16x32_bf16 v[60:63], a[124:127], v[160:163], v[60:63]
  s_add_u32 s66, s66, 0x10000
  buffer_store_dwordx4 v[232:235], v2, s[28:31], s66 offen offset:0 sc1
  v_accvgpr_read_b32 v104, a20
  v_mfma_f32_16x16x32_bf16 v[64:67], a[108:111], v[132:135], 0
  v_accvgpr_read_b32 v105, a21
  v_accvgpr_read_b32 v106, a22
  v_mfma_f32_16x16x32_bf16 v[64:67], a[116:119], v[148:151], v[64:67]
  v_accvgpr_read_b32 v107, a23
  v_lshl_or_b32 v96, v104, 16, s69
  v_mfma_f32_16x16x32_bf16 v[64:67], a[124:127], v[164:167], v[64:67]
  v_and_b32 v97, 0xffff0000, v104
  v_lshlrev_b32 v98, 16, v105
  s_waitcnt lgkmcnt(0)
  v_mfma_f32_16x16x32_bf16 v[44:47], a[128:131], v[176:179], v[44:47]
  ds_read_b128 a[64:67], v116 offset:32768
  v_and_b32 v99, 0xffff0000, v105
  v_mfma_f32_16x16x32_bf16 v[44:47], a[136:139], v[192:195], v[44:47]
  ds_read_b128 a[68:71], v116 offset:33792
  v_lshlrev_b32 v100, 16, v106
  v_mfma_f32_16x16x32_bf16 v[44:47], a[144:147], v[208:211], v[44:47]
  v_and_b32 v101, 0xffff0000, v106
  v_lshlrev_b32 v102, 16, v107
  v_mfma_f32_16x16x32_bf16 v[44:47], a[152:155], v[224:227], v[44:47]
  ds_read_b128 a[72:75], v116 offset:34816
  v_and_b32 v103, 0xffff0000, v107
  v_mfma_f32_16x16x32_bf16 v[44:47], a[160:163], v[240:243], v[44:47]
  ds_read_b128 a[76:79], v116 offset:35840
  v_add_f32 v236, v236, v96
  v_mfma_f32_16x16x32_bf16 v[44:47], a[168:171], v[4:7], v[44:47]
  v_add_f32 v237, v237, v97
  v_add_f32 v238, v238, v98
  v_mfma_f32_16x16x32_bf16 v[44:47], a[176:179], v[12:15], v[44:47]
  ds_read_b128 a[80:83], v116 offset:36864
  v_add_f32 v239, v239, v99
  v_mfma_f32_16x16x32_bf16 v[44:47], a[184:187], v[20:23], v[44:47]
  ds_read_b128 a[84:87], v116 offset:37888
  v_add_f32 v252, v252, v100
  v_mfma_f32_16x16x32_bf16 v[52:55], a[128:131], v[180:183], v[52:55]
  v_add_f32 v253, v253, v101
  v_add_f32 v254, v254, v102
  v_mfma_f32_16x16x32_bf16 v[52:55], a[136:139], v[196:199], v[52:55]
  ds_read_b128 a[88:91], v116 offset:38912
  v_add_f32 v255, v255, v103
  v_mfma_f32_16x16x32_bf16 v[52:55], a[144:147], v[212:215], v[52:55]
  ds_read_b128 a[92:95], v116 offset:39936
  v_cvt_pk_bf16_f32 v236, v236, v237
  v_mfma_f32_16x16x32_bf16 v[52:55], a[152:155], v[228:231], v[52:55]
  v_cvt_pk_bf16_f32 v237, v238, v239
  v_cvt_pk_bf16_f32 v238, v252, v253
  v_mfma_f32_16x16x32_bf16 v[52:55], a[160:163], v[244:247], v[52:55]
  ds_read_b128 a[96:99], v116 offset:40960
  v_cvt_pk_bf16_f32 v239, v254, v255
  v_mfma_f32_16x16x32_bf16 v[52:55], a[168:171], v[32:35], v[52:55]
  ds_read_b128 a[100:103], v116 offset:41984
  v_or_b32 v236, 1, v236
  v_mfma_f32_16x16x32_bf16 v[52:55], a[176:179], v[40:43], v[52:55]
  buffer_store_dwordx4 v[236:239], v2, s[28:31], s66 offen offset:1024 sc1
  v_accvgpr_read_b32 v104, a24
  v_mfma_f32_16x16x32_bf16 v[52:55], a[184:187], v[48:51], v[52:55]
  ds_read_b128 a[104:107], v116 offset:43008
  v_accvgpr_read_b32 v105, a25
  v_mfma_f32_16x16x32_bf16 v[60:63], a[132:135], v[176:179], v[60:63]
  ds_read_b128 a[108:111], v116 offset:44032
  v_accvgpr_read_b32 v106, a26
  v_mfma_f32_16x16x32_bf16 v[60:63], a[140:143], v[192:195], v[60:63]
  v_accvgpr_read_b32 v107, a27
  v_lshl_or_b32 v96, v104, 16, s69
  v_mfma_f32_16x16x32_bf16 v[60:63], a[148:151], v[208:211], v[60:63]
  ds_read_b128 a[112:115], v116 offset:45056
  v_and_b32 v97, 0xffff0000, v104
  v_mfma_f32_16x16x32_bf16 v[60:63], a[156:159], v[224:227], v[60:63]
  ds_read_b128 a[116:119], v116 offset:46080
  v_lshlrev_b32 v98, 16, v105
  v_mfma_f32_16x16x32_bf16 v[60:63], a[164:167], v[240:243], v[60:63]
  v_and_b32 v99, 0xffff0000, v105
  v_lshlrev_b32 v100, 16, v106
  v_mfma_f32_16x16x32_bf16 v[60:63], a[172:175], v[4:7], v[60:63]
  ds_read_b128 a[120:123], v116 offset:47104
  v_and_b32 v101, 0xffff0000, v106
  v_mfma_f32_16x16x32_bf16 v[60:63], a[180:183], v[12:15], v[60:63]
  ds_read_b128 a[124:127], v116 offset:48128
  v_lshlrev_b32 v102, 16, v107
  v_mfma_f32_16x16x32_bf16 v[60:63], a[188:191], v[20:23], v[60:63]
  v_and_b32 v103, 0xffff0000, v107
  v_add_f32 v8, v8, v96
  v_mfma_f32_16x16x32_bf16 v[64:67], a[132:135], v[180:183], v[64:67]
  v_add_f32 v9, v9, v97
  v_xor_b32 v116, 0x10000, v116
  v_mfma_f32_16x16x32_bf16 v[64:67], a[140:143], v[196:199], v[64:67]
  v_add_f32 v10, v10, v98
  v_add_f32 v11, v11, v99
  v_mfma_f32_16x16x32_bf16 v[64:67], a[148:151], v[212:215], v[64:67]
  v_add_f32 v24, v24, v100
  v_add_f32 v25, v25, v101
  v_mfma_f32_16x16x32_bf16 v[64:67], a[156:159], v[228:231], v[64:67]
  v_add_f32 v26, v26, v102
  v_add_f32 v27, v27, v103
  v_mfma_f32_16x16x32_bf16 v[64:67], a[164:167], v[244:247], v[64:67]
  v_cvt_pk_bf16_f32 v8, v8, v9
  v_cvt_pk_bf16_f32 v9, v10, v11
  v_mfma_f32_16x16x32_bf16 v[64:67], a[172:175], v[32:35], v[64:67]
  v_cvt_pk_bf16_f32 v10, v24, v25
  v_cvt_pk_bf16_f32 v11, v26, v27
  v_mfma_f32_16x16x32_bf16 v[64:67], a[180:183], v[40:43], v[64:67]
  v_or_b32 v8, 1, v8
  v_mfma_f32_16x16x32_bf16 v[64:67], a[188:191], v[48:51], v[64:67]
  s_add_u32 s66, s66, 0x10000
  buffer_store_dwordx4 v[8:11], v2, s[28:31], s66 offen offset:0 sc1
  v_accvgpr_read_b32 v104, a28
  s_waitcnt lgkmcnt(0)
  s_cmp_lg_u32 s19, 0
  s_cbranch_scc1 Lk_tk99
  s_mov_b64 exec, 1
  v_mov_b32 v117, 1
  buffer_atomic_add v117, off, s[24:27], 0 offset:4 sc0 sc1
  s_mov_b64 exec, -1
Lk_tk99:
  s_barrier
  v_mfma_f32_16x16x32_bf16 v[44:47], a[64:67], v[28:31], v[44:47]
  ds_read_b128 a[128:131], v116 offset:16384
  v_accvgpr_read_b32 v105, a29
  v_mfma_f32_16x16x32_bf16 v[52:55], a[64:67], v[56:59], v[52:55]
  ds_read_b128 a[132:135], v116 offset:17408
  v_accvgpr_read_b32 v106, a30
  v_mfma_f32_16x16x32_bf16 v[60:63], a[68:71], v[28:31], v[60:63]
  v_accvgpr_read_b32 v107, a31
  v_lshl_or_b32 v96, v104, 16, s69
  v_mfma_f32_16x16x32_bf16 v[64:67], a[68:71], v[56:59], v[64:67]
  ds_read_b128 a[136:139], v116 offset:18432
  v_and_b32 v97, 0xffff0000, v104
  v_mfma_f32_16x16x32_bf16 v[136:139], a[72:75], v[128:131], 0
  ds_read_b128 a[140:143], v116 offset:19456
  v_lshlrev_b32 v98, 16, v105
  v_mfma_f32_16x16x32_bf16 v[136:139], a[80:83], v[144:147], v[136:139]
  v_and_b32 v99, 0xffff0000, v105
  v_lshlrev_b32 v100, 16, v106
  v_mfma_f32_16x16x32_bf16 v[136:139], a[88:91], v[160:163], v[136:139]
  ds_read_b128 a[144:147], v116 offset:20480
  v_and_b32 v101, 0xffff0000, v106
  v_mfma_f32_16x16x32_bf16 v[136:139], a[96:99], v[176:179], v[136:139]
  ds_read_b128 a[148:151], v116 offset:21504
  v_lshlrev_b32 v102, 16, v107
  v_mfma_f32_16x16x32_bf16 v[136:139], a[104:107], v[192:195], v[136:139]
  v_and_b32 v103, 0xffff0000, v107
  v_add_f32 v16, v16, v96
  v_mfma_f32_16x16x32_bf16 v[136:139], a[112:115], v[208:211], v[136:139]
  ds_read_b128 a[152:155], v116 offset:22528
  v_add_f32 v17, v17, v97
  v_mfma_f32_16x16x32_bf16 v[136:139], a[120:123], v[224:227], v[136:139]
  ds_read_b128 a[156:159], v116 offset:23552
  v_add_f32 v18, v18, v98
  v_mfma_f32_16x16x32_bf16 v[140:143], a[72:75], v[132:135], 0
  v_add_f32 v19, v19, v99
  v_add_f32 v36, v36, v100
  v_mfma_f32_16x16x32_bf16 v[140:143], a[80:83], v[148:151], v[140:143]
  ds_read_b128 a[160:163], v116 offset:24576
  s_waitcnt vmcnt(4)
  v_accvgpr_read_b32 v169, a48
  v_mfma_f32_16x16x32_bf16 v[140:143], a[88:91], v[164:167], v[140:143]
  ds_read_b128 a[164:167], v116 offset:25600
  v_lshl_or_b32 v168, v169, 16, s69
  v_mfma_f32_16x16x32_bf16 v[140:143], a[96:99], v[180:183], v[140:143]
  v_and_b32 v169, 0xffff0000, v169
  v_add_f32 v37, v37, v101
  v_mfma_f32_16x16x32_bf16 v[140:143], a[104:107], v[196:199], v[140:143]
  ds_read_b128 a[168:171], v116 offset:26624
  v_accvgpr_read_b32 v171, a49
  v_mfma_f32_16x16x32_bf16 v[140:143], a[112:115], v[212:215], v[140:143]
  ds_read_b128 a[172:175], v116 offset:27648
  v_lshlrev_b32 v170, 16, v171
  v_mfma_f32_16x16x32_bf16 v[140:143], a[120:123], v[228:231], v[140:143]
  v_and_b32 v171, 0xffff0000, v171
  v_add_f32 v38, v38, v102
  v_mfma_f32_16x16x32_bf16 v[152:155], a[76:79], v[128:131], 0
  ds_read_b128 a[176:179], v116 offset:28672
  v_accvgpr_read_b32 v185, a50
  v_mfma_f32_16x16x32_bf16 v[152:155], a[84:87], v[144:147], v[152:155]
  ds_read_b128 a[180:183], v116 offset:29696
  v_lshlrev_b32 v184, 16, v185
  v_mfma_f32_16x16x32_bf16 v[152:155], a[92:95], v[160:163], v[152:155]
  v_and_b32 v185, 0xffff0000, v185
  v_add_f32 v39, v39, v103
  v_mfma_f32_16x16x32_bf16 v[152:155], a[100:103], v[176:179], v[152:155]
  ds_read_b128 a[184:187], v116 offset:30720
  v_accvgpr_read_b32 v187, a51
  v_mfma_f32_16x16x32_bf16 v[152:155], a[108:111], v[192:195], v[152:155]
  ds_read_b128 a[188:191], v116 offset:31744
  v_lshlrev_b32 v186, 16, v187
  v_mfma_f32_16x16x32_bf16 v[152:155], a[116:119], v[208:211], v[152:155]
  v_and_b32 v187, 0xffff0000, v187
  v_cvt_pk_bf16_f32 v16, v16, v17
  v_mfma_f32_16x16x32_bf16 v[152:155], a[124:127], v[224:227], v[152:155]
  s_waitcnt vmcnt(3)
  v_accvgpr_read_b32 v173, a52
  v_cvt_pk_bf16_f32 v17, v18, v19
  v_mfma_f32_16x16x32_bf16 v[156:159], a[76:79], v[132:135], 0
  v_lshl_or_b32 v172, v173, 16, s69
  v_cvt_pk_bf16_f32 v18, v36, v37
  v_mfma_f32_16x16x32_bf16 v[156:159], a[84:87], v[148:151], v[156:159]
  v_and_b32 v173, 0xffff0000, v173
  v_cvt_pk_bf16_f32 v19, v38, v39
  v_mfma_f32_16x16x32_bf16 v[156:159], a[92:95], v[164:167], v[156:159]
  v_accvgpr_read_b32 v175, a53
  v_or_b32 v16, 1, v16
  v_mfma_f32_16x16x32_bf16 v[156:159], a[100:103], v[180:183], v[156:159]
  buffer_store_dwordx4 v[16:19], v2, s[28:31], s66 offen offset:1024 sc1
  v_lshlrev_b32 v174, 16, v175
  v_mfma_f32_16x16x32_bf16 v[156:159], a[108:111], v[196:199], v[156:159]
  v_and_b32 v175, 0xffff0000, v175
  v_accvgpr_read_b32 v104, a32
  v_mfma_f32_16x16x32_bf16 v[156:159], a[116:119], v[212:215], v[156:159]
  v_accvgpr_read_b32 v189, a54
  v_accvgpr_read_b32 v105, a33
  v_mfma_f32_16x16x32_bf16 v[156:159], a[124:127], v[228:231], v[156:159]
  v_lshlrev_b32 v188, 16, v189
  v_accvgpr_read_b32 v106, a34
  s_waitcnt lgkmcnt(0)
  v_mfma_f32_16x16x32_bf16 v[136:139], a[128:131], v[240:243], v[136:139]
  ds_read_b128 a[64:67], v116 offset:0
  v_and_b32 v189, 0xffff0000, v189
  v_mfma_f32_16x16x32_bf16 v[136:139], a[136:139], v[4:7], v[136:139]
  ds_read_b128 a[68:71], v116 offset:1024
  v_accvgpr_read_b32 v191, a55
  v_mfma_f32_16x16x32_bf16 v[136:139], a[144:147], v[12:15], v[136:139]
  v_lshlrev_b32 v190, 16, v191
  v_accvgpr_read_b32 v107, a35
  v_mfma_f32_16x16x32_bf16 v[136:139], a[152:155], v[20:23], v[136:139]
  ds_read_b128 a[72:75], v116 offset:2048
  v_and_b32 v191, 0xffff0000, v191
  v_mfma_f32_16x16x32_bf16 v[136:139], a[160:163], v[28:31], v[136:139]
  ds_read_b128 a[76:79], v116 offset:3072
  v_lshl_or_b32 v96, v104, 16, s69
  v_mfma_f32_16x16x32_bf16 v[140:143], a[128:131], v[244:247], v[140:143]
  v_and_b32 v97, 0xffff0000, v104
  v_lshlrev_b32 v98, 16, v105
  v_mfma_f32_16x16x32_bf16 v[140:143], a[136:139], v[32:35], v[140:143]
  ds_read_b128 a[80:83], v116 offset:4096
  v_and_b32 v99, 0xffff0000, v105
  v_mfma_f32_16x16x32_bf16 v[140:143], a[144:147], v[40:43], v[140:143]
  ds_read_b128 a[84:87], v116 offset:5120
  v_lshlrev_b32 v100, 16, v106
  v_mfma_f32_16x16x32_bf16 v[140:143], a[152:155], v[48:51], v[140:143]
  v_and_b32 v101, 0xffff0000, v106
  v_lshlrev_b32 v102, 16, v107
  v_mfma_f32_16x16x32_bf16 v[140:143], a[160:163], v[56:59], v[140:143]
  ds_read_b128 a[88:91], v116 offset:6144
  v_and_b32 v103, 0xffff0000, v107
  v_mfma_f32_16x16x32_bf16 v[152:155], a[132:135], v[240:243], v[152:155]
  ds_read_b128 a[92:95], v116 offset:7168
  v_add_f32 v44, v44, v96
  v_mfma_f32_16x16x32_bf16 v[152:155], a[140:143], v[4:7], v[152:155]
  v_add_f32 v45, v45, v97
  v_add_f32 v46, v46, v98
  v_mfma_f32_16x16x32_bf16 v[152:155], a[148:151], v[12:15], v[152:155]
  ds_read_b128 a[96:99], v116 offset:8192
  v_add_f32 v47, v47, v99
  v_mfma_f32_16x16x32_bf16 v[152:155], a[156:159], v[20:23], v[152:155]
  ds_read_b128 a[100:103], v116 offset:9216
  v_add_f32 v60, v60, v100
  v_mfma_f32_16x16x32_bf16 v[152:155], a[164:167], v[28:31], v[152:155]
  v_add_f32 v61, v61, v101
  v_add_f32 v62, v62, v102
  v_mfma_f32_16x16x32_bf16 v[156:159], a[132:135], v[244:247], v[156:159]
  ds_read_b128 a[104:107], v116 offset:10240
  v_add_f32 v63, v63, v103
  v_mfma_f32_16x16x32_bf16 v[156:159], a[140:143], v[32:35], v[156:159]
  ds_read_b128 a[108:111], v116 offset:11264
  v_cvt_pk_bf16_f32 v44, v44, v45
  v_mfma_f32_16x16x32_bf16 v[156:159], a[148:151], v[40:43], v[156:159]
  v_cvt_pk_bf16_f32 v45, v46, v47
  v_cvt_pk_bf16_f32 v46, v60, v61
  v_mfma_f32_16x16x32_bf16 v[156:159], a[156:159], v[48:51], v[156:159]
  ds_read_b128 a[112:115], v116 offset:12288
  v_cvt_pk_bf16_f32 v47, v62, v63
  v_mfma_f32_16x16x32_bf16 v[156:159], a[164:167], v[56:59], v[156:159]
  ds_read_b128 a[116:119], v116 offset:13312
  v_or_b32 v44, 1, v44
  v_mfma_f32_16x16x32_bf16 v[168:171], a[168:171], v[128:131], v[168:171]
  s_add_u32 s66, s66, 0x10000
  buffer_store_dwordx4 v[44:47], v2, s[28:31], s66 offen offset:0 sc1
  v_accvgpr_read_b32 v104, a36
  v_mfma_f32_16x16x32_bf16 v[168:171], a[176:179], v[144:147], v[168:171]
  ds_read_b128 a[120:123], v116 offset:14336
  v_accvgpr_read_b32 v105, a37
  v_mfma_f32_16x16x32_bf16 v[168:171], a[184:187], v[160:163], v[168:171]
  ds_read_b128 a[124:127], v116 offset:15360
  v_accvgpr_read_b32 v106, a38
  v_mfma_f32_16x16x32_bf16 v[172:175], a[168:171], v[132:135], v[172:175]
  v_accvgpr_read_b32 v107, a39
  v_lshl_or_b32 v96, v104, 16, s69
  v_mfma_f32_16x16x32_bf16 v[172:175], a[176:179], v[148:151], v[172:175]
  v_and_b32 v97, 0xffff0000, v104
  v_lshlrev_b32 v98, 16, v105
  v_mfma_f32_16x16x32_bf16 v[172:175], a[184:187], v[164:167], v[172:175]
  v_and_b32 v99, 0xffff0000, v105
  v_lshlrev_b32 v100, 16, v106
  v_mfma_f32_16x16x32_bf16 v[184:187], a[172:175], v[128:131], v[184:187]
  v_and_b32 v101, 0xffff0000, v106
  v_lshlrev_b32 v102, 16, v107
  v_mfma_f32_16x16x32_bf16 v[184:187], a[180:183], v[144:147], v[184:187]
  v_and_b32 v103, 0xffff0000, v107
  v_add_f32 v52, v52, v96
  v_mfma_f32_16x16x32_bf16 v[184:187], a[188:191], v[160:163], v[184:187]
  v_add_f32 v53, v53, v97
  v_add_f32 v54, v54, v98
  v_mfma_f32_16x16x32_bf16 v[188:191], a[172:175], v[132:135], v[188:191]
  v_add_f32 v55, v55, v99
  v_add_f32 v64, v64, v100
  v_mfma_f32_16x16x32_bf16 v[188:191], a[180:183], v[148:151], v[188:191]
  v_add_f32 v65, v65, v101
  v_add_f32 v66, v66, v102
  v_mfma_f32_16x16x32_bf16 v[188:191], a[188:191], v[164:167], v[188:191]
  v_add_f32 v67, v67, v103
  v_cvt_pk_bf16_f32 v52, v52, v53
  s_waitcnt lgkmcnt(0)
  s_cmp_lg_u32 s19, 0
  s_cbranch_scc1 Lk_tk100
  s_mov_b64 exec, 1
  v_mov_b32 v120, 0x27000
  s_waitcnt vmcnt(2)
  ds_write_b32 v120, v117
  s_waitcnt lgkmcnt(0)
  s_mov_b64 exec, -1
Lk_tk100:
  s_barrier
  v_mfma_f32_16x16x32_bf16 v[168:171], a[64:67], v[176:179], v[168:171]
  ds_read_b128 a[128:131], v116 offset:49152
  v_mov_b32 v120, 0x27000
  v_mfma_f32_16x16x32_bf16 v[168:171], a[72:75], v[192:195], v[168:171]
  ds_read_b32 v120, v120
  v_and_b32 v121, 15, v0
  v_mfma_f32_16x16x32_bf16 v[168:171], a[80:83], v[208:211], v[168:171]
  ds_read_b128 a[132:135], v116 offset:50176
  v_cvt_pk_bf16_f32 v53, v54, v55
  v_mfma_f32_16x16x32_bf16 v[168:171], a[88:91], v[224:227], v[168:171]
  v_cvt_pk_bf16_f32 v54, v64, v65
  v_cvt_pk_bf16_f32 v55, v66, v67
  v_mfma_f32_16x16x32_bf16 v[168:171], a[96:99], v[240:243], v[168:171]
  v_or_b32 v52, 1, v52
  v_mfma_f32_16x16x32_bf16 v[168:171], a[104:107], v[4:7], v[168:171]
  buffer_store_dwordx4 v[52:55], v2, s[28:31], s66 offen offset:1024 sc1
  v_accvgpr_read_b32 v104, a40
  v_mfma_f32_16x16x32_bf16 v[168:171], a[112:115], v[12:15], v[168:171]
  v_accvgpr_read_b32 v105, a41
  v_accvgpr_read_b32 v106, a42
  v_mfma_f32_16x16x32_bf16 v[168:171], a[120:123], v[20:23], v[168:171]
  v_accvgpr_read_b32 v107, a43
  v_lshl_or_b32 v96, v104, 16, s69
  v_mfma_f32_16x16x32_bf16 v[172:175], a[64:67], v[180:183], v[172:175]
  v_and_b32 v97, 0xffff0000, v104
  v_lshlrev_b32 v98, 16, v105
  v_mfma_f32_16x16x32_bf16 v[172:175], a[72:75], v[196:199], v[172:175]
  v_and_b32 v99, 0xffff0000, v105
  v_lshlrev_b32 v100, 16, v106
  v_mfma_f32_16x16x32_bf16 v[172:175], a[80:83], v[212:215], v[172:175]
  v_and_b32 v101, 0xffff0000, v106
  v_lshlrev_b32 v102, 16, v107
  v_mfma_f32_16x16x32_bf16 v[172:175], a[88:91], v[228:231], v[172:175]
  v_and_b32 v103, 0xffff0000, v107
  v_add_f32 v136, v136, v96
  v_mfma_f32_16x16x32_bf16 v[172:175], a[96:99], v[244:247], v[172:175]
  s_waitcnt lgkmcnt(1)
  v_readfirstlane_b32 s33, v120
  v_add_f32 v137, v137, v97
  v_mfma_f32_16x16x32_bf16 v[172:175], a[104:107], v[32:35], v[172:175]
  v_nop
  v_add_f32 v138, v138, v98
  v_mfma_f32_16x16x32_bf16 v[172:175], a[112:115], v[40:43], v[172:175]
  v_nop
  v_add_f32 v139, v139, v99
  v_mfma_f32_16x16x32_bf16 v[172:175], a[120:123], v[48:51], v[172:175]
  s_bfe_u32 s46, s33, 0x40001
  s_add_u32 s40, s46, 192
  s_lshl_b32 s40, s40, 7
  v_mfma_f32_16x16x32_bf16 v[184:187], a[68:71], v[176:179], v[184:187]
  s_mov_b32 s83, s33
  v_lshl_add_u32 v120, v121, 2, s40
  v_add_f32 v152, v152, v100
  v_mfma_f32_16x16x32_bf16 v[184:187], a[76:79], v[192:195], v[184:187]
  buffer_load_dword v122, v120, s[20:23], 0 offen offset:64 sc1
  v_add_f32 v153, v153, v101
  v_mfma_f32_16x16x32_bf16 v[184:187], a[84:87], v[208:211], v[184:187]
  v_add_f32 v154, v154, v102
  v_add_f32 v155, v155, v103
  v_mfma_f32_16x16x32_bf16 v[184:187], a[92:95], v[224:227], v[184:187]
  v_cvt_pk_bf16_f32 v136, v136, v137
  v_cvt_pk_bf16_f32 v137, v138, v139
  v_mfma_f32_16x16x32_bf16 v[184:187], a[100:103], v[240:243], v[184:187]
  v_cvt_pk_bf16_f32 v138, v152, v153
  v_cvt_pk_bf16_f32 v139, v154, v155
  v_mfma_f32_16x16x32_bf16 v[184:187], a[108:111], v[4:7], v[184:187]
  v_or_b32 v136, 1, v136
  v_mfma_f32_16x16x32_bf16 v[184:187], a[116:119], v[12:15], v[184:187]
  s_add_u32 s66, s66, 0x10000
  buffer_store_dwordx4 v[136:139], v2, s[28:31], s66 offen offset:0 sc1
  v_accvgpr_read_b32 v104, a44
  v_mfma_f32_16x16x32_bf16 v[184:187], a[124:127], v[20:23], v[184:187]
  v_accvgpr_read_b32 v105, a45
  v_accvgpr_read_b32 v106, a46
  v_mfma_f32_16x16x32_bf16 v[188:191], a[68:71], v[180:183], v[188:191]
  v_accvgpr_read_b32 v107, a47
  v_lshl_or_b32 v96, v104, 16, s69
  v_mfma_f32_16x16x32_bf16 v[188:191], a[76:79], v[196:199], v[188:191]
  v_and_b32 v97, 0xffff0000, v104
  v_lshlrev_b32 v98, 16, v105
  v_mfma_f32_16x16x32_bf16 v[188:191], a[84:87], v[212:215], v[188:191]
  v_and_b32 v99, 0xffff0000, v105
  v_lshlrev_b32 v100, 16, v106
  v_mfma_f32_16x16x32_bf16 v[188:191], a[92:95], v[228:231], v[188:191]
  v_and_b32 v101, 0xffff0000, v106
  v_lshlrev_b32 v102, 16, v107
  v_mfma_f32_16x16x32_bf16 v[188:191], a[100:103], v[244:247], v[188:191]
  v_and_b32 v103, 0xffff0000, v107
  v_add_f32 v140, v140, v96
  v_mfma_f32_16x16x32_bf16 v[188:191], a[108:111], v[32:35], v[188:191]
  v_add_f32 v141, v141, v97
  v_add_f32 v142, v142, v98
  v_mfma_f32_16x16x32_bf16 v[188:191], a[116:119], v[40:43], v[188:191]
  v_add_f32 v143, v143, v99
  v_add_f32 v156, v156, v100
  v_mfma_f32_16x16x32_bf16 v[188:191], a[124:127], v[48:51], v[188:191]
  v_add_f32 v157, v157, v101
  v_add_f32 v158, v158, v102
  s_waitcnt lgkmcnt(0)
  v_mfma_f32_16x16x32_bf16 v[168:171], a[128:131], v[28:31], v[168:171]
  v_add_f32 v159, v159, v103
  v_xor_b32 v116, 0x10000, v116
  v_mfma_f32_16x16x32_bf16 v[172:175], a[128:131], v[56:59], v[172:175]
  v_cvt_pk_bf16_f32 v140, v140, v141
  v_cvt_pk_bf16_f32 v141, v142, v143
  v_mfma_f32_16x16x32_bf16 v[184:187], a[132:135], v[28:31], v[184:187]
  v_cvt_pk_bf16_f32 v142, v156, v157
  v_cvt_pk_bf16_f32 v143, v158, v159
  v_mfma_f32_16x16x32_bf16 v[188:191], a[132:135], v[56:59], v[188:191]
  v_or_b32 v140, 1, v140
  buffer_store_dwordx4 v[140:143], v2, s[28:31], s66 offen offset:1024 sc1
  v_cvt_pk_bf16_f32 v168, v168, v169
  v_cvt_pk_bf16_f32 v169, v170, v171
  s_nop 0
  v_cvt_pk_bf16_f32 v170, v184, v185
  v_cvt_pk_bf16_f32 v171, v186, v187
  v_or_b32 v168, 1, v168
  s_add_u32 s66, s66, 0x10000
  buffer_store_dwordx4 v[168:171], v2, s[28:31], s66 offen offset:0 sc1
  v_cvt_pk_bf16_f32 v172, v172, v173
  v_cvt_pk_bf16_f32 v173, v174, v175
  v_cvt_pk_bf16_f32 v174, v188, v189
  v_cvt_pk_bf16_f32 v175, v190, v191
  v_or_b32 v172, 1, v172
  buffer_store_dwordx4 v[172:175], v2, s[28:31], s66 offen offset:1024 sc1
  s_cmp_ge_u32 s33, 224
  s_cbranch_scc1 Lk_r101
  v_and_b32 v1, 63, v0
  v_mov_b32 v3, v121
  s_and_b32 s45, s33, 1
  s_lshr_b32 s33, s33, 5
  s_mov_b32 s41, 2
  s_cmp_lt_u32 s33, 4
  s_cmov_b32 s41, 1
  v_xor_b32 v121, s45, v121
  v_and_b32 v121, 1, v121
  v_xor_b32 v121, 1, v121
  v_mul_u32_u24 v121, s41, v121
  s_mul_i32 s40, s45, 7
  s_add_u32 s33, s33, s40
  s_mul_i32 s35, s46, 14
  s_add_u32 s35, s35, s33
  s_lshl_b32 s35, s35, 16
  s_lshl_b32 s40, s19, 11
  s_add_u32 s35, s35, s40
  s_add_u32 s35, s35, 0x9000000
  s_lshl_b32 s46, s46, 3
  s_lshl_b32 s40, s19, 1
  s_add_u32 s46, s46, s40
  s_mul_i32 s34, s46, 14
  s_add_u32 s34, s34, s33
  s_lshl_b32 s34, s34, 10
  s_waitcnt vmcnt(4)
  v_cmp_lt_u32 vcc, v122, v121
  s_nop 4
  s_cbranch_vccz Lk_go103
  s_mov_b32 s43, 0
Lk_poll102:
  s_sleep 3
  buffer_load_dword v122, v120, s[20:23], 0 offen offset:64 sc1
  s_waitcnt vmcnt(0)
  v_cmp_lt_u32 vcc, v122, v121
  s_nop 4
  s_cbranch_vccz Lk_go103
  s_add_u32 s43, s43, 1
  s_cmp_lt_u32 s43, 0x40000
  s_cbranch_scc1 Lk_poll102
Lk_go103:
  s_add_u32 s41, s35, 0
  buffer_load_dwordx4 v[128:131], v2, s[28:31], s41 offen offset:0 sc1
  buffer_load_dwordx4 v[132:135], v2, s[28:31], s41 offen offset:1024 sc1
  s_add_u32 s41, s35, 8192
  buffer_load_dwordx4 v[136:139], v2, s[28:31], s41 offen offset:0 sc1
  buffer_load_dwordx4 v[140:143], v2, s[28:31], s41 offen offset:1024 sc1
  s_add_u32 s41, s35, 16384
  buffer_load_dwordx4 v[144:147], v2, s[28:31], s41 offen offset:0 sc1
  buffer_load_dwordx4 v[148:151], v2, s[28:31], s41 offen offset:1024 sc1
  s_add_u32 s41, s35, 24576
  buffer_load_dwordx4 v[152:155], v2, s[28:31], s41 offen offset:0 sc1
  buffer_load_dwordx4 v[156:159], v2, s[28:31], s41 offen offset:1024 sc1
  s_add_u32 s41, s35, 32768
  buffer_load_dwordx4 v[160:163], v2, s[28:31], s41 offen offset:0 sc1
  buffer_load_dwordx4 v[164:167], v2, s[28:31], s41 offen offset:1024 sc1
  s_add_u32 s41, s35, 40960
  buffer_load_dwordx4 v[168:171], v2, s[28:31], s41 offen offset:0 sc1
  buffer_load_dwordx4 v[172:175], v2, s[28:31], s41 offen offset:1024 sc1
  s_add_u32 s41, s35, 49152
  buffer_load_dwordx4 v[176:179], v2, s[28:31], s41 offen offset:0 sc1
  buffer_load_dwordx4 v[180:183], v2, s[28:31], s41 offen offset:1024 sc1
  s_add_u32 s41, s35, 57344
  buffer_load_dwordx4 v[184:187], v2, s[28:31], s41 offen offset:0 sc1
  buffer_load_dwordx4 v[188:191], v2, s[28:31], s41 offen offset:1024 sc1
  v_add_u32 v6, 14336, v2
  s_add_u32 s40, s34, 0x4a00000
  buffer_load_dwordx4 v[52:55], v2, s[28:31], s40 offen sc1
  buffer_load_dwordx4 v[56:59], v6, s[28:31], s40 offen sc1
  v_bfe_u32 v8, v1, 4, 1
  v_lshlrev_b32 v8, 5, v8
  v_lshrrev_b32 v9, 5, v1
  v_lshl_add_u32 v8, v9, 4, v8
  s_mov_b32 s47, 0x4c00000
  s_lshl_b32 s43, s33, 6
  s_add_u32 s41, s46, 0
  s_lshl_b32 s41, s41, 4
  v_add_u32 v9, s41, v3
  v_lshlrev_b32 v10, 2, v9
  buffer_load_dword v12, v10, s[28:31], s47 offen sc1
  v_mul_u32_u24 v16, 896, v9
  v_add3_u32 v16, v16, v8, s43
  s_add_u32 s41, s46, 1
  s_lshl_b32 s41, s41, 4
  v_add_u32 v9, s41, v3
  v_lshlrev_b32 v10, 2, v9
  buffer_load_dword v13, v10, s[28:31], s47 offen sc1
  v_mul_u32_u24 v17, 896, v9
  v_add3_u32 v17, v17, v8, s43
  s_mov_b32 s38, 0
  s_mov_b32 s39, 0xffff8000
Lk_r104:
  s_waitcnt vmcnt(0)
  s_mov_b32 s36, 0
  v_and_b32 v11, v128, v132
  v_and_b32 v11, 1, v11
  v_cmp_eq_u32 vcc, 0, v11
  s_nop 4
  s_cbranch_vccz Lk_r106
  s_cmp_lg_u32 s36, 0
  s_cbranch_scc1 Lk_r107
  s_sleep 3
Lk_r107:
  s_add_u32 s41, s35, 0
  buffer_load_dwordx4 v[128:131], v2, s[28:31], s41 offen offset:0 sc1
  buffer_load_dwordx4 v[132:135], v2, s[28:31], s41 offen offset:1024 sc1
  s_mov_b32 s36, 1
Lk_r106:
  v_and_b32 v11, v136, v140
  v_and_b32 v11, 1, v11
  v_cmp_eq_u32 vcc, 0, v11
  s_nop 4
  s_cbranch_vccz Lk_r108
  s_cmp_lg_u32 s36, 0
  s_cbranch_scc1 Lk_r109
  s_sleep 3
Lk_r109:
  s_add_u32 s41, s35, 8192
  buffer_load_dwordx4 v[136:139], v2, s[28:31], s41 offen offset:0 sc1
  buffer_load_dwordx4 v[140:143], v2, s[28:31], s41 offen offset:1024 sc1
  s_mov_b32 s36, 1
Lk_r108:
  v_and_b32 v11, v144, v148
  v_and_b32 v11, 1, v11
  v_cmp_eq_u32 vcc, 0, v11
  s_nop 4
  s_cbranch_vccz Lk_r110
  s_cmp_lg_u32 s36, 0
  s_cbranch_scc1 Lk_r111
  s_sleep 3
Lk_r111:
  s_add_u32 s41, s35, 16384
  buffer_load_dwordx4 v[144:147], v2, s[28:31], s41 offen offset:0 sc1
  buffer_load_dwordx4 v[148:151], v2, s[28:31], s41 offen offset:1024 sc1
  s_mov_b32 s36, 1
Lk_r110:
  v_and_b32 v11, v152, v156
  v_and_b32 v11, 1, v11
  v_cmp_eq_u32 vcc, 0, v11
  s_nop 4
  s_cbranch_vccz Lk_r112
  s_cmp_lg_u32 s36, 0
  s_cbranch_scc1 Lk_r113
  s_sleep 3
Lk_r113:
  s_add_u32 s41, s35, 24576
  buffer_load_dwordx4 v[152:155], v2, s[28:31], s41 offen offset:0 sc1
  buffer_load_dwordx4 v[156:159], v2, s[28:31], s41 offen offset:1024 sc1
  s_mov_b32 s36, 1
Lk_r112:
  v_and_b32 v11, v160, v164
  v_and_b32 v11, 1, v11
  v_cmp_eq_u32 vcc, 0, v11
  s_nop 4
  s_cbranch_vccz Lk_r114
  s_cmp_lg_u32 s36, 0
  s_cbranch_scc1 Lk_r115
  s_sleep 3
Lk_r115:
  s_add_u32 s41, s35, 32768
  buffer_load_dwordx4 v[160:163], v2, s[28:31], s41 offen offset:0 sc1
  buffer_load_dwordx4 v[164:167], v2, s[28:31], s41 offen offset:1024 sc1
  s_mov_b32 s36, 1
Lk_r114:
  v_and_b32 v11, v168, v172
  v_and_b32 v11, 1, v11
  v_cmp_eq_u32 vcc, 0, v11
  s_nop 4
  s_cbranch_vccz Lk_r116
  s_cmp_lg_u32 s36, 0
  s_cbranch_scc1 Lk_r117
  s_sleep 3
Lk_r117:
  s_add_u32 s41, s35, 40960
  buffer_load_dwordx4 v[168:171], v2, s[28:31], s41 offen offset:0 sc1
  buffer_load_dwordx4 v[172:175], v2, s[28:31], s41 offen offset:1024 sc1
  s_mov_b32 s36, 1
Lk_r116:
  v_and_b32 v11, v176, v180
  v_and_b32 v11, 1, v11
  v_cmp_eq_u32 vcc, 0, v11
  s_nop 4
  s_cbranch_vccz Lk_r118
  s_cmp_lg_u32 s36, 0
  s_cbranch_scc1 Lk_r119
  s_sleep 3
Lk_r119:
  s_add_u32 s41, s35, 49152
  buffer_load_dwordx4 v[176:179], v2, s[28:31], s41 offen offset:0 sc1
  buffer_load_dwordx4 v[180:183], v2, s[28:31], s41 offen offset:1024 sc1
  s_mov_b32 s36, 1
Lk_r118:
  v_and_b32 v11, v184, v188
  v_and_b32 v11, 1, v11
  v_cmp_eq_u32 vcc, 0, v11
  s_nop 4
  s_cbranch_vccz Lk_r120
  s_cmp_lg_u32 s36, 0
  s_cbranch_scc1 Lk_r121
  s_sleep 3
Lk_r121:
  s_add_u32 s41, s35, 57344
  buffer_load_dwordx4 v[184:187], v2, s[28:31], s41 offen offset:0 sc1
  buffer_load_dwordx4 v[188:191], v2, s[28:31], s41 offen offset:1024 sc1
  s_mov_b32 s36, 1
Lk_r120:
  s_cmp_eq_u32 s36, 0
  s_cbranch_scc1 Lk_r105
  s_add_u32 s38, s38, 1
  s_cmp_lt_u32 s38, 0x40000
  s_cbranch_scc1 Lk_r104
  s_waitcnt vmcnt(0)
Lk_r105:
  s_mov_b32 s8, s4
  s_and_b32 s9, s5, 0xffff
  s_mov_b32 s10, 0x1c0000
  s_mov_b32 s11, 0x20000
  s_waitcnt vmcnt(1)
  v_lshl_add_u32 v20, v128, 16, s39
  v_and_b32 v21, 0xffff0000, v128
  v_lshlrev_b32 v22, 16, v129
  v_and_b32 v23, 0xffff0000, v129
  v_lshlrev_b32 v24, 16, v130
  v_and_b32 v25, 0xffff0000, v130
  v_lshlrev_b32 v26, 16, v131
  v_and_b32 v27, 0xffff0000, v131
  s_waitcnt vmcnt(0)
  v_lshl_add_u32 v28, v132, 16, s39
  v_and_b32 v29, 0xffff0000, v132
  v_lshlrev_b32 v30, 16, v133
  v_and_b32 v31, 0xffff0000, v133
  v_lshlrev_b32 v32, 16, v134
  v_and_b32 v33, 0xffff0000, v134
  v_lshlrev_b32 v34, 16, v135
  v_and_b32 v35, 0xffff0000, v135
  v_lshl_add_u32 v8, v136, 16, s39
  v_and_b32 v9, 0xffff0000, v136
  v_pk_add_f32 v[20:21], v[20:21], v[8:9]
  v_lshlrev_b32 v10, 16, v137
  v_and_b32 v11, 0xffff0000, v137
  v_pk_add_f32 v[22:23], v[22:23], v[10:11]
  v_lshlrev_b32 v8, 16, v138
  v_and_b32 v9, 0xffff0000, v138
  v_pk_add_f32 v[24:25], v[24:25], v[8:9]
  v_lshlrev_b32 v10, 16, v139
  v_and_b32 v11, 0xffff0000, v139
  v_pk_add_f32 v[26:27], v[26:27], v[10:11]
  v_lshl_add_u32 v8, v140, 16, s39
  v_and_b32 v9, 0xffff0000, v140
  v_pk_add_f32 v[28:29], v[28:29], v[8:9]
  v_lshlrev_b32 v10, 16, v141
  v_and_b32 v11, 0xffff0000, v141
  v_pk_add_f32 v[30:31], v[30:31], v[10:11]
  v_lshlrev_b32 v8, 16, v142
  v_and_b32 v9, 0xffff0000, v142
  v_pk_add_f32 v[32:33], v[32:33], v[8:9]
  v_lshlrev_b32 v10, 16, v143
  v_and_b32 v11, 0xffff0000, v143
  v_pk_add_f32 v[34:35], v[34:35], v[10:11]
  v_lshl_add_u32 v8, v144, 16, s39
  v_and_b32 v9, 0xffff0000, v144
  v_pk_add_f32 v[20:21], v[20:21], v[8:9]
  v_lshlrev_b32 v10, 16, v145
  v_and_b32 v11, 0xffff0000, v145
  v_pk_add_f32 v[22:23], v[22:23], v[10:11]
  v_lshlrev_b32 v8, 16, v146
  v_and_b32 v9, 0xffff0000, v146
  v_pk_add_f32 v[24:25], v[24:25], v[8:9]
  v_lshlrev_b32 v10, 16, v147
  v_and_b32 v11, 0xffff0000, v147
  v_pk_add_f32 v[26:27], v[26:27], v[10:11]
  v_lshl_add_u32 v8, v148, 16, s39
  v_and_b32 v9, 0xffff0000, v148
  v_pk_add_f32 v[28:29], v[28:29], v[8:9]
  v_lshlrev_b32 v10, 16, v149
  v_and_b32 v11, 0xffff0000, v149
  v_pk_add_f32 v[30:31], v[30:31], v[10:11]
  v_lshlrev_b32 v8, 16, v150
  v_and_b32 v9, 0xffff0000, v150
  v_pk_add_f32 v[32:33], v[32:33], v[8:9]
  v_lshlrev_b32 v10, 16, v151
  v_and_b32 v11, 0xffff0000, v151
  v_pk_add_f32 v[34:35], v[34:35], v[10:11]
  v_lshl_add_u32 v8, v152, 16, s39
  v_and_b32 v9, 0xffff0000, v152
  v_pk_add_f32 v[20:21], v[20:21], v[8:9]
  v_lshlrev_b32 v10, 16, v153
  v_and_b32 v11, 0xffff0000, v153
  v_pk_add_f32 v[22:23], v[22:23], v[10:11]
  v_lshlrev_b32 v8, 16, v154
  v_and_b32 v9, 0xffff0000, v154
  v_pk_add_f32 v[24:25], v[24:25], v[8:9]
  v_lshlrev_b32 v10, 16, v155
  v_and_b32 v11, 0xffff0000, v155
  v_pk_add_f32 v[26:27], v[26:27], v[10:11]
  v_lshl_add_u32 v8, v156, 16, s39
  v_and_b32 v9, 0xffff0000, v156
  v_pk_add_f32 v[28:29], v[28:29], v[8:9]
  v_lshlrev_b32 v10, 16, v157
  v_and_b32 v11, 0xffff0000, v157
  v_pk_add_f32 v[30:31], v[30:31], v[10:11]
  v_lshlrev_b32 v8, 16, v158
  v_and_b32 v9, 0xffff0000, v158
  v_pk_add_f32 v[32:33], v[32:33], v[8:9]
  v_lshlrev_b32 v10, 16, v159
  v_and_b32 v11, 0xffff0000, v159
  v_pk_add_f32 v[34:35], v[34:35], v[10:11]
  v_lshl_add_u32 v8, v160, 16, s39
  v_and_b32 v9, 0xffff0000, v160
  v_pk_add_f32 v[20:21], v[20:21], v[8:9]
  v_lshlrev_b32 v10, 16, v161
  v_and_b32 v11, 0xffff0000, v161
  v_pk_add_f32 v[22:23], v[22:23], v[10:11]
  v_lshlrev_b32 v8, 16, v162
  v_and_b32 v9, 0xffff0000, v162
  v_pk_add_f32 v[24:25], v[24:25], v[8:9]
  v_lshlrev_b32 v10, 16, v163
  v_and_b32 v11, 0xffff0000, v163
  v_pk_add_f32 v[26:27], v[26:27], v[10:11]
  v_lshl_add_u32 v8, v164, 16, s39
  v_and_b32 v9, 0xffff0000, v164
  v_pk_add_f32 v[28:29], v[28:29], v[8:9]
  v_lshlrev_b32 v10, 16, v165
  v_and_b32 v11, 0xffff0000, v165
  v_pk_add_f32 v[30:31], v[30:31], v[10:11]
  v_lshlrev_b32 v8, 16, v166
  v_and_b32 v9, 0xffff0000, v166
  v_pk_add_f32 v[32:33], v[32:33], v[8:9]
  v_lshlrev_b32 v10, 16, v167
  v_and_b32 v11, 0xffff0000, v167
  v_pk_add_f32 v[34:35], v[34:35], v[10:11]
  v_lshl_add_u32 v8, v168, 16, s39
  v_and_b32 v9, 0xffff0000, v168
  v_pk_add_f32 v[20:21], v[20:21], v[8:9]
  v_lshlrev_b32 v10, 16, v169
  v_and_b32 v11, 0xffff0000, v169
  v_pk_add_f32 v[22:23], v[22:23], v[10:11]
  v_lshlrev_b32 v8, 16, v170
  v_and_b32 v9, 0xffff0000, v170
  v_pk_add_f32 v[24:25], v[24:25], v[8:9]
  v_lshlrev_b32 v10, 16, v171
  v_and_b32 v11, 0xffff0000, v171
  v_pk_add_f32 v[26:27], v[26:27], v[10:11]
  v_lshl_add_u32 v8, v172, 16, s39
  v_and_b32 v9, 0xffff0000, v172
  v_pk_add_f32 v[28:29], v[28:29], v[8:9]
  v_lshlrev_b32 v10, 16, v173
  v_and_b32 v11, 0xffff0000, v173
  v_pk_add_f32 v[30:31], v[30:31], v[10:11]
  v_lshlrev_b32 v8, 16, v174
  v_and_b32 v9, 0xffff0000, v174
  v_pk_add_f32 v[32:33], v[32:33], v[8:9]
  v_lshlrev_b32 v10, 16, v175
  v_and_b32 v11, 0xffff0000, v175
  v_pk_add_f32 v[34:35], v[34:35], v[10:11]
  v_lshl_add_u32 v8, v176, 16, s39
  v_and_b32 v9, 0xffff0000, v176
  v_pk_add_f32 v[20:21], v[20:21], v[8:9]
  v_lshlrev_b32 v10, 16, v177
  v_and_b32 v11, 0xffff0000, v177
  v_pk_add_f32 v[22:23], v[22:23], v[10:11]
  v_lshlrev_b32 v8, 16, v178
  v_and_b32 v9, 0xffff0000, v178
  v_pk_add_f32 v[24:25], v[24:25], v[8:9]
  v_lshlrev_b32 v10, 16, v179
  v_and_b32 v11, 0xffff0000, v179
  v_pk_add_f32 v[26:27], v[26:27], v[10:11]
  v_lshl_add_u32 v8, v180, 16, s39
  v_and_b32 v9, 0xffff0000, v180
  v_pk_add_f32 v[28:29], v[28:29], v[8:9]
  v_lshlrev_b32 v10, 16, v181
  v_and_b32 v11, 0xffff0000, v181
  v_pk_add_f32 v[30:31], v[30:31], v[10:11]
  v_lshlrev_b32 v8, 16, v182
  v_and_b32 v9, 0xffff0000, v182
  v_pk_add_f32 v[32:33], v[32:33], v[8:9]
  v_lshlrev_b32 v10, 16, v183
  v_and_b32 v11, 0xffff0000, v183
  v_pk_add_f32 v[34:35], v[34:35], v[10:11]
  v_lshl_add_u32 v8, v184, 16, s39
  v_and_b32 v9, 0xffff0000, v184
  v_pk_add_f32 v[20:21], v[20:21], v[8:9]
  v_lshlrev_b32 v10, 16, v185
  v_and_b32 v11, 0xffff0000, v185
  v_pk_add_f32 v[22:23], v[22:23], v[10:11]
  v_lshlrev_b32 v8, 16, v186
  v_and_b32 v9, 0xffff0000, v186
  v_pk_add_f32 v[24:25], v[24:25], v[8:9]
  v_lshlrev_b32 v10, 16, v187
  v_and_b32 v11, 0xffff0000, v187
  v_pk_add_f32 v[26:27], v[26:27], v[10:11]
  v_lshl_add_u32 v8, v188, 16, s39
  v_and_b32 v9, 0xffff0000, v188
  v_pk_add_f32 v[28:29], v[28:29], v[8:9]
  v_lshlrev_b32 v10, 16, v189
  v_and_b32 v11, 0xffff0000, v189
  v_pk_add_f32 v[30:31], v[30:31], v[10:11]
  v_lshlrev_b32 v8, 16, v190
  v_and_b32 v9, 0xffff0000, v190
  v_pk_add_f32 v[32:33], v[32:33], v[8:9]
  v_lshlrev_b32 v10, 16, v191
  v_and_b32 v11, 0xffff0000, v191
  v_pk_add_f32 v[34:35], v[34:35], v[10:11]
  v_sub_f32 v12, 1.0, v12
  v_lshlrev_b32 v8, 16, v52
  v_and_b32 v9, 0xffff0000, v52
  v_fma_f32 v20, v8, v12, v20
  v_fma_f32 v21, v9, v12, v21
  v_lshlrev_b32 v10, 16, v53
  v_and_b32 v11, 0xffff0000, v53
  v_fma_f32 v22, v10, v12, v22
  v_fma_f32 v23, v11, v12, v23
  v_lshlrev_b32 v8, 16, v54
  v_and_b32 v9, 0xffff0000, v54
  v_fma_f32 v24, v8, v12, v24
  v_fma_f32 v25, v9, v12, v25
  v_lshlrev_b32 v10, 16, v55
  v_and_b32 v11, 0xffff0000, v55
  v_fma_f32 v26, v10, v12, v26
  v_fma_f32 v27, v11, v12, v27
  v_cvt_pk_bf16_f32 v52, v20, v21
  v_cvt_pk_bf16_f32 v53, v22, v23
  v_cvt_pk_bf16_f32 v54, v24, v25
  v_cvt_pk_bf16_f32 v55, v26, v27
  s_nop 0
  v_permlane16_swap_b32 v52, v54
  v_permlane16_swap_b32 v53, v55
  buffer_store_dwordx4 v[52:55], v16, s[8:11], 0 offen offset:0
  v_sub_f32 v13, 1.0, v13
  v_lshlrev_b32 v8, 16, v56
  v_and_b32 v9, 0xffff0000, v56
  v_fma_f32 v28, v8, v13, v28
  v_fma_f32 v29, v9, v13, v29
  v_lshlrev_b32 v10, 16, v57
  v_and_b32 v11, 0xffff0000, v57
  v_fma_f32 v30, v10, v13, v30
  v_fma_f32 v31, v11, v13, v31
  v_lshlrev_b32 v8, 16, v58
  v_and_b32 v9, 0xffff0000, v58
  v_fma_f32 v32, v8, v13, v32
  v_fma_f32 v33, v9, v13, v33
  v_lshlrev_b32 v10, 16, v59
  v_and_b32 v11, 0xffff0000, v59
  v_fma_f32 v34, v10, v13, v34
  v_fma_f32 v35, v11, v13, v35
  v_cvt_pk_bf16_f32 v56, v28, v29
  v_cvt_pk_bf16_f32 v57, v30, v31
  v_cvt_pk_bf16_f32 v58, v32, v33
  v_cvt_pk_bf16_f32 v59, v34, v35
  s_nop 0
  v_permlane16_swap_b32 v56, v58
  v_permlane16_swap_b32 v57, v59
  buffer_store_dwordx4 v[56:59], v17, s[8:11], 0 offen offset:0
Lk_r101:
  s_endpgm
Lk_fix83:
  v_max_f32 v120, 0, v84
  v_sub_f32 v84, v84, v120
  v_exp_f32 v120, -v120
  v_max_f32 v121, 0, v86
  v_sub_f32 v86, v86, v121
  v_exp_f32 v121, -v121
  v_mul_f32 v128, v128, v120
  v_mul_f32 v129, v129, v120
  v_mul_f32 v130, v130, v120
  v_mul_f32 v131, v131, v120
  v_mul_f32 v132, v132, v121
  v_mul_f32 v133, v133, v121
  v_mul_f32 v134, v134, v121
  v_mul_f32 v135, v135, v121
  v_mul_f32 v136, v136, v120
  v_mul_f32 v137, v137, v120
  v_mul_f32 v138, v138, v120
  v_mul_f32 v139, v139, v120
  v_mul_f32 v140, v140, v121
  v_mul_f32 v141, v141, v121
  v_mul_f32 v142, v142, v121
  v_mul_f32 v143, v143, v121
  v_mul_f32 v144, v144, v120
  v_mul_f32 v145, v145, v120
  v_mul_f32 v146, v146, v120
  v_mul_f32 v147, v147, v120
  v_mul_f32 v148, v148, v121
  v_mul_f32 v149, v149, v121
  v_mul_f32 v150, v150, v121
  v_mul_f32 v151, v151, v121
  v_mul_f32 v152, v152, v120
  v_mul_f32 v153, v153, v120
  v_mul_f32 v154, v154, v120
  v_mul_f32 v155, v155, v120
  v_mul_f32 v156, v156, v121
  v_mul_f32 v157, v157, v121
  v_mul_f32 v158, v158, v121
  v_mul_f32 v159, v159, v121
  v_mul_f32 v160, v160, v120
  v_mul_f32 v161, v161, v120
  v_mul_f32 v162, v162, v120
  v_mul_f32 v163, v163, v120
  v_mul_f32 v164, v164, v121
  v_mul_f32 v165, v165, v121
  v_mul_f32 v166, v166, v121
  v_mul_f32 v167, v167, v121
  v_mul_f32 v168, v168, v120
  v_mul_f32 v169, v169, v120
  v_mul_f32 v170, v170, v120
  v_mul_f32 v171, v171, v120
  v_mul_f32 v172, v172, v121
  v_mul_f32 v173, v173, v121
  v_mul_f32 v174, v174, v121
  v_mul_f32 v175, v175, v121
  v_mul_f32 v176, v176, v120
  v_mul_f32 v177, v177, v120
  v_mul_f32 v178, v178, v120
  v_mul_f32 v179, v179, v120
  v_mul_f32 v180, v180, v121
  v_mul_f32 v181, v181, v121
  v_mul_f32 v182, v182, v121
  v_mul_f32 v183, v183, v121
  v_mul_f32 v184, v184, v120
  v_mul_f32 v185, v185, v120
  v_mul_f32 v186, v186, v120
  v_mul_f32 v187, v187, v120
  v_mul_f32 v188, v188, v121
  v_mul_f32 v189, v189, v121
  v_mul_f32 v190, v190, v121
  v_mul_f32 v191, v191, v121
  v_mul_f32 v192, v192, v120
  v_mul_f32 v193, v193, v120
  v_mul_f32 v194, v194, v120
  v_mul_f32 v195, v195, v120
  v_mul_f32 v196, v196, v121
  v_mul_f32 v197, v197, v121
  v_mul_f32 v198, v198, v121
  v_mul_f32 v199, v199, v121
  v_mul_f32 v200, v200, v120
  v_mul_f32 v201, v201, v120
  v_mul_f32 v202, v202, v120
  v_mul_f32 v203, v203, v120
  v_mul_f32 v204, v204, v121
  v_mul_f32 v205, v205, v121
  v_mul_f32 v206, v206, v121
  v_mul_f32 v207, v207, v121
  v_mul_f32 v208, v208, v120
  v_mul_f32 v209, v209, v120
  v_mul_f32 v210, v210, v120
  v_mul_f32 v211, v211, v120
  v_mul_f32 v212, v212, v121
  v_mul_f32 v213, v213, v121
  v_mul_f32 v214, v214, v121
  v_mul_f32 v215, v215, v121
  v_mul_f32 v216, v216, v120
  v_mul_f32 v217, v217, v120
  v_mul_f32 v218, v218, v120
  v_mul_f32 v219, v219, v120
  v_mul_f32 v220, v220, v121
  v_mul_f32 v221, v221, v121
  v_mul_f32 v222, v222, v121
  v_mul_f32 v223, v223, v121
  v_mul_f32 v224, v224, v120
  v_mul_f32 v225, v225, v120
  v_mul_f32 v226, v226, v120
  v_mul_f32 v227, v227, v120
  v_mul_f32 v228, v228, v121
  v_mul_f32 v229, v229, v121
  v_mul_f32 v230, v230, v121
  v_mul_f32 v231, v231, v121
  v_mul_f32 v232, v232, v120
  v_mul_f32 v233, v233, v120
  v_mul_f32 v234, v234, v120
  v_mul_f32 v235, v235, v120
  v_mul_f32 v236, v236, v121
  v_mul_f32 v237, v237, v121
  v_mul_f32 v238, v238, v121
  v_mul_f32 v239, v239, v121
  v_mul_f32 v240, v240, v120
  v_mul_f32 v241, v241, v120
  v_mul_f32 v242, v242, v120
  v_mul_f32 v243, v243, v120
  v_mul_f32 v244, v244, v121
  v_mul_f32 v245, v245, v121
  v_mul_f32 v246, v246, v121
  v_mul_f32 v247, v247, v121
  v_mul_f32 v248, v248, v120
  v_mul_f32 v249, v249, v120
  v_mul_f32 v250, v250, v120
  v_mul_f32 v251, v251, v120
  v_mul_f32 v252, v252, v121
  v_mul_f32 v253, v253, v121
  v_mul_f32 v254, v254, v121
  v_mul_f32 v255, v255, v121
  v_mul_f32 v88, v88, v120
  v_mul_f32 v92, v92, v121
  s_branch Lk_fr84
Lk_end:
  s_endpgm
.section .rodata,"a"
.p2align 6
.amdhsa_kernel gated_mix__compressed_kv_cla__mixer_s_mlp__prompt_kernel
  .amdhsa_next_free_vgpr 512
  .amdhsa_next_free_sgpr 102
  .amdhsa_accum_offset 256
  .amdhsa_group_segment_fixed_size 0
  .amdhsa_kernarg_size 120
  .amdhsa_user_sgpr_count 2
  .amdhsa_user_sgpr_kernarg_segment_ptr 1
  .amdhsa_system_sgpr_workgroup_id_x 1
  .amdhsa_float_denorm_mode_32 3
  .amdhsa_float_denorm_mode_16_64 3
.end_amdhsa_kernel
```
